```python
import torch

def _softmax(x, axis=-1):
    return torch.softmax(x, dim=axis)
def _gelu(x):
    return torch.nn.functional.gelu(x, approximate="tanh")
def _silu(x):
    return torch.nn.functional.silu(x)
def _sigmoid(x):
    return torch.sigmoid(x)
def _layernorm(x, axis=-1, eps=1e-5):
    m = x.mean(dim=axis, keepdim=True)
    v = x.var(dim=axis, keepdim=True, unbiased=False)
    return (x - m) / torch.sqrt(v + eps)
def _scatter_add(tgt, idx, src, axis=0):
    return tgt.clone().index_add_(axis, idx, src)
def _segment_sum(src, seg, n):
    out = torch.zeros((n,) + src.shape[1:], dtype=src.dtype)
    return out.index_add_(0, seg, src)
def _pad(x, pw):
    flat = tuple(v for pair in reversed(pw) for v in pair)
    return torch.nn.functional.pad(x, flat)

kernel_name = 'standalone__normalfloat_lut_af4__prompt'

def setup_inputs():

    _w = (lambda a: (lambda t: t.to(torch.bfloat16) if t.is_floating_point() else t)(torch.as_tensor(a)))
    B, S, D, F = 1, 2048, 1024, 3584
    G = -1 if -1 > 0 else D
    D = (D // G) * G
    ng = D // G
    nf4 = torch.tensor([
        -1.0, -0.6961928009986877, -0.5250730514526367, -0.39491748809814453,
        -0.28444138169288635, -0.18477343022823334, -0.09105003625154495, 0.0,
        0.07958029955625534, 0.16093020141124725, 0.24611230194568634,
        0.33791524171829224, 0.44070982933044434, 0.5626170039176941,
        0.7229568362236023, 1.0,
    ], dtype=float)
    qw = torch.randint(0, 16, (D, F)).to(torch.int64)
    return {
        "x": _w((lambda *s: torch.randn(*s, dtype=torch.bfloat16) * 0.05)(B, S, D)),
        "qw": _w(qw),
        "lut": _w(nf4),
        "scales": _w(torch.abs((lambda *s: torch.randn(*s, dtype=torch.bfloat16) * 0.05)(ng, F)).to(float) + 0.01),
    }

def reference(x, qw, lut, scales):
    B, S, D = x.shape
    ng, F = scales.shape
    G = D // ng
    deq = lut[qw]
    s = (lambda x, n, axis: torch.repeat_interleave(x, n, dim=axis))(scales, G, axis=0)
    w = (lambda x, dt: x.to(dt))(deq, x.dtype) * (lambda x, dt: x.to(dt))(s, x.dtype)
    return torch.einsum("bsd,df->bsf", x, w)
```

```asm
; @launch kernel=af4_pack_kernel grid=(448,1,1) block=(256,1,1) lds=0
; @launch kernel=af4_gemm_kernel grid=(256,1,1) block=(256,1,1) lds=163840
.amdgcn_target "amdgcn-amd-amdhsa--gfx950"
.text
.globl af4_pack_kernel
.p2align 8
.type af4_pack_kernel,@function
af4_pack_kernel:
    s_cmp_ge_u32 s2, 448
    s_cbranch_scc1 L_pack_end
    s_load_dwordx4 s[4:7], s[0:1], 0
    s_load_dwordx2 s[12:13], s[0:1], 48
    v_lshrrev_b32 v1, 6, v0
    v_and_b32 v2, 63, v0
    v_readfirstlane_b32 s3, v1
    v_lshlrev_b32 v3, 4, v2
    s_lshl_b32 s16, s2, 2
    s_add_u32 s16, s16, s3
    s_mul_hi_u32 s17, s16, 306783379
    s_mul_i32 s18, s17, 14
    s_sub_u32 s18, s16, s18
    s_lshl_b32 s18, s18, 10
    s_mul_i32 s19, s17, 114688
    s_add_u32 s19, s19, s18
    s_mul_i32 s20, s17, 14336
    s_add_u32 s20, s20, s18
    s_waitcnt lgkmcnt(0)
    s_mov_b32 s8, s6
    s_mov_b32 s9, s7
    s_mov_b32 s10, 14680064
    s_mov_b32 s11, 0x20000
    s_mov_b32 s14, 1835008
    s_mov_b32 s15, 0x20000
    buffer_load_dwordx4 v[8:11], v3, s[8:11], s19 offen
    s_add_u32 s19, s19, 14336
    buffer_load_dwordx4 v[12:15], v3, s[8:11], s19 offen
    s_add_u32 s19, s19, 14336
    buffer_load_dwordx4 v[16:19], v3, s[8:11], s19 offen
    s_add_u32 s19, s19, 14336
    buffer_load_dwordx4 v[20:23], v3, s[8:11], s19 offen
    s_add_u32 s19, s19, 14336
    buffer_load_dwordx4 v[24:27], v3, s[8:11], s19 offen
    s_add_u32 s19, s19, 14336
    buffer_load_dwordx4 v[28:31], v3, s[8:11], s19 offen
    s_add_u32 s19, s19, 14336
    buffer_load_dwordx4 v[32:35], v3, s[8:11], s19 offen
    s_add_u32 s19, s19, 14336
    buffer_load_dwordx4 v[36:39], v3, s[8:11], s19 offen
    s_mov_b32 s6, 4194304
    s_mov_b32 s7, 0x20000
    s_lshl_b32 s21, s16, 13
    v_lshlrev_b32 v4, 7, v2
    buffer_load_dword v5, v4, s[4:7], s21 offen
    s_waitcnt vmcnt(7)
    v_lshl_or_b32 v8, v12, 4, v8
    v_lshl_or_b32 v9, v13, 4, v9
    v_lshl_or_b32 v10, v14, 4, v10
    v_lshl_or_b32 v11, v15, 4, v11
    s_waitcnt vmcnt(6)
    v_lshl_or_b32 v8, v16, 8, v8
    v_lshl_or_b32 v9, v17, 8, v9
    v_lshl_or_b32 v10, v18, 8, v10
    v_lshl_or_b32 v11, v19, 8, v11
    s_waitcnt vmcnt(5)
    v_lshl_or_b32 v8, v20, 12, v8
    v_lshl_or_b32 v9, v21, 12, v9
    v_lshl_or_b32 v10, v22, 12, v10
    v_lshl_or_b32 v11, v23, 12, v11
    s_waitcnt vmcnt(4)
    v_lshl_or_b32 v8, v24, 16, v8
    v_lshl_or_b32 v9, v25, 16, v9
    v_lshl_or_b32 v10, v26, 16, v10
    v_lshl_or_b32 v11, v27, 16, v11
    s_waitcnt vmcnt(3)
    v_lshl_or_b32 v8, v28, 20, v8
    v_lshl_or_b32 v9, v29, 20, v9
    v_lshl_or_b32 v10, v30, 20, v10
    v_lshl_or_b32 v11, v31, 20, v11
    s_waitcnt vmcnt(2)
    v_lshl_or_b32 v8, v32, 24, v8
    v_lshl_or_b32 v9, v33, 24, v9
    v_lshl_or_b32 v10, v34, 24, v10
    v_lshl_or_b32 v11, v35, 24, v11
    s_waitcnt vmcnt(1)
    v_lshl_or_b32 v8, v36, 28, v8
    v_lshl_or_b32 v9, v37, 28, v9
    v_lshl_or_b32 v10, v38, 28, v10
    v_lshl_or_b32 v11, v39, 28, v11
    buffer_store_dwordx4 v[8:11], v3, s[12:15], s20 offen
L_pack_end:
    s_endpgm

.text
.globl af4_gemm_kernel
.p2align 8
.type af4_gemm_kernel,@function
af4_gemm_kernel:
    s_cmp_ge_u32 s2, 256
    s_cbranch_scc1 L_end
    s_load_dwordx2 s[8:9], s[0:1], 0
    s_load_dwordx4 s[20:23], s[0:1], 16
    s_load_dwordx2 s[16:17], s[0:1], 32
    s_load_dwordx2 s[12:13], s[0:1], 48
    s_and_b32 s60, s2, 7
    s_lshr_b32 s61, s2, 3
    s_and_b32 s58, s60, 3
    s_lshl_b32 s58, s58, 2
    s_and_b32 s62, s61, 3
    s_add_u32 s58, s58, s62
    s_lshr_b32 s59, s60, 2
    s_lshl_b32 s59, s59, 3
    s_lshr_b32 s62, s61, 2
    s_add_u32 s59, s59, s62
    v_lshrrev_b32 v1, 6, v0
    v_and_b32 v2, 63, v0
    v_readfirstlane_b32 s63, v1
    v_lshrrev_b32 v3, 4, v2
    v_and_b32 v4, 15, v2
    s_and_b32 s64, s63, 1
    s_lshr_b32 s65, s63, 1
    v_and_b32 v5, 15, v0
    v_lshlrev_b32 v5, 1, v5
    v_lshrrev_b32 v6, 4, v0
    v_lshlrev_b32 v6, 1, v6
    s_mul_i32 s66, s59, 224
    s_mul_i32 s67, s65, 112
    s_add_u32 s66, s66, s67
    s_mul_i32 s67, s64, 48
    s_add_u32 s67, s66, s67
    v_mul_u32_u24 v7, 14336, v3
    s_mul_i32 s68, s64, 114688
    s_lshl_b32 s69, s67, 2
    s_add_u32 s70, s69, s68
    v_mad_u32_u24 v33, v4, 12, v7
    v_add_u32 v32, s70, v33
    s_sub_u32 s70, 114688, s68
    s_add_u32 s70, s70, s69
    v_add_u32 v33, s70, v33
    s_add_u32 s70, s66, 96
    s_lshl_b32 s70, s70, 2
    s_add_u32 s70, s70, s68
    v_lshl_add_u32 v34, v4, 2, v7
    v_add_u32 v34, s70, v34
    v_lshrrev_b32 v8, 3, v2
    v_and_b32 v9, 7, v2
    v_xor_b32 v9, v9, v3
    s_lshl_b32 s70, s63, 5
    v_add_u32 v8, s70, v8
    v_lshlrev_b32 v8, 11, v8
    v_lshl_add_u32 v36, v9, 4, v8
    v_xor_b32 v37, 64, v36
    v_add_u32 v38, 30720, v36
    v_add_u32 v37, 15360, v37
    v_add_u32 v39, 30720, v37
    s_waitcnt lgkmcnt(0)
    s_mov_b32 s10, 4194304
    s_mov_b32 s11, 0x20000
    s_mov_b32 s14, 1835008
    s_mov_b32 s15, 0x20000
    s_mov_b32 s28, s20
    s_mov_b32 s29, s21
    s_mov_b32 s30, 32
    s_mov_b32 s31, 0x20000
    buffer_load_ushort v24, v5, s[28:31], 0 offen
    buffer_load_ushort v23, v6, s[28:31], 0 offen
    s_lshl_b32 s56, s58, 18
    s_lshl_b32 s57, s63, 12
    s_add_u32 s57, s57, 65536
    s_xor_b32 s71, s63, 2
    s_lshl_b32 s71, s71, 12
    s_add_u32 s71, s71, 81920
    s_mov_b32 s40, 0
    s_mov_b32 s41, 57344
    s_mov_b32 s42, 229376
    s_mov_b32 s43, 286720
    s_mov_b32 s44, 458752
    s_mov_b32 s45, 516096
    s_mov_b32 s46, 688128
    s_mov_b32 s47, 745472
    s_mov_b32 s48, 917504
    s_mov_b32 s49, 974848
    s_mov_b32 s50, 1146880
    s_mov_b32 s51, 1204224
    s_mov_b32 s52, 1376256
    s_mov_b32 s53, 1433600
    s_mov_b32 s54, 1605632
    s_mov_b32 s55, 1662976
    buffer_load_dwordx3 v[64:66], v32, s[12:15], s40 offen
    buffer_load_dwordx3 v[68:70], v32, s[12:15], s41 offen
    buffer_load_dword v67, v34, s[12:15], s40 offen
    buffer_load_dword v71, v34, s[12:15], s41 offen
    buffer_load_dwordx3 v[72:74], v33, s[12:15], s40 offen
    buffer_load_dwordx3 v[76:78], v33, s[12:15], s41 offen
    s_add_u32 m0, s57, 32768
    s_nop 0
    buffer_load_dwordx4 v36, s[8:11], s56 offen offset:0 lds
    buffer_load_dwordx4 v37, s[8:11], s56 offen offset:1024 lds
    buffer_load_dwordx4 v38, s[8:11], s56 offen offset:2048 lds
    buffer_load_dwordx4 v39, s[8:11], s56 offen offset:3072 lds
    s_add_u32 m0, s71, 32768
    s_add_u32 s56, s56, 128
    buffer_load_dwordx4 v36, s[8:11], s56 offen offset:0 lds
    buffer_load_dwordx4 v37, s[8:11], s56 offen offset:1024 lds
    buffer_load_dwordx4 v38, s[8:11], s56 offen offset:2048 lds
    buffer_load_dwordx4 v39, s[8:11], s56 offen offset:3072 lds
    buffer_load_dwordx3 v[80:82], v32, s[12:15], s42 offen
    buffer_load_dwordx3 v[84:86], v32, s[12:15], s43 offen
    buffer_load_dword v83, v34, s[12:15], s42 offen
    buffer_load_dword v87, v34, s[12:15], s43 offen
    buffer_load_dwordx3 v[88:90], v33, s[12:15], s42 offen
    buffer_load_dwordx3 v[92:94], v33, s[12:15], s43 offen
    s_add_u32 m0, s57, 65536
    s_add_u32 s56, s56, 128
    buffer_load_dwordx4 v36, s[8:11], s56 offen offset:0 lds
    buffer_load_dwordx4 v37, s[8:11], s56 offen offset:1024 lds
    buffer_load_dwordx4 v38, s[8:11], s56 offen offset:2048 lds
    buffer_load_dwordx4 v39, s[8:11], s56 offen offset:3072 lds
    s_add_u32 m0, s71, 65536
    s_add_u32 s56, s56, 128
    buffer_load_dwordx4 v36, s[8:11], s56 offen offset:0 lds
    buffer_load_dwordx4 v37, s[8:11], s56 offen offset:1024 lds
    buffer_load_dwordx4 v38, s[8:11], s56 offen offset:2048 lds
    buffer_load_dwordx4 v39, s[8:11], s56 offen offset:3072 lds
    s_mov_b32 s32, s22
    s_mov_b32 s33, s23
    s_mov_b32 s34, 7168
    s_mov_b32 s35, 0x20000
    v_mul_u32_u24 v10, 24, v3
    s_lshl_b32 s70, s67, 1
    v_add_u32 v10, s70, v10
    s_add_u32 s70, s66, 96
    s_lshl_b32 s70, s70, 1
    v_lshl_add_u32 v12, v3, 3, s70
    buffer_load_dwordx4 v[48:51], v10, s[32:35], 0 offen
    buffer_load_dwordx2 v[52:53], v10, s[32:35], 0 offen offset:16
    buffer_load_dwordx2 v[54:55], v12, s[32:35], 0 offen
    buffer_load_dwordx3 v[96:98], v32, s[12:15], s44 offen
    buffer_load_dwordx3 v[100:102], v32, s[12:15], s45 offen
    buffer_load_dword v99, v34, s[12:15], s44 offen
    buffer_load_dword v103, v34, s[12:15], s45 offen
    buffer_load_dwordx3 v[104:106], v33, s[12:15], s44 offen
    buffer_load_dwordx3 v[108:110], v33, s[12:15], s45 offen
    s_add_u32 m0, s57, 0
    s_add_u32 s56, s56, 128
    buffer_load_dwordx4 v36, s[8:11], s56 offen offset:0 lds
    buffer_load_dwordx4 v37, s[8:11], s56 offen offset:1024 lds
    buffer_load_dwordx4 v38, s[8:11], s56 offen offset:2048 lds
    buffer_load_dwordx4 v39, s[8:11], s56 offen offset:3072 lds
    s_add_u32 m0, s71, 0
    s_add_u32 s56, s56, 128
    buffer_load_dwordx4 v36, s[8:11], s56 offen offset:0 lds
    buffer_load_dwordx4 v37, s[8:11], s56 offen offset:1024 lds
    buffer_load_dwordx4 v38, s[8:11], s56 offen offset:2048 lds
    buffer_load_dwordx4 v39, s[8:11], s56 offen offset:3072 lds
    s_mov_b32 s18, 14680064
    s_mov_b32 s19, 0x20000
    s_mov_b32 s36, 202114048
    s_mov_b32 s37, 202114304
    s_mov_b32 s38, 202114560
    s_mov_b32 s39, 202114816
    v_and_b32 v35, 31, v2
    v_lshlrev_b32 v35, 2, v35
    v_lshrrev_b32 v8, 1, v4
    v_xor_b32 v8, v8, v3
    v_lshlrev_b32 v8, 4, v8
    v_lshl_add_u32 v8, v4, 7, v8
    s_lshl_b32 s70, s64, 14
    s_add_u32 s72, s70, 65536
    s_sub_u32 s73, 81920, s70
    v_add_u32 v40, s72, v8
    v_add_u32 v42, s73, v8
    v_xor_b32 v41, 64, v40
    v_xor_b32 v43, 64, v42
    v_add_u32 v44, 65536, v40
    v_add_u32 v45, 65536, v41
    v_add_u32 v46, 65536, v42
    v_add_u32 v47, 65536, v43
    v_mul_u32_u24 v8, 464, v4
    s_mul_i32 s70, s64, 29696
    s_mul_i32 s72, s65, 224
    s_add_u32 s72, s72, 65536
    s_mul_i32 s73, s64, 96
    s_add_u32 s73, s73, s72
    v_mad_u32_u24 v9, v3, 24, v8
    s_add_u32 s74, s73, s70
    v_add_u32 v26, s74, v9
    s_sub_u32 s74, 29696, s70
    s_add_u32 s74, s74, s73
    v_add_u32 v27, s74, v9
    s_add_u32 s74, s72, s70
    s_add_u32 s74, s74, 192
    v_lshl_add_u32 v28, v3, 3, v8
    v_add_u32 v28, s74, v28
    s_mov_b32 s72, 153391690
    s_mul_i32 s73, s63, 7424
    s_add_u32 s73, s73, 65536
    s_lshl_b32 s74, s58, 7
    s_lshl_b32 s75, s63, 4
    s_add_u32 s74, s74, s75
    s_mul_i32 s74, s74, 7168
    s_mul_i32 s75, s59, 448
    s_add_u32 s74, s74, s75
    v_add_u32 v29, 0, v2
    v_mul_hi_u32 v30, v29, s72
    v_lshlrev_b32 v29, 4, v29
    v_mad_u32_u24 v31, v30, 16, v29
    v_add_u32 v8, s73, v31
    v_mul_u32_u24 v30, 6720, v30
    v_add3_u32 v16, v30, v29, s74
    v_add_u32 v29, 64, v2
    v_mul_hi_u32 v30, v29, s72
    v_lshlrev_b32 v29, 4, v29
    v_mad_u32_u24 v31, v30, 16, v29
    v_add_u32 v9, s73, v31
    v_mul_u32_u24 v30, 6720, v30
    v_add3_u32 v17, v30, v29, s74
    v_add_u32 v29, 128, v2
    v_mul_hi_u32 v30, v29, s72
    v_lshlrev_b32 v29, 4, v29
    v_mad_u32_u24 v31, v30, 16, v29
    v_add_u32 v10, s73, v31
    v_mul_u32_u24 v30, 6720, v30
    v_add3_u32 v18, v30, v29, s74
    v_add_u32 v29, 192, v2
    v_mul_hi_u32 v30, v29, s72
    v_lshlrev_b32 v29, 4, v29
    v_mad_u32_u24 v31, v30, 16, v29
    v_add_u32 v11, s73, v31
    v_mul_u32_u24 v30, 6720, v30
    v_add3_u32 v19, v30, v29, s74
    v_add_u32 v29, 256, v2
    v_mul_hi_u32 v30, v29, s72
    v_lshlrev_b32 v29, 4, v29
    v_mad_u32_u24 v31, v30, 16, v29
    v_add_u32 v12, s73, v31
    v_mul_u32_u24 v30, 6720, v30
    v_add3_u32 v20, v30, v29, s74
    v_add_u32 v29, 320, v2
    v_mul_hi_u32 v30, v29, s72
    v_lshlrev_b32 v29, 4, v29
    v_mad_u32_u24 v31, v30, 16, v29
    v_add_u32 v13, s73, v31
    v_mul_u32_u24 v30, 6720, v30
    v_add3_u32 v21, v30, v29, s74
    v_add_u32 v29, 384, v2
    v_mul_hi_u32 v30, v29, s72
    v_lshlrev_b32 v29, 4, v29
    v_mad_u32_u24 v31, v30, 16, v29
    v_add_u32 v14, s73, v31
    v_mul_u32_u24 v30, 6720, v30
    v_add3_u32 v22, v30, v29, s74
    s_lshl_b32 s70, s63, 12
    s_add_u32 s70, s70, 131072
    v_lshl_add_u32 v29, v2, 4, s70
    v_xor_b32 v30, 4096, v29
    v_and_b32 v25, 7, v0
    v_lshlrev_b32 v25, 4, v25
    v_lshl_add_u32 v25, v0, 8, v25
    s_waitcnt vmcnt(45)
    v_lshl_or_b32 v56, v23, 16, v24
    v_lshl_or_b32 v57, v23, 16, v24
    v_lshl_or_b32 v58, v23, 16, v24
    v_lshl_or_b32 v59, v23, 16, v24
    ds_write_b128 v25, v[56:59]
    v_xor_b32 v61, 16, v25
    ds_write_b128 v61, v[56:59]
    v_xor_b32 v60, 32, v25
    ds_write_b128 v60, v[56:59]
    v_xor_b32 v61, 48, v25
    ds_write_b128 v61, v[56:59]
    v_xor_b32 v60, 64, v25
    ds_write_b128 v60, v[56:59]
    v_xor_b32 v61, 80, v25
    ds_write_b128 v61, v[56:59]
    v_xor_b32 v60, 96, v25
    ds_write_b128 v60, v[56:59]
    v_xor_b32 v61, 112, v25
    ds_write_b128 v61, v[56:59]
    s_waitcnt vmcnt(31) lgkmcnt(0)
    s_barrier
    ds_read_b128 a[0:3], v40 offset:32768
    ds_read_b128 a[4:7], v41 offset:32768
    ds_read_b128 a[8:11], v40 offset:34816
    ds_read_b128 a[12:15], v41 offset:34816
    ds_read_b128 a[16:19], v40 offset:36864
    ds_read_b128 a[20:23], v41 offset:36864
    ds_read_b128 a[24:27], v40 offset:38912
    ds_read_b128 a[28:31], v41 offset:38912
    v_perm_b32 v56, v64, v35, s36
    ds_read_b32 a128, v56
    v_perm_b32 v57, v64, v35, s37
    ds_read_b128 a[32:35], v40 offset:40960
    ds_read_b32 a129, v57
    v_perm_b32 v58, v64, v35, s38
    ds_read_b128 a[36:39], v41 offset:40960
    ds_read_b32 a130, v58
    v_perm_b32 v59, v64, v35, s39
    ds_read_b32 a131, v59
    v_perm_b32 v60, v68, v35, s36
    ds_read_b128 a[40:43], v40 offset:43008
    ds_read_b32 a132, v60
    v_perm_b32 v61, v68, v35, s37
    ds_read_b128 a[44:47], v41 offset:43008
    ds_read_b32 a133, v61
    v_perm_b32 v62, v68, v35, s38
    ds_read_b32 a134, v62
    v_perm_b32 v63, v68, v35, s39
    ds_read_b128 a[48:51], v40 offset:45056
    ds_read_b32 a135, v63
    v_perm_b32 v56, v65, v35, s36
    ds_read_b128 a[52:55], v41 offset:45056
    ds_read_b32 a136, v56
    v_perm_b32 v57, v65, v35, s37
    ds_read_b32 a137, v57
    v_perm_b32 v58, v65, v35, s38
    ds_read_b128 a[56:59], v40 offset:47104
    ds_read_b32 a138, v58
    v_perm_b32 v59, v65, v35, s39
    ds_read_b128 a[60:63], v41 offset:47104
    ds_read_b32 a139, v59
    v_perm_b32 v60, v69, v35, s36
    s_waitcnt lgkmcnt(14)
    v_mfma_f32_16x16x32_bf16 v[128:131], a[128:131], a[0:3], 0
    s_waitcnt lgkmcnt(7)
    ds_read_b32 a140, v60
    v_perm_b32 v61, v69, v35, s37
    v_mfma_f32_16x16x32_bf16 v[128:131], a[132:135], a[4:7], v[128:131]
    ds_read_b128 a[64:67], v42 offset:40960
    v_mfma_f32_16x16x32_bf16 v[132:135], a[128:131], a[8:11], 0
    ds_read_b32 a141, v61
    v_perm_b32 v62, v69, v35, s38
    v_mfma_f32_16x16x32_bf16 v[132:135], a[132:135], a[12:15], v[132:135]
    ds_read_b128 a[68:71], v43 offset:40960
    v_mfma_f32_16x16x32_bf16 v[136:139], a[128:131], a[16:19], 0
    ds_read_b32 a142, v62
    v_perm_b32 v63, v69, v35, s39
    v_mfma_f32_16x16x32_bf16 v[136:139], a[132:135], a[20:23], v[136:139]
    buffer_load_dwordx3 v[112:114], v32, s[12:15], s46 offen
    v_mfma_f32_16x16x32_bf16 v[140:143], a[128:131], a[24:27], 0
    ds_read_b32 a143, v63
    v_perm_b32 v56, v66, v35, s36
    v_mfma_f32_16x16x32_bf16 v[140:143], a[132:135], a[28:31], v[140:143]
    ds_read_b128 a[72:75], v42 offset:43008
    v_mfma_f32_16x16x32_bf16 v[144:147], a[128:131], a[32:35], 0
    ds_read_b32 a144, v56
    v_perm_b32 v57, v66, v35, s37
    v_mfma_f32_16x16x32_bf16 v[144:147], a[132:135], a[36:39], v[144:147]
    ds_read_b128 a[76:79], v43 offset:43008
    v_mfma_f32_16x16x32_bf16 v[148:151], a[128:131], a[40:43], 0
    ds_read_b32 a145, v57
    v_perm_b32 v58, v66, v35, s38
    v_mfma_f32_16x16x32_bf16 v[148:151], a[132:135], a[44:47], v[148:151]
    buffer_load_dwordx3 v[116:118], v32, s[12:15], s47 offen
    v_mfma_f32_16x16x32_bf16 v[152:155], a[128:131], a[48:51], 0
    s_waitcnt lgkmcnt(15)
    ds_read_b32 a146, v58
    v_perm_b32 v59, v66, v35, s39
    v_mfma_f32_16x16x32_bf16 v[152:155], a[132:135], a[52:55], v[152:155]
    s_waitcnt lgkmcnt(14)
    ds_read_b128 a[80:83], v42 offset:45056
    v_mfma_f32_16x16x32_bf16 v[156:159], a[128:131], a[56:59], 0
    s_waitcnt lgkmcnt(13)
    ds_read_b32 a147, v59
    v_perm_b32 v60, v70, v35, s36
    v_mfma_f32_16x16x32_bf16 v[156:159], a[132:135], a[60:63], v[156:159]
    s_waitcnt lgkmcnt(13)
    ds_read_b128 a[84:87], v43 offset:45056
    v_mfma_f32_16x16x32_bf16 v[160:163], a[136:139], a[0:3], 0
    s_waitcnt lgkmcnt(8)
    ds_read_b32 a148, v60
    v_perm_b32 v61, v70, v35, s37
    v_mfma_f32_16x16x32_bf16 v[160:163], a[140:143], a[4:7], v[160:163]
    buffer_load_dword v115, v34, s[12:15], s46 offen
    v_mfma_f32_16x16x32_bf16 v[164:167], a[136:139], a[8:11], 0
    ds_read_b32 a149, v61
    v_perm_b32 v62, v70, v35, s38
    v_mfma_f32_16x16x32_bf16 v[164:167], a[140:143], a[12:15], v[164:167]
    ds_read_b128 a[88:91], v42 offset:47104
    v_mfma_f32_16x16x32_bf16 v[168:171], a[136:139], a[16:19], 0
    ds_read_b32 a150, v62
    v_perm_b32 v63, v70, v35, s39
    v_mfma_f32_16x16x32_bf16 v[168:171], a[140:143], a[20:23], v[168:171]
    ds_read_b128 a[92:95], v43 offset:47104
    v_mfma_f32_16x16x32_bf16 v[172:175], a[136:139], a[24:27], 0
    ds_read_b32 a151, v63
    v_perm_b32 v56, v67, v35, s36
    v_mfma_f32_16x16x32_bf16 v[172:175], a[140:143], a[28:31], v[172:175]
    buffer_load_dword v119, v34, s[12:15], s47 offen
    v_mfma_f32_16x16x32_bf16 v[176:179], a[136:139], a[32:35], 0
    ds_read_b32 a152, v56
    v_perm_b32 v57, v67, v35, s37
    v_mfma_f32_16x16x32_bf16 v[176:179], a[140:143], a[36:39], v[176:179]
    ds_read_b128 a[96:99], v42 offset:32768
    v_mfma_f32_16x16x32_bf16 v[180:183], a[136:139], a[40:43], 0
    ds_read_b32 a153, v57
    v_perm_b32 v58, v67, v35, s38
    v_mfma_f32_16x16x32_bf16 v[180:183], a[140:143], a[44:47], v[180:183]
    ds_read_b128 a[100:103], v43 offset:32768
    v_mfma_f32_16x16x32_bf16 v[184:187], a[136:139], a[48:51], 0
    ds_read_b32 a154, v58
    v_perm_b32 v59, v67, v35, s39
    v_mfma_f32_16x16x32_bf16 v[184:187], a[140:143], a[52:55], v[184:187]
    buffer_load_dwordx3 v[120:122], v33, s[12:15], s46 offen
    v_mfma_f32_16x16x32_bf16 v[188:191], a[136:139], a[56:59], 0
    ds_read_b32 a155, v59
    v_perm_b32 v60, v71, v35, s36
    v_mfma_f32_16x16x32_bf16 v[188:191], a[140:143], a[60:63], v[188:191]
    s_waitcnt lgkmcnt(13)
    ds_read_b128 a[104:107], v42 offset:34816
    v_mfma_f32_16x16x32_bf16 v[192:195], a[144:147], a[0:3], 0
    s_waitcnt lgkmcnt(7)
    ds_read_b32 a156, v60
    v_perm_b32 v61, v71, v35, s37
    v_mfma_f32_16x16x32_bf16 v[192:195], a[148:151], a[4:7], v[192:195]
    ds_read_b128 a[108:111], v43 offset:34816
    v_mfma_f32_16x16x32_bf16 v[196:199], a[144:147], a[8:11], 0
    ds_read_b32 a157, v61
    v_perm_b32 v62, v71, v35, s38
    v_mfma_f32_16x16x32_bf16 v[196:199], a[148:151], a[12:15], v[196:199]
    buffer_load_dwordx3 v[124:126], v33, s[12:15], s47 offen
    v_mfma_f32_16x16x32_bf16 v[200:203], a[144:147], a[16:19], 0
    ds_read_b32 a158, v62
    v_perm_b32 v63, v71, v35, s39
    v_mfma_f32_16x16x32_bf16 v[200:203], a[148:151], a[20:23], v[200:203]
    ds_read_b128 a[112:115], v42 offset:36864
    v_mfma_f32_16x16x32_bf16 v[204:207], a[144:147], a[24:27], 0
    ds_read_b32 a159, v63
    v_perm_b32 v56, v72, v35, s36
    v_mfma_f32_16x16x32_bf16 v[204:207], a[148:151], a[28:31], v[204:207]
    ds_read_b128 a[116:119], v43 offset:36864
    v_mfma_f32_16x16x32_bf16 v[208:211], a[144:147], a[32:35], 0
    ds_read_b32 a160, v56
    v_perm_b32 v57, v72, v35, s37
    v_mfma_f32_16x16x32_bf16 v[208:211], a[148:151], a[36:39], v[208:211]
    v_mfma_f32_16x16x32_bf16 v[212:215], a[144:147], a[40:43], 0
    ds_read_b32 a161, v57
    v_perm_b32 v58, v72, v35, s38
    v_mfma_f32_16x16x32_bf16 v[212:215], a[148:151], a[44:47], v[212:215]
    ds_read_b128 a[120:123], v42 offset:38912
    v_mfma_f32_16x16x32_bf16 v[216:219], a[144:147], a[48:51], 0
    ds_read_b32 a162, v58
    v_perm_b32 v59, v72, v35, s39
    v_mfma_f32_16x16x32_bf16 v[216:219], a[148:151], a[52:55], v[216:219]
    ds_read_b128 a[124:127], v43 offset:38912
    v_mfma_f32_16x16x32_bf16 v[220:223], a[144:147], a[56:59], 0
    ds_read_b32 a163, v59
    v_perm_b32 v60, v76, v35, s36
    v_mfma_f32_16x16x32_bf16 v[220:223], a[148:151], a[60:63], v[220:223]
    s_waitcnt lgkmcnt(14)
    v_mfma_f32_16x16x32_bf16 v[224:227], a[152:155], a[0:3], 0
    s_waitcnt lgkmcnt(7)
    ds_read_b32 a164, v60
    v_perm_b32 v61, v76, v35, s37
    v_mfma_f32_16x16x32_bf16 v[224:227], a[156:159], a[4:7], v[224:227]
    v_mfma_f32_16x16x32_bf16 v[228:231], a[152:155], a[8:11], 0
    ds_read_b32 a165, v61
    v_perm_b32 v62, v76, v35, s38
    v_mfma_f32_16x16x32_bf16 v[228:231], a[156:159], a[12:15], v[228:231]
    v_mfma_f32_16x16x32_bf16 v[232:235], a[152:155], a[16:19], 0
    ds_read_b32 a166, v62
    v_perm_b32 v63, v76, v35, s39
    v_mfma_f32_16x16x32_bf16 v[232:235], a[156:159], a[20:23], v[232:235]
    v_mfma_f32_16x16x32_bf16 v[236:239], a[152:155], a[24:27], 0
    ds_read_b32 a167, v63
    v_perm_b32 v56, v73, v35, s36
    v_mfma_f32_16x16x32_bf16 v[236:239], a[156:159], a[28:31], v[236:239]
    v_mfma_f32_16x16x32_bf16 v[240:243], a[152:155], a[32:35], 0
    ds_read_b32 a168, v56
    v_perm_b32 v57, v73, v35, s37
    v_mfma_f32_16x16x32_bf16 v[240:243], a[156:159], a[36:39], v[240:243]
    v_mfma_f32_16x16x32_bf16 v[244:247], a[152:155], a[40:43], 0
    ds_read_b32 a169, v57
    v_perm_b32 v58, v73, v35, s38
    v_mfma_f32_16x16x32_bf16 v[244:247], a[156:159], a[44:47], v[244:247]
    v_mfma_f32_16x16x32_bf16 v[248:251], a[152:155], a[48:51], 0
    ds_read_b32 a170, v58
    v_perm_b32 v59, v73, v35, s39
    v_mfma_f32_16x16x32_bf16 v[248:251], a[156:159], a[52:55], v[248:251]
    v_mfma_f32_16x16x32_bf16 v[252:255], a[152:155], a[56:59], 0
    ds_read_b32 a171, v59
    v_perm_b32 v60, v77, v35, s36
    v_mfma_f32_16x16x32_bf16 v[252:255], a[156:159], a[60:63], v[252:255]
    s_waitcnt vmcnt(23) lgkmcnt(9)
    s_barrier
    s_waitcnt lgkmcnt(8)
    v_mfma_f32_16x16x32_bf16 v[128:131], a[160:163], a[64:67], v[128:131]
    s_waitcnt lgkmcnt(4)
    ds_read_b32 a172, v60
    v_perm_b32 v61, v77, v35, s37
    v_mfma_f32_16x16x32_bf16 v[128:131], a[164:167], a[68:71], v[128:131]
    s_add_u32 s56, s56, 128
    ds_read_b128 a[0:3], v44 offset:0
    v_mfma_f32_16x16x32_bf16 v[132:135], a[160:163], a[72:75], v[132:135]
    ds_read_b32 a173, v61
    v_perm_b32 v62, v77, v35, s38
    v_mfma_f32_16x16x32_bf16 v[132:135], a[164:167], a[76:79], v[132:135]
    s_add_u32 m0, s57, 32768
    ds_read_b128 a[4:7], v45 offset:0
    v_mfma_f32_16x16x32_bf16 v[136:139], a[160:163], a[80:83], v[136:139]
    ds_read_b32 a174, v62
    v_perm_b32 v63, v77, v35, s39
    v_mfma_f32_16x16x32_bf16 v[136:139], a[164:167], a[84:87], v[136:139]
    buffer_load_dwordx4 v36, s[8:11], s56 offen offset:0 lds
    v_mfma_f32_16x16x32_bf16 v[140:143], a[160:163], a[88:91], v[140:143]
    ds_read_b32 a175, v63
    v_perm_b32 v56, v74, v35, s36
    v_mfma_f32_16x16x32_bf16 v[140:143], a[164:167], a[92:95], v[140:143]
    ds_read_b128 a[8:11], v44 offset:2048
    v_mfma_f32_16x16x32_bf16 v[144:147], a[160:163], a[96:99], v[144:147]
    ds_read_b32 a176, v56
    v_perm_b32 v57, v74, v35, s37
    v_mfma_f32_16x16x32_bf16 v[144:147], a[164:167], a[100:103], v[144:147]
    ds_read_b128 a[12:15], v45 offset:2048
    v_mfma_f32_16x16x32_bf16 v[148:151], a[160:163], a[104:107], v[148:151]
    ds_read_b32 a177, v57
    v_perm_b32 v58, v74, v35, s38
    v_mfma_f32_16x16x32_bf16 v[148:151], a[164:167], a[108:111], v[148:151]
    buffer_load_dwordx4 v37, s[8:11], s56 offen offset:1024 lds
    v_mfma_f32_16x16x32_bf16 v[152:155], a[160:163], a[112:115], v[152:155]
    ds_read_b32 a178, v58
    v_perm_b32 v59, v74, v35, s39
    v_mfma_f32_16x16x32_bf16 v[152:155], a[164:167], a[116:119], v[152:155]
    ds_read_b128 a[16:19], v44 offset:4096
    v_mfma_f32_16x16x32_bf16 v[156:159], a[160:163], a[120:123], v[156:159]
    ds_read_b32 a179, v59
    v_perm_b32 v60, v78, v35, s36
    v_mfma_f32_16x16x32_bf16 v[156:159], a[164:167], a[124:127], v[156:159]
    s_waitcnt lgkmcnt(13)
    ds_read_b128 a[20:23], v45 offset:4096
    v_mfma_f32_16x16x32_bf16 v[160:163], a[168:171], a[64:67], v[160:163]
    s_waitcnt lgkmcnt(8)
    ds_read_b32 a180, v60
    v_perm_b32 v61, v78, v35, s37
    v_mfma_f32_16x16x32_bf16 v[160:163], a[172:175], a[68:71], v[160:163]
    buffer_load_dwordx4 v38, s[8:11], s56 offen offset:2048 lds
    v_mfma_f32_16x16x32_bf16 v[164:167], a[168:171], a[72:75], v[164:167]
    ds_read_b32 a181, v61
    v_perm_b32 v62, v78, v35, s38
    v_mfma_f32_16x16x32_bf16 v[164:167], a[172:175], a[76:79], v[164:167]
    ds_read_b128 a[24:27], v44 offset:6144
    v_mfma_f32_16x16x32_bf16 v[168:171], a[168:171], a[80:83], v[168:171]
    ds_read_b32 a182, v62
    v_perm_b32 v63, v78, v35, s39
    v_mfma_f32_16x16x32_bf16 v[168:171], a[172:175], a[84:87], v[168:171]
    ds_read_b128 a[28:31], v45 offset:6144
    v_mfma_f32_16x16x32_bf16 v[172:175], a[168:171], a[88:91], v[172:175]
    ds_read_b32 a183, v63
    v_perm_b32 v56, v80, v35, s36
    v_mfma_f32_16x16x32_bf16 v[172:175], a[172:175], a[92:95], v[172:175]
    buffer_load_dwordx4 v39, s[8:11], s56 offen offset:3072 lds
    v_mfma_f32_16x16x32_bf16 v[176:179], a[168:171], a[96:99], v[176:179]
    ds_read_b32 a128, v56
    v_perm_b32 v57, v80, v35, s37
    v_mfma_f32_16x16x32_bf16 v[176:179], a[172:175], a[100:103], v[176:179]
    s_add_u32 s56, s56, 128
    ds_read_b128 a[32:35], v44 offset:8192
    v_mfma_f32_16x16x32_bf16 v[180:183], a[168:171], a[104:107], v[180:183]
    ds_read_b32 a129, v57
    v_perm_b32 v58, v80, v35, s38
    v_mfma_f32_16x16x32_bf16 v[180:183], a[172:175], a[108:111], v[180:183]
    s_add_u32 m0, s71, 32768
    ds_read_b128 a[36:39], v45 offset:8192
    v_mfma_f32_16x16x32_bf16 v[184:187], a[168:171], a[112:115], v[184:187]
    ds_read_b32 a130, v58
    v_perm_b32 v59, v80, v35, s39
    v_mfma_f32_16x16x32_bf16 v[184:187], a[172:175], a[116:119], v[184:187]
    buffer_load_dwordx4 v36, s[8:11], s56 offen offset:0 lds
    v_mfma_f32_16x16x32_bf16 v[188:191], a[168:171], a[120:123], v[188:191]
    ds_read_b32 a131, v59
    v_perm_b32 v60, v84, v35, s36
    v_mfma_f32_16x16x32_bf16 v[188:191], a[172:175], a[124:127], v[188:191]
    s_waitcnt lgkmcnt(13)
    ds_read_b128 a[40:43], v44 offset:10240
    v_mfma_f32_16x16x32_bf16 v[192:195], a[176:179], a[64:67], v[192:195]
    s_waitcnt lgkmcnt(7)
    ds_read_b32 a132, v60
    v_perm_b32 v61, v84, v35, s37
    v_mfma_f32_16x16x32_bf16 v[192:195], a[180:183], a[68:71], v[192:195]
    ds_read_b128 a[44:47], v45 offset:10240
    v_mfma_f32_16x16x32_bf16 v[196:199], a[176:179], a[72:75], v[196:199]
    ds_read_b32 a133, v61
    v_perm_b32 v62, v84, v35, s38
    v_mfma_f32_16x16x32_bf16 v[196:199], a[180:183], a[76:79], v[196:199]
    buffer_load_dwordx4 v37, s[8:11], s56 offen offset:1024 lds
    v_mfma_f32_16x16x32_bf16 v[200:203], a[176:179], a[80:83], v[200:203]
    ds_read_b32 a134, v62
    v_perm_b32 v63, v84, v35, s39
    v_mfma_f32_16x16x32_bf16 v[200:203], a[180:183], a[84:87], v[200:203]
    ds_read_b128 a[48:51], v44 offset:12288
    v_mfma_f32_16x16x32_bf16 v[204:207], a[176:179], a[88:91], v[204:207]
    ds_read_b32 a135, v63
    v_perm_b32 v56, v81, v35, s36
    v_mfma_f32_16x16x32_bf16 v[204:207], a[180:183], a[92:95], v[204:207]
    ds_read_b128 a[52:55], v45 offset:12288
    v_mfma_f32_16x16x32_bf16 v[208:211], a[176:179], a[96:99], v[208:211]
    ds_read_b32 a136, v56
    v_perm_b32 v57, v81, v35, s37
    v_mfma_f32_16x16x32_bf16 v[208:211], a[180:183], a[100:103], v[208:211]
    buffer_load_dwordx4 v38, s[8:11], s56 offen offset:2048 lds
    v_mfma_f32_16x16x32_bf16 v[212:215], a[176:179], a[104:107], v[212:215]
    ds_read_b32 a137, v57
    v_perm_b32 v58, v81, v35, s38
    v_mfma_f32_16x16x32_bf16 v[212:215], a[180:183], a[108:111], v[212:215]
    ds_read_b128 a[56:59], v44 offset:14336
    v_mfma_f32_16x16x32_bf16 v[216:219], a[176:179], a[112:115], v[216:219]
    ds_read_b32 a138, v58
    v_perm_b32 v59, v81, v35, s39
    v_mfma_f32_16x16x32_bf16 v[216:219], a[180:183], a[116:119], v[216:219]
    ds_read_b128 a[60:63], v45 offset:14336
    v_mfma_f32_16x16x32_bf16 v[220:223], a[176:179], a[120:123], v[220:223]
    ds_read_b32 a139, v59
    v_perm_b32 v60, v85, v35, s36
    v_mfma_f32_16x16x32_bf16 v[220:223], a[180:183], a[124:127], v[220:223]
    s_waitcnt lgkmcnt(14)
    buffer_load_dwordx4 v39, s[8:11], s56 offen offset:3072 lds
    v_mfma_f32_16x16x32_bf16 v[128:131], a[128:131], a[0:3], v[128:131]
    s_waitcnt lgkmcnt(7)
    ds_read_b32 a140, v60
    v_perm_b32 v61, v85, v35, s37
    v_mfma_f32_16x16x32_bf16 v[128:131], a[132:135], a[4:7], v[128:131]
    ds_read_b128 a[64:67], v46 offset:8192
    v_mfma_f32_16x16x32_bf16 v[132:135], a[128:131], a[8:11], v[132:135]
    ds_read_b32 a141, v61
    v_perm_b32 v62, v85, v35, s38
    v_mfma_f32_16x16x32_bf16 v[132:135], a[132:135], a[12:15], v[132:135]
    ds_read_b128 a[68:71], v47 offset:8192
    v_mfma_f32_16x16x32_bf16 v[136:139], a[128:131], a[16:19], v[136:139]
    ds_read_b32 a142, v62
    v_perm_b32 v63, v85, v35, s39
    v_mfma_f32_16x16x32_bf16 v[136:139], a[132:135], a[20:23], v[136:139]
    buffer_load_dwordx3 v[64:66], v32, s[12:15], s48 offen
    v_mfma_f32_16x16x32_bf16 v[140:143], a[128:131], a[24:27], v[140:143]
    ds_read_b32 a143, v63
    v_perm_b32 v56, v82, v35, s36
    v_mfma_f32_16x16x32_bf16 v[140:143], a[132:135], a[28:31], v[140:143]
    ds_read_b128 a[72:75], v46 offset:10240
    v_mfma_f32_16x16x32_bf16 v[144:147], a[128:131], a[32:35], v[144:147]
    ds_read_b32 a144, v56
    v_perm_b32 v57, v82, v35, s37
    v_mfma_f32_16x16x32_bf16 v[144:147], a[132:135], a[36:39], v[144:147]
    ds_read_b128 a[76:79], v47 offset:10240
    v_mfma_f32_16x16x32_bf16 v[148:151], a[128:131], a[40:43], v[148:151]
    ds_read_b32 a145, v57
    v_perm_b32 v58, v82, v35, s38
    v_mfma_f32_16x16x32_bf16 v[148:151], a[132:135], a[44:47], v[148:151]
    buffer_load_dwordx3 v[68:70], v32, s[12:15], s49 offen
    v_mfma_f32_16x16x32_bf16 v[152:155], a[128:131], a[48:51], v[152:155]
    s_waitcnt lgkmcnt(15)
    ds_read_b32 a146, v58
    v_perm_b32 v59, v82, v35, s39
    v_mfma_f32_16x16x32_bf16 v[152:155], a[132:135], a[52:55], v[152:155]
    s_waitcnt lgkmcnt(14)
    ds_read_b128 a[80:83], v46 offset:12288
    v_mfma_f32_16x16x32_bf16 v[156:159], a[128:131], a[56:59], v[156:159]
    s_waitcnt lgkmcnt(13)
    ds_read_b32 a147, v59
    v_perm_b32 v60, v86, v35, s36
    v_mfma_f32_16x16x32_bf16 v[156:159], a[132:135], a[60:63], v[156:159]
    s_waitcnt lgkmcnt(13)
    ds_read_b128 a[84:87], v47 offset:12288
    v_mfma_f32_16x16x32_bf16 v[160:163], a[136:139], a[0:3], v[160:163]
    s_waitcnt lgkmcnt(8)
    ds_read_b32 a148, v60
    v_perm_b32 v61, v86, v35, s37
    v_mfma_f32_16x16x32_bf16 v[160:163], a[140:143], a[4:7], v[160:163]
    buffer_load_dword v67, v34, s[12:15], s48 offen
    v_mfma_f32_16x16x32_bf16 v[164:167], a[136:139], a[8:11], v[164:167]
    ds_read_b32 a149, v61
    v_perm_b32 v62, v86, v35, s38
    v_mfma_f32_16x16x32_bf16 v[164:167], a[140:143], a[12:15], v[164:167]
    ds_read_b128 a[88:91], v46 offset:14336
    v_mfma_f32_16x16x32_bf16 v[168:171], a[136:139], a[16:19], v[168:171]
    ds_read_b32 a150, v62
    v_perm_b32 v63, v86, v35, s39
    v_mfma_f32_16x16x32_bf16 v[168:171], a[140:143], a[20:23], v[168:171]
    ds_read_b128 a[92:95], v47 offset:14336
    v_mfma_f32_16x16x32_bf16 v[172:175], a[136:139], a[24:27], v[172:175]
    ds_read_b32 a151, v63
    v_perm_b32 v56, v83, v35, s36
    v_mfma_f32_16x16x32_bf16 v[172:175], a[140:143], a[28:31], v[172:175]
    buffer_load_dword v71, v34, s[12:15], s49 offen
    v_mfma_f32_16x16x32_bf16 v[176:179], a[136:139], a[32:35], v[176:179]
    ds_read_b32 a152, v56
    v_perm_b32 v57, v83, v35, s37
    v_mfma_f32_16x16x32_bf16 v[176:179], a[140:143], a[36:39], v[176:179]
    ds_read_b128 a[96:99], v46 offset:0
    v_mfma_f32_16x16x32_bf16 v[180:183], a[136:139], a[40:43], v[180:183]
    ds_read_b32 a153, v57
    v_perm_b32 v58, v83, v35, s38
    v_mfma_f32_16x16x32_bf16 v[180:183], a[140:143], a[44:47], v[180:183]
    ds_read_b128 a[100:103], v47 offset:0
    v_mfma_f32_16x16x32_bf16 v[184:187], a[136:139], a[48:51], v[184:187]
    ds_read_b32 a154, v58
    v_perm_b32 v59, v83, v35, s39
    v_mfma_f32_16x16x32_bf16 v[184:187], a[140:143], a[52:55], v[184:187]
    buffer_load_dwordx3 v[72:74], v33, s[12:15], s48 offen
    v_mfma_f32_16x16x32_bf16 v[188:191], a[136:139], a[56:59], v[188:191]
    ds_read_b32 a155, v59
    v_perm_b32 v60, v87, v35, s36
    v_mfma_f32_16x16x32_bf16 v[188:191], a[140:143], a[60:63], v[188:191]
    s_waitcnt lgkmcnt(13)
    ds_read_b128 a[104:107], v46 offset:2048
    v_mfma_f32_16x16x32_bf16 v[192:195], a[144:147], a[0:3], v[192:195]
    s_waitcnt lgkmcnt(7)
    ds_read_b32 a156, v60
    v_perm_b32 v61, v87, v35, s37
    v_mfma_f32_16x16x32_bf16 v[192:195], a[148:151], a[4:7], v[192:195]
    ds_read_b128 a[108:111], v47 offset:2048
    v_mfma_f32_16x16x32_bf16 v[196:199], a[144:147], a[8:11], v[196:199]
    ds_read_b32 a157, v61
    v_perm_b32 v62, v87, v35, s38
    v_mfma_f32_16x16x32_bf16 v[196:199], a[148:151], a[12:15], v[196:199]
    buffer_load_dwordx3 v[76:78], v33, s[12:15], s49 offen
    v_mfma_f32_16x16x32_bf16 v[200:203], a[144:147], a[16:19], v[200:203]
    ds_read_b32 a158, v62
    v_perm_b32 v63, v87, v35, s39
    v_mfma_f32_16x16x32_bf16 v[200:203], a[148:151], a[20:23], v[200:203]
    ds_read_b128 a[112:115], v46 offset:4096
    v_mfma_f32_16x16x32_bf16 v[204:207], a[144:147], a[24:27], v[204:207]
    ds_read_b32 a159, v63
    v_perm_b32 v56, v88, v35, s36
    v_mfma_f32_16x16x32_bf16 v[204:207], a[148:151], a[28:31], v[204:207]
    ds_read_b128 a[116:119], v47 offset:4096
    v_mfma_f32_16x16x32_bf16 v[208:211], a[144:147], a[32:35], v[208:211]
    ds_read_b32 a160, v56
    v_perm_b32 v57, v88, v35, s37
    v_mfma_f32_16x16x32_bf16 v[208:211], a[148:151], a[36:39], v[208:211]
    v_mfma_f32_16x16x32_bf16 v[212:215], a[144:147], a[40:43], v[212:215]
    ds_read_b32 a161, v57
    v_perm_b32 v58, v88, v35, s38
    v_mfma_f32_16x16x32_bf16 v[212:215], a[148:151], a[44:47], v[212:215]
    ds_read_b128 a[120:123], v46 offset:6144
    v_mfma_f32_16x16x32_bf16 v[216:219], a[144:147], a[48:51], v[216:219]
    ds_read_b32 a162, v58
    v_perm_b32 v59, v88, v35, s39
    v_mfma_f32_16x16x32_bf16 v[216:219], a[148:151], a[52:55], v[216:219]
    ds_read_b128 a[124:127], v47 offset:6144
    v_mfma_f32_16x16x32_bf16 v[220:223], a[144:147], a[56:59], v[220:223]
    ds_read_b32 a163, v59
    v_perm_b32 v60, v92, v35, s36
    v_mfma_f32_16x16x32_bf16 v[220:223], a[148:151], a[60:63], v[220:223]
    s_waitcnt lgkmcnt(14)
    v_mfma_f32_16x16x32_bf16 v[224:227], a[152:155], a[0:3], v[224:227]
    s_waitcnt lgkmcnt(7)
    ds_read_b32 a164, v60
    v_perm_b32 v61, v92, v35, s37
    v_mfma_f32_16x16x32_bf16 v[224:227], a[156:159], a[4:7], v[224:227]
    v_mfma_f32_16x16x32_bf16 v[228:231], a[152:155], a[8:11], v[228:231]
    ds_read_b32 a165, v61
    v_perm_b32 v62, v92, v35, s38
    v_mfma_f32_16x16x32_bf16 v[228:231], a[156:159], a[12:15], v[228:231]
    v_mfma_f32_16x16x32_bf16 v[232:235], a[152:155], a[16:19], v[232:235]
    ds_read_b32 a166, v62
    v_perm_b32 v63, v92, v35, s39
    v_mfma_f32_16x16x32_bf16 v[232:235], a[156:159], a[20:23], v[232:235]
    v_mfma_f32_16x16x32_bf16 v[236:239], a[152:155], a[24:27], v[236:239]
    ds_read_b32 a167, v63
    v_perm_b32 v56, v89, v35, s36
    v_mfma_f32_16x16x32_bf16 v[236:239], a[156:159], a[28:31], v[236:239]
    v_mfma_f32_16x16x32_bf16 v[240:243], a[152:155], a[32:35], v[240:243]
    ds_read_b32 a168, v56
    v_perm_b32 v57, v89, v35, s37
    v_mfma_f32_16x16x32_bf16 v[240:243], a[156:159], a[36:39], v[240:243]
    v_mfma_f32_16x16x32_bf16 v[244:247], a[152:155], a[40:43], v[244:247]
    ds_read_b32 a169, v57
    v_perm_b32 v58, v89, v35, s38
    v_mfma_f32_16x16x32_bf16 v[244:247], a[156:159], a[44:47], v[244:247]
    v_mfma_f32_16x16x32_bf16 v[248:251], a[152:155], a[48:51], v[248:251]
    ds_read_b32 a170, v58
    v_perm_b32 v59, v89, v35, s39
    v_mfma_f32_16x16x32_bf16 v[248:251], a[156:159], a[52:55], v[248:251]
    v_mfma_f32_16x16x32_bf16 v[252:255], a[152:155], a[56:59], v[252:255]
    ds_read_b32 a171, v59
    v_perm_b32 v60, v93, v35, s36
    v_mfma_f32_16x16x32_bf16 v[252:255], a[156:159], a[60:63], v[252:255]
    s_waitcnt vmcnt(20) lgkmcnt(9)
    s_barrier
    s_waitcnt lgkmcnt(8)
    v_mfma_f32_16x16x32_bf16 v[128:131], a[160:163], a[64:67], v[128:131]
    s_waitcnt lgkmcnt(4)
    ds_read_b32 a172, v60
    v_perm_b32 v61, v93, v35, s37
    v_mfma_f32_16x16x32_bf16 v[128:131], a[164:167], a[68:71], v[128:131]
    s_add_u32 s56, s56, 128
    ds_read_b128 a[0:3], v40 offset:0
    v_mfma_f32_16x16x32_bf16 v[132:135], a[160:163], a[72:75], v[132:135]
    ds_read_b32 a173, v61
    v_perm_b32 v62, v93, v35, s38
    v_mfma_f32_16x16x32_bf16 v[132:135], a[164:167], a[76:79], v[132:135]
    s_add_u32 m0, s57, 65536
    ds_read_b128 a[4:7], v41 offset:0
    v_mfma_f32_16x16x32_bf16 v[136:139], a[160:163], a[80:83], v[136:139]
    ds_read_b32 a174, v62
    v_perm_b32 v63, v93, v35, s39
    v_mfma_f32_16x16x32_bf16 v[136:139], a[164:167], a[84:87], v[136:139]
    buffer_load_dwordx4 v36, s[8:11], s56 offen offset:0 lds
    v_mfma_f32_16x16x32_bf16 v[140:143], a[160:163], a[88:91], v[140:143]
    ds_read_b32 a175, v63
    v_perm_b32 v56, v90, v35, s36
    v_mfma_f32_16x16x32_bf16 v[140:143], a[164:167], a[92:95], v[140:143]
    ds_read_b128 a[8:11], v40 offset:2048
    v_mfma_f32_16x16x32_bf16 v[144:147], a[160:163], a[96:99], v[144:147]
    ds_read_b32 a176, v56
    v_perm_b32 v57, v90, v35, s37
    v_mfma_f32_16x16x32_bf16 v[144:147], a[164:167], a[100:103], v[144:147]
    ds_read_b128 a[12:15], v41 offset:2048
    v_mfma_f32_16x16x32_bf16 v[148:151], a[160:163], a[104:107], v[148:151]
    ds_read_b32 a177, v57
    v_perm_b32 v58, v90, v35, s38
    v_mfma_f32_16x16x32_bf16 v[148:151], a[164:167], a[108:111], v[148:151]
    buffer_load_dwordx4 v37, s[8:11], s56 offen offset:1024 lds
    v_mfma_f32_16x16x32_bf16 v[152:155], a[160:163], a[112:115], v[152:155]
    ds_read_b32 a178, v58
    v_perm_b32 v59, v90, v35, s39
    v_mfma_f32_16x16x32_bf16 v[152:155], a[164:167], a[116:119], v[152:155]
    ds_read_b128 a[16:19], v40 offset:4096
    v_mfma_f32_16x16x32_bf16 v[156:159], a[160:163], a[120:123], v[156:159]
    ds_read_b32 a179, v59
    v_perm_b32 v60, v94, v35, s36
    v_mfma_f32_16x16x32_bf16 v[156:159], a[164:167], a[124:127], v[156:159]
    s_waitcnt lgkmcnt(13)
    ds_read_b128 a[20:23], v41 offset:4096
    v_mfma_f32_16x16x32_bf16 v[160:163], a[168:171], a[64:67], v[160:163]
    s_waitcnt lgkmcnt(8)
    ds_read_b32 a180, v60
    v_perm_b32 v61, v94, v35, s37
    v_mfma_f32_16x16x32_bf16 v[160:163], a[172:175], a[68:71], v[160:163]
    buffer_load_dwordx4 v38, s[8:11], s56 offen offset:2048 lds
    v_mfma_f32_16x16x32_bf16 v[164:167], a[168:171], a[72:75], v[164:167]
    ds_read_b32 a181, v61
    v_perm_b32 v62, v94, v35, s38
    v_mfma_f32_16x16x32_bf16 v[164:167], a[172:175], a[76:79], v[164:167]
    ds_read_b128 a[24:27], v40 offset:6144
    v_mfma_f32_16x16x32_bf16 v[168:171], a[168:171], a[80:83], v[168:171]
    ds_read_b32 a182, v62
    v_perm_b32 v63, v94, v35, s39
    v_mfma_f32_16x16x32_bf16 v[168:171], a[172:175], a[84:87], v[168:171]
    ds_read_b128 a[28:31], v41 offset:6144
    v_mfma_f32_16x16x32_bf16 v[172:175], a[168:171], a[88:91], v[172:175]
    ds_read_b32 a183, v63
    v_perm_b32 v56, v96, v35, s36
    v_mfma_f32_16x16x32_bf16 v[172:175], a[172:175], a[92:95], v[172:175]
    buffer_load_dwordx4 v39, s[8:11], s56 offen offset:3072 lds
    v_mfma_f32_16x16x32_bf16 v[176:179], a[168:171], a[96:99], v[176:179]
    ds_read_b32 a128, v56
    v_perm_b32 v57, v96, v35, s37
    v_mfma_f32_16x16x32_bf16 v[176:179], a[172:175], a[100:103], v[176:179]
    s_add_u32 s56, s56, 128
    ds_read_b128 a[32:35], v40 offset:8192
    v_mfma_f32_16x16x32_bf16 v[180:183], a[168:171], a[104:107], v[180:183]
    ds_read_b32 a129, v57
    v_perm_b32 v58, v96, v35, s38
    v_mfma_f32_16x16x32_bf16 v[180:183], a[172:175], a[108:111], v[180:183]
    s_add_u32 m0, s71, 65536
    ds_read_b128 a[36:39], v41 offset:8192
    v_mfma_f32_16x16x32_bf16 v[184:187], a[168:171], a[112:115], v[184:187]
    ds_read_b32 a130, v58
    v_perm_b32 v59, v96, v35, s39
    v_mfma_f32_16x16x32_bf16 v[184:187], a[172:175], a[116:119], v[184:187]
    buffer_load_dwordx4 v36, s[8:11], s56 offen offset:0 lds
    v_mfma_f32_16x16x32_bf16 v[188:191], a[168:171], a[120:123], v[188:191]
    ds_read_b32 a131, v59
    v_perm_b32 v60, v100, v35, s36
    v_mfma_f32_16x16x32_bf16 v[188:191], a[172:175], a[124:127], v[188:191]
    s_waitcnt lgkmcnt(13)
    ds_read_b128 a[40:43], v40 offset:10240
    v_mfma_f32_16x16x32_bf16 v[192:195], a[176:179], a[64:67], v[192:195]
    s_waitcnt lgkmcnt(7)
    ds_read_b32 a132, v60
    v_perm_b32 v61, v100, v35, s37
    v_mfma_f32_16x16x32_bf16 v[192:195], a[180:183], a[68:71], v[192:195]
    ds_read_b128 a[44:47], v41 offset:10240
    v_mfma_f32_16x16x32_bf16 v[196:199], a[176:179], a[72:75], v[196:199]
    ds_read_b32 a133, v61
    v_perm_b32 v62, v100, v35, s38
    v_mfma_f32_16x16x32_bf16 v[196:199], a[180:183], a[76:79], v[196:199]
    buffer_load_dwordx4 v37, s[8:11], s56 offen offset:1024 lds
    v_mfma_f32_16x16x32_bf16 v[200:203], a[176:179], a[80:83], v[200:203]
    ds_read_b32 a134, v62
    v_perm_b32 v63, v100, v35, s39
    v_mfma_f32_16x16x32_bf16 v[200:203], a[180:183], a[84:87], v[200:203]
    ds_read_b128 a[48:51], v40 offset:12288
    v_mfma_f32_16x16x32_bf16 v[204:207], a[176:179], a[88:91], v[204:207]
    ds_read_b32 a135, v63
    v_perm_b32 v56, v97, v35, s36
    v_mfma_f32_16x16x32_bf16 v[204:207], a[180:183], a[92:95], v[204:207]
    ds_read_b128 a[52:55], v41 offset:12288
    v_mfma_f32_16x16x32_bf16 v[208:211], a[176:179], a[96:99], v[208:211]
    ds_read_b32 a136, v56
    v_perm_b32 v57, v97, v35, s37
    v_mfma_f32_16x16x32_bf16 v[208:211], a[180:183], a[100:103], v[208:211]
    buffer_load_dwordx4 v38, s[8:11], s56 offen offset:2048 lds
    v_mfma_f32_16x16x32_bf16 v[212:215], a[176:179], a[104:107], v[212:215]
    ds_read_b32 a137, v57
    v_perm_b32 v58, v97, v35, s38
    v_mfma_f32_16x16x32_bf16 v[212:215], a[180:183], a[108:111], v[212:215]
    ds_read_b128 a[56:59], v40 offset:14336
    v_mfma_f32_16x16x32_bf16 v[216:219], a[176:179], a[112:115], v[216:219]
    ds_read_b32 a138, v58
    v_perm_b32 v59, v97, v35, s39
    v_mfma_f32_16x16x32_bf16 v[216:219], a[180:183], a[116:119], v[216:219]
    ds_read_b128 a[60:63], v41 offset:14336
    v_mfma_f32_16x16x32_bf16 v[220:223], a[176:179], a[120:123], v[220:223]
    ds_read_b32 a139, v59
    v_perm_b32 v60, v101, v35, s36
    v_mfma_f32_16x16x32_bf16 v[220:223], a[180:183], a[124:127], v[220:223]
    s_waitcnt lgkmcnt(14)
    buffer_load_dwordx4 v39, s[8:11], s56 offen offset:3072 lds
    v_mfma_f32_16x16x32_bf16 v[128:131], a[128:131], a[0:3], v[128:131]
    s_waitcnt lgkmcnt(7)
    ds_read_b32 a140, v60
    v_perm_b32 v61, v101, v35, s37
    v_mfma_f32_16x16x32_bf16 v[128:131], a[132:135], a[4:7], v[128:131]
    ds_read_b128 a[64:67], v42 offset:8192
    v_mfma_f32_16x16x32_bf16 v[132:135], a[128:131], a[8:11], v[132:135]
    ds_read_b32 a141, v61
    v_perm_b32 v62, v101, v35, s38
    v_mfma_f32_16x16x32_bf16 v[132:135], a[132:135], a[12:15], v[132:135]
    ds_read_b128 a[68:71], v43 offset:8192
    v_mfma_f32_16x16x32_bf16 v[136:139], a[128:131], a[16:19], v[136:139]
    ds_read_b32 a142, v62
    v_perm_b32 v63, v101, v35, s39
    v_mfma_f32_16x16x32_bf16 v[136:139], a[132:135], a[20:23], v[136:139]
    buffer_load_dwordx3 v[80:82], v32, s[12:15], s50 offen
    v_mfma_f32_16x16x32_bf16 v[140:143], a[128:131], a[24:27], v[140:143]
    ds_read_b32 a143, v63
    v_perm_b32 v56, v98, v35, s36
    v_mfma_f32_16x16x32_bf16 v[140:143], a[132:135], a[28:31], v[140:143]
    ds_read_b128 a[72:75], v42 offset:10240
    v_mfma_f32_16x16x32_bf16 v[144:147], a[128:131], a[32:35], v[144:147]
    ds_read_b32 a144, v56
    v_perm_b32 v57, v98, v35, s37
    v_mfma_f32_16x16x32_bf16 v[144:147], a[132:135], a[36:39], v[144:147]
    ds_read_b128 a[76:79], v43 offset:10240
    v_mfma_f32_16x16x32_bf16 v[148:151], a[128:131], a[40:43], v[148:151]
    ds_read_b32 a145, v57
    v_perm_b32 v58, v98, v35, s38
    v_mfma_f32_16x16x32_bf16 v[148:151], a[132:135], a[44:47], v[148:151]
    buffer_load_dwordx3 v[84:86], v32, s[12:15], s51 offen
    v_mfma_f32_16x16x32_bf16 v[152:155], a[128:131], a[48:51], v[152:155]
    s_waitcnt lgkmcnt(15)
    ds_read_b32 a146, v58
    v_perm_b32 v59, v98, v35, s39
    v_mfma_f32_16x16x32_bf16 v[152:155], a[132:135], a[52:55], v[152:155]
    s_waitcnt lgkmcnt(14)
    ds_read_b128 a[80:83], v42 offset:12288
    v_mfma_f32_16x16x32_bf16 v[156:159], a[128:131], a[56:59], v[156:159]
    s_waitcnt lgkmcnt(13)
    ds_read_b32 a147, v59
    v_perm_b32 v60, v102, v35, s36
    v_mfma_f32_16x16x32_bf16 v[156:159], a[132:135], a[60:63], v[156:159]
    s_waitcnt lgkmcnt(13)
    ds_read_b128 a[84:87], v43 offset:12288
    v_mfma_f32_16x16x32_bf16 v[160:163], a[136:139], a[0:3], v[160:163]
    s_waitcnt lgkmcnt(8)
    ds_read_b32 a148, v60
    v_perm_b32 v61, v102, v35, s37
    v_mfma_f32_16x16x32_bf16 v[160:163], a[140:143], a[4:7], v[160:163]
    buffer_load_dword v83, v34, s[12:15], s50 offen
    v_mfma_f32_16x16x32_bf16 v[164:167], a[136:139], a[8:11], v[164:167]
    ds_read_b32 a149, v61
    v_perm_b32 v62, v102, v35, s38
    v_mfma_f32_16x16x32_bf16 v[164:167], a[140:143], a[12:15], v[164:167]
    ds_read_b128 a[88:91], v42 offset:14336
    v_mfma_f32_16x16x32_bf16 v[168:171], a[136:139], a[16:19], v[168:171]
    ds_read_b32 a150, v62
    v_perm_b32 v63, v102, v35, s39
    v_mfma_f32_16x16x32_bf16 v[168:171], a[140:143], a[20:23], v[168:171]
    ds_read_b128 a[92:95], v43 offset:14336
    v_mfma_f32_16x16x32_bf16 v[172:175], a[136:139], a[24:27], v[172:175]
    ds_read_b32 a151, v63
    v_perm_b32 v56, v99, v35, s36
    v_mfma_f32_16x16x32_bf16 v[172:175], a[140:143], a[28:31], v[172:175]
    buffer_load_dword v87, v34, s[12:15], s51 offen
    v_mfma_f32_16x16x32_bf16 v[176:179], a[136:139], a[32:35], v[176:179]
    ds_read_b32 a152, v56
    v_perm_b32 v57, v99, v35, s37
    v_mfma_f32_16x16x32_bf16 v[176:179], a[140:143], a[36:39], v[176:179]
    ds_read_b128 a[96:99], v42 offset:0
    v_mfma_f32_16x16x32_bf16 v[180:183], a[136:139], a[40:43], v[180:183]
    ds_read_b32 a153, v57
    v_perm_b32 v58, v99, v35, s38
    v_mfma_f32_16x16x32_bf16 v[180:183], a[140:143], a[44:47], v[180:183]
    ds_read_b128 a[100:103], v43 offset:0
    v_mfma_f32_16x16x32_bf16 v[184:187], a[136:139], a[48:51], v[184:187]
    ds_read_b32 a154, v58
    v_perm_b32 v59, v99, v35, s39
    v_mfma_f32_16x16x32_bf16 v[184:187], a[140:143], a[52:55], v[184:187]
    buffer_load_dwordx3 v[88:90], v33, s[12:15], s50 offen
    v_mfma_f32_16x16x32_bf16 v[188:191], a[136:139], a[56:59], v[188:191]
    ds_read_b32 a155, v59
    v_perm_b32 v60, v103, v35, s36
    v_mfma_f32_16x16x32_bf16 v[188:191], a[140:143], a[60:63], v[188:191]
    s_waitcnt lgkmcnt(13)
    ds_read_b128 a[104:107], v42 offset:2048
    v_mfma_f32_16x16x32_bf16 v[192:195], a[144:147], a[0:3], v[192:195]
    s_waitcnt lgkmcnt(7)
    ds_read_b32 a156, v60
    v_perm_b32 v61, v103, v35, s37
    v_mfma_f32_16x16x32_bf16 v[192:195], a[148:151], a[4:7], v[192:195]
    ds_read_b128 a[108:111], v43 offset:2048
    v_mfma_f32_16x16x32_bf16 v[196:199], a[144:147], a[8:11], v[196:199]
    ds_read_b32 a157, v61
    v_perm_b32 v62, v103, v35, s38
    v_mfma_f32_16x16x32_bf16 v[196:199], a[148:151], a[12:15], v[196:199]
    buffer_load_dwordx3 v[92:94], v33, s[12:15], s51 offen
    v_mfma_f32_16x16x32_bf16 v[200:203], a[144:147], a[16:19], v[200:203]
    ds_read_b32 a158, v62
    v_perm_b32 v63, v103, v35, s39
    v_mfma_f32_16x16x32_bf16 v[200:203], a[148:151], a[20:23], v[200:203]
    ds_read_b128 a[112:115], v42 offset:4096
    v_mfma_f32_16x16x32_bf16 v[204:207], a[144:147], a[24:27], v[204:207]
    ds_read_b32 a159, v63
    v_perm_b32 v56, v104, v35, s36
    v_mfma_f32_16x16x32_bf16 v[204:207], a[148:151], a[28:31], v[204:207]
    ds_read_b128 a[116:119], v43 offset:4096
    v_mfma_f32_16x16x32_bf16 v[208:211], a[144:147], a[32:35], v[208:211]
    ds_read_b32 a160, v56
    v_perm_b32 v57, v104, v35, s37
    v_mfma_f32_16x16x32_bf16 v[208:211], a[148:151], a[36:39], v[208:211]
    v_mfma_f32_16x16x32_bf16 v[212:215], a[144:147], a[40:43], v[212:215]
    ds_read_b32 a161, v57
    v_perm_b32 v58, v104, v35, s38
    v_mfma_f32_16x16x32_bf16 v[212:215], a[148:151], a[44:47], v[212:215]
    ds_read_b128 a[120:123], v42 offset:6144
    v_mfma_f32_16x16x32_bf16 v[216:219], a[144:147], a[48:51], v[216:219]
    ds_read_b32 a162, v58
    v_perm_b32 v59, v104, v35, s39
    v_mfma_f32_16x16x32_bf16 v[216:219], a[148:151], a[52:55], v[216:219]
    ds_read_b128 a[124:127], v43 offset:6144
    v_mfma_f32_16x16x32_bf16 v[220:223], a[144:147], a[56:59], v[220:223]
    ds_read_b32 a163, v59
    v_perm_b32 v60, v108, v35, s36
    v_mfma_f32_16x16x32_bf16 v[220:223], a[148:151], a[60:63], v[220:223]
    s_waitcnt lgkmcnt(14)
    v_mfma_f32_16x16x32_bf16 v[224:227], a[152:155], a[0:3], v[224:227]
    s_waitcnt lgkmcnt(7)
    ds_read_b32 a164, v60
    v_perm_b32 v61, v108, v35, s37
    v_mfma_f32_16x16x32_bf16 v[224:227], a[156:159], a[4:7], v[224:227]
    v_mfma_f32_16x16x32_bf16 v[228:231], a[152:155], a[8:11], v[228:231]
    ds_read_b32 a165, v61
    v_perm_b32 v62, v108, v35, s38
    v_mfma_f32_16x16x32_bf16 v[228:231], a[156:159], a[12:15], v[228:231]
    v_mfma_f32_16x16x32_bf16 v[232:235], a[152:155], a[16:19], v[232:235]
    ds_read_b32 a166, v62
    v_perm_b32 v63, v108, v35, s39
    v_mfma_f32_16x16x32_bf16 v[232:235], a[156:159], a[20:23], v[232:235]
    v_mfma_f32_16x16x32_bf16 v[236:239], a[152:155], a[24:27], v[236:239]
    ds_read_b32 a167, v63
    v_perm_b32 v56, v105, v35, s36
    v_mfma_f32_16x16x32_bf16 v[236:239], a[156:159], a[28:31], v[236:239]
    v_mfma_f32_16x16x32_bf16 v[240:243], a[152:155], a[32:35], v[240:243]
    ds_read_b32 a168, v56
    v_perm_b32 v57, v105, v35, s37
    v_mfma_f32_16x16x32_bf16 v[240:243], a[156:159], a[36:39], v[240:243]
    v_mfma_f32_16x16x32_bf16 v[244:247], a[152:155], a[40:43], v[244:247]
    ds_read_b32 a169, v57
    v_perm_b32 v58, v105, v35, s38
    v_mfma_f32_16x16x32_bf16 v[244:247], a[156:159], a[44:47], v[244:247]
    v_mfma_f32_16x16x32_bf16 v[248:251], a[152:155], a[48:51], v[248:251]
    ds_read_b32 a170, v58
    v_perm_b32 v59, v105, v35, s39
    v_mfma_f32_16x16x32_bf16 v[248:251], a[156:159], a[52:55], v[248:251]
    v_mfma_f32_16x16x32_bf16 v[252:255], a[152:155], a[56:59], v[252:255]
    ds_read_b32 a171, v59
    v_perm_b32 v60, v109, v35, s36
    v_mfma_f32_16x16x32_bf16 v[252:255], a[156:159], a[60:63], v[252:255]
    s_waitcnt vmcnt(20) lgkmcnt(9)
    s_barrier
    s_waitcnt lgkmcnt(8)
    v_mfma_f32_16x16x32_bf16 v[128:131], a[160:163], a[64:67], v[128:131]
    s_waitcnt lgkmcnt(4)
    ds_read_b32 a172, v60
    v_perm_b32 v61, v109, v35, s37
    v_mfma_f32_16x16x32_bf16 v[128:131], a[164:167], a[68:71], v[128:131]
    s_add_u32 s56, s56, 128
    ds_read_b128 a[0:3], v40 offset:32768
    v_mfma_f32_16x16x32_bf16 v[132:135], a[160:163], a[72:75], v[132:135]
    ds_read_b32 a173, v61
    v_perm_b32 v62, v109, v35, s38
    v_mfma_f32_16x16x32_bf16 v[132:135], a[164:167], a[76:79], v[132:135]
    s_add_u32 m0, s57, 0
    ds_read_b128 a[4:7], v41 offset:32768
    v_mfma_f32_16x16x32_bf16 v[136:139], a[160:163], a[80:83], v[136:139]
    ds_read_b32 a174, v62
    v_perm_b32 v63, v109, v35, s39
    v_mfma_f32_16x16x32_bf16 v[136:139], a[164:167], a[84:87], v[136:139]
    buffer_load_dwordx4 v36, s[8:11], s56 offen offset:0 lds
    v_mfma_f32_16x16x32_bf16 v[140:143], a[160:163], a[88:91], v[140:143]
    ds_read_b32 a175, v63
    v_perm_b32 v56, v106, v35, s36
    v_mfma_f32_16x16x32_bf16 v[140:143], a[164:167], a[92:95], v[140:143]
    ds_read_b128 a[8:11], v40 offset:34816
    v_mfma_f32_16x16x32_bf16 v[144:147], a[160:163], a[96:99], v[144:147]
    ds_read_b32 a176, v56
    v_perm_b32 v57, v106, v35, s37
    v_mfma_f32_16x16x32_bf16 v[144:147], a[164:167], a[100:103], v[144:147]
    ds_read_b128 a[12:15], v41 offset:34816
    v_mfma_f32_16x16x32_bf16 v[148:151], a[160:163], a[104:107], v[148:151]
    ds_read_b32 a177, v57
    v_perm_b32 v58, v106, v35, s38
    v_mfma_f32_16x16x32_bf16 v[148:151], a[164:167], a[108:111], v[148:151]
    buffer_load_dwordx4 v37, s[8:11], s56 offen offset:1024 lds
    v_mfma_f32_16x16x32_bf16 v[152:155], a[160:163], a[112:115], v[152:155]
    ds_read_b32 a178, v58
    v_perm_b32 v59, v106, v35, s39
    v_mfma_f32_16x16x32_bf16 v[152:155], a[164:167], a[116:119], v[152:155]
    ds_read_b128 a[16:19], v40 offset:36864
    v_mfma_f32_16x16x32_bf16 v[156:159], a[160:163], a[120:123], v[156:159]
    ds_read_b32 a179, v59
    v_perm_b32 v60, v110, v35, s36
    v_mfma_f32_16x16x32_bf16 v[156:159], a[164:167], a[124:127], v[156:159]
    s_waitcnt lgkmcnt(13)
    ds_read_b128 a[20:23], v41 offset:36864
    v_mfma_f32_16x16x32_bf16 v[160:163], a[168:171], a[64:67], v[160:163]
    s_waitcnt lgkmcnt(8)
    ds_read_b32 a180, v60
    v_perm_b32 v61, v110, v35, s37
    v_mfma_f32_16x16x32_bf16 v[160:163], a[172:175], a[68:71], v[160:163]
    buffer_load_dwordx4 v38, s[8:11], s56 offen offset:2048 lds
    v_mfma_f32_16x16x32_bf16 v[164:167], a[168:171], a[72:75], v[164:167]
    ds_read_b32 a181, v61
    v_perm_b32 v62, v110, v35, s38
    v_mfma_f32_16x16x32_bf16 v[164:167], a[172:175], a[76:79], v[164:167]
    ds_read_b128 a[24:27], v40 offset:38912
    v_mfma_f32_16x16x32_bf16 v[168:171], a[168:171], a[80:83], v[168:171]
    ds_read_b32 a182, v62
    v_perm_b32 v63, v110, v35, s39
    v_mfma_f32_16x16x32_bf16 v[168:171], a[172:175], a[84:87], v[168:171]
    ds_read_b128 a[28:31], v41 offset:38912
    v_mfma_f32_16x16x32_bf16 v[172:175], a[168:171], a[88:91], v[172:175]
    ds_read_b32 a183, v63
    v_perm_b32 v56, v112, v35, s36
    v_mfma_f32_16x16x32_bf16 v[172:175], a[172:175], a[92:95], v[172:175]
    buffer_load_dwordx4 v39, s[8:11], s56 offen offset:3072 lds
    v_mfma_f32_16x16x32_bf16 v[176:179], a[168:171], a[96:99], v[176:179]
    ds_read_b32 a128, v56
    v_perm_b32 v57, v112, v35, s37
    v_mfma_f32_16x16x32_bf16 v[176:179], a[172:175], a[100:103], v[176:179]
    s_add_u32 s56, s56, 128
    ds_read_b128 a[32:35], v40 offset:40960
    v_mfma_f32_16x16x32_bf16 v[180:183], a[168:171], a[104:107], v[180:183]
    ds_read_b32 a129, v57
    v_perm_b32 v58, v112, v35, s38
    v_mfma_f32_16x16x32_bf16 v[180:183], a[172:175], a[108:111], v[180:183]
    s_add_u32 m0, s71, 0
    ds_read_b128 a[36:39], v41 offset:40960
    v_mfma_f32_16x16x32_bf16 v[184:187], a[168:171], a[112:115], v[184:187]
    ds_read_b32 a130, v58
    v_perm_b32 v59, v112, v35, s39
    v_mfma_f32_16x16x32_bf16 v[184:187], a[172:175], a[116:119], v[184:187]
    buffer_load_dwordx4 v36, s[8:11], s56 offen offset:0 lds
    v_mfma_f32_16x16x32_bf16 v[188:191], a[168:171], a[120:123], v[188:191]
    ds_read_b32 a131, v59
    v_perm_b32 v60, v116, v35, s36
    v_mfma_f32_16x16x32_bf16 v[188:191], a[172:175], a[124:127], v[188:191]
    s_waitcnt lgkmcnt(13)
    ds_read_b128 a[40:43], v40 offset:43008
    v_mfma_f32_16x16x32_bf16 v[192:195], a[176:179], a[64:67], v[192:195]
    s_waitcnt lgkmcnt(7)
    ds_read_b32 a132, v60
    v_perm_b32 v61, v116, v35, s37
    v_mfma_f32_16x16x32_bf16 v[192:195], a[180:183], a[68:71], v[192:195]
    ds_read_b128 a[44:47], v41 offset:43008
    v_mfma_f32_16x16x32_bf16 v[196:199], a[176:179], a[72:75], v[196:199]
    ds_read_b32 a133, v61
    v_perm_b32 v62, v116, v35, s38
    v_mfma_f32_16x16x32_bf16 v[196:199], a[180:183], a[76:79], v[196:199]
    buffer_load_dwordx4 v37, s[8:11], s56 offen offset:1024 lds
    v_mfma_f32_16x16x32_bf16 v[200:203], a[176:179], a[80:83], v[200:203]
    ds_read_b32 a134, v62
    v_perm_b32 v63, v116, v35, s39
    v_mfma_f32_16x16x32_bf16 v[200:203], a[180:183], a[84:87], v[200:203]
    ds_read_b128 a[48:51], v40 offset:45056
    v_mfma_f32_16x16x32_bf16 v[204:207], a[176:179], a[88:91], v[204:207]
    ds_read_b32 a135, v63
    v_perm_b32 v56, v113, v35, s36
    v_mfma_f32_16x16x32_bf16 v[204:207], a[180:183], a[92:95], v[204:207]
    ds_read_b128 a[52:55], v41 offset:45056
    v_mfma_f32_16x16x32_bf16 v[208:211], a[176:179], a[96:99], v[208:211]
    ds_read_b32 a136, v56
    v_perm_b32 v57, v113, v35, s37
    v_mfma_f32_16x16x32_bf16 v[208:211], a[180:183], a[100:103], v[208:211]
    buffer_load_dwordx4 v38, s[8:11], s56 offen offset:2048 lds
    v_mfma_f32_16x16x32_bf16 v[212:215], a[176:179], a[104:107], v[212:215]
    ds_read_b32 a137, v57
    v_perm_b32 v58, v113, v35, s38
    v_mfma_f32_16x16x32_bf16 v[212:215], a[180:183], a[108:111], v[212:215]
    ds_read_b128 a[56:59], v40 offset:47104
    v_mfma_f32_16x16x32_bf16 v[216:219], a[176:179], a[112:115], v[216:219]
    ds_read_b32 a138, v58
    v_perm_b32 v59, v113, v35, s39
    v_mfma_f32_16x16x32_bf16 v[216:219], a[180:183], a[116:119], v[216:219]
    ds_read_b128 a[60:63], v41 offset:47104
    v_mfma_f32_16x16x32_bf16 v[220:223], a[176:179], a[120:123], v[220:223]
    ds_read_b32 a139, v59
    v_perm_b32 v60, v117, v35, s36
    v_mfma_f32_16x16x32_bf16 v[220:223], a[180:183], a[124:127], v[220:223]
    s_waitcnt lgkmcnt(14)
    buffer_load_dwordx4 v39, s[8:11], s56 offen offset:3072 lds
    v_mfma_f32_16x16x32_bf16 v[128:131], a[128:131], a[0:3], v[128:131]
    s_waitcnt lgkmcnt(7)
    ds_read_b32 a140, v60
    v_perm_b32 v61, v117, v35, s37
    v_mfma_f32_16x16x32_bf16 v[128:131], a[132:135], a[4:7], v[128:131]
    ds_read_b128 a[64:67], v42 offset:40960
    v_mfma_f32_16x16x32_bf16 v[132:135], a[128:131], a[8:11], v[132:135]
    ds_read_b32 a141, v61
    v_perm_b32 v62, v117, v35, s38
    v_mfma_f32_16x16x32_bf16 v[132:135], a[132:135], a[12:15], v[132:135]
    ds_read_b128 a[68:71], v43 offset:40960
    v_mfma_f32_16x16x32_bf16 v[136:139], a[128:131], a[16:19], v[136:139]
    ds_read_b32 a142, v62
    v_perm_b32 v63, v117, v35, s39
    v_mfma_f32_16x16x32_bf16 v[136:139], a[132:135], a[20:23], v[136:139]
    buffer_load_dwordx3 v[96:98], v32, s[12:15], s52 offen
    v_mfma_f32_16x16x32_bf16 v[140:143], a[128:131], a[24:27], v[140:143]
    ds_read_b32 a143, v63
    v_perm_b32 v56, v114, v35, s36
    v_mfma_f32_16x16x32_bf16 v[140:143], a[132:135], a[28:31], v[140:143]
    ds_read_b128 a[72:75], v42 offset:43008
    v_mfma_f32_16x16x32_bf16 v[144:147], a[128:131], a[32:35], v[144:147]
    ds_read_b32 a144, v56
    v_perm_b32 v57, v114, v35, s37
    v_mfma_f32_16x16x32_bf16 v[144:147], a[132:135], a[36:39], v[144:147]
    ds_read_b128 a[76:79], v43 offset:43008
    v_mfma_f32_16x16x32_bf16 v[148:151], a[128:131], a[40:43], v[148:151]
    ds_read_b32 a145, v57
    v_perm_b32 v58, v114, v35, s38
    v_mfma_f32_16x16x32_bf16 v[148:151], a[132:135], a[44:47], v[148:151]
    buffer_load_dwordx3 v[100:102], v32, s[12:15], s53 offen
    v_mfma_f32_16x16x32_bf16 v[152:155], a[128:131], a[48:51], v[152:155]
    s_waitcnt lgkmcnt(15)
    ds_read_b32 a146, v58
    v_perm_b32 v59, v114, v35, s39
    v_mfma_f32_16x16x32_bf16 v[152:155], a[132:135], a[52:55], v[152:155]
    s_waitcnt lgkmcnt(14)
    ds_read_b128 a[80:83], v42 offset:45056
    v_mfma_f32_16x16x32_bf16 v[156:159], a[128:131], a[56:59], v[156:159]
    s_waitcnt lgkmcnt(13)
    ds_read_b32 a147, v59
    v_perm_b32 v60, v118, v35, s36
    v_mfma_f32_16x16x32_bf16 v[156:159], a[132:135], a[60:63], v[156:159]
    s_waitcnt lgkmcnt(13)
    ds_read_b128 a[84:87], v43 offset:45056
    v_mfma_f32_16x16x32_bf16 v[160:163], a[136:139], a[0:3], v[160:163]
    s_waitcnt lgkmcnt(8)
    ds_read_b32 a148, v60
    v_perm_b32 v61, v118, v35, s37
    v_mfma_f32_16x16x32_bf16 v[160:163], a[140:143], a[4:7], v[160:163]
    buffer_load_dword v99, v34, s[12:15], s52 offen
    v_mfma_f32_16x16x32_bf16 v[164:167], a[136:139], a[8:11], v[164:167]
    ds_read_b32 a149, v61
    v_perm_b32 v62, v118, v35, s38
    v_mfma_f32_16x16x32_bf16 v[164:167], a[140:143], a[12:15], v[164:167]
    ds_read_b128 a[88:91], v42 offset:47104
    v_mfma_f32_16x16x32_bf16 v[168:171], a[136:139], a[16:19], v[168:171]
    ds_read_b32 a150, v62
    v_perm_b32 v63, v118, v35, s39
    v_mfma_f32_16x16x32_bf16 v[168:171], a[140:143], a[20:23], v[168:171]
    ds_read_b128 a[92:95], v43 offset:47104
    v_mfma_f32_16x16x32_bf16 v[172:175], a[136:139], a[24:27], v[172:175]
    ds_read_b32 a151, v63
    v_perm_b32 v56, v115, v35, s36
    v_mfma_f32_16x16x32_bf16 v[172:175], a[140:143], a[28:31], v[172:175]
    buffer_load_dword v103, v34, s[12:15], s53 offen
    v_mfma_f32_16x16x32_bf16 v[176:179], a[136:139], a[32:35], v[176:179]
    ds_read_b32 a152, v56
    v_perm_b32 v57, v115, v35, s37
    v_mfma_f32_16x16x32_bf16 v[176:179], a[140:143], a[36:39], v[176:179]
    ds_read_b128 a[96:99], v42 offset:32768
    v_mfma_f32_16x16x32_bf16 v[180:183], a[136:139], a[40:43], v[180:183]
    ds_read_b32 a153, v57
    v_perm_b32 v58, v115, v35, s38
    v_mfma_f32_16x16x32_bf16 v[180:183], a[140:143], a[44:47], v[180:183]
    ds_read_b128 a[100:103], v43 offset:32768
    v_mfma_f32_16x16x32_bf16 v[184:187], a[136:139], a[48:51], v[184:187]
    ds_read_b32 a154, v58
    v_perm_b32 v59, v115, v35, s39
    v_mfma_f32_16x16x32_bf16 v[184:187], a[140:143], a[52:55], v[184:187]
    buffer_load_dwordx3 v[104:106], v33, s[12:15], s52 offen
    v_mfma_f32_16x16x32_bf16 v[188:191], a[136:139], a[56:59], v[188:191]
    ds_read_b32 a155, v59
    v_perm_b32 v60, v119, v35, s36
    v_mfma_f32_16x16x32_bf16 v[188:191], a[140:143], a[60:63], v[188:191]
    s_waitcnt lgkmcnt(13)
    ds_read_b128 a[104:107], v42 offset:34816
    v_mfma_f32_16x16x32_bf16 v[192:195], a[144:147], a[0:3], v[192:195]
    s_waitcnt lgkmcnt(7)
    ds_read_b32 a156, v60
    v_perm_b32 v61, v119, v35, s37
    v_mfma_f32_16x16x32_bf16 v[192:195], a[148:151], a[4:7], v[192:195]
    ds_read_b128 a[108:111], v43 offset:34816
    v_mfma_f32_16x16x32_bf16 v[196:199], a[144:147], a[8:11], v[196:199]
    ds_read_b32 a157, v61
    v_perm_b32 v62, v119, v35, s38
    v_mfma_f32_16x16x32_bf16 v[196:199], a[148:151], a[12:15], v[196:199]
    buffer_load_dwordx3 v[108:110], v33, s[12:15], s53 offen
    v_mfma_f32_16x16x32_bf16 v[200:203], a[144:147], a[16:19], v[200:203]
    ds_read_b32 a158, v62
    v_perm_b32 v63, v119, v35, s39
    v_mfma_f32_16x16x32_bf16 v[200:203], a[148:151], a[20:23], v[200:203]
    ds_read_b128 a[112:115], v42 offset:36864
    v_mfma_f32_16x16x32_bf16 v[204:207], a[144:147], a[24:27], v[204:207]
    ds_read_b32 a159, v63
    v_perm_b32 v56, v120, v35, s36
    v_mfma_f32_16x16x32_bf16 v[204:207], a[148:151], a[28:31], v[204:207]
    ds_read_b128 a[116:119], v43 offset:36864
    v_mfma_f32_16x16x32_bf16 v[208:211], a[144:147], a[32:35], v[208:211]
    ds_read_b32 a160, v56
    v_perm_b32 v57, v120, v35, s37
    v_mfma_f32_16x16x32_bf16 v[208:211], a[148:151], a[36:39], v[208:211]
    v_mfma_f32_16x16x32_bf16 v[212:215], a[144:147], a[40:43], v[212:215]
    ds_read_b32 a161, v57
    v_perm_b32 v58, v120, v35, s38
    v_mfma_f32_16x16x32_bf16 v[212:215], a[148:151], a[44:47], v[212:215]
    ds_read_b128 a[120:123], v42 offset:38912
    v_mfma_f32_16x16x32_bf16 v[216:219], a[144:147], a[48:51], v[216:219]
    ds_read_b32 a162, v58
    v_perm_b32 v59, v120, v35, s39
    v_mfma_f32_16x16x32_bf16 v[216:219], a[148:151], a[52:55], v[216:219]
    ds_read_b128 a[124:127], v43 offset:38912
    v_mfma_f32_16x16x32_bf16 v[220:223], a[144:147], a[56:59], v[220:223]
    ds_read_b32 a163, v59
    v_perm_b32 v60, v124, v35, s36
    v_mfma_f32_16x16x32_bf16 v[220:223], a[148:151], a[60:63], v[220:223]
    s_waitcnt lgkmcnt(14)
    v_mfma_f32_16x16x32_bf16 v[224:227], a[152:155], a[0:3], v[224:227]
    s_waitcnt lgkmcnt(7)
    ds_read_b32 a164, v60
    v_perm_b32 v61, v124, v35, s37
    v_mfma_f32_16x16x32_bf16 v[224:227], a[156:159], a[4:7], v[224:227]
    v_mfma_f32_16x16x32_bf16 v[228:231], a[152:155], a[8:11], v[228:231]
    ds_read_b32 a165, v61
    v_perm_b32 v62, v124, v35, s38
    v_mfma_f32_16x16x32_bf16 v[228:231], a[156:159], a[12:15], v[228:231]
    v_mfma_f32_16x16x32_bf16 v[232:235], a[152:155], a[16:19], v[232:235]
    ds_read_b32 a166, v62
    v_perm_b32 v63, v124, v35, s39
    v_mfma_f32_16x16x32_bf16 v[232:235], a[156:159], a[20:23], v[232:235]
    v_mfma_f32_16x16x32_bf16 v[236:239], a[152:155], a[24:27], v[236:239]
    ds_read_b32 a167, v63
    v_perm_b32 v56, v121, v35, s36
    v_mfma_f32_16x16x32_bf16 v[236:239], a[156:159], a[28:31], v[236:239]
    v_mfma_f32_16x16x32_bf16 v[240:243], a[152:155], a[32:35], v[240:243]
    ds_read_b32 a168, v56
    v_perm_b32 v57, v121, v35, s37
    v_mfma_f32_16x16x32_bf16 v[240:243], a[156:159], a[36:39], v[240:243]
    v_mfma_f32_16x16x32_bf16 v[244:247], a[152:155], a[40:43], v[244:247]
    ds_read_b32 a169, v57
    v_perm_b32 v58, v121, v35, s38
    v_mfma_f32_16x16x32_bf16 v[244:247], a[156:159], a[44:47], v[244:247]
    v_mfma_f32_16x16x32_bf16 v[248:251], a[152:155], a[48:51], v[248:251]
    ds_read_b32 a170, v58
    v_perm_b32 v59, v121, v35, s39
    v_mfma_f32_16x16x32_bf16 v[248:251], a[156:159], a[52:55], v[248:251]
    v_mfma_f32_16x16x32_bf16 v[252:255], a[152:155], a[56:59], v[252:255]
    ds_read_b32 a171, v59
    v_perm_b32 v60, v125, v35, s36
    v_mfma_f32_16x16x32_bf16 v[252:255], a[156:159], a[60:63], v[252:255]
    s_waitcnt vmcnt(20) lgkmcnt(9)
    s_barrier
    s_waitcnt lgkmcnt(8)
    v_mfma_f32_16x16x32_bf16 v[128:131], a[160:163], a[64:67], v[128:131]
    s_waitcnt lgkmcnt(4)
    ds_read_b32 a172, v60
    v_perm_b32 v61, v125, v35, s37
    v_mfma_f32_16x16x32_bf16 v[128:131], a[164:167], a[68:71], v[128:131]
    s_add_u32 s56, s56, 128
    ds_read_b128 a[0:3], v44 offset:0
    v_mfma_f32_16x16x32_bf16 v[132:135], a[160:163], a[72:75], v[132:135]
    ds_read_b32 a173, v61
    v_perm_b32 v62, v125, v35, s38
    v_mfma_f32_16x16x32_bf16 v[132:135], a[164:167], a[76:79], v[132:135]
    s_add_u32 m0, s57, 32768
    ds_read_b128 a[4:7], v45 offset:0
    v_mfma_f32_16x16x32_bf16 v[136:139], a[160:163], a[80:83], v[136:139]
    ds_read_b32 a174, v62
    v_perm_b32 v63, v125, v35, s39
    v_mfma_f32_16x16x32_bf16 v[136:139], a[164:167], a[84:87], v[136:139]
    buffer_load_dwordx4 v36, s[8:11], s56 offen offset:0 lds
    v_mfma_f32_16x16x32_bf16 v[140:143], a[160:163], a[88:91], v[140:143]
    ds_read_b32 a175, v63
    v_perm_b32 v56, v122, v35, s36
    v_mfma_f32_16x16x32_bf16 v[140:143], a[164:167], a[92:95], v[140:143]
    ds_read_b128 a[8:11], v44 offset:2048
    v_mfma_f32_16x16x32_bf16 v[144:147], a[160:163], a[96:99], v[144:147]
    ds_read_b32 a176, v56
    v_perm_b32 v57, v122, v35, s37
    v_mfma_f32_16x16x32_bf16 v[144:147], a[164:167], a[100:103], v[144:147]
    ds_read_b128 a[12:15], v45 offset:2048
    v_mfma_f32_16x16x32_bf16 v[148:151], a[160:163], a[104:107], v[148:151]
    ds_read_b32 a177, v57
    v_perm_b32 v58, v122, v35, s38
    v_mfma_f32_16x16x32_bf16 v[148:151], a[164:167], a[108:111], v[148:151]
    buffer_load_dwordx4 v37, s[8:11], s56 offen offset:1024 lds
    v_mfma_f32_16x16x32_bf16 v[152:155], a[160:163], a[112:115], v[152:155]
    ds_read_b32 a178, v58
    v_perm_b32 v59, v122, v35, s39
    v_mfma_f32_16x16x32_bf16 v[152:155], a[164:167], a[116:119], v[152:155]
    ds_read_b128 a[16:19], v44 offset:4096
    v_mfma_f32_16x16x32_bf16 v[156:159], a[160:163], a[120:123], v[156:159]
    ds_read_b32 a179, v59
    v_perm_b32 v60, v126, v35, s36
    v_mfma_f32_16x16x32_bf16 v[156:159], a[164:167], a[124:127], v[156:159]
    s_waitcnt lgkmcnt(13)
    ds_read_b128 a[20:23], v45 offset:4096
    v_mfma_f32_16x16x32_bf16 v[160:163], a[168:171], a[64:67], v[160:163]
    s_waitcnt lgkmcnt(8)
    ds_read_b32 a180, v60
    v_perm_b32 v61, v126, v35, s37
    v_mfma_f32_16x16x32_bf16 v[160:163], a[172:175], a[68:71], v[160:163]
    buffer_load_dwordx4 v38, s[8:11], s56 offen offset:2048 lds
    v_mfma_f32_16x16x32_bf16 v[164:167], a[168:171], a[72:75], v[164:167]
    ds_read_b32 a181, v61
    v_perm_b32 v62, v126, v35, s38
    v_mfma_f32_16x16x32_bf16 v[164:167], a[172:175], a[76:79], v[164:167]
    ds_read_b128 a[24:27], v44 offset:6144
    v_mfma_f32_16x16x32_bf16 v[168:171], a[168:171], a[80:83], v[168:171]
    ds_read_b32 a182, v62
    v_perm_b32 v63, v126, v35, s39
    v_mfma_f32_16x16x32_bf16 v[168:171], a[172:175], a[84:87], v[168:171]
    ds_read_b128 a[28:31], v45 offset:6144
    v_mfma_f32_16x16x32_bf16 v[172:175], a[168:171], a[88:91], v[172:175]
    ds_read_b32 a183, v63
    v_perm_b32 v56, v64, v35, s36
    v_mfma_f32_16x16x32_bf16 v[172:175], a[172:175], a[92:95], v[172:175]
    buffer_load_dwordx4 v39, s[8:11], s56 offen offset:3072 lds
    v_mfma_f32_16x16x32_bf16 v[176:179], a[168:171], a[96:99], v[176:179]
    ds_read_b32 a128, v56
    v_perm_b32 v57, v64, v35, s37
    v_mfma_f32_16x16x32_bf16 v[176:179], a[172:175], a[100:103], v[176:179]
    s_add_u32 s56, s56, 128
    ds_read_b128 a[32:35], v44 offset:8192
    v_mfma_f32_16x16x32_bf16 v[180:183], a[168:171], a[104:107], v[180:183]
    ds_read_b32 a129, v57
    v_perm_b32 v58, v64, v35, s38
    v_mfma_f32_16x16x32_bf16 v[180:183], a[172:175], a[108:111], v[180:183]
    s_add_u32 m0, s71, 32768
    ds_read_b128 a[36:39], v45 offset:8192
    v_mfma_f32_16x16x32_bf16 v[184:187], a[168:171], a[112:115], v[184:187]
    ds_read_b32 a130, v58
    v_perm_b32 v59, v64, v35, s39
    v_mfma_f32_16x16x32_bf16 v[184:187], a[172:175], a[116:119], v[184:187]
    buffer_load_dwordx4 v36, s[8:11], s56 offen offset:0 lds
    v_mfma_f32_16x16x32_bf16 v[188:191], a[168:171], a[120:123], v[188:191]
    ds_read_b32 a131, v59
    v_perm_b32 v60, v68, v35, s36
    v_mfma_f32_16x16x32_bf16 v[188:191], a[172:175], a[124:127], v[188:191]
    s_waitcnt lgkmcnt(13)
    ds_read_b128 a[40:43], v44 offset:10240
    v_mfma_f32_16x16x32_bf16 v[192:195], a[176:179], a[64:67], v[192:195]
    s_waitcnt lgkmcnt(7)
    ds_read_b32 a132, v60
    v_perm_b32 v61, v68, v35, s37
    v_mfma_f32_16x16x32_bf16 v[192:195], a[180:183], a[68:71], v[192:195]
    ds_read_b128 a[44:47], v45 offset:10240
    v_mfma_f32_16x16x32_bf16 v[196:199], a[176:179], a[72:75], v[196:199]
    ds_read_b32 a133, v61
    v_perm_b32 v62, v68, v35, s38
    v_mfma_f32_16x16x32_bf16 v[196:199], a[180:183], a[76:79], v[196:199]
    buffer_load_dwordx4 v37, s[8:11], s56 offen offset:1024 lds
    v_mfma_f32_16x16x32_bf16 v[200:203], a[176:179], a[80:83], v[200:203]
    ds_read_b32 a134, v62
    v_perm_b32 v63, v68, v35, s39
    v_mfma_f32_16x16x32_bf16 v[200:203], a[180:183], a[84:87], v[200:203]
    ds_read_b128 a[48:51], v44 offset:12288
    v_mfma_f32_16x16x32_bf16 v[204:207], a[176:179], a[88:91], v[204:207]
    ds_read_b32 a135, v63
    v_perm_b32 v56, v65, v35, s36
    v_mfma_f32_16x16x32_bf16 v[204:207], a[180:183], a[92:95], v[204:207]
    ds_read_b128 a[52:55], v45 offset:12288
    v_mfma_f32_16x16x32_bf16 v[208:211], a[176:179], a[96:99], v[208:211]
    ds_read_b32 a136, v56
    v_perm_b32 v57, v65, v35, s37
    v_mfma_f32_16x16x32_bf16 v[208:211], a[180:183], a[100:103], v[208:211]
    buffer_load_dwordx4 v38, s[8:11], s56 offen offset:2048 lds
    v_mfma_f32_16x16x32_bf16 v[212:215], a[176:179], a[104:107], v[212:215]
    ds_read_b32 a137, v57
    v_perm_b32 v58, v65, v35, s38
    v_mfma_f32_16x16x32_bf16 v[212:215], a[180:183], a[108:111], v[212:215]
    ds_read_b128 a[56:59], v44 offset:14336
    v_mfma_f32_16x16x32_bf16 v[216:219], a[176:179], a[112:115], v[216:219]
    ds_read_b32 a138, v58
    v_perm_b32 v59, v65, v35, s39
    v_mfma_f32_16x16x32_bf16 v[216:219], a[180:183], a[116:119], v[216:219]
    ds_read_b128 a[60:63], v45 offset:14336
    v_mfma_f32_16x16x32_bf16 v[220:223], a[176:179], a[120:123], v[220:223]
    ds_read_b32 a139, v59
    v_perm_b32 v60, v69, v35, s36
    v_mfma_f32_16x16x32_bf16 v[220:223], a[180:183], a[124:127], v[220:223]
    s_waitcnt lgkmcnt(14)
    buffer_load_dwordx4 v39, s[8:11], s56 offen offset:3072 lds
    v_mfma_f32_16x16x32_bf16 v[128:131], a[128:131], a[0:3], v[128:131]
    s_waitcnt lgkmcnt(7)
    ds_read_b32 a140, v60
    v_perm_b32 v61, v69, v35, s37
    v_mfma_f32_16x16x32_bf16 v[128:131], a[132:135], a[4:7], v[128:131]
    ds_read_b128 a[64:67], v46 offset:8192
    v_mfma_f32_16x16x32_bf16 v[132:135], a[128:131], a[8:11], v[132:135]
    ds_read_b32 a141, v61
    v_perm_b32 v62, v69, v35, s38
    v_mfma_f32_16x16x32_bf16 v[132:135], a[132:135], a[12:15], v[132:135]
    ds_read_b128 a[68:71], v47 offset:8192
    v_mfma_f32_16x16x32_bf16 v[136:139], a[128:131], a[16:19], v[136:139]
    ds_read_b32 a142, v62
    v_perm_b32 v63, v69, v35, s39
    v_mfma_f32_16x16x32_bf16 v[136:139], a[132:135], a[20:23], v[136:139]
    buffer_load_dwordx3 v[112:114], v32, s[12:15], s54 offen
    v_mfma_f32_16x16x32_bf16 v[140:143], a[128:131], a[24:27], v[140:143]
    ds_read_b32 a143, v63
    v_perm_b32 v56, v66, v35, s36
    v_mfma_f32_16x16x32_bf16 v[140:143], a[132:135], a[28:31], v[140:143]
    ds_read_b128 a[72:75], v46 offset:10240
    v_mfma_f32_16x16x32_bf16 v[144:147], a[128:131], a[32:35], v[144:147]
    ds_read_b32 a144, v56
    v_perm_b32 v57, v66, v35, s37
    v_mfma_f32_16x16x32_bf16 v[144:147], a[132:135], a[36:39], v[144:147]
    ds_read_b128 a[76:79], v47 offset:10240
    v_mfma_f32_16x16x32_bf16 v[148:151], a[128:131], a[40:43], v[148:151]
    ds_read_b32 a145, v57
    v_perm_b32 v58, v66, v35, s38
    v_mfma_f32_16x16x32_bf16 v[148:151], a[132:135], a[44:47], v[148:151]
    buffer_load_dwordx3 v[116:118], v32, s[12:15], s55 offen
    v_mfma_f32_16x16x32_bf16 v[152:155], a[128:131], a[48:51], v[152:155]
    s_waitcnt lgkmcnt(15)
    ds_read_b32 a146, v58
    v_perm_b32 v59, v66, v35, s39
    v_mfma_f32_16x16x32_bf16 v[152:155], a[132:135], a[52:55], v[152:155]
    s_waitcnt lgkmcnt(14)
    ds_read_b128 a[80:83], v46 offset:12288
    v_mfma_f32_16x16x32_bf16 v[156:159], a[128:131], a[56:59], v[156:159]
    s_waitcnt lgkmcnt(13)
    ds_read_b32 a147, v59
    v_perm_b32 v60, v70, v35, s36
    v_mfma_f32_16x16x32_bf16 v[156:159], a[132:135], a[60:63], v[156:159]
    s_waitcnt lgkmcnt(13)
    ds_read_b128 a[84:87], v47 offset:12288
    v_mfma_f32_16x16x32_bf16 v[160:163], a[136:139], a[0:3], v[160:163]
    s_waitcnt lgkmcnt(8)
    ds_read_b32 a148, v60
    v_perm_b32 v61, v70, v35, s37
    v_mfma_f32_16x16x32_bf16 v[160:163], a[140:143], a[4:7], v[160:163]
    buffer_load_dword v115, v34, s[12:15], s54 offen
    v_mfma_f32_16x16x32_bf16 v[164:167], a[136:139], a[8:11], v[164:167]
    ds_read_b32 a149, v61
    v_perm_b32 v62, v70, v35, s38
    v_mfma_f32_16x16x32_bf16 v[164:167], a[140:143], a[12:15], v[164:167]
    ds_read_b128 a[88:91], v46 offset:14336
    v_mfma_f32_16x16x32_bf16 v[168:171], a[136:139], a[16:19], v[168:171]
    ds_read_b32 a150, v62
    v_perm_b32 v63, v70, v35, s39
    v_mfma_f32_16x16x32_bf16 v[168:171], a[140:143], a[20:23], v[168:171]
    ds_read_b128 a[92:95], v47 offset:14336
    v_mfma_f32_16x16x32_bf16 v[172:175], a[136:139], a[24:27], v[172:175]
    ds_read_b32 a151, v63
    v_perm_b32 v56, v67, v35, s36
    v_mfma_f32_16x16x32_bf16 v[172:175], a[140:143], a[28:31], v[172:175]
    buffer_load_dword v119, v34, s[12:15], s55 offen
    v_mfma_f32_16x16x32_bf16 v[176:179], a[136:139], a[32:35], v[176:179]
    ds_read_b32 a152, v56
    v_perm_b32 v57, v67, v35, s37
    v_mfma_f32_16x16x32_bf16 v[176:179], a[140:143], a[36:39], v[176:179]
    ds_read_b128 a[96:99], v46 offset:0
    v_mfma_f32_16x16x32_bf16 v[180:183], a[136:139], a[40:43], v[180:183]
    ds_read_b32 a153, v57
    v_perm_b32 v58, v67, v35, s38
    v_mfma_f32_16x16x32_bf16 v[180:183], a[140:143], a[44:47], v[180:183]
    ds_read_b128 a[100:103], v47 offset:0
    v_mfma_f32_16x16x32_bf16 v[184:187], a[136:139], a[48:51], v[184:187]
    ds_read_b32 a154, v58
    v_perm_b32 v59, v67, v35, s39
    v_mfma_f32_16x16x32_bf16 v[184:187], a[140:143], a[52:55], v[184:187]
    buffer_load_dwordx3 v[120:122], v33, s[12:15], s54 offen
    v_mfma_f32_16x16x32_bf16 v[188:191], a[136:139], a[56:59], v[188:191]
    ds_read_b32 a155, v59
    v_perm_b32 v60, v71, v35, s36
    v_mfma_f32_16x16x32_bf16 v[188:191], a[140:143], a[60:63], v[188:191]
    s_waitcnt lgkmcnt(13)
    ds_read_b128 a[104:107], v46 offset:2048
    v_mfma_f32_16x16x32_bf16 v[192:195], a[144:147], a[0:3], v[192:195]
    s_waitcnt lgkmcnt(7)
    ds_read_b32 a156, v60
    v_perm_b32 v61, v71, v35, s37
    v_mfma_f32_16x16x32_bf16 v[192:195], a[148:151], a[4:7], v[192:195]
    ds_read_b128 a[108:111], v47 offset:2048
    v_mfma_f32_16x16x32_bf16 v[196:199], a[144:147], a[8:11], v[196:199]
    ds_read_b32 a157, v61
    v_perm_b32 v62, v71, v35, s38
    v_mfma_f32_16x16x32_bf16 v[196:199], a[148:151], a[12:15], v[196:199]
    buffer_load_dwordx3 v[124:126], v33, s[12:15], s55 offen
    v_mfma_f32_16x16x32_bf16 v[200:203], a[144:147], a[16:19], v[200:203]
    ds_read_b32 a158, v62
    v_perm_b32 v63, v71, v35, s39
    v_mfma_f32_16x16x32_bf16 v[200:203], a[148:151], a[20:23], v[200:203]
    ds_read_b128 a[112:115], v46 offset:4096
    v_mfma_f32_16x16x32_bf16 v[204:207], a[144:147], a[24:27], v[204:207]
    ds_read_b32 a159, v63
    v_perm_b32 v56, v72, v35, s36
    v_mfma_f32_16x16x32_bf16 v[204:207], a[148:151], a[28:31], v[204:207]
    ds_read_b128 a[116:119], v47 offset:4096
    v_mfma_f32_16x16x32_bf16 v[208:211], a[144:147], a[32:35], v[208:211]
    ds_read_b32 a160, v56
    v_perm_b32 v57, v72, v35, s37
    v_mfma_f32_16x16x32_bf16 v[208:211], a[148:151], a[36:39], v[208:211]
    v_mfma_f32_16x16x32_bf16 v[212:215], a[144:147], a[40:43], v[212:215]
    ds_read_b32 a161, v57
    v_perm_b32 v58, v72, v35, s38
    v_mfma_f32_16x16x32_bf16 v[212:215], a[148:151], a[44:47], v[212:215]
    ds_read_b128 a[120:123], v46 offset:6144
    v_mfma_f32_16x16x32_bf16 v[216:219], a[144:147], a[48:51], v[216:219]
    ds_read_b32 a162, v58
    v_perm_b32 v59, v72, v35, s39
    v_mfma_f32_16x16x32_bf16 v[216:219], a[148:151], a[52:55], v[216:219]
    ds_read_b128 a[124:127], v47 offset:6144
    v_mfma_f32_16x16x32_bf16 v[220:223], a[144:147], a[56:59], v[220:223]
    ds_read_b32 a163, v59
    v_perm_b32 v60, v76, v35, s36
    v_mfma_f32_16x16x32_bf16 v[220:223], a[148:151], a[60:63], v[220:223]
    s_waitcnt lgkmcnt(14)
    v_mfma_f32_16x16x32_bf16 v[224:227], a[152:155], a[0:3], v[224:227]
    s_waitcnt lgkmcnt(7)
    ds_read_b32 a164, v60
    v_perm_b32 v61, v76, v35, s37
    v_mfma_f32_16x16x32_bf16 v[224:227], a[156:159], a[4:7], v[224:227]
    v_mfma_f32_16x16x32_bf16 v[228:231], a[152:155], a[8:11], v[228:231]
    ds_read_b32 a165, v61
    v_perm_b32 v62, v76, v35, s38
    v_mfma_f32_16x16x32_bf16 v[228:231], a[156:159], a[12:15], v[228:231]
    v_mfma_f32_16x16x32_bf16 v[232:235], a[152:155], a[16:19], v[232:235]
    ds_read_b32 a166, v62
    v_perm_b32 v63, v76, v35, s39
    v_mfma_f32_16x16x32_bf16 v[232:235], a[156:159], a[20:23], v[232:235]
    v_mfma_f32_16x16x32_bf16 v[236:239], a[152:155], a[24:27], v[236:239]
    ds_read_b32 a167, v63
    v_perm_b32 v56, v73, v35, s36
    v_mfma_f32_16x16x32_bf16 v[236:239], a[156:159], a[28:31], v[236:239]
    v_mfma_f32_16x16x32_bf16 v[240:243], a[152:155], a[32:35], v[240:243]
    ds_read_b32 a168, v56
    v_perm_b32 v57, v73, v35, s37
    v_mfma_f32_16x16x32_bf16 v[240:243], a[156:159], a[36:39], v[240:243]
    v_mfma_f32_16x16x32_bf16 v[244:247], a[152:155], a[40:43], v[244:247]
    ds_read_b32 a169, v57
    v_perm_b32 v58, v73, v35, s38
    v_mfma_f32_16x16x32_bf16 v[244:247], a[156:159], a[44:47], v[244:247]
    v_mfma_f32_16x16x32_bf16 v[248:251], a[152:155], a[48:51], v[248:251]
    ds_read_b32 a170, v58
    v_perm_b32 v59, v73, v35, s39
    v_mfma_f32_16x16x32_bf16 v[248:251], a[156:159], a[52:55], v[248:251]
    v_mfma_f32_16x16x32_bf16 v[252:255], a[152:155], a[56:59], v[252:255]
    ds_read_b32 a171, v59
    v_perm_b32 v60, v77, v35, s36
    v_mfma_f32_16x16x32_bf16 v[252:255], a[156:159], a[60:63], v[252:255]
    s_waitcnt vmcnt(20) lgkmcnt(9)
    s_barrier
    s_waitcnt lgkmcnt(8)
    v_mfma_f32_16x16x32_bf16 v[128:131], a[160:163], a[64:67], v[128:131]
    s_waitcnt lgkmcnt(4)
    ds_read_b32 a172, v60
    v_perm_b32 v61, v77, v35, s37
    v_mfma_f32_16x16x32_bf16 v[128:131], a[164:167], a[68:71], v[128:131]
    s_add_u32 s56, s56, 128
    ds_read_b128 a[0:3], v40 offset:0
    v_mfma_f32_16x16x32_bf16 v[132:135], a[160:163], a[72:75], v[132:135]
    ds_read_b32 a173, v61
    v_perm_b32 v62, v77, v35, s38
    v_mfma_f32_16x16x32_bf16 v[132:135], a[164:167], a[76:79], v[132:135]
    s_add_u32 m0, s57, 65536
    ds_read_b128 a[4:7], v41 offset:0
    v_mfma_f32_16x16x32_bf16 v[136:139], a[160:163], a[80:83], v[136:139]
    ds_read_b32 a174, v62
    v_perm_b32 v63, v77, v35, s39
    v_mfma_f32_16x16x32_bf16 v[136:139], a[164:167], a[84:87], v[136:139]
    buffer_load_dwordx4 v36, s[8:11], s56 offen offset:0 lds
    v_mfma_f32_16x16x32_bf16 v[140:143], a[160:163], a[88:91], v[140:143]
    ds_read_b32 a175, v63
    v_perm_b32 v56, v74, v35, s36
    v_mfma_f32_16x16x32_bf16 v[140:143], a[164:167], a[92:95], v[140:143]
    ds_read_b128 a[8:11], v40 offset:2048
    v_mfma_f32_16x16x32_bf16 v[144:147], a[160:163], a[96:99], v[144:147]
    ds_read_b32 a176, v56
    v_perm_b32 v57, v74, v35, s37
    v_mfma_f32_16x16x32_bf16 v[144:147], a[164:167], a[100:103], v[144:147]
    ds_read_b128 a[12:15], v41 offset:2048
    v_mfma_f32_16x16x32_bf16 v[148:151], a[160:163], a[104:107], v[148:151]
    ds_read_b32 a177, v57
    v_perm_b32 v58, v74, v35, s38
    v_mfma_f32_16x16x32_bf16 v[148:151], a[164:167], a[108:111], v[148:151]
    buffer_load_dwordx4 v37, s[8:11], s56 offen offset:1024 lds
    v_mfma_f32_16x16x32_bf16 v[152:155], a[160:163], a[112:115], v[152:155]
    ds_read_b32 a178, v58
    v_perm_b32 v59, v74, v35, s39
    v_mfma_f32_16x16x32_bf16 v[152:155], a[164:167], a[116:119], v[152:155]
    ds_read_b128 a[16:19], v40 offset:4096
    v_mfma_f32_16x16x32_bf16 v[156:159], a[160:163], a[120:123], v[156:159]
    ds_read_b32 a179, v59
    v_perm_b32 v60, v78, v35, s36
    v_mfma_f32_16x16x32_bf16 v[156:159], a[164:167], a[124:127], v[156:159]
    s_waitcnt lgkmcnt(13)
    ds_read_b128 a[20:23], v41 offset:4096
    v_mfma_f32_16x16x32_bf16 v[160:163], a[168:171], a[64:67], v[160:163]
    s_waitcnt lgkmcnt(8)
    ds_read_b32 a180, v60
    v_perm_b32 v61, v78, v35, s37
    v_mfma_f32_16x16x32_bf16 v[160:163], a[172:175], a[68:71], v[160:163]
    buffer_load_dwordx4 v38, s[8:11], s56 offen offset:2048 lds
    v_mfma_f32_16x16x32_bf16 v[164:167], a[168:171], a[72:75], v[164:167]
    ds_read_b32 a181, v61
    v_perm_b32 v62, v78, v35, s38
    v_mfma_f32_16x16x32_bf16 v[164:167], a[172:175], a[76:79], v[164:167]
    ds_read_b128 a[24:27], v40 offset:6144
    v_mfma_f32_16x16x32_bf16 v[168:171], a[168:171], a[80:83], v[168:171]
    ds_read_b32 a182, v62
    v_perm_b32 v63, v78, v35, s39
    v_mfma_f32_16x16x32_bf16 v[168:171], a[172:175], a[84:87], v[168:171]
    ds_read_b128 a[28:31], v41 offset:6144
    v_mfma_f32_16x16x32_bf16 v[172:175], a[168:171], a[88:91], v[172:175]
    ds_read_b32 a183, v63
    v_perm_b32 v56, v80, v35, s36
    v_mfma_f32_16x16x32_bf16 v[172:175], a[172:175], a[92:95], v[172:175]
    buffer_load_dwordx4 v39, s[8:11], s56 offen offset:3072 lds
    v_mfma_f32_16x16x32_bf16 v[176:179], a[168:171], a[96:99], v[176:179]
    ds_read_b32 a128, v56
    v_perm_b32 v57, v80, v35, s37
    v_mfma_f32_16x16x32_bf16 v[176:179], a[172:175], a[100:103], v[176:179]
    s_add_u32 s56, s56, 128
    ds_read_b128 a[32:35], v40 offset:8192
    v_mfma_f32_16x16x32_bf16 v[180:183], a[168:171], a[104:107], v[180:183]
    ds_read_b32 a129, v57
    v_perm_b32 v58, v80, v35, s38
    v_mfma_f32_16x16x32_bf16 v[180:183], a[172:175], a[108:111], v[180:183]
    s_add_u32 m0, s71, 65536
    ds_read_b128 a[36:39], v41 offset:8192
    v_mfma_f32_16x16x32_bf16 v[184:187], a[168:171], a[112:115], v[184:187]
    ds_read_b32 a130, v58
    v_perm_b32 v59, v80, v35, s39
    v_mfma_f32_16x16x32_bf16 v[184:187], a[172:175], a[116:119], v[184:187]
    buffer_load_dwordx4 v36, s[8:11], s56 offen offset:0 lds
    v_mfma_f32_16x16x32_bf16 v[188:191], a[168:171], a[120:123], v[188:191]
    ds_read_b32 a131, v59
    v_perm_b32 v60, v84, v35, s36
    v_mfma_f32_16x16x32_bf16 v[188:191], a[172:175], a[124:127], v[188:191]
    s_waitcnt lgkmcnt(13)
    ds_read_b128 a[40:43], v40 offset:10240
    v_mfma_f32_16x16x32_bf16 v[192:195], a[176:179], a[64:67], v[192:195]
    s_waitcnt lgkmcnt(7)
    ds_read_b32 a132, v60
    v_perm_b32 v61, v84, v35, s37
    v_mfma_f32_16x16x32_bf16 v[192:195], a[180:183], a[68:71], v[192:195]
    ds_read_b128 a[44:47], v41 offset:10240
    v_mfma_f32_16x16x32_bf16 v[196:199], a[176:179], a[72:75], v[196:199]
    ds_read_b32 a133, v61
    v_perm_b32 v62, v84, v35, s38
    v_mfma_f32_16x16x32_bf16 v[196:199], a[180:183], a[76:79], v[196:199]
    buffer_load_dwordx4 v37, s[8:11], s56 offen offset:1024 lds
    v_mfma_f32_16x16x32_bf16 v[200:203], a[176:179], a[80:83], v[200:203]
    ds_read_b32 a134, v62
    v_perm_b32 v63, v84, v35, s39
    v_mfma_f32_16x16x32_bf16 v[200:203], a[180:183], a[84:87], v[200:203]
    ds_read_b128 a[48:51], v40 offset:12288
    v_mfma_f32_16x16x32_bf16 v[204:207], a[176:179], a[88:91], v[204:207]
    ds_read_b32 a135, v63
    v_perm_b32 v56, v81, v35, s36
    v_mfma_f32_16x16x32_bf16 v[204:207], a[180:183], a[92:95], v[204:207]
    ds_read_b128 a[52:55], v41 offset:12288
    v_mfma_f32_16x16x32_bf16 v[208:211], a[176:179], a[96:99], v[208:211]
    ds_read_b32 a136, v56
    v_perm_b32 v57, v81, v35, s37
    v_mfma_f32_16x16x32_bf16 v[208:211], a[180:183], a[100:103], v[208:211]
    buffer_load_dwordx4 v38, s[8:11], s56 offen offset:2048 lds
    v_mfma_f32_16x16x32_bf16 v[212:215], a[176:179], a[104:107], v[212:215]
    ds_read_b32 a137, v57
    v_perm_b32 v58, v81, v35, s38
    v_mfma_f32_16x16x32_bf16 v[212:215], a[180:183], a[108:111], v[212:215]
    ds_read_b128 a[56:59], v40 offset:14336
    v_mfma_f32_16x16x32_bf16 v[216:219], a[176:179], a[112:115], v[216:219]
    ds_read_b32 a138, v58
    v_perm_b32 v59, v81, v35, s39
    v_mfma_f32_16x16x32_bf16 v[216:219], a[180:183], a[116:119], v[216:219]
    ds_read_b128 a[60:63], v41 offset:14336
    v_mfma_f32_16x16x32_bf16 v[220:223], a[176:179], a[120:123], v[220:223]
    ds_read_b32 a139, v59
    v_perm_b32 v60, v85, v35, s36
    v_mfma_f32_16x16x32_bf16 v[220:223], a[180:183], a[124:127], v[220:223]
    s_waitcnt lgkmcnt(14)
    buffer_load_dwordx4 v39, s[8:11], s56 offen offset:3072 lds
    v_mfma_f32_16x16x32_bf16 v[128:131], a[128:131], a[0:3], v[128:131]
    s_waitcnt lgkmcnt(7)
    ds_read_b32 a140, v60
    v_perm_b32 v61, v85, v35, s37
    v_mfma_f32_16x16x32_bf16 v[128:131], a[132:135], a[4:7], v[128:131]
    ds_read_b128 a[64:67], v42 offset:8192
    v_mfma_f32_16x16x32_bf16 v[132:135], a[128:131], a[8:11], v[132:135]
    ds_read_b32 a141, v61
    v_perm_b32 v62, v85, v35, s38
    v_mfma_f32_16x16x32_bf16 v[132:135], a[132:135], a[12:15], v[132:135]
    ds_read_b128 a[68:71], v43 offset:8192
    v_mfma_f32_16x16x32_bf16 v[136:139], a[128:131], a[16:19], v[136:139]
    ds_read_b32 a142, v62
    v_perm_b32 v63, v85, v35, s39
    v_mfma_f32_16x16x32_bf16 v[136:139], a[132:135], a[20:23], v[136:139]
    v_mfma_f32_16x16x32_bf16 v[140:143], a[128:131], a[24:27], v[140:143]
    ds_read_b32 a143, v63
    v_perm_b32 v56, v82, v35, s36
    v_mfma_f32_16x16x32_bf16 v[140:143], a[132:135], a[28:31], v[140:143]
    ds_read_b128 a[72:75], v42 offset:10240
    v_mfma_f32_16x16x32_bf16 v[144:147], a[128:131], a[32:35], v[144:147]
    ds_read_b32 a144, v56
    v_perm_b32 v57, v82, v35, s37
    v_mfma_f32_16x16x32_bf16 v[144:147], a[132:135], a[36:39], v[144:147]
    ds_read_b128 a[76:79], v43 offset:10240
    v_mfma_f32_16x16x32_bf16 v[148:151], a[128:131], a[40:43], v[148:151]
    ds_read_b32 a145, v57
    v_perm_b32 v58, v82, v35, s38
    v_mfma_f32_16x16x32_bf16 v[148:151], a[132:135], a[44:47], v[148:151]
    v_mfma_f32_16x16x32_bf16 v[152:155], a[128:131], a[48:51], v[152:155]
    s_waitcnt lgkmcnt(15)
    ds_read_b32 a146, v58
    v_perm_b32 v59, v82, v35, s39
    v_mfma_f32_16x16x32_bf16 v[152:155], a[132:135], a[52:55], v[152:155]
    s_waitcnt lgkmcnt(14)
    ds_read_b128 a[80:83], v42 offset:12288
    v_mfma_f32_16x16x32_bf16 v[156:159], a[128:131], a[56:59], v[156:159]
    s_waitcnt lgkmcnt(13)
    ds_read_b32 a147, v59
    v_perm_b32 v60, v86, v35, s36
    v_mfma_f32_16x16x32_bf16 v[156:159], a[132:135], a[60:63], v[156:159]
    s_waitcnt lgkmcnt(13)
    ds_read_b128 a[84:87], v43 offset:12288
    v_mfma_f32_16x16x32_bf16 v[160:163], a[136:139], a[0:3], v[160:163]
    s_waitcnt lgkmcnt(8)
    ds_read_b32 a148, v60
    v_perm_b32 v61, v86, v35, s37
    v_mfma_f32_16x16x32_bf16 v[160:163], a[140:143], a[4:7], v[160:163]
    v_mfma_f32_16x16x32_bf16 v[164:167], a[136:139], a[8:11], v[164:167]
    ds_read_b32 a149, v61
    v_perm_b32 v62, v86, v35, s38
    v_mfma_f32_16x16x32_bf16 v[164:167], a[140:143], a[12:15], v[164:167]
    ds_read_b128 a[88:91], v42 offset:14336
    v_mfma_f32_16x16x32_bf16 v[168:171], a[136:139], a[16:19], v[168:171]
    ds_read_b32 a150, v62
    v_perm_b32 v63, v86, v35, s39
    v_mfma_f32_16x16x32_bf16 v[168:171], a[140:143], a[20:23], v[168:171]
    ds_read_b128 a[92:95], v43 offset:14336
    v_mfma_f32_16x16x32_bf16 v[172:175], a[136:139], a[24:27], v[172:175]
    ds_read_b32 a151, v63
    v_perm_b32 v56, v83, v35, s36
    v_mfma_f32_16x16x32_bf16 v[172:175], a[140:143], a[28:31], v[172:175]
    v_mfma_f32_16x16x32_bf16 v[176:179], a[136:139], a[32:35], v[176:179]
    ds_read_b32 a152, v56
    v_perm_b32 v57, v83, v35, s37
    v_mfma_f32_16x16x32_bf16 v[176:179], a[140:143], a[36:39], v[176:179]
    ds_read_b128 a[96:99], v42 offset:0
    v_mfma_f32_16x16x32_bf16 v[180:183], a[136:139], a[40:43], v[180:183]
    ds_read_b32 a153, v57
    v_perm_b32 v58, v83, v35, s38
    v_mfma_f32_16x16x32_bf16 v[180:183], a[140:143], a[44:47], v[180:183]
    ds_read_b128 a[100:103], v43 offset:0
    v_mfma_f32_16x16x32_bf16 v[184:187], a[136:139], a[48:51], v[184:187]
    ds_read_b32 a154, v58
    v_perm_b32 v59, v83, v35, s39
    v_mfma_f32_16x16x32_bf16 v[184:187], a[140:143], a[52:55], v[184:187]
    v_mfma_f32_16x16x32_bf16 v[188:191], a[136:139], a[56:59], v[188:191]
    ds_read_b32 a155, v59
    v_perm_b32 v60, v87, v35, s36
    v_mfma_f32_16x16x32_bf16 v[188:191], a[140:143], a[60:63], v[188:191]
    s_waitcnt lgkmcnt(13)
    ds_read_b128 a[104:107], v42 offset:2048
    v_mfma_f32_16x16x32_bf16 v[192:195], a[144:147], a[0:3], v[192:195]
    s_waitcnt lgkmcnt(7)
    ds_read_b32 a156, v60
    v_perm_b32 v61, v87, v35, s37
    v_mfma_f32_16x16x32_bf16 v[192:195], a[148:151], a[4:7], v[192:195]
    ds_read_b128 a[108:111], v43 offset:2048
    v_mfma_f32_16x16x32_bf16 v[196:199], a[144:147], a[8:11], v[196:199]
    ds_read_b32 a157, v61
    v_perm_b32 v62, v87, v35, s38
    v_mfma_f32_16x16x32_bf16 v[196:199], a[148:151], a[12:15], v[196:199]
    v_mfma_f32_16x16x32_bf16 v[200:203], a[144:147], a[16:19], v[200:203]
    ds_read_b32 a158, v62
    v_perm_b32 v63, v87, v35, s39
    v_mfma_f32_16x16x32_bf16 v[200:203], a[148:151], a[20:23], v[200:203]
    ds_read_b128 a[112:115], v42 offset:4096
    v_mfma_f32_16x16x32_bf16 v[204:207], a[144:147], a[24:27], v[204:207]
    ds_read_b32 a159, v63
    v_perm_b32 v56, v88, v35, s36
    v_mfma_f32_16x16x32_bf16 v[204:207], a[148:151], a[28:31], v[204:207]
    ds_read_b128 a[116:119], v43 offset:4096
    v_mfma_f32_16x16x32_bf16 v[208:211], a[144:147], a[32:35], v[208:211]
    ds_read_b32 a160, v56
    v_perm_b32 v57, v88, v35, s37
    v_mfma_f32_16x16x32_bf16 v[208:211], a[148:151], a[36:39], v[208:211]
    v_mfma_f32_16x16x32_bf16 v[212:215], a[144:147], a[40:43], v[212:215]
    ds_read_b32 a161, v57
    v_perm_b32 v58, v88, v35, s38
    v_mfma_f32_16x16x32_bf16 v[212:215], a[148:151], a[44:47], v[212:215]
    ds_read_b128 a[120:123], v42 offset:6144
    v_mfma_f32_16x16x32_bf16 v[216:219], a[144:147], a[48:51], v[216:219]
    ds_read_b32 a162, v58
    v_perm_b32 v59, v88, v35, s39
    v_mfma_f32_16x16x32_bf16 v[216:219], a[148:151], a[52:55], v[216:219]
    ds_read_b128 a[124:127], v43 offset:6144
    v_mfma_f32_16x16x32_bf16 v[220:223], a[144:147], a[56:59], v[220:223]
    ds_read_b32 a163, v59
    v_perm_b32 v60, v92, v35, s36
    v_mfma_f32_16x16x32_bf16 v[220:223], a[148:151], a[60:63], v[220:223]
    s_waitcnt lgkmcnt(14)
    v_mfma_f32_16x16x32_bf16 v[224:227], a[152:155], a[0:3], v[224:227]
    s_waitcnt lgkmcnt(7)
    ds_read_b32 a164, v60
    v_perm_b32 v61, v92, v35, s37
    v_mfma_f32_16x16x32_bf16 v[224:227], a[156:159], a[4:7], v[224:227]
    v_mfma_f32_16x16x32_bf16 v[228:231], a[152:155], a[8:11], v[228:231]
    ds_read_b32 a165, v61
    v_perm_b32 v62, v92, v35, s38
    v_mfma_f32_16x16x32_bf16 v[228:231], a[156:159], a[12:15], v[228:231]
    v_mfma_f32_16x16x32_bf16 v[232:235], a[152:155], a[16:19], v[232:235]
    ds_read_b32 a166, v62
    v_perm_b32 v63, v92, v35, s39
    v_mfma_f32_16x16x32_bf16 v[232:235], a[156:159], a[20:23], v[232:235]
    v_mfma_f32_16x16x32_bf16 v[236:239], a[152:155], a[24:27], v[236:239]
    ds_read_b32 a167, v63
    v_perm_b32 v56, v89, v35, s36
    v_mfma_f32_16x16x32_bf16 v[236:239], a[156:159], a[28:31], v[236:239]
    v_mfma_f32_16x16x32_bf16 v[240:243], a[152:155], a[32:35], v[240:243]
    ds_read_b32 a168, v56
    v_perm_b32 v57, v89, v35, s37
    v_mfma_f32_16x16x32_bf16 v[240:243], a[156:159], a[36:39], v[240:243]
    v_mfma_f32_16x16x32_bf16 v[244:247], a[152:155], a[40:43], v[244:247]
    ds_read_b32 a169, v57
    v_perm_b32 v58, v89, v35, s38
    v_mfma_f32_16x16x32_bf16 v[244:247], a[156:159], a[44:47], v[244:247]
    v_mfma_f32_16x16x32_bf16 v[248:251], a[152:155], a[48:51], v[248:251]
    ds_read_b32 a170, v58
    v_perm_b32 v59, v89, v35, s39
    v_mfma_f32_16x16x32_bf16 v[248:251], a[156:159], a[52:55], v[248:251]
    v_mfma_f32_16x16x32_bf16 v[252:255], a[152:155], a[56:59], v[252:255]
    ds_read_b32 a171, v59
    v_perm_b32 v60, v93, v35, s36
    v_mfma_f32_16x16x32_bf16 v[252:255], a[156:159], a[60:63], v[252:255]
    s_waitcnt vmcnt(14) lgkmcnt(9)
    s_barrier
    s_waitcnt lgkmcnt(8)
    v_mfma_f32_16x16x32_bf16 v[128:131], a[160:163], a[64:67], v[128:131]
    s_waitcnt lgkmcnt(4)
    ds_read_b32 a172, v60
    v_perm_b32 v61, v93, v35, s37
    v_mfma_f32_16x16x32_bf16 v[128:131], a[164:167], a[68:71], v[128:131]
    ds_read_b128 a[0:3], v40 offset:32768
    v_mfma_f32_16x16x32_bf16 v[132:135], a[160:163], a[72:75], v[132:135]
    ds_read_b32 a173, v61
    v_perm_b32 v62, v93, v35, s38
    v_mfma_f32_16x16x32_bf16 v[132:135], a[164:167], a[76:79], v[132:135]
    ds_read_b128 a[4:7], v41 offset:32768
    v_mfma_f32_16x16x32_bf16 v[136:139], a[160:163], a[80:83], v[136:139]
    ds_read_b32 a174, v62
    v_perm_b32 v63, v93, v35, s39
    v_mfma_f32_16x16x32_bf16 v[136:139], a[164:167], a[84:87], v[136:139]
    v_mfma_f32_16x16x32_bf16 v[140:143], a[160:163], a[88:91], v[140:143]
    ds_read_b32 a175, v63
    v_perm_b32 v56, v90, v35, s36
    v_mfma_f32_16x16x32_bf16 v[140:143], a[164:167], a[92:95], v[140:143]
    ds_read_b128 a[8:11], v40 offset:34816
    v_mfma_f32_16x16x32_bf16 v[144:147], a[160:163], a[96:99], v[144:147]
    ds_read_b32 a176, v56
    v_perm_b32 v57, v90, v35, s37
    v_mfma_f32_16x16x32_bf16 v[144:147], a[164:167], a[100:103], v[144:147]
    ds_read_b128 a[12:15], v41 offset:34816
    v_mfma_f32_16x16x32_bf16 v[148:151], a[160:163], a[104:107], v[148:151]
    ds_read_b32 a177, v57
    v_perm_b32 v58, v90, v35, s38
    v_mfma_f32_16x16x32_bf16 v[148:151], a[164:167], a[108:111], v[148:151]
    v_mfma_f32_16x16x32_bf16 v[152:155], a[160:163], a[112:115], v[152:155]
    ds_read_b32 a178, v58
    v_perm_b32 v59, v90, v35, s39
    v_mfma_f32_16x16x32_bf16 v[152:155], a[164:167], a[116:119], v[152:155]
    ds_read_b128 a[16:19], v40 offset:36864
    v_mfma_f32_16x16x32_bf16 v[156:159], a[160:163], a[120:123], v[156:159]
    ds_read_b32 a179, v59
    v_perm_b32 v60, v94, v35, s36
    v_mfma_f32_16x16x32_bf16 v[156:159], a[164:167], a[124:127], v[156:159]
    s_waitcnt lgkmcnt(13)
    ds_read_b128 a[20:23], v41 offset:36864
    v_mfma_f32_16x16x32_bf16 v[160:163], a[168:171], a[64:67], v[160:163]
    s_waitcnt lgkmcnt(8)
    ds_read_b32 a180, v60
    v_perm_b32 v61, v94, v35, s37
    v_mfma_f32_16x16x32_bf16 v[160:163], a[172:175], a[68:71], v[160:163]
    v_mfma_f32_16x16x32_bf16 v[164:167], a[168:171], a[72:75], v[164:167]
    ds_read_b32 a181, v61
    v_perm_b32 v62, v94, v35, s38
    v_mfma_f32_16x16x32_bf16 v[164:167], a[172:175], a[76:79], v[164:167]
    ds_read_b128 a[24:27], v40 offset:38912
    v_mfma_f32_16x16x32_bf16 v[168:171], a[168:171], a[80:83], v[168:171]
    ds_read_b32 a182, v62
    v_perm_b32 v63, v94, v35, s39
    v_mfma_f32_16x16x32_bf16 v[168:171], a[172:175], a[84:87], v[168:171]
    ds_read_b128 a[28:31], v41 offset:38912
    v_mfma_f32_16x16x32_bf16 v[172:175], a[168:171], a[88:91], v[172:175]
    ds_read_b32 a183, v63
    v_perm_b32 v56, v96, v35, s36
    v_mfma_f32_16x16x32_bf16 v[172:175], a[172:175], a[92:95], v[172:175]
    v_mfma_f32_16x16x32_bf16 v[176:179], a[168:171], a[96:99], v[176:179]
    ds_read_b32 a128, v56
    v_perm_b32 v57, v96, v35, s37
    v_mfma_f32_16x16x32_bf16 v[176:179], a[172:175], a[100:103], v[176:179]
    ds_read_b128 a[32:35], v40 offset:40960
    v_mfma_f32_16x16x32_bf16 v[180:183], a[168:171], a[104:107], v[180:183]
    ds_read_b32 a129, v57
    v_perm_b32 v58, v96, v35, s38
    v_mfma_f32_16x16x32_bf16 v[180:183], a[172:175], a[108:111], v[180:183]
    ds_read_b128 a[36:39], v41 offset:40960
    v_mfma_f32_16x16x32_bf16 v[184:187], a[168:171], a[112:115], v[184:187]
    ds_read_b32 a130, v58
    v_perm_b32 v59, v96, v35, s39
    v_mfma_f32_16x16x32_bf16 v[184:187], a[172:175], a[116:119], v[184:187]
    v_mfma_f32_16x16x32_bf16 v[188:191], a[168:171], a[120:123], v[188:191]
    ds_read_b32 a131, v59
    v_perm_b32 v60, v100, v35, s36
    v_mfma_f32_16x16x32_bf16 v[188:191], a[172:175], a[124:127], v[188:191]
    s_waitcnt lgkmcnt(13)
    ds_read_b128 a[40:43], v40 offset:43008
    v_mfma_f32_16x16x32_bf16 v[192:195], a[176:179], a[64:67], v[192:195]
    s_waitcnt lgkmcnt(7)
    ds_read_b32 a132, v60
    v_perm_b32 v61, v100, v35, s37
    v_mfma_f32_16x16x32_bf16 v[192:195], a[180:183], a[68:71], v[192:195]
    ds_read_b128 a[44:47], v41 offset:43008
    v_mfma_f32_16x16x32_bf16 v[196:199], a[176:179], a[72:75], v[196:199]
    ds_read_b32 a133, v61
    v_perm_b32 v62, v100, v35, s38
    v_mfma_f32_16x16x32_bf16 v[196:199], a[180:183], a[76:79], v[196:199]
    v_mfma_f32_16x16x32_bf16 v[200:203], a[176:179], a[80:83], v[200:203]
    ds_read_b32 a134, v62
    v_perm_b32 v63, v100, v35, s39
    v_mfma_f32_16x16x32_bf16 v[200:203], a[180:183], a[84:87], v[200:203]
    ds_read_b128 a[48:51], v40 offset:45056
    v_mfma_f32_16x16x32_bf16 v[204:207], a[176:179], a[88:91], v[204:207]
    ds_read_b32 a135, v63
    v_perm_b32 v56, v97, v35, s36
    v_mfma_f32_16x16x32_bf16 v[204:207], a[180:183], a[92:95], v[204:207]
    ds_read_b128 a[52:55], v41 offset:45056
    v_mfma_f32_16x16x32_bf16 v[208:211], a[176:179], a[96:99], v[208:211]
    ds_read_b32 a136, v56
    v_perm_b32 v57, v97, v35, s37
    v_mfma_f32_16x16x32_bf16 v[208:211], a[180:183], a[100:103], v[208:211]
    v_mfma_f32_16x16x32_bf16 v[212:215], a[176:179], a[104:107], v[212:215]
    ds_read_b32 a137, v57
    v_perm_b32 v58, v97, v35, s38
    v_mfma_f32_16x16x32_bf16 v[212:215], a[180:183], a[108:111], v[212:215]
    ds_read_b128 a[56:59], v40 offset:47104
    v_mfma_f32_16x16x32_bf16 v[216:219], a[176:179], a[112:115], v[216:219]
    ds_read_b32 a138, v58
    v_perm_b32 v59, v97, v35, s39
    v_mfma_f32_16x16x32_bf16 v[216:219], a[180:183], a[116:119], v[216:219]
    ds_read_b128 a[60:63], v41 offset:47104
    v_mfma_f32_16x16x32_bf16 v[220:223], a[176:179], a[120:123], v[220:223]
    ds_read_b32 a139, v59
    v_perm_b32 v60, v101, v35, s36
    v_mfma_f32_16x16x32_bf16 v[220:223], a[180:183], a[124:127], v[220:223]
    s_waitcnt lgkmcnt(14)
    v_mfma_f32_16x16x32_bf16 v[128:131], a[128:131], a[0:3], v[128:131]
    s_waitcnt lgkmcnt(7)
    ds_read_b32 a140, v60
    v_perm_b32 v61, v101, v35, s37
    v_mfma_f32_16x16x32_bf16 v[128:131], a[132:135], a[4:7], v[128:131]
    ds_read_b128 a[64:67], v42 offset:40960
    v_mfma_f32_16x16x32_bf16 v[132:135], a[128:131], a[8:11], v[132:135]
    ds_read_b32 a141, v61
    v_perm_b32 v62, v101, v35, s38
    v_mfma_f32_16x16x32_bf16 v[132:135], a[132:135], a[12:15], v[132:135]
    ds_read_b128 a[68:71], v43 offset:40960
    v_mfma_f32_16x16x32_bf16 v[136:139], a[128:131], a[16:19], v[136:139]
    ds_read_b32 a142, v62
    v_perm_b32 v63, v101, v35, s39
    v_mfma_f32_16x16x32_bf16 v[136:139], a[132:135], a[20:23], v[136:139]
    v_mfma_f32_16x16x32_bf16 v[140:143], a[128:131], a[24:27], v[140:143]
    ds_read_b32 a143, v63
    v_perm_b32 v56, v98, v35, s36
    v_mfma_f32_16x16x32_bf16 v[140:143], a[132:135], a[28:31], v[140:143]
    ds_read_b128 a[72:75], v42 offset:43008
    v_mfma_f32_16x16x32_bf16 v[144:147], a[128:131], a[32:35], v[144:147]
    ds_read_b32 a144, v56
    v_perm_b32 v57, v98, v35, s37
    v_mfma_f32_16x16x32_bf16 v[144:147], a[132:135], a[36:39], v[144:147]
    ds_read_b128 a[76:79], v43 offset:43008
    v_mfma_f32_16x16x32_bf16 v[148:151], a[128:131], a[40:43], v[148:151]
    ds_read_b32 a145, v57
    v_perm_b32 v58, v98, v35, s38
    v_mfma_f32_16x16x32_bf16 v[148:151], a[132:135], a[44:47], v[148:151]
    v_mfma_f32_16x16x32_bf16 v[152:155], a[128:131], a[48:51], v[152:155]
    s_waitcnt lgkmcnt(15)
    ds_read_b32 a146, v58
    v_perm_b32 v59, v98, v35, s39
    v_mfma_f32_16x16x32_bf16 v[152:155], a[132:135], a[52:55], v[152:155]
    s_waitcnt lgkmcnt(14)
    ds_read_b128 a[80:83], v42 offset:45056
    v_mfma_f32_16x16x32_bf16 v[156:159], a[128:131], a[56:59], v[156:159]
    s_waitcnt lgkmcnt(13)
    ds_read_b32 a147, v59
    v_perm_b32 v60, v102, v35, s36
    v_mfma_f32_16x16x32_bf16 v[156:159], a[132:135], a[60:63], v[156:159]
    s_waitcnt lgkmcnt(13)
    ds_read_b128 a[84:87], v43 offset:45056
    v_mfma_f32_16x16x32_bf16 v[160:163], a[136:139], a[0:3], v[160:163]
    s_waitcnt lgkmcnt(8)
    ds_read_b32 a148, v60
    v_perm_b32 v61, v102, v35, s37
    v_mfma_f32_16x16x32_bf16 v[160:163], a[140:143], a[4:7], v[160:163]
    v_mfma_f32_16x16x32_bf16 v[164:167], a[136:139], a[8:11], v[164:167]
    ds_read_b32 a149, v61
    v_perm_b32 v62, v102, v35, s38
    v_mfma_f32_16x16x32_bf16 v[164:167], a[140:143], a[12:15], v[164:167]
    ds_read_b128 a[88:91], v42 offset:47104
    v_mfma_f32_16x16x32_bf16 v[168:171], a[136:139], a[16:19], v[168:171]
    ds_read_b32 a150, v62
    v_perm_b32 v63, v102, v35, s39
    v_mfma_f32_16x16x32_bf16 v[168:171], a[140:143], a[20:23], v[168:171]
    ds_read_b128 a[92:95], v43 offset:47104
    v_mfma_f32_16x16x32_bf16 v[172:175], a[136:139], a[24:27], v[172:175]
    ds_read_b32 a151, v63
    v_perm_b32 v56, v99, v35, s36
    v_mfma_f32_16x16x32_bf16 v[172:175], a[140:143], a[28:31], v[172:175]
    v_mfma_f32_16x16x32_bf16 v[176:179], a[136:139], a[32:35], v[176:179]
    ds_read_b32 a152, v56
    v_perm_b32 v57, v99, v35, s37
    v_mfma_f32_16x16x32_bf16 v[176:179], a[140:143], a[36:39], v[176:179]
    ds_read_b128 a[96:99], v42 offset:32768
    v_mfma_f32_16x16x32_bf16 v[180:183], a[136:139], a[40:43], v[180:183]
    ds_read_b32 a153, v57
    v_perm_b32 v58, v99, v35, s38
    v_mfma_f32_16x16x32_bf16 v[180:183], a[140:143], a[44:47], v[180:183]
    ds_read_b128 a[100:103], v43 offset:32768
    v_mfma_f32_16x16x32_bf16 v[184:187], a[136:139], a[48:51], v[184:187]
    ds_read_b32 a154, v58
    v_perm_b32 v59, v99, v35, s39
    v_mfma_f32_16x16x32_bf16 v[184:187], a[140:143], a[52:55], v[184:187]
    v_mfma_f32_16x16x32_bf16 v[188:191], a[136:139], a[56:59], v[188:191]
    ds_read_b32 a155, v59
    v_perm_b32 v60, v103, v35, s36
    v_mfma_f32_16x16x32_bf16 v[188:191], a[140:143], a[60:63], v[188:191]
    s_waitcnt lgkmcnt(13)
    ds_read_b128 a[104:107], v42 offset:34816
    v_mfma_f32_16x16x32_bf16 v[192:195], a[144:147], a[0:3], v[192:195]
    s_waitcnt lgkmcnt(7)
    ds_read_b32 a156, v60
    v_perm_b32 v61, v103, v35, s37
    v_mfma_f32_16x16x32_bf16 v[192:195], a[148:151], a[4:7], v[192:195]
    ds_read_b128 a[108:111], v43 offset:34816
    v_mfma_f32_16x16x32_bf16 v[196:199], a[144:147], a[8:11], v[196:199]
    ds_read_b32 a157, v61
    v_perm_b32 v62, v103, v35, s38
    v_mfma_f32_16x16x32_bf16 v[196:199], a[148:151], a[12:15], v[196:199]
    v_mfma_f32_16x16x32_bf16 v[200:203], a[144:147], a[16:19], v[200:203]
    ds_read_b32 a158, v62
    v_perm_b32 v63, v103, v35, s39
    v_mfma_f32_16x16x32_bf16 v[200:203], a[148:151], a[20:23], v[200:203]
    ds_read_b128 a[112:115], v42 offset:36864
    v_mfma_f32_16x16x32_bf16 v[204:207], a[144:147], a[24:27], v[204:207]
    ds_read_b32 a159, v63
    v_perm_b32 v56, v104, v35, s36
    v_mfma_f32_16x16x32_bf16 v[204:207], a[148:151], a[28:31], v[204:207]
    ds_read_b128 a[116:119], v43 offset:36864
    v_mfma_f32_16x16x32_bf16 v[208:211], a[144:147], a[32:35], v[208:211]
    ds_read_b32 a160, v56
    v_perm_b32 v57, v104, v35, s37
    v_mfma_f32_16x16x32_bf16 v[208:211], a[148:151], a[36:39], v[208:211]
    v_mfma_f32_16x16x32_bf16 v[212:215], a[144:147], a[40:43], v[212:215]
    ds_read_b32 a161, v57
    v_perm_b32 v58, v104, v35, s38
    v_mfma_f32_16x16x32_bf16 v[212:215], a[148:151], a[44:47], v[212:215]
    ds_read_b128 a[120:123], v42 offset:38912
    v_mfma_f32_16x16x32_bf16 v[216:219], a[144:147], a[48:51], v[216:219]
    ds_read_b32 a162, v58
    v_perm_b32 v59, v104, v35, s39
    v_mfma_f32_16x16x32_bf16 v[216:219], a[148:151], a[52:55], v[216:219]
    ds_read_b128 a[124:127], v43 offset:38912
    v_mfma_f32_16x16x32_bf16 v[220:223], a[144:147], a[56:59], v[220:223]
    ds_read_b32 a163, v59
    v_perm_b32 v60, v108, v35, s36
    v_mfma_f32_16x16x32_bf16 v[220:223], a[148:151], a[60:63], v[220:223]
    s_waitcnt lgkmcnt(14)
    v_mfma_f32_16x16x32_bf16 v[224:227], a[152:155], a[0:3], v[224:227]
    s_waitcnt lgkmcnt(7)
    ds_read_b32 a164, v60
    v_perm_b32 v61, v108, v35, s37
    v_mfma_f32_16x16x32_bf16 v[224:227], a[156:159], a[4:7], v[224:227]
    v_mfma_f32_16x16x32_bf16 v[228:231], a[152:155], a[8:11], v[228:231]
    ds_read_b32 a165, v61
    v_perm_b32 v62, v108, v35, s38
    v_mfma_f32_16x16x32_bf16 v[228:231], a[156:159], a[12:15], v[228:231]
    v_mfma_f32_16x16x32_bf16 v[232:235], a[152:155], a[16:19], v[232:235]
    ds_read_b32 a166, v62
    v_perm_b32 v63, v108, v35, s39
    v_mfma_f32_16x16x32_bf16 v[232:235], a[156:159], a[20:23], v[232:235]
    v_mfma_f32_16x16x32_bf16 v[236:239], a[152:155], a[24:27], v[236:239]
    ds_read_b32 a167, v63
    v_perm_b32 v56, v105, v35, s36
    v_mfma_f32_16x16x32_bf16 v[236:239], a[156:159], a[28:31], v[236:239]
    v_mfma_f32_16x16x32_bf16 v[240:243], a[152:155], a[32:35], v[240:243]
    ds_read_b32 a168, v56
    v_perm_b32 v57, v105, v35, s37
    v_mfma_f32_16x16x32_bf16 v[240:243], a[156:159], a[36:39], v[240:243]
    v_mfma_f32_16x16x32_bf16 v[244:247], a[152:155], a[40:43], v[244:247]
    ds_read_b32 a169, v57
    v_perm_b32 v58, v105, v35, s38
    v_mfma_f32_16x16x32_bf16 v[244:247], a[156:159], a[44:47], v[244:247]
    v_mfma_f32_16x16x32_bf16 v[248:251], a[152:155], a[48:51], v[248:251]
    ds_read_b32 a170, v58
    v_perm_b32 v59, v105, v35, s39
    v_mfma_f32_16x16x32_bf16 v[248:251], a[156:159], a[52:55], v[248:251]
    v_mfma_f32_16x16x32_bf16 v[252:255], a[152:155], a[56:59], v[252:255]
    ds_read_b32 a171, v59
    v_perm_b32 v60, v109, v35, s36
    v_mfma_f32_16x16x32_bf16 v[252:255], a[156:159], a[60:63], v[252:255]
    s_waitcnt vmcnt(0) lgkmcnt(9)
    s_barrier
    s_waitcnt lgkmcnt(8)
    v_mfma_f32_16x16x32_bf16 v[128:131], a[160:163], a[64:67], v[128:131]
    s_waitcnt lgkmcnt(4)
    ds_read_b32 a172, v60
    v_perm_b32 v61, v109, v35, s37
    v_mfma_f32_16x16x32_bf16 v[128:131], a[164:167], a[68:71], v[128:131]
    ds_read_b128 a[0:3], v44 offset:0
    v_mfma_f32_16x16x32_bf16 v[132:135], a[160:163], a[72:75], v[132:135]
    ds_read_b32 a173, v61
    v_perm_b32 v62, v109, v35, s38
    v_mfma_f32_16x16x32_bf16 v[132:135], a[164:167], a[76:79], v[132:135]
    ds_read_b128 a[4:7], v45 offset:0
    v_mfma_f32_16x16x32_bf16 v[136:139], a[160:163], a[80:83], v[136:139]
    ds_read_b32 a174, v62
    v_perm_b32 v63, v109, v35, s39
    v_mfma_f32_16x16x32_bf16 v[136:139], a[164:167], a[84:87], v[136:139]
    v_mfma_f32_16x16x32_bf16 v[140:143], a[160:163], a[88:91], v[140:143]
    ds_read_b32 a175, v63
    v_perm_b32 v56, v106, v35, s36
    v_mfma_f32_16x16x32_bf16 v[140:143], a[164:167], a[92:95], v[140:143]
    ds_read_b128 a[8:11], v44 offset:2048
    v_mfma_f32_16x16x32_bf16 v[144:147], a[160:163], a[96:99], v[144:147]
    ds_read_b32 a176, v56
    v_perm_b32 v57, v106, v35, s37
    v_mfma_f32_16x16x32_bf16 v[144:147], a[164:167], a[100:103], v[144:147]
    ds_read_b128 a[12:15], v45 offset:2048
    v_mfma_f32_16x16x32_bf16 v[148:151], a[160:163], a[104:107], v[148:151]
    ds_read_b32 a177, v57
    v_perm_b32 v58, v106, v35, s38
    v_mfma_f32_16x16x32_bf16 v[148:151], a[164:167], a[108:111], v[148:151]
    v_mfma_f32_16x16x32_bf16 v[152:155], a[160:163], a[112:115], v[152:155]
    ds_read_b32 a178, v58
    v_perm_b32 v59, v106, v35, s39
    v_mfma_f32_16x16x32_bf16 v[152:155], a[164:167], a[116:119], v[152:155]
    ds_read_b128 a[16:19], v44 offset:4096
    v_mfma_f32_16x16x32_bf16 v[156:159], a[160:163], a[120:123], v[156:159]
    ds_read_b32 a179, v59
    v_perm_b32 v60, v110, v35, s36
    v_mfma_f32_16x16x32_bf16 v[156:159], a[164:167], a[124:127], v[156:159]
    s_waitcnt lgkmcnt(13)
    ds_read_b128 a[20:23], v45 offset:4096
    v_mfma_f32_16x16x32_bf16 v[160:163], a[168:171], a[64:67], v[160:163]
    s_waitcnt lgkmcnt(8)
    ds_read_b32 a180, v60
    v_perm_b32 v61, v110, v35, s37
    v_mfma_f32_16x16x32_bf16 v[160:163], a[172:175], a[68:71], v[160:163]
    v_mfma_f32_16x16x32_bf16 v[164:167], a[168:171], a[72:75], v[164:167]
    ds_read_b32 a181, v61
    v_perm_b32 v62, v110, v35, s38
    v_mfma_f32_16x16x32_bf16 v[164:167], a[172:175], a[76:79], v[164:167]
    ds_read_b128 a[24:27], v44 offset:6144
    v_mfma_f32_16x16x32_bf16 v[168:171], a[168:171], a[80:83], v[168:171]
    ds_read_b32 a182, v62
    v_perm_b32 v63, v110, v35, s39
    v_mfma_f32_16x16x32_bf16 v[168:171], a[172:175], a[84:87], v[168:171]
    ds_read_b128 a[28:31], v45 offset:6144
    v_mfma_f32_16x16x32_bf16 v[172:175], a[168:171], a[88:91], v[172:175]
    ds_read_b32 a183, v63
    v_perm_b32 v56, v112, v35, s36
    v_mfma_f32_16x16x32_bf16 v[172:175], a[172:175], a[92:95], v[172:175]
    v_mfma_f32_16x16x32_bf16 v[176:179], a[168:171], a[96:99], v[176:179]
    ds_read_b32 a128, v56
    v_perm_b32 v57, v112, v35, s37
    v_mfma_f32_16x16x32_bf16 v[176:179], a[172:175], a[100:103], v[176:179]
    ds_read_b128 a[32:35], v44 offset:8192
    v_mfma_f32_16x16x32_bf16 v[180:183], a[168:171], a[104:107], v[180:183]
    ds_read_b32 a129, v57
    v_perm_b32 v58, v112, v35, s38
    v_mfma_f32_16x16x32_bf16 v[180:183], a[172:175], a[108:111], v[180:183]
    ds_read_b128 a[36:39], v45 offset:8192
    v_mfma_f32_16x16x32_bf16 v[184:187], a[168:171], a[112:115], v[184:187]
    ds_read_b32 a130, v58
    v_perm_b32 v59, v112, v35, s39
    v_mfma_f32_16x16x32_bf16 v[184:187], a[172:175], a[116:119], v[184:187]
    v_mfma_f32_16x16x32_bf16 v[188:191], a[168:171], a[120:123], v[188:191]
    ds_read_b32 a131, v59
    v_perm_b32 v60, v116, v35, s36
    v_mfma_f32_16x16x32_bf16 v[188:191], a[172:175], a[124:127], v[188:191]
    s_waitcnt lgkmcnt(13)
    ds_read_b128 a[40:43], v44 offset:10240
    v_mfma_f32_16x16x32_bf16 v[192:195], a[176:179], a[64:67], v[192:195]
    s_waitcnt lgkmcnt(7)
    ds_read_b32 a132, v60
    v_perm_b32 v61, v116, v35, s37
    v_mfma_f32_16x16x32_bf16 v[192:195], a[180:183], a[68:71], v[192:195]
    ds_read_b128 a[44:47], v45 offset:10240
    v_mfma_f32_16x16x32_bf16 v[196:199], a[176:179], a[72:75], v[196:199]
    ds_read_b32 a133, v61
    v_perm_b32 v62, v116, v35, s38
    v_mfma_f32_16x16x32_bf16 v[196:199], a[180:183], a[76:79], v[196:199]
    v_mfma_f32_16x16x32_bf16 v[200:203], a[176:179], a[80:83], v[200:203]
    ds_read_b32 a134, v62
    v_perm_b32 v63, v116, v35, s39
    v_mfma_f32_16x16x32_bf16 v[200:203], a[180:183], a[84:87], v[200:203]
    ds_read_b128 a[48:51], v44 offset:12288
    v_mfma_f32_16x16x32_bf16 v[204:207], a[176:179], a[88:91], v[204:207]
    ds_read_b32 a135, v63
    v_perm_b32 v56, v113, v35, s36
    v_mfma_f32_16x16x32_bf16 v[204:207], a[180:183], a[92:95], v[204:207]
    ds_read_b128 a[52:55], v45 offset:12288
    v_mfma_f32_16x16x32_bf16 v[208:211], a[176:179], a[96:99], v[208:211]
    ds_read_b32 a136, v56
    v_perm_b32 v57, v113, v35, s37
    v_mfma_f32_16x16x32_bf16 v[208:211], a[180:183], a[100:103], v[208:211]
    v_mfma_f32_16x16x32_bf16 v[212:215], a[176:179], a[104:107], v[212:215]
    ds_read_b32 a137, v57
    v_perm_b32 v58, v113, v35, s38
    v_mfma_f32_16x16x32_bf16 v[212:215], a[180:183], a[108:111], v[212:215]
    ds_read_b128 a[56:59], v44 offset:14336
    v_mfma_f32_16x16x32_bf16 v[216:219], a[176:179], a[112:115], v[216:219]
    ds_read_b32 a138, v58
    v_perm_b32 v59, v113, v35, s39
    v_mfma_f32_16x16x32_bf16 v[216:219], a[180:183], a[116:119], v[216:219]
    ds_read_b128 a[60:63], v45 offset:14336
    v_mfma_f32_16x16x32_bf16 v[220:223], a[176:179], a[120:123], v[220:223]
    ds_read_b32 a139, v59
    v_perm_b32 v60, v117, v35, s36
    v_mfma_f32_16x16x32_bf16 v[220:223], a[180:183], a[124:127], v[220:223]
    s_waitcnt lgkmcnt(14)
    v_mfma_f32_16x16x32_bf16 v[128:131], a[128:131], a[0:3], v[128:131]
    s_waitcnt lgkmcnt(7)
    ds_read_b32 a140, v60
    v_perm_b32 v61, v117, v35, s37
    v_mfma_f32_16x16x32_bf16 v[128:131], a[132:135], a[4:7], v[128:131]
    ds_read_b128 a[64:67], v46 offset:8192
    v_mfma_f32_16x16x32_bf16 v[132:135], a[128:131], a[8:11], v[132:135]
    ds_read_b32 a141, v61
    v_perm_b32 v62, v117, v35, s38
    v_mfma_f32_16x16x32_bf16 v[132:135], a[132:135], a[12:15], v[132:135]
    ds_read_b128 a[68:71], v47 offset:8192
    v_mfma_f32_16x16x32_bf16 v[136:139], a[128:131], a[16:19], v[136:139]
    ds_read_b32 a142, v62
    v_perm_b32 v63, v117, v35, s39
    v_mfma_f32_16x16x32_bf16 v[136:139], a[132:135], a[20:23], v[136:139]
    v_mfma_f32_16x16x32_bf16 v[140:143], a[128:131], a[24:27], v[140:143]
    ds_read_b32 a143, v63
    v_perm_b32 v56, v114, v35, s36
    v_mfma_f32_16x16x32_bf16 v[140:143], a[132:135], a[28:31], v[140:143]
    ds_read_b128 a[72:75], v46 offset:10240
    v_mfma_f32_16x16x32_bf16 v[144:147], a[128:131], a[32:35], v[144:147]
    ds_read_b32 a144, v56
    v_perm_b32 v57, v114, v35, s37
    v_mfma_f32_16x16x32_bf16 v[144:147], a[132:135], a[36:39], v[144:147]
    ds_read_b128 a[76:79], v47 offset:10240
    v_mfma_f32_16x16x32_bf16 v[148:151], a[128:131], a[40:43], v[148:151]
    ds_read_b32 a145, v57
    v_perm_b32 v58, v114, v35, s38
    v_mfma_f32_16x16x32_bf16 v[148:151], a[132:135], a[44:47], v[148:151]
    v_mfma_f32_16x16x32_bf16 v[152:155], a[128:131], a[48:51], v[152:155]
    s_waitcnt lgkmcnt(15)
    ds_read_b32 a146, v58
    v_perm_b32 v59, v114, v35, s39
    v_mfma_f32_16x16x32_bf16 v[152:155], a[132:135], a[52:55], v[152:155]
    s_waitcnt lgkmcnt(14)
    ds_read_b128 a[80:83], v46 offset:12288
    v_mfma_f32_16x16x32_bf16 v[156:159], a[128:131], a[56:59], v[156:159]
    s_waitcnt lgkmcnt(13)
    ds_read_b32 a147, v59
    v_perm_b32 v60, v118, v35, s36
    v_mfma_f32_16x16x32_bf16 v[156:159], a[132:135], a[60:63], v[156:159]
    s_waitcnt lgkmcnt(13)
    ds_read_b128 a[84:87], v47 offset:12288
    v_mfma_f32_16x16x32_bf16 v[160:163], a[136:139], a[0:3], v[160:163]
    s_waitcnt lgkmcnt(8)
    ds_read_b32 a148, v60
    v_perm_b32 v61, v118, v35, s37
    v_mfma_f32_16x16x32_bf16 v[160:163], a[140:143], a[4:7], v[160:163]
    v_mfma_f32_16x16x32_bf16 v[164:167], a[136:139], a[8:11], v[164:167]
    ds_read_b32 a149, v61
    v_perm_b32 v62, v118, v35, s38
    v_mfma_f32_16x16x32_bf16 v[164:167], a[140:143], a[12:15], v[164:167]
    ds_read_b128 a[88:91], v46 offset:14336
    v_mfma_f32_16x16x32_bf16 v[168:171], a[136:139], a[16:19], v[168:171]
    ds_read_b32 a150, v62
    v_perm_b32 v63, v118, v35, s39
    v_mfma_f32_16x16x32_bf16 v[168:171], a[140:143], a[20:23], v[168:171]
    ds_read_b128 a[92:95], v47 offset:14336
    v_mfma_f32_16x16x32_bf16 v[172:175], a[136:139], a[24:27], v[172:175]
    ds_read_b32 a151, v63
    v_perm_b32 v56, v115, v35, s36
    v_mfma_f32_16x16x32_bf16 v[172:175], a[140:143], a[28:31], v[172:175]
    v_mfma_f32_16x16x32_bf16 v[176:179], a[136:139], a[32:35], v[176:179]
    ds_read_b32 a152, v56
    v_perm_b32 v57, v115, v35, s37
    v_mfma_f32_16x16x32_bf16 v[176:179], a[140:143], a[36:39], v[176:179]
    ds_read_b128 a[96:99], v46 offset:0
    v_mfma_f32_16x16x32_bf16 v[180:183], a[136:139], a[40:43], v[180:183]
    ds_read_b32 a153, v57
    v_perm_b32 v58, v115, v35, s38
    v_mfma_f32_16x16x32_bf16 v[180:183], a[140:143], a[44:47], v[180:183]
    ds_read_b128 a[100:103], v47 offset:0
    v_mfma_f32_16x16x32_bf16 v[184:187], a[136:139], a[48:51], v[184:187]
    ds_read_b32 a154, v58
    v_perm_b32 v59, v115, v35, s39
    v_mfma_f32_16x16x32_bf16 v[184:187], a[140:143], a[52:55], v[184:187]
    v_mfma_f32_16x16x32_bf16 v[188:191], a[136:139], a[56:59], v[188:191]
    ds_read_b32 a155, v59
    v_perm_b32 v60, v119, v35, s36
    v_mfma_f32_16x16x32_bf16 v[188:191], a[140:143], a[60:63], v[188:191]
    s_waitcnt lgkmcnt(13)
    ds_read_b128 a[104:107], v46 offset:2048
    v_mfma_f32_16x16x32_bf16 v[192:195], a[144:147], a[0:3], v[192:195]
    s_waitcnt lgkmcnt(7)
    ds_read_b32 a156, v60
    v_perm_b32 v61, v119, v35, s37
    v_mfma_f32_16x16x32_bf16 v[192:195], a[148:151], a[4:7], v[192:195]
    ds_read_b128 a[108:111], v47 offset:2048
    v_mfma_f32_16x16x32_bf16 v[196:199], a[144:147], a[8:11], v[196:199]
    ds_read_b32 a157, v61
    v_perm_b32 v62, v119, v35, s38
    v_mfma_f32_16x16x32_bf16 v[196:199], a[148:151], a[12:15], v[196:199]
    v_mfma_f32_16x16x32_bf16 v[200:203], a[144:147], a[16:19], v[200:203]
    ds_read_b32 a158, v62
    v_perm_b32 v63, v119, v35, s39
    v_mfma_f32_16x16x32_bf16 v[200:203], a[148:151], a[20:23], v[200:203]
    ds_read_b128 a[112:115], v46 offset:4096
    v_mfma_f32_16x16x32_bf16 v[204:207], a[144:147], a[24:27], v[204:207]
    ds_read_b32 a159, v63
    v_perm_b32 v56, v120, v35, s36
    v_mfma_f32_16x16x32_bf16 v[204:207], a[148:151], a[28:31], v[204:207]
    ds_read_b128 a[116:119], v47 offset:4096
    v_mfma_f32_16x16x32_bf16 v[208:211], a[144:147], a[32:35], v[208:211]
    ds_read_b32 a160, v56
    v_perm_b32 v57, v120, v35, s37
    v_mfma_f32_16x16x32_bf16 v[208:211], a[148:151], a[36:39], v[208:211]
    v_mfma_f32_16x16x32_bf16 v[212:215], a[144:147], a[40:43], v[212:215]
    ds_read_b32 a161, v57
    v_perm_b32 v58, v120, v35, s38
    v_mfma_f32_16x16x32_bf16 v[212:215], a[148:151], a[44:47], v[212:215]
    ds_read_b128 a[120:123], v46 offset:6144
    v_mfma_f32_16x16x32_bf16 v[216:219], a[144:147], a[48:51], v[216:219]
    ds_read_b32 a162, v58
    v_perm_b32 v59, v120, v35, s39
    v_mfma_f32_16x16x32_bf16 v[216:219], a[148:151], a[52:55], v[216:219]
    ds_read_b128 a[124:127], v47 offset:6144
    v_mfma_f32_16x16x32_bf16 v[220:223], a[144:147], a[56:59], v[220:223]
    ds_read_b32 a163, v59
    v_perm_b32 v60, v124, v35, s36
    v_mfma_f32_16x16x32_bf16 v[220:223], a[148:151], a[60:63], v[220:223]
    s_waitcnt lgkmcnt(14)
    v_mfma_f32_16x16x32_bf16 v[224:227], a[152:155], a[0:3], v[224:227]
    s_waitcnt lgkmcnt(7)
    ds_read_b32 a164, v60
    v_perm_b32 v61, v124, v35, s37
    v_mfma_f32_16x16x32_bf16 v[224:227], a[156:159], a[4:7], v[224:227]
    v_mfma_f32_16x16x32_bf16 v[228:231], a[152:155], a[8:11], v[228:231]
    ds_read_b32 a165, v61
    v_perm_b32 v62, v124, v35, s38
    v_mfma_f32_16x16x32_bf16 v[228:231], a[156:159], a[12:15], v[228:231]
    v_mfma_f32_16x16x32_bf16 v[232:235], a[152:155], a[16:19], v[232:235]
    ds_read_b32 a166, v62
    v_perm_b32 v63, v124, v35, s39
    v_mfma_f32_16x16x32_bf16 v[232:235], a[156:159], a[20:23], v[232:235]
    v_mfma_f32_16x16x32_bf16 v[236:239], a[152:155], a[24:27], v[236:239]
    ds_read_b32 a167, v63
    v_perm_b32 v56, v121, v35, s36
    v_mfma_f32_16x16x32_bf16 v[236:239], a[156:159], a[28:31], v[236:239]
    v_mfma_f32_16x16x32_bf16 v[240:243], a[152:155], a[32:35], v[240:243]
    ds_read_b32 a168, v56
    v_perm_b32 v57, v121, v35, s37
    v_mfma_f32_16x16x32_bf16 v[240:243], a[156:159], a[36:39], v[240:243]
    v_mfma_f32_16x16x32_bf16 v[244:247], a[152:155], a[40:43], v[244:247]
    ds_read_b32 a169, v57
    v_perm_b32 v58, v121, v35, s38
    v_mfma_f32_16x16x32_bf16 v[244:247], a[156:159], a[44:47], v[244:247]
    v_mfma_f32_16x16x32_bf16 v[248:251], a[152:155], a[48:51], v[248:251]
    ds_read_b32 a170, v58
    v_perm_b32 v59, v121, v35, s39
    v_mfma_f32_16x16x32_bf16 v[248:251], a[156:159], a[52:55], v[248:251]
    v_mfma_f32_16x16x32_bf16 v[252:255], a[152:155], a[56:59], v[252:255]
    ds_read_b32 a171, v59
    v_perm_b32 v60, v125, v35, s36
    v_mfma_f32_16x16x32_bf16 v[252:255], a[156:159], a[60:63], v[252:255]
    s_waitcnt lgkmcnt(8)
    v_mfma_f32_16x16x32_bf16 v[128:131], a[160:163], a[64:67], v[128:131]
    s_waitcnt lgkmcnt(4)
    ds_read_b32 a172, v60
    v_perm_b32 v61, v125, v35, s37
    v_mfma_f32_16x16x32_bf16 v[128:131], a[164:167], a[68:71], v[128:131]
    v_mfma_f32_16x16x32_bf16 v[132:135], a[160:163], a[72:75], v[132:135]
    ds_read_b32 a173, v61
    v_perm_b32 v62, v125, v35, s38
    v_mfma_f32_16x16x32_bf16 v[132:135], a[164:167], a[76:79], v[132:135]
    v_mfma_f32_16x16x32_bf16 v[136:139], a[160:163], a[80:83], v[136:139]
    ds_read_b32 a174, v62
    v_perm_b32 v63, v125, v35, s39
    v_mfma_f32_16x16x32_bf16 v[136:139], a[164:167], a[84:87], v[136:139]
    v_mfma_f32_16x16x32_bf16 v[140:143], a[160:163], a[88:91], v[140:143]
    ds_read_b32 a175, v63
    v_perm_b32 v56, v122, v35, s36
    v_mfma_f32_16x16x32_bf16 v[140:143], a[164:167], a[92:95], v[140:143]
    v_mfma_f32_16x16x32_bf16 v[144:147], a[160:163], a[96:99], v[144:147]
    ds_read_b32 a176, v56
    v_perm_b32 v57, v122, v35, s37
    v_mfma_f32_16x16x32_bf16 v[144:147], a[164:167], a[100:103], v[144:147]
    v_mfma_f32_16x16x32_bf16 v[148:151], a[160:163], a[104:107], v[148:151]
    ds_read_b32 a177, v57
    v_perm_b32 v58, v122, v35, s38
    v_mfma_f32_16x16x32_bf16 v[148:151], a[164:167], a[108:111], v[148:151]
    v_mfma_f32_16x16x32_bf16 v[152:155], a[160:163], a[112:115], v[152:155]
    ds_read_b32 a178, v58
    v_perm_b32 v59, v122, v35, s39
    v_mfma_f32_16x16x32_bf16 v[152:155], a[164:167], a[116:119], v[152:155]
    v_mfma_f32_16x16x32_bf16 v[156:159], a[160:163], a[120:123], v[156:159]
    ds_read_b32 a179, v59
    v_perm_b32 v60, v126, v35, s36
    v_mfma_f32_16x16x32_bf16 v[156:159], a[164:167], a[124:127], v[156:159]
    s_waitcnt lgkmcnt(8)
    v_mfma_f32_16x16x32_bf16 v[160:163], a[168:171], a[64:67], v[160:163]
    s_waitcnt lgkmcnt(4)
    ds_read_b32 a180, v60
    v_perm_b32 v61, v126, v35, s37
    v_mfma_f32_16x16x32_bf16 v[160:163], a[172:175], a[68:71], v[160:163]
    v_mfma_f32_16x16x32_bf16 v[164:167], a[168:171], a[72:75], v[164:167]
    ds_read_b32 a181, v61
    v_perm_b32 v62, v126, v35, s38
    v_mfma_f32_16x16x32_bf16 v[164:167], a[172:175], a[76:79], v[164:167]
    v_mfma_f32_16x16x32_bf16 v[168:171], a[168:171], a[80:83], v[168:171]
    ds_read_b32 a182, v62
    v_perm_b32 v63, v126, v35, s39
    v_mfma_f32_16x16x32_bf16 v[168:171], a[172:175], a[84:87], v[168:171]
    v_mfma_f32_16x16x32_bf16 v[172:175], a[168:171], a[88:91], v[172:175]
    ds_read_b32 a183, v63
    v_mfma_f32_16x16x32_bf16 v[172:175], a[172:175], a[92:95], v[172:175]
    v_mfma_f32_16x16x32_bf16 v[176:179], a[168:171], a[96:99], v[176:179]
    v_mfma_f32_16x16x32_bf16 v[176:179], a[172:175], a[100:103], v[176:179]
    v_mfma_f32_16x16x32_bf16 v[180:183], a[168:171], a[104:107], v[180:183]
    v_mfma_f32_16x16x32_bf16 v[180:183], a[172:175], a[108:111], v[180:183]
    v_mfma_f32_16x16x32_bf16 v[184:187], a[168:171], a[112:115], v[184:187]
    v_mfma_f32_16x16x32_bf16 v[184:187], a[172:175], a[116:119], v[184:187]
    v_mfma_f32_16x16x32_bf16 v[188:191], a[168:171], a[120:123], v[188:191]
    v_mfma_f32_16x16x32_bf16 v[188:191], a[172:175], a[124:127], v[188:191]
    s_waitcnt lgkmcnt(4)
    v_mfma_f32_16x16x32_bf16 v[192:195], a[176:179], a[64:67], v[192:195]
    s_waitcnt lgkmcnt(0)
    v_mfma_f32_16x16x32_bf16 v[192:195], a[180:183], a[68:71], v[192:195]
    v_mfma_f32_16x16x32_bf16 v[196:199], a[176:179], a[72:75], v[196:199]
    v_mfma_f32_16x16x32_bf16 v[196:199], a[180:183], a[76:79], v[196:199]
    v_mfma_f32_16x16x32_bf16 v[200:203], a[176:179], a[80:83], v[200:203]
    v_mfma_f32_16x16x32_bf16 v[200:203], a[180:183], a[84:87], v[200:203]
    v_mfma_f32_16x16x32_bf16 v[204:207], a[176:179], a[88:91], v[204:207]
    v_mfma_f32_16x16x32_bf16 v[204:207], a[180:183], a[92:95], v[204:207]
    v_mfma_f32_16x16x32_bf16 v[208:211], a[176:179], a[96:99], v[208:211]
    v_mfma_f32_16x16x32_bf16 v[208:211], a[180:183], a[100:103], v[208:211]
    v_mfma_f32_16x16x32_bf16 v[212:215], a[176:179], a[104:107], v[212:215]
    v_mfma_f32_16x16x32_bf16 v[212:215], a[180:183], a[108:111], v[212:215]
    v_mfma_f32_16x16x32_bf16 v[216:219], a[176:179], a[112:115], v[216:219]
    v_mfma_f32_16x16x32_bf16 v[216:219], a[180:183], a[116:119], v[216:219]
    v_mfma_f32_16x16x32_bf16 v[220:223], a[176:179], a[120:123], v[220:223]
    v_mfma_f32_16x16x32_bf16 v[220:223], a[180:183], a[124:127], v[220:223]
    s_barrier
    ds_write_b128 v29, v[240:243] offset:0
    ds_write_b128 v29, v[244:247] offset:1024
    ds_write_b128 v29, v[248:251] offset:2048
    ds_write_b128 v29, v[252:255] offset:3072
    v_lshlrev_b32 v64, 16, v48
    v_and_b32 v65, 0xffff0000, v49
    v_lshlrev_b32 v66, 16, v51
    v_and_b32 v67, 0xffff0000, v52
    v_and_b32 v68, 0xffff0000, v48
    v_lshlrev_b32 v69, 16, v50
    v_and_b32 v70, 0xffff0000, v51
    v_lshlrev_b32 v71, 16, v53
    v_lshlrev_b32 v72, 16, v49
    v_and_b32 v73, 0xffff0000, v50
    v_lshlrev_b32 v74, 16, v52
    v_and_b32 v75, 0xffff0000, v53
    v_lshlrev_b32 v76, 16, v54
    v_and_b32 v77, 0xffff0000, v54
    v_lshlrev_b32 v78, 16, v55
    v_and_b32 v79, 0xffff0000, v55
    s_waitcnt lgkmcnt(0)
    s_barrier
    ds_read_b128 v[80:83], v30 offset:0
    ds_read_b128 v[84:87], v30 offset:1024
    ds_read_b128 v[88:91], v30 offset:2048
    ds_read_b128 v[92:95], v30 offset:3072
    v_pk_mul_f32 v[128:129], v[128:129], v[64:65]
    v_pk_mul_f32 v[130:131], v[130:131], v[66:67]
    v_pk_mul_f32 v[160:161], v[160:161], v[68:69]
    v_pk_mul_f32 v[162:163], v[162:163], v[70:71]
    v_pk_mul_f32 v[192:193], v[192:193], v[72:73]
    v_pk_mul_f32 v[194:195], v[194:195], v[74:75]
    v_cvt_pk_bf16_f32 v96, v128, v160
    v_cvt_pk_bf16_f32 v97, v192, v129
    v_cvt_pk_bf16_f32 v98, v161, v193
    v_cvt_pk_bf16_f32 v99, v130, v162
    v_cvt_pk_bf16_f32 v100, v194, v131
    v_cvt_pk_bf16_f32 v101, v163, v195
    ds_write_b64 v26, v[96:97] offset:0
    ds_write_b64 v26, v[98:99] offset:8
    ds_write_b64 v26, v[100:101] offset:16
    v_pk_mul_f32 v[132:133], v[132:133], v[64:65]
    v_pk_mul_f32 v[134:135], v[134:135], v[66:67]
    v_pk_mul_f32 v[164:165], v[164:165], v[68:69]
    v_pk_mul_f32 v[166:167], v[166:167], v[70:71]
    v_pk_mul_f32 v[196:197], v[196:197], v[72:73]
    v_pk_mul_f32 v[198:199], v[198:199], v[74:75]
    v_cvt_pk_bf16_f32 v102, v132, v164
    v_cvt_pk_bf16_f32 v103, v196, v133
    v_cvt_pk_bf16_f32 v104, v165, v197
    v_cvt_pk_bf16_f32 v105, v134, v166
    v_cvt_pk_bf16_f32 v106, v198, v135
    v_cvt_pk_bf16_f32 v107, v167, v199
    ds_write_b64 v26, v[102:103] offset:7424
    ds_write_b64 v26, v[104:105] offset:7432
    ds_write_b64 v26, v[106:107] offset:7440
    v_pk_mul_f32 v[136:137], v[136:137], v[64:65]
    v_pk_mul_f32 v[138:139], v[138:139], v[66:67]
    v_pk_mul_f32 v[168:169], v[168:169], v[68:69]
    v_pk_mul_f32 v[170:171], v[170:171], v[70:71]
    v_pk_mul_f32 v[200:201], v[200:201], v[72:73]
    v_pk_mul_f32 v[202:203], v[202:203], v[74:75]
    v_cvt_pk_bf16_f32 v96, v136, v168
    v_cvt_pk_bf16_f32 v97, v200, v137
    v_cvt_pk_bf16_f32 v98, v169, v201
    v_cvt_pk_bf16_f32 v99, v138, v170
    v_cvt_pk_bf16_f32 v100, v202, v139
    v_cvt_pk_bf16_f32 v101, v171, v203
    ds_write_b64 v26, v[96:97] offset:14848
    ds_write_b64 v26, v[98:99] offset:14856
    ds_write_b64 v26, v[100:101] offset:14864
    v_pk_mul_f32 v[140:141], v[140:141], v[64:65]
    v_pk_mul_f32 v[142:143], v[142:143], v[66:67]
    v_pk_mul_f32 v[172:173], v[172:173], v[68:69]
    v_pk_mul_f32 v[174:175], v[174:175], v[70:71]
    v_pk_mul_f32 v[204:205], v[204:205], v[72:73]
    v_pk_mul_f32 v[206:207], v[206:207], v[74:75]
    v_cvt_pk_bf16_f32 v102, v140, v172
    v_cvt_pk_bf16_f32 v103, v204, v141
    v_cvt_pk_bf16_f32 v104, v173, v205
    v_cvt_pk_bf16_f32 v105, v142, v174
    v_cvt_pk_bf16_f32 v106, v206, v143
    v_cvt_pk_bf16_f32 v107, v175, v207
    ds_write_b64 v26, v[102:103] offset:22272
    ds_write_b64 v26, v[104:105] offset:22280
    ds_write_b64 v26, v[106:107] offset:22288
    v_pk_mul_f32 v[144:145], v[144:145], v[64:65]
    v_pk_mul_f32 v[146:147], v[146:147], v[66:67]
    v_pk_mul_f32 v[176:177], v[176:177], v[68:69]
    v_pk_mul_f32 v[178:179], v[178:179], v[70:71]
    v_pk_mul_f32 v[208:209], v[208:209], v[72:73]
    v_pk_mul_f32 v[210:211], v[210:211], v[74:75]
    v_cvt_pk_bf16_f32 v96, v144, v176
    v_cvt_pk_bf16_f32 v97, v208, v145
    v_cvt_pk_bf16_f32 v98, v177, v209
    v_cvt_pk_bf16_f32 v99, v146, v178
    v_cvt_pk_bf16_f32 v100, v210, v147
    v_cvt_pk_bf16_f32 v101, v179, v211
    ds_write_b64 v27, v[96:97] offset:0
    ds_write_b64 v27, v[98:99] offset:8
    ds_write_b64 v27, v[100:101] offset:16
    v_pk_mul_f32 v[148:149], v[148:149], v[64:65]
    v_pk_mul_f32 v[150:151], v[150:151], v[66:67]
    v_pk_mul_f32 v[180:181], v[180:181], v[68:69]
    v_pk_mul_f32 v[182:183], v[182:183], v[70:71]
    v_pk_mul_f32 v[212:213], v[212:213], v[72:73]
    v_pk_mul_f32 v[214:215], v[214:215], v[74:75]
    v_cvt_pk_bf16_f32 v102, v148, v180
    v_cvt_pk_bf16_f32 v103, v212, v149
    v_cvt_pk_bf16_f32 v104, v181, v213
    v_cvt_pk_bf16_f32 v105, v150, v182
    v_cvt_pk_bf16_f32 v106, v214, v151
    v_cvt_pk_bf16_f32 v107, v183, v215
    ds_write_b64 v27, v[102:103] offset:7424
    ds_write_b64 v27, v[104:105] offset:7432
    ds_write_b64 v27, v[106:107] offset:7440
    v_pk_mul_f32 v[152:153], v[152:153], v[64:65]
    v_pk_mul_f32 v[154:155], v[154:155], v[66:67]
    v_pk_mul_f32 v[184:185], v[184:185], v[68:69]
    v_pk_mul_f32 v[186:187], v[186:187], v[70:71]
    v_pk_mul_f32 v[216:217], v[216:217], v[72:73]
    v_pk_mul_f32 v[218:219], v[218:219], v[74:75]
    v_cvt_pk_bf16_f32 v96, v152, v184
    v_cvt_pk_bf16_f32 v97, v216, v153
    v_cvt_pk_bf16_f32 v98, v185, v217
    v_cvt_pk_bf16_f32 v99, v154, v186
    v_cvt_pk_bf16_f32 v100, v218, v155
    v_cvt_pk_bf16_f32 v101, v187, v219
    ds_write_b64 v27, v[96:97] offset:14848
    ds_write_b64 v27, v[98:99] offset:14856
    ds_write_b64 v27, v[100:101] offset:14864
    v_pk_mul_f32 v[156:157], v[156:157], v[64:65]
    v_pk_mul_f32 v[158:159], v[158:159], v[66:67]
    v_pk_mul_f32 v[188:189], v[188:189], v[68:69]
    v_pk_mul_f32 v[190:191], v[190:191], v[70:71]
    v_pk_mul_f32 v[220:221], v[220:221], v[72:73]
    v_pk_mul_f32 v[222:223], v[222:223], v[74:75]
    v_cvt_pk_bf16_f32 v102, v156, v188
    v_cvt_pk_bf16_f32 v103, v220, v157
    v_cvt_pk_bf16_f32 v104, v189, v221
    v_cvt_pk_bf16_f32 v105, v158, v190
    v_cvt_pk_bf16_f32 v106, v222, v159
    v_cvt_pk_bf16_f32 v107, v191, v223
    ds_write_b64 v27, v[102:103] offset:22272
    ds_write_b64 v27, v[104:105] offset:22280
    ds_write_b64 v27, v[106:107] offset:22288
    s_waitcnt lgkmcnt(15)
    v_pk_add_f32 v[224:225], v[224:225], v[80:81]
    v_pk_add_f32 v[226:227], v[226:227], v[82:83]
    v_pk_mul_f32 v[224:225], v[224:225], v[76:77]
    v_pk_mul_f32 v[226:227], v[226:227], v[78:79]
    v_cvt_pk_bf16_f32 v108, v224, v225
    v_cvt_pk_bf16_f32 v109, v226, v227
    ds_write_b64 v28, v[108:109] offset:0
    v_pk_add_f32 v[228:229], v[228:229], v[84:85]
    v_pk_add_f32 v[230:231], v[230:231], v[86:87]
    v_pk_mul_f32 v[228:229], v[228:229], v[76:77]
    v_pk_mul_f32 v[230:231], v[230:231], v[78:79]
    v_cvt_pk_bf16_f32 v110, v228, v229
    v_cvt_pk_bf16_f32 v111, v230, v231
    ds_write_b64 v28, v[110:111] offset:7424
    v_pk_add_f32 v[232:233], v[232:233], v[88:89]
    v_pk_add_f32 v[234:235], v[234:235], v[90:91]
    v_pk_mul_f32 v[232:233], v[232:233], v[76:77]
    v_pk_mul_f32 v[234:235], v[234:235], v[78:79]
    v_cvt_pk_bf16_f32 v112, v232, v233
    v_cvt_pk_bf16_f32 v113, v234, v235
    ds_write_b64 v28, v[112:113] offset:14848
    v_pk_add_f32 v[236:237], v[236:237], v[92:93]
    v_pk_add_f32 v[238:239], v[238:239], v[94:95]
    v_pk_mul_f32 v[236:237], v[236:237], v[76:77]
    v_pk_mul_f32 v[238:239], v[238:239], v[78:79]
    v_cvt_pk_bf16_f32 v114, v236, v237
    v_cvt_pk_bf16_f32 v115, v238, v239
    ds_write_b64 v28, v[114:115] offset:22272
    s_mov_b32 s70, 458752
    s_waitcnt lgkmcnt(0)
    s_barrier
    ds_read_b128 v[128:131], v8 offset:0
    ds_read_b128 v[132:135], v9 offset:0
    ds_read_b128 v[136:139], v10 offset:0
    ds_read_b128 v[140:143], v11 offset:0
    ds_read_b128 v[144:147], v12 offset:0
    ds_read_b128 v[148:151], v13 offset:0
    ds_read_b128 v[152:155], v14 offset:0
    ds_read_b128 v[156:159], v8 offset:29696
    ds_read_b128 v[160:163], v9 offset:29696
    ds_read_b128 v[164:167], v10 offset:29696
    ds_read_b128 v[168:171], v11 offset:29696
    ds_read_b128 v[172:175], v12 offset:29696
    ds_read_b128 v[176:179], v13 offset:29696
    ds_read_b128 v[180:183], v14 offset:29696
    s_waitcnt lgkmcnt(13)
    buffer_store_dwordx4 v[128:131], v16, s[16:19], 0 offen sc1
    s_waitcnt lgkmcnt(12)
    buffer_store_dwordx4 v[132:135], v17, s[16:19], 0 offen sc1
    s_waitcnt lgkmcnt(11)
    buffer_store_dwordx4 v[136:139], v18, s[16:19], 0 offen sc1
    s_waitcnt lgkmcnt(10)
    buffer_store_dwordx4 v[140:143], v19, s[16:19], 0 offen sc1
    s_waitcnt lgkmcnt(9)
    buffer_store_dwordx4 v[144:147], v20, s[16:19], 0 offen sc1
    s_waitcnt lgkmcnt(8)
    buffer_store_dwordx4 v[148:151], v21, s[16:19], 0 offen sc1
    s_waitcnt lgkmcnt(7)
    buffer_store_dwordx4 v[152:155], v22, s[16:19], 0 offen sc1
    s_waitcnt lgkmcnt(6)
    buffer_store_dwordx4 v[156:159], v16, s[16:19], s70 offen sc1
    s_waitcnt lgkmcnt(5)
    buffer_store_dwordx4 v[160:163], v17, s[16:19], s70 offen sc1
    s_waitcnt lgkmcnt(4)
    buffer_store_dwordx4 v[164:167], v18, s[16:19], s70 offen sc1
    s_waitcnt lgkmcnt(3)
    buffer_store_dwordx4 v[168:171], v19, s[16:19], s70 offen sc1
    s_waitcnt lgkmcnt(2)
    buffer_store_dwordx4 v[172:175], v20, s[16:19], s70 offen sc1
    s_waitcnt lgkmcnt(1)
    buffer_store_dwordx4 v[176:179], v21, s[16:19], s70 offen sc1
    s_waitcnt lgkmcnt(0)
    buffer_store_dwordx4 v[180:183], v22, s[16:19], s70 offen sc1
L_end:
    s_endpgm

.section .rodata,"a"
.p2align 6
.amdhsa_kernel af4_pack_kernel
  .amdhsa_next_free_vgpr 40
  .amdhsa_next_free_sgpr 32
  .amdhsa_accum_offset 40
  .amdhsa_group_segment_fixed_size 0
  .amdhsa_kernarg_size 56
  .amdhsa_user_sgpr_count 2
  .amdhsa_user_sgpr_kernarg_segment_ptr 1
  .amdhsa_system_sgpr_workgroup_id_x 1
.end_amdhsa_kernel
.p2align 6
.amdhsa_kernel af4_gemm_kernel
  .amdhsa_next_free_vgpr 440
  .amdhsa_next_free_sgpr 102
  .amdhsa_accum_offset 256
  .amdhsa_group_segment_fixed_size 0
  .amdhsa_kernarg_size 56
  .amdhsa_user_sgpr_count 2
  .amdhsa_user_sgpr_kernarg_segment_ptr 1
  .amdhsa_system_sgpr_workgroup_id_x 1
.end_amdhsa_kernel
```

```asm
; @launch kernel=af4_pack_kernel grid=(448,1,1) block=(256,1,1) lds=0
; @launch kernel=af4_gemm_kernel grid=(256,1,1) block=(256,1,1) lds=163840
.amdgcn_target "amdgcn-amd-amdhsa--gfx950"
.text
.globl af4_pack_kernel
.p2align 8
.type af4_pack_kernel,@function
af4_pack_kernel:
    s_cmp_ge_u32 s2, 448
    s_cbranch_scc1 L_pack_end
    s_load_dwordx4 s[4:7], s[0:1], 0
    s_load_dwordx2 s[12:13], s[0:1], 48
    v_lshrrev_b32 v1, 6, v0
    v_and_b32 v2, 63, v0
    v_readfirstlane_b32 s3, v1
    v_lshlrev_b32 v3, 4, v2
    s_lshl_b32 s16, s2, 2
    s_add_u32 s16, s16, s3
    s_mul_hi_u32 s17, s16, 306783379
    s_mul_i32 s18, s17, 14
    s_sub_u32 s18, s16, s18
    s_lshl_b32 s18, s18, 10
    s_mul_i32 s19, s17, 114688
    s_add_u32 s19, s19, s18
    s_mul_i32 s20, s17, 14336
    s_add_u32 s20, s20, s18
    s_waitcnt lgkmcnt(0)
    s_mov_b32 s8, s6
    s_mov_b32 s9, s7
    s_mov_b32 s10, 14680064
    s_mov_b32 s11, 0x20000
    s_mov_b32 s14, 1835008
    s_mov_b32 s15, 0x20000
    buffer_load_dwordx4 v[8:11], v3, s[8:11], s19 offen
    s_add_u32 s19, s19, 14336
    buffer_load_dwordx4 v[12:15], v3, s[8:11], s19 offen
    s_add_u32 s19, s19, 14336
    buffer_load_dwordx4 v[16:19], v3, s[8:11], s19 offen
    s_add_u32 s19, s19, 14336
    buffer_load_dwordx4 v[20:23], v3, s[8:11], s19 offen
    s_add_u32 s19, s19, 14336
    buffer_load_dwordx4 v[24:27], v3, s[8:11], s19 offen
    s_add_u32 s19, s19, 14336
    buffer_load_dwordx4 v[28:31], v3, s[8:11], s19 offen
    s_add_u32 s19, s19, 14336
    buffer_load_dwordx4 v[32:35], v3, s[8:11], s19 offen
    s_add_u32 s19, s19, 14336
    buffer_load_dwordx4 v[36:39], v3, s[8:11], s19 offen
    s_mov_b32 s6, 4194304
    s_mov_b32 s7, 0x20000
    s_lshl_b32 s21, s16, 13
    v_lshlrev_b32 v4, 7, v2
    buffer_load_dword v5, v4, s[4:7], s21 offen
    s_waitcnt vmcnt(7)
    v_lshl_or_b32 v8, v12, 4, v8
    v_lshl_or_b32 v9, v13, 4, v9
    v_lshl_or_b32 v10, v14, 4, v10
    v_lshl_or_b32 v11, v15, 4, v11
    s_waitcnt vmcnt(6)
    v_lshl_or_b32 v8, v16, 8, v8
    v_lshl_or_b32 v9, v17, 8, v9
    v_lshl_or_b32 v10, v18, 8, v10
    v_lshl_or_b32 v11, v19, 8, v11
    s_waitcnt vmcnt(5)
    v_lshl_or_b32 v8, v20, 12, v8
    v_lshl_or_b32 v9, v21, 12, v9
    v_lshl_or_b32 v10, v22, 12, v10
    v_lshl_or_b32 v11, v23, 12, v11
    s_waitcnt vmcnt(4)
    v_lshl_or_b32 v8, v24, 16, v8
    v_lshl_or_b32 v9, v25, 16, v9
    v_lshl_or_b32 v10, v26, 16, v10
    v_lshl_or_b32 v11, v27, 16, v11
    s_waitcnt vmcnt(3)
    v_lshl_or_b32 v8, v28, 20, v8
    v_lshl_or_b32 v9, v29, 20, v9
    v_lshl_or_b32 v10, v30, 20, v10
    v_lshl_or_b32 v11, v31, 20, v11
    s_waitcnt vmcnt(2)
    v_lshl_or_b32 v8, v32, 24, v8
    v_lshl_or_b32 v9, v33, 24, v9
    v_lshl_or_b32 v10, v34, 24, v10
    v_lshl_or_b32 v11, v35, 24, v11
    s_waitcnt vmcnt(1)
    v_lshl_or_b32 v8, v36, 28, v8
    v_lshl_or_b32 v9, v37, 28, v9
    v_lshl_or_b32 v10, v38, 28, v10
    v_lshl_or_b32 v11, v39, 28, v11
    buffer_store_dwordx4 v[8:11], v3, s[12:15], s20 offen
L_pack_end:
    s_endpgm

.text
.globl af4_gemm_kernel
.p2align 8
.type af4_gemm_kernel,@function
af4_gemm_kernel:
    s_cmp_ge_u32 s2, 256
    s_cbranch_scc1 L_end
    s_load_dwordx2 s[8:9], s[0:1], 0
    s_load_dwordx4 s[20:23], s[0:1], 16
    s_load_dwordx2 s[12:13], s[0:1], 48
    s_load_dwordx2 s[16:17], s[0:1], 32
    s_getpc_b64 s[72:73]
    s_mov_b32 s74, L_code_end-af4_gemm_kernel-256
    s_mov_b32 s75, 0x20000
    v_lshlrev_b32 v10, 7, v0
    buffer_load_dword v1, v10, s[72:75], 0 offen offset:256
    v_lshrrev_b32 v5, 6, v0
    v_and_b32 v2, 63, v0
    s_and_b32 s60, s2, 7
    s_lshr_b32 s61, s2, 3
    v_readfirstlane_b32 s63, v5
    v_lshrrev_b32 v3, 4, v2
    v_and_b32 v4, 15, v2
    s_and_b32 s58, s60, 3
    s_lshl_b32 s58, s58, 2
    s_and_b32 s62, s61, 3
    s_add_u32 s58, s58, s62
    s_lshr_b32 s59, s60, 2
    s_lshl_b32 s59, s59, 3
    s_lshr_b32 s62, s61, 2
    s_add_u32 s59, s59, s62
    s_and_b32 s64, s63, 1
    s_lshr_b32 s65, s63, 1
    v_lshlrev_b32 v5, 1, v4
    v_lshrrev_b32 v6, 4, v0
    v_lshlrev_b32 v6, 1, v6
    s_mul_i32 s66, s59, 224
    s_mul_i32 s67, s65, 112
    s_add_u32 s66, s66, s67
    s_mul_i32 s67, s64, 48
    s_add_u32 s67, s66, s67
    v_mul_u32_u24 v7, 14336, v3
    s_mul_i32 s68, s64, 114688
    s_lshl_b32 s69, s67, 2
    s_add_u32 s70, s69, s68
    v_mad_u32_u24 v33, v4, 12, v7
    v_add_u32 v32, s70, v33
    s_sub_u32 s70, 114688, s68
    s_add_u32 s70, s70, s69
    v_add_u32 v33, s70, v33
    s_add_u32 s71, s66, 96
    s_lshl_b32 s70, s71, 2
    s_add_u32 s70, s70, s68
    v_lshl_add_u32 v34, v4, 2, v7
    v_add_u32 v34, s70, v34
    v_lshrrev_b32 v8, 3, v0
    v_and_b32 v9, 7, v2
    v_xor_b32 v9, v9, v3
    s_mul_i32 s70, s63, 24
    v_add_lshl_u32 v8, v8, s70, 11
    v_lshl_add_u32 v36, v9, 4, v8
    v_xor_b32 v37, 64, v36
    v_add_u32 v38, 30720, v36
    v_add_u32 v37, 15360, v37
    v_add_u32 v39, 30720, v37
    s_mov_b32 s10, 4194304
    s_mov_b32 s11, 0x20000
    s_mov_b32 s14, 1835008
    s_mov_b32 s15, 0x20000
    s_mov_b32 s30, 32
    s_mov_b32 s31, 0x20000
    s_lshl_b32 s55, s58, 18
    s_lshl_b32 s57, s63, 12
    s_add_u32 s57, s57, 65536
    s_waitcnt lgkmcnt(0)
    s_mov_b32 s28, s20
    s_mov_b32 s29, s21
    buffer_load_ushort v16, v5, s[28:31], 0 offen
    buffer_load_ushort v17, v6, s[28:31], 0 offen
    s_mov_b32 s40, 0
    buffer_load_dwordx3 v[64:66], v32, s[12:15], s40 offen
    buffer_load_dword v67, v34, s[12:15], s40 offen
    s_mov_b32 s41, 57344
    buffer_load_dwordx3 v[68:70], v32, s[12:15], s41 offen
    buffer_load_dword v71, v34, s[12:15], s41 offen
    s_mov_b32 s42, 0
    buffer_load_dwordx3 v[72:74], v33, s[12:15], s42 offen
    s_mov_b32 s43, 57344
    buffer_load_dwordx3 v[76:78], v33, s[12:15], s43 offen
    s_add_u32 m0, s57, 32768
    s_add_u32 s56, s55, 0
    buffer_load_dwordx4 v36, s[8:11], s56 offen offset:0 lds
    buffer_load_dwordx4 v37, s[8:11], s56 offen offset:1024 lds
    buffer_load_dwordx4 v38, s[8:11], s56 offen offset:2048 lds
    buffer_load_dwordx4 v39, s[8:11], s56 offen offset:3072 lds
    s_add_u32 m0, s57, 51200
    s_add_u32 s56, s55, 128
    buffer_load_dwordx4 v36, s[8:11], s56 offen offset:0 lds
    buffer_load_dwordx4 v37, s[8:11], s56 offen offset:1024 lds
    s_add_u32 m0, s57, 47104
    s_nop 0
    buffer_load_dwordx4 v38, s[8:11], s56 offen offset:2048 lds
    buffer_load_dwordx4 v39, s[8:11], s56 offen offset:3072 lds
    s_mov_b32 s44, 229376
    buffer_load_dwordx3 v[80:82], v32, s[12:15], s44 offen
    buffer_load_dword v83, v34, s[12:15], s44 offen
    s_mov_b32 s45, 286720
    buffer_load_dwordx3 v[84:86], v32, s[12:15], s45 offen
    buffer_load_dword v87, v34, s[12:15], s45 offen
    s_add_u32 m0, s57, 65536
    s_add_u32 s56, s55, 256
    buffer_load_dwordx4 v36, s[8:11], s56 offen offset:0 lds
    buffer_load_dwordx4 v37, s[8:11], s56 offen offset:1024 lds
    buffer_load_dwordx4 v38, s[8:11], s56 offen offset:2048 lds
    buffer_load_dwordx4 v39, s[8:11], s56 offen offset:3072 lds
    s_add_u32 m0, s57, 83968
    s_add_u32 s56, s55, 384
    buffer_load_dwordx4 v36, s[8:11], s56 offen offset:0 lds
    buffer_load_dwordx4 v37, s[8:11], s56 offen offset:1024 lds
    s_add_u32 m0, s57, 79872
    s_nop 0
    buffer_load_dwordx4 v38, s[8:11], s56 offen offset:2048 lds
    buffer_load_dwordx4 v39, s[8:11], s56 offen offset:3072 lds
    s_mov_b32 s32, s22
    s_mov_b32 s33, s23
    s_mov_b32 s34, 7168
    s_mov_b32 s35, 0x20000
    s_mov_b32 s18, 14680064
    s_mov_b32 s19, 0x20000
    s_mov_b32 s36, 202114048
    s_mov_b32 s37, 202114304
    s_mov_b32 s38, 202114560
    s_mov_b32 s39, 202114816
    v_and_b32 v18, 7, v0
    v_lshlrev_b32 v18, 4, v18
    v_lshl_add_u32 v18, v0, 8, v18
    v_and_b32 v35, 31, v2
    v_lshlrev_b32 v35, 2, v35
    v_lshrrev_b32 v8, 1, v4
    v_xor_b32 v8, v8, v3
    v_lshlrev_b32 v8, 4, v8
    v_lshl_add_u32 v8, v4, 7, v8
    s_lshl_b32 s70, s64, 14
    s_add_u32 s72, s70, 65536
    s_sub_u32 s73, 81920, s70
    v_add_u32 v40, s72, v8
    v_add_u32 v42, s73, v8
    v_xor_b32 v41, 64, v40
    v_xor_b32 v43, 64, v42
    v_add_u32 v44, 65536, v40
    v_add_u32 v45, 65536, v41
    v_add_u32 v46, 65536, v42
    v_add_u32 v47, 65536, v43
    s_lshl_b32 s70, s67, 1
    v_mad_u32_u24 v22, v3, 24, s70
    s_lshl_b32 s70, s71, 1
    v_lshl_add_u32 v23, v3, 3, s70
    v_mul_u32_u24 v8, 464, v4
    s_mul_i32 s70, s64, 7424
    s_mul_i32 s72, s65, 224
    s_mul_i32 s73, s64, 96
    s_add_u32 s73, s73, s72
    v_mad_u32_u24 v9, v3, 24, v8
    s_add_u32 s74, s73, s70
    v_add_u32 v26, s74, v9
    s_sub_u32 s74, 7424, s70
    s_add_u32 s74, s74, s73
    v_add_u32 v27, s74, v9
    s_add_u32 s74, s72, s70
    s_add_u32 s74, s74, 192
    v_lshl_add_u32 v28, v3, 3, v8
    v_add_u32 v28, s74, v28
    v_lshlrev_b32 v29, 4, v0
    v_add_u32 v29, 65536, v29
    v_xor_b32 v30, 1024, v29
    v_mul_u32_u24 v8, 2341, v2
    v_lshrrev_b32 v8, 16, v8
    s_mul_i32 s73, s63, 3712
    v_add_lshl_u32 v24, v2, v8, 4
    v_add_u32 v24, s73, v24
    s_lshl_b32 s74, s58, 7
    s_lshl_b32 s75, s63, 3
    s_add_u32 s74, s74, s75
    s_mul_i32 s74, s74, 7168
    s_mul_i32 s75, s59, 448
    s_add_u32 s74, s74, s75
    v_mul_u32_u24 v9, 6720, v8
    v_lshl_add_u32 v25, v2, 4, v9
    v_lshrrev_b32 v8, 1, v8
    v_lshlrev_b32 v8, 30, v8
    v_add3_u32 v25, v25, v8, s74
    s_waitcnt vmcnt(26)
    v_lshl_or_b32 v56, v17, 16, v16
    v_lshl_or_b32 v57, v17, 16, v16
    v_lshl_or_b32 v58, v17, 16, v16
    v_lshl_or_b32 v59, v17, 16, v16
    v_xor_b32 v9, 16, v18
    v_xor_b32 v10, 32, v18
    v_xor_b32 v11, 48, v18
    v_xor_b32 v12, 64, v18
    v_xor_b32 v13, 80, v18
    v_xor_b32 v14, 96, v18
    v_xor_b32 v15, 112, v18
    ds_write_b128 v18, v[56:59]
    ds_write_b128 v9, v[56:59]
    ds_write_b128 v10, v[56:59]
    ds_write_b128 v11, v[56:59]
    ds_write_b128 v12, v[56:59]
    ds_write_b128 v13, v[56:59]
    ds_write_b128 v14, v[56:59]
    ds_write_b128 v15, v[56:59]
    s_waitcnt vmcnt(25) lgkmcnt(0)
    v_perm_b32 v56, v64, v35, s36
    v_perm_b32 v57, v64, v35, s37
    v_perm_b32 v58, v64, v35, s38
    v_perm_b32 v59, v64, v35, s39
    s_waitcnt vmcnt(23)
    v_perm_b32 v60, v68, v35, s36
    v_perm_b32 v61, v68, v35, s37
    v_perm_b32 v62, v68, v35, s38
    v_perm_b32 v63, v68, v35, s39
    v_perm_b32 v8, v65, v35, s36
    v_perm_b32 v9, v65, v35, s37
    v_perm_b32 v10, v65, v35, s38
    v_perm_b32 v11, v65, v35, s39
    v_perm_b32 v12, v69, v35, s36
    s_waitcnt vmcnt(12)
    s_barrier
    ds_read_b32 a32, v56
    ds_read_b32 a33, v57
    ds_read_b32 a34, v58
    ds_read_b32 a35, v59
    ds_read_b128 a[0:3], v40 offset:32768
    ds_read_b32 a48, v60
    ds_read_b32 a49, v61
    ds_read_b32 a50, v62
    ds_read_b32 a51, v63
    ds_read_b128 a[4:7], v41 offset:32768
    ds_read_b128 a[8:11], v40 offset:34816
    ds_read_b128 a[12:15], v41 offset:34816
    ds_read_b128 a[16:19], v40 offset:36864
    ds_read_b128 a[20:23], v41 offset:36864
    ds_read_b128 a[24:27], v40 offset:38912
    ds_read_b128 a[28:31], v41 offset:38912
    ds_read_b128 a[36:39], v40 offset:40960
    ds_read_b128 a[40:43], v41 offset:40960
    ds_read_b128 a[44:47], v40 offset:43008
    ds_read_b128 a[52:55], v41 offset:43008
    ds_read_b128 a[56:59], v40 offset:45056
    ds_read_b128 a[60:63], v41 offset:45056
    ds_read_b128 a[68:71], v40 offset:47104
    ds_read_b128 a[72:75], v41 offset:47104
    ds_read_b32 a64, v8
    ds_read_b32 a65, v9
    ds_read_b32 a66, v10
    ds_read_b32 a67, v11
    s_waitcnt lgkmcnt(15)
    v_mfma_f32_16x16x32_bf16 v[128:131], a[32:35], a[0:3], 0
    ds_read_b32 a76, v12
    v_perm_b32 v13, v69, v35, s37
    v_mfma_f32_16x16x32_bf16 v[128:131], a[48:51], a[4:7], v[128:131]
    ds_read_b128 a[80:83], v42 offset:34816
    v_mfma_f32_16x16x32_bf16 v[132:135], a[32:35], a[8:11], 0
    ds_read_b32 a77, v13
    v_perm_b32 v14, v69, v35, s38
    v_mfma_f32_16x16x32_bf16 v[132:135], a[48:51], a[12:15], v[132:135]
    s_add_u32 s56, s55, 512
    ds_read_b128 a[84:87], v43 offset:34816
    v_mfma_f32_16x16x32_bf16 v[136:139], a[32:35], a[16:19], 0
    s_waitcnt lgkmcnt(15)
    s_add_u32 m0, s57, 0
    ds_read_b32 a78, v14
    v_perm_b32 v15, v69, v35, s39
    v_mfma_f32_16x16x32_bf16 v[136:139], a[48:51], a[20:23], v[136:139]
    buffer_load_dwordx4 v36, s[8:11], s56 offen offset:0 lds
    v_mfma_f32_16x16x32_bf16 v[140:143], a[32:35], a[24:27], 0
    ds_read_b32 a79, v15
    v_perm_b32 v56, v66, v35, s36
    v_mfma_f32_16x16x32_bf16 v[140:143], a[48:51], a[28:31], v[140:143]
    ds_read_b128 a[88:91], v42 offset:32768
    v_mfma_f32_16x16x32_bf16 v[144:147], a[32:35], a[36:39], 0
    s_waitcnt lgkmcnt(7)
    ds_read_b32 a92, v56
    v_perm_b32 v57, v66, v35, s37
    v_mfma_f32_16x16x32_bf16 v[144:147], a[48:51], a[40:43], v[144:147]
    ds_read_b128 a[96:99], v43 offset:32768
    v_mfma_f32_16x16x32_bf16 v[148:151], a[32:35], a[44:47], 0
    ds_read_b32 a93, v57
    v_perm_b32 v58, v66, v35, s38
    v_mfma_f32_16x16x32_bf16 v[148:151], a[48:51], a[52:55], v[148:151]
    buffer_load_dwordx4 v37, s[8:11], s56 offen offset:1024 lds
    v_mfma_f32_16x16x32_bf16 v[152:155], a[32:35], a[56:59], 0
    ds_read_b32 a94, v58
    v_perm_b32 v59, v66, v35, s39
    v_mfma_f32_16x16x32_bf16 v[152:155], a[48:51], a[60:63], v[152:155]
    ds_read_b128 a[100:103], v42 offset:38912
    v_mfma_f32_16x16x32_bf16 v[156:159], a[32:35], a[68:71], 0
    ds_read_b32 a95, v59
    v_perm_b32 v60, v70, v35, s36
    v_mfma_f32_16x16x32_bf16 v[156:159], a[48:51], a[72:75], v[156:159]
    ds_read_b128 a[104:107], v43 offset:38912
    v_mfma_f32_16x16x32_bf16 v[160:163], a[64:67], a[0:3], 0
    s_waitcnt lgkmcnt(7)
    ds_read_b32 a108, v60
    v_perm_b32 v61, v70, v35, s37
    v_mfma_f32_16x16x32_bf16 v[160:163], a[76:79], a[4:7], v[160:163]
    buffer_load_dwordx4 v38, s[8:11], s56 offen offset:2048 lds
    v_mfma_f32_16x16x32_bf16 v[164:167], a[64:67], a[8:11], 0
    ds_read_b32 a109, v61
    v_perm_b32 v62, v70, v35, s38
    v_mfma_f32_16x16x32_bf16 v[164:167], a[76:79], a[12:15], v[164:167]
    ds_read_b128 a[112:115], v42 offset:36864
    v_mfma_f32_16x16x32_bf16 v[168:171], a[64:67], a[16:19], 0
    ds_read_b32 a110, v62
    v_perm_b32 v63, v70, v35, s39
    v_mfma_f32_16x16x32_bf16 v[168:171], a[76:79], a[20:23], v[168:171]
    ds_read_b128 a[116:119], v43 offset:36864
    v_mfma_f32_16x16x32_bf16 v[172:175], a[64:67], a[24:27], 0
    ds_read_b32 a111, v63
    v_perm_b32 v8, v67, v35, s36
    v_mfma_f32_16x16x32_bf16 v[172:175], a[76:79], a[28:31], v[172:175]
    buffer_load_dwordx4 v39, s[8:11], s56 offen offset:3072 lds
    v_mfma_f32_16x16x32_bf16 v[176:179], a[64:67], a[36:39], 0
    ds_read_b32 a120, v8
    v_perm_b32 v9, v67, v35, s37
    v_mfma_f32_16x16x32_bf16 v[176:179], a[76:79], a[40:43], v[176:179]
    ds_read_b128 a[124:127], v42 offset:43008
    v_mfma_f32_16x16x32_bf16 v[180:183], a[64:67], a[44:47], 0
    ds_read_b32 a121, v9
    v_perm_b32 v10, v67, v35, s38
    v_mfma_f32_16x16x32_bf16 v[180:183], a[76:79], a[52:55], v[180:183]
    s_add_u32 s56, s55, 640
    ds_read_b128 a[128:131], v43 offset:43008
    v_mfma_f32_16x16x32_bf16 v[184:187], a[64:67], a[56:59], 0
    s_add_u32 m0, s57, 18432
    ds_read_b32 a122, v10
    v_perm_b32 v11, v67, v35, s39
    v_mfma_f32_16x16x32_bf16 v[184:187], a[76:79], a[60:63], v[184:187]
    buffer_load_dwordx4 v36, s[8:11], s56 offen offset:0 lds
    v_mfma_f32_16x16x32_bf16 v[188:191], a[64:67], a[68:71], 0
    ds_read_b32 a123, v11
    v_perm_b32 v12, v71, v35, s36
    v_mfma_f32_16x16x32_bf16 v[188:191], a[76:79], a[72:75], v[188:191]
    s_waitcnt lgkmcnt(6)
    ds_read_b128 a[132:135], v42 offset:40960
    v_mfma_f32_16x16x32_bf16 v[192:195], a[92:95], a[0:3], 0
    ds_read_b32 a136, v12
    v_perm_b32 v13, v71, v35, s37
    v_mfma_f32_16x16x32_bf16 v[192:195], a[108:111], a[4:7], v[192:195]
    ds_read_b128 a[140:143], v43 offset:40960
    v_mfma_f32_16x16x32_bf16 v[196:199], a[92:95], a[8:11], 0
    ds_read_b32 a137, v13
    v_perm_b32 v14, v71, v35, s38
    v_mfma_f32_16x16x32_bf16 v[196:199], a[108:111], a[12:15], v[196:199]
    buffer_load_dwordx4 v37, s[8:11], s56 offen offset:1024 lds
    v_mfma_f32_16x16x32_bf16 v[200:203], a[92:95], a[16:19], 0
    ds_read_b32 a138, v14
    v_perm_b32 v15, v71, v35, s39
    v_mfma_f32_16x16x32_bf16 v[200:203], a[108:111], a[20:23], v[200:203]
    ds_read_b128 a[144:147], v42 offset:47104
    v_mfma_f32_16x16x32_bf16 v[204:207], a[92:95], a[24:27], 0
    ds_read_b32 a139, v15
    v_perm_b32 v56, v72, v35, s36
    v_mfma_f32_16x16x32_bf16 v[204:207], a[108:111], a[28:31], v[204:207]
    ds_read_b128 a[148:151], v43 offset:47104
    v_mfma_f32_16x16x32_bf16 v[208:211], a[92:95], a[36:39], 0
    s_add_u32 m0, s57, 14336
    ds_read_b32 a152, v56
    v_perm_b32 v57, v72, v35, s37
    v_mfma_f32_16x16x32_bf16 v[208:211], a[108:111], a[40:43], v[208:211]
    buffer_load_dwordx4 v38, s[8:11], s56 offen offset:2048 lds
    v_mfma_f32_16x16x32_bf16 v[212:215], a[92:95], a[44:47], 0
    ds_read_b32 a153, v57
    v_perm_b32 v58, v72, v35, s38
    v_mfma_f32_16x16x32_bf16 v[212:215], a[108:111], a[52:55], v[212:215]
    ds_read_b128 a[156:159], v42 offset:45056
    v_mfma_f32_16x16x32_bf16 v[216:219], a[92:95], a[56:59], 0
    ds_read_b32 a154, v58
    v_perm_b32 v59, v72, v35, s39
    v_mfma_f32_16x16x32_bf16 v[216:219], a[108:111], a[60:63], v[216:219]
    ds_read_b128 a[160:163], v43 offset:45056
    v_mfma_f32_16x16x32_bf16 v[220:223], a[92:95], a[68:71], 0
    ds_read_b32 a155, v59
    v_perm_b32 v60, v76, v35, s36
    v_mfma_f32_16x16x32_bf16 v[220:223], a[108:111], a[72:75], v[220:223]
    s_waitcnt lgkmcnt(7)
    buffer_load_dwordx4 v39, s[8:11], s56 offen offset:3072 lds
    v_mfma_f32_16x16x32_bf16 v[224:227], a[120:123], a[0:3], 0
    s_mov_b32 s46, 1376256
    ds_read_b32 a164, v60
    v_perm_b32 v61, v76, v35, s37
    v_mfma_f32_16x16x32_bf16 v[224:227], a[136:139], a[4:7], v[224:227]
    buffer_load_dwordx3 v[88:90], v32, s[12:15], s46 offen
    v_mfma_f32_16x16x32_bf16 v[228:231], a[120:123], a[8:11], 0
    ds_read_b32 a165, v61
    v_perm_b32 v62, v76, v35, s38
    v_mfma_f32_16x16x32_bf16 v[228:231], a[136:139], a[12:15], v[228:231]
    buffer_load_dword v91, v34, s[12:15], s46 offen
    v_mfma_f32_16x16x32_bf16 v[232:235], a[120:123], a[16:19], 0
    s_mov_b32 s47, 1433600
    ds_read_b32 a166, v62
    v_perm_b32 v63, v76, v35, s39
    v_mfma_f32_16x16x32_bf16 v[232:235], a[136:139], a[20:23], v[232:235]
    buffer_load_dwordx3 v[92:94], v32, s[12:15], s47 offen
    v_mfma_f32_16x16x32_bf16 v[236:239], a[120:123], a[24:27], 0
    ds_read_b32 a167, v63
    v_perm_b32 v8, v73, v35, s36
    v_mfma_f32_16x16x32_bf16 v[236:239], a[136:139], a[28:31], v[236:239]
    buffer_load_dword v95, v34, s[12:15], s47 offen
    v_mfma_f32_16x16x32_bf16 v[240:243], a[120:123], a[36:39], 0
    s_mov_b32 s40, 1605632
    ds_read_b32 a168, v8
    v_perm_b32 v9, v73, v35, s37
    v_mfma_f32_16x16x32_bf16 v[240:243], a[136:139], a[40:43], v[240:243]
    buffer_load_dwordx3 v[96:98], v32, s[12:15], s40 offen
    v_mfma_f32_16x16x32_bf16 v[244:247], a[120:123], a[44:47], 0
    ds_read_b32 a169, v9
    v_perm_b32 v10, v73, v35, s38
    v_mfma_f32_16x16x32_bf16 v[244:247], a[136:139], a[52:55], v[244:247]
    buffer_load_dword v99, v34, s[12:15], s40 offen
    v_mfma_f32_16x16x32_bf16 v[248:251], a[120:123], a[56:59], 0
    s_mov_b32 s41, 229376
    ds_read_b32 a170, v10
    v_perm_b32 v11, v73, v35, s39
    v_mfma_f32_16x16x32_bf16 v[248:251], a[136:139], a[60:63], v[248:251]
    buffer_load_dwordx3 v[100:102], v33, s[12:15], s41 offen
    v_mfma_f32_16x16x32_bf16 v[252:255], a[120:123], a[68:71], 0
    s_mov_b32 s42, 286720
    ds_read_b32 a171, v11
    v_perm_b32 v12, v77, v35, s36
    v_mfma_f32_16x16x32_bf16 v[252:255], a[136:139], a[72:75], v[252:255]
    s_waitcnt vmcnt(15) lgkmcnt(4)
    s_barrier
    buffer_load_dwordx3 v[104:106], v33, s[12:15], s42 offen
    v_mfma_f32_16x16x32_bf16 v[128:131], a[152:155], a[80:83], v[128:131]
    ds_read_b32 a172, v12
    v_perm_b32 v13, v77, v35, s37
    v_mfma_f32_16x16x32_bf16 v[128:131], a[164:167], a[84:87], v[128:131]
    ds_read_b128 a[176:179], v44 offset:0
    v_mfma_f32_16x16x32_bf16 v[132:135], a[152:155], a[88:91], v[132:135]
    ds_read_b32 a173, v13
    v_perm_b32 v14, v77, v35, s38
    v_mfma_f32_16x16x32_bf16 v[132:135], a[164:167], a[96:99], v[132:135]
    s_add_u32 s56, s55, 768
    ds_read_b128 a[180:183], v45 offset:0
    v_mfma_f32_16x16x32_bf16 v[136:139], a[152:155], a[100:103], v[136:139]
    s_add_u32 m0, s57, 32768
    ds_read_b32 a174, v14
    v_perm_b32 v15, v77, v35, s39
    v_mfma_f32_16x16x32_bf16 v[136:139], a[164:167], a[104:107], v[136:139]
    buffer_load_dwordx4 v36, s[8:11], s56 offen offset:0 lds
    v_mfma_f32_16x16x32_bf16 v[140:143], a[152:155], a[112:115], v[140:143]
    ds_read_b32 a175, v15
    v_perm_b32 v56, v74, v35, s36
    v_mfma_f32_16x16x32_bf16 v[140:143], a[164:167], a[116:119], v[140:143]
    ds_read_b128 a[184:187], v44 offset:2048
    v_mfma_f32_16x16x32_bf16 v[144:147], a[152:155], a[124:127], v[144:147]
    ds_read_b32 a188, v56
    v_perm_b32 v57, v74, v35, s37
    v_mfma_f32_16x16x32_bf16 v[144:147], a[164:167], a[128:131], v[144:147]
    ds_read_b128 a[192:195], v45 offset:2048
    v_mfma_f32_16x16x32_bf16 v[148:151], a[152:155], a[132:135], v[148:151]
    ds_read_b32 a189, v57
    v_perm_b32 v58, v74, v35, s38
    v_mfma_f32_16x16x32_bf16 v[148:151], a[164:167], a[140:143], v[148:151]
    buffer_load_dwordx4 v37, s[8:11], s56 offen offset:1024 lds
    v_mfma_f32_16x16x32_bf16 v[152:155], a[152:155], a[144:147], v[152:155]
    ds_read_b32 a190, v58
    v_perm_b32 v59, v74, v35, s39
    v_mfma_f32_16x16x32_bf16 v[152:155], a[164:167], a[148:151], v[152:155]
    ds_read_b128 a[196:199], v44 offset:4096
    v_mfma_f32_16x16x32_bf16 v[156:159], a[152:155], a[156:159], v[156:159]
    ds_read_b32 a191, v59
    v_perm_b32 v60, v78, v35, s36
    v_mfma_f32_16x16x32_bf16 v[156:159], a[164:167], a[160:163], v[156:159]
    s_waitcnt lgkmcnt(7)
    ds_read_b128 a[200:203], v45 offset:4096
    v_mfma_f32_16x16x32_bf16 v[160:163], a[168:171], a[80:83], v[160:163]
    ds_read_b32 a204, v60
    v_perm_b32 v61, v78, v35, s37
    v_mfma_f32_16x16x32_bf16 v[160:163], a[172:175], a[84:87], v[160:163]
    buffer_load_dwordx4 v38, s[8:11], s56 offen offset:2048 lds
    v_mfma_f32_16x16x32_bf16 v[164:167], a[168:171], a[88:91], v[164:167]
    ds_read_b32 a205, v61
    v_perm_b32 v62, v78, v35, s38
    v_mfma_f32_16x16x32_bf16 v[164:167], a[172:175], a[96:99], v[164:167]
    ds_read_b128 a[208:211], v44 offset:6144
    v_mfma_f32_16x16x32_bf16 v[168:171], a[168:171], a[100:103], v[168:171]
    ds_read_b32 a206, v62
    v_perm_b32 v63, v78, v35, s39
    v_mfma_f32_16x16x32_bf16 v[168:171], a[172:175], a[104:107], v[168:171]
    ds_read_b128 a[212:215], v45 offset:6144
    v_mfma_f32_16x16x32_bf16 v[172:175], a[168:171], a[112:115], v[172:175]
    ds_read_b32 a207, v63
    v_perm_b32 v8, v80, v35, s36
    v_mfma_f32_16x16x32_bf16 v[172:175], a[172:175], a[116:119], v[172:175]
    buffer_load_dwordx4 v39, s[8:11], s56 offen offset:3072 lds
    v_mfma_f32_16x16x32_bf16 v[176:179], a[168:171], a[124:127], v[176:179]
    ds_read_b32 a216, v8
    v_perm_b32 v9, v80, v35, s37
    v_mfma_f32_16x16x32_bf16 v[176:179], a[172:175], a[128:131], v[176:179]
    ds_read_b128 a[220:223], v44 offset:8192
    v_mfma_f32_16x16x32_bf16 v[180:183], a[168:171], a[132:135], v[180:183]
    ds_read_b32 a217, v9
    v_perm_b32 v10, v80, v35, s38
    v_mfma_f32_16x16x32_bf16 v[180:183], a[172:175], a[140:143], v[180:183]
    s_add_u32 s56, s55, 896
    ds_read_b128 a[224:227], v45 offset:8192
    v_mfma_f32_16x16x32_bf16 v[184:187], a[168:171], a[144:147], v[184:187]
    s_add_u32 m0, s57, 51200
    ds_read_b32 a218, v10
    v_perm_b32 v11, v80, v35, s39
    v_mfma_f32_16x16x32_bf16 v[184:187], a[172:175], a[148:151], v[184:187]
    buffer_load_dwordx4 v36, s[8:11], s56 offen offset:0 lds
    v_mfma_f32_16x16x32_bf16 v[188:191], a[168:171], a[156:159], v[188:191]
    ds_read_b32 a219, v11
    v_perm_b32 v12, v84, v35, s36
    v_mfma_f32_16x16x32_bf16 v[188:191], a[172:175], a[160:163], v[188:191]
    s_waitcnt lgkmcnt(6)
    ds_read_b128 a[228:231], v44 offset:10240
    v_mfma_f32_16x16x32_bf16 v[192:195], a[188:191], a[80:83], v[192:195]
    ds_read_b32 a232, v12
    v_perm_b32 v13, v84, v35, s37
    v_mfma_f32_16x16x32_bf16 v[192:195], a[204:207], a[84:87], v[192:195]
    ds_read_b128 a[236:239], v45 offset:10240
    v_mfma_f32_16x16x32_bf16 v[196:199], a[188:191], a[88:91], v[196:199]
    ds_read_b32 a233, v13
    v_perm_b32 v14, v84, v35, s38
    v_mfma_f32_16x16x32_bf16 v[196:199], a[204:207], a[96:99], v[196:199]
    s_waitcnt vmcnt(11)
    buffer_load_dwordx4 v37, s[8:11], s56 offen offset:1024 lds
    v_perm_b32 v15, v91, v35, s36
    v_mfma_f32_16x16x32_bf16 v[200:203], a[188:191], a[100:103], v[200:203]
    ds_read_b32 a234, v14
    v_perm_b32 v56, v84, v35, s39
    v_mfma_f32_16x16x32_bf16 v[200:203], a[204:207], a[104:107], v[200:203]
    ds_read_b128 a[240:243], v44 offset:12288
    ds_read_b32 a244, v15
    v_mfma_f32_16x16x32_bf16 v[204:207], a[188:191], a[112:115], v[204:207]
    ds_read_b32 a235, v56
    v_perm_b32 v57, v81, v35, s36
    v_mfma_f32_16x16x32_bf16 v[204:207], a[204:207], a[116:119], v[204:207]
    ds_read_b128 a[248:251], v45 offset:12288
    v_mfma_f32_16x16x32_bf16 v[208:211], a[188:191], a[124:127], v[208:211]
    s_add_u32 m0, s57, 47104
    ds_read_b32 a252, v57
    v_perm_b32 v58, v81, v35, s37
    v_mfma_f32_16x16x32_bf16 v[208:211], a[204:207], a[128:131], v[208:211]
    buffer_load_dwordx4 v38, s[8:11], s56 offen offset:2048 lds
    v_perm_b32 v59, v91, v35, s37
    v_mfma_f32_16x16x32_bf16 v[212:215], a[188:191], a[132:135], v[212:215]
    ds_read_b32 a253, v58
    v_perm_b32 v60, v81, v35, s38
    v_mfma_f32_16x16x32_bf16 v[212:215], a[204:207], a[140:143], v[212:215]
    ds_read_b128 a[32:35], v44 offset:14336
    ds_read_b32 a245, v59
    v_mfma_f32_16x16x32_bf16 v[216:219], a[188:191], a[144:147], v[216:219]
    ds_read_b32 a254, v60
    v_perm_b32 v61, v81, v35, s39
    v_mfma_f32_16x16x32_bf16 v[216:219], a[204:207], a[148:151], v[216:219]
    ds_read_b128 a[48:51], v45 offset:14336
    v_mfma_f32_16x16x32_bf16 v[220:223], a[188:191], a[156:159], v[220:223]
    ds_read_b32 a255, v61
    v_perm_b32 v62, v85, v35, s36
    v_mfma_f32_16x16x32_bf16 v[220:223], a[204:207], a[160:163], v[220:223]
    s_waitcnt lgkmcnt(8)
    buffer_load_dwordx4 v39, s[8:11], s56 offen offset:3072 lds
    v_perm_b32 v63, v91, v35, s38
    v_mfma_f32_16x16x32_bf16 v[128:131], a[216:219], a[176:179], v[128:131]
    ds_read_b32 a64, v62
    v_perm_b32 v8, v85, v35, s37
    v_mfma_f32_16x16x32_bf16 v[128:131], a[232:235], a[180:183], v[128:131]
    ds_read_b128 a[76:79], v46 offset:2048
    ds_read_b32 a246, v63
    v_mfma_f32_16x16x32_bf16 v[132:135], a[216:219], a[184:187], v[132:135]
    ds_read_b32 a65, v8
    v_perm_b32 v9, v85, v35, s38
    v_mfma_f32_16x16x32_bf16 v[132:135], a[232:235], a[192:195], v[132:135]
    ds_read_b128 a[92:95], v47 offset:2048
    v_mfma_f32_16x16x32_bf16 v[136:139], a[216:219], a[196:199], v[136:139]
    s_mov_b32 s43, 1662976
    ds_read_b32 a66, v9
    v_perm_b32 v10, v85, v35, s39
    v_mfma_f32_16x16x32_bf16 v[136:139], a[232:235], a[200:203], v[136:139]
    buffer_load_dwordx3 v[108:110], v32, s[12:15], s43 offen
    v_perm_b32 v11, v91, v35, s39
    v_mfma_f32_16x16x32_bf16 v[140:143], a[216:219], a[208:211], v[140:143]
    ds_read_b32 a67, v10
    v_perm_b32 v12, v82, v35, s36
    v_mfma_f32_16x16x32_bf16 v[140:143], a[232:235], a[212:215], v[140:143]
    ds_read_b128 a[108:111], v46 offset:0
    ds_read_b32 a247, v11
    v_mfma_f32_16x16x32_bf16 v[144:147], a[216:219], a[220:223], v[144:147]
    ds_read_b32 a0, v12
    v_perm_b32 v13, v82, v35, s37
    v_mfma_f32_16x16x32_bf16 v[144:147], a[232:235], a[224:227], v[144:147]
    ds_read_b128 a[4:7], v47 offset:0
    v_mfma_f32_16x16x32_bf16 v[148:151], a[216:219], a[228:231], v[148:151]
    ds_read_b32 a1, v13
    v_perm_b32 v14, v82, v35, s38
    v_mfma_f32_16x16x32_bf16 v[148:151], a[232:235], a[236:239], v[148:151]
    s_waitcnt vmcnt(13)
    buffer_load_dword v111, v34, s[12:15], s43 offen
    v_perm_b32 v15, v95, v35, s36
    v_mfma_f32_16x16x32_bf16 v[152:155], a[216:219], a[240:243], v[152:155]
    s_waitcnt lgkmcnt(7)
    ds_read_b32 a2, v14
    v_perm_b32 v56, v82, v35, s39
    v_mfma_f32_16x16x32_bf16 v[152:155], a[232:235], a[248:251], v[152:155]
    ds_read_b128 a[8:11], v46 offset:6144
    ds_read_b32 a12, v15
    v_mfma_f32_16x16x32_bf16 v[156:159], a[216:219], a[32:35], v[156:159]
    ds_read_b32 a3, v56
    v_perm_b32 v57, v86, v35, s36
    v_mfma_f32_16x16x32_bf16 v[156:159], a[232:235], a[48:51], v[156:159]
    s_waitcnt lgkmcnt(9)
    ds_read_b128 a[16:19], v47 offset:6144
    v_mfma_f32_16x16x32_bf16 v[160:163], a[252:255], a[176:179], v[160:163]
    s_mov_b32 s44, 458752
    ds_read_b32 a20, v57
    v_perm_b32 v58, v86, v35, s37
    v_mfma_f32_16x16x32_bf16 v[160:163], a[64:67], a[180:183], v[160:163]
    buffer_load_dwordx3 v[112:114], v32, s[12:15], s44 offen
    v_perm_b32 v59, v95, v35, s37
    v_mfma_f32_16x16x32_bf16 v[164:167], a[252:255], a[184:187], v[164:167]
    ds_read_b32 a21, v58
    v_perm_b32 v60, v86, v35, s38
    v_mfma_f32_16x16x32_bf16 v[164:167], a[64:67], a[192:195], v[164:167]
    ds_read_b128 a[24:27], v46 offset:4096
    ds_read_b32 a13, v59
    v_mfma_f32_16x16x32_bf16 v[168:171], a[252:255], a[196:199], v[168:171]
    ds_read_b32 a22, v60
    v_perm_b32 v61, v86, v35, s39
    v_mfma_f32_16x16x32_bf16 v[168:171], a[64:67], a[200:203], v[168:171]
    ds_read_b128 a[28:31], v47 offset:4096
    v_mfma_f32_16x16x32_bf16 v[172:175], a[252:255], a[208:211], v[172:175]
    ds_read_b32 a23, v61
    v_perm_b32 v62, v83, v35, s36
    v_mfma_f32_16x16x32_bf16 v[172:175], a[64:67], a[212:215], v[172:175]
    buffer_load_dword v115, v34, s[12:15], s44 offen
    v_mfma_f32_16x16x32_bf16 v[176:179], a[252:255], a[220:223], v[176:179]
    ds_read_b32 a36, v62
    v_perm_b32 v63, v83, v35, s37
    v_mfma_f32_16x16x32_bf16 v[176:179], a[64:67], a[224:227], v[176:179]
    ds_read_b128 a[40:43], v46 offset:10240
    v_perm_b32 v8, v95, v35, s38
    v_mfma_f32_16x16x32_bf16 v[180:183], a[252:255], a[228:231], v[180:183]
    ds_read_b32 a37, v63
    v_perm_b32 v9, v83, v35, s38
    v_mfma_f32_16x16x32_bf16 v[180:183], a[64:67], a[236:239], v[180:183]
    ds_read_b128 a[44:47], v47 offset:10240
    ds_read_b32 a14, v8
    v_mfma_f32_16x16x32_bf16 v[184:187], a[252:255], a[240:243], v[184:187]
    s_mov_b32 s45, 516096
    ds_read_b32 a38, v9
    v_perm_b32 v10, v83, v35, s39
    v_mfma_f32_16x16x32_bf16 v[184:187], a[64:67], a[248:251], v[184:187]
    buffer_load_dwordx3 v[116:118], v32, s[12:15], s45 offen
    v_mfma_f32_16x16x32_bf16 v[188:191], a[252:255], a[32:35], v[188:191]
    ds_read_b32 a39, v10
    v_perm_b32 v11, v87, v35, s36
    v_mfma_f32_16x16x32_bf16 v[188:191], a[64:67], a[48:51], v[188:191]
    s_waitcnt lgkmcnt(7)
    ds_read_b128 a[52:55], v46 offset:8192
    v_perm_b32 v12, v95, v35, s39
    v_mfma_f32_16x16x32_bf16 v[192:195], a[0:3], a[176:179], v[192:195]
    ds_read_b32 a56, v11
    v_perm_b32 v13, v87, v35, s37
    v_mfma_f32_16x16x32_bf16 v[192:195], a[20:23], a[180:183], v[192:195]
    ds_read_b128 a[60:63], v47 offset:8192
    ds_read_b32 a15, v12
    v_mfma_f32_16x16x32_bf16 v[196:199], a[0:3], a[184:187], v[196:199]
    ds_read_b32 a57, v13
    v_perm_b32 v14, v87, v35, s38
    v_mfma_f32_16x16x32_bf16 v[196:199], a[20:23], a[192:195], v[196:199]
    buffer_load_dword v119, v34, s[12:15], s45 offen
    v_mfma_f32_16x16x32_bf16 v[200:203], a[0:3], a[196:199], v[200:203]
    ds_read_b32 a58, v14
    v_perm_b32 v15, v87, v35, s39
    v_mfma_f32_16x16x32_bf16 v[200:203], a[20:23], a[200:203], v[200:203]
    s_waitcnt vmcnt(16)
    ds_read_b128 a[68:71], v46 offset:14336
    v_perm_b32 v56, v99, v35, s36
    v_mfma_f32_16x16x32_bf16 v[204:207], a[0:3], a[208:211], v[204:207]
    s_waitcnt vmcnt(15)
    ds_read_b32 a59, v15
    v_perm_b32 v57, v100, v35, s36
    v_mfma_f32_16x16x32_bf16 v[204:207], a[20:23], a[212:215], v[204:207]
    ds_read_b128 a[120:123], v47 offset:14336
    ds_read_b32 a72, v56
    v_mfma_f32_16x16x32_bf16 v[208:211], a[0:3], a[220:223], v[208:211]
    s_mov_b32 s46, 1376256
    ds_read_b32 a136, v57
    v_perm_b32 v58, v100, v35, s37
    v_mfma_f32_16x16x32_bf16 v[208:211], a[20:23], a[224:227], v[208:211]
    buffer_load_dwordx3 v[120:122], v33, s[12:15], s46 offen
    v_mfma_f32_16x16x32_bf16 v[212:215], a[0:3], a[228:231], v[212:215]
    ds_read_b32 a137, v58
    v_perm_b32 v59, v100, v35, s38
    v_mfma_f32_16x16x32_bf16 v[212:215], a[20:23], a[236:239], v[212:215]
    ds_read_b128 a[152:155], v46 offset:12288
    v_perm_b32 v60, v99, v35, s37
    v_mfma_f32_16x16x32_bf16 v[216:219], a[0:3], a[240:243], v[216:219]
    ds_read_b32 a138, v59
    v_perm_b32 v61, v100, v35, s39
    v_mfma_f32_16x16x32_bf16 v[216:219], a[20:23], a[248:251], v[216:219]
    s_waitcnt vmcnt(15)
    ds_read_b128 a[164:167], v47 offset:12288
    ds_read_b32 a73, v60
    v_mfma_f32_16x16x32_bf16 v[220:223], a[0:3], a[32:35], v[220:223]
    s_mov_b32 s47, 458752
    ds_read_b32 a139, v61
    v_perm_b32 v62, v104, v35, s36
    v_mfma_f32_16x16x32_bf16 v[220:223], a[20:23], a[48:51], v[220:223]
    s_waitcnt lgkmcnt(9)
    buffer_load_dwordx3 v[124:126], v33, s[12:15], s47 offen
    v_mfma_f32_16x16x32_bf16 v[224:227], a[36:39], a[176:179], v[224:227]
    s_mov_b32 s40, 516096
    ds_read_b32 a168, v62
    v_perm_b32 v63, v104, v35, s37
    v_mfma_f32_16x16x32_bf16 v[224:227], a[56:59], a[180:183], v[224:227]
    buffer_load_dwordx3 v[64:66], v33, s[12:15], s40 offen
    v_perm_b32 v8, v99, v35, s38
    v_mfma_f32_16x16x32_bf16 v[228:231], a[36:39], a[184:187], v[228:231]
    ds_read_b32 a169, v63
    v_perm_b32 v9, v104, v35, s38
    v_mfma_f32_16x16x32_bf16 v[228:231], a[56:59], a[192:195], v[228:231]
    ds_read_b32 a74, v8
    v_mfma_f32_16x16x32_bf16 v[232:235], a[36:39], a[196:199], v[232:235]
    s_mov_b32 s41, 1433600
    ds_read_b32 a170, v9
    v_perm_b32 v10, v104, v35, s39
    v_mfma_f32_16x16x32_bf16 v[232:235], a[56:59], a[200:203], v[232:235]
    buffer_load_dwordx3 v[68:70], v33, s[12:15], s41 offen
    v_mfma_f32_16x16x32_bf16 v[236:239], a[36:39], a[208:211], v[236:239]
    s_mov_b32 s42, 688128
    ds_read_b32 a171, v10
    v_perm_b32 v11, v101, v35, s36
    v_mfma_f32_16x16x32_bf16 v[236:239], a[56:59], a[212:215], v[236:239]
    buffer_load_dwordx3 v[72:74], v32, s[12:15], s42 offen
    v_mfma_f32_16x16x32_bf16 v[240:243], a[36:39], a[220:223], v[240:243]
    ds_read_b32 a172, v11
    v_perm_b32 v12, v101, v35, s37
    v_mfma_f32_16x16x32_bf16 v[240:243], a[56:59], a[224:227], v[240:243]
    buffer_load_dword v75, v34, s[12:15], s42 offen
    v_perm_b32 v13, v99, v35, s39
    v_mfma_f32_16x16x32_bf16 v[244:247], a[36:39], a[228:231], v[244:247]
    ds_read_b32 a173, v12
    v_perm_b32 v14, v101, v35, s38
    v_mfma_f32_16x16x32_bf16 v[244:247], a[56:59], a[236:239], v[244:247]
    ds_read_b32 a75, v13
    v_mfma_f32_16x16x32_bf16 v[248:251], a[36:39], a[240:243], v[248:251]
    s_mov_b32 s43, 745472
    ds_read_b32 a174, v14
    v_perm_b32 v15, v101, v35, s39
    v_mfma_f32_16x16x32_bf16 v[248:251], a[56:59], a[248:251], v[248:251]
    buffer_load_dwordx3 v[76:78], v32, s[12:15], s43 offen
    v_mfma_f32_16x16x32_bf16 v[252:255], a[36:39], a[32:35], v[252:255]
    s_waitcnt vmcnt(11) lgkmcnt(5)
    ds_read_b32 a175, v15
    v_perm_b32 v56, v105, v35, s36
    v_mfma_f32_16x16x32_bf16 v[252:255], a[56:59], a[48:51], v[252:255]
    s_barrier
    buffer_load_dword v79, v34, s[12:15], s43 offen
    v_perm_b32 v57, v111, v35, s36
    v_mfma_f32_16x16x32_bf16 v[128:131], a[136:139], a[76:79], v[128:131]
    s_waitcnt lgkmcnt(5)
    ds_read_b32 a80, v56
    v_perm_b32 v58, v105, v35, s37
    v_mfma_f32_16x16x32_bf16 v[128:131], a[168:171], a[92:95], v[128:131]
    ds_read_b128 a[84:87], v40 offset:0
    ds_read_b32 a88, v57
    v_mfma_f32_16x16x32_bf16 v[132:135], a[136:139], a[108:111], v[132:135]
    ds_read_b32 a81, v58
    v_perm_b32 v59, v105, v35, s38
    v_mfma_f32_16x16x32_bf16 v[132:135], a[168:171], a[4:7], v[132:135]
    s_add_u32 s56, s55, 1024
    ds_read_b128 a[96:99], v41 offset:0
    v_mfma_f32_16x16x32_bf16 v[136:139], a[136:139], a[8:11], v[136:139]
    s_add_u32 m0, s57, 65536
    ds_read_b32 a82, v59
    v_perm_b32 v60, v105, v35, s39
    v_mfma_f32_16x16x32_bf16 v[136:139], a[168:171], a[16:19], v[136:139]
    buffer_load_dwordx4 v36, s[8:11], s56 offen offset:0 lds
    v_perm_b32 v61, v111, v35, s37
    v_mfma_f32_16x16x32_bf16 v[140:143], a[136:139], a[24:27], v[140:143]
    ds_read_b32 a83, v60
    v_perm_b32 v62, v102, v35, s36
    v_mfma_f32_16x16x32_bf16 v[140:143], a[168:171], a[28:31], v[140:143]
    ds_read_b128 a[100:103], v40 offset:2048
    ds_read_b32 a89, v61
    v_mfma_f32_16x16x32_bf16 v[144:147], a[136:139], a[40:43], v[144:147]
    ds_read_b32 a104, v62
    v_perm_b32 v63, v102, v35, s37
    v_mfma_f32_16x16x32_bf16 v[144:147], a[168:171], a[44:47], v[144:147]
    ds_read_b128 a[112:115], v41 offset:2048
    v_mfma_f32_16x16x32_bf16 v[148:151], a[136:139], a[52:55], v[148:151]
    ds_read_b32 a105, v63
    v_perm_b32 v8, v102, v35, s38
    v_mfma_f32_16x16x32_bf16 v[148:151], a[168:171], a[60:63], v[148:151]
    buffer_load_dwordx4 v37, s[8:11], s56 offen offset:1024 lds
    v_perm_b32 v9, v111, v35, s38
    v_mfma_f32_16x16x32_bf16 v[152:155], a[136:139], a[68:71], v[152:155]
    ds_read_b32 a106, v8
    v_perm_b32 v10, v102, v35, s39
    v_mfma_f32_16x16x32_bf16 v[152:155], a[168:171], a[120:123], v[152:155]
    ds_read_b128 a[116:119], v40 offset:4096
    ds_read_b32 a90, v9
    v_mfma_f32_16x16x32_bf16 v[156:159], a[136:139], a[152:155], v[156:159]
    ds_read_b32 a107, v10
    v_perm_b32 v11, v106, v35, s36
    v_mfma_f32_16x16x32_bf16 v[156:159], a[168:171], a[164:167], v[156:159]
    s_waitcnt lgkmcnt(9)
    ds_read_b128 a[124:127], v41 offset:4096
    v_mfma_f32_16x16x32_bf16 v[160:163], a[172:175], a[76:79], v[160:163]
    ds_read_b32 a128, v11
    v_perm_b32 v12, v106, v35, s37
    v_mfma_f32_16x16x32_bf16 v[160:163], a[80:83], a[92:95], v[160:163]
    buffer_load_dwordx4 v38, s[8:11], s56 offen offset:2048 lds
    v_perm_b32 v13, v111, v35, s39
    v_mfma_f32_16x16x32_bf16 v[164:167], a[172:175], a[108:111], v[164:167]
    ds_read_b32 a129, v12
    v_perm_b32 v14, v106, v35, s38
    v_mfma_f32_16x16x32_bf16 v[164:167], a[80:83], a[4:7], v[164:167]
    ds_read_b128 a[132:135], v40 offset:6144
    ds_read_b32 a91, v13
    v_mfma_f32_16x16x32_bf16 v[168:171], a[172:175], a[8:11], v[168:171]
    ds_read_b32 a130, v14
    v_perm_b32 v15, v106, v35, s39
    v_mfma_f32_16x16x32_bf16 v[168:171], a[80:83], a[16:19], v[168:171]
    ds_read_b128 a[140:143], v41 offset:6144
    v_mfma_f32_16x16x32_bf16 v[172:175], a[172:175], a[24:27], v[172:175]
    s_waitcnt vmcnt(14)
    ds_read_b32 a131, v15
    v_perm_b32 v56, v112, v35, s36
    v_mfma_f32_16x16x32_bf16 v[172:175], a[80:83], a[28:31], v[172:175]
    buffer_load_dwordx4 v39, s[8:11], s56 offen offset:3072 lds
    v_perm_b32 v57, v88, v35, s36
    v_mfma_f32_16x16x32_bf16 v[176:179], a[172:175], a[40:43], v[176:179]
    ds_read_b32 a144, v56
    v_perm_b32 v58, v112, v35, s37
    v_mfma_f32_16x16x32_bf16 v[176:179], a[80:83], a[44:47], v[176:179]
    ds_read_b128 a[148:151], v40 offset:8192
    ds_read_b32 a156, v57
    v_mfma_f32_16x16x32_bf16 v[180:183], a[172:175], a[52:55], v[180:183]
    ds_read_b32 a145, v58
    v_perm_b32 v59, v112, v35, s38
    v_mfma_f32_16x16x32_bf16 v[180:183], a[80:83], a[60:63], v[180:183]
    s_add_u32 s56, s55, 1152
    ds_read_b128 a[188:191], v41 offset:8192
    v_mfma_f32_16x16x32_bf16 v[184:187], a[172:175], a[68:71], v[184:187]
    s_add_u32 m0, s57, 83968
    ds_read_b32 a146, v59
    v_perm_b32 v60, v112, v35, s39
    v_mfma_f32_16x16x32_bf16 v[184:187], a[80:83], a[120:123], v[184:187]
    buffer_load_dwordx4 v36, s[8:11], s56 offen offset:0 lds
    v_mfma_f32_16x16x32_bf16 v[188:191], a[172:175], a[152:155], v[188:191]
    s_waitcnt vmcnt(14)
    ds_read_b32 a147, v60
    v_perm_b32 v61, v116, v35, s36
    v_mfma_f32_16x16x32_bf16 v[188:191], a[80:83], a[164:167], v[188:191]
    s_waitcnt lgkmcnt(7)
    ds_read_b128 a[160:163], v40 offset:10240
    v_perm_b32 v62, v88, v35, s37
    v_mfma_f32_16x16x32_bf16 v[192:195], a[104:107], a[76:79], v[192:195]
    ds_read_b32 a204, v61
    v_perm_b32 v63, v116, v35, s37
    v_mfma_f32_16x16x32_bf16 v[192:195], a[128:131], a[92:95], v[192:195]
    ds_read_b128 a[216:219], v41 offset:10240
    ds_read_b32 a157, v62
    v_mfma_f32_16x16x32_bf16 v[196:199], a[104:107], a[108:111], v[196:199]
    ds_read_b32 a205, v63
    v_perm_b32 v8, v116, v35, s38
    v_mfma_f32_16x16x32_bf16 v[196:199], a[128:131], a[4:7], v[196:199]
    buffer_load_dwordx4 v37, s[8:11], s56 offen offset:1024 lds
    v_mfma_f32_16x16x32_bf16 v[200:203], a[104:107], a[8:11], v[200:203]
    ds_read_b32 a206, v8
    v_perm_b32 v9, v116, v35, s39
    v_mfma_f32_16x16x32_bf16 v[200:203], a[128:131], a[16:19], v[200:203]
    ds_read_b128 a[232:235], v40 offset:12288
    v_perm_b32 v10, v88, v35, s38
    v_mfma_f32_16x16x32_bf16 v[204:207], a[104:107], a[24:27], v[204:207]
    ds_read_b32 a207, v9
    v_perm_b32 v11, v113, v35, s36
    v_mfma_f32_16x16x32_bf16 v[204:207], a[128:131], a[28:31], v[204:207]
    ds_read_b128 a[252:255], v41 offset:12288
    ds_read_b32 a158, v10
    v_mfma_f32_16x16x32_bf16 v[208:211], a[104:107], a[40:43], v[208:211]
    s_add_u32 m0, s57, 79872
    ds_read_b32 a64, v11
    v_perm_b32 v12, v113, v35, s37
    v_mfma_f32_16x16x32_bf16 v[208:211], a[128:131], a[44:47], v[208:211]
    buffer_load_dwordx4 v38, s[8:11], s56 offen offset:2048 lds
    v_mfma_f32_16x16x32_bf16 v[212:215], a[104:107], a[52:55], v[212:215]
    ds_read_b32 a65, v12
    v_perm_b32 v13, v113, v35, s38
    v_mfma_f32_16x16x32_bf16 v[212:215], a[128:131], a[60:63], v[212:215]
    ds_read_b128 a[0:3], v40 offset:14336
    v_perm_b32 v14, v88, v35, s39
    v_mfma_f32_16x16x32_bf16 v[216:219], a[104:107], a[68:71], v[216:219]
    ds_read_b32 a66, v13
    v_perm_b32 v15, v113, v35, s39
    v_mfma_f32_16x16x32_bf16 v[216:219], a[128:131], a[120:123], v[216:219]
    ds_read_b128 a[20:23], v41 offset:14336
    ds_read_b32 a159, v14
    v_mfma_f32_16x16x32_bf16 v[220:223], a[104:107], a[152:155], v[220:223]
    ds_read_b32 a67, v15
    v_perm_b32 v56, v117, v35, s36
    v_mfma_f32_16x16x32_bf16 v[220:223], a[128:131], a[164:167], v[220:223]
    s_waitcnt lgkmcnt(9)
    buffer_load_dwordx4 v39, s[8:11], s56 offen offset:3072 lds
    v_mfma_f32_16x16x32_bf16 v[128:131], a[144:147], a[84:87], v[128:131]
    ds_read_b32 a176, v56
    v_perm_b32 v57, v117, v35, s37
    v_mfma_f32_16x16x32_bf16 v[128:131], a[204:207], a[96:99], v[128:131]
    ds_read_b128 a[180:183], v42 offset:2048
    v_perm_b32 v58, v92, v35, s36
    v_mfma_f32_16x16x32_bf16 v[132:135], a[144:147], a[100:103], v[132:135]
    ds_read_b32 a177, v57
    v_perm_b32 v59, v117, v35, s38
    v_mfma_f32_16x16x32_bf16 v[132:135], a[204:207], a[112:115], v[132:135]
    ds_read_b128 a[184:187], v43 offset:2048
    ds_read_b32 a192, v58
    v_mfma_f32_16x16x32_bf16 v[136:139], a[144:147], a[116:119], v[136:139]
    s_mov_b32 s44, 1605632
    ds_read_b32 a178, v59
    v_perm_b32 v60, v117, v35, s39
    v_mfma_f32_16x16x32_bf16 v[136:139], a[204:207], a[124:127], v[136:139]
    buffer_load_dwordx3 v[80:82], v33, s[12:15], s44 offen
    v_mfma_f32_16x16x32_bf16 v[140:143], a[144:147], a[132:135], v[140:143]
    ds_read_b32 a179, v60
    v_perm_b32 v61, v114, v35, s36
    v_mfma_f32_16x16x32_bf16 v[140:143], a[204:207], a[140:143], v[140:143]
    ds_read_b128 a[196:199], v42 offset:0
    v_perm_b32 v62, v92, v35, s37
    v_mfma_f32_16x16x32_bf16 v[144:147], a[144:147], a[148:151], v[144:147]
    ds_read_b32 a200, v61
    v_perm_b32 v63, v114, v35, s37
    v_mfma_f32_16x16x32_bf16 v[144:147], a[204:207], a[188:191], v[144:147]
    ds_read_b128 a[208:211], v43 offset:0
    ds_read_b32 a193, v62
    v_mfma_f32_16x16x32_bf16 v[148:151], a[144:147], a[160:163], v[148:151]
    s_mov_b32 s45, 688128
    ds_read_b32 a201, v63
    v_perm_b32 v8, v114, v35, s38
    v_mfma_f32_16x16x32_bf16 v[148:151], a[204:207], a[216:219], v[148:151]
    buffer_load_dwordx3 v[84:86], v33, s[12:15], s45 offen
    v_mfma_f32_16x16x32_bf16 v[152:155], a[144:147], a[232:235], v[152:155]
    s_waitcnt lgkmcnt(7)
    ds_read_b32 a202, v8
    v_perm_b32 v9, v114, v35, s39
    v_mfma_f32_16x16x32_bf16 v[152:155], a[204:207], a[252:255], v[152:155]
    ds_read_b128 a[212:215], v42 offset:6144
    v_mfma_f32_16x16x32_bf16 v[156:159], a[144:147], a[0:3], v[156:159]
    ds_read_b32 a203, v9
    v_perm_b32 v10, v118, v35, s36
    v_mfma_f32_16x16x32_bf16 v[156:159], a[204:207], a[20:23], v[156:159]
    ds_read_b128 a[220:223], v43 offset:6144
    v_perm_b32 v11, v92, v35, s38
    v_mfma_f32_16x16x32_bf16 v[160:163], a[64:67], a[84:87], v[160:163]
    s_waitcnt lgkmcnt(8)
    ds_read_b32 a224, v10
    v_perm_b32 v12, v118, v35, s37
    v_mfma_f32_16x16x32_bf16 v[160:163], a[176:179], a[96:99], v[160:163]
    ds_read_b32 a194, v11
    v_mfma_f32_16x16x32_bf16 v[164:167], a[64:67], a[100:103], v[164:167]
    ds_read_b32 a225, v12
    v_perm_b32 v13, v118, v35, s38
    v_mfma_f32_16x16x32_bf16 v[164:167], a[176:179], a[112:115], v[164:167]
    ds_read_b128 a[228:231], v42 offset:4096
    v_mfma_f32_16x16x32_bf16 v[168:171], a[64:67], a[116:119], v[168:171]
    ds_read_b32 a226, v13
    v_perm_b32 v14, v118, v35, s39
    v_mfma_f32_16x16x32_bf16 v[168:171], a[176:179], a[124:127], v[168:171]
    ds_read_b128 a[236:239], v43 offset:4096
    v_perm_b32 v15, v92, v35, s39
    v_mfma_f32_16x16x32_bf16 v[172:175], a[64:67], a[132:135], v[172:175]
    ds_read_b32 a227, v14
    v_perm_b32 v56, v115, v35, s36
    v_mfma_f32_16x16x32_bf16 v[172:175], a[176:179], a[140:143], v[172:175]
    ds_read_b32 a195, v15
    v_mfma_f32_16x16x32_bf16 v[176:179], a[64:67], a[148:151], v[176:179]
    ds_read_b32 a240, v56
    v_perm_b32 v57, v115, v35, s37
    v_mfma_f32_16x16x32_bf16 v[176:179], a[176:179], a[188:191], v[176:179]
    ds_read_b128 a[248:251], v42 offset:10240
    v_mfma_f32_16x16x32_bf16 v[180:183], a[64:67], a[160:163], v[180:183]
    ds_read_b32 a241, v57
    v_perm_b32 v58, v115, v35, s38
    v_mfma_f32_16x16x32_bf16 v[180:183], a[176:179], a[216:219], v[180:183]
    s_waitcnt vmcnt(17)
    ds_read_b128 a[32:35], v43 offset:10240
    v_perm_b32 v59, v120, v35, s36
    v_mfma_f32_16x16x32_bf16 v[184:187], a[64:67], a[232:235], v[184:187]
    ds_read_b32 a242, v58
    v_perm_b32 v60, v115, v35, s39
    v_mfma_f32_16x16x32_bf16 v[184:187], a[176:179], a[252:255], v[184:187]
    ds_read_b32 a36, v59
    v_mfma_f32_16x16x32_bf16 v[188:191], a[64:67], a[0:3], v[188:191]
    ds_read_b32 a243, v60
    v_perm_b32 v61, v119, v35, s36
    v_mfma_f32_16x16x32_bf16 v[188:191], a[176:179], a[20:23], v[188:191]
    s_waitcnt lgkmcnt(8)
    ds_read_b128 a[48:51], v42 offset:8192
    v_mfma_f32_16x16x32_bf16 v[192:195], a[200:203], a[84:87], v[192:195]
    ds_read_b32 a56, v61
    v_perm_b32 v62, v119, v35, s37
    v_mfma_f32_16x16x32_bf16 v[192:195], a[224:227], a[96:99], v[192:195]
    ds_read_b128 a[136:139], v43 offset:8192
    v_perm_b32 v63, v120, v35, s37
    v_mfma_f32_16x16x32_bf16 v[196:199], a[200:203], a[100:103], v[196:199]
    ds_read_b32 a57, v62
    v_perm_b32 v8, v119, v35, s38
    v_mfma_f32_16x16x32_bf16 v[196:199], a[224:227], a[112:115], v[196:199]
    ds_read_b32 a37, v63
    v_mfma_f32_16x16x32_bf16 v[200:203], a[200:203], a[116:119], v[200:203]
    ds_read_b32 a58, v8
    v_perm_b32 v9, v119, v35, s39
    v_mfma_f32_16x16x32_bf16 v[200:203], a[224:227], a[124:127], v[200:203]
    ds_read_b128 a[168:171], v42 offset:14336
    v_mfma_f32_16x16x32_bf16 v[204:207], a[200:203], a[132:135], v[204:207]
    s_waitcnt vmcnt(16)
    ds_read_b32 a59, v9
    v_perm_b32 v10, v124, v35, s36
    v_mfma_f32_16x16x32_bf16 v[204:207], a[224:227], a[140:143], v[204:207]
    ds_read_b128 a[172:175], v43 offset:14336
    v_perm_b32 v11, v120, v35, s38
    v_mfma_f32_16x16x32_bf16 v[208:211], a[200:203], a[148:151], v[208:211]
    ds_read_b32 a80, v10
    v_perm_b32 v12, v124, v35, s37
    v_mfma_f32_16x16x32_bf16 v[208:211], a[224:227], a[188:191], v[208:211]
    ds_read_b32 a38, v11
    v_mfma_f32_16x16x32_bf16 v[212:215], a[200:203], a[160:163], v[212:215]
    ds_read_b32 a81, v12
    v_perm_b32 v13, v124, v35, s38
    v_mfma_f32_16x16x32_bf16 v[212:215], a[224:227], a[216:219], v[212:215]
    ds_read_b128 a[76:79], v42 offset:12288
    v_mfma_f32_16x16x32_bf16 v[216:219], a[200:203], a[232:235], v[216:219]
    ds_read_b32 a82, v13
    v_perm_b32 v14, v124, v35, s39
    v_mfma_f32_16x16x32_bf16 v[216:219], a[224:227], a[252:255], v[216:219]
    s_waitcnt vmcnt(15)
    ds_read_b128 a[92:95], v43 offset:12288
    v_mfma_f32_16x16x32_bf16 v[220:223], a[200:203], a[0:3], v[220:223]
    s_mov_b32 s46, 1662976
    ds_read_b32 a83, v14
    v_perm_b32 v15, v64, v35, s36
    v_mfma_f32_16x16x32_bf16 v[220:223], a[224:227], a[20:23], v[220:223]
    s_waitcnt lgkmcnt(8)
    buffer_load_dwordx3 v[100:102], v33, s[12:15], s46 offen
    v_perm_b32 v56, v120, v35, s39
    v_mfma_f32_16x16x32_bf16 v[224:227], a[240:243], a[84:87], v[224:227]
    ds_read_b32 a108, v15
    v_perm_b32 v57, v64, v35, s37
    v_mfma_f32_16x16x32_bf16 v[224:227], a[56:59], a[96:99], v[224:227]
    ds_read_b32 a39, v56
    v_mfma_f32_16x16x32_bf16 v[228:231], a[240:243], a[100:103], v[228:231]
    s_mov_b32 s47, 745472
    ds_read_b32 a109, v57
    v_perm_b32 v58, v64, v35, s38
    v_mfma_f32_16x16x32_bf16 v[228:231], a[56:59], a[112:115], v[228:231]
    buffer_load_dwordx3 v[104:106], v33, s[12:15], s47 offen
    v_mfma_f32_16x16x32_bf16 v[232:235], a[240:243], a[116:119], v[232:235]
    s_mov_b32 s40, 917504
    ds_read_b32 a110, v58
    v_perm_b32 v59, v64, v35, s39
    v_mfma_f32_16x16x32_bf16 v[232:235], a[56:59], a[124:127], v[232:235]
    s_waitcnt vmcnt(16)
    buffer_load_dwordx3 v[112:114], v32, s[12:15], s40 offen
    v_perm_b32 v60, v68, v35, s36
    v_mfma_f32_16x16x32_bf16 v[236:239], a[240:243], a[132:135], v[236:239]
    ds_read_b32 a111, v59
    v_perm_b32 v61, v125, v35, s36
    v_mfma_f32_16x16x32_bf16 v[236:239], a[56:59], a[140:143], v[236:239]
    ds_read_b32 a4, v60
    v_mfma_f32_16x16x32_bf16 v[240:243], a[240:243], a[148:151], v[240:243]
    ds_read_b32 a8, v61
    v_perm_b32 v62, v125, v35, s37
    v_mfma_f32_16x16x32_bf16 v[240:243], a[56:59], a[188:191], v[240:243]
    buffer_load_dword v115, v34, s[12:15], s40 offen
    v_mfma_f32_16x16x32_bf16 v[244:247], a[240:243], a[160:163], v[244:247]
    s_mov_b32 s41, 974848
    ds_read_b32 a9, v62
    v_perm_b32 v63, v125, v35, s38
    v_mfma_f32_16x16x32_bf16 v[244:247], a[56:59], a[216:219], v[244:247]
    buffer_load_dwordx3 v[116:118], v32, s[12:15], s41 offen
    v_perm_b32 v8, v68, v35, s37
    v_mfma_f32_16x16x32_bf16 v[248:251], a[240:243], a[232:235], v[248:251]
    ds_read_b32 a10, v63
    v_perm_b32 v9, v125, v35, s39
    v_mfma_f32_16x16x32_bf16 v[248:251], a[56:59], a[252:255], v[248:251]
    ds_read_b32 a5, v8
    v_mfma_f32_16x16x32_bf16 v[252:255], a[240:243], a[0:3], v[252:255]
    ds_read_b32 a11, v9
    v_perm_b32 v10, v65, v35, s36
    v_mfma_f32_16x16x32_bf16 v[252:255], a[56:59], a[20:23], v[252:255]
    s_waitcnt lgkmcnt(6)
    s_barrier
    buffer_load_dword v119, v34, s[12:15], s41 offen
    v_mfma_f32_16x16x32_bf16 v[128:131], a[80:83], a[180:183], v[128:131]
    ds_read_b32 a16, v10
    v_perm_b32 v11, v65, v35, s37
    v_mfma_f32_16x16x32_bf16 v[128:131], a[108:111], a[184:187], v[128:131]
    ds_read_b128 a[24:27], v40 offset:32768
    v_perm_b32 v12, v68, v35, s38
    v_mfma_f32_16x16x32_bf16 v[132:135], a[80:83], a[196:199], v[132:135]
    ds_read_b32 a17, v11
    v_perm_b32 v13, v65, v35, s38
    v_mfma_f32_16x16x32_bf16 v[132:135], a[108:111], a[208:211], v[132:135]
    s_add_u32 s56, s55, 1280
    ds_read_b128 a[28:31], v41 offset:32768
    ds_read_b32 a6, v12
    v_mfma_f32_16x16x32_bf16 v[136:139], a[80:83], a[212:215], v[136:139]
    s_add_u32 m0, s57, 0
    ds_read_b32 a18, v13
    v_perm_b32 v14, v65, v35, s39
    v_mfma_f32_16x16x32_bf16 v[136:139], a[108:111], a[220:223], v[136:139]
    buffer_load_dwordx4 v36, s[8:11], s56 offen offset:0 lds
    v_mfma_f32_16x16x32_bf16 v[140:143], a[80:83], a[228:231], v[140:143]
    ds_read_b32 a19, v14
    v_perm_b32 v15, v126, v35, s36
    v_mfma_f32_16x16x32_bf16 v[140:143], a[108:111], a[236:239], v[140:143]
    ds_read_b128 a[40:43], v40 offset:34816
    v_perm_b32 v56, v68, v35, s39
    v_mfma_f32_16x16x32_bf16 v[144:147], a[80:83], a[248:251], v[144:147]
    ds_read_b32 a44, v15
    v_perm_b32 v57, v126, v35, s37
    v_mfma_f32_16x16x32_bf16 v[144:147], a[108:111], a[32:35], v[144:147]
    ds_read_b128 a[52:55], v41 offset:34816
    ds_read_b32 a7, v56
    v_mfma_f32_16x16x32_bf16 v[148:151], a[80:83], a[48:51], v[148:151]
    ds_read_b32 a45, v57
    v_perm_b32 v58, v126, v35, s38
    v_mfma_f32_16x16x32_bf16 v[148:151], a[108:111], a[136:139], v[148:151]
    buffer_load_dwordx4 v37, s[8:11], s56 offen offset:1024 lds
    v_mfma_f32_16x16x32_bf16 v[152:155], a[80:83], a[168:171], v[152:155]
    ds_read_b32 a46, v58
    v_perm_b32 v59, v126, v35, s39
    v_mfma_f32_16x16x32_bf16 v[152:155], a[108:111], a[172:175], v[152:155]
    ds_read_b128 a[60:63], v40 offset:36864
    v_perm_b32 v60, v96, v35, s36
    v_mfma_f32_16x16x32_bf16 v[156:159], a[80:83], a[76:79], v[156:159]
    ds_read_b32 a47, v59
    v_perm_b32 v61, v66, v35, s36
    v_mfma_f32_16x16x32_bf16 v[156:159], a[108:111], a[92:95], v[156:159]
    s_waitcnt lgkmcnt(8)
    ds_read_b128 a[68:71], v41 offset:36864
    ds_read_b32 a120, v60
    v_mfma_f32_16x16x32_bf16 v[160:163], a[8:11], a[180:183], v[160:163]
    ds_read_b32 a152, v61
    v_perm_b32 v62, v66, v35, s37
    v_mfma_f32_16x16x32_bf16 v[160:163], a[16:19], a[184:187], v[160:163]
    buffer_load_dwordx4 v38, s[8:11], s56 offen offset:2048 lds
    v_mfma_f32_16x16x32_bf16 v[164:167], a[8:11], a[196:199], v[164:167]
    ds_read_b32 a153, v62
    v_perm_b32 v63, v66, v35, s38
    v_mfma_f32_16x16x32_bf16 v[164:167], a[16:19], a[208:211], v[164:167]
    ds_read_b128 a[104:107], v40 offset:38912
    v_mfma_f32_16x16x32_bf16 v[168:171], a[8:11], a[212:215], v[168:171]
    ds_read_b32 a154, v63
    v_perm_b32 v8, v66, v35, s39
    v_mfma_f32_16x16x32_bf16 v[168:171], a[16:19], a[220:223], v[168:171]
    ds_read_b128 a[164:167], v41 offset:38912
    v_mfma_f32_16x16x32_bf16 v[172:175], a[8:11], a[228:231], v[172:175]
    s_waitcnt vmcnt(22)
    ds_read_b32 a155, v8
    v_perm_b32 v9, v72, v35, s36
    v_mfma_f32_16x16x32_bf16 v[172:175], a[16:19], a[236:239], v[172:175]
    buffer_load_dwordx4 v39, s[8:11], s56 offen offset:3072 lds
    v_perm_b32 v10, v96, v35, s37
    v_mfma_f32_16x16x32_bf16 v[176:179], a[8:11], a[248:251], v[176:179]
    ds_read_b32 a128, v9
    ds_read_b32 a121, v10
    v_mfma_f32_16x16x32_bf16 v[176:179], a[16:19], a[32:35], v[176:179]
    ds_read_b128 a[144:147], v40 offset:40960
    v_perm_b32 v11, v72, v35, s37
    v_mfma_f32_16x16x32_bf16 v[180:183], a[8:11], a[48:51], v[180:183]
    ds_read_b32 a129, v11
    v_perm_b32 v12, v72, v35, s38
    v_mfma_f32_16x16x32_bf16 v[180:183], a[16:19], a[136:139], v[180:183]
    s_add_u32 s56, s55, 1408
    ds_read_b128 a[204:207], v41 offset:40960
    v_mfma_f32_16x16x32_bf16 v[184:187], a[8:11], a[168:171], v[184:187]
    s_add_u32 m0, s57, 18432
    ds_read_b32 a130, v12
    v_perm_b32 v13, v72, v35, s39
    v_mfma_f32_16x16x32_bf16 v[184:187], a[16:19], a[172:175], v[184:187]
    buffer_load_dwordx4 v36, s[8:11], s56 offen offset:0 lds
    v_perm_b32 v14, v96, v35, s38
    v_mfma_f32_16x16x32_bf16 v[188:191], a[8:11], a[76:79], v[188:191]
    ds_read_b32 a131, v13
    ds_read_b32 a122, v14
    v_mfma_f32_16x16x32_bf16 v[188:191], a[16:19], a[92:95], v[188:191]
    s_waitcnt vmcnt(22) lgkmcnt(8)
    ds_read_b128 a[64:67], v40 offset:43008
    v_perm_b32 v15, v76, v35, s36
    v_mfma_f32_16x16x32_bf16 v[192:195], a[44:47], a[180:183], v[192:195]
    ds_read_b32 a176, v15
    v_perm_b32 v56, v76, v35, s37
    v_mfma_f32_16x16x32_bf16 v[192:195], a[152:155], a[184:187], v[192:195]
    ds_read_b128 a[200:203], v41 offset:43008
    v_mfma_f32_16x16x32_bf16 v[196:199], a[44:47], a[196:199], v[196:199]
    ds_read_b32 a177, v56
    v_perm_b32 v57, v76, v35, s38
    v_mfma_f32_16x16x32_bf16 v[196:199], a[152:155], a[208:211], v[196:199]
    buffer_load_dwordx4 v37, s[8:11], s56 offen offset:1024 lds
    v_perm_b32 v58, v96, v35, s39
    v_mfma_f32_16x16x32_bf16 v[200:203], a[44:47], a[212:215], v[200:203]
    ds_read_b32 a178, v57
    ds_read_b32 a123, v58
    v_mfma_f32_16x16x32_bf16 v[200:203], a[152:155], a[220:223], v[200:203]
    ds_read_b128 a[224:227], v40 offset:45056
    v_perm_b32 v59, v76, v35, s39
    v_mfma_f32_16x16x32_bf16 v[204:207], a[44:47], a[228:231], v[204:207]
    ds_read_b32 a179, v59
    v_perm_b32 v60, v73, v35, s36
    v_mfma_f32_16x16x32_bf16 v[204:207], a[152:155], a[236:239], v[204:207]
    ds_read_b128 a[84:87], v41 offset:45056
    v_mfma_f32_16x16x32_bf16 v[208:211], a[44:47], a[248:251], v[208:211]
    s_add_u32 m0, s57, 14336
    ds_read_b32 a96, v60
    v_perm_b32 v61, v73, v35, s37
    v_mfma_f32_16x16x32_bf16 v[208:211], a[152:155], a[32:35], v[208:211]
    buffer_load_dwordx4 v38, s[8:11], s56 offen offset:2048 lds
    v_perm_b32 v62, v108, v35, s36
    v_mfma_f32_16x16x32_bf16 v[212:215], a[44:47], a[48:51], v[212:215]
    ds_read_b32 a97, v61
    ds_read_b32 a100, v62
    v_mfma_f32_16x16x32_bf16 v[212:215], a[152:155], a[136:139], v[212:215]
    ds_read_b128 a[112:115], v40 offset:47104
    v_perm_b32 v63, v73, v35, s38
    v_mfma_f32_16x16x32_bf16 v[216:219], a[44:47], a[168:171], v[216:219]
    ds_read_b32 a98, v63
    v_perm_b32 v8, v73, v35, s39
    v_mfma_f32_16x16x32_bf16 v[216:219], a[152:155], a[172:175], v[216:219]
    ds_read_b128 a[116:119], v41 offset:47104
    v_mfma_f32_16x16x32_bf16 v[220:223], a[44:47], a[76:79], v[220:223]
    ds_read_b32 a99, v8
    v_perm_b32 v9, v77, v35, s36
    v_mfma_f32_16x16x32_bf16 v[220:223], a[152:155], a[92:95], v[220:223]
    s_waitcnt lgkmcnt(8)
    buffer_load_dwordx4 v39, s[8:11], s56 offen offset:3072 lds
    v_perm_b32 v10, v108, v35, s37
    v_mfma_f32_16x16x32_bf16 v[128:131], a[128:131], a[24:27], v[128:131]
    ds_read_b32 a124, v9
    ds_read_b32 a101, v10
    v_mfma_f32_16x16x32_bf16 v[128:131], a[176:179], a[28:31], v[128:131]
    ds_read_b128 a[132:135], v42 offset:34816
    v_perm_b32 v11, v77, v35, s37
    v_mfma_f32_16x16x32_bf16 v[132:135], a[128:131], a[40:43], v[132:135]
    ds_read_b32 a125, v11
    v_perm_b32 v12, v77, v35, s38
    v_mfma_f32_16x16x32_bf16 v[132:135], a[176:179], a[52:55], v[132:135]
    ds_read_b128 a[140:143], v43 offset:34816
    v_mfma_f32_16x16x32_bf16 v[136:139], a[128:131], a[60:63], v[136:139]
    s_mov_b32 s42, 917504
    ds_read_b32 a126, v12
    v_perm_b32 v13, v77, v35, s39
    v_mfma_f32_16x16x32_bf16 v[136:139], a[176:179], a[68:71], v[136:139]
    buffer_load_dwordx3 v[124:126], v33, s[12:15], s42 offen
    v_perm_b32 v14, v108, v35, s38
    v_mfma_f32_16x16x32_bf16 v[140:143], a[128:131], a[104:107], v[140:143]
    ds_read_b32 a127, v13
    v_perm_b32 v15, v74, v35, s36
    v_mfma_f32_16x16x32_bf16 v[140:143], a[176:179], a[164:167], v[140:143]
    ds_read_b128 a[148:151], v42 offset:32768
    ds_read_b32 a102, v14
    v_mfma_f32_16x16x32_bf16 v[144:147], a[128:131], a[144:147], v[144:147]
    ds_read_b32 a188, v15
    v_perm_b32 v56, v74, v35, s37
    v_mfma_f32_16x16x32_bf16 v[144:147], a[176:179], a[204:207], v[144:147]
    ds_read_b128 a[160:163], v43 offset:32768
    v_mfma_f32_16x16x32_bf16 v[148:151], a[128:131], a[64:67], v[148:151]
    s_mov_b32 s43, 974848
    ds_read_b32 a189, v56
    v_perm_b32 v57, v74, v35, s38
    v_mfma_f32_16x16x32_bf16 v[148:151], a[176:179], a[200:203], v[148:151]
    buffer_load_dwordx3 v[64:66], v33, s[12:15], s43 offen
    v_perm_b32 v58, v108, v35, s39
    v_mfma_f32_16x16x32_bf16 v[152:155], a[128:131], a[224:227], v[152:155]
    s_waitcnt lgkmcnt(7)
    ds_read_b32 a190, v57
    v_perm_b32 v59, v74, v35, s39
    v_mfma_f32_16x16x32_bf16 v[152:155], a[176:179], a[84:87], v[152:155]
    ds_read_b128 a[216:219], v42 offset:38912
    ds_read_b32 a103, v58
    v_mfma_f32_16x16x32_bf16 v[156:159], a[128:131], a[112:115], v[156:159]
    ds_read_b32 a191, v59
    v_perm_b32 v60, v78, v35, s36
    v_mfma_f32_16x16x32_bf16 v[156:159], a[176:179], a[116:119], v[156:159]
    ds_read_b128 a[232:235], v43 offset:38912
    v_mfma_f32_16x16x32_bf16 v[160:163], a[96:99], a[24:27], v[160:163]
    s_waitcnt lgkmcnt(8)
    ds_read_b32 a252, v60
    v_perm_b32 v61, v78, v35, s37
    v_mfma_f32_16x16x32_bf16 v[160:163], a[124:127], a[28:31], v[160:163]
    s_waitcnt vmcnt(17)
    buffer_load_dwordx4 v[48:51], v22, s[32:35], 0 offen
    v_perm_b32 v62, v80, v35, s36
    v_mfma_f32_16x16x32_bf16 v[164:167], a[96:99], a[40:43], v[164:167]
    ds_read_b32 a253, v61
    v_perm_b32 v63, v78, v35, s38
    v_mfma_f32_16x16x32_bf16 v[164:167], a[124:127], a[52:55], v[164:167]
    ds_read_b128 a[0:3], v42 offset:36864
    ds_read_b32 a240, v62
    v_mfma_f32_16x16x32_bf16 v[168:171], a[96:99], a[60:63], v[168:171]
    ds_read_b32 a254, v63
    v_perm_b32 v8, v78, v35, s39
    v_mfma_f32_16x16x32_bf16 v[168:171], a[124:127], a[68:71], v[168:171]
    ds_read_b128 a[20:23], v43 offset:36864
    v_mfma_f32_16x16x32_bf16 v[172:175], a[96:99], a[104:107], v[172:175]
    ds_read_b32 a255, v8
    v_perm_b32 v9, v75, v35, s36
    v_mfma_f32_16x16x32_bf16 v[172:175], a[124:127], a[164:167], v[172:175]
    buffer_load_dwordx2 v[52:53], v22, s[32:35], 0 offen offset:16
    v_perm_b32 v10, v80, v35, s37
    v_mfma_f32_16x16x32_bf16 v[176:179], a[96:99], a[144:147], v[176:179]
    ds_read_b32 a56, v9
    v_perm_b32 v11, v75, v35, s37
    v_mfma_f32_16x16x32_bf16 v[176:179], a[124:127], a[204:207], v[176:179]
    ds_read_b128 a[80:83], v42 offset:43008
    ds_read_b32 a241, v10
    v_mfma_f32_16x16x32_bf16 v[180:183], a[96:99], a[64:67], v[180:183]
    ds_read_b32 a57, v11
    v_perm_b32 v12, v75, v35, s38
    v_mfma_f32_16x16x32_bf16 v[180:183], a[124:127], a[200:203], v[180:183]
    ds_read_b128 a[108:111], v43 offset:43008
    v_mfma_f32_16x16x32_bf16 v[184:187], a[96:99], a[224:227], v[184:187]
    ds_read_b32 a58, v12
    v_perm_b32 v13, v75, v35, s39
    v_mfma_f32_16x16x32_bf16 v[184:187], a[124:127], a[84:87], v[184:187]
    buffer_load_dwordx2 v[54:55], v23, s[32:35], 0 offen
    v_perm_b32 v14, v80, v35, s38
    v_mfma_f32_16x16x32_bf16 v[188:191], a[96:99], a[112:115], v[188:191]
    ds_read_b32 a59, v13
    v_perm_b32 v15, v79, v35, s36
    v_mfma_f32_16x16x32_bf16 v[188:191], a[124:127], a[116:119], v[188:191]
    s_waitcnt lgkmcnt(7)
    ds_read_b128 a[8:11], v42 offset:40960
    ds_read_b32 a242, v14
    v_mfma_f32_16x16x32_bf16 v[192:195], a[188:191], a[24:27], v[192:195]
    ds_read_b32 a16, v15
    v_perm_b32 v56, v79, v35, s37
    v_mfma_f32_16x16x32_bf16 v[192:195], a[252:255], a[28:31], v[192:195]
    ds_read_b128 a[180:183], v43 offset:40960
    v_mfma_f32_16x16x32_bf16 v[196:199], a[188:191], a[40:43], v[196:199]
    ds_read_b32 a17, v56
    v_perm_b32 v57, v79, v35, s38
    v_mfma_f32_16x16x32_bf16 v[196:199], a[252:255], a[52:55], v[196:199]
    v_mfma_f32_16x16x32_bf16 v[200:203], a[188:191], a[60:63], v[200:203]
    ds_read_b32 a18, v57
    v_perm_b32 v58, v79, v35, s39
    v_mfma_f32_16x16x32_bf16 v[200:203], a[252:255], a[68:71], v[200:203]
    ds_read_b128 a[184:187], v42 offset:47104
    v_perm_b32 v59, v80, v35, s39
    v_mfma_f32_16x16x32_bf16 v[204:207], a[188:191], a[104:107], v[204:207]
    s_waitcnt vmcnt(19)
    ds_read_b32 a19, v58
    v_perm_b32 v60, v84, v35, s36
    v_mfma_f32_16x16x32_bf16 v[204:207], a[252:255], a[164:167], v[204:207]
    ds_read_b128 a[196:199], v43 offset:47104
    ds_read_b32 a243, v59
    v_mfma_f32_16x16x32_bf16 v[208:211], a[188:191], a[144:147], v[208:211]
    ds_read_b32 a208, v60
    v_perm_b32 v61, v84, v35, s37
    v_mfma_f32_16x16x32_bf16 v[208:211], a[252:255], a[204:207], v[208:211]
    v_mfma_f32_16x16x32_bf16 v[212:215], a[188:191], a[64:67], v[212:215]
    ds_read_b32 a209, v61
    v_perm_b32 v62, v84, v35, s38
    v_mfma_f32_16x16x32_bf16 v[212:215], a[252:255], a[200:203], v[212:215]
    s_waitcnt vmcnt(18)
    ds_read_b128 a[212:215], v42 offset:45056
    v_perm_b32 v63, v100, v35, s36
    v_mfma_f32_16x16x32_bf16 v[216:219], a[188:191], a[224:227], v[216:219]
    ds_read_b32 a210, v62
    v_perm_b32 v8, v84, v35, s39
    v_mfma_f32_16x16x32_bf16 v[216:219], a[252:255], a[84:87], v[216:219]
    ds_read_b128 a[220:223], v43 offset:45056
    ds_read_b32 a228, v63
    v_mfma_f32_16x16x32_bf16 v[220:223], a[188:191], a[112:115], v[220:223]
    s_waitcnt vmcnt(17)
    ds_read_b32 a211, v8
    v_perm_b32 v9, v104, v35, s36
    v_mfma_f32_16x16x32_bf16 v[220:223], a[252:255], a[116:119], v[220:223]
    s_waitcnt lgkmcnt(9)
    v_mfma_f32_16x16x32_bf16 v[224:227], a[56:59], a[24:27], v[224:227]
    ds_read_b32 a236, v9
    v_perm_b32 v10, v104, v35, s37
    v_mfma_f32_16x16x32_bf16 v[224:227], a[16:19], a[28:31], v[224:227]
    v_perm_b32 v11, v100, v35, s37
    v_mfma_f32_16x16x32_bf16 v[228:231], a[56:59], a[40:43], v[228:231]
    ds_read_b32 a237, v10
    v_perm_b32 v12, v104, v35, s38
    v_mfma_f32_16x16x32_bf16 v[228:231], a[16:19], a[52:55], v[228:231]
    ds_read_b32 a229, v11
    v_mfma_f32_16x16x32_bf16 v[232:235], a[56:59], a[60:63], v[232:235]
    s_mov_b32 s44, 1146880
    ds_read_b32 a238, v12
    v_perm_b32 v13, v104, v35, s39
    v_mfma_f32_16x16x32_bf16 v[232:235], a[16:19], a[68:71], v[232:235]
    buffer_load_dwordx3 v[72:74], v32, s[12:15], s44 offen
    v_mfma_f32_16x16x32_bf16 v[236:239], a[56:59], a[104:107], v[236:239]
    ds_read_b32 a239, v13
    v_perm_b32 v14, v85, v35, s36
    v_mfma_f32_16x16x32_bf16 v[236:239], a[16:19], a[164:167], v[236:239]
    buffer_load_dword v75, v34, s[12:15], s44 offen
    v_perm_b32 v15, v100, v35, s38
    v_mfma_f32_16x16x32_bf16 v[240:243], a[56:59], a[144:147], v[240:243]
    ds_read_b32 a248, v14
    v_perm_b32 v56, v85, v35, s37
    v_mfma_f32_16x16x32_bf16 v[240:243], a[16:19], a[204:207], v[240:243]
    ds_read_b32 a230, v15
    v_mfma_f32_16x16x32_bf16 v[244:247], a[56:59], a[64:67], v[244:247]
    s_mov_b32 s45, 1204224
    ds_read_b32 a249, v56
    v_perm_b32 v57, v85, v35, s38
    v_mfma_f32_16x16x32_bf16 v[244:247], a[16:19], a[200:203], v[244:247]
    buffer_load_dwordx3 v[76:78], v32, s[12:15], s45 offen
    v_mfma_f32_16x16x32_bf16 v[248:251], a[56:59], a[224:227], v[248:251]
    ds_read_b32 a250, v57
    v_perm_b32 v58, v85, v35, s39
    v_mfma_f32_16x16x32_bf16 v[248:251], a[16:19], a[84:87], v[248:251]
    buffer_load_dword v79, v34, s[12:15], s45 offen
    v_perm_b32 v59, v100, v35, s39
    v_mfma_f32_16x16x32_bf16 v[252:255], a[56:59], a[112:115], v[252:255]
    ds_read_b32 a251, v58
    v_perm_b32 v60, v105, v35, s36
    v_mfma_f32_16x16x32_bf16 v[252:255], a[16:19], a[116:119], v[252:255]
    s_waitcnt lgkmcnt(5)
    s_barrier
    ds_read_b32 a231, v59
    v_mfma_f32_16x16x32_bf16 v[128:131], a[208:211], a[132:135], v[128:131]
    ds_read_b32 a32, v60
    v_perm_b32 v61, v105, v35, s37
    v_mfma_f32_16x16x32_bf16 v[128:131], a[236:239], a[140:143], v[128:131]
    ds_read_b128 a[48:51], v44 offset:0
    v_mfma_f32_16x16x32_bf16 v[132:135], a[208:211], a[148:151], v[132:135]
    ds_read_b32 a33, v61
    v_perm_b32 v62, v105, v35, s38
    v_mfma_f32_16x16x32_bf16 v[132:135], a[236:239], a[160:163], v[132:135]
    s_add_u32 s56, s55, 1536
    ds_read_b128 a[136:139], v45 offset:0
    v_mfma_f32_16x16x32_bf16 v[136:139], a[208:211], a[216:219], v[136:139]
    s_add_u32 m0, s57, 32768
    ds_read_b32 a34, v62
    v_perm_b32 v63, v105, v35, s39
    v_mfma_f32_16x16x32_bf16 v[136:139], a[236:239], a[232:235], v[136:139]
    buffer_load_dwordx4 v36, s[8:11], s56 offen offset:0 lds
    v_perm_b32 v8, v89, v35, s36
    v_mfma_f32_16x16x32_bf16 v[140:143], a[208:211], a[0:3], v[140:143]
    ds_read_b32 a35, v63
    ds_read_b32 a168, v8
    v_mfma_f32_16x16x32_bf16 v[140:143], a[236:239], a[20:23], v[140:143]
    ds_read_b128 a[172:175], v44 offset:2048
    v_perm_b32 v9, v86, v35, s36
    v_mfma_f32_16x16x32_bf16 v[144:147], a[208:211], a[80:83], v[144:147]
    ds_read_b32 a76, v9
    v_perm_b32 v10, v86, v35, s37
    v_mfma_f32_16x16x32_bf16 v[144:147], a[236:239], a[108:111], v[144:147]
    ds_read_b128 a[44:47], v45 offset:2048
    v_mfma_f32_16x16x32_bf16 v[148:151], a[208:211], a[8:11], v[148:151]
    ds_read_b32 a77, v10
    v_perm_b32 v11, v86, v35, s38
    v_mfma_f32_16x16x32_bf16 v[148:151], a[236:239], a[180:183], v[148:151]
    buffer_load_dwordx4 v37, s[8:11], s56 offen offset:1024 lds
    v_perm_b32 v12, v89, v35, s37
    v_mfma_f32_16x16x32_bf16 v[152:155], a[208:211], a[184:187], v[152:155]
    ds_read_b32 a78, v11
    v_perm_b32 v13, v86, v35, s39
    v_mfma_f32_16x16x32_bf16 v[152:155], a[236:239], a[196:199], v[152:155]
    ds_read_b128 a[92:95], v44 offset:4096
    ds_read_b32 a169, v12
    v_mfma_f32_16x16x32_bf16 v[156:159], a[208:211], a[212:215], v[156:159]
    ds_read_b32 a79, v13
    v_perm_b32 v14, v106, v35, s36
    v_mfma_f32_16x16x32_bf16 v[156:159], a[236:239], a[220:223], v[156:159]
    s_waitcnt lgkmcnt(8)
    ds_read_b128 a[152:155], v45 offset:4096
    v_mfma_f32_16x16x32_bf16 v[160:163], a[248:251], a[132:135], v[160:163]
    ds_read_b32 a128, v14
    v_perm_b32 v15, v106, v35, s37
    v_mfma_f32_16x16x32_bf16 v[160:163], a[32:35], a[140:143], v[160:163]
    buffer_load_dwordx4 v38, s[8:11], s56 offen offset:2048 lds
    v_perm_b32 v56, v89, v35, s38
    v_mfma_f32_16x16x32_bf16 v[164:167], a[248:251], a[148:151], v[164:167]
    ds_read_b32 a129, v15
    v_perm_b32 v57, v106, v35, s38
    v_mfma_f32_16x16x32_bf16 v[164:167], a[32:35], a[160:163], v[164:167]
    ds_read_b128 a[176:179], v44 offset:6144
    ds_read_b32 a170, v56
    v_mfma_f32_16x16x32_bf16 v[168:171], a[248:251], a[216:219], v[168:171]
    ds_read_b32 a130, v57
    v_perm_b32 v58, v106, v35, s39
    v_mfma_f32_16x16x32_bf16 v[168:171], a[32:35], a[232:235], v[168:171]
    ds_read_b128 a[96:99], v45 offset:6144
    v_mfma_f32_16x16x32_bf16 v[172:175], a[248:251], a[0:3], v[172:175]
    s_waitcnt vmcnt(23)
    ds_read_b32 a131, v58
    v_perm_b32 v59, v112, v35, s36
    v_mfma_f32_16x16x32_bf16 v[172:175], a[32:35], a[20:23], v[172:175]
    buffer_load_dwordx4 v39, s[8:11], s56 offen offset:3072 lds
    v_perm_b32 v60, v89, v35, s39
    v_mfma_f32_16x16x32_bf16 v[176:179], a[248:251], a[80:83], v[176:179]
    ds_read_b32 a124, v59
    v_perm_b32 v61, v112, v35, s37
    v_mfma_f32_16x16x32_bf16 v[176:179], a[32:35], a[108:111], v[176:179]
    ds_read_b128 a[188:191], v44 offset:8192
    ds_read_b32 a171, v60
    v_mfma_f32_16x16x32_bf16 v[180:183], a[248:251], a[8:11], v[180:183]
    ds_read_b32 a125, v61
    v_perm_b32 v62, v112, v35, s38
    v_mfma_f32_16x16x32_bf16 v[180:183], a[32:35], a[180:183], v[180:183]
    s_add_u32 s56, s55, 1664
    ds_read_b128 a[252:255], v45 offset:8192
    v_mfma_f32_16x16x32_bf16 v[184:187], a[248:251], a[184:187], v[184:187]
    s_add_u32 m0, s57, 51200
    ds_read_b32 a126, v62
    v_perm_b32 v63, v112, v35, s39
    v_mfma_f32_16x16x32_bf16 v[184:187], a[32:35], a[196:199], v[184:187]
    buffer_load_dwordx4 v36, s[8:11], s56 offen offset:0 lds
    v_perm_b32 v8, v93, v35, s36
    v_mfma_f32_16x16x32_bf16 v[188:191], a[248:251], a[212:215], v[188:191]
    s_waitcnt vmcnt(23)
    ds_read_b32 a127, v63
    v_perm_b32 v9, v116, v35, s36
    v_mfma_f32_16x16x32_bf16 v[188:191], a[32:35], a[220:223], v[188:191]
    s_waitcnt lgkmcnt(7)
    ds_read_b128 a[24:27], v44 offset:10240
    ds_read_b32 a28, v8
    v_mfma_f32_16x16x32_bf16 v[192:195], a[76:79], a[132:135], v[192:195]
    ds_read_b32 a40, v9
    v_perm_b32 v10, v116, v35, s37
    v_mfma_f32_16x16x32_bf16 v[192:195], a[128:131], a[140:143], v[192:195]
    ds_read_b128 a[52:55], v45 offset:10240
    v_mfma_f32_16x16x32_bf16 v[196:199], a[76:79], a[148:151], v[196:199]
    ds_read_b32 a41, v10
    v_perm_b32 v11, v116, v35, s38
    v_mfma_f32_16x16x32_bf16 v[196:199], a[128:131], a[160:163], v[196:199]
    buffer_load_dwordx4 v37, s[8:11], s56 offen offset:1024 lds
    v_perm_b32 v12, v93, v35, s37
    v_mfma_f32_16x16x32_bf16 v[200:203], a[76:79], a[216:219], v[200:203]
    ds_read_b32 a42, v11
    v_perm_b32 v13, v116, v35, s39
    v_mfma_f32_16x16x32_bf16 v[200:203], a[128:131], a[232:235], v[200:203]
    ds_read_b128 a[60:63], v44 offset:12288
    ds_read_b32 a29, v12
    v_mfma_f32_16x16x32_bf16 v[204:207], a[76:79], a[0:3], v[204:207]
    ds_read_b32 a43, v13
    v_perm_b32 v14, v113, v35, s36
    v_mfma_f32_16x16x32_bf16 v[204:207], a[128:131], a[20:23], v[204:207]
    ds_read_b128 a[68:71], v45 offset:12288
    v_mfma_f32_16x16x32_bf16 v[208:211], a[76:79], a[80:83], v[208:211]
    s_add_u32 m0, s57, 47104
    ds_read_b32 a104, v14
    v_perm_b32 v15, v113, v35, s37
    v_mfma_f32_16x16x32_bf16 v[208:211], a[128:131], a[108:111], v[208:211]
    buffer_load_dwordx4 v38, s[8:11], s56 offen offset:2048 lds
    v_mfma_f32_16x16x32_bf16 v[212:215], a[76:79], a[8:11], v[212:215]
    ds_read_b32 a105, v15
    v_perm_b32 v56, v113, v35, s38
    v_mfma_f32_16x16x32_bf16 v[212:215], a[128:131], a[180:183], v[212:215]
    ds_read_b128 a[164:167], v44 offset:14336
    v_perm_b32 v57, v93, v35, s38
    v_mfma_f32_16x16x32_bf16 v[216:219], a[76:79], a[184:187], v[216:219]
    ds_read_b32 a106, v56
    v_perm_b32 v58, v113, v35, s39
    v_mfma_f32_16x16x32_bf16 v[216:219], a[128:131], a[196:199], v[216:219]
    ds_read_b128 a[144:147], v45 offset:14336
    ds_read_b32 a30, v57
    v_mfma_f32_16x16x32_bf16 v[220:223], a[76:79], a[212:215], v[220:223]
    ds_read_b32 a107, v58
    v_perm_b32 v59, v117, v35, s36
    v_mfma_f32_16x16x32_bf16 v[220:223], a[128:131], a[220:223], v[220:223]
    s_waitcnt lgkmcnt(8)
    buffer_load_dwordx4 v39, s[8:11], s56 offen offset:3072 lds
    v_mfma_f32_16x16x32_bf16 v[128:131], a[124:127], a[48:51], v[128:131]
    ds_read_b32 a204, v59
    v_perm_b32 v60, v117, v35, s37
    v_mfma_f32_16x16x32_bf16 v[128:131], a[40:43], a[136:139], v[128:131]
    ds_read_b128 a[64:67], v46 offset:2048
    v_perm_b32 v61, v93, v35, s39
    v_mfma_f32_16x16x32_bf16 v[132:135], a[124:127], a[172:175], v[132:135]
    ds_read_b32 a205, v60
    v_perm_b32 v62, v117, v35, s38
    v_mfma_f32_16x16x32_bf16 v[132:135], a[40:43], a[44:47], v[132:135]
    ds_read_b128 a[200:203], v47 offset:2048
    ds_read_b32 a31, v61
    v_mfma_f32_16x16x32_bf16 v[136:139], a[124:127], a[92:95], v[136:139]
    s_mov_b32 s46, 1146880
    ds_read_b32 a206, v62
    v_perm_b32 v63, v117, v35, s39
    v_mfma_f32_16x16x32_bf16 v[136:139], a[40:43], a[152:155], v[136:139]
    buffer_load_dwordx3 v[84:86], v33, s[12:15], s46 offen
    v_mfma_f32_16x16x32_bf16 v[140:143], a[124:127], a[176:179], v[140:143]
    ds_read_b32 a207, v63
    v_perm_b32 v8, v114, v35, s36
    v_mfma_f32_16x16x32_bf16 v[140:143], a[40:43], a[96:99], v[140:143]
    ds_read_b128 a[224:227], v46 offset:0
    v_perm_b32 v9, v121, v35, s36
    v_mfma_f32_16x16x32_bf16 v[144:147], a[124:127], a[188:191], v[144:147]
    ds_read_b32 a84, v8
    v_perm_b32 v10, v114, v35, s37
    v_mfma_f32_16x16x32_bf16 v[144:147], a[40:43], a[252:255], v[144:147]
    ds_read_b128 a[112:115], v47 offset:0
    ds_read_b32 a56, v9
    v_mfma_f32_16x16x32_bf16 v[148:151], a[124:127], a[24:27], v[148:151]
    s_mov_b32 s47, 1204224
    ds_read_b32 a85, v10
    v_perm_b32 v11, v114, v35, s38
    v_mfma_f32_16x16x32_bf16 v[148:151], a[40:43], a[52:55], v[148:151]
    buffer_load_dwordx3 v[104:106], v33, s[12:15], s47 offen
    v_mfma_f32_16x16x32_bf16 v[152:155], a[124:127], a[60:63], v[152:155]
    s_waitcnt lgkmcnt(7)
    ds_read_b32 a86, v11
    v_perm_b32 v12, v114, v35, s39
    v_mfma_f32_16x16x32_bf16 v[152:155], a[40:43], a[68:71], v[152:155]
    ds_read_b128 a[116:119], v46 offset:6144
    v_perm_b32 v13, v121, v35, s37
    v_mfma_f32_16x16x32_bf16 v[156:159], a[124:127], a[164:167], v[156:159]
    ds_read_b32 a87, v12
    v_perm_b32 v14, v118, v35, s36
    v_mfma_f32_16x16x32_bf16 v[156:159], a[40:43], a[144:147], v[156:159]
    ds_read_b128 a[16:19], v47 offset:6144
    ds_read_b32 a57, v13
    v_mfma_f32_16x16x32_bf16 v[160:163], a[104:107], a[48:51], v[160:163]
    s_waitcnt lgkmcnt(9)
    ds_read_b32 a208, v14
    v_perm_b32 v15, v118, v35, s37
    v_mfma_f32_16x16x32_bf16 v[160:163], a[204:207], a[136:139], v[160:163]
    v_mfma_f32_16x16x32_bf16 v[164:167], a[104:107], a[172:175], v[164:167]
    ds_read_b32 a209, v15
    v_perm_b32 v56, v118, v35, s38
    v_mfma_f32_16x16x32_bf16 v[164:167], a[204:207], a[44:47], v[164:167]
    ds_read_b128 a[236:239], v46 offset:4096
    v_perm_b32 v57, v121, v35, s38
    v_mfma_f32_16x16x32_bf16 v[168:171], a[104:107], a[92:95], v[168:171]
    ds_read_b32 a210, v56
    v_perm_b32 v58, v118, v35, s39
    v_mfma_f32_16x16x32_bf16 v[168:171], a[204:207], a[152:155], v[168:171]
    ds_read_b128 a[248:251], v47 offset:4096
    ds_read_b32 a58, v57
    v_mfma_f32_16x16x32_bf16 v[172:175], a[104:107], a[176:179], v[172:175]
    ds_read_b32 a211, v58
    v_perm_b32 v59, v115, v35, s36
    v_mfma_f32_16x16x32_bf16 v[172:175], a[204:207], a[96:99], v[172:175]
    v_mfma_f32_16x16x32_bf16 v[176:179], a[104:107], a[188:191], v[176:179]
    ds_read_b32 a32, v59
    v_perm_b32 v60, v115, v35, s37
    v_mfma_f32_16x16x32_bf16 v[176:179], a[204:207], a[252:255], v[176:179]
    ds_read_b128 a[132:135], v46 offset:10240
    v_perm_b32 v61, v121, v35, s39
    v_mfma_f32_16x16x32_bf16 v[180:183], a[104:107], a[24:27], v[180:183]
    ds_read_b32 a33, v60
    v_perm_b32 v62, v115, v35, s38
    v_mfma_f32_16x16x32_bf16 v[180:183], a[204:207], a[52:55], v[180:183]
    ds_read_b128 a[140:143], v47 offset:10240
    ds_read_b32 a59, v61
    v_mfma_f32_16x16x32_bf16 v[184:187], a[104:107], a[60:63], v[184:187]
    ds_read_b32 a34, v62
    v_perm_b32 v63, v115, v35, s39
    v_mfma_f32_16x16x32_bf16 v[184:187], a[204:207], a[68:71], v[184:187]
    v_mfma_f32_16x16x32_bf16 v[188:191], a[104:107], a[164:167], v[188:191]
    s_waitcnt vmcnt(27)
    ds_read_b32 a35, v63
    v_perm_b32 v8, v119, v35, s36
    v_mfma_f32_16x16x32_bf16 v[188:191], a[204:207], a[144:147], v[188:191]
    s_waitcnt lgkmcnt(7)
    ds_read_b128 a[148:151], v46 offset:8192
    v_mfma_f32_16x16x32_bf16 v[192:195], a[84:87], a[48:51], v[192:195]
    ds_read_b32 a160, v8
    v_perm_b32 v9, v119, v35, s37
    v_mfma_f32_16x16x32_bf16 v[192:195], a[208:211], a[136:139], v[192:195]
    ds_read_b128 a[216:219], v47 offset:8192
    v_perm_b32 v10, v69, v35, s36
    v_mfma_f32_16x16x32_bf16 v[196:199], a[84:87], a[172:175], v[196:199]
    ds_read_b32 a161, v9
    v_perm_b32 v11, v119, v35, s38
    v_mfma_f32_16x16x32_bf16 v[196:199], a[208:211], a[44:47], v[196:199]
    ds_read_b32 a232, v10
    v_mfma_f32_16x16x32_bf16 v[200:203], a[84:87], a[92:95], v[200:203]
    ds_read_b32 a162, v11
    v_perm_b32 v12, v119, v35, s39
    v_mfma_f32_16x16x32_bf16 v[200:203], a[208:211], a[152:155], v[200:203]
    ds_read_b128 a[0:3], v46 offset:14336
    v_mfma_f32_16x16x32_bf16 v[204:207], a[84:87], a[176:179], v[204:207]
    s_waitcnt vmcnt(18)
    ds_read_b32 a163, v12
    v_perm_b32 v13, v124, v35, s36
    v_mfma_f32_16x16x32_bf16 v[204:207], a[208:211], a[96:99], v[204:207]
    ds_read_b128 a[20:23], v47 offset:14336
    v_perm_b32 v14, v69, v35, s37
    v_mfma_f32_16x16x32_bf16 v[208:211], a[84:87], a[188:191], v[208:211]
    ds_read_b32 a80, v13
    v_perm_b32 v15, v124, v35, s37
    v_mfma_f32_16x16x32_bf16 v[208:211], a[208:211], a[252:255], v[208:211]
    ds_read_b32 a233, v14
    v_mfma_f32_16x16x32_bf16 v[212:215], a[84:87], a[24:27], v[212:215]
    ds_read_b32 a81, v15
    v_perm_b32 v56, v124, v35, s38
    v_mfma_f32_16x16x32_bf16 v[212:215], a[208:211], a[52:55], v[212:215]
    ds_read_b128 a[108:111], v46 offset:12288
    v_mfma_f32_16x16x32_bf16 v[216:219], a[84:87], a[60:63], v[216:219]
    ds_read_b32 a82, v56
    v_perm_b32 v57, v124, v35, s39
    v_mfma_f32_16x16x32_bf16 v[216:219], a[208:211], a[68:71], v[216:219]
    ds_read_b128 a[8:11], v47 offset:12288
    v_perm_b32 v58, v69, v35, s38
    v_mfma_f32_16x16x32_bf16 v[220:223], a[84:87], a[164:167], v[220:223]
    s_waitcnt vmcnt(17)
    ds_read_b32 a83, v57
    v_perm_b32 v59, v64, v35, s36
    v_mfma_f32_16x16x32_bf16 v[220:223], a[208:211], a[144:147], v[220:223]
    s_waitcnt lgkmcnt(8)
    ds_read_b32 a234, v58
    v_mfma_f32_16x16x32_bf16 v[224:227], a[32:35], a[48:51], v[224:227]
    ds_read_b32 a180, v59
    v_perm_b32 v60, v64, v35, s37
    v_mfma_f32_16x16x32_bf16 v[224:227], a[160:163], a[136:139], v[224:227]
    v_mfma_f32_16x16x32_bf16 v[228:231], a[32:35], a[172:175], v[228:231]
    ds_read_b32 a181, v60
    v_perm_b32 v61, v64, v35, s38
    v_mfma_f32_16x16x32_bf16 v[228:231], a[160:163], a[44:47], v[228:231]
    v_perm_b32 v62, v69, v35, s39
    v_mfma_f32_16x16x32_bf16 v[232:235], a[32:35], a[92:95], v[232:235]
    ds_read_b32 a182, v61
    v_perm_b32 v63, v64, v35, s39
    v_mfma_f32_16x16x32_bf16 v[232:235], a[160:163], a[152:155], v[232:235]
    ds_read_b32 a235, v62
    v_mfma_f32_16x16x32_bf16 v[236:239], a[32:35], a[176:179], v[236:239]
    ds_read_b32 a183, v63
    v_perm_b32 v8, v125, v35, s36
    v_mfma_f32_16x16x32_bf16 v[236:239], a[160:163], a[96:99], v[236:239]
    v_mfma_f32_16x16x32_bf16 v[240:243], a[32:35], a[188:191], v[240:243]
    ds_read_b32 a184, v8
    v_perm_b32 v9, v125, v35, s37
    v_mfma_f32_16x16x32_bf16 v[240:243], a[160:163], a[252:255], v[240:243]
    v_perm_b32 v10, v97, v35, s36
    v_mfma_f32_16x16x32_bf16 v[244:247], a[32:35], a[24:27], v[244:247]
    ds_read_b32 a185, v9
    v_perm_b32 v11, v125, v35, s38
    v_mfma_f32_16x16x32_bf16 v[244:247], a[160:163], a[52:55], v[244:247]
    ds_read_b32 a196, v10
    v_mfma_f32_16x16x32_bf16 v[248:251], a[32:35], a[60:63], v[248:251]
    ds_read_b32 a186, v11
    v_perm_b32 v12, v125, v35, s39
    v_mfma_f32_16x16x32_bf16 v[248:251], a[160:163], a[68:71], v[248:251]
    v_mfma_f32_16x16x32_bf16 v[252:255], a[32:35], a[164:167], v[252:255]
    ds_read_b32 a187, v12
    v_perm_b32 v13, v65, v35, s36
    v_mfma_f32_16x16x32_bf16 v[252:255], a[160:163], a[144:147], v[252:255]
    s_waitcnt lgkmcnt(5)
    s_barrier
    v_mfma_f32_16x16x32_bf16 v[128:131], a[80:83], a[64:67], v[128:131]
    ds_read_b32 a212, v13
    v_perm_b32 v14, v65, v35, s37
    v_mfma_f32_16x16x32_bf16 v[128:131], a[180:183], a[200:203], v[128:131]
    ds_read_b128 a[76:79], v40 offset:0
    v_perm_b32 v15, v97, v35, s37
    v_mfma_f32_16x16x32_bf16 v[132:135], a[80:83], a[224:227], v[132:135]
    ds_read_b32 a213, v14
    v_perm_b32 v56, v65, v35, s38
    v_mfma_f32_16x16x32_bf16 v[132:135], a[180:183], a[112:115], v[132:135]
    s_add_u32 s56, s55, 1792
    ds_read_b128 a[220:223], v41 offset:0
    ds_read_b32 a197, v15
    v_mfma_f32_16x16x32_bf16 v[136:139], a[80:83], a[116:119], v[136:139]
    s_add_u32 m0, s57, 65536
    ds_read_b32 a214, v56
    v_perm_b32 v57, v65, v35, s39
    v_mfma_f32_16x16x32_bf16 v[136:139], a[180:183], a[16:19], v[136:139]
    buffer_load_dwordx4 v36, s[8:11], s56 offen offset:0 lds
    v_mfma_f32_16x16x32_bf16 v[140:143], a[80:83], a[236:239], v[140:143]
    ds_read_b32 a215, v57
    v_perm_b32 v58, v126, v35, s36
    v_mfma_f32_16x16x32_bf16 v[140:143], a[180:183], a[248:251], v[140:143]
    ds_read_b128 a[128:131], v40 offset:2048
    v_perm_b32 v59, v97, v35, s38
    v_mfma_f32_16x16x32_bf16 v[144:147], a[80:83], a[132:135], v[144:147]
    ds_read_b32 a124, v58
    v_perm_b32 v60, v126, v35, s37
    v_mfma_f32_16x16x32_bf16 v[144:147], a[180:183], a[140:143], v[144:147]
    ds_read_b128 a[40:43], v41 offset:2048
    ds_read_b32 a198, v59
    v_mfma_f32_16x16x32_bf16 v[148:151], a[80:83], a[148:151], v[148:151]
    ds_read_b32 a125, v60
    v_perm_b32 v61, v126, v35, s38
    v_mfma_f32_16x16x32_bf16 v[148:151], a[180:183], a[216:219], v[148:151]
    buffer_load_dwordx4 v37, s[8:11], s56 offen offset:1024 lds
    v_mfma_f32_16x16x32_bf16 v[152:155], a[80:83], a[0:3], v[152:155]
    ds_read_b32 a126, v61
    v_perm_b32 v62, v126, v35, s39
    v_mfma_f32_16x16x32_bf16 v[152:155], a[180:183], a[20:23], v[152:155]
    ds_read_b128 a[104:107], v40 offset:4096
    v_perm_b32 v63, v97, v35, s39
    v_mfma_f32_16x16x32_bf16 v[156:159], a[80:83], a[108:111], v[156:159]
    ds_read_b32 a127, v62
    v_perm_b32 v8, v66, v35, s36
    v_mfma_f32_16x16x32_bf16 v[156:159], a[180:183], a[8:11], v[156:159]
    s_waitcnt lgkmcnt(8)
    ds_read_b128 a[204:207], v41 offset:4096
    ds_read_b32 a199, v63
    v_mfma_f32_16x16x32_bf16 v[160:163], a[184:187], a[64:67], v[160:163]
    ds_read_b32 a84, v8
    v_perm_b32 v9, v66, v35, s37
    v_mfma_f32_16x16x32_bf16 v[160:163], a[212:215], a[200:203], v[160:163]
    buffer_load_dwordx4 v38, s[8:11], s56 offen offset:2048 lds
    v_mfma_f32_16x16x32_bf16 v[164:167], a[184:187], a[224:227], v[164:167]
    ds_read_b32 a85, v9
    v_perm_b32 v10, v66, v35, s38
    v_mfma_f32_16x16x32_bf16 v[164:167], a[212:215], a[112:115], v[164:167]
    ds_read_b128 a[208:211], v40 offset:6144
    v_perm_b32 v11, v109, v35, s36
    v_mfma_f32_16x16x32_bf16 v[168:171], a[184:187], a[116:119], v[168:171]
    ds_read_b32 a86, v10
    v_perm_b32 v12, v66, v35, s39
    v_mfma_f32_16x16x32_bf16 v[168:171], a[212:215], a[16:19], v[168:171]
    ds_read_b128 a[48:51], v41 offset:6144
    ds_read_b32 a136, v11
    v_mfma_f32_16x16x32_bf16 v[172:175], a[184:187], a[236:239], v[172:175]
    s_waitcnt vmcnt(16)
    ds_read_b32 a87, v12
    v_perm_b32 v13, v72, v35, s36
    v_mfma_f32_16x16x32_bf16 v[172:175], a[212:215], a[248:251], v[172:175]
    buffer_load_dwordx4 v39, s[8:11], s56 offen offset:3072 lds
    v_mfma_f32_16x16x32_bf16 v[176:179], a[184:187], a[132:135], v[176:179]
    ds_read_b32 a172, v13
    v_perm_b32 v14, v72, v35, s37
    v_mfma_f32_16x16x32_bf16 v[176:179], a[212:215], a[140:143], v[176:179]
    ds_read_b128 a[44:47], v40 offset:8192
    v_perm_b32 v15, v109, v35, s37
    v_mfma_f32_16x16x32_bf16 v[180:183], a[184:187], a[148:151], v[180:183]
    ds_read_b32 a173, v14
    v_perm_b32 v56, v72, v35, s38
    v_mfma_f32_16x16x32_bf16 v[180:183], a[212:215], a[216:219], v[180:183]
    s_add_u32 s56, s55, 1920
    ds_read_b128 a[92:95], v41 offset:8192
    ds_read_b32 a137, v15
    v_mfma_f32_16x16x32_bf16 v[184:187], a[184:187], a[0:3], v[184:187]
    s_add_u32 m0, s57, 83968
    ds_read_b32 a174, v56
    v_perm_b32 v57, v72, v35, s39
    v_mfma_f32_16x16x32_bf16 v[184:187], a[212:215], a[20:23], v[184:187]
    buffer_load_dwordx4 v36, s[8:11], s56 offen offset:0 lds
    v_mfma_f32_16x16x32_bf16 v[188:191], a[184:187], a[108:111], v[188:191]
    s_waitcnt vmcnt(16)
    ds_read_b32 a175, v57
    v_perm_b32 v58, v76, v35, s36
    v_mfma_f32_16x16x32_bf16 v[188:191], a[212:215], a[8:11], v[188:191]
    s_waitcnt lgkmcnt(7)
    ds_read_b128 a[152:155], v40 offset:10240
    v_mfma_f32_16x16x32_bf16 v[192:195], a[124:127], a[64:67], v[192:195]
    ds_read_b32 a176, v58
    v_perm_b32 v59, v76, v35, s37
    v_mfma_f32_16x16x32_bf16 v[192:195], a[84:87], a[200:203], v[192:195]
    ds_read_b128 a[96:99], v41 offset:10240
    v_mfma_f32_16x16x32_bf16 v[196:199], a[124:127], a[224:227], v[196:199]
    ds_read_b32 a177, v59
    v_perm_b32 v60, v76, v35, s38
    v_mfma_f32_16x16x32_bf16 v[196:199], a[84:87], a[112:115], v[196:199]
    buffer_load_dwordx4 v37, s[8:11], s56 offen offset:1024 lds
    v_perm_b32 v61, v109, v35, s38
    v_mfma_f32_16x16x32_bf16 v[200:203], a[124:127], a[116:119], v[200:203]
    ds_read_b32 a178, v60
    ds_read_b32 a138, v61
    v_mfma_f32_16x16x32_bf16 v[200:203], a[84:87], a[16:19], v[200:203]
    ds_read_b128 a[188:191], v40 offset:12288
    v_perm_b32 v62, v76, v35, s39
    v_mfma_f32_16x16x32_bf16 v[204:207], a[124:127], a[236:239], v[204:207]
    ds_read_b32 a179, v62
    v_perm_b32 v63, v73, v35, s36
    v_mfma_f32_16x16x32_bf16 v[204:207], a[84:87], a[248:251], v[204:207]
    ds_read_b128 a[252:255], v41 offset:12288
    v_mfma_f32_16x16x32_bf16 v[208:211], a[124:127], a[132:135], v[208:211]
    s_add_u32 m0, s57, 79872
    ds_read_b32 a24, v63
    v_perm_b32 v8, v73, v35, s37
    v_mfma_f32_16x16x32_bf16 v[208:211], a[84:87], a[140:143], v[208:211]
    buffer_load_dwordx4 v38, s[8:11], s56 offen offset:2048 lds
    v_perm_b32 v9, v109, v35, s39
    v_mfma_f32_16x16x32_bf16 v[212:215], a[124:127], a[148:151], v[212:215]
    ds_read_b32 a25, v8
    ds_read_b32 a139, v9
    v_mfma_f32_16x16x32_bf16 v[212:215], a[84:87], a[216:219], v[212:215]
    ds_read_b128 a[52:55], v40 offset:14336
    v_perm_b32 v10, v73, v35, s38
    v_mfma_f32_16x16x32_bf16 v[216:219], a[124:127], a[0:3], v[216:219]
    ds_read_b32 a26, v10
    v_perm_b32 v11, v73, v35, s39
    v_mfma_f32_16x16x32_bf16 v[216:219], a[84:87], a[20:23], v[216:219]
    ds_read_b128 a[60:63], v41 offset:14336
    v_mfma_f32_16x16x32_bf16 v[220:223], a[124:127], a[108:111], v[220:223]
    ds_read_b32 a27, v11
    v_perm_b32 v12, v77, v35, s36
    v_mfma_f32_16x16x32_bf16 v[220:223], a[84:87], a[8:11], v[220:223]
    s_waitcnt lgkmcnt(8)
    buffer_load_dwordx4 v39, s[8:11], s56 offen offset:3072 lds
    v_perm_b32 v13, v81, v35, s36
    v_mfma_f32_16x16x32_bf16 v[128:131], a[172:175], a[76:79], v[128:131]
    ds_read_b32 a68, v12
    ds_read_b32 a164, v13
    v_mfma_f32_16x16x32_bf16 v[128:131], a[176:179], a[220:223], v[128:131]
    ds_read_b128 a[32:35], v42 offset:2048
    v_perm_b32 v14, v77, v35, s37
    v_mfma_f32_16x16x32_bf16 v[132:135], a[172:175], a[128:131], v[132:135]
    ds_read_b32 a69, v14
    v_perm_b32 v15, v77, v35, s38
    v_mfma_f32_16x16x32_bf16 v[132:135], a[176:179], a[40:43], v[132:135]
    ds_read_b128 a[144:147], v43 offset:2048
    v_perm_b32 v56, v81, v35, s37
    v_mfma_f32_16x16x32_bf16 v[136:139], a[172:175], a[104:107], v[136:139]
    ds_read_b32 a70, v15
    v_perm_b32 v57, v77, v35, s39
    v_mfma_f32_16x16x32_bf16 v[136:139], a[176:179], a[204:207], v[136:139]
    ds_read_b32 a165, v56
    v_mfma_f32_16x16x32_bf16 v[140:143], a[172:175], a[208:211], v[140:143]
    ds_read_b32 a71, v57
    v_perm_b32 v58, v74, v35, s36
    v_mfma_f32_16x16x32_bf16 v[140:143], a[176:179], a[48:51], v[140:143]
    ds_read_b128 a[160:163], v42 offset:0
    v_mfma_f32_16x16x32_bf16 v[144:147], a[172:175], a[44:47], v[144:147]
    ds_read_b32 a80, v58
    v_perm_b32 v59, v74, v35, s37
    v_mfma_f32_16x16x32_bf16 v[144:147], a[176:179], a[92:95], v[144:147]
    ds_read_b128 a[180:183], v43 offset:0
    v_perm_b32 v60, v81, v35, s38
    v_mfma_f32_16x16x32_bf16 v[148:151], a[172:175], a[152:155], v[148:151]
    ds_read_b32 a81, v59
    v_perm_b32 v61, v74, v35, s38
    v_mfma_f32_16x16x32_bf16 v[148:151], a[176:179], a[96:99], v[148:151]
    ds_read_b32 a166, v60
    v_mfma_f32_16x16x32_bf16 v[152:155], a[172:175], a[188:191], v[152:155]
    s_waitcnt lgkmcnt(8)
    ds_read_b32 a82, v61
    v_perm_b32 v62, v74, v35, s39
    v_mfma_f32_16x16x32_bf16 v[152:155], a[176:179], a[252:255], v[152:155]
    ds_read_b128 a[184:187], v42 offset:6144
    v_mfma_f32_16x16x32_bf16 v[156:159], a[172:175], a[52:55], v[156:159]
    ds_read_b32 a83, v62
    v_perm_b32 v63, v78, v35, s36
    v_mfma_f32_16x16x32_bf16 v[156:159], a[176:179], a[60:63], v[156:159]
    ds_read_b128 a[212:215], v43 offset:6144
    v_perm_b32 v8, v81, v35, s39
    v_mfma_f32_16x16x32_bf16 v[160:163], a[24:27], a[76:79], v[160:163]
    s_waitcnt lgkmcnt(8)
    ds_read_b32 a64, v63
    v_perm_b32 v9, v78, v35, s37
    v_mfma_f32_16x16x32_bf16 v[160:163], a[68:71], a[220:223], v[160:163]
    ds_read_b32 a167, v8
    v_mfma_f32_16x16x32_bf16 v[164:167], a[24:27], a[128:131], v[164:167]
    ds_read_b32 a65, v9
    v_perm_b32 v10, v78, v35, s38
    v_mfma_f32_16x16x32_bf16 v[164:167], a[68:71], a[40:43], v[164:167]
    ds_read_b128 a[200:203], v42 offset:4096
    v_mfma_f32_16x16x32_bf16 v[168:171], a[24:27], a[104:107], v[168:171]
    ds_read_b32 a66, v10
    v_perm_b32 v11, v78, v35, s39
    v_mfma_f32_16x16x32_bf16 v[168:171], a[68:71], a[204:207], v[168:171]
    ds_read_b128 a[224:227], v43 offset:4096
    v_mfma_f32_16x16x32_bf16 v[172:175], a[24:27], a[208:211], v[172:175]
    ds_read_b32 a67, v11
    v_perm_b32 v12, v75, v35, s36
    v_mfma_f32_16x16x32_bf16 v[172:175], a[68:71], a[48:51], v[172:175]
    v_perm_b32 v13, v101, v35, s36
    v_mfma_f32_16x16x32_bf16 v[176:179], a[24:27], a[44:47], v[176:179]
    ds_read_b32 a112, v12
    v_perm_b32 v14, v75, v35, s37
    v_mfma_f32_16x16x32_bf16 v[176:179], a[68:71], a[92:95], v[176:179]
    ds_read_b128 a[116:119], v42 offset:10240
    ds_read_b32 a16, v13
    v_mfma_f32_16x16x32_bf16 v[180:183], a[24:27], a[152:155], v[180:183]
    ds_read_b32 a113, v14
    v_perm_b32 v15, v75, v35, s38
    v_mfma_f32_16x16x32_bf16 v[180:183], a[68:71], a[96:99], v[180:183]
    ds_read_b128 a[236:239], v43 offset:10240
    v_mfma_f32_16x16x32_bf16 v[184:187], a[24:27], a[188:191], v[184:187]
    ds_read_b32 a114, v15
    v_perm_b32 v56, v75, v35, s39
    v_mfma_f32_16x16x32_bf16 v[184:187], a[68:71], a[252:255], v[184:187]
    v_perm_b32 v57, v101, v35, s37
    v_mfma_f32_16x16x32_bf16 v[188:191], a[24:27], a[52:55], v[188:191]
    s_waitcnt vmcnt(18)
    ds_read_b32 a115, v56
    v_perm_b32 v58, v79, v35, s36
    v_mfma_f32_16x16x32_bf16 v[188:191], a[68:71], a[60:63], v[188:191]
    s_waitcnt lgkmcnt(7)
    ds_read_b128 a[248:251], v42 offset:8192
    ds_read_b32 a17, v57
    v_mfma_f32_16x16x32_bf16 v[192:195], a[80:83], a[76:79], v[192:195]
    ds_read_b32 a132, v58
    v_perm_b32 v59, v79, v35, s37
    v_mfma_f32_16x16x32_bf16 v[192:195], a[64:67], a[220:223], v[192:195]
    ds_read_b128 a[140:143], v43 offset:8192
    v_mfma_f32_16x16x32_bf16 v[196:199], a[80:83], a[128:131], v[196:199]
    ds_read_b32 a133, v59
    v_perm_b32 v60, v79, v35, s38
    v_mfma_f32_16x16x32_bf16 v[196:199], a[64:67], a[40:43], v[196:199]
    v_perm_b32 v61, v101, v35, s38
    v_mfma_f32_16x16x32_bf16 v[200:203], a[80:83], a[104:107], v[200:203]
    ds_read_b32 a134, v60
    v_perm_b32 v62, v79, v35, s39
    v_mfma_f32_16x16x32_bf16 v[200:203], a[64:67], a[204:207], v[200:203]
    ds_read_b128 a[148:151], v42 offset:14336
    ds_read_b32 a18, v61
    v_mfma_f32_16x16x32_bf16 v[204:207], a[80:83], a[208:211], v[204:207]
    s_waitcnt vmcnt(9)
    ds_read_b32 a135, v62
    v_perm_b32 v63, v84, v35, s36
    v_mfma_f32_16x16x32_bf16 v[204:207], a[64:67], a[48:51], v[204:207]
    ds_read_b128 a[216:219], v43 offset:14336
    v_mfma_f32_16x16x32_bf16 v[208:211], a[80:83], a[44:47], v[208:211]
    ds_read_b32 a0, v63
    v_perm_b32 v8, v84, v35, s37
    v_mfma_f32_16x16x32_bf16 v[208:211], a[64:67], a[92:95], v[208:211]
    v_perm_b32 v9, v101, v35, s39
    v_mfma_f32_16x16x32_bf16 v[212:215], a[80:83], a[152:155], v[212:215]
    ds_read_b32 a1, v8
    v_perm_b32 v10, v84, v35, s38
    v_mfma_f32_16x16x32_bf16 v[212:215], a[64:67], a[96:99], v[212:215]
    ds_read_b128 a[20:23], v42 offset:12288
    ds_read_b32 a19, v9
    v_mfma_f32_16x16x32_bf16 v[216:219], a[80:83], a[188:191], v[216:219]
    ds_read_b32 a2, v10
    v_perm_b32 v11, v84, v35, s39
    v_mfma_f32_16x16x32_bf16 v[216:219], a[64:67], a[252:255], v[216:219]
    ds_read_b128 a[108:111], v43 offset:12288
    v_mfma_f32_16x16x32_bf16 v[220:223], a[80:83], a[52:55], v[220:223]
    s_waitcnt vmcnt(8)
    ds_read_b32 a3, v11
    v_perm_b32 v12, v104, v35, s36
    v_mfma_f32_16x16x32_bf16 v[220:223], a[64:67], a[60:63], v[220:223]
    s_waitcnt lgkmcnt(8)
    v_perm_b32 v13, v90, v35, s36
    v_mfma_f32_16x16x32_bf16 v[224:227], a[112:115], a[76:79], v[224:227]
    ds_read_b32 a124, v12
    v_perm_b32 v14, v104, v35, s37
    v_mfma_f32_16x16x32_bf16 v[224:227], a[132:135], a[220:223], v[224:227]
    ds_read_b32 a8, v13
    v_mfma_f32_16x16x32_bf16 v[228:231], a[112:115], a[128:131], v[228:231]
    ds_read_b32 a125, v14
    v_perm_b32 v15, v104, v35, s38
    v_mfma_f32_16x16x32_bf16 v[228:231], a[132:135], a[40:43], v[228:231]
    v_mfma_f32_16x16x32_bf16 v[232:235], a[112:115], a[104:107], v[232:235]
    s_mov_b32 s3, 0
    ds_read_b32 a126, v15
    v_perm_b32 v56, v104, v35, s39
    v_mfma_f32_16x16x32_bf16 v[232:235], a[132:135], a[204:207], v[232:235]
    v_mfma_f32_16x16x32_bf16 v[236:239], a[112:115], a[208:211], v[236:239]
    ds_read_b32 a127, v56
    v_perm_b32 v57, v85, v35, s36
    v_mfma_f32_16x16x32_bf16 v[236:239], a[132:135], a[48:51], v[236:239]
    s_mov_b32 s4, 14336
    v_perm_b32 v58, v90, v35, s37
    v_mfma_f32_16x16x32_bf16 v[240:243], a[112:115], a[44:47], v[240:243]
    ds_read_b32 a84, v57
    v_perm_b32 v59, v85, v35, s37
    v_mfma_f32_16x16x32_bf16 v[240:243], a[132:135], a[92:95], v[240:243]
    ds_read_b32 a9, v58
    v_mfma_f32_16x16x32_bf16 v[244:247], a[112:115], a[152:155], v[244:247]
    s_mov_b32 s5, 28672
    ds_read_b32 a85, v59
    v_perm_b32 v60, v85, v35, s38
    v_mfma_f32_16x16x32_bf16 v[244:247], a[132:135], a[96:99], v[244:247]
    v_mfma_f32_16x16x32_bf16 v[248:251], a[112:115], a[188:191], v[248:251]
    ds_read_b32 a86, v60
    v_perm_b32 v61, v85, v35, s39
    v_mfma_f32_16x16x32_bf16 v[248:251], a[132:135], a[252:255], v[248:251]
    s_mov_b32 s6, 43008
    v_perm_b32 v62, v90, v35, s38
    v_mfma_f32_16x16x32_bf16 v[252:255], a[112:115], a[52:55], v[252:255]
    ds_read_b32 a87, v61
    v_perm_b32 v63, v105, v35, s36
    v_mfma_f32_16x16x32_bf16 v[252:255], a[132:135], a[60:63], v[252:255]
    s_waitcnt lgkmcnt(5)
    s_barrier
    ds_read_b32 a10, v62
    v_mfma_f32_16x16x32_bf16 v[128:131], a[0:3], a[32:35], v[128:131]
    s_mov_b32 s7, 229376
    ds_read_b32 a172, v63
    v_perm_b32 v8, v105, v35, s37
    v_mfma_f32_16x16x32_bf16 v[128:131], a[124:127], a[144:147], v[128:131]
    ds_read_b128 a[176:179], v40 offset:34816
    v_mfma_f32_16x16x32_bf16 v[132:135], a[0:3], a[160:163], v[132:135]
    ds_read_b32 a173, v8
    v_perm_b32 v9, v105, v35, s38
    v_mfma_f32_16x16x32_bf16 v[132:135], a[124:127], a[180:183], v[132:135]
    s_mov_b32 s24, 243712
    ds_read_b128 a[24:27], v41 offset:34816
    v_perm_b32 v10, v90, v35, s39
    v_mfma_f32_16x16x32_bf16 v[136:139], a[0:3], a[184:187], v[136:139]
    ds_read_b32 a174, v9
    v_perm_b32 v11, v105, v35, s39
    v_mfma_f32_16x16x32_bf16 v[136:139], a[124:127], a[212:215], v[136:139]
    ds_read_b32 a11, v10
    v_mfma_f32_16x16x32_bf16 v[140:143], a[0:3], a[200:203], v[140:143]
    s_mov_b32 s25, 258048
    ds_read_b32 a175, v11
    v_perm_b32 v12, v86, v35, s36
    v_mfma_f32_16x16x32_bf16 v[140:143], a[124:127], a[224:227], v[140:143]
    ds_read_b128 a[68:71], v42 offset:32768
    v_mfma_f32_16x16x32_bf16 v[144:147], a[0:3], a[116:119], v[144:147]
    ds_read_b32 a80, v12
    v_perm_b32 v13, v86, v35, s37
    v_mfma_f32_16x16x32_bf16 v[144:147], a[124:127], a[236:239], v[144:147]
    s_mov_b32 s26, 272384
    ds_read_b128 a[64:67], v43 offset:32768
    v_perm_b32 v14, v94, v35, s36
    v_mfma_f32_16x16x32_bf16 v[148:151], a[0:3], a[248:251], v[148:151]
    ds_read_b32 a81, v13
    v_perm_b32 v15, v86, v35, s38
    v_mfma_f32_16x16x32_bf16 v[148:151], a[124:127], a[140:143], v[148:151]
    ds_read_b32 a76, v14
    v_mfma_f32_16x16x32_bf16 v[152:155], a[0:3], a[148:151], v[152:155]
    s_mov_b32 s27, 458752
    ds_read_b32 a82, v15
    v_perm_b32 v56, v86, v35, s39
    v_mfma_f32_16x16x32_bf16 v[152:155], a[124:127], a[216:219], v[152:155]
    ds_read_b128 a[220:223], v40 offset:32768
    v_mfma_f32_16x16x32_bf16 v[156:159], a[0:3], a[20:23], v[156:159]
    s_waitcnt lgkmcnt(8)
    ds_read_b32 a83, v56
    v_perm_b32 v57, v106, v35, s36
    v_mfma_f32_16x16x32_bf16 v[156:159], a[124:127], a[108:111], v[156:159]
    s_mov_b32 s48, 473088
    ds_read_b128 a[128:131], v41 offset:32768
    v_perm_b32 v58, v94, v35, s37
    v_mfma_f32_16x16x32_bf16 v[160:163], a[84:87], a[32:35], v[160:163]
    s_waitcnt lgkmcnt(8)
    ds_read_b32 a40, v57
    v_perm_b32 v59, v106, v35, s37
    v_mfma_f32_16x16x32_bf16 v[160:163], a[172:175], a[144:147], v[160:163]
    ds_read_b32 a77, v58
    v_mfma_f32_16x16x32_bf16 v[164:167], a[84:87], a[160:163], v[164:167]
    s_mov_b32 s49, 487424
    ds_read_b32 a41, v59
    v_perm_b32 v60, v106, v35, s38
    v_mfma_f32_16x16x32_bf16 v[164:167], a[172:175], a[180:183], v[164:167]
    ds_read_b128 a[104:107], v42 offset:34816
    v_mfma_f32_16x16x32_bf16 v[168:171], a[84:87], a[184:187], v[168:171]
    ds_read_b32 a42, v60
    v_perm_b32 v61, v106, v35, s39
    v_mfma_f32_16x16x32_bf16 v[168:171], a[172:175], a[212:215], v[168:171]
    s_mov_b32 s50, 501760
    ds_read_b128 a[204:207], v43 offset:34816
    v_mfma_f32_16x16x32_bf16 v[172:175], a[84:87], a[200:203], v[172:175]
    ds_read_b32 a43, v61
    v_perm_b32 v62, v94, v35, s38
    v_mfma_f32_16x16x32_bf16 v[172:175], a[172:175], a[224:227], v[172:175]
    s_waitcnt vmcnt(0)
    v_mfma_f32_16x16x32_bf16 v[176:179], a[84:87], a[116:119], v[176:179]
    s_barrier
    ds_read_b32 a78, v62
    v_perm_b32 v63, v94, v35, s39
    v_mfma_f32_16x16x32_bf16 v[176:179], a[172:175], a[236:239], v[176:179]
    s_mov_b32 s51, 688128
    ds_read_b128 a[208:211], v44 offset:2048
    ds_read_b32 a79, v63
    v_mfma_f32_16x16x32_bf16 v[180:183], a[84:87], a[248:251], v[180:183]
    v_perm_b32 v8, v122, v35, s36
    v_perm_b32 v9, v122, v35, s37
    v_mfma_f32_16x16x32_bf16 v[180:183], a[172:175], a[140:143], v[180:183]
    s_mov_b32 s52, 702464
    ds_read_b128 a[48:51], v45 offset:2048
    ds_read_b32 a44, v8
    v_mfma_f32_16x16x32_bf16 v[184:187], a[84:87], a[148:151], v[184:187]
    ds_read_b32 a45, v9
    v_perm_b32 v10, v122, v35, s38
    v_mfma_f32_16x16x32_bf16 v[184:187], a[172:175], a[216:219], v[184:187]
    v_lshlrev_b32 v112, 16, v48
    v_mfma_f32_16x16x32_bf16 v[188:191], a[84:87], a[20:23], v[188:191]
    s_mov_b32 s53, 716800
    ds_read_b32 a46, v10
    v_perm_b32 v11, v122, v35, s39
    v_mfma_f32_16x16x32_bf16 v[188:191], a[172:175], a[108:111], v[188:191]
    s_waitcnt lgkmcnt(7)
    ds_read_b128 a[92:95], v46 offset:0
    ds_read_b32 a47, v11
    v_mfma_f32_16x16x32_bf16 v[192:195], a[80:83], a[32:35], v[192:195]
    v_perm_b32 v12, v70, v35, s36
    v_perm_b32 v13, v70, v35, s37
    v_mfma_f32_16x16x32_bf16 v[192:195], a[40:43], a[144:147], v[192:195]
    s_mov_b32 s54, 731136
    ds_read_b128 a[152:155], v47 offset:0
    ds_read_b32 a96, v12
    v_mfma_f32_16x16x32_bf16 v[196:199], a[80:83], a[160:163], v[196:199]
    ds_read_b32 a97, v13
    v_perm_b32 v14, v70, v35, s38
    v_mfma_f32_16x16x32_bf16 v[196:199], a[40:43], a[180:183], v[196:199]
    v_and_b32 v113, 0xffff0000, v49
    v_lshlrev_b32 v114, 16, v51
    v_mfma_f32_16x16x32_bf16 v[200:203], a[80:83], a[184:187], v[200:203]
    ds_read_b32 a98, v14
    v_perm_b32 v15, v70, v35, s39
    v_mfma_f32_16x16x32_bf16 v[200:203], a[40:43], a[212:215], v[200:203]
    ds_read_b128 a[188:191], v44 offset:0
    ds_read_b32 a99, v15
    v_mfma_f32_16x16x32_bf16 v[204:207], a[80:83], a[200:203], v[204:207]
    v_perm_b32 v56, v98, v35, s36
    v_perm_b32 v57, v98, v35, s37
    v_mfma_f32_16x16x32_bf16 v[204:207], a[40:43], a[224:227], v[204:207]
    ds_read_b128 a[252:255], v45 offset:0
    ds_read_b32 a52, v56
    v_mfma_f32_16x16x32_bf16 v[208:211], a[80:83], a[116:119], v[208:211]
    ds_read_b32 a53, v57
    v_perm_b32 v58, v98, v35, s38
    v_mfma_f32_16x16x32_bf16 v[208:211], a[40:43], a[236:239], v[208:211]
    v_and_b32 v115, 0xffff0000, v52
    v_and_b32 v116, 0xffff0000, v48
    v_mfma_f32_16x16x32_bf16 v[212:215], a[80:83], a[248:251], v[212:215]
    ds_read_b32 a54, v58
    v_perm_b32 v59, v98, v35, s39
    v_mfma_f32_16x16x32_bf16 v[212:215], a[40:43], a[140:143], v[212:215]
    ds_read_b128 a[112:115], v46 offset:2048
    ds_read_b32 a55, v59
    v_mfma_f32_16x16x32_bf16 v[216:219], a[80:83], a[148:151], v[216:219]
    v_perm_b32 v60, v110, v35, s36
    v_perm_b32 v61, v110, v35, s37
    v_mfma_f32_16x16x32_bf16 v[216:219], a[40:43], a[216:219], v[216:219]
    ds_read_b128 a[60:63], v47 offset:2048
    ds_read_b32 a132, v60
    v_mfma_f32_16x16x32_bf16 v[220:223], a[80:83], a[20:23], v[220:223]
    ds_read_b32 a133, v61
    v_perm_b32 v62, v110, v35, s38
    v_mfma_f32_16x16x32_bf16 v[220:223], a[40:43], a[108:111], v[220:223]
    v_lshlrev_b32 v117, 16, v50
    v_and_b32 v118, 0xffff0000, v51
    v_mfma_f32_16x16x32_bf16 v[228:231], a[244:247], a[176:179], v[228:231]
    ds_read_b32 a134, v62
    v_perm_b32 v63, v110, v35, s39
    v_mfma_f32_16x16x32_bf16 v[228:231], a[12:15], a[24:27], v[228:231]
    s_waitcnt lgkmcnt(7)
    ds_read_b32 a135, v63
    v_perm_b32 v8, v82, v35, s36
    v_mfma_f32_16x16x32_bf16 v[228:231], a[72:75], a[208:211], v[228:231]
    ds_read_b128 a[0:3], v40 offset:38912
    v_perm_b32 v9, v82, v35, s37
    v_mfma_f32_16x16x32_bf16 v[228:231], a[88:91], a[48:51], v[228:231]
    ds_read_b32 a124, v8
    v_lshlrev_b32 v119, 16, v53
    v_mfma_f32_16x16x32_bf16 v[132:135], a[156:159], a[176:179], v[132:135]
    ds_read_b32 a125, v9
    v_perm_b32 v10, v82, v35, s38
    v_mfma_f32_16x16x32_bf16 v[132:135], a[192:195], a[24:27], v[132:135]
    v_perm_b32 v11, v82, v35, s39
    v_lshlrev_b32 v124, 16, v49
    v_mfma_f32_16x16x32_bf16 v[132:135], a[36:39], a[68:71], v[132:135]
    ds_read_b128 a[84:87], v41 offset:38912
    ds_read_b32 a126, v10
    v_mfma_f32_16x16x32_bf16 v[132:135], a[4:7], a[64:67], v[132:135]
    ds_read_b32 a127, v11
    v_perm_b32 v12, v102, v35, s36
    v_mfma_f32_16x16x32_bf16 v[132:135], a[120:123], a[208:211], v[132:135]
    v_perm_b32 v13, v102, v35, s37
    v_and_b32 v125, 0xffff0000, v50
    v_mfma_f32_16x16x32_bf16 v[132:135], a[100:103], a[48:51], v[132:135]
    ds_read_b128 a[172:175], v44 offset:6144
    ds_read_b32 a32, v12
    v_mfma_f32_16x16x32_bf16 v[132:135], a[240:243], a[92:95], v[132:135]
    ds_read_b32 a33, v13
    v_perm_b32 v14, v102, v35, s38
    v_mfma_f32_16x16x32_bf16 v[132:135], a[228:231], a[152:155], v[132:135]
    v_lshlrev_b32 v126, 16, v52
    v_and_b32 v127, 0xffff0000, v53
    v_mfma_f32_16x16x32_bf16 v[164:167], a[168:171], a[176:179], v[164:167]
    ds_read_b32 a34, v14
    v_perm_b32 v15, v102, v35, s39
    v_mfma_f32_16x16x32_bf16 v[164:167], a[28:31], a[24:27], v[164:167]
    ds_read_b128 a[144:147], v45 offset:6144
    ds_read_b32 a35, v15
    v_mfma_f32_16x16x32_bf16 v[164:167], a[56:59], a[68:71], v[164:167]
    v_lshlrev_b32 v64, 16, v54
    v_and_b32 v65, 0xffff0000, v54
    v_mfma_f32_16x16x32_bf16 v[164:167], a[232:235], a[64:67], v[164:167]
    v_lshlrev_b32 v66, 16, v55
    v_and_b32 v67, 0xffff0000, v55
    v_mfma_f32_16x16x32_bf16 v[164:167], a[196:199], a[208:211], v[164:167]
    ds_read_b128 a[160:163], v42 offset:36864
    v_mul_f32 v132, v132, v112
    v_mfma_f32_16x16x32_bf16 v[164:167], a[136:139], a[48:51], v[164:167]
    ds_write_b128 v29, v[228:231] offset:0
    v_mul_f32 v133, v133, v113
    v_mfma_f32_16x16x32_bf16 v[164:167], a[164:167], a[92:95], v[164:167]
    v_mul_f32 v134, v134, v114
    v_mul_f32 v135, v135, v115
    v_mfma_f32_16x16x32_bf16 v[164:167], a[16:19], a[152:155], v[164:167]
    v_mfma_f32_16x16x32_bf16 v[196:199], a[8:11], a[176:179], v[196:199]
    ds_read_b128 a[180:183], v43 offset:36864
    v_mfma_f32_16x16x32_bf16 v[196:199], a[76:79], a[24:27], v[196:199]
    v_mfma_f32_16x16x32_bf16 v[196:199], a[44:47], a[68:71], v[196:199]
    s_waitcnt lgkmcnt(1)
    s_barrier
    v_mfma_f32_16x16x32_bf16 v[196:199], a[96:99], a[64:67], v[196:199]
    ds_read_b128 a[184:187], v46 offset:4096
    v_mul_f32 v164, v164, v116
    v_mfma_f32_16x16x32_bf16 v[196:199], a[52:55], a[208:211], v[196:199]
    ds_read_b128 v[72:75], v30 offset:0
    v_mul_f32 v165, v165, v117
    v_mfma_f32_16x16x32_bf16 v[196:199], a[132:135], a[48:51], v[196:199]
    v_mul_f32 v166, v166, v118
    v_mul_f32 v167, v167, v119
    v_mfma_f32_16x16x32_bf16 v[196:199], a[124:127], a[92:95], v[196:199]
    v_mfma_f32_16x16x32_bf16 v[196:199], a[32:35], a[152:155], v[196:199]
    ds_read_b128 a[212:215], v47 offset:4096
    v_mfma_f32_16x16x32_bf16 v[224:227], a[244:247], a[220:223], v[224:227]
    v_mfma_f32_16x16x32_bf16 v[224:227], a[12:15], a[128:131], v[224:227]
    v_mfma_f32_16x16x32_bf16 v[224:227], a[72:75], a[188:191], v[224:227]
    ds_read_b128 a[200:203], v40 offset:36864
    v_mfma_f32_16x16x32_bf16 v[224:227], a[88:91], a[252:255], v[224:227]
    v_mul_f32 v196, v196, v124
    v_mul_f32 v197, v197, v125
    v_mfma_f32_16x16x32_bf16 v[128:131], a[156:159], a[220:223], v[128:131]
    v_mul_f32 v198, v198, v126
    v_mul_f32 v199, v199, v127
    v_mfma_f32_16x16x32_bf16 v[128:131], a[192:195], a[128:131], v[128:131]
    v_cvt_pk_bf16_f32 v76, v132, v164
    v_cvt_pk_bf16_f32 v77, v196, v133
    v_mfma_f32_16x16x32_bf16 v[128:131], a[36:39], a[104:107], v[128:131]
    ds_read_b128 a[224:227], v41 offset:36864
    v_cvt_pk_bf16_f32 v78, v165, v197
    v_mfma_f32_16x16x32_bf16 v[128:131], a[4:7], a[204:207], v[128:131]
    ds_write_b64 v27, v[76:77] offset:0
    v_cvt_pk_bf16_f32 v79, v134, v166
    v_mfma_f32_16x16x32_bf16 v[128:131], a[120:123], a[188:191], v[128:131]
    ds_write_b64 v27, v[78:79] offset:8
    v_cvt_pk_bf16_f32 v88, v198, v135
    v_mfma_f32_16x16x32_bf16 v[128:131], a[100:103], a[252:255], v[128:131]
    ds_read_b128 a[116:119], v44 offset:4096
    v_cvt_pk_bf16_f32 v89, v167, v199
    v_mfma_f32_16x16x32_bf16 v[128:131], a[240:243], a[112:115], v[128:131]
    s_waitcnt lgkmcnt(5)
    ds_write_b64 v27, v[88:89] offset:16
    v_add_f32 v224, v224, v72
    v_mfma_f32_16x16x32_bf16 v[128:131], a[228:231], a[60:63], v[128:131]
    v_add_f32 v225, v225, v73
    v_add_f32 v226, v226, v74
    v_mfma_f32_16x16x32_bf16 v[160:163], a[168:171], a[220:223], v[160:163]
    v_add_f32 v227, v227, v75
    v_mul_f32 v224, v224, v64
    v_mfma_f32_16x16x32_bf16 v[160:163], a[28:31], a[128:131], v[160:163]
    ds_read_b128 a[236:239], v45 offset:4096
    v_mul_f32 v225, v225, v65
    v_mfma_f32_16x16x32_bf16 v[160:163], a[56:59], a[104:107], v[160:163]
    v_mul_f32 v226, v226, v66
    v_mul_f32 v227, v227, v67
    v_mfma_f32_16x16x32_bf16 v[160:163], a[232:235], a[204:207], v[160:163]
    v_cvt_pk_bf16_f32 v72, v224, v225
    v_cvt_pk_bf16_f32 v73, v226, v227
    v_mfma_f32_16x16x32_bf16 v[160:163], a[196:199], a[188:191], v[160:163]
    ds_read_b128 a[248:251], v42 offset:38912
    v_mul_f32 v128, v128, v112
    v_mfma_f32_16x16x32_bf16 v[160:163], a[136:139], a[252:255], v[160:163]
    ds_write_b64 v28, v[72:73] offset:0
    v_mul_f32 v129, v129, v113
    v_mfma_f32_16x16x32_bf16 v[160:163], a[164:167], a[112:115], v[160:163]
    v_mul_f32 v130, v130, v114
    v_mul_f32 v131, v131, v115
    v_mfma_f32_16x16x32_bf16 v[160:163], a[16:19], a[60:63], v[160:163]
    v_mfma_f32_16x16x32_bf16 v[192:195], a[8:11], a[220:223], v[192:195]
    ds_read_b128 a[140:143], v43 offset:38912
    v_mfma_f32_16x16x32_bf16 v[192:195], a[76:79], a[128:131], v[192:195]
    v_mfma_f32_16x16x32_bf16 v[192:195], a[44:47], a[104:107], v[192:195]
    v_mfma_f32_16x16x32_bf16 v[192:195], a[96:99], a[204:207], v[192:195]
    ds_read_b128 a[148:151], v46 offset:6144
    v_mul_f32 v160, v160, v116
    v_mfma_f32_16x16x32_bf16 v[192:195], a[52:55], a[188:191], v[192:195]
    v_mul_f32 v161, v161, v117
    v_mul_f32 v162, v162, v118
    v_mfma_f32_16x16x32_bf16 v[192:195], a[132:135], a[252:255], v[192:195]
    v_mul_f32 v163, v163, v119
    v_mfma_f32_16x16x32_bf16 v[192:195], a[124:127], a[112:115], v[192:195]
    v_mfma_f32_16x16x32_bf16 v[192:195], a[32:35], a[60:63], v[192:195]
    ds_read_b128 a[216:219], v47 offset:6144
    v_mfma_f32_16x16x32_bf16 v[236:239], a[244:247], a[0:3], v[236:239]
    v_mfma_f32_16x16x32_bf16 v[236:239], a[12:15], a[84:87], v[236:239]
    v_mfma_f32_16x16x32_bf16 v[236:239], a[72:75], a[172:175], v[236:239]
    ds_read_b128 a[20:23], v40 offset:43008
    v_mfma_f32_16x16x32_bf16 v[236:239], a[88:91], a[144:147], v[236:239]
    v_mul_f32 v192, v192, v124
    v_mul_f32 v193, v193, v125
    v_mfma_f32_16x16x32_bf16 v[140:143], a[156:159], a[0:3], v[140:143]
    v_mul_f32 v194, v194, v126
    v_mul_f32 v195, v195, v127
    v_mfma_f32_16x16x32_bf16 v[140:143], a[192:195], a[84:87], v[140:143]
    v_cvt_pk_bf16_f32 v84, v128, v160
    v_cvt_pk_bf16_f32 v85, v192, v129
    v_mfma_f32_16x16x32_bf16 v[140:143], a[36:39], a[160:163], v[140:143]
    ds_read_b128 a[80:83], v41 offset:43008
    v_cvt_pk_bf16_f32 v86, v161, v193
    v_mfma_f32_16x16x32_bf16 v[140:143], a[4:7], a[180:183], v[140:143]
    ds_write_b64 v26, v[84:85] offset:0
    v_cvt_pk_bf16_f32 v87, v130, v162
    v_mfma_f32_16x16x32_bf16 v[140:143], a[120:123], a[172:175], v[140:143]
    ds_write_b64 v26, v[86:87] offset:8
    v_cvt_pk_bf16_f32 v104, v194, v131
    v_mfma_f32_16x16x32_bf16 v[140:143], a[100:103], a[144:147], v[140:143]
    ds_read_b128 a[108:111], v44 offset:10240
    v_cvt_pk_bf16_f32 v105, v163, v195
    v_mfma_f32_16x16x32_bf16 v[140:143], a[240:243], a[184:187], v[140:143]
    ds_write_b64 v26, v[104:105] offset:16
    v_mfma_f32_16x16x32_bf16 v[140:143], a[228:231], a[212:215], v[140:143]
    ds_write_b128 v29, v[236:239] offset:4096
    v_mfma_f32_16x16x32_bf16 v[172:175], a[168:171], a[0:3], v[172:175]
    v_mfma_f32_16x16x32_bf16 v[172:175], a[28:31], a[84:87], v[172:175]
    ds_read_b128 a[40:43], v45 offset:10240
    v_mfma_f32_16x16x32_bf16 v[172:175], a[56:59], a[160:163], v[172:175]
    v_mfma_f32_16x16x32_bf16 v[172:175], a[232:235], a[180:183], v[172:175]
    v_mul_f32 v140, v140, v112
    v_mul_f32 v141, v141, v113
    v_mfma_f32_16x16x32_bf16 v[172:175], a[196:199], a[172:175], v[172:175]
    s_waitcnt lgkmcnt(1)
    s_barrier
    ds_read_b128 a[176:179], v42 offset:40960
    v_mul_f32 v142, v142, v114
    v_mfma_f32_16x16x32_bf16 v[172:175], a[136:139], a[144:147], v[172:175]
    ds_read_b128 v[92:95], v24 offset:0
    v_mul_f32 v143, v143, v115
    v_mfma_f32_16x16x32_bf16 v[172:175], a[164:167], a[184:187], v[172:175]
    ds_read_b128 v[120:123], v24 offset:928
    v_mfma_f32_16x16x32_bf16 v[172:175], a[16:19], a[212:215], v[172:175]
    ds_read_b128 v[68:71], v24 offset:1856
    v_mfma_f32_16x16x32_bf16 v[204:207], a[8:11], a[0:3], v[204:207]
    ds_read_b128 a[24:27], v43 offset:40960
    v_mfma_f32_16x16x32_bf16 v[204:207], a[76:79], a[84:87], v[204:207]
    ds_read_b128 v[96:99], v24 offset:2784
    v_mfma_f32_16x16x32_bf16 v[204:207], a[44:47], a[160:163], v[204:207]
    ds_read_b128 v[108:111], v30 offset:4096
    v_mfma_f32_16x16x32_bf16 v[204:207], a[96:99], a[180:183], v[204:207]
    ds_read_b128 a[68:71], v46 offset:8192
    v_mul_f32 v172, v172, v116
    v_mfma_f32_16x16x32_bf16 v[204:207], a[52:55], a[172:175], v[204:207]
    v_mul_f32 v173, v173, v117
    v_mul_f32 v174, v174, v118
    v_mfma_f32_16x16x32_bf16 v[204:207], a[132:135], a[144:147], v[204:207]
    s_waitcnt lgkmcnt(6)
    buffer_store_dwordx4 v[92:95], v25, s[16:19], s3 offen sc1
    v_mul_f32 v175, v175, v119
    v_mfma_f32_16x16x32_bf16 v[204:207], a[124:127], a[184:187], v[204:207]
    v_mfma_f32_16x16x32_bf16 v[204:207], a[32:35], a[212:215], v[204:207]
    ds_read_b128 a[64:67], v47 offset:8192
    v_mfma_f32_16x16x32_bf16 v[232:235], a[244:247], a[200:203], v[232:235]
    s_waitcnt lgkmcnt(5)
    buffer_store_dwordx4 v[120:123], v25, s[16:19], s4 offen sc1
    v_mfma_f32_16x16x32_bf16 v[232:235], a[12:15], a[224:227], v[232:235]
    v_mfma_f32_16x16x32_bf16 v[232:235], a[72:75], a[116:119], v[232:235]
    ds_read_b128 a[208:211], v40 offset:40960
    v_mfma_f32_16x16x32_bf16 v[232:235], a[88:91], a[236:239], v[232:235]
    buffer_store_dwordx4 v[68:71], v25, s[16:19], s5 offen sc1
    v_mul_f32 v204, v204, v124
    v_mfma_f32_16x16x32_bf16 v[136:139], a[156:159], a[200:203], v[136:139]
    v_mul_f32 v205, v205, v125
    v_mul_f32 v206, v206, v126
    v_mfma_f32_16x16x32_bf16 v[136:139], a[192:195], a[224:227], v[136:139]
    s_waitcnt lgkmcnt(2)
    buffer_store_dwordx4 v[96:99], v25, s[16:19], s6 offen sc1
    v_mul_f32 v207, v207, v127
    v_mfma_f32_16x16x32_bf16 v[136:139], a[36:39], a[248:251], v[136:139]
    ds_read_b128 a[48:51], v41 offset:40960
    v_cvt_pk_bf16_f32 v80, v140, v172
    v_mfma_f32_16x16x32_bf16 v[136:139], a[4:7], a[140:143], v[136:139]
    v_cvt_pk_bf16_f32 v81, v204, v141
    v_cvt_pk_bf16_f32 v82, v173, v205
    v_mfma_f32_16x16x32_bf16 v[136:139], a[120:123], a[116:119], v[136:139]
    ds_write_b64 v27, v[80:81] offset:14848
    v_cvt_pk_bf16_f32 v83, v142, v174
    v_mfma_f32_16x16x32_bf16 v[136:139], a[100:103], a[236:239], v[136:139]
    ds_read_b128 a[92:95], v44 offset:8192
    v_cvt_pk_bf16_f32 v100, v206, v143
    v_mfma_f32_16x16x32_bf16 v[136:139], a[240:243], a[148:151], v[136:139]
    ds_write_b64 v27, v[82:83] offset:14856
    v_cvt_pk_bf16_f32 v101, v175, v207
    v_mfma_f32_16x16x32_bf16 v[136:139], a[228:231], a[216:219], v[136:139]
    ds_write_b64 v27, v[100:101] offset:14864
    v_add_f32 v232, v232, v108
    v_mfma_f32_16x16x32_bf16 v[168:171], a[168:171], a[200:203], v[168:171]
    v_add_f32 v233, v233, v109
    v_add_f32 v234, v234, v110
    v_mfma_f32_16x16x32_bf16 v[168:171], a[28:31], a[224:227], v[168:171]
    ds_read_b128 a[152:155], v45 offset:8192
    v_add_f32 v235, v235, v111
    v_mfma_f32_16x16x32_bf16 v[168:171], a[56:59], a[248:251], v[168:171]
    v_mul_f32 v232, v232, v64
    v_mul_f32 v233, v233, v65
    v_mfma_f32_16x16x32_bf16 v[168:171], a[232:235], a[140:143], v[168:171]
    v_mul_f32 v234, v234, v66
    v_mul_f32 v235, v235, v67
    v_mfma_f32_16x16x32_bf16 v[168:171], a[196:199], a[116:119], v[168:171]
    ds_read_b128 a[220:223], v42 offset:43008
    v_cvt_pk_bf16_f32 v108, v232, v233
    v_mfma_f32_16x16x32_bf16 v[168:171], a[136:139], a[236:239], v[168:171]
    v_cvt_pk_bf16_f32 v109, v234, v235
    v_mul_f32 v136, v136, v112
    v_mfma_f32_16x16x32_bf16 v[168:171], a[164:167], a[148:151], v[168:171]
    ds_write_b64 v28, v[108:109] offset:14848
    v_mul_f32 v137, v137, v113
    v_mfma_f32_16x16x32_bf16 v[168:171], a[16:19], a[216:219], v[168:171]
    v_mul_f32 v138, v138, v114
    v_mul_f32 v139, v139, v115
    v_mfma_f32_16x16x32_bf16 v[200:203], a[8:11], a[200:203], v[200:203]
    ds_read_b128 a[128:131], v43 offset:43008
    v_mfma_f32_16x16x32_bf16 v[200:203], a[76:79], a[224:227], v[200:203]
    v_mfma_f32_16x16x32_bf16 v[200:203], a[44:47], a[248:251], v[200:203]
    v_mfma_f32_16x16x32_bf16 v[200:203], a[96:99], a[140:143], v[200:203]
    ds_read_b128 a[104:107], v46 offset:10240
    v_mul_f32 v168, v168, v116
    v_mfma_f32_16x16x32_bf16 v[200:203], a[52:55], a[116:119], v[200:203]
    v_mul_f32 v169, v169, v117
    v_mul_f32 v170, v170, v118
    v_mfma_f32_16x16x32_bf16 v[200:203], a[132:135], a[236:239], v[200:203]
    v_mul_f32 v171, v171, v119
    v_mfma_f32_16x16x32_bf16 v[200:203], a[124:127], a[148:151], v[200:203]
    v_mfma_f32_16x16x32_bf16 v[200:203], a[32:35], a[216:219], v[200:203]
    ds_read_b128 a[204:207], v47 offset:10240
    v_mfma_f32_16x16x32_bf16 v[244:247], a[244:247], a[20:23], v[244:247]
    v_mfma_f32_16x16x32_bf16 v[244:247], a[12:15], a[80:83], v[244:247]
    v_mfma_f32_16x16x32_bf16 v[244:247], a[72:75], a[108:111], v[244:247]
    ds_read_b128 a[188:191], v40 offset:47104
    v_mfma_f32_16x16x32_bf16 v[244:247], a[88:91], a[40:43], v[244:247]
    v_mul_f32 v200, v200, v124
    v_mul_f32 v201, v201, v125
    v_mfma_f32_16x16x32_bf16 v[148:151], a[156:159], a[20:23], v[148:151]
    v_mul_f32 v202, v202, v126
    v_mul_f32 v203, v203, v127
    v_mfma_f32_16x16x32_bf16 v[148:151], a[192:195], a[80:83], v[148:151]
    v_cvt_pk_bf16_f32 v76, v136, v168
    v_cvt_pk_bf16_f32 v77, v200, v137
    v_mfma_f32_16x16x32_bf16 v[148:151], a[36:39], a[176:179], v[148:151]
    ds_read_b128 a[252:255], v41 offset:47104
    v_cvt_pk_bf16_f32 v78, v169, v201
    v_mfma_f32_16x16x32_bf16 v[148:151], a[4:7], a[24:27], v[148:151]
    ds_write_b64 v26, v[76:77] offset:14848
    v_cvt_pk_bf16_f32 v79, v138, v170
    v_mfma_f32_16x16x32_bf16 v[148:151], a[120:123], a[108:111], v[148:151]
    ds_write_b64 v26, v[78:79] offset:14856
    v_cvt_pk_bf16_f32 v88, v202, v139
    v_mfma_f32_16x16x32_bf16 v[148:151], a[100:103], a[40:43], v[148:151]
    ds_read_b128 a[112:115], v44 offset:14336
    v_cvt_pk_bf16_f32 v89, v171, v203
    v_mfma_f32_16x16x32_bf16 v[148:151], a[240:243], a[68:71], v[148:151]
    s_waitcnt lgkmcnt(5)
    ds_write_b64 v26, v[88:89] offset:14864
    v_mfma_f32_16x16x32_bf16 v[148:151], a[228:231], a[64:67], v[148:151]
    ds_write_b128 v29, v[244:247] offset:8192
    v_mfma_f32_16x16x32_bf16 v[180:183], a[168:171], a[20:23], v[180:183]
    v_mfma_f32_16x16x32_bf16 v[180:183], a[28:31], a[80:83], v[180:183]
    ds_read_b128 a[60:63], v45 offset:14336
    v_mfma_f32_16x16x32_bf16 v[180:183], a[56:59], a[176:179], v[180:183]
    v_mfma_f32_16x16x32_bf16 v[180:183], a[232:235], a[24:27], v[180:183]
    v_mul_f32 v148, v148, v112
    v_mul_f32 v149, v149, v113
    v_mfma_f32_16x16x32_bf16 v[180:183], a[196:199], a[108:111], v[180:183]
    s_waitcnt lgkmcnt(1)
    s_barrier
    ds_read_b128 a[0:3], v42 offset:45056
    v_mul_f32 v150, v150, v114
    v_mfma_f32_16x16x32_bf16 v[180:183], a[136:139], a[40:43], v[180:183]
    ds_read_b128 v[72:75], v24 offset:14848
    v_mul_f32 v151, v151, v115
    v_mfma_f32_16x16x32_bf16 v[180:183], a[164:167], a[68:71], v[180:183]
    ds_read_b128 v[84:87], v24 offset:15776
    v_mfma_f32_16x16x32_bf16 v[180:183], a[16:19], a[64:67], v[180:183]
    ds_read_b128 v[104:107], v24 offset:16704
    v_mfma_f32_16x16x32_bf16 v[212:215], a[8:11], a[20:23], v[212:215]
    ds_read_b128 a[84:87], v43 offset:45056
    v_mfma_f32_16x16x32_bf16 v[212:215], a[76:79], a[80:83], v[212:215]
    ds_read_b128 v[92:95], v24 offset:17632
    v_mfma_f32_16x16x32_bf16 v[212:215], a[44:47], a[176:179], v[212:215]
    ds_read_b128 v[120:123], v30 offset:8192
    v_mfma_f32_16x16x32_bf16 v[212:215], a[96:99], a[24:27], v[212:215]
    ds_read_b128 a[160:163], v46 offset:12288
    v_mul_f32 v180, v180, v116
    v_mfma_f32_16x16x32_bf16 v[212:215], a[52:55], a[108:111], v[212:215]
    v_mul_f32 v181, v181, v117
    v_mul_f32 v182, v182, v118
    v_mfma_f32_16x16x32_bf16 v[212:215], a[132:135], a[40:43], v[212:215]
    s_waitcnt lgkmcnt(6)
    buffer_store_dwordx4 v[72:75], v25, s[16:19], s7 offen sc1
    v_mul_f32 v183, v183, v119
    v_mfma_f32_16x16x32_bf16 v[212:215], a[124:127], a[68:71], v[212:215]
    v_mfma_f32_16x16x32_bf16 v[212:215], a[32:35], a[64:67], v[212:215]
    ds_read_b128 a[180:183], v47 offset:12288
    v_mfma_f32_16x16x32_bf16 v[240:243], a[244:247], a[208:211], v[240:243]
    s_waitcnt lgkmcnt(5)
    buffer_store_dwordx4 v[84:87], v25, s[16:19], s24 offen sc1
    v_mfma_f32_16x16x32_bf16 v[240:243], a[12:15], a[48:51], v[240:243]
    v_mfma_f32_16x16x32_bf16 v[240:243], a[72:75], a[92:95], v[240:243]
    ds_read_b128 a[172:175], v40 offset:45056
    v_mfma_f32_16x16x32_bf16 v[240:243], a[88:91], a[152:155], v[240:243]
    buffer_store_dwordx4 v[104:107], v25, s[16:19], s25 offen sc1
    v_mul_f32 v212, v212, v124
    v_mfma_f32_16x16x32_bf16 v[144:147], a[156:159], a[208:211], v[144:147]
    v_mul_f32 v213, v213, v125
    v_mul_f32 v214, v214, v126
    v_mfma_f32_16x16x32_bf16 v[144:147], a[192:195], a[48:51], v[144:147]
    s_waitcnt lgkmcnt(2)
    buffer_store_dwordx4 v[92:95], v25, s[16:19], s26 offen sc1
    v_mul_f32 v215, v215, v127
    v_mfma_f32_16x16x32_bf16 v[144:147], a[36:39], a[220:223], v[144:147]
    ds_read_b128 a[144:147], v41 offset:45056
    v_cvt_pk_bf16_f32 v68, v148, v180
    v_mfma_f32_16x16x32_bf16 v[144:147], a[4:7], a[128:131], v[144:147]
    v_cvt_pk_bf16_f32 v69, v212, v149
    v_cvt_pk_bf16_f32 v70, v181, v213
    v_mfma_f32_16x16x32_bf16 v[144:147], a[120:123], a[92:95], v[144:147]
    ds_write_b64 v27, v[68:69] offset:29696
    v_cvt_pk_bf16_f32 v71, v150, v182
    v_mfma_f32_16x16x32_bf16 v[144:147], a[100:103], a[152:155], v[144:147]
    ds_read_b128 a[184:187], v44 offset:12288
    v_cvt_pk_bf16_f32 v96, v214, v151
    v_mfma_f32_16x16x32_bf16 v[144:147], a[240:243], a[104:107], v[144:147]
    ds_write_b64 v27, v[70:71] offset:29704
    v_cvt_pk_bf16_f32 v97, v183, v215
    v_mfma_f32_16x16x32_bf16 v[144:147], a[228:231], a[204:207], v[144:147]
    ds_write_b64 v27, v[96:97] offset:29712
    v_add_f32 v240, v240, v120
    v_mfma_f32_16x16x32_bf16 v[176:179], a[168:171], a[208:211], v[176:179]
    v_add_f32 v241, v241, v121
    v_add_f32 v242, v242, v122
    v_mfma_f32_16x16x32_bf16 v[176:179], a[28:31], a[48:51], v[176:179]
    ds_read_b128 a[212:215], v45 offset:12288
    v_add_f32 v243, v243, v123
    v_mfma_f32_16x16x32_bf16 v[176:179], a[56:59], a[220:223], v[176:179]
    v_mul_f32 v240, v240, v64
    v_mul_f32 v241, v241, v65
    v_mfma_f32_16x16x32_bf16 v[176:179], a[232:235], a[128:131], v[176:179]
    v_mul_f32 v242, v242, v66
    v_mul_f32 v243, v243, v67
    v_mfma_f32_16x16x32_bf16 v[176:179], a[196:199], a[92:95], v[176:179]
    ds_read_b128 a[200:203], v42 offset:47104
    v_cvt_pk_bf16_f32 v120, v240, v241
    v_mfma_f32_16x16x32_bf16 v[176:179], a[136:139], a[152:155], v[176:179]
    v_cvt_pk_bf16_f32 v121, v242, v243
    v_mul_f32 v144, v144, v112
    v_mfma_f32_16x16x32_bf16 v[176:179], a[164:167], a[104:107], v[176:179]
    ds_write_b64 v28, v[120:121] offset:29696
    v_mul_f32 v145, v145, v113
    v_mfma_f32_16x16x32_bf16 v[176:179], a[16:19], a[204:207], v[176:179]
    v_mul_f32 v146, v146, v114
    v_mul_f32 v147, v147, v115
    v_mfma_f32_16x16x32_bf16 v[208:211], a[8:11], a[208:211], v[208:211]
    ds_read_b128 a[224:227], v43 offset:47104
    v_mfma_f32_16x16x32_bf16 v[208:211], a[76:79], a[48:51], v[208:211]
    v_mfma_f32_16x16x32_bf16 v[208:211], a[44:47], a[220:223], v[208:211]
    v_mfma_f32_16x16x32_bf16 v[208:211], a[96:99], a[128:131], v[208:211]
    ds_read_b128 a[248:251], v46 offset:14336
    v_mul_f32 v176, v176, v116
    v_mfma_f32_16x16x32_bf16 v[208:211], a[52:55], a[92:95], v[208:211]
    v_mul_f32 v177, v177, v117
    v_mul_f32 v178, v178, v118
    v_mfma_f32_16x16x32_bf16 v[208:211], a[132:135], a[152:155], v[208:211]
    v_mul_f32 v179, v179, v119
    v_mfma_f32_16x16x32_bf16 v[208:211], a[124:127], a[104:107], v[208:211]
    v_mfma_f32_16x16x32_bf16 v[208:211], a[32:35], a[204:207], v[208:211]
    ds_read_b128 a[140:143], v47 offset:14336
    v_mfma_f32_16x16x32_bf16 v[252:255], a[244:247], a[188:191], v[252:255]
    v_mfma_f32_16x16x32_bf16 v[252:255], a[12:15], a[252:255], v[252:255]
    v_mfma_f32_16x16x32_bf16 v[252:255], a[72:75], a[112:115], v[252:255]
    v_mfma_f32_16x16x32_bf16 v[252:255], a[88:91], a[60:63], v[252:255]
    v_mul_f32 v208, v208, v124
    v_mul_f32 v209, v209, v125
    v_mfma_f32_16x16x32_bf16 v[156:159], a[156:159], a[188:191], v[156:159]
    v_mul_f32 v210, v210, v126
    v_mul_f32 v211, v211, v127
    v_mfma_f32_16x16x32_bf16 v[156:159], a[192:195], a[252:255], v[156:159]
    v_cvt_pk_bf16_f32 v80, v144, v176
    v_cvt_pk_bf16_f32 v81, v208, v145
    v_mfma_f32_16x16x32_bf16 v[156:159], a[36:39], a[0:3], v[156:159]
    ds_write_b64 v26, v[80:81] offset:29696
    v_cvt_pk_bf16_f32 v82, v177, v209
    v_mfma_f32_16x16x32_bf16 v[156:159], a[4:7], a[84:87], v[156:159]
    v_cvt_pk_bf16_f32 v83, v146, v178
    v_cvt_pk_bf16_f32 v100, v210, v147
    v_mfma_f32_16x16x32_bf16 v[156:159], a[120:123], a[112:115], v[156:159]
    ds_write_b64 v26, v[82:83] offset:29704
    v_cvt_pk_bf16_f32 v101, v179, v211
    v_mfma_f32_16x16x32_bf16 v[156:159], a[100:103], a[60:63], v[156:159]
    ds_write_b64 v26, v[100:101] offset:29712
    v_mfma_f32_16x16x32_bf16 v[156:159], a[240:243], a[160:163], v[156:159]
    s_waitcnt lgkmcnt(3)
    ds_write_b128 v29, v[252:255] offset:12288
    v_mfma_f32_16x16x32_bf16 v[156:159], a[228:231], a[180:183], v[156:159]
    v_mfma_f32_16x16x32_bf16 v[188:191], a[168:171], a[188:191], v[188:191]
    v_mfma_f32_16x16x32_bf16 v[188:191], a[28:31], a[252:255], v[188:191]
    v_mfma_f32_16x16x32_bf16 v[188:191], a[56:59], a[0:3], v[188:191]
    v_mfma_f32_16x16x32_bf16 v[188:191], a[232:235], a[84:87], v[188:191]
    s_waitcnt lgkmcnt(0)
    s_barrier
    v_mul_f32 v156, v156, v112
    v_mul_f32 v157, v157, v113
    v_mfma_f32_16x16x32_bf16 v[188:191], a[196:199], a[112:115], v[188:191]
    ds_read_b128 v[108:111], v24 offset:29696
    v_mul_f32 v158, v158, v114
    v_mfma_f32_16x16x32_bf16 v[188:191], a[136:139], a[60:63], v[188:191]
    ds_read_b128 v[76:79], v24 offset:30624
    v_mul_f32 v159, v159, v115
    v_mfma_f32_16x16x32_bf16 v[188:191], a[164:167], a[160:163], v[188:191]
    ds_read_b128 v[88:91], v24 offset:31552
    v_mfma_f32_16x16x32_bf16 v[188:191], a[16:19], a[180:183], v[188:191]
    ds_read_b128 v[72:75], v24 offset:32480
    v_mfma_f32_16x16x32_bf16 v[220:223], a[8:11], a[188:191], v[220:223]
    ds_read_b128 v[84:87], v30 offset:12288
    v_mfma_f32_16x16x32_bf16 v[220:223], a[76:79], a[252:255], v[220:223]
    v_mfma_f32_16x16x32_bf16 v[220:223], a[44:47], a[0:3], v[220:223]
    v_mfma_f32_16x16x32_bf16 v[220:223], a[96:99], a[84:87], v[220:223]
    v_mul_f32 v188, v188, v116
    v_mul_f32 v189, v189, v117
    v_mfma_f32_16x16x32_bf16 v[220:223], a[52:55], a[112:115], v[220:223]
    s_waitcnt lgkmcnt(4)
    buffer_store_dwordx4 v[108:111], v25, s[16:19], s27 offen sc1
    v_mul_f32 v190, v190, v118
    v_mfma_f32_16x16x32_bf16 v[220:223], a[132:135], a[60:63], v[220:223]
    v_mul_f32 v191, v191, v119
    v_mfma_f32_16x16x32_bf16 v[220:223], a[124:127], a[160:163], v[220:223]
    s_waitcnt lgkmcnt(3)
    buffer_store_dwordx4 v[76:79], v25, s[16:19], s48 offen sc1
    v_mfma_f32_16x16x32_bf16 v[220:223], a[32:35], a[180:183], v[220:223]
    v_mfma_f32_16x16x32_bf16 v[248:251], a[244:247], a[172:175], v[248:251]
    s_waitcnt lgkmcnt(1)
    buffer_store_dwordx4 v[88:91], v25, s[16:19], s49 offen sc1
    v_mfma_f32_16x16x32_bf16 v[248:251], a[12:15], a[144:147], v[248:251]
    v_mfma_f32_16x16x32_bf16 v[248:251], a[72:75], a[184:187], v[248:251]
    buffer_store_dwordx4 v[72:75], v25, s[16:19], s50 offen sc1
    v_mfma_f32_16x16x32_bf16 v[248:251], a[88:91], a[212:215], v[248:251]
    v_mul_f32 v220, v220, v124
    v_mul_f32 v221, v221, v125
    v_mfma_f32_16x16x32_bf16 v[152:155], a[156:159], a[172:175], v[152:155]
    v_mul_f32 v222, v222, v126
    v_mul_f32 v223, v223, v127
    v_mfma_f32_16x16x32_bf16 v[152:155], a[192:195], a[144:147], v[152:155]
    v_cvt_pk_bf16_f32 v104, v156, v188
    v_cvt_pk_bf16_f32 v105, v220, v157
    v_mfma_f32_16x16x32_bf16 v[152:155], a[36:39], a[200:203], v[152:155]
    ds_write_b64 v27, v[104:105] offset:44544
    v_cvt_pk_bf16_f32 v106, v189, v221
    v_mfma_f32_16x16x32_bf16 v[152:155], a[4:7], a[224:227], v[152:155]
    v_cvt_pk_bf16_f32 v107, v158, v190
    v_cvt_pk_bf16_f32 v92, v222, v159
    v_mfma_f32_16x16x32_bf16 v[152:155], a[120:123], a[184:187], v[152:155]
    ds_write_b64 v27, v[106:107] offset:44552
    v_cvt_pk_bf16_f32 v93, v191, v223
    v_mfma_f32_16x16x32_bf16 v[152:155], a[100:103], a[212:215], v[152:155]
    s_waitcnt lgkmcnt(2)
    ds_write_b64 v27, v[92:93] offset:44560
    v_add_f32 v248, v248, v84
    v_mfma_f32_16x16x32_bf16 v[152:155], a[240:243], a[248:251], v[152:155]
    v_add_f32 v249, v249, v85
    v_add_f32 v250, v250, v86
    v_mfma_f32_16x16x32_bf16 v[152:155], a[228:231], a[140:143], v[152:155]
    v_add_f32 v251, v251, v87
    v_mul_f32 v248, v248, v64
    v_mfma_f32_16x16x32_bf16 v[184:187], a[168:171], a[172:175], v[184:187]
    v_mul_f32 v249, v249, v65
    v_mul_f32 v250, v250, v66
    v_mfma_f32_16x16x32_bf16 v[184:187], a[28:31], a[144:147], v[184:187]
    v_mul_f32 v251, v251, v67
    v_cvt_pk_bf16_f32 v84, v248, v249
    v_mfma_f32_16x16x32_bf16 v[184:187], a[56:59], a[200:203], v[184:187]
    v_cvt_pk_bf16_f32 v85, v250, v251
    v_mfma_f32_16x16x32_bf16 v[184:187], a[232:235], a[224:227], v[184:187]
    ds_write_b64 v28, v[84:85] offset:44544
    v_mul_f32 v152, v152, v112
    v_mfma_f32_16x16x32_bf16 v[184:187], a[196:199], a[184:187], v[184:187]
    v_mul_f32 v153, v153, v113
    v_mul_f32 v154, v154, v114
    v_mfma_f32_16x16x32_bf16 v[184:187], a[136:139], a[212:215], v[184:187]
    v_mul_f32 v155, v155, v115
    v_mfma_f32_16x16x32_bf16 v[184:187], a[164:167], a[248:251], v[184:187]
    v_mfma_f32_16x16x32_bf16 v[184:187], a[16:19], a[140:143], v[184:187]
    v_mfma_f32_16x16x32_bf16 v[216:219], a[8:11], a[172:175], v[216:219]
    v_mfma_f32_16x16x32_bf16 v[216:219], a[76:79], a[144:147], v[216:219]
    v_mfma_f32_16x16x32_bf16 v[216:219], a[44:47], a[200:203], v[216:219]
    v_mfma_f32_16x16x32_bf16 v[216:219], a[96:99], a[224:227], v[216:219]
    v_mul_f32 v184, v184, v116
    v_mul_f32 v185, v185, v117
    v_mfma_f32_16x16x32_bf16 v[216:219], a[52:55], a[184:187], v[216:219]
    v_mul_f32 v186, v186, v118
    v_mul_f32 v187, v187, v119
    v_mfma_f32_16x16x32_bf16 v[216:219], a[132:135], a[212:215], v[216:219]
    v_mfma_f32_16x16x32_bf16 v[216:219], a[124:127], a[248:251], v[216:219]
    v_mfma_f32_16x16x32_bf16 v[216:219], a[32:35], a[140:143], v[216:219]
    s_nop 7
    v_mul_f32 v216, v216, v124
    v_mul_f32 v217, v217, v125
    v_mul_f32 v218, v218, v126
    v_mul_f32 v219, v219, v127
    v_cvt_pk_bf16_f32 v68, v152, v184
    v_cvt_pk_bf16_f32 v69, v216, v153
    v_cvt_pk_bf16_f32 v70, v185, v217
    v_cvt_pk_bf16_f32 v71, v154, v186
    v_cvt_pk_bf16_f32 v96, v218, v155
    v_cvt_pk_bf16_f32 v97, v187, v219
    ds_write_b64 v26, v[68:69] offset:44544
    ds_write_b64 v26, v[70:71] offset:44552
    ds_write_b64 v26, v[96:97] offset:44560
    s_waitcnt lgkmcnt(0)
    s_barrier
    ds_read_b128 v[120:123], v24 offset:44544
    ds_read_b128 v[80:83], v24 offset:45472
    ds_read_b128 v[100:103], v24 offset:46400
    ds_read_b128 v[108:111], v24 offset:47328
    s_waitcnt lgkmcnt(3)
    buffer_store_dwordx4 v[120:123], v25, s[16:19], s51 offen sc1
    s_waitcnt lgkmcnt(2)
    buffer_store_dwordx4 v[80:83], v25, s[16:19], s52 offen sc1
    s_waitcnt lgkmcnt(1)
    buffer_store_dwordx4 v[100:103], v25, s[16:19], s53 offen sc1
    s_waitcnt lgkmcnt(0)
    buffer_store_dwordx4 v[108:111], v25, s[16:19], s54 offen sc1
L_end:
    s_endpgm
L_code_end:

.section .rodata,"a"
.p2align 6
.amdhsa_kernel af4_pack_kernel
  .amdhsa_next_free_vgpr 40
  .amdhsa_next_free_sgpr 40
  .amdhsa_accum_offset 40
  .amdhsa_group_segment_fixed_size 0
  .amdhsa_kernarg_size 56
  .amdhsa_user_sgpr_count 2
  .amdhsa_user_sgpr_kernarg_segment_ptr 1
  .amdhsa_system_sgpr_workgroup_id_x 1
.end_amdhsa_kernel
.p2align 6
.amdhsa_kernel af4_gemm_kernel
  .amdhsa_next_free_vgpr 512
  .amdhsa_next_free_sgpr 102
  .amdhsa_accum_offset 256
  .amdhsa_group_segment_fixed_size 0
  .amdhsa_kernarg_size 56
  .amdhsa_user_sgpr_count 2
  .amdhsa_user_sgpr_kernarg_segment_ptr 1
  .amdhsa_system_sgpr_workgroup_id_x 1
.end_amdhsa_kernel
```

```asm
; @launch grid=(256,1,1) block=(256,1,1) lds=163840
.amdgcn_target "amdgcn-amd-amdhsa--gfx950"
.text
.globl standalone__normalfloat_lut_af4__prompt_kernel
.p2align 8
.type standalone__normalfloat_lut_af4__prompt_kernel,@function
standalone__normalfloat_lut_af4__prompt_kernel:
    s_cmp_ge_u32 s2, 256
    s_cbranch_scc1 L_end
    s_load_dwordx2 s[4:5], s[0:1], 8
    s_load_dwordx2 s[12:13], s[0:1], 48
    s_load_dwordx2 s[8:9], s[0:1], 0
    s_load_dwordx4 s[20:23], s[0:1], 16
    s_load_dwordx2 s[16:17], s[0:1], 32
    s_getpc_b64 s[72:73]
    s_mov_b32 s74, L_code_end-standalone__normalfloat_lut_af4__prompt_kernel-256
    s_mov_b32 s75, 0x20000
    v_lshlrev_b32 v10, 7, v0
    buffer_load_dword v1, v10, s[72:75], 0 offen offset:256
    v_lshrrev_b32 v5, 6, v0
    v_and_b32 v2, 63, v0
    s_and_b32 s60, s2, 7
    s_lshr_b32 s61, s2, 3
    v_readfirstlane_b32 s63, v5
    s_and_b32 s58, s60, 3
    s_lshl_b32 s58, s58, 2
    s_and_b32 s62, s61, 3
    s_add_u32 s58, s58, s62
    s_lshr_b32 s59, s60, 2
    s_lshl_b32 s59, s59, 3
    s_lshr_b32 s62, s61, 2
    s_add_u32 s59, s59, s62
    v_add_u32 v8, 8, v2
    v_lshrrev_b32 v8, 6, v8
    v_lshlrev_b32 v8, 30, v8
    v_lshl_add_u32 v18, v2, 4, v8
    s_lshl_b32 s60, s58, 2
    s_add_u32 s60, s60, s63
    s_mul_i32 s61, s60, 114688
    s_mul_i32 s62, s59, 896
    s_add_u32 s61, s61, s62
    s_mov_b32 s6, 14680064
    s_mov_b32 s7, 0x20000
    s_mov_b32 s14, 8388608
    s_mov_b32 s15, 0x20000
    s_mul_i32 s78, s59, 1152
    s_add_u32 s78, s78, 4194304
    s_waitcnt lgkmcnt(0)
    s_load_dwordx2 s[76:77], s[12:13], s78
    buffer_load_dwordx4 v[128:131], v18, s[4:7], s61 offen
    s_add_u32 s61, s61, 14336
    buffer_load_dwordx4 v[132:135], v18, s[4:7], s61 offen
    s_add_u32 s61, s61, 14336
    buffer_load_dwordx4 v[136:139], v18, s[4:7], s61 offen
    s_add_u32 s61, s61, 14336
    buffer_load_dwordx4 v[140:143], v18, s[4:7], s61 offen
    s_add_u32 s61, s61, 14336
    buffer_load_dwordx4 v[144:147], v18, s[4:7], s61 offen
    s_add_u32 s61, s61, 14336
    buffer_load_dwordx4 v[148:151], v18, s[4:7], s61 offen
    s_add_u32 s61, s61, 14336
    buffer_load_dwordx4 v[152:155], v18, s[4:7], s61 offen
    s_add_u32 s61, s61, 14336
    buffer_load_dwordx4 v[156:159], v18, s[4:7], s61 offen
    s_add_u32 s61, s61, 7239680
    v_lshrrev_b32 v3, 4, v2
    v_and_b32 v4, 15, v2
    v_lshrrev_b32 v8, 3, v0
    v_and_b32 v9, 7, v2
    v_xor_b32 v9, v9, v3
    s_mul_i32 s70, s63, 24
    v_add_lshl_u32 v8, v8, s70, 11
    v_lshl_add_u32 v36, v9, 4, v8
    v_xor_b32 v37, 64, v36
    v_add_u32 v38, 30720, v36
    v_add_u32 v37, 15360, v37
    v_add_u32 v39, 30720, v37
    v_lshlrev_b32 v5, 1, v4
    v_lshrrev_b32 v6, 4, v0
    v_lshlrev_b32 v6, 1, v6
    s_mov_b32 s10, 4194304
    s_mov_b32 s11, 0x20000
    s_mov_b32 s28, s20
    s_mov_b32 s29, s21
    s_mov_b32 s30, 32
    s_mov_b32 s31, 0x20000
    s_lshl_b32 s55, s58, 18
    s_lshl_b32 s57, s63, 12
    s_add_u32 s57, s57, 65536
    buffer_load_ushort v16, v5, s[28:31], 0 offen
    buffer_load_ushort v17, v6, s[28:31], 0 offen
    s_add_u32 m0, s57, 32768
    s_add_u32 s56, s55, 0
    buffer_load_dwordx4 v36, s[8:11], s56 offen offset:0 lds
    buffer_load_dwordx4 v37, s[8:11], s56 offen offset:1024 lds
    buffer_load_dwordx4 v38, s[8:11], s56 offen offset:2048 lds
    buffer_load_dwordx4 v39, s[8:11], s56 offen offset:3072 lds
    s_add_u32 m0, s57, 51200
    s_add_u32 s56, s55, 128
    buffer_load_dwordx4 v36, s[8:11], s56 offen offset:0 lds
    buffer_load_dwordx4 v37, s[8:11], s56 offen offset:1024 lds
    s_add_u32 m0, s57, 47104
    s_nop 0
    buffer_load_dwordx4 v38, s[8:11], s56 offen offset:2048 lds
    buffer_load_dwordx4 v39, s[8:11], s56 offen offset:3072 lds
    s_and_b32 s64, s63, 1
    s_lshr_b32 s65, s63, 1
    s_lshl_b32 s68, s59, 17
    s_lshl_b32 s62, s60, 10
    s_add_u32 s62, s62, s68
    s_mul_i32 s66, s65, 112
    s_mul_i32 s67, s64, 48
    s_add_u32 s67, s66, s67
    s_lshl_b32 s69, s64, 13
    v_lshlrev_b32 v7, 10, v3
    s_lshl_b32 s70, s67, 2
    s_add_u32 s70, s70, s68
    v_mad_u32_u24 v33, v4, 12, v7
    s_add_u32 s71, s70, s69
    v_add_u32 v32, s71, v33
    s_sub_u32 s71, 8192, s69
    s_add_u32 s71, s71, s70
    v_add_u32 v33, s71, v33
    s_add_u32 s71, s66, 96
    s_lshl_b32 s70, s71, 2
    s_add_u32 s70, s70, s68
    s_add_u32 s70, s70, s69
    v_lshl_add_u32 v34, v4, 2, v7
    v_add_u32 v34, s70, v34
    s_mul_i32 s70, s59, 224
    s_add_u32 s67, s67, s70
    s_add_u32 s71, s71, s70
    s_lshl_b32 s70, s67, 1
    v_mad_u32_u24 v22, v3, 24, s70
    s_lshl_b32 s70, s71, 1
    v_lshl_add_u32 v23, v3, 3, s70
    s_add_u32 s78, s78, 128
    s_mul_i32 s70, s60, 8
    s_add_u32 s70, s70, s78
    v_min_u32 v19, 1, v2
    v_lshlrev_b32 v19, 30, v19
    v_add_u32 v19, s70, v19
    v_mul_u32_u24 v5, 8, v2
    s_waitcnt lgkmcnt(0)
    s_add_u32 s76, s76, 2135587861
    s_addc_u32 s77, s77, 2654435769
    v_mov_b32 v20, s76
    v_mov_b32 v21, s77
    s_waitcnt vmcnt(16)
    v_lshl_or_b32 v128, v132, 4, v128
    v_lshl_or_b32 v129, v133, 4, v129
    v_lshl_or_b32 v130, v134, 4, v130
    v_lshl_or_b32 v131, v135, 4, v131
    s_waitcnt vmcnt(14)
    v_lshl_or_b32 v136, v140, 4, v136
    v_lshl_or_b32 v137, v141, 4, v137
    v_lshl_or_b32 v138, v142, 4, v138
    v_lshl_or_b32 v139, v143, 4, v139
    v_lshl_or_b32 v128, v136, 8, v128
    v_lshl_or_b32 v129, v137, 8, v129
    v_lshl_or_b32 v130, v138, 8, v130
    v_lshl_or_b32 v131, v139, 8, v131
    s_waitcnt vmcnt(12)
    v_lshl_or_b32 v144, v148, 4, v144
    v_lshl_or_b32 v145, v149, 4, v145
    v_lshl_or_b32 v146, v150, 4, v146
    v_lshl_or_b32 v147, v151, 4, v147
    s_waitcnt vmcnt(10)
    v_lshl_or_b32 v152, v156, 4, v152
    v_lshl_or_b32 v153, v157, 4, v153
    v_lshl_or_b32 v154, v158, 4, v154
    v_lshl_or_b32 v155, v159, 4, v155
    v_lshl_or_b32 v144, v152, 8, v144
    v_lshl_or_b32 v145, v153, 8, v145
    v_lshl_or_b32 v146, v154, 8, v146
    v_lshl_or_b32 v147, v155, 8, v147
    v_lshl_or_b32 v128, v144, 16, v128
    v_lshl_or_b32 v129, v145, 16, v129
    v_lshl_or_b32 v130, v146, 16, v130
    v_lshl_or_b32 v131, v147, 16, v131
    buffer_store_dwordx4 v[128:131], v18, s[12:15], s62 offen sc1
    s_add_u32 s62, s62, 65536
    buffer_load_dwordx4 v[160:163], v18, s[4:7], s61 offen
    s_add_u32 s61, s61, 14336
    buffer_load_dwordx4 v[164:167], v18, s[4:7], s61 offen
    s_add_u32 s61, s61, 14336
    buffer_load_dwordx4 v[168:171], v18, s[4:7], s61 offen
    s_add_u32 s61, s61, 14336
    buffer_load_dwordx4 v[172:175], v18, s[4:7], s61 offen
    s_add_u32 s61, s61, 14336
    buffer_load_dwordx4 v[176:179], v18, s[4:7], s61 offen
    s_add_u32 s61, s61, 14336
    buffer_load_dwordx4 v[180:183], v18, s[4:7], s61 offen
    s_add_u32 s61, s61, 14336
    buffer_load_dwordx4 v[184:187], v18, s[4:7], s61 offen
    s_add_u32 s61, s61, 14336
    buffer_load_dwordx4 v[188:191], v18, s[4:7], s61 offen
    s_add_u32 s61, s61, 7239680
    s_add_u32 m0, s57, 65536
    s_add_u32 s56, s55, 256
    buffer_load_dwordx4 v36, s[8:11], s56 offen offset:0 lds
    buffer_load_dwordx4 v37, s[8:11], s56 offen offset:1024 lds
    buffer_load_dwordx4 v38, s[8:11], s56 offen offset:2048 lds
    buffer_load_dwordx4 v39, s[8:11], s56 offen offset:3072 lds
    s_add_u32 m0, s57, 83968
    s_add_u32 s56, s55, 384
    buffer_load_dwordx4 v36, s[8:11], s56 offen offset:0 lds
    buffer_load_dwordx4 v37, s[8:11], s56 offen offset:1024 lds
    s_add_u32 m0, s57, 79872
    s_nop 0
    buffer_load_dwordx4 v38, s[8:11], s56 offen offset:2048 lds
    buffer_load_dwordx4 v39, s[8:11], s56 offen offset:3072 lds
    s_waitcnt vmcnt(16)
    buffer_store_dwordx2 v[20:21], v19, s[12:15], 0 offen sc1
    v_add_u32 v19, 512, v19
    s_mov_b32 s32, s22
    s_mov_b32 s33, s23
    s_mov_b32 s34, 7168
    s_mov_b32 s35, 0x20000
    s_mov_b32 s18, 14680064
    s_mov_b32 s19, 0x20000
    s_mov_b32 s36, 202114048
    s_mov_b32 s37, 202114304
    s_mov_b32 s38, 202114560
    s_mov_b32 s39, 202114816
    v_and_b32 v8, 7, v0
    v_lshlrev_b32 v8, 4, v8
    v_lshl_add_u32 v8, v0, 8, v8
    v_lshl_or_b32 v56, v17, 16, v16
    v_lshl_or_b32 v57, v17, 16, v16
    v_lshl_or_b32 v58, v17, 16, v16
    v_lshl_or_b32 v59, v17, 16, v16
    v_xor_b32 v9, 16, v8
    v_xor_b32 v10, 32, v8
    v_xor_b32 v11, 48, v8
    v_xor_b32 v12, 64, v8
    v_xor_b32 v13, 80, v8
    v_xor_b32 v14, 96, v8
    v_xor_b32 v15, 112, v8
    ds_write_b128 v8, v[56:59]
    ds_write_b128 v9, v[56:59]
    ds_write_b128 v10, v[56:59]
    ds_write_b128 v11, v[56:59]
    ds_write_b128 v12, v[56:59]
    ds_write_b128 v13, v[56:59]
    ds_write_b128 v14, v[56:59]
    ds_write_b128 v15, v[56:59]
    v_and_b32 v35, 31, v2
    v_lshlrev_b32 v35, 2, v35
    v_lshrrev_b32 v16, 1, v4
    v_xor_b32 v16, v16, v3
    v_lshlrev_b32 v16, 4, v16
    v_lshl_add_u32 v16, v4, 7, v16
    s_lshl_b32 s70, s64, 14
    s_add_u32 s72, s70, 65536
    s_sub_u32 s73, 81920, s70
    v_add_u32 v40, s72, v16
    v_add_u32 v42, s73, v16
    v_xor_b32 v41, 64, v40
    v_xor_b32 v43, 64, v42
    v_add_u32 v44, 65536, v40
    v_add_u32 v45, 65536, v41
    v_add_u32 v46, 65536, v42
    v_add_u32 v47, 65536, v43
    v_mul_u32_u24 v16, 464, v4
    s_mul_i32 s70, s64, 7424
    s_mul_i32 s72, s65, 224
    s_mul_i32 s73, s64, 96
    s_add_u32 s73, s73, s72
    v_mad_u32_u24 v17, v3, 24, v16
    s_add_u32 s74, s73, s70
    v_add_u32 v26, s74, v17
    s_sub_u32 s74, 7424, s70
    s_add_u32 s74, s74, s73
    v_add_u32 v27, s74, v17
    s_add_u32 s74, s72, s70
    s_add_u32 s74, s74, 192
    v_lshl_add_u32 v28, v3, 3, v16
    v_add_u32 v28, s74, v28
    v_lshlrev_b32 v29, 4, v0
    v_add_u32 v29, 65536, v29
    v_xor_b32 v30, 1024, v29
    v_mul_u32_u24 v16, 2341, v2
    v_lshrrev_b32 v16, 16, v16
    s_mul_i32 s73, s63, 3712
    v_add_lshl_u32 v24, v2, v16, 4
    v_add_u32 v24, s73, v24
    s_lshl_b32 s74, s58, 7
    s_lshl_b32 s75, s63, 3
    s_add_u32 s74, s74, s75
    s_mul_i32 s74, s74, 7168
    s_mul_i32 s75, s59, 448
    s_add_u32 s74, s74, s75
    v_mul_u32_u24 v17, 6720, v16
    v_lshl_add_u32 v25, v2, 4, v17
    v_lshrrev_b32 v16, 1, v16
    v_lshlrev_b32 v16, 30, v16
    v_add3_u32 v25, v25, v16, s74
    s_waitcnt lgkmcnt(0)
    s_barrier
    ds_read_b128 a[0:3], v40 offset:32768
    ds_read_b128 a[4:7], v41 offset:32768
    ds_read_b128 a[8:11], v40 offset:34816
    ds_read_b128 a[12:15], v41 offset:34816
    ds_read_b128 a[16:19], v40 offset:36864
    ds_read_b128 a[20:23], v41 offset:36864
    ds_read_b128 a[24:27], v40 offset:38912
    ds_read_b128 a[28:31], v41 offset:38912
    ds_read_b128 a[36:39], v40 offset:40960
    ds_read_b128 a[40:43], v41 offset:40960
    ds_read_b128 a[44:47], v40 offset:43008
    ds_read_b128 a[52:55], v41 offset:43008
    ds_read_b128 a[56:59], v40 offset:45056
    ds_read_b128 a[60:63], v41 offset:45056
    ds_read_b128 a[68:71], v40 offset:47104
    ds_read_b128 a[72:75], v41 offset:47104
    s_mov_b32 s79, 0
L_poll0:
    buffer_load_dwordx2 v[6:7], v5, s[12:15], s78 offen sc1
    s_add_u32 s79, s79, 1
    s_cmp_gt_u32 s79, 20000
    s_cbranch_scc1 L_go0
    s_waitcnt vmcnt(0)
    v_cmp_ne_u64 vcc, s[76:77], v[6:7]
    s_cbranch_vccnz L_poll0
L_go0:
    s_mov_b32 s40, 0
    buffer_load_dwordx3 v[64:66], v32, s[12:15], s40 offen sc1
    buffer_load_dword v67, v34, s[12:15], s40 offen sc1
    s_mov_b32 s41, 4096
    buffer_load_dwordx3 v[68:70], v32, s[12:15], s41 offen sc1
    buffer_load_dword v71, v34, s[12:15], s41 offen sc1
    s_mov_b32 s42, 0
    buffer_load_dwordx3 v[72:74], v33, s[12:15], s42 offen sc1
    s_mov_b32 s43, 4096
    buffer_load_dwordx3 v[76:78], v33, s[12:15], s43 offen sc1
    s_mov_b32 s44, 16384
    buffer_load_dwordx3 v[80:82], v32, s[12:15], s44 offen sc1
    buffer_load_dword v83, v34, s[12:15], s44 offen sc1
    s_mov_b32 s45, 20480
    buffer_load_dwordx3 v[84:86], v32, s[12:15], s45 offen sc1
    buffer_load_dword v87, v34, s[12:15], s45 offen sc1
    s_sub_u32 s70, s78, 128
    v_or_b32 v16, s60, v2
    v_min_u32 v16, 1, v16
    v_lshlrev_b32 v16, 30, v16
    v_lshl_or_b32 v160, v164, 4, v160
    v_lshl_or_b32 v161, v165, 4, v161
    v_lshl_or_b32 v162, v166, 4, v162
    v_lshl_or_b32 v163, v167, 4, v163
    v_lshl_or_b32 v168, v172, 4, v168
    v_lshl_or_b32 v169, v173, 4, v169
    v_lshl_or_b32 v170, v174, 4, v170
    v_lshl_or_b32 v171, v175, 4, v171
    v_lshl_or_b32 v160, v168, 8, v160
    v_lshl_or_b32 v161, v169, 8, v161
    v_lshl_or_b32 v162, v170, 8, v162
    v_lshl_or_b32 v163, v171, 8, v163
    v_lshl_or_b32 v176, v180, 4, v176
    v_lshl_or_b32 v177, v181, 4, v177
    v_lshl_or_b32 v178, v182, 4, v178
    v_lshl_or_b32 v179, v183, 4, v179
    v_lshl_or_b32 v184, v188, 4, v184
    v_lshl_or_b32 v185, v189, 4, v185
    v_lshl_or_b32 v186, v190, 4, v186
    v_lshl_or_b32 v187, v191, 4, v187
    v_lshl_or_b32 v176, v184, 8, v176
    v_lshl_or_b32 v177, v185, 8, v177
    v_lshl_or_b32 v178, v186, 8, v178
    v_lshl_or_b32 v179, v187, 8, v179
    v_lshl_or_b32 v160, v176, 16, v160
    v_lshl_or_b32 v161, v177, 16, v161
    v_lshl_or_b32 v162, v178, 16, v162
    v_lshl_or_b32 v163, v179, 16, v163
    buffer_store_dwordx4 v[160:163], v18, s[12:15], s62 offen sc1
    buffer_store_dwordx2 v[20:21], v16, s[12:15], s70 offen sc1
    s_add_u32 s78, s78, 512
    s_waitcnt vmcnt(11)
    v_perm_b32 v56, v64, v35, s36
    v_perm_b32 v57, v64, v35, s37
    v_perm_b32 v58, v64, v35, s38
    v_perm_b32 v59, v64, v35, s39
    s_waitcnt vmcnt(9)
    v_perm_b32 v60, v68, v35, s36
    v_perm_b32 v61, v68, v35, s37
    v_perm_b32 v62, v68, v35, s38
    v_perm_b32 v63, v68, v35, s39
    ds_read_b32 a32, v56
    ds_read_b32 a33, v57
    ds_read_b32 a34, v58
    ds_read_b32 a35, v59
    ds_read_b32 a48, v60
    ds_read_b32 a49, v61
    ds_read_b32 a50, v62
    ds_read_b32 a51, v63
    v_perm_b32 v8, v65, v35, s36
    v_perm_b32 v9, v65, v35, s37
    v_perm_b32 v10, v65, v35, s38
    v_perm_b32 v11, v65, v35, s39
    v_perm_b32 v12, v69, v35, s36
    ds_read_b32 a64, v8
    ds_read_b32 a65, v9
    ds_read_b32 a66, v10
    ds_read_b32 a67, v11
    s_waitcnt lgkmcnt(8)
    v_mfma_f32_16x16x32_bf16 v[128:131], a[32:35], a[0:3], 0
    s_waitcnt lgkmcnt(4)
    ds_read_b32 a76, v12
    v_perm_b32 v13, v69, v35, s37
    v_mfma_f32_16x16x32_bf16 v[128:131], a[48:51], a[4:7], v[128:131]
    ds_read_b128 a[80:83], v42 offset:34816
    v_mfma_f32_16x16x32_bf16 v[132:135], a[32:35], a[8:11], 0
    ds_read_b32 a77, v13
    v_perm_b32 v14, v69, v35, s38
    v_mfma_f32_16x16x32_bf16 v[132:135], a[48:51], a[12:15], v[132:135]
    s_add_u32 s56, s55, 512
    ds_read_b128 a[84:87], v43 offset:34816
    v_mfma_f32_16x16x32_bf16 v[136:139], a[32:35], a[16:19], 0
    s_add_u32 m0, s57, 0
    ds_read_b32 a78, v14
    v_perm_b32 v15, v69, v35, s39
    v_mfma_f32_16x16x32_bf16 v[136:139], a[48:51], a[20:23], v[136:139]
    buffer_load_dwordx4 v36, s[8:11], s56 offen offset:0 lds
    v_mfma_f32_16x16x32_bf16 v[140:143], a[32:35], a[24:27], 0
    ds_read_b32 a79, v15
    v_perm_b32 v56, v66, v35, s36
    v_mfma_f32_16x16x32_bf16 v[140:143], a[48:51], a[28:31], v[140:143]
    ds_read_b128 a[88:91], v42 offset:32768
    v_mfma_f32_16x16x32_bf16 v[144:147], a[32:35], a[36:39], 0
    ds_read_b32 a92, v56
    v_perm_b32 v57, v66, v35, s37
    v_mfma_f32_16x16x32_bf16 v[144:147], a[48:51], a[40:43], v[144:147]
    ds_read_b128 a[96:99], v43 offset:32768
    v_mfma_f32_16x16x32_bf16 v[148:151], a[32:35], a[44:47], 0
    ds_read_b32 a93, v57
    v_perm_b32 v58, v66, v35, s38
    v_mfma_f32_16x16x32_bf16 v[148:151], a[48:51], a[52:55], v[148:151]
    buffer_load_dwordx4 v37, s[8:11], s56 offen offset:1024 lds
    v_mfma_f32_16x16x32_bf16 v[152:155], a[32:35], a[56:59], 0
    ds_read_b32 a94, v58
    v_perm_b32 v59, v66, v35, s39
    v_mfma_f32_16x16x32_bf16 v[152:155], a[48:51], a[60:63], v[152:155]
    ds_read_b128 a[100:103], v42 offset:38912
    v_mfma_f32_16x16x32_bf16 v[156:159], a[32:35], a[68:71], 0
    ds_read_b32 a95, v59
    v_perm_b32 v60, v70, v35, s36
    v_mfma_f32_16x16x32_bf16 v[156:159], a[48:51], a[72:75], v[156:159]
    s_waitcnt lgkmcnt(7)
    ds_read_b128 a[104:107], v43 offset:38912
    v_mfma_f32_16x16x32_bf16 v[160:163], a[64:67], a[0:3], 0
    ds_read_b32 a108, v60
    v_perm_b32 v61, v70, v35, s37
    v_mfma_f32_16x16x32_bf16 v[160:163], a[76:79], a[4:7], v[160:163]
    buffer_load_dwordx4 v38, s[8:11], s56 offen offset:2048 lds
    v_mfma_f32_16x16x32_bf16 v[164:167], a[64:67], a[8:11], 0
    ds_read_b32 a109, v61
    v_perm_b32 v62, v70, v35, s38
    v_mfma_f32_16x16x32_bf16 v[164:167], a[76:79], a[12:15], v[164:167]
    ds_read_b128 a[112:115], v42 offset:36864
    v_mfma_f32_16x16x32_bf16 v[168:171], a[64:67], a[16:19], 0
    ds_read_b32 a110, v62
    v_perm_b32 v63, v70, v35, s39
    v_mfma_f32_16x16x32_bf16 v[168:171], a[76:79], a[20:23], v[168:171]
    ds_read_b128 a[116:119], v43 offset:36864
    v_mfma_f32_16x16x32_bf16 v[172:175], a[64:67], a[24:27], 0
    ds_read_b32 a111, v63
    v_perm_b32 v8, v67, v35, s36
    v_mfma_f32_16x16x32_bf16 v[172:175], a[76:79], a[28:31], v[172:175]
    buffer_load_dwordx4 v39, s[8:11], s56 offen offset:3072 lds
    v_mfma_f32_16x16x32_bf16 v[176:179], a[64:67], a[36:39], 0
    ds_read_b32 a120, v8
    v_perm_b32 v9, v67, v35, s37
    v_mfma_f32_16x16x32_bf16 v[176:179], a[76:79], a[40:43], v[176:179]
    ds_read_b128 a[124:127], v42 offset:43008
    v_mfma_f32_16x16x32_bf16 v[180:183], a[64:67], a[44:47], 0
    ds_read_b32 a121, v9
    v_perm_b32 v10, v67, v35, s38
    v_mfma_f32_16x16x32_bf16 v[180:183], a[76:79], a[52:55], v[180:183]
    s_add_u32 s56, s55, 640
    ds_read_b128 a[128:131], v43 offset:43008
    v_mfma_f32_16x16x32_bf16 v[184:187], a[64:67], a[56:59], 0
    s_add_u32 m0, s57, 18432
    ds_read_b32 a122, v10
    v_perm_b32 v11, v67, v35, s39
    v_mfma_f32_16x16x32_bf16 v[184:187], a[76:79], a[60:63], v[184:187]
    buffer_load_dwordx4 v36, s[8:11], s56 offen offset:0 lds
    v_mfma_f32_16x16x32_bf16 v[188:191], a[64:67], a[68:71], 0
    s_waitcnt vmcnt(13)
    ds_read_b32 a123, v11
    v_perm_b32 v12, v71, v35, s36
    v_mfma_f32_16x16x32_bf16 v[188:191], a[76:79], a[72:75], v[188:191]
    s_waitcnt lgkmcnt(6)
    ds_read_b128 a[132:135], v42 offset:40960
    v_mfma_f32_16x16x32_bf16 v[192:195], a[92:95], a[0:3], 0
    ds_read_b32 a136, v12
    v_perm_b32 v13, v71, v35, s37
    v_mfma_f32_16x16x32_bf16 v[192:195], a[108:111], a[4:7], v[192:195]
    ds_read_b128 a[140:143], v43 offset:40960
    v_mfma_f32_16x16x32_bf16 v[196:199], a[92:95], a[8:11], 0
    ds_read_b32 a137, v13
    v_perm_b32 v14, v71, v35, s38
    v_mfma_f32_16x16x32_bf16 v[196:199], a[108:111], a[12:15], v[196:199]
    buffer_load_dwordx4 v37, s[8:11], s56 offen offset:1024 lds
    v_mfma_f32_16x16x32_bf16 v[200:203], a[92:95], a[16:19], 0
    ds_read_b32 a138, v14
    v_perm_b32 v15, v71, v35, s39
    v_mfma_f32_16x16x32_bf16 v[200:203], a[108:111], a[20:23], v[200:203]
    ds_read_b128 a[144:147], v42 offset:47104
    v_mfma_f32_16x16x32_bf16 v[204:207], a[92:95], a[24:27], 0
    s_waitcnt vmcnt(13)
    ds_read_b32 a139, v15
    v_perm_b32 v56, v72, v35, s36
    v_mfma_f32_16x16x32_bf16 v[204:207], a[108:111], a[28:31], v[204:207]
    ds_read_b128 a[148:151], v43 offset:47104
    v_mfma_f32_16x16x32_bf16 v[208:211], a[92:95], a[36:39], 0
    s_add_u32 m0, s57, 14336
    ds_read_b32 a152, v56
    v_perm_b32 v57, v72, v35, s37
    v_mfma_f32_16x16x32_bf16 v[208:211], a[108:111], a[40:43], v[208:211]
    buffer_load_dwordx4 v38, s[8:11], s56 offen offset:2048 lds
    v_mfma_f32_16x16x32_bf16 v[212:215], a[92:95], a[44:47], 0
    ds_read_b32 a153, v57
    v_perm_b32 v58, v72, v35, s38
    v_mfma_f32_16x16x32_bf16 v[212:215], a[108:111], a[52:55], v[212:215]
    ds_read_b128 a[156:159], v42 offset:45056
    v_mfma_f32_16x16x32_bf16 v[216:219], a[92:95], a[56:59], 0
    ds_read_b32 a154, v58
    v_perm_b32 v59, v72, v35, s39
    v_mfma_f32_16x16x32_bf16 v[216:219], a[108:111], a[60:63], v[216:219]
    ds_read_b128 a[160:163], v43 offset:45056
    v_mfma_f32_16x16x32_bf16 v[220:223], a[92:95], a[68:71], 0
    s_waitcnt vmcnt(13)
    ds_read_b32 a155, v59
    v_perm_b32 v60, v76, v35, s36
    v_mfma_f32_16x16x32_bf16 v[220:223], a[108:111], a[72:75], v[220:223]
    s_waitcnt lgkmcnt(7)
    buffer_load_dwordx4 v39, s[8:11], s56 offen offset:3072 lds
    v_mfma_f32_16x16x32_bf16 v[224:227], a[120:123], a[0:3], 0
    s_mov_b32 s46, 49152
    ds_read_b32 a164, v60
    v_perm_b32 v61, v76, v35, s37
    v_mfma_f32_16x16x32_bf16 v[224:227], a[136:139], a[4:7], v[224:227]
    buffer_load_dwordx3 v[88:90], v32, s[12:15], s46 offen sc1
    v_mfma_f32_16x16x32_bf16 v[228:231], a[120:123], a[8:11], 0
    ds_read_b32 a165, v61
    v_perm_b32 v62, v76, v35, s38
    v_mfma_f32_16x16x32_bf16 v[228:231], a[136:139], a[12:15], v[228:231]
    s_waitcnt vmcnt(10)
    buffer_store_dwordx2 v[20:21], v19, s[12:15], 0 offen offset:0 sc1
    v_mfma_f32_16x16x32_bf16 v[232:235], a[120:123], a[16:19], 0
    ds_read_b32 a166, v62
    v_perm_b32 v63, v76, v35, s39
    v_mfma_f32_16x16x32_bf16 v[232:235], a[136:139], a[20:23], v[232:235]
    buffer_load_dword v91, v34, s[12:15], s46 offen sc1
    v_mfma_f32_16x16x32_bf16 v[236:239], a[120:123], a[24:27], 0
    s_mov_b32 s47, 53248
    ds_read_b32 a167, v63
    v_perm_b32 v8, v73, v35, s36
    v_mfma_f32_16x16x32_bf16 v[236:239], a[136:139], a[28:31], v[236:239]
    buffer_load_dwordx3 v[92:94], v32, s[12:15], s47 offen sc1
    v_mfma_f32_16x16x32_bf16 v[240:243], a[120:123], a[36:39], 0
    ds_read_b32 a168, v8
    v_perm_b32 v9, v73, v35, s37
    v_mfma_f32_16x16x32_bf16 v[240:243], a[136:139], a[40:43], v[240:243]
    buffer_load_dword v95, v34, s[12:15], s47 offen sc1
    v_mfma_f32_16x16x32_bf16 v[244:247], a[120:123], a[44:47], 0
    s_mov_b32 s40, 16384
    ds_read_b32 a169, v9
    v_perm_b32 v10, v73, v35, s38
    v_mfma_f32_16x16x32_bf16 v[244:247], a[136:139], a[52:55], v[244:247]
    buffer_load_dwordx3 v[96:98], v33, s[12:15], s40 offen sc1
    v_mfma_f32_16x16x32_bf16 v[248:251], a[120:123], a[56:59], 0
    s_mov_b32 s41, 20480
    ds_read_b32 a170, v10
    v_perm_b32 v11, v73, v35, s39
    v_mfma_f32_16x16x32_bf16 v[248:251], a[136:139], a[60:63], v[248:251]
    buffer_load_dwordx3 v[100:102], v33, s[12:15], s41 offen sc1
    v_mfma_f32_16x16x32_bf16 v[252:255], a[120:123], a[68:71], 0
    s_mov_b32 s42, 49152
    ds_read_b32 a171, v11
    v_perm_b32 v12, v77, v35, s36
    v_mfma_f32_16x16x32_bf16 v[252:255], a[136:139], a[72:75], v[252:255]
    s_waitcnt lgkmcnt(4)
    s_barrier
    buffer_load_dwordx3 v[104:106], v33, s[12:15], s42 offen sc1
    v_mfma_f32_16x16x32_bf16 v[128:131], a[152:155], a[80:83], v[128:131]
    ds_read_b32 a172, v12
    v_perm_b32 v13, v77, v35, s37
    v_mfma_f32_16x16x32_bf16 v[128:131], a[164:167], a[84:87], v[128:131]
    ds_read_b128 a[176:179], v44 offset:0
    v_mfma_f32_16x16x32_bf16 v[132:135], a[152:155], a[88:91], v[132:135]
    ds_read_b32 a173, v13
    v_perm_b32 v14, v77, v35, s38
    v_mfma_f32_16x16x32_bf16 v[132:135], a[164:167], a[96:99], v[132:135]
    s_add_u32 s56, s55, 1024
    ds_read_b128 a[180:183], v45 offset:0
    v_mfma_f32_16x16x32_bf16 v[136:139], a[152:155], a[100:103], v[136:139]
    s_add_u32 m0, s57, 32768
    ds_read_b32 a174, v14
    v_perm_b32 v15, v77, v35, s39
    v_mfma_f32_16x16x32_bf16 v[136:139], a[164:167], a[104:107], v[136:139]
    buffer_load_dwordx4 v36, s[8:11], s56 offen offset:0 lds
    v_mfma_f32_16x16x32_bf16 v[140:143], a[152:155], a[112:115], v[140:143]
    ds_read_b32 a175, v15
    v_perm_b32 v56, v74, v35, s36
    v_mfma_f32_16x16x32_bf16 v[140:143], a[164:167], a[116:119], v[140:143]
    ds_read_b128 a[184:187], v44 offset:2048
    v_mfma_f32_16x16x32_bf16 v[144:147], a[152:155], a[124:127], v[144:147]
    ds_read_b32 a188, v56
    v_perm_b32 v57, v74, v35, s37
    v_mfma_f32_16x16x32_bf16 v[144:147], a[164:167], a[128:131], v[144:147]
    ds_read_b128 a[192:195], v45 offset:2048
    v_mfma_f32_16x16x32_bf16 v[148:151], a[152:155], a[132:135], v[148:151]
    ds_read_b32 a189, v57
    v_perm_b32 v58, v74, v35, s38
    v_mfma_f32_16x16x32_bf16 v[148:151], a[164:167], a[140:143], v[148:151]
    buffer_load_dwordx4 v37, s[8:11], s56 offen offset:1024 lds
    v_mfma_f32_16x16x32_bf16 v[152:155], a[152:155], a[144:147], v[152:155]
    ds_read_b32 a190, v58
    v_perm_b32 v59, v74, v35, s39
    v_mfma_f32_16x16x32_bf16 v[152:155], a[164:167], a[148:151], v[152:155]
    ds_read_b128 a[196:199], v44 offset:4096
    v_mfma_f32_16x16x32_bf16 v[156:159], a[152:155], a[156:159], v[156:159]
    ds_read_b32 a191, v59
    v_perm_b32 v60, v78, v35, s36
    v_mfma_f32_16x16x32_bf16 v[156:159], a[164:167], a[160:163], v[156:159]
    s_waitcnt lgkmcnt(7)
    ds_read_b128 a[200:203], v45 offset:4096
    v_mfma_f32_16x16x32_bf16 v[160:163], a[168:171], a[80:83], v[160:163]
    ds_read_b32 a204, v60
    v_perm_b32 v61, v78, v35, s37
    v_mfma_f32_16x16x32_bf16 v[160:163], a[172:175], a[84:87], v[160:163]
    buffer_load_dwordx4 v38, s[8:11], s56 offen offset:2048 lds
    v_mfma_f32_16x16x32_bf16 v[164:167], a[168:171], a[88:91], v[164:167]
    ds_read_b32 a205, v61
    v_perm_b32 v62, v78, v35, s38
    v_mfma_f32_16x16x32_bf16 v[164:167], a[172:175], a[96:99], v[164:167]
    ds_read_b128 a[208:211], v44 offset:6144
    v_mfma_f32_16x16x32_bf16 v[168:171], a[168:171], a[100:103], v[168:171]
    ds_read_b32 a206, v62
    v_perm_b32 v63, v78, v35, s39
    v_mfma_f32_16x16x32_bf16 v[168:171], a[172:175], a[104:107], v[168:171]
    ds_read_b128 a[212:215], v45 offset:6144
    v_mfma_f32_16x16x32_bf16 v[172:175], a[168:171], a[112:115], v[172:175]
    ds_read_b32 a207, v63
    v_perm_b32 v8, v80, v35, s36
    v_mfma_f32_16x16x32_bf16 v[172:175], a[172:175], a[116:119], v[172:175]
    buffer_load_dwordx4 v39, s[8:11], s56 offen offset:3072 lds
    v_mfma_f32_16x16x32_bf16 v[176:179], a[168:171], a[124:127], v[176:179]
    ds_read_b32 a216, v8
    v_perm_b32 v9, v80, v35, s37
    v_mfma_f32_16x16x32_bf16 v[176:179], a[172:175], a[128:131], v[176:179]
    ds_read_b128 a[220:223], v44 offset:8192
    v_mfma_f32_16x16x32_bf16 v[180:183], a[168:171], a[132:135], v[180:183]
    ds_read_b32 a217, v9
    v_perm_b32 v10, v80, v35, s38
    v_mfma_f32_16x16x32_bf16 v[180:183], a[172:175], a[140:143], v[180:183]
    s_add_u32 s56, s55, 1152
    ds_read_b128 a[224:227], v45 offset:8192
    v_mfma_f32_16x16x32_bf16 v[184:187], a[168:171], a[144:147], v[184:187]
    s_add_u32 m0, s57, 51200
    ds_read_b32 a218, v10
    v_perm_b32 v11, v80, v35, s39
    v_mfma_f32_16x16x32_bf16 v[184:187], a[172:175], a[148:151], v[184:187]
    buffer_load_dwordx4 v36, s[8:11], s56 offen offset:0 lds
    v_mfma_f32_16x16x32_bf16 v[188:191], a[168:171], a[156:159], v[188:191]
    ds_read_b32 a219, v11
    v_perm_b32 v12, v84, v35, s36
    v_mfma_f32_16x16x32_bf16 v[188:191], a[172:175], a[160:163], v[188:191]
    s_waitcnt lgkmcnt(6)
    ds_read_b128 a[228:231], v44 offset:10240
    v_mfma_f32_16x16x32_bf16 v[192:195], a[188:191], a[80:83], v[192:195]
    ds_read_b32 a232, v12
    v_perm_b32 v13, v84, v35, s37
    v_mfma_f32_16x16x32_bf16 v[192:195], a[204:207], a[84:87], v[192:195]
    ds_read_b128 a[236:239], v45 offset:10240
    v_mfma_f32_16x16x32_bf16 v[196:199], a[188:191], a[88:91], v[196:199]
    ds_read_b32 a233, v13
    v_perm_b32 v14, v84, v35, s38
    v_mfma_f32_16x16x32_bf16 v[196:199], a[204:207], a[96:99], v[196:199]
    s_waitcnt vmcnt(10)
    buffer_load_dwordx4 v37, s[8:11], s56 offen offset:1024 lds
    v_perm_b32 v15, v91, v35, s36
    v_mfma_f32_16x16x32_bf16 v[200:203], a[188:191], a[100:103], v[200:203]
    ds_read_b32 a234, v14
    v_perm_b32 v56, v84, v35, s39
    v_mfma_f32_16x16x32_bf16 v[200:203], a[204:207], a[104:107], v[200:203]
    ds_read_b128 a[240:243], v44 offset:12288
    ds_read_b32 a244, v15
    v_mfma_f32_16x16x32_bf16 v[204:207], a[188:191], a[112:115], v[204:207]
    ds_read_b32 a235, v56
    v_perm_b32 v57, v81, v35, s36
    v_mfma_f32_16x16x32_bf16 v[204:207], a[204:207], a[116:119], v[204:207]
    ds_read_b128 a[248:251], v45 offset:12288
    v_mfma_f32_16x16x32_bf16 v[208:211], a[188:191], a[124:127], v[208:211]
    s_add_u32 m0, s57, 47104
    ds_read_b32 a252, v57
    v_perm_b32 v58, v81, v35, s37
    v_mfma_f32_16x16x32_bf16 v[208:211], a[204:207], a[128:131], v[208:211]
    buffer_load_dwordx4 v38, s[8:11], s56 offen offset:2048 lds
    v_perm_b32 v59, v91, v35, s37
    v_mfma_f32_16x16x32_bf16 v[212:215], a[188:191], a[132:135], v[212:215]
    ds_read_b32 a253, v58
    ds_read_b32 a245, v59
    v_mfma_f32_16x16x32_bf16 v[212:215], a[204:207], a[140:143], v[212:215]
    ds_read_b128 a[32:35], v44 offset:14336
    v_perm_b32 v60, v81, v35, s38
    v_mfma_f32_16x16x32_bf16 v[216:219], a[188:191], a[144:147], v[216:219]
    ds_read_b32 a254, v60
    v_perm_b32 v61, v81, v35, s39
    v_mfma_f32_16x16x32_bf16 v[216:219], a[204:207], a[148:151], v[216:219]
    ds_read_b128 a[48:51], v45 offset:14336
    v_mfma_f32_16x16x32_bf16 v[220:223], a[188:191], a[156:159], v[220:223]
    ds_read_b32 a255, v61
    v_perm_b32 v62, v85, v35, s36
    v_mfma_f32_16x16x32_bf16 v[220:223], a[204:207], a[160:163], v[220:223]
    s_waitcnt lgkmcnt(8)
    buffer_load_dwordx4 v39, s[8:11], s56 offen offset:3072 lds
    v_perm_b32 v63, v91, v35, s38
    v_mfma_f32_16x16x32_bf16 v[128:131], a[216:219], a[176:179], v[128:131]
    ds_read_b32 a64, v62
    ds_read_b32 a246, v63
    v_mfma_f32_16x16x32_bf16 v[128:131], a[232:235], a[180:183], v[128:131]
    ds_read_b128 a[76:79], v46 offset:2048
    v_perm_b32 v8, v85, v35, s37
    v_mfma_f32_16x16x32_bf16 v[132:135], a[216:219], a[184:187], v[132:135]
    ds_read_b32 a65, v8
    v_perm_b32 v9, v85, v35, s38
    v_mfma_f32_16x16x32_bf16 v[132:135], a[232:235], a[192:195], v[132:135]
    ds_read_b128 a[92:95], v47 offset:2048
    v_perm_b32 v10, v91, v35, s39
    v_mfma_f32_16x16x32_bf16 v[136:139], a[216:219], a[196:199], v[136:139]
    ds_read_b32 a66, v9
    v_perm_b32 v11, v85, v35, s39
    v_mfma_f32_16x16x32_bf16 v[136:139], a[232:235], a[200:203], v[136:139]
    ds_read_b32 a247, v10
    v_mfma_f32_16x16x32_bf16 v[140:143], a[216:219], a[208:211], v[140:143]
    ds_read_b32 a67, v11
    v_perm_b32 v12, v82, v35, s36
    v_mfma_f32_16x16x32_bf16 v[140:143], a[232:235], a[212:215], v[140:143]
    ds_read_b128 a[108:111], v46 offset:0
    v_mfma_f32_16x16x32_bf16 v[144:147], a[216:219], a[220:223], v[144:147]
    ds_read_b32 a0, v12
    v_perm_b32 v13, v82, v35, s37
    v_mfma_f32_16x16x32_bf16 v[144:147], a[232:235], a[224:227], v[144:147]
    s_waitcnt vmcnt(11)
    ds_read_b128 a[4:7], v47 offset:0
    v_perm_b32 v14, v95, v35, s36
    v_mfma_f32_16x16x32_bf16 v[148:151], a[216:219], a[228:231], v[148:151]
    ds_read_b32 a1, v13
    v_perm_b32 v15, v82, v35, s38
    v_mfma_f32_16x16x32_bf16 v[148:151], a[232:235], a[236:239], v[148:151]
    ds_read_b32 a8, v14
    v_mfma_f32_16x16x32_bf16 v[152:155], a[216:219], a[240:243], v[152:155]
    s_waitcnt lgkmcnt(8)
    ds_read_b32 a2, v15
    v_perm_b32 v56, v82, v35, s39
    v_mfma_f32_16x16x32_bf16 v[152:155], a[232:235], a[248:251], v[152:155]
    ds_read_b128 a[12:15], v46 offset:6144
    v_mfma_f32_16x16x32_bf16 v[156:159], a[216:219], a[32:35], v[156:159]
    ds_read_b32 a3, v56
    v_perm_b32 v57, v86, v35, s36
    v_mfma_f32_16x16x32_bf16 v[156:159], a[232:235], a[48:51], v[156:159]
    ds_read_b128 a[16:19], v47 offset:6144
    v_perm_b32 v58, v95, v35, s37
    v_mfma_f32_16x16x32_bf16 v[160:163], a[252:255], a[176:179], v[160:163]
    s_waitcnt lgkmcnt(8)
    ds_read_b32 a20, v57
    v_perm_b32 v59, v86, v35, s37
    v_mfma_f32_16x16x32_bf16 v[160:163], a[64:67], a[180:183], v[160:163]
    ds_read_b32 a9, v58
    v_mfma_f32_16x16x32_bf16 v[164:167], a[252:255], a[184:187], v[164:167]
    ds_read_b32 a21, v59
    v_perm_b32 v60, v86, v35, s38
    v_mfma_f32_16x16x32_bf16 v[164:167], a[64:67], a[192:195], v[164:167]
    ds_read_b128 a[24:27], v46 offset:4096
    v_mfma_f32_16x16x32_bf16 v[168:171], a[252:255], a[196:199], v[168:171]
    ds_read_b32 a22, v60
    v_perm_b32 v61, v86, v35, s39
    v_mfma_f32_16x16x32_bf16 v[168:171], a[64:67], a[200:203], v[168:171]
    ds_read_b128 a[28:31], v47 offset:4096
    v_perm_b32 v62, v95, v35, s38
    v_mfma_f32_16x16x32_bf16 v[172:175], a[252:255], a[208:211], v[172:175]
    ds_read_b32 a23, v61
    v_perm_b32 v63, v83, v35, s36
    v_mfma_f32_16x16x32_bf16 v[172:175], a[64:67], a[212:215], v[172:175]
    ds_read_b32 a10, v62
    v_mfma_f32_16x16x32_bf16 v[176:179], a[252:255], a[220:223], v[176:179]
    ds_read_b32 a36, v63
    v_perm_b32 v8, v83, v35, s37
    v_mfma_f32_16x16x32_bf16 v[176:179], a[64:67], a[224:227], v[176:179]
    ds_read_b128 a[40:43], v46 offset:10240
    v_mfma_f32_16x16x32_bf16 v[180:183], a[252:255], a[228:231], v[180:183]
    ds_read_b32 a37, v8
    v_perm_b32 v9, v83, v35, s38
    v_mfma_f32_16x16x32_bf16 v[180:183], a[64:67], a[236:239], v[180:183]
    ds_read_b128 a[44:47], v47 offset:10240
    v_perm_b32 v10, v95, v35, s39
    v_mfma_f32_16x16x32_bf16 v[184:187], a[252:255], a[240:243], v[184:187]
    ds_read_b32 a38, v9
    v_perm_b32 v11, v83, v35, s39
    v_mfma_f32_16x16x32_bf16 v[184:187], a[64:67], a[248:251], v[184:187]
    ds_read_b32 a11, v10
    v_mfma_f32_16x16x32_bf16 v[188:191], a[252:255], a[32:35], v[188:191]
    ds_read_b32 a39, v11
    v_perm_b32 v12, v87, v35, s36
    v_mfma_f32_16x16x32_bf16 v[188:191], a[64:67], a[48:51], v[188:191]
    s_waitcnt lgkmcnt(8)
    ds_read_b128 a[52:55], v46 offset:8192
    v_mfma_f32_16x16x32_bf16 v[192:195], a[0:3], a[176:179], v[192:195]
    ds_read_b32 a56, v12
    v_perm_b32 v13, v87, v35, s37
    v_mfma_f32_16x16x32_bf16 v[192:195], a[20:23], a[180:183], v[192:195]
    ds_read_b128 a[60:63], v47 offset:8192
    v_perm_b32 v14, v88, v35, s36
    v_mfma_f32_16x16x32_bf16 v[196:199], a[0:3], a[184:187], v[196:199]
    ds_read_b32 a57, v13
    v_perm_b32 v15, v87, v35, s38
    v_mfma_f32_16x16x32_bf16 v[196:199], a[20:23], a[192:195], v[196:199]
    ds_read_b32 a68, v14
    v_mfma_f32_16x16x32_bf16 v[200:203], a[0:3], a[196:199], v[200:203]
    ds_read_b32 a58, v15
    v_perm_b32 v56, v87, v35, s39
    v_mfma_f32_16x16x32_bf16 v[200:203], a[20:23], a[200:203], v[200:203]
    ds_read_b128 a[120:123], v46 offset:14336
    v_mfma_f32_16x16x32_bf16 v[204:207], a[0:3], a[208:211], v[204:207]
    s_waitcnt vmcnt(10)
    ds_read_b32 a59, v56
    v_perm_b32 v57, v96, v35, s36
    v_mfma_f32_16x16x32_bf16 v[204:207], a[20:23], a[212:215], v[204:207]
    ds_read_b128 a[72:75], v47 offset:14336
    v_perm_b32 v58, v88, v35, s37
    v_mfma_f32_16x16x32_bf16 v[208:211], a[0:3], a[220:223], v[208:211]
    ds_read_b32 a136, v57
    v_perm_b32 v59, v96, v35, s37
    v_mfma_f32_16x16x32_bf16 v[208:211], a[20:23], a[224:227], v[208:211]
    ds_read_b32 a69, v58
    v_mfma_f32_16x16x32_bf16 v[212:215], a[0:3], a[228:231], v[212:215]
    ds_read_b32 a137, v59
    v_perm_b32 v60, v96, v35, s38
    v_mfma_f32_16x16x32_bf16 v[212:215], a[20:23], a[236:239], v[212:215]
    ds_read_b128 a[152:155], v46 offset:12288
    v_mfma_f32_16x16x32_bf16 v[216:219], a[0:3], a[240:243], v[216:219]
    ds_read_b32 a138, v60
    v_perm_b32 v61, v96, v35, s39
    v_mfma_f32_16x16x32_bf16 v[216:219], a[20:23], a[248:251], v[216:219]
    ds_read_b128 a[164:167], v47 offset:12288
    v_perm_b32 v62, v88, v35, s38
    v_mfma_f32_16x16x32_bf16 v[220:223], a[0:3], a[32:35], v[220:223]
    s_waitcnt vmcnt(9)
    ds_read_b32 a139, v61
    v_perm_b32 v63, v100, v35, s36
    v_mfma_f32_16x16x32_bf16 v[220:223], a[20:23], a[48:51], v[220:223]
    s_waitcnt lgkmcnt(8)
    ds_read_b32 a70, v62
    v_mfma_f32_16x16x32_bf16 v[224:227], a[36:39], a[176:179], v[224:227]
    ds_read_b32 a168, v63
    v_perm_b32 v8, v100, v35, s37
    v_mfma_f32_16x16x32_bf16 v[224:227], a[56:59], a[180:183], v[224:227]
    buffer_load_dwordx2 v[6:7], v5, s[12:15], s78 offen sc1
    v_mfma_f32_16x16x32_bf16 v[228:231], a[36:39], a[184:187], v[228:231]
    s_mov_b32 s43, 32768
    ds_read_b32 a169, v8
    v_perm_b32 v9, v100, v35, s38
    v_mfma_f32_16x16x32_bf16 v[228:231], a[56:59], a[192:195], v[228:231]
    buffer_load_dwordx3 v[108:110], v32, s[12:15], s43 offen sc1
    v_perm_b32 v10, v88, v35, s39
    v_mfma_f32_16x16x32_bf16 v[232:235], a[36:39], a[196:199], v[232:235]
    ds_read_b32 a170, v9
    v_perm_b32 v11, v100, v35, s39
    v_mfma_f32_16x16x32_bf16 v[232:235], a[56:59], a[200:203], v[232:235]
    ds_read_b32 a71, v10
    v_mfma_f32_16x16x32_bf16 v[236:239], a[36:39], a[208:211], v[236:239]
    ds_read_b32 a171, v11
    v_perm_b32 v12, v97, v35, s36
    v_mfma_f32_16x16x32_bf16 v[236:239], a[56:59], a[212:215], v[236:239]
    buffer_load_dword v111, v34, s[12:15], s43 offen sc1
    v_mfma_f32_16x16x32_bf16 v[240:243], a[36:39], a[220:223], v[240:243]
    s_mov_b32 s44, 36864
    ds_read_b32 a172, v12
    v_perm_b32 v13, v97, v35, s37
    v_mfma_f32_16x16x32_bf16 v[240:243], a[56:59], a[224:227], v[240:243]
    buffer_load_dwordx3 v[112:114], v32, s[12:15], s44 offen sc1
    v_perm_b32 v14, v92, v35, s36
    v_mfma_f32_16x16x32_bf16 v[244:247], a[36:39], a[228:231], v[244:247]
    ds_read_b32 a173, v13
    v_perm_b32 v15, v97, v35, s38
    v_mfma_f32_16x16x32_bf16 v[244:247], a[56:59], a[236:239], v[244:247]
    ds_read_b32 a80, v14
    v_mfma_f32_16x16x32_bf16 v[248:251], a[36:39], a[240:243], v[248:251]
    ds_read_b32 a174, v15
    v_perm_b32 v56, v97, v35, s39
    v_mfma_f32_16x16x32_bf16 v[248:251], a[56:59], a[248:251], v[248:251]
    s_waitcnt lgkmcnt(6)
    buffer_load_dword v115, v34, s[12:15], s44 offen sc1
    v_mfma_f32_16x16x32_bf16 v[252:255], a[36:39], a[32:35], v[252:255]
    s_mov_b32 s45, 53248
    ds_read_b32 a175, v56
    v_perm_b32 v57, v101, v35, s36
    v_mfma_f32_16x16x32_bf16 v[252:255], a[56:59], a[48:51], v[252:255]
    s_barrier
    buffer_load_dwordx3 v[116:118], v33, s[12:15], s45 offen sc1
    v_perm_b32 v58, v92, v35, s37
    v_mfma_f32_16x16x32_bf16 v[128:131], a[136:139], a[76:79], v[128:131]
    s_waitcnt lgkmcnt(5)
    ds_read_b32 a84, v57
    v_perm_b32 v59, v101, v35, s37
    v_mfma_f32_16x16x32_bf16 v[128:131], a[168:171], a[92:95], v[128:131]
    ds_read_b128 a[88:91], v40 offset:0
    ds_read_b32 a81, v58
    v_mfma_f32_16x16x32_bf16 v[132:135], a[136:139], a[108:111], v[132:135]
    ds_read_b32 a85, v59
    v_perm_b32 v60, v101, v35, s38
    v_mfma_f32_16x16x32_bf16 v[132:135], a[168:171], a[4:7], v[132:135]
    s_add_u32 s56, s55, 1280
    ds_read_b128 a[96:99], v41 offset:0
    v_mfma_f32_16x16x32_bf16 v[136:139], a[136:139], a[12:15], v[136:139]
    s_add_u32 m0, s57, 65536
    ds_read_b32 a86, v60
    v_perm_b32 v61, v101, v35, s39
    v_mfma_f32_16x16x32_bf16 v[136:139], a[168:171], a[16:19], v[136:139]
    buffer_load_dwordx4 v36, s[8:11], s56 offen offset:0 lds
    v_perm_b32 v62, v92, v35, s38
    v_mfma_f32_16x16x32_bf16 v[140:143], a[136:139], a[24:27], v[140:143]
    ds_read_b32 a87, v61
    v_perm_b32 v63, v98, v35, s36
    v_mfma_f32_16x16x32_bf16 v[140:143], a[168:171], a[28:31], v[140:143]
    ds_read_b128 a[100:103], v40 offset:2048
    ds_read_b32 a82, v62
    v_mfma_f32_16x16x32_bf16 v[144:147], a[136:139], a[40:43], v[144:147]
    ds_read_b32 a104, v63
    v_perm_b32 v8, v98, v35, s37
    v_mfma_f32_16x16x32_bf16 v[144:147], a[168:171], a[44:47], v[144:147]
    ds_read_b128 a[112:115], v41 offset:2048
    v_mfma_f32_16x16x32_bf16 v[148:151], a[136:139], a[52:55], v[148:151]
    ds_read_b32 a105, v8
    v_perm_b32 v9, v98, v35, s38
    v_mfma_f32_16x16x32_bf16 v[148:151], a[168:171], a[60:63], v[148:151]
    buffer_load_dwordx4 v37, s[8:11], s56 offen offset:1024 lds
    v_perm_b32 v10, v92, v35, s39
    v_mfma_f32_16x16x32_bf16 v[152:155], a[136:139], a[120:123], v[152:155]
    ds_read_b32 a106, v9
    v_perm_b32 v11, v98, v35, s39
    v_mfma_f32_16x16x32_bf16 v[152:155], a[168:171], a[72:75], v[152:155]
    ds_read_b128 a[116:119], v40 offset:4096
    ds_read_b32 a83, v10
    v_mfma_f32_16x16x32_bf16 v[156:159], a[136:139], a[152:155], v[156:159]
    ds_read_b32 a107, v11
    v_perm_b32 v12, v102, v35, s36
    v_mfma_f32_16x16x32_bf16 v[156:159], a[168:171], a[164:167], v[156:159]
    s_waitcnt lgkmcnt(9)
    ds_read_b128 a[124:127], v41 offset:4096
    v_mfma_f32_16x16x32_bf16 v[160:163], a[172:175], a[76:79], v[160:163]
    ds_read_b32 a128, v12
    v_perm_b32 v13, v102, v35, s37
    v_mfma_f32_16x16x32_bf16 v[160:163], a[84:87], a[92:95], v[160:163]
    s_waitcnt vmcnt(16)
    buffer_load_dwordx4 v38, s[8:11], s56 offen offset:2048 lds
    v_perm_b32 v14, v104, v35, s36
    v_mfma_f32_16x16x32_bf16 v[164:167], a[172:175], a[108:111], v[164:167]
    ds_read_b32 a129, v13
    v_perm_b32 v15, v102, v35, s38
    v_mfma_f32_16x16x32_bf16 v[164:167], a[84:87], a[4:7], v[164:167]
    ds_read_b128 a[132:135], v40 offset:6144
    ds_read_b32 a140, v14
    v_mfma_f32_16x16x32_bf16 v[168:171], a[172:175], a[12:15], v[168:171]
    ds_read_b32 a130, v15
    v_perm_b32 v56, v102, v35, s39
    v_mfma_f32_16x16x32_bf16 v[168:171], a[84:87], a[16:19], v[168:171]
    ds_read_b128 a[144:147], v41 offset:6144
    v_mfma_f32_16x16x32_bf16 v[172:175], a[172:175], a[24:27], v[172:175]
    s_waitcnt vmcnt(7)
    ds_read_b32 a131, v56
    v_perm_b32 v57, v108, v35, s36
    v_mfma_f32_16x16x32_bf16 v[172:175], a[84:87], a[28:31], v[172:175]
    buffer_load_dwordx4 v39, s[8:11], s56 offen offset:3072 lds
    v_perm_b32 v58, v104, v35, s37
    v_mfma_f32_16x16x32_bf16 v[176:179], a[172:175], a[40:43], v[176:179]
    ds_read_b32 a148, v57
    v_perm_b32 v59, v108, v35, s37
    v_mfma_f32_16x16x32_bf16 v[176:179], a[84:87], a[44:47], v[176:179]
    ds_read_b128 a[156:159], v40 offset:8192
    ds_read_b32 a141, v58
    v_mfma_f32_16x16x32_bf16 v[180:183], a[172:175], a[52:55], v[180:183]
    ds_read_b32 a149, v59
    v_perm_b32 v60, v108, v35, s38
    v_mfma_f32_16x16x32_bf16 v[180:183], a[84:87], a[60:63], v[180:183]
    s_add_u32 s56, s55, 1408
    ds_read_b128 a[188:191], v41 offset:8192
    v_perm_b32 v61, v104, v35, s38
    v_mfma_f32_16x16x32_bf16 v[184:187], a[172:175], a[120:123], v[184:187]
    s_add_u32 m0, s57, 83968
    ds_read_b32 a150, v60
    v_perm_b32 v62, v108, v35, s39
    v_mfma_f32_16x16x32_bf16 v[184:187], a[84:87], a[72:75], v[184:187]
    s_waitcnt vmcnt(6)
    buffer_load_dwordx4 v36, s[8:11], s56 offen offset:0 lds
    v_perm_b32 v63, v112, v35, s36
    v_mfma_f32_16x16x32_bf16 v[188:191], a[172:175], a[152:155], v[188:191]
    ds_read_b32 a151, v62
    v_cmp_ne_u64 vcc, s[76:77], v[6:7]
    v_mfma_f32_16x16x32_bf16 v[188:191], a[84:87], a[164:167], v[188:191]
    s_waitcnt lgkmcnt(7)
    ds_read_b128 a[160:163], v40 offset:10240
    ds_read_b32 a142, v61
    v_mfma_f32_16x16x32_bf16 v[192:195], a[104:107], a[76:79], v[192:195]
    s_cbranch_vccnz L_slow1
L_back1:
    ds_read_b32 a204, v63
    v_perm_b32 v8, v112, v35, s37
    v_mfma_f32_16x16x32_bf16 v[192:195], a[128:131], a[92:95], v[192:195]
    ds_read_b128 a[216:219], v41 offset:10240
    v_mfma_f32_16x16x32_bf16 v[196:199], a[104:107], a[108:111], v[196:199]
    ds_read_b32 a205, v8
    v_perm_b32 v9, v112, v35, s38
    v_mfma_f32_16x16x32_bf16 v[196:199], a[128:131], a[4:7], v[196:199]
    buffer_load_dwordx4 v37, s[8:11], s56 offen offset:1024 lds
    v_perm_b32 v10, v104, v35, s39
    v_mfma_f32_16x16x32_bf16 v[200:203], a[104:107], a[12:15], v[200:203]
    ds_read_b32 a206, v9
    v_perm_b32 v11, v112, v35, s39
    v_mfma_f32_16x16x32_bf16 v[200:203], a[128:131], a[16:19], v[200:203]
    ds_read_b128 a[232:235], v40 offset:12288
    ds_read_b32 a143, v10
    v_mfma_f32_16x16x32_bf16 v[204:207], a[104:107], a[24:27], v[204:207]
    ds_read_b32 a207, v11
    v_perm_b32 v12, v109, v35, s36
    v_mfma_f32_16x16x32_bf16 v[204:207], a[128:131], a[28:31], v[204:207]
    ds_read_b128 a[252:255], v41 offset:12288
    v_mfma_f32_16x16x32_bf16 v[208:211], a[104:107], a[40:43], v[208:211]
    s_add_u32 m0, s57, 79872
    ds_read_b32 a64, v12
    v_perm_b32 v13, v109, v35, s37
    v_mfma_f32_16x16x32_bf16 v[208:211], a[128:131], a[44:47], v[208:211]
    s_waitcnt vmcnt(6)
    buffer_load_dwordx4 v38, s[8:11], s56 offen offset:2048 lds
    v_perm_b32 v14, v116, v35, s36
    v_mfma_f32_16x16x32_bf16 v[212:215], a[104:107], a[52:55], v[212:215]
    ds_read_b32 a65, v13
    v_perm_b32 v15, v109, v35, s38
    v_mfma_f32_16x16x32_bf16 v[212:215], a[128:131], a[60:63], v[212:215]
    ds_read_b128 a[0:3], v40 offset:14336
    ds_read_b32 a20, v14
    v_mfma_f32_16x16x32_bf16 v[216:219], a[104:107], a[120:123], v[216:219]
    ds_read_b32 a66, v15
    v_perm_b32 v56, v109, v35, s39
    v_mfma_f32_16x16x32_bf16 v[216:219], a[128:131], a[72:75], v[216:219]
    ds_read_b128 a[176:179], v41 offset:14336
    v_mfma_f32_16x16x32_bf16 v[220:223], a[104:107], a[152:155], v[220:223]
    ds_read_b32 a67, v56
    v_perm_b32 v57, v113, v35, s36
    v_mfma_f32_16x16x32_bf16 v[220:223], a[128:131], a[164:167], v[220:223]
    s_waitcnt lgkmcnt(8)
    buffer_load_dwordx4 v39, s[8:11], s56 offen offset:3072 lds
    v_perm_b32 v58, v116, v35, s37
    v_mfma_f32_16x16x32_bf16 v[128:131], a[148:151], a[88:91], v[128:131]
    ds_read_b32 a180, v57
    v_perm_b32 v59, v113, v35, s37
    v_mfma_f32_16x16x32_bf16 v[128:131], a[204:207], a[96:99], v[128:131]
    ds_read_b128 a[184:187], v42 offset:2048
    ds_read_b32 a21, v58
    v_mfma_f32_16x16x32_bf16 v[132:135], a[148:151], a[100:103], v[132:135]
    ds_read_b32 a181, v59
    v_perm_b32 v60, v113, v35, s38
    v_mfma_f32_16x16x32_bf16 v[132:135], a[204:207], a[112:115], v[132:135]
    ds_read_b128 a[192:195], v43 offset:2048
    v_mfma_f32_16x16x32_bf16 v[136:139], a[148:151], a[116:119], v[136:139]
    s_mov_b32 s46, 32768
    ds_read_b32 a182, v60
    v_perm_b32 v62, v113, v35, s39
    v_mfma_f32_16x16x32_bf16 v[136:139], a[204:207], a[124:127], v[136:139]
    buffer_load_dwordx3 v[120:122], v33, s[12:15], s46 offen sc1
    v_perm_b32 v61, v116, v35, s38
    v_mfma_f32_16x16x32_bf16 v[140:143], a[148:151], a[132:135], v[140:143]
    ds_read_b32 a183, v62
    v_perm_b32 v63, v110, v35, s36
    v_mfma_f32_16x16x32_bf16 v[140:143], a[204:207], a[144:147], v[140:143]
    ds_read_b128 a[196:199], v42 offset:0
    ds_read_b32 a22, v61
    v_mfma_f32_16x16x32_bf16 v[144:147], a[148:151], a[156:159], v[144:147]
    ds_read_b32 a200, v63
    v_perm_b32 v8, v110, v35, s37
    v_mfma_f32_16x16x32_bf16 v[144:147], a[204:207], a[188:191], v[144:147]
    ds_read_b128 a[208:211], v43 offset:0
    v_mfma_f32_16x16x32_bf16 v[148:151], a[148:151], a[160:163], v[148:151]
    s_mov_b32 s47, 36864
    ds_read_b32 a201, v8
    v_perm_b32 v9, v110, v35, s38
    v_mfma_f32_16x16x32_bf16 v[148:151], a[204:207], a[216:219], v[148:151]
    buffer_load_dwordx3 v[124:126], v33, s[12:15], s47 offen sc1
    v_perm_b32 v10, v116, v35, s39
    v_mfma_f32_16x16x32_bf16 v[152:155], a[148:151], a[232:235], v[152:155]
    s_waitcnt lgkmcnt(7)
    ds_read_b32 a202, v9
    v_perm_b32 v11, v110, v35, s39
    v_mfma_f32_16x16x32_bf16 v[152:155], a[204:207], a[252:255], v[152:155]
    ds_read_b128 a[212:215], v42 offset:6144
    ds_read_b32 a23, v10
    v_mfma_f32_16x16x32_bf16 v[156:159], a[148:151], a[0:3], v[156:159]
    ds_read_b32 a203, v11
    v_perm_b32 v12, v114, v35, s36
    v_mfma_f32_16x16x32_bf16 v[156:159], a[204:207], a[176:179], v[156:159]
    s_waitcnt lgkmcnt(9)
    ds_read_b128 a[220:223], v43 offset:6144
    v_mfma_f32_16x16x32_bf16 v[160:163], a[64:67], a[88:91], v[160:163]
    s_mov_b32 s40, 65536
    ds_read_b32 a224, v12
    v_perm_b32 v13, v114, v35, s37
    v_mfma_f32_16x16x32_bf16 v[160:163], a[180:183], a[96:99], v[160:163]
    buffer_load_dwordx3 v[64:66], v32, s[12:15], s40 offen sc1
    v_perm_b32 v14, v89, v35, s36
    v_mfma_f32_16x16x32_bf16 v[164:167], a[64:67], a[100:103], v[164:167]
    ds_read_b32 a225, v13
    v_perm_b32 v15, v114, v35, s38
    v_mfma_f32_16x16x32_bf16 v[164:167], a[180:183], a[112:115], v[164:167]
    ds_read_b128 a[228:231], v42 offset:4096
    ds_read_b32 a236, v14
    v_mfma_f32_16x16x32_bf16 v[168:171], a[64:67], a[116:119], v[168:171]
    ds_read_b32 a226, v15
    v_perm_b32 v56, v114, v35, s39
    v_mfma_f32_16x16x32_bf16 v[168:171], a[180:183], a[124:127], v[168:171]
    ds_read_b128 a[240:243], v43 offset:4096
    v_mfma_f32_16x16x32_bf16 v[172:175], a[64:67], a[132:135], v[172:175]
    ds_read_b32 a227, v56
    v_perm_b32 v57, v111, v35, s36
    v_mfma_f32_16x16x32_bf16 v[172:175], a[180:183], a[144:147], v[172:175]
    buffer_load_dword v67, v34, s[12:15], s40 offen sc1
    v_perm_b32 v58, v89, v35, s37
    v_mfma_f32_16x16x32_bf16 v[176:179], a[64:67], a[156:159], v[176:179]
    ds_read_b32 a248, v57
    v_perm_b32 v59, v111, v35, s37
    v_mfma_f32_16x16x32_bf16 v[176:179], a[180:183], a[188:191], v[176:179]
    ds_read_b128 a[32:35], v42 offset:10240
    ds_read_b32 a237, v58
    v_mfma_f32_16x16x32_bf16 v[180:183], a[64:67], a[160:163], v[180:183]
    ds_read_b32 a249, v59
    v_perm_b32 v60, v111, v35, s38
    v_mfma_f32_16x16x32_bf16 v[180:183], a[180:183], a[216:219], v[180:183]
    ds_read_b128 a[36:39], v43 offset:10240
    v_mfma_f32_16x16x32_bf16 v[184:187], a[64:67], a[232:235], v[184:187]
    s_mov_b32 s41, 69632
    ds_read_b32 a250, v60
    v_perm_b32 v62, v111, v35, s39
    v_mfma_f32_16x16x32_bf16 v[184:187], a[180:183], a[252:255], v[184:187]
    buffer_load_dwordx3 v[68:70], v32, s[12:15], s41 offen sc1
    v_perm_b32 v61, v89, v35, s38
    v_mfma_f32_16x16x32_bf16 v[188:191], a[64:67], a[0:3], v[188:191]
    ds_read_b32 a251, v62
    v_perm_b32 v63, v115, v35, s36
    v_mfma_f32_16x16x32_bf16 v[188:191], a[180:183], a[176:179], v[188:191]
    s_waitcnt lgkmcnt(7)
    ds_read_b128 a[48:51], v42 offset:8192
    ds_read_b32 a238, v61
    v_mfma_f32_16x16x32_bf16 v[192:195], a[200:203], a[88:91], v[192:195]
    ds_read_b32 a56, v63
    v_perm_b32 v8, v115, v35, s37
    v_mfma_f32_16x16x32_bf16 v[192:195], a[224:227], a[96:99], v[192:195]
    ds_read_b128 a[136:139], v43 offset:8192
    v_mfma_f32_16x16x32_bf16 v[196:199], a[200:203], a[100:103], v[196:199]
    ds_read_b32 a57, v8
    v_perm_b32 v9, v115, v35, s38
    v_mfma_f32_16x16x32_bf16 v[196:199], a[224:227], a[112:115], v[196:199]
    buffer_load_dword v71, v34, s[12:15], s41 offen sc1
    v_perm_b32 v10, v89, v35, s39
    v_mfma_f32_16x16x32_bf16 v[200:203], a[200:203], a[116:119], v[200:203]
    ds_read_b32 a58, v9
    v_perm_b32 v11, v115, v35, s39
    v_mfma_f32_16x16x32_bf16 v[200:203], a[224:227], a[124:127], v[200:203]
    ds_read_b128 a[168:171], v42 offset:14336
    ds_read_b32 a239, v10
    v_mfma_f32_16x16x32_bf16 v[204:207], a[200:203], a[132:135], v[204:207]
    s_waitcnt vmcnt(5)
    ds_read_b32 a59, v11
    v_perm_b32 v12, v120, v35, s36
    v_mfma_f32_16x16x32_bf16 v[204:207], a[224:227], a[144:147], v[204:207]
    ds_read_b128 a[172:175], v43 offset:14336
    v_mfma_f32_16x16x32_bf16 v[208:211], a[200:203], a[156:159], v[208:211]
    s_mov_b32 s42, 65536
    ds_read_b32 a84, v12
    v_perm_b32 v13, v120, v35, s37
    v_mfma_f32_16x16x32_bf16 v[208:211], a[224:227], a[188:191], v[208:211]
    buffer_load_dwordx3 v[72:74], v33, s[12:15], s42 offen sc1
    v_perm_b32 v14, v93, v35, s36
    v_mfma_f32_16x16x32_bf16 v[212:215], a[200:203], a[160:163], v[212:215]
    ds_read_b32 a85, v13
    v_perm_b32 v15, v120, v35, s38
    v_mfma_f32_16x16x32_bf16 v[212:215], a[224:227], a[216:219], v[212:215]
    ds_read_b128 a[76:79], v42 offset:12288
    ds_read_b32 a92, v14
    v_mfma_f32_16x16x32_bf16 v[216:219], a[200:203], a[232:235], v[216:219]
    ds_read_b32 a86, v15
    v_perm_b32 v56, v120, v35, s39
    v_mfma_f32_16x16x32_bf16 v[216:219], a[224:227], a[252:255], v[216:219]
    s_waitcnt vmcnt(5)
    ds_read_b128 a[108:111], v43 offset:12288
    v_mfma_f32_16x16x32_bf16 v[220:223], a[200:203], a[0:3], v[220:223]
    s_mov_b32 s43, 69632
    ds_read_b32 a87, v56
    v_perm_b32 v57, v124, v35, s36
    v_mfma_f32_16x16x32_bf16 v[220:223], a[224:227], a[176:179], v[220:223]
    s_waitcnt lgkmcnt(8)
    buffer_load_dwordx3 v[76:78], v33, s[12:15], s43 offen sc1
    v_perm_b32 v58, v93, v35, s37
    v_mfma_f32_16x16x32_bf16 v[224:227], a[248:251], a[88:91], v[224:227]
    ds_read_b32 a4, v57
    v_perm_b32 v59, v124, v35, s37
    v_mfma_f32_16x16x32_bf16 v[224:227], a[56:59], a[96:99], v[224:227]
    ds_read_b32 a93, v58
    v_mfma_f32_16x16x32_bf16 v[228:231], a[248:251], a[100:103], v[228:231]
    s_mov_b32 s44, 81920
    ds_read_b32 a5, v59
    v_perm_b32 v60, v124, v35, s38
    v_mfma_f32_16x16x32_bf16 v[228:231], a[56:59], a[112:115], v[228:231]
    buffer_load_dwordx3 v[80:82], v32, s[12:15], s44 offen sc1
    v_mfma_f32_16x16x32_bf16 v[232:235], a[248:251], a[116:119], v[232:235]
    ds_read_b32 a6, v60
    v_perm_b32 v62, v124, v35, s39
    v_mfma_f32_16x16x32_bf16 v[232:235], a[56:59], a[124:127], v[232:235]
    buffer_load_dword v83, v34, s[12:15], s44 offen sc1
    v_perm_b32 v61, v93, v35, s38
    v_mfma_f32_16x16x32_bf16 v[236:239], a[248:251], a[132:135], v[236:239]
    ds_read_b32 a7, v62
    v_perm_b32 v63, v121, v35, s36
    v_mfma_f32_16x16x32_bf16 v[236:239], a[56:59], a[144:147], v[236:239]
    ds_read_b32 a94, v61
    v_mfma_f32_16x16x32_bf16 v[240:243], a[248:251], a[156:159], v[240:243]
    ds_read_b32 a12, v63
    v_perm_b32 v8, v121, v35, s37
    v_mfma_f32_16x16x32_bf16 v[240:243], a[56:59], a[188:191], v[240:243]
    buffer_load_dwordx4 v[48:51], v22, s[32:35], 0 offen
    v_mfma_f32_16x16x32_bf16 v[244:247], a[248:251], a[160:163], v[244:247]
    s_mov_b32 s45, 86016
    ds_read_b32 a13, v8
    v_perm_b32 v9, v121, v35, s38
    v_mfma_f32_16x16x32_bf16 v[244:247], a[56:59], a[216:219], v[244:247]
    buffer_load_dwordx3 v[84:86], v32, s[12:15], s45 offen sc1
    v_perm_b32 v10, v93, v35, s39
    v_mfma_f32_16x16x32_bf16 v[248:251], a[248:251], a[232:235], v[248:251]
    ds_read_b32 a14, v9
    v_perm_b32 v11, v121, v35, s39
    v_mfma_f32_16x16x32_bf16 v[248:251], a[56:59], a[252:255], v[248:251]
    ds_read_b32 a95, v10
    v_mfma_f32_16x16x32_bf16 v[252:255], a[248:251], a[0:3], v[252:255]
    ds_read_b32 a15, v11
    v_perm_b32 v12, v125, v35, s36
    v_mfma_f32_16x16x32_bf16 v[252:255], a[56:59], a[176:179], v[252:255]
    s_waitcnt lgkmcnt(6)
    s_barrier
    buffer_load_dword v87, v34, s[12:15], s45 offen sc1
    v_mfma_f32_16x16x32_bf16 v[128:131], a[84:87], a[184:187], v[128:131]
    ds_read_b32 a16, v12
    v_perm_b32 v13, v125, v35, s37
    v_mfma_f32_16x16x32_bf16 v[128:131], a[4:7], a[192:195], v[128:131]
    ds_read_b128 a[24:27], v40 offset:32768
    v_perm_b32 v14, v105, v35, s36
    v_mfma_f32_16x16x32_bf16 v[132:135], a[84:87], a[196:199], v[132:135]
    ds_read_b32 a17, v13
    v_perm_b32 v15, v125, v35, s38
    v_mfma_f32_16x16x32_bf16 v[132:135], a[4:7], a[208:211], v[132:135]
    s_add_u32 s56, s55, 1536
    ds_read_b128 a[28:31], v41 offset:32768
    ds_read_b32 a40, v14
    v_mfma_f32_16x16x32_bf16 v[136:139], a[84:87], a[212:215], v[136:139]
    s_add_u32 m0, s57, 0
    ds_read_b32 a18, v15
    v_perm_b32 v56, v125, v35, s39
    v_mfma_f32_16x16x32_bf16 v[136:139], a[4:7], a[220:223], v[136:139]
    buffer_load_dwordx4 v36, s[8:11], s56 offen offset:0 lds
    v_mfma_f32_16x16x32_bf16 v[140:143], a[84:87], a[228:231], v[140:143]
    ds_read_b32 a19, v56
    v_perm_b32 v57, v122, v35, s36
    v_mfma_f32_16x16x32_bf16 v[140:143], a[4:7], a[240:243], v[140:143]
    ds_read_b128 a[44:47], v40 offset:34816
    v_perm_b32 v58, v105, v35, s37
    v_mfma_f32_16x16x32_bf16 v[144:147], a[84:87], a[32:35], v[144:147]
    ds_read_b32 a52, v57
    v_perm_b32 v59, v122, v35, s37
    v_mfma_f32_16x16x32_bf16 v[144:147], a[4:7], a[36:39], v[144:147]
    ds_read_b128 a[60:63], v41 offset:34816
    ds_read_b32 a41, v58
    v_mfma_f32_16x16x32_bf16 v[148:151], a[84:87], a[48:51], v[148:151]
    ds_read_b32 a53, v59
    v_perm_b32 v60, v122, v35, s38
    v_mfma_f32_16x16x32_bf16 v[148:151], a[4:7], a[136:139], v[148:151]
    buffer_load_dwordx4 v37, s[8:11], s56 offen offset:1024 lds
    v_mfma_f32_16x16x32_bf16 v[152:155], a[84:87], a[168:171], v[152:155]
    ds_read_b32 a54, v60
    v_perm_b32 v62, v122, v35, s39
    v_mfma_f32_16x16x32_bf16 v[152:155], a[4:7], a[172:175], v[152:155]
    ds_read_b128 a[120:123], v40 offset:36864
    v_perm_b32 v61, v105, v35, s38
    v_mfma_f32_16x16x32_bf16 v[156:159], a[84:87], a[76:79], v[156:159]
    ds_read_b32 a55, v62
    v_perm_b32 v63, v126, v35, s36
    v_mfma_f32_16x16x32_bf16 v[156:159], a[4:7], a[108:111], v[156:159]
    s_waitcnt lgkmcnt(8)
    ds_read_b128 a[72:75], v41 offset:36864
    ds_read_b32 a42, v61
    v_mfma_f32_16x16x32_bf16 v[160:163], a[12:15], a[184:187], v[160:163]
    ds_read_b32 a152, v63
    v_perm_b32 v8, v126, v35, s37
    v_mfma_f32_16x16x32_bf16 v[160:163], a[16:19], a[192:195], v[160:163]
    buffer_load_dwordx4 v38, s[8:11], s56 offen offset:2048 lds
    v_mfma_f32_16x16x32_bf16 v[164:167], a[12:15], a[196:199], v[164:167]
    ds_read_b32 a153, v8
    v_perm_b32 v9, v126, v35, s38
    v_mfma_f32_16x16x32_bf16 v[164:167], a[16:19], a[208:211], v[164:167]
    ds_read_b128 a[104:107], v40 offset:38912
    v_perm_b32 v10, v105, v35, s39
    v_mfma_f32_16x16x32_bf16 v[168:171], a[12:15], a[212:215], v[168:171]
    ds_read_b32 a154, v9
    v_perm_b32 v11, v126, v35, s39
    v_mfma_f32_16x16x32_bf16 v[168:171], a[16:19], a[220:223], v[168:171]
    ds_read_b128 a[164:167], v41 offset:38912
    ds_read_b32 a43, v10
    v_mfma_f32_16x16x32_bf16 v[172:175], a[12:15], a[228:231], v[172:175]
    s_waitcnt vmcnt(13)
    ds_read_b32 a155, v11
    v_perm_b32 v12, v64, v35, s36
    v_mfma_f32_16x16x32_bf16 v[172:175], a[16:19], a[240:243], v[172:175]
    buffer_load_dwordx4 v39, s[8:11], s56 offen offset:3072 lds
    v_mfma_f32_16x16x32_bf16 v[176:179], a[12:15], a[32:35], v[176:179]
    ds_read_b32 a128, v12
    v_perm_b32 v13, v64, v35, s37
    v_mfma_f32_16x16x32_bf16 v[176:179], a[16:19], a[36:39], v[176:179]
    ds_read_b128 a[148:151], v40 offset:40960
    v_perm_b32 v14, v117, v35, s36
    v_mfma_f32_16x16x32_bf16 v[180:183], a[12:15], a[48:51], v[180:183]
    ds_read_b32 a129, v13
    v_perm_b32 v15, v64, v35, s38
    v_mfma_f32_16x16x32_bf16 v[180:183], a[16:19], a[136:139], v[180:183]
    s_add_u32 s56, s55, 1664
    ds_read_b128 a[204:207], v41 offset:40960
    ds_read_b32 a64, v14
    v_mfma_f32_16x16x32_bf16 v[184:187], a[12:15], a[168:171], v[184:187]
    s_add_u32 m0, s57, 18432
    ds_read_b32 a130, v15
    v_perm_b32 v56, v64, v35, s39
    v_mfma_f32_16x16x32_bf16 v[184:187], a[16:19], a[172:175], v[184:187]
    buffer_load_dwordx4 v36, s[8:11], s56 offen offset:0 lds
    v_mfma_f32_16x16x32_bf16 v[188:191], a[12:15], a[76:79], v[188:191]
    s_waitcnt vmcnt(13)
    ds_read_b32 a131, v56
    v_perm_b32 v57, v68, v35, s36
    v_mfma_f32_16x16x32_bf16 v[188:191], a[16:19], a[108:111], v[188:191]
    s_waitcnt lgkmcnt(7)
    ds_read_b128 a[180:183], v40 offset:43008
    v_perm_b32 v58, v117, v35, s37
    v_mfma_f32_16x16x32_bf16 v[192:195], a[52:55], a[184:187], v[192:195]
    ds_read_b32 a200, v57
    v_perm_b32 v59, v68, v35, s37
    v_mfma_f32_16x16x32_bf16 v[192:195], a[152:155], a[192:195], v[192:195]
    ds_read_b128 a[224:227], v41 offset:43008
    ds_read_b32 a65, v58
    v_mfma_f32_16x16x32_bf16 v[196:199], a[52:55], a[196:199], v[196:199]
    ds_read_b32 a201, v59
    v_perm_b32 v60, v68, v35, s38
    v_mfma_f32_16x16x32_bf16 v[196:199], a[152:155], a[208:211], v[196:199]
    buffer_load_dwordx4 v37, s[8:11], s56 offen offset:1024 lds
    v_mfma_f32_16x16x32_bf16 v[200:203], a[52:55], a[212:215], v[200:203]
    ds_read_b32 a202, v60
    v_perm_b32 v62, v68, v35, s39
    v_mfma_f32_16x16x32_bf16 v[200:203], a[152:155], a[220:223], v[200:203]
    ds_read_b128 a[88:91], v40 offset:45056
    v_perm_b32 v61, v117, v35, s38
    v_mfma_f32_16x16x32_bf16 v[204:207], a[52:55], a[228:231], v[204:207]
    ds_read_b32 a203, v62
    v_perm_b32 v63, v65, v35, s36
    v_mfma_f32_16x16x32_bf16 v[204:207], a[152:155], a[240:243], v[204:207]
    ds_read_b128 a[96:99], v41 offset:45056
    ds_read_b32 a66, v61
    v_mfma_f32_16x16x32_bf16 v[208:211], a[52:55], a[32:35], v[208:211]
    s_add_u32 m0, s57, 14336
    ds_read_b32 a100, v63
    v_perm_b32 v8, v65, v35, s37
    v_mfma_f32_16x16x32_bf16 v[208:211], a[152:155], a[36:39], v[208:211]
    buffer_load_dwordx4 v38, s[8:11], s56 offen offset:2048 lds
    v_mfma_f32_16x16x32_bf16 v[212:215], a[52:55], a[48:51], v[212:215]
    ds_read_b32 a101, v8
    v_perm_b32 v9, v65, v35, s38
    v_mfma_f32_16x16x32_bf16 v[212:215], a[152:155], a[136:139], v[212:215]
    ds_read_b128 a[112:115], v40 offset:47104
    v_perm_b32 v10, v117, v35, s39
    v_mfma_f32_16x16x32_bf16 v[216:219], a[52:55], a[168:171], v[216:219]
    ds_read_b32 a102, v9
    v_perm_b32 v11, v65, v35, s39
    v_mfma_f32_16x16x32_bf16 v[216:219], a[152:155], a[172:175], v[216:219]
    ds_read_b128 a[116:119], v41 offset:47104
    ds_read_b32 a67, v10
    v_mfma_f32_16x16x32_bf16 v[220:223], a[52:55], a[76:79], v[220:223]
    ds_read_b32 a103, v11
    v_perm_b32 v12, v69, v35, s36
    v_mfma_f32_16x16x32_bf16 v[220:223], a[152:155], a[108:111], v[220:223]
    s_waitcnt lgkmcnt(9)
    buffer_load_dwordx4 v39, s[8:11], s56 offen offset:3072 lds
    v_mfma_f32_16x16x32_bf16 v[128:131], a[128:131], a[24:27], v[128:131]
    ds_read_b32 a124, v12
    v_perm_b32 v13, v69, v35, s37
    v_mfma_f32_16x16x32_bf16 v[128:131], a[200:203], a[28:31], v[128:131]
    ds_read_b128 a[132:135], v42 offset:34816
    v_perm_b32 v14, v90, v35, s36
    v_mfma_f32_16x16x32_bf16 v[132:135], a[128:131], a[44:47], v[132:135]
    ds_read_b32 a125, v13
    v_perm_b32 v15, v69, v35, s38
    v_mfma_f32_16x16x32_bf16 v[132:135], a[200:203], a[60:63], v[132:135]
    ds_read_b128 a[144:147], v43 offset:34816
    ds_read_b32 a156, v14
    v_mfma_f32_16x16x32_bf16 v[136:139], a[128:131], a[120:123], v[136:139]
    s_mov_b32 s46, 114688
    ds_read_b32 a126, v15
    v_perm_b32 v56, v69, v35, s39
    v_mfma_f32_16x16x32_bf16 v[136:139], a[200:203], a[72:75], v[136:139]
    buffer_load_dwordx3 v[96:98], v32, s[12:15], s46 offen sc1
    v_mfma_f32_16x16x32_bf16 v[140:143], a[128:131], a[104:107], v[140:143]
    ds_read_b32 a127, v56
    v_perm_b32 v57, v66, v35, s36
    v_mfma_f32_16x16x32_bf16 v[140:143], a[200:203], a[164:167], v[140:143]
    ds_read_b128 a[188:191], v42 offset:32768
    v_perm_b32 v58, v90, v35, s37
    v_mfma_f32_16x16x32_bf16 v[144:147], a[128:131], a[148:151], v[144:147]
    ds_read_b32 a160, v57
    v_perm_b32 v59, v66, v35, s37
    v_mfma_f32_16x16x32_bf16 v[144:147], a[200:203], a[204:207], v[144:147]
    ds_read_b128 a[216:219], v43 offset:32768
    ds_read_b32 a157, v58
    v_mfma_f32_16x16x32_bf16 v[148:151], a[128:131], a[180:183], v[148:151]
    ds_read_b32 a161, v59
    v_perm_b32 v60, v66, v35, s38
    v_mfma_f32_16x16x32_bf16 v[148:151], a[200:203], a[224:227], v[148:151]
    buffer_load_dword v99, v34, s[12:15], s46 offen sc1
    v_mfma_f32_16x16x32_bf16 v[152:155], a[128:131], a[88:91], v[152:155]
    s_waitcnt lgkmcnt(7)
    ds_read_b32 a162, v60
    v_perm_b32 v62, v66, v35, s39
    v_mfma_f32_16x16x32_bf16 v[152:155], a[200:203], a[96:99], v[152:155]
    ds_read_b128 a[232:235], v42 offset:38912
    v_perm_b32 v61, v90, v35, s38
    v_mfma_f32_16x16x32_bf16 v[156:159], a[128:131], a[112:115], v[156:159]
    ds_read_b32 a163, v62
    v_perm_b32 v63, v70, v35, s36
    v_mfma_f32_16x16x32_bf16 v[156:159], a[200:203], a[116:119], v[156:159]
    s_waitcnt lgkmcnt(8)
    ds_read_b128 a[252:255], v43 offset:38912
    ds_read_b32 a158, v61
    v_mfma_f32_16x16x32_bf16 v[160:163], a[100:103], a[24:27], v[160:163]
    s_mov_b32 s47, 118784
    ds_read_b32 a0, v63
    v_perm_b32 v8, v70, v35, s37
    v_mfma_f32_16x16x32_bf16 v[160:163], a[124:127], a[28:31], v[160:163]
    buffer_load_dwordx3 v[100:102], v32, s[12:15], s47 offen sc1
    v_mfma_f32_16x16x32_bf16 v[164:167], a[100:103], a[44:47], v[164:167]
    ds_read_b32 a1, v8
    v_perm_b32 v9, v70, v35, s38
    v_mfma_f32_16x16x32_bf16 v[164:167], a[124:127], a[60:63], v[164:167]
    ds_read_b128 a[248:251], v42 offset:36864
    v_perm_b32 v10, v90, v35, s39
    v_mfma_f32_16x16x32_bf16 v[168:171], a[100:103], a[120:123], v[168:171]
    ds_read_b32 a2, v9
    v_perm_b32 v11, v70, v35, s39
    v_mfma_f32_16x16x32_bf16 v[168:171], a[124:127], a[72:75], v[168:171]
    ds_read_b128 a[176:179], v43 offset:36864
    ds_read_b32 a159, v10
    v_mfma_f32_16x16x32_bf16 v[172:175], a[100:103], a[104:107], v[172:175]
    ds_read_b32 a3, v11
    v_perm_b32 v12, v67, v35, s36
    v_mfma_f32_16x16x32_bf16 v[172:175], a[124:127], a[164:167], v[172:175]
    buffer_load_dword v103, v34, s[12:15], s47 offen sc1
    v_mfma_f32_16x16x32_bf16 v[176:179], a[100:103], a[148:151], v[176:179]
    ds_read_b32 a56, v12
    v_perm_b32 v13, v67, v35, s37
    v_mfma_f32_16x16x32_bf16 v[176:179], a[124:127], a[204:207], v[176:179]
    ds_read_b128 a[84:87], v42 offset:43008
    v_perm_b32 v14, v94, v35, s36
    v_mfma_f32_16x16x32_bf16 v[180:183], a[100:103], a[180:183], v[180:183]
    ds_read_b32 a57, v13
    v_perm_b32 v15, v67, v35, s38
    v_mfma_f32_16x16x32_bf16 v[180:183], a[124:127], a[224:227], v[180:183]
    ds_read_b128 a[4:7], v43 offset:43008
    ds_read_b32 a12, v14
    v_mfma_f32_16x16x32_bf16 v[184:187], a[100:103], a[88:91], v[184:187]
    s_mov_b32 s40, 81920
    ds_read_b32 a58, v15
    v_perm_b32 v56, v67, v35, s39
    v_mfma_f32_16x16x32_bf16 v[184:187], a[124:127], a[96:99], v[184:187]
    buffer_load_dwordx3 v[108:110], v33, s[12:15], s40 offen sc1
    v_mfma_f32_16x16x32_bf16 v[188:191], a[100:103], a[112:115], v[188:191]
    s_waitcnt vmcnt(20)
    ds_read_b32 a59, v56
    v_perm_b32 v57, v71, v35, s36
    v_mfma_f32_16x16x32_bf16 v[188:191], a[124:127], a[116:119], v[188:191]
    s_waitcnt lgkmcnt(7)
    ds_read_b128 a[16:19], v42 offset:40960
    v_perm_b32 v58, v94, v35, s37
    v_mfma_f32_16x16x32_bf16 v[192:195], a[160:163], a[24:27], v[192:195]
    ds_read_b32 a184, v57
    v_perm_b32 v59, v71, v35, s37
    v_mfma_f32_16x16x32_bf16 v[192:195], a[0:3], a[28:31], v[192:195]
    ds_read_b128 a[192:195], v43 offset:40960
    ds_read_b32 a13, v58
    v_mfma_f32_16x16x32_bf16 v[196:199], a[160:163], a[44:47], v[196:199]
    s_mov_b32 s41, 86016
    ds_read_b32 a185, v59
    v_perm_b32 v60, v71, v35, s38
    v_mfma_f32_16x16x32_bf16 v[196:199], a[0:3], a[60:63], v[196:199]
    buffer_load_dwordx3 v[112:114], v33, s[12:15], s41 offen sc1
    v_mfma_f32_16x16x32_bf16 v[200:203], a[160:163], a[120:123], v[200:203]
    ds_read_b32 a186, v60
    v_perm_b32 v62, v71, v35, s39
    v_mfma_f32_16x16x32_bf16 v[200:203], a[0:3], a[72:75], v[200:203]
    ds_read_b128 a[196:199], v42 offset:47104
    v_perm_b32 v61, v94, v35, s38
    v_mfma_f32_16x16x32_bf16 v[204:207], a[160:163], a[104:107], v[204:207]
    s_waitcnt vmcnt(20)
    ds_read_b32 a187, v62
    v_perm_b32 v63, v72, v35, s36
    v_mfma_f32_16x16x32_bf16 v[204:207], a[0:3], a[164:167], v[204:207]
    ds_read_b128 a[208:211], v43 offset:47104
    ds_read_b32 a14, v61
    v_mfma_f32_16x16x32_bf16 v[208:211], a[160:163], a[148:151], v[208:211]
    ds_read_b32 a212, v63
    v_perm_b32 v8, v72, v35, s37
    v_mfma_f32_16x16x32_bf16 v[208:211], a[0:3], a[204:207], v[208:211]
    buffer_load_dwordx2 v[52:53], v22, s[32:35], 0 offen offset:16
    v_perm_b32 v9, v94, v35, s39
    v_mfma_f32_16x16x32_bf16 v[212:215], a[160:163], a[180:183], v[212:215]
    ds_read_b32 a213, v8
    v_perm_b32 v10, v72, v35, s38
    v_mfma_f32_16x16x32_bf16 v[212:215], a[0:3], a[224:227], v[212:215]
    ds_read_b128 a[220:223], v42 offset:45056
    ds_read_b32 a15, v9
    v_mfma_f32_16x16x32_bf16 v[216:219], a[160:163], a[88:91], v[216:219]
    ds_read_b32 a214, v10
    v_perm_b32 v11, v72, v35, s39
    v_mfma_f32_16x16x32_bf16 v[216:219], a[0:3], a[96:99], v[216:219]
    s_waitcnt vmcnt(20)
    ds_read_b128 a[228:231], v43 offset:45056
    v_mfma_f32_16x16x32_bf16 v[220:223], a[160:163], a[112:115], v[220:223]
    s_mov_b32 s42, 114688
    ds_read_b32 a215, v11
    v_perm_b32 v12, v76, v35, s36
    v_mfma_f32_16x16x32_bf16 v[220:223], a[0:3], a[116:119], v[220:223]
    s_waitcnt lgkmcnt(9)
    buffer_load_dwordx3 v[120:122], v33, s[12:15], s42 offen sc1
    v_perm_b32 v13, v106, v35, s36
    v_mfma_f32_16x16x32_bf16 v[224:227], a[56:59], a[24:27], v[224:227]
    ds_read_b32 a240, v12
    v_perm_b32 v14, v76, v35, s37
    v_mfma_f32_16x16x32_bf16 v[224:227], a[184:187], a[28:31], v[224:227]
    ds_read_b32 a32, v13
    v_mfma_f32_16x16x32_bf16 v[228:231], a[56:59], a[44:47], v[228:231]
    s_mov_b32 s43, 98304
    ds_read_b32 a241, v14
    v_perm_b32 v15, v76, v35, s38
    v_mfma_f32_16x16x32_bf16 v[228:231], a[184:187], a[60:63], v[228:231]
    buffer_load_dwordx3 v[124:126], v32, s[12:15], s43 offen sc1
    v_mfma_f32_16x16x32_bf16 v[232:235], a[56:59], a[120:123], v[232:235]
    ds_read_b32 a242, v15
    v_perm_b32 v56, v76, v35, s39
    v_mfma_f32_16x16x32_bf16 v[232:235], a[184:187], a[72:75], v[232:235]
    buffer_load_dword v127, v34, s[12:15], s43 offen sc1
    v_perm_b32 v57, v106, v35, s37
    v_mfma_f32_16x16x32_bf16 v[236:239], a[56:59], a[104:107], v[236:239]
    ds_read_b32 a243, v56
    v_perm_b32 v58, v73, v35, s36
    v_mfma_f32_16x16x32_bf16 v[236:239], a[184:187], a[164:167], v[236:239]
    ds_read_b32 a33, v57
    v_mfma_f32_16x16x32_bf16 v[240:243], a[56:59], a[148:151], v[240:243]
    ds_read_b32 a36, v58
    v_perm_b32 v59, v73, v35, s37
    v_mfma_f32_16x16x32_bf16 v[240:243], a[184:187], a[204:207], v[240:243]
    buffer_load_dwordx2 v[54:55], v23, s[32:35], 0 offen
    v_mfma_f32_16x16x32_bf16 v[244:247], a[56:59], a[180:183], v[244:247]
    s_mov_b32 s44, 102400
    ds_read_b32 a37, v59
    v_perm_b32 v60, v73, v35, s38
    v_mfma_f32_16x16x32_bf16 v[244:247], a[184:187], a[224:227], v[244:247]
    buffer_load_dwordx3 v[88:90], v32, s[12:15], s44 offen sc1
    v_perm_b32 v62, v106, v35, s38
    v_mfma_f32_16x16x32_bf16 v[248:251], a[56:59], a[88:91], v[248:251]
    ds_read_b32 a38, v60
    v_perm_b32 v61, v73, v35, s39
    v_mfma_f32_16x16x32_bf16 v[248:251], a[184:187], a[96:99], v[248:251]
    ds_read_b32 a34, v62
    v_mfma_f32_16x16x32_bf16 v[252:255], a[56:59], a[112:115], v[252:255]
    ds_read_b32 a39, v61
    v_perm_b32 v63, v77, v35, s36
    v_mfma_f32_16x16x32_bf16 v[252:255], a[184:187], a[116:119], v[252:255]
    s_waitcnt lgkmcnt(6)
    s_barrier
    buffer_load_dword v91, v34, s[12:15], s44 offen sc1
    v_mfma_f32_16x16x32_bf16 v[128:131], a[212:215], a[132:135], v[128:131]
    ds_read_b32 a48, v63
    v_perm_b32 v8, v77, v35, s37
    v_mfma_f32_16x16x32_bf16 v[128:131], a[240:243], a[144:147], v[128:131]
    ds_read_b128 a[136:139], v44 offset:0
    v_perm_b32 v9, v106, v35, s39
    v_mfma_f32_16x16x32_bf16 v[132:135], a[212:215], a[188:191], v[132:135]
    ds_read_b32 a49, v8
    v_perm_b32 v10, v77, v35, s38
    v_mfma_f32_16x16x32_bf16 v[132:135], a[240:243], a[216:219], v[132:135]
    s_add_u32 s56, s55, 768
    ds_read_b128 a[168:171], v45 offset:0
    ds_read_b32 a35, v9
    v_mfma_f32_16x16x32_bf16 v[136:139], a[212:215], a[232:235], v[136:139]
    s_add_u32 m0, s57, 32768
    ds_read_b32 a50, v10
    v_perm_b32 v11, v77, v35, s39
    v_mfma_f32_16x16x32_bf16 v[136:139], a[240:243], a[252:255], v[136:139]
    buffer_load_dwordx4 v36, s[8:11], s56 offen offset:0 lds
    v_mfma_f32_16x16x32_bf16 v[140:143], a[212:215], a[248:251], v[140:143]
    ds_read_b32 a51, v11
    v_perm_b32 v12, v74, v35, s36
    v_mfma_f32_16x16x32_bf16 v[140:143], a[240:243], a[176:179], v[140:143]
    ds_read_b128 a[172:175], v44 offset:2048
    v_perm_b32 v13, v118, v35, s36
    v_mfma_f32_16x16x32_bf16 v[144:147], a[212:215], a[84:87], v[144:147]
    ds_read_b32 a76, v12
    v_perm_b32 v14, v74, v35, s37
    v_mfma_f32_16x16x32_bf16 v[144:147], a[240:243], a[4:7], v[144:147]
    ds_read_b128 a[52:55], v45 offset:2048
    ds_read_b32 a108, v13
    v_mfma_f32_16x16x32_bf16 v[148:151], a[212:215], a[16:19], v[148:151]
    ds_read_b32 a77, v14
    v_perm_b32 v15, v74, v35, s38
    v_mfma_f32_16x16x32_bf16 v[148:151], a[240:243], a[192:195], v[148:151]
    buffer_load_dwordx4 v37, s[8:11], s56 offen offset:1024 lds
    v_mfma_f32_16x16x32_bf16 v[152:155], a[212:215], a[196:199], v[152:155]
    ds_read_b32 a78, v15
    v_perm_b32 v56, v74, v35, s39
    v_mfma_f32_16x16x32_bf16 v[152:155], a[240:243], a[208:211], v[152:155]
    ds_read_b128 a[152:155], v44 offset:4096
    v_perm_b32 v57, v118, v35, s37
    v_mfma_f32_16x16x32_bf16 v[156:159], a[212:215], a[220:223], v[156:159]
    ds_read_b32 a79, v56
    v_perm_b32 v58, v78, v35, s36
    v_mfma_f32_16x16x32_bf16 v[156:159], a[240:243], a[228:231], v[156:159]
    s_waitcnt lgkmcnt(8)
    ds_read_b128 a[128:131], v45 offset:4096
    ds_read_b32 a109, v57
    v_mfma_f32_16x16x32_bf16 v[160:163], a[36:39], a[132:135], v[160:163]
    ds_read_b32 a200, v58
    v_perm_b32 v59, v78, v35, s37
    v_mfma_f32_16x16x32_bf16 v[160:163], a[48:51], a[144:147], v[160:163]
    buffer_load_dwordx4 v38, s[8:11], s56 offen offset:2048 lds
    v_mfma_f32_16x16x32_bf16 v[164:167], a[36:39], a[188:191], v[164:167]
    ds_read_b32 a201, v59
    v_perm_b32 v60, v78, v35, s38
    v_mfma_f32_16x16x32_bf16 v[164:167], a[48:51], a[216:219], v[164:167]
    ds_read_b128 a[100:103], v44 offset:6144
    v_perm_b32 v62, v118, v35, s38
    v_mfma_f32_16x16x32_bf16 v[168:171], a[36:39], a[232:235], v[168:171]
    ds_read_b32 a202, v60
    v_perm_b32 v61, v78, v35, s39
    v_mfma_f32_16x16x32_bf16 v[168:171], a[48:51], a[252:255], v[168:171]
    ds_read_b128 a[124:127], v45 offset:6144
    ds_read_b32 a110, v62
    v_mfma_f32_16x16x32_bf16 v[172:175], a[36:39], a[248:251], v[172:175]
    s_waitcnt vmcnt(28)
    ds_read_b32 a203, v61
    v_perm_b32 v63, v80, v35, s36
    v_mfma_f32_16x16x32_bf16 v[172:175], a[48:51], a[176:179], v[172:175]
    buffer_load_dwordx4 v39, s[8:11], s56 offen offset:3072 lds
    v_mfma_f32_16x16x32_bf16 v[176:179], a[36:39], a[84:87], v[176:179]
    ds_read_b32 a160, v63
    v_perm_b32 v8, v80, v35, s37
    v_mfma_f32_16x16x32_bf16 v[176:179], a[48:51], a[4:7], v[176:179]
    ds_read_b128 a[0:3], v44 offset:8192
    v_perm_b32 v9, v118, v35, s39
    v_mfma_f32_16x16x32_bf16 v[180:183], a[36:39], a[16:19], v[180:183]
    ds_read_b32 a161, v8
    v_perm_b32 v10, v80, v35, s38
    v_mfma_f32_16x16x32_bf16 v[180:183], a[48:51], a[192:195], v[180:183]
    s_add_u32 s56, s55, 896
    ds_read_b128 a[24:27], v45 offset:8192
    ds_read_b32 a111, v9
    v_mfma_f32_16x16x32_bf16 v[184:187], a[36:39], a[196:199], v[184:187]
    s_add_u32 m0, s57, 51200
    ds_read_b32 a162, v10
    v_perm_b32 v11, v80, v35, s39
    v_mfma_f32_16x16x32_bf16 v[184:187], a[48:51], a[208:211], v[184:187]
    buffer_load_dwordx4 v36, s[8:11], s56 offen offset:0 lds
    v_mfma_f32_16x16x32_bf16 v[188:191], a[36:39], a[220:223], v[188:191]
    s_waitcnt vmcnt(27)
    ds_read_b32 a163, v11
    v_perm_b32 v12, v84, v35, s36
    v_mfma_f32_16x16x32_bf16 v[188:191], a[48:51], a[228:231], v[188:191]
    s_waitcnt vmcnt(16) lgkmcnt(7)
    ds_read_b128 a[28:31], v44 offset:10240
    v_perm_b32 v13, v99, v35, s36
    v_mfma_f32_16x16x32_bf16 v[192:195], a[76:79], a[132:135], v[192:195]
    ds_read_b32 a44, v12
    v_perm_b32 v14, v84, v35, s37
    v_mfma_f32_16x16x32_bf16 v[192:195], a[200:203], a[144:147], v[192:195]
    ds_read_b128 a[60:63], v45 offset:10240
    ds_read_b32 a120, v13
    v_mfma_f32_16x16x32_bf16 v[196:199], a[76:79], a[188:191], v[196:199]
    ds_read_b32 a45, v14
    v_perm_b32 v15, v84, v35, s38
    v_mfma_f32_16x16x32_bf16 v[196:199], a[200:203], a[216:219], v[196:199]
    buffer_load_dwordx4 v37, s[8:11], s56 offen offset:1024 lds
    v_mfma_f32_16x16x32_bf16 v[200:203], a[76:79], a[232:235], v[200:203]
    ds_read_b32 a46, v15
    v_perm_b32 v56, v84, v35, s39
    v_mfma_f32_16x16x32_bf16 v[200:203], a[200:203], a[252:255], v[200:203]
    ds_read_b128 a[72:75], v44 offset:12288
    v_perm_b32 v57, v99, v35, s37
    v_mfma_f32_16x16x32_bf16 v[204:207], a[76:79], a[248:251], v[204:207]
    ds_read_b32 a47, v56
    v_perm_b32 v58, v81, v35, s36
    v_mfma_f32_16x16x32_bf16 v[204:207], a[200:203], a[176:179], v[204:207]
    ds_read_b128 a[104:107], v45 offset:12288
    ds_read_b32 a121, v57
    v_mfma_f32_16x16x32_bf16 v[208:211], a[76:79], a[84:87], v[208:211]
    s_add_u32 m0, s57, 47104
    ds_read_b32 a164, v58
    v_perm_b32 v59, v81, v35, s37
    v_mfma_f32_16x16x32_bf16 v[208:211], a[200:203], a[4:7], v[208:211]
    buffer_load_dwordx4 v38, s[8:11], s56 offen offset:2048 lds
    v_mfma_f32_16x16x32_bf16 v[212:215], a[76:79], a[16:19], v[212:215]
    ds_read_b32 a165, v59
    v_perm_b32 v60, v81, v35, s38
    v_mfma_f32_16x16x32_bf16 v[212:215], a[200:203], a[192:195], v[212:215]
    ds_read_b128 a[148:151], v44 offset:14336
    v_perm_b32 v62, v99, v35, s38
    v_mfma_f32_16x16x32_bf16 v[216:219], a[76:79], a[196:199], v[216:219]
    ds_read_b32 a166, v60
    v_perm_b32 v61, v81, v35, s39
    v_mfma_f32_16x16x32_bf16 v[216:219], a[200:203], a[208:211], v[216:219]
    ds_read_b128 a[204:207], v45 offset:14336
    ds_read_b32 a122, v62
    v_mfma_f32_16x16x32_bf16 v[220:223], a[76:79], a[220:223], v[220:223]
    ds_read_b32 a167, v61
    v_perm_b32 v63, v85, v35, s36
    v_mfma_f32_16x16x32_bf16 v[220:223], a[200:203], a[228:231], v[220:223]
    s_waitcnt lgkmcnt(9)
    buffer_load_dwordx4 v39, s[8:11], s56 offen offset:3072 lds
    v_mfma_f32_16x16x32_bf16 v[128:131], a[160:163], a[136:139], v[128:131]
    ds_read_b32 a180, v63
    v_perm_b32 v8, v85, v35, s37
    v_mfma_f32_16x16x32_bf16 v[128:131], a[44:47], a[168:171], v[128:131]
    ds_read_b128 a[224:227], v46 offset:2048
    v_perm_b32 v9, v99, v35, s39
    v_mfma_f32_16x16x32_bf16 v[132:135], a[160:163], a[172:175], v[132:135]
    ds_read_b32 a181, v8
    v_perm_b32 v10, v85, v35, s38
    v_mfma_f32_16x16x32_bf16 v[132:135], a[44:47], a[52:55], v[132:135]
    ds_read_b128 a[88:91], v47 offset:2048
    ds_read_b32 a123, v9
    v_mfma_f32_16x16x32_bf16 v[136:139], a[160:163], a[152:155], v[136:139]
    s_mov_b32 s45, 118784
    ds_read_b32 a182, v10
    v_perm_b32 v11, v85, v35, s39
    v_mfma_f32_16x16x32_bf16 v[136:139], a[44:47], a[128:131], v[136:139]
    buffer_load_dwordx3 v[64:66], v33, s[12:15], s45 offen sc1
    v_mfma_f32_16x16x32_bf16 v[140:143], a[160:163], a[100:103], v[140:143]
    ds_read_b32 a183, v11
    v_perm_b32 v12, v82, v35, s36
    v_mfma_f32_16x16x32_bf16 v[140:143], a[44:47], a[124:127], v[140:143]
    s_waitcnt vmcnt(18)
    ds_read_b128 a[96:99], v46 offset:0
    v_perm_b32 v13, v103, v35, s36
    v_mfma_f32_16x16x32_bf16 v[144:147], a[160:163], a[0:3], v[144:147]
    ds_read_b32 a112, v12
    v_perm_b32 v14, v82, v35, s37
    v_mfma_f32_16x16x32_bf16 v[144:147], a[44:47], a[24:27], v[144:147]
    ds_read_b128 a[56:59], v47 offset:0
    ds_read_b32 a116, v13
    v_mfma_f32_16x16x32_bf16 v[148:151], a[160:163], a[28:31], v[148:151]
    s_mov_b32 s46, 98304
    ds_read_b32 a113, v14
    v_perm_b32 v15, v82, v35, s38
    v_mfma_f32_16x16x32_bf16 v[148:151], a[44:47], a[60:63], v[148:151]
    buffer_load_dwordx3 v[68:70], v33, s[12:15], s46 offen sc1
    v_mfma_f32_16x16x32_bf16 v[152:155], a[160:163], a[72:75], v[152:155]
    s_waitcnt lgkmcnt(7)
    ds_read_b32 a114, v15
    v_perm_b32 v56, v82, v35, s39
    v_mfma_f32_16x16x32_bf16 v[152:155], a[44:47], a[104:107], v[152:155]
    ds_read_b128 a[184:187], v46 offset:6144
    v_perm_b32 v57, v103, v35, s37
    v_mfma_f32_16x16x32_bf16 v[156:159], a[160:163], a[148:151], v[156:159]
    ds_read_b32 a115, v56
    v_perm_b32 v58, v86, v35, s36
    v_mfma_f32_16x16x32_bf16 v[156:159], a[44:47], a[204:207], v[156:159]
    s_waitcnt lgkmcnt(8)
    ds_read_b128 a[212:215], v47 offset:6144
    ds_read_b32 a117, v57
    v_mfma_f32_16x16x32_bf16 v[160:163], a[164:167], a[136:139], v[160:163]
    s_mov_b32 s47, 102400
    ds_read_b32 a240, v58
    v_perm_b32 v59, v86, v35, s37
    v_mfma_f32_16x16x32_bf16 v[160:163], a[180:183], a[168:171], v[160:163]
    buffer_load_dwordx3 v[92:94], v33, s[12:15], s47 offen sc1
    v_mfma_f32_16x16x32_bf16 v[164:167], a[164:167], a[172:175], v[164:167]
    ds_read_b32 a241, v59
    v_perm_b32 v60, v86, v35, s38
    v_mfma_f32_16x16x32_bf16 v[164:167], a[180:183], a[52:55], v[164:167]
    ds_read_b128 a[36:39], v46 offset:4096
    v_perm_b32 v62, v103, v35, s38
    v_mfma_f32_16x16x32_bf16 v[168:171], a[164:167], a[152:155], v[168:171]
    ds_read_b32 a242, v60
    v_perm_b32 v61, v86, v35, s39
    v_mfma_f32_16x16x32_bf16 v[168:171], a[180:183], a[128:131], v[168:171]
    ds_read_b128 a[48:51], v47 offset:4096
    ds_read_b32 a118, v62
    v_mfma_f32_16x16x32_bf16 v[172:175], a[164:167], a[100:103], v[172:175]
    ds_read_b32 a243, v61
    v_perm_b32 v63, v83, v35, s36
    v_mfma_f32_16x16x32_bf16 v[172:175], a[180:183], a[124:127], v[172:175]
    v_mfma_f32_16x16x32_bf16 v[176:179], a[164:167], a[0:3], v[176:179]
    ds_read_b32 a132, v63
    v_perm_b32 v8, v83, v35, s37
    v_mfma_f32_16x16x32_bf16 v[176:179], a[180:183], a[24:27], v[176:179]
    ds_read_b128 a[144:147], v46 offset:10240
    v_perm_b32 v9, v103, v35, s39
    v_mfma_f32_16x16x32_bf16 v[180:183], a[164:167], a[28:31], v[180:183]
    ds_read_b32 a133, v8
    v_perm_b32 v10, v83, v35, s38
    v_mfma_f32_16x16x32_bf16 v[180:183], a[180:183], a[60:63], v[180:183]
    ds_read_b128 a[188:191], v47 offset:10240
    ds_read_b32 a119, v9
    v_mfma_f32_16x16x32_bf16 v[184:187], a[164:167], a[72:75], v[184:187]
    ds_read_b32 a134, v10
    v_perm_b32 v11, v83, v35, s39
    v_mfma_f32_16x16x32_bf16 v[184:187], a[180:183], a[104:107], v[184:187]
    v_mfma_f32_16x16x32_bf16 v[188:191], a[164:167], a[148:151], v[188:191]
    ds_read_b32 a135, v11
    v_perm_b32 v12, v87, v35, s36
    v_mfma_f32_16x16x32_bf16 v[188:191], a[180:183], a[204:207], v[188:191]
    s_waitcnt lgkmcnt(7)
    ds_read_b128 a[216:219], v46 offset:8192
    v_perm_b32 v13, v96, v35, s36
    v_mfma_f32_16x16x32_bf16 v[192:195], a[112:115], a[136:139], v[192:195]
    ds_read_b32 a232, v12
    v_perm_b32 v14, v87, v35, s37
    v_mfma_f32_16x16x32_bf16 v[192:195], a[240:243], a[168:171], v[192:195]
    ds_read_b128 a[252:255], v47 offset:8192
    ds_read_b32 a248, v13
    v_mfma_f32_16x16x32_bf16 v[196:199], a[112:115], a[172:175], v[196:199]
    ds_read_b32 a233, v14
    v_perm_b32 v15, v87, v35, s38
    v_mfma_f32_16x16x32_bf16 v[196:199], a[240:243], a[52:55], v[196:199]
    v_mfma_f32_16x16x32_bf16 v[200:203], a[112:115], a[152:155], v[200:203]
    ds_read_b32 a234, v15
    v_perm_b32 v56, v87, v35, s39
    v_mfma_f32_16x16x32_bf16 v[200:203], a[240:243], a[128:131], v[200:203]
    ds_read_b128 a[176:179], v46 offset:14336
    v_perm_b32 v57, v96, v35, s37
    v_mfma_f32_16x16x32_bf16 v[204:207], a[112:115], a[100:103], v[204:207]
    s_waitcnt vmcnt(19)
    ds_read_b32 a235, v56
    v_perm_b32 v58, v108, v35, s36
    v_mfma_f32_16x16x32_bf16 v[204:207], a[240:243], a[124:127], v[204:207]
    ds_read_b128 a[84:87], v47 offset:14336
    ds_read_b32 a249, v57
    v_mfma_f32_16x16x32_bf16 v[208:211], a[112:115], a[0:3], v[208:211]
    ds_read_b32 a4, v58
    v_perm_b32 v59, v108, v35, s37
    v_mfma_f32_16x16x32_bf16 v[208:211], a[240:243], a[24:27], v[208:211]
    v_mfma_f32_16x16x32_bf16 v[212:215], a[112:115], a[28:31], v[212:215]
    ds_read_b32 a5, v59
    v_perm_b32 v60, v108, v35, s38
    v_mfma_f32_16x16x32_bf16 v[212:215], a[240:243], a[60:63], v[212:215]
    ds_read_b128 a[16:19], v46 offset:12288
    v_perm_b32 v62, v96, v35, s38
    v_mfma_f32_16x16x32_bf16 v[216:219], a[112:115], a[72:75], v[216:219]
    ds_read_b32 a6, v60
    v_perm_b32 v61, v108, v35, s39
    v_mfma_f32_16x16x32_bf16 v[216:219], a[240:243], a[104:107], v[216:219]
    ds_read_b128 a[192:195], v47 offset:12288
    ds_read_b32 a250, v62
    v_mfma_f32_16x16x32_bf16 v[220:223], a[112:115], a[148:151], v[220:223]
    s_waitcnt vmcnt(18)
    ds_read_b32 a7, v61
    v_perm_b32 v63, v112, v35, s36
    v_mfma_f32_16x16x32_bf16 v[220:223], a[240:243], a[204:207], v[220:223]
    s_waitcnt lgkmcnt(9)
    v_mfma_f32_16x16x32_bf16 v[224:227], a[132:135], a[136:139], v[224:227]
    ds_read_b32 a196, v63
    v_perm_b32 v8, v112, v35, s37
    v_mfma_f32_16x16x32_bf16 v[224:227], a[232:235], a[168:171], v[224:227]
    v_perm_b32 v9, v96, v35, s39
    v_mfma_f32_16x16x32_bf16 v[228:231], a[132:135], a[172:175], v[228:231]
    ds_read_b32 a197, v8
    v_perm_b32 v10, v112, v35, s38
    v_mfma_f32_16x16x32_bf16 v[228:231], a[232:235], a[52:55], v[228:231]
    ds_read_b32 a251, v9
    v_mfma_f32_16x16x32_bf16 v[232:235], a[132:135], a[152:155], v[232:235]
    ds_read_b32 a198, v10
    v_perm_b32 v11, v112, v35, s39
    v_mfma_f32_16x16x32_bf16 v[232:235], a[232:235], a[128:131], v[232:235]
    v_mfma_f32_16x16x32_bf16 v[236:239], a[132:135], a[100:103], v[236:239]
    ds_read_b32 a199, v11
    v_perm_b32 v12, v109, v35, s36
    v_mfma_f32_16x16x32_bf16 v[236:239], a[232:235], a[124:127], v[236:239]
    v_perm_b32 v13, v100, v35, s36
    v_mfma_f32_16x16x32_bf16 v[240:243], a[132:135], a[0:3], v[240:243]
    ds_read_b32 a208, v12
    v_perm_b32 v14, v109, v35, s37
    v_mfma_f32_16x16x32_bf16 v[240:243], a[232:235], a[24:27], v[240:243]
    ds_read_b32 a220, v13
    v_mfma_f32_16x16x32_bf16 v[244:247], a[132:135], a[28:31], v[244:247]
    ds_read_b32 a209, v14
    v_perm_b32 v15, v109, v35, s38
    v_mfma_f32_16x16x32_bf16 v[244:247], a[232:235], a[60:63], v[244:247]
    v_mfma_f32_16x16x32_bf16 v[248:251], a[132:135], a[72:75], v[248:251]
    ds_read_b32 a210, v15
    v_perm_b32 v56, v109, v35, s39
    v_mfma_f32_16x16x32_bf16 v[248:251], a[232:235], a[104:107], v[248:251]
    v_perm_b32 v57, v100, v35, s37
    v_mfma_f32_16x16x32_bf16 v[252:255], a[132:135], a[148:151], v[252:255]
    ds_read_b32 a211, v56
    v_perm_b32 v58, v113, v35, s36
    v_mfma_f32_16x16x32_bf16 v[252:255], a[232:235], a[204:207], v[252:255]
    s_waitcnt lgkmcnt(5)
    s_barrier
    ds_read_b32 a221, v57
    v_mfma_f32_16x16x32_bf16 v[128:131], a[4:7], a[224:227], v[128:131]
    ds_read_b32 a76, v58
    v_perm_b32 v59, v113, v35, s37
    v_mfma_f32_16x16x32_bf16 v[128:131], a[196:199], a[88:91], v[128:131]
    ds_read_b128 a[228:231], v40 offset:0
    v_mfma_f32_16x16x32_bf16 v[132:135], a[4:7], a[96:99], v[132:135]
    ds_read_b32 a77, v59
    v_perm_b32 v60, v113, v35, s38
    v_mfma_f32_16x16x32_bf16 v[132:135], a[196:199], a[56:59], v[132:135]
    s_add_u32 s56, s55, 1792
    ds_read_b128 a[200:203], v41 offset:0
    v_mfma_f32_16x16x32_bf16 v[136:139], a[4:7], a[184:187], v[136:139]
    s_add_u32 m0, s57, 65536
    ds_read_b32 a78, v60
    v_perm_b32 v62, v113, v35, s39
    v_mfma_f32_16x16x32_bf16 v[136:139], a[196:199], a[212:215], v[136:139]
    buffer_load_dwordx4 v36, s[8:11], s56 offen offset:0 lds
    v_perm_b32 v61, v100, v35, s38
    v_mfma_f32_16x16x32_bf16 v[140:143], a[4:7], a[36:39], v[140:143]
    ds_read_b32 a79, v62
    ds_read_b32 a222, v61
    v_mfma_f32_16x16x32_bf16 v[140:143], a[196:199], a[48:51], v[140:143]
    ds_read_b128 a[160:163], v40 offset:2048
    v_perm_b32 v63, v110, v35, s36
    v_mfma_f32_16x16x32_bf16 v[144:147], a[4:7], a[144:147], v[144:147]
    ds_read_b32 a44, v63
    v_perm_b32 v8, v110, v35, s37
    v_mfma_f32_16x16x32_bf16 v[144:147], a[196:199], a[188:191], v[144:147]
    ds_read_b128 a[164:167], v41 offset:2048
    v_mfma_f32_16x16x32_bf16 v[148:151], a[4:7], a[216:219], v[148:151]
    ds_read_b32 a45, v8
    v_perm_b32 v9, v110, v35, s38
    v_mfma_f32_16x16x32_bf16 v[148:151], a[196:199], a[252:255], v[148:151]
    buffer_load_dwordx4 v37, s[8:11], s56 offen offset:1024 lds
    v_perm_b32 v10, v100, v35, s39
    v_mfma_f32_16x16x32_bf16 v[152:155], a[4:7], a[176:179], v[152:155]
    ds_read_b32 a46, v9
    ds_read_b32 a223, v10
    v_mfma_f32_16x16x32_bf16 v[152:155], a[196:199], a[84:87], v[152:155]
    ds_read_b128 a[180:183], v40 offset:4096
    v_perm_b32 v11, v110, v35, s39
    v_mfma_f32_16x16x32_bf16 v[156:159], a[4:7], a[16:19], v[156:159]
    ds_read_b32 a47, v11
    v_perm_b32 v12, v114, v35, s36
    v_mfma_f32_16x16x32_bf16 v[156:159], a[196:199], a[192:195], v[156:159]
    s_waitcnt lgkmcnt(8)
    ds_read_b128 a[112:115], v41 offset:4096
    v_mfma_f32_16x16x32_bf16 v[160:163], a[208:211], a[224:227], v[160:163]
    ds_read_b32 a240, v12
    v_perm_b32 v13, v114, v35, s37
    v_mfma_f32_16x16x32_bf16 v[160:163], a[76:79], a[88:91], v[160:163]
    s_waitcnt vmcnt(18)
    buffer_load_dwordx4 v38, s[8:11], s56 offen offset:2048 lds
    v_perm_b32 v14, v120, v35, s36
    v_mfma_f32_16x16x32_bf16 v[164:167], a[208:211], a[96:99], v[164:167]
    ds_read_b32 a241, v13
    ds_read_b32 a136, v14
    v_mfma_f32_16x16x32_bf16 v[164:167], a[76:79], a[56:59], v[164:167]
    ds_read_b128 a[168:171], v40 offset:6144
    v_perm_b32 v15, v114, v35, s38
    v_mfma_f32_16x16x32_bf16 v[168:171], a[208:211], a[184:187], v[168:171]
    ds_read_b32 a242, v15
    v_perm_b32 v56, v114, v35, s39
    v_mfma_f32_16x16x32_bf16 v[168:171], a[76:79], a[212:215], v[168:171]
    ds_read_b128 a[172:175], v41 offset:6144
    v_mfma_f32_16x16x32_bf16 v[172:175], a[208:211], a[36:39], v[172:175]
    s_waitcnt vmcnt(18)
    ds_read_b32 a243, v56
    v_perm_b32 v57, v124, v35, s36
    v_mfma_f32_16x16x32_bf16 v[172:175], a[76:79], a[48:51], v[172:175]
    buffer_load_dwordx4 v39, s[8:11], s56 offen offset:3072 lds
    v_perm_b32 v58, v120, v35, s37
    v_mfma_f32_16x16x32_bf16 v[176:179], a[208:211], a[144:147], v[176:179]
    ds_read_b32 a52, v57
    ds_read_b32 a137, v58
    v_mfma_f32_16x16x32_bf16 v[176:179], a[76:79], a[188:191], v[176:179]
    ds_read_b128 a[152:155], v40 offset:8192
    v_perm_b32 v59, v124, v35, s37
    v_mfma_f32_16x16x32_bf16 v[180:183], a[208:211], a[216:219], v[180:183]
    ds_read_b32 a53, v59
    v_perm_b32 v60, v124, v35, s38
    v_mfma_f32_16x16x32_bf16 v[180:183], a[76:79], a[252:255], v[180:183]
    s_add_u32 s56, s55, 1920
    ds_read_b128 a[128:131], v41 offset:8192
    v_mfma_f32_16x16x32_bf16 v[184:187], a[208:211], a[176:179], v[184:187]
    s_add_u32 m0, s57, 83968
    ds_read_b32 a54, v60
    v_perm_b32 v62, v124, v35, s39
    v_mfma_f32_16x16x32_bf16 v[184:187], a[76:79], a[84:87], v[184:187]
    buffer_load_dwordx4 v36, s[8:11], s56 offen offset:0 lds
    v_perm_b32 v61, v120, v35, s38
    v_mfma_f32_16x16x32_bf16 v[188:191], a[208:211], a[16:19], v[188:191]
    ds_read_b32 a55, v62
    ds_read_b32 a138, v61
    v_mfma_f32_16x16x32_bf16 v[188:191], a[76:79], a[192:195], v[188:191]
    s_waitcnt vmcnt(17) lgkmcnt(8)
    ds_read_b128 a[100:103], v40 offset:10240
    v_perm_b32 v63, v88, v35, s36
    v_mfma_f32_16x16x32_bf16 v[192:195], a[44:47], a[224:227], v[192:195]
    ds_read_b32 a124, v63
    v_perm_b32 v8, v88, v35, s37
    v_mfma_f32_16x16x32_bf16 v[192:195], a[240:243], a[88:91], v[192:195]
    ds_read_b128 a[0:3], v41 offset:10240
    v_mfma_f32_16x16x32_bf16 v[196:199], a[44:47], a[96:99], v[196:199]
    ds_read_b32 a125, v8
    v_perm_b32 v9, v88, v35, s38
    v_mfma_f32_16x16x32_bf16 v[196:199], a[240:243], a[56:59], v[196:199]
    buffer_load_dwordx4 v37, s[8:11], s56 offen offset:1024 lds
    v_perm_b32 v10, v120, v35, s39
    v_mfma_f32_16x16x32_bf16 v[200:203], a[44:47], a[184:187], v[200:203]
    ds_read_b32 a126, v9
    ds_read_b32 a139, v10
    v_mfma_f32_16x16x32_bf16 v[200:203], a[240:243], a[212:215], v[200:203]
    ds_read_b128 a[24:27], v40 offset:12288
    v_perm_b32 v11, v88, v35, s39
    v_mfma_f32_16x16x32_bf16 v[204:207], a[44:47], a[36:39], v[204:207]
    ds_read_b32 a127, v11
    v_perm_b32 v12, v125, v35, s36
    v_mfma_f32_16x16x32_bf16 v[204:207], a[240:243], a[48:51], v[204:207]
    ds_read_b128 a[28:31], v41 offset:12288
    v_mfma_f32_16x16x32_bf16 v[208:211], a[44:47], a[144:147], v[208:211]
    s_add_u32 m0, s57, 79872
    ds_read_b32 a60, v12
    v_perm_b32 v13, v125, v35, s37
    v_mfma_f32_16x16x32_bf16 v[208:211], a[240:243], a[188:191], v[208:211]
    s_waitcnt vmcnt(8)
    buffer_load_dwordx4 v38, s[8:11], s56 offen offset:2048 lds
    v_perm_b32 v14, v64, v35, s36
    v_mfma_f32_16x16x32_bf16 v[212:215], a[44:47], a[216:219], v[212:215]
    ds_read_b32 a61, v13
    ds_read_b32 a72, v14
    v_mfma_f32_16x16x32_bf16 v[212:215], a[240:243], a[252:255], v[212:215]
    ds_read_b128 a[104:107], v40 offset:14336
    v_perm_b32 v15, v125, v35, s38
    v_mfma_f32_16x16x32_bf16 v[216:219], a[44:47], a[176:179], v[216:219]
    ds_read_b32 a62, v15
    v_perm_b32 v56, v125, v35, s39
    v_mfma_f32_16x16x32_bf16 v[216:219], a[240:243], a[84:87], v[216:219]
    ds_read_b128 a[148:151], v41 offset:14336
    v_mfma_f32_16x16x32_bf16 v[220:223], a[44:47], a[16:19], v[220:223]
    ds_read_b32 a63, v56
    v_perm_b32 v57, v89, v35, s36
    v_mfma_f32_16x16x32_bf16 v[220:223], a[240:243], a[192:195], v[220:223]
    s_waitcnt lgkmcnt(8)
    buffer_load_dwordx4 v39, s[8:11], s56 offen offset:3072 lds
    v_perm_b32 v58, v64, v35, s37
    v_mfma_f32_16x16x32_bf16 v[128:131], a[52:55], a[228:231], v[128:131]
    ds_read_b32 a132, v57
    ds_read_b32 a73, v58
    v_mfma_f32_16x16x32_bf16 v[128:131], a[124:127], a[200:203], v[128:131]
    ds_read_b128 a[204:207], v42 offset:2048
    v_perm_b32 v59, v89, v35, s37
    v_mfma_f32_16x16x32_bf16 v[132:135], a[52:55], a[160:163], v[132:135]
    ds_read_b32 a133, v59
    v_perm_b32 v60, v89, v35, s38
    v_mfma_f32_16x16x32_bf16 v[132:135], a[124:127], a[164:167], v[132:135]
    ds_read_b128 a[232:235], v43 offset:2048
    v_perm_b32 v62, v64, v35, s38
    v_mfma_f32_16x16x32_bf16 v[136:139], a[52:55], a[180:183], v[136:139]
    ds_read_b32 a134, v60
    v_perm_b32 v61, v89, v35, s39
    v_mfma_f32_16x16x32_bf16 v[136:139], a[124:127], a[112:115], v[136:139]
    ds_read_b32 a74, v62
    v_mfma_f32_16x16x32_bf16 v[140:143], a[52:55], a[168:171], v[140:143]
    ds_read_b32 a135, v61
    v_perm_b32 v63, v126, v35, s36
    v_mfma_f32_16x16x32_bf16 v[140:143], a[124:127], a[172:175], v[140:143]
    ds_read_b128 a[4:7], v42 offset:0
    v_mfma_f32_16x16x32_bf16 v[144:147], a[52:55], a[152:155], v[144:147]
    ds_read_b32 a196, v63
    v_perm_b32 v8, v126, v35, s37
    v_mfma_f32_16x16x32_bf16 v[144:147], a[124:127], a[128:131], v[144:147]
    ds_read_b128 a[208:211], v43 offset:0
    v_perm_b32 v9, v64, v35, s39
    v_mfma_f32_16x16x32_bf16 v[148:151], a[52:55], a[100:103], v[148:151]
    ds_read_b32 a197, v8
    v_perm_b32 v10, v126, v35, s38
    v_mfma_f32_16x16x32_bf16 v[148:151], a[124:127], a[0:3], v[148:151]
    ds_read_b32 a75, v9
    v_mfma_f32_16x16x32_bf16 v[152:155], a[52:55], a[24:27], v[152:155]
    s_waitcnt lgkmcnt(8)
    ds_read_b32 a198, v10
    v_perm_b32 v11, v126, v35, s39
    v_mfma_f32_16x16x32_bf16 v[152:155], a[124:127], a[28:31], v[152:155]
    ds_read_b128 a[76:79], v42 offset:6144
    v_mfma_f32_16x16x32_bf16 v[156:159], a[52:55], a[104:107], v[156:159]
    ds_read_b32 a199, v11
    v_perm_b32 v12, v90, v35, s36
    v_mfma_f32_16x16x32_bf16 v[156:159], a[124:127], a[148:151], v[156:159]
    ds_read_b128 a[224:227], v43 offset:6144
    v_perm_b32 v13, v97, v35, s36
    v_mfma_f32_16x16x32_bf16 v[160:163], a[60:63], a[228:231], v[160:163]
    s_waitcnt lgkmcnt(8)
    ds_read_b32 a88, v12
    v_perm_b32 v14, v90, v35, s37
    v_mfma_f32_16x16x32_bf16 v[160:163], a[132:135], a[200:203], v[160:163]
    ds_read_b32 a96, v13
    v_mfma_f32_16x16x32_bf16 v[164:167], a[60:63], a[160:163], v[164:167]
    ds_read_b32 a89, v14
    v_perm_b32 v15, v90, v35, s38
    v_mfma_f32_16x16x32_bf16 v[164:167], a[132:135], a[164:167], v[164:167]
    ds_read_b128 a[56:59], v42 offset:4096
    v_mfma_f32_16x16x32_bf16 v[168:171], a[60:63], a[180:183], v[168:171]
    ds_read_b32 a90, v15
    v_perm_b32 v56, v90, v35, s39
    v_mfma_f32_16x16x32_bf16 v[168:171], a[132:135], a[112:115], v[168:171]
    ds_read_b128 a[184:187], v43 offset:4096
    v_perm_b32 v57, v97, v35, s37
    v_mfma_f32_16x16x32_bf16 v[172:175], a[60:63], a[168:171], v[172:175]
    ds_read_b32 a91, v56
    v_perm_b32 v58, v127, v35, s36
    v_mfma_f32_16x16x32_bf16 v[172:175], a[132:135], a[172:175], v[172:175]
    ds_read_b32 a97, v57
    v_mfma_f32_16x16x32_bf16 v[176:179], a[60:63], a[152:155], v[176:179]
    ds_read_b32 a212, v58
    v_perm_b32 v59, v127, v35, s37
    v_mfma_f32_16x16x32_bf16 v[176:179], a[132:135], a[128:131], v[176:179]
    ds_read_b128 a[36:39], v42 offset:10240
    v_mfma_f32_16x16x32_bf16 v[180:183], a[60:63], a[100:103], v[180:183]
    ds_read_b32 a213, v59
    v_perm_b32 v60, v127, v35, s38
    v_mfma_f32_16x16x32_bf16 v[180:183], a[132:135], a[0:3], v[180:183]
    ds_read_b128 a[48:51], v43 offset:10240
    v_perm_b32 v62, v97, v35, s38
    v_mfma_f32_16x16x32_bf16 v[184:187], a[60:63], a[24:27], v[184:187]
    ds_read_b32 a214, v60
    v_perm_b32 v61, v127, v35, s39
    v_mfma_f32_16x16x32_bf16 v[184:187], a[132:135], a[28:31], v[184:187]
    ds_read_b32 a98, v62
    v_mfma_f32_16x16x32_bf16 v[188:191], a[60:63], a[104:107], v[188:191]
    ds_read_b32 a215, v61
    v_perm_b32 v63, v91, v35, s36
    v_mfma_f32_16x16x32_bf16 v[188:191], a[132:135], a[148:151], v[188:191]
    s_waitcnt lgkmcnt(8)
    ds_read_b128 a[144:147], v42 offset:8192
    v_mfma_f32_16x16x32_bf16 v[192:195], a[196:199], a[228:231], v[192:195]
    ds_read_b32 a188, v63
    v_perm_b32 v8, v91, v35, s37
    v_mfma_f32_16x16x32_bf16 v[192:195], a[88:91], a[200:203], v[192:195]
    ds_read_b128 a[216:219], v43 offset:8192
    v_perm_b32 v9, v97, v35, s39
    v_mfma_f32_16x16x32_bf16 v[196:199], a[196:199], a[160:163], v[196:199]
    ds_read_b32 a189, v8
    v_perm_b32 v10, v91, v35, s38
    v_mfma_f32_16x16x32_bf16 v[196:199], a[88:91], a[164:167], v[196:199]
    ds_read_b32 a99, v9
    v_mfma_f32_16x16x32_bf16 v[200:203], a[196:199], a[180:183], v[200:203]
    ds_read_b32 a190, v10
    v_perm_b32 v11, v91, v35, s39
    v_mfma_f32_16x16x32_bf16 v[200:203], a[88:91], a[112:115], v[200:203]
    ds_read_b128 a[252:255], v42 offset:14336
    v_mfma_f32_16x16x32_bf16 v[204:207], a[196:199], a[168:171], v[204:207]
    s_waitcnt vmcnt(9)
    ds_read_b32 a191, v11
    v_perm_b32 v12, v68, v35, s36
    v_mfma_f32_16x16x32_bf16 v[204:207], a[88:91], a[172:175], v[204:207]
    ds_read_b128 a[176:179], v43 offset:14336
    v_perm_b32 v13, v101, v35, s36
    v_mfma_f32_16x16x32_bf16 v[208:211], a[196:199], a[152:155], v[208:211]
    ds_read_b32 a84, v12
    v_perm_b32 v14, v68, v35, s37
    v_mfma_f32_16x16x32_bf16 v[208:211], a[88:91], a[128:131], v[208:211]
    ds_read_b32 a16, v13
    v_mfma_f32_16x16x32_bf16 v[212:215], a[196:199], a[100:103], v[212:215]
    ds_read_b32 a85, v14
    v_perm_b32 v15, v68, v35, s38
    v_mfma_f32_16x16x32_bf16 v[212:215], a[88:91], a[0:3], v[212:215]
    ds_read_b128 a[44:47], v42 offset:12288
    v_mfma_f32_16x16x32_bf16 v[216:219], a[196:199], a[24:27], v[216:219]
    ds_read_b32 a86, v15
    v_perm_b32 v56, v68, v35, s39
    v_mfma_f32_16x16x32_bf16 v[216:219], a[88:91], a[28:31], v[216:219]
    ds_read_b128 a[192:195], v43 offset:12288
    v_perm_b32 v57, v101, v35, s37
    v_mfma_f32_16x16x32_bf16 v[220:223], a[196:199], a[104:107], v[220:223]
    s_waitcnt vmcnt(8)
    ds_read_b32 a87, v56
    v_perm_b32 v58, v92, v35, s36
    v_mfma_f32_16x16x32_bf16 v[220:223], a[88:91], a[148:151], v[220:223]
    s_waitcnt lgkmcnt(8)
    ds_read_b32 a17, v57
    v_mfma_f32_16x16x32_bf16 v[224:227], a[212:215], a[228:231], v[224:227]
    ds_read_b32 a240, v58
    v_perm_b32 v59, v92, v35, s37
    v_mfma_f32_16x16x32_bf16 v[224:227], a[188:191], a[200:203], v[224:227]
    v_mfma_f32_16x16x32_bf16 v[228:231], a[212:215], a[160:163], v[228:231]
    ds_read_b32 a241, v59
    v_perm_b32 v60, v92, v35, s38
    v_mfma_f32_16x16x32_bf16 v[228:231], a[188:191], a[164:167], v[228:231]
    v_perm_b32 v62, v101, v35, s38
    v_mfma_f32_16x16x32_bf16 v[232:235], a[212:215], a[180:183], v[232:235]
    s_mov_b32 s3, 0
    ds_read_b32 a242, v60
    v_perm_b32 v61, v92, v35, s39
    v_mfma_f32_16x16x32_bf16 v[232:235], a[188:191], a[112:115], v[232:235]
    ds_read_b32 a18, v62
    v_mfma_f32_16x16x32_bf16 v[236:239], a[212:215], a[168:171], v[236:239]
    ds_read_b32 a243, v61
    v_perm_b32 v63, v69, v35, s36
    v_mfma_f32_16x16x32_bf16 v[236:239], a[188:191], a[172:175], v[236:239]
    s_mov_b32 s4, 14336
    v_mfma_f32_16x16x32_bf16 v[240:243], a[212:215], a[152:155], v[240:243]
    ds_read_b32 a52, v63
    v_perm_b32 v8, v69, v35, s37
    v_mfma_f32_16x16x32_bf16 v[240:243], a[188:191], a[128:131], v[240:243]
    v_perm_b32 v9, v101, v35, s39
    v_mfma_f32_16x16x32_bf16 v[244:247], a[212:215], a[100:103], v[244:247]
    s_mov_b32 s5, 28672
    ds_read_b32 a53, v8
    v_perm_b32 v10, v69, v35, s38
    v_mfma_f32_16x16x32_bf16 v[244:247], a[188:191], a[0:3], v[244:247]
    ds_read_b32 a19, v9
    v_mfma_f32_16x16x32_bf16 v[248:251], a[212:215], a[24:27], v[248:251]
    ds_read_b32 a54, v10
    v_perm_b32 v11, v69, v35, s39
    v_mfma_f32_16x16x32_bf16 v[248:251], a[188:191], a[28:31], v[248:251]
    s_mov_b32 s6, 43008
    v_mfma_f32_16x16x32_bf16 v[252:255], a[212:215], a[104:107], v[252:255]
    ds_read_b32 a55, v11
    v_perm_b32 v12, v93, v35, s36
    v_mfma_f32_16x16x32_bf16 v[252:255], a[188:191], a[148:151], v[252:255]
    s_waitcnt lgkmcnt(5)
    s_barrier
    v_perm_b32 v13, v121, v35, s36
    v_mfma_f32_16x16x32_bf16 v[128:131], a[84:87], a[204:207], v[128:131]
    s_mov_b32 s7, 229376
    ds_read_b32 a124, v12
    v_perm_b32 v14, v93, v35, s37
    v_mfma_f32_16x16x32_bf16 v[128:131], a[240:243], a[232:235], v[128:131]
    ds_read_b128 a[60:63], v40 offset:34816
    ds_read_b32 a132, v13
    v_mfma_f32_16x16x32_bf16 v[132:135], a[84:87], a[4:7], v[132:135]
    ds_read_b32 a125, v14
    v_perm_b32 v15, v93, v35, s38
    v_mfma_f32_16x16x32_bf16 v[132:135], a[240:243], a[208:211], v[132:135]
    s_mov_b32 s24, 243712
    ds_read_b128 a[196:199], v41 offset:34816
    v_mfma_f32_16x16x32_bf16 v[136:139], a[84:87], a[76:79], v[136:139]
    ds_read_b32 a126, v15
    v_perm_b32 v56, v93, v35, s39
    v_mfma_f32_16x16x32_bf16 v[136:139], a[240:243], a[224:227], v[136:139]
    v_perm_b32 v57, v121, v35, s37
    v_mfma_f32_16x16x32_bf16 v[140:143], a[84:87], a[56:59], v[140:143]
    s_mov_b32 s25, 258048
    ds_read_b32 a127, v56
    v_perm_b32 v58, v70, v35, s36
    v_mfma_f32_16x16x32_bf16 v[140:143], a[240:243], a[184:187], v[140:143]
    ds_read_b128 a[88:91], v42 offset:32768
    ds_read_b32 a133, v57
    v_mfma_f32_16x16x32_bf16 v[144:147], a[84:87], a[36:39], v[144:147]
    ds_read_b32 a228, v58
    v_perm_b32 v59, v70, v35, s37
    v_mfma_f32_16x16x32_bf16 v[144:147], a[240:243], a[48:51], v[144:147]
    s_mov_b32 s26, 272384
    ds_read_b128 a[200:203], v43 offset:32768
    v_mfma_f32_16x16x32_bf16 v[148:151], a[84:87], a[144:147], v[148:151]
    ds_read_b32 a229, v59
    v_perm_b32 v60, v70, v35, s38
    v_mfma_f32_16x16x32_bf16 v[148:151], a[240:243], a[216:219], v[148:151]
    v_perm_b32 v62, v121, v35, s38
    v_mfma_f32_16x16x32_bf16 v[152:155], a[84:87], a[252:255], v[152:155]
    s_mov_b32 s27, 458752
    ds_read_b32 a230, v60
    v_perm_b32 v61, v70, v35, s39
    v_mfma_f32_16x16x32_bf16 v[152:155], a[240:243], a[176:179], v[152:155]
    ds_read_b128 a[160:163], v40 offset:32768
    ds_read_b32 a134, v62
    v_mfma_f32_16x16x32_bf16 v[156:159], a[84:87], a[44:47], v[156:159]
    ds_read_b32 a231, v61
    v_perm_b32 v63, v94, v35, s36
    v_mfma_f32_16x16x32_bf16 v[156:159], a[240:243], a[192:195], v[156:159]
    s_waitcnt lgkmcnt(9)
    s_mov_b32 s48, 473088
    ds_read_b128 a[164:167], v41 offset:32768
    v_mfma_f32_16x16x32_bf16 v[160:163], a[52:55], a[204:207], v[160:163]
    ds_read_b32 a180, v63
    v_perm_b32 v8, v94, v35, s37
    v_mfma_f32_16x16x32_bf16 v[160:163], a[124:127], a[232:235], v[160:163]
    v_perm_b32 v9, v121, v35, s39
    v_mfma_f32_16x16x32_bf16 v[164:167], a[52:55], a[4:7], v[164:167]
    s_mov_b32 s49, 487424
    ds_read_b32 a181, v8
    v_perm_b32 v10, v94, v35, s38
    v_mfma_f32_16x16x32_bf16 v[164:167], a[124:127], a[208:211], v[164:167]
    ds_read_b128 a[112:115], v42 offset:34816
    ds_read_b32 a135, v9
    v_mfma_f32_16x16x32_bf16 v[168:171], a[52:55], a[76:79], v[168:171]
    ds_read_b32 a182, v10
    v_perm_b32 v11, v94, v35, s39
    v_mfma_f32_16x16x32_bf16 v[168:171], a[124:127], a[224:227], v[168:171]
    s_mov_b32 s50, 501760
    ds_read_b128 a[168:171], v43 offset:34816
    v_mfma_f32_16x16x32_bf16 v[172:175], a[52:55], a[56:59], v[172:175]
    ds_read_b32 a183, v11
    v_perm_b32 v12, v65, v35, s36
    v_mfma_f32_16x16x32_bf16 v[172:175], a[124:127], a[184:187], v[172:175]
    s_waitcnt vmcnt(0)
    v_mfma_f32_16x16x32_bf16 v[176:179], a[52:55], a[36:39], v[176:179]
    s_barrier
    ds_read_b32 a172, v12
    v_perm_b32 v13, v65, v35, s37
    v_mfma_f32_16x16x32_bf16 v[176:179], a[124:127], a[48:51], v[176:179]
    s_mov_b32 s51, 688128
    ds_read_b128 a[152:155], v44 offset:2048
    ds_read_b32 a173, v13
    v_mfma_f32_16x16x32_bf16 v[180:183], a[52:55], a[144:147], v[180:183]
    v_perm_b32 v14, v65, v35, s38
    v_perm_b32 v15, v65, v35, s39
    v_mfma_f32_16x16x32_bf16 v[180:183], a[124:127], a[216:219], v[180:183]
    s_mov_b32 s52, 702464
    ds_read_b128 a[128:131], v45 offset:2048
    ds_read_b32 a174, v14
    v_mfma_f32_16x16x32_bf16 v[184:187], a[52:55], a[252:255], v[184:187]
    ds_read_b32 a175, v15
    v_perm_b32 v56, v98, v35, s36
    v_mfma_f32_16x16x32_bf16 v[184:187], a[124:127], a[176:179], v[184:187]
    v_lshlrev_b32 v104, 16, v48
    v_mfma_f32_16x16x32_bf16 v[188:191], a[52:55], a[44:47], v[188:191]
    s_mov_b32 s53, 716800
    ds_read_b32 a100, v56
    v_perm_b32 v57, v98, v35, s37
    v_mfma_f32_16x16x32_bf16 v[188:191], a[124:127], a[192:195], v[188:191]
    s_waitcnt lgkmcnt(7)
    ds_read_b128 a[0:3], v46 offset:0
    ds_read_b32 a101, v57
    v_mfma_f32_16x16x32_bf16 v[192:195], a[228:231], a[204:207], v[192:195]
    v_perm_b32 v58, v98, v35, s38
    v_perm_b32 v59, v98, v35, s39
    v_mfma_f32_16x16x32_bf16 v[192:195], a[180:183], a[232:235], v[192:195]
    s_mov_b32 s54, 731136
    ds_read_b128 a[24:27], v47 offset:0
    ds_read_b32 a102, v58
    v_mfma_f32_16x16x32_bf16 v[196:199], a[228:231], a[4:7], v[196:199]
    ds_read_b32 a103, v59
    v_perm_b32 v60, v102, v35, s36
    v_mfma_f32_16x16x32_bf16 v[196:199], a[180:183], a[208:211], v[196:199]
    v_and_b32 v105, 0xffff0000, v49
    v_lshlrev_b32 v106, 16, v51
    v_mfma_f32_16x16x32_bf16 v[200:203], a[228:231], a[76:79], v[200:203]
    ds_read_b32 a28, v60
    v_perm_b32 v62, v102, v35, s37
    v_mfma_f32_16x16x32_bf16 v[200:203], a[180:183], a[224:227], v[200:203]
    ds_read_b128 a[104:107], v44 offset:0
    ds_read_b32 a29, v62
    v_mfma_f32_16x16x32_bf16 v[204:207], a[228:231], a[56:59], v[204:207]
    v_perm_b32 v61, v102, v35, s38
    v_perm_b32 v63, v102, v35, s39
    v_mfma_f32_16x16x32_bf16 v[204:207], a[180:183], a[184:187], v[204:207]
    ds_read_b128 a[212:215], v45 offset:0
    ds_read_b32 a30, v61
    v_mfma_f32_16x16x32_bf16 v[208:211], a[228:231], a[36:39], v[208:211]
    ds_read_b32 a31, v63
    v_perm_b32 v8, v122, v35, s36
    v_mfma_f32_16x16x32_bf16 v[208:211], a[180:183], a[48:51], v[208:211]
    v_and_b32 v107, 0xffff0000, v52
    v_and_b32 v72, 0xffff0000, v48
    v_mfma_f32_16x16x32_bf16 v[212:215], a[228:231], a[144:147], v[212:215]
    ds_read_b32 a148, v8
    v_perm_b32 v9, v122, v35, s37
    v_mfma_f32_16x16x32_bf16 v[212:215], a[180:183], a[216:219], v[212:215]
    ds_read_b128 a[188:191], v46 offset:2048
    ds_read_b32 a149, v9
    v_mfma_f32_16x16x32_bf16 v[216:219], a[228:231], a[252:255], v[216:219]
    v_perm_b32 v10, v122, v35, s38
    v_perm_b32 v11, v122, v35, s39
    v_mfma_f32_16x16x32_bf16 v[216:219], a[180:183], a[176:179], v[216:219]
    ds_read_b128 a[84:87], v47 offset:2048
    ds_read_b32 a150, v10
    v_mfma_f32_16x16x32_bf16 v[220:223], a[228:231], a[44:47], v[220:223]
    ds_read_b32 a151, v11
    v_perm_b32 v12, v66, v35, s36
    v_mfma_f32_16x16x32_bf16 v[220:223], a[180:183], a[192:195], v[220:223]
    v_lshlrev_b32 v73, 16, v50
    v_and_b32 v74, 0xffff0000, v51
    v_mfma_f32_16x16x32_bf16 v[228:231], a[244:247], a[60:63], v[228:231]
    ds_read_b32 a240, v12
    v_perm_b32 v13, v66, v35, s37
    v_mfma_f32_16x16x32_bf16 v[228:231], a[8:11], a[196:199], v[228:231]
    s_waitcnt lgkmcnt(7)
    ds_read_b32 a241, v13
    v_perm_b32 v14, v66, v35, s38
    v_mfma_f32_16x16x32_bf16 v[228:231], a[120:123], a[152:155], v[228:231]
    ds_read_b128 a[52:55], v40 offset:38912
    v_perm_b32 v15, v66, v35, s39
    v_mfma_f32_16x16x32_bf16 v[228:231], a[116:119], a[128:131], v[228:231]
    ds_read_b32 a242, v14
    v_lshlrev_b32 v75, 16, v53
    v_mfma_f32_16x16x32_bf16 v[132:135], a[68:71], a[60:63], v[132:135]
    ds_read_b32 a243, v15
    v_lshlrev_b32 v76, 16, v49
    v_mfma_f32_16x16x32_bf16 v[132:135], a[80:83], a[196:199], v[132:135]
    v_and_b32 v77, 0xffff0000, v50
    v_lshlrev_b32 v78, 16, v52
    v_mfma_f32_16x16x32_bf16 v[132:135], a[140:143], a[88:91], v[132:135]
    ds_read_b128 a[124:127], v41 offset:38912
    v_and_b32 v79, 0xffff0000, v53
    v_mfma_f32_16x16x32_bf16 v[132:135], a[20:23], a[200:203], v[132:135]
    v_lshlrev_b32 v116, 16, v54
    v_and_b32 v117, 0xffff0000, v54
    v_mfma_f32_16x16x32_bf16 v[132:135], a[248:251], a[152:155], v[132:135]
    ds_write_b128 v29, v[228:231] offset:0
    v_lshlrev_b32 v118, 16, v55
    v_mfma_f32_16x16x32_bf16 v[132:135], a[220:223], a[128:131], v[132:135]
    ds_read_b128 a[204:207], v44 offset:6144
    v_mfma_f32_16x16x32_bf16 v[132:135], a[136:139], a[0:3], v[132:135]
    v_and_b32 v119, 0xffff0000, v55
    v_mfma_f32_16x16x32_bf16 v[132:135], a[72:75], a[24:27], v[132:135]
    v_mfma_f32_16x16x32_bf16 v[164:167], a[236:239], a[60:63], v[164:167]
    v_mfma_f32_16x16x32_bf16 v[164:167], a[92:95], a[196:199], v[164:167]
    s_waitcnt lgkmcnt(1)
    s_barrier
    ds_read_b128 a[232:235], v45 offset:6144
    v_mfma_f32_16x16x32_bf16 v[164:167], a[40:43], a[88:91], v[164:167]
    ds_read_b128 v[80:83], v30 offset:0
    v_mfma_f32_16x16x32_bf16 v[164:167], a[64:67], a[200:203], v[164:167]
    v_mul_f32 v132, v132, v104
    v_mul_f32 v133, v133, v105
    v_mfma_f32_16x16x32_bf16 v[164:167], a[96:99], a[152:155], v[164:167]
    ds_read_b128 a[4:7], v42 offset:36864
    v_mul_f32 v134, v134, v106
    v_mfma_f32_16x16x32_bf16 v[164:167], a[16:19], a[128:131], v[164:167]
    v_mul_f32 v135, v135, v107
    v_mfma_f32_16x16x32_bf16 v[164:167], a[132:135], a[0:3], v[164:167]
    v_mfma_f32_16x16x32_bf16 v[164:167], a[172:175], a[24:27], v[164:167]
    v_mfma_f32_16x16x32_bf16 v[196:199], a[156:159], a[60:63], v[196:199]
    ds_read_b128 a[208:211], v43 offset:36864
    v_mfma_f32_16x16x32_bf16 v[196:199], a[12:15], a[196:199], v[196:199]
    v_mfma_f32_16x16x32_bf16 v[196:199], a[32:35], a[88:91], v[196:199]
    v_mfma_f32_16x16x32_bf16 v[196:199], a[108:111], a[200:203], v[196:199]
    ds_read_b128 a[76:79], v46 offset:4096
    v_mul_f32 v164, v164, v72
    v_mfma_f32_16x16x32_bf16 v[196:199], a[100:103], a[152:155], v[196:199]
    v_mul_f32 v165, v165, v73
    v_mul_f32 v166, v166, v74
    v_mfma_f32_16x16x32_bf16 v[196:199], a[28:31], a[128:131], v[196:199]
    v_mul_f32 v167, v167, v75
    v_mfma_f32_16x16x32_bf16 v[196:199], a[148:151], a[0:3], v[196:199]
    v_mfma_f32_16x16x32_bf16 v[196:199], a[240:243], a[24:27], v[196:199]
    ds_read_b128 a[224:227], v47 offset:4096
    v_mfma_f32_16x16x32_bf16 v[224:227], a[244:247], a[160:163], v[224:227]
    v_mfma_f32_16x16x32_bf16 v[224:227], a[8:11], a[164:167], v[224:227]
    v_mfma_f32_16x16x32_bf16 v[224:227], a[120:123], a[104:107], v[224:227]
    ds_read_b128 a[56:59], v40 offset:36864
    v_mfma_f32_16x16x32_bf16 v[224:227], a[116:119], a[212:215], v[224:227]
    v_mul_f32 v196, v196, v76
    v_mul_f32 v197, v197, v77
    v_mfma_f32_16x16x32_bf16 v[128:131], a[68:71], a[160:163], v[128:131]
    v_mul_f32 v198, v198, v78
    v_mul_f32 v199, v199, v79
    v_mfma_f32_16x16x32_bf16 v[128:131], a[80:83], a[164:167], v[128:131]
    v_cvt_pk_bf16_f32 v84, v132, v164
    v_cvt_pk_bf16_f32 v85, v196, v133
    v_mfma_f32_16x16x32_bf16 v[128:131], a[140:143], a[112:115], v[128:131]
    ds_read_b128 a[184:187], v41 offset:36864
    v_cvt_pk_bf16_f32 v86, v165, v197
    v_mfma_f32_16x16x32_bf16 v[128:131], a[20:23], a[168:171], v[128:131]
    ds_write_b64 v27, v[84:85] offset:0
    v_cvt_pk_bf16_f32 v87, v134, v166
    v_mfma_f32_16x16x32_bf16 v[128:131], a[248:251], a[104:107], v[128:131]
    ds_write_b64 v27, v[86:87] offset:8
    v_cvt_pk_bf16_f32 v108, v198, v135
    v_mfma_f32_16x16x32_bf16 v[128:131], a[220:223], a[212:215], v[128:131]
    ds_read_b128 a[36:39], v44 offset:4096
    v_cvt_pk_bf16_f32 v109, v167, v199
    v_mfma_f32_16x16x32_bf16 v[128:131], a[136:139], a[188:191], v[128:131]
    s_waitcnt lgkmcnt(5)
    ds_write_b64 v27, v[108:109] offset:16
    v_add_f32 v224, v224, v80
    v_mfma_f32_16x16x32_bf16 v[128:131], a[72:75], a[84:87], v[128:131]
    v_add_f32 v225, v225, v81
    v_add_f32 v226, v226, v82
    v_mfma_f32_16x16x32_bf16 v[160:163], a[236:239], a[160:163], v[160:163]
    v_add_f32 v227, v227, v83
    v_mul_f32 v224, v224, v116
    v_mfma_f32_16x16x32_bf16 v[160:163], a[92:95], a[164:167], v[160:163]
    ds_read_b128 a[48:51], v45 offset:4096
    v_mul_f32 v225, v225, v117
    v_mfma_f32_16x16x32_bf16 v[160:163], a[40:43], a[112:115], v[160:163]
    v_mul_f32 v226, v226, v118
    v_mul_f32 v227, v227, v119
    v_mfma_f32_16x16x32_bf16 v[160:163], a[64:67], a[168:171], v[160:163]
    v_cvt_pk_bf16_f32 v80, v224, v225
    v_cvt_pk_bf16_f32 v81, v226, v227
    v_mfma_f32_16x16x32_bf16 v[160:163], a[96:99], a[104:107], v[160:163]
    ds_read_b128 a[144:147], v42 offset:38912
    v_mul_f32 v128, v128, v104
    v_mfma_f32_16x16x32_bf16 v[160:163], a[16:19], a[212:215], v[160:163]
    ds_write_b64 v28, v[80:81] offset:0
    v_mul_f32 v129, v129, v105
    v_mfma_f32_16x16x32_bf16 v[160:163], a[132:135], a[188:191], v[160:163]
    v_mul_f32 v130, v130, v106
    v_mul_f32 v131, v131, v107
    v_mfma_f32_16x16x32_bf16 v[160:163], a[172:175], a[84:87], v[160:163]
    v_mfma_f32_16x16x32_bf16 v[192:195], a[156:159], a[160:163], v[192:195]
    ds_read_b128 a[216:219], v43 offset:38912
    v_mfma_f32_16x16x32_bf16 v[192:195], a[12:15], a[164:167], v[192:195]
    v_mfma_f32_16x16x32_bf16 v[192:195], a[32:35], a[112:115], v[192:195]
    v_mfma_f32_16x16x32_bf16 v[192:195], a[108:111], a[168:171], v[192:195]
    ds_read_b128 a[252:255], v46 offset:6144
    v_mul_f32 v160, v160, v72
    v_mfma_f32_16x16x32_bf16 v[192:195], a[100:103], a[104:107], v[192:195]
    v_mul_f32 v161, v161, v73
    v_mul_f32 v162, v162, v74
    v_mfma_f32_16x16x32_bf16 v[192:195], a[28:31], a[212:215], v[192:195]
    v_mul_f32 v163, v163, v75
    v_mfma_f32_16x16x32_bf16 v[192:195], a[148:151], a[188:191], v[192:195]
    v_mfma_f32_16x16x32_bf16 v[192:195], a[240:243], a[84:87], v[192:195]
    ds_read_b128 a[176:179], v47 offset:6144
    v_mfma_f32_16x16x32_bf16 v[236:239], a[244:247], a[52:55], v[236:239]
    v_mfma_f32_16x16x32_bf16 v[236:239], a[8:11], a[124:127], v[236:239]
    v_mfma_f32_16x16x32_bf16 v[236:239], a[120:123], a[204:207], v[236:239]
    ds_read_b128 a[44:47], v40 offset:43008
    v_mfma_f32_16x16x32_bf16 v[236:239], a[116:119], a[232:235], v[236:239]
    v_mul_f32 v192, v192, v76
    v_mul_f32 v193, v193, v77
    v_mfma_f32_16x16x32_bf16 v[140:143], a[68:71], a[52:55], v[140:143]
    v_mul_f32 v194, v194, v78
    v_mul_f32 v195, v195, v79
    v_mfma_f32_16x16x32_bf16 v[140:143], a[80:83], a[124:127], v[140:143]
    v_cvt_pk_bf16_f32 v112, v128, v160
    v_cvt_pk_bf16_f32 v113, v192, v129
    v_mfma_f32_16x16x32_bf16 v[140:143], a[140:143], a[4:7], v[140:143]
    ds_read_b128 a[228:231], v41 offset:43008
    v_cvt_pk_bf16_f32 v114, v161, v193
    v_mfma_f32_16x16x32_bf16 v[140:143], a[20:23], a[208:211], v[140:143]
    ds_write_b64 v26, v[112:113] offset:0
    v_cvt_pk_bf16_f32 v115, v130, v162
    v_mfma_f32_16x16x32_bf16 v[140:143], a[248:251], a[204:207], v[140:143]
    ds_write_b64 v26, v[114:115] offset:8
    v_cvt_pk_bf16_f32 v124, v194, v131
    v_mfma_f32_16x16x32_bf16 v[140:143], a[220:223], a[232:235], v[140:143]
    ds_read_b128 a[192:195], v44 offset:10240
    v_cvt_pk_bf16_f32 v125, v163, v195
    v_mfma_f32_16x16x32_bf16 v[140:143], a[136:139], a[76:79], v[140:143]
    ds_write_b64 v26, v[124:125] offset:16
    v_mfma_f32_16x16x32_bf16 v[140:143], a[72:75], a[224:227], v[140:143]
    ds_write_b128 v29, v[236:239] offset:4096
    v_mfma_f32_16x16x32_bf16 v[172:175], a[236:239], a[52:55], v[172:175]
    v_mfma_f32_16x16x32_bf16 v[172:175], a[92:95], a[124:127], v[172:175]
    ds_read_b128 a[180:183], v45 offset:10240
    v_mfma_f32_16x16x32_bf16 v[172:175], a[40:43], a[4:7], v[172:175]
    v_mfma_f32_16x16x32_bf16 v[172:175], a[64:67], a[208:211], v[172:175]
    v_mul_f32 v140, v140, v104
    v_mul_f32 v141, v141, v105
    v_mfma_f32_16x16x32_bf16 v[172:175], a[96:99], a[204:207], v[172:175]
    s_waitcnt lgkmcnt(1)
    s_barrier
    ds_read_b128 a[60:63], v42 offset:40960
    v_mul_f32 v142, v142, v106
    v_mfma_f32_16x16x32_bf16 v[172:175], a[16:19], a[232:235], v[172:175]
    ds_read_b128 v[88:91], v24 offset:0
    v_mul_f32 v143, v143, v107
    v_mfma_f32_16x16x32_bf16 v[172:175], a[132:135], a[76:79], v[172:175]
    ds_read_b128 v[68:71], v24 offset:928
    v_mfma_f32_16x16x32_bf16 v[172:175], a[172:175], a[224:227], v[172:175]
    ds_read_b128 v[92:95], v24 offset:1856
    v_mfma_f32_16x16x32_bf16 v[204:207], a[156:159], a[52:55], v[204:207]
    ds_read_b128 a[196:199], v43 offset:40960
    v_mfma_f32_16x16x32_bf16 v[204:207], a[12:15], a[124:127], v[204:207]
    ds_read_b128 v[96:99], v24 offset:2784
    v_mfma_f32_16x16x32_bf16 v[204:207], a[32:35], a[4:7], v[204:207]
    ds_read_b128 v[100:103], v30 offset:4096
    v_mfma_f32_16x16x32_bf16 v[204:207], a[108:111], a[208:211], v[204:207]
    ds_read_b128 a[88:91], v46 offset:8192
    v_mul_f32 v172, v172, v72
    v_mfma_f32_16x16x32_bf16 v[204:207], a[100:103], a[204:207], v[204:207]
    v_mul_f32 v173, v173, v73
    v_mul_f32 v174, v174, v74
    v_mfma_f32_16x16x32_bf16 v[204:207], a[28:31], a[232:235], v[204:207]
    s_waitcnt lgkmcnt(6)
    buffer_store_dwordx4 v[88:91], v25, s[16:19], s3 offen sc1
    v_mul_f32 v175, v175, v75
    v_mfma_f32_16x16x32_bf16 v[204:207], a[148:151], a[76:79], v[204:207]
    v_mfma_f32_16x16x32_bf16 v[204:207], a[240:243], a[224:227], v[204:207]
    ds_read_b128 a[200:203], v47 offset:8192
    v_mfma_f32_16x16x32_bf16 v[232:235], a[244:247], a[56:59], v[232:235]
    s_waitcnt lgkmcnt(5)
    buffer_store_dwordx4 v[68:71], v25, s[16:19], s4 offen sc1
    v_mfma_f32_16x16x32_bf16 v[232:235], a[8:11], a[184:187], v[232:235]
    v_mfma_f32_16x16x32_bf16 v[232:235], a[120:123], a[36:39], v[232:235]
    ds_read_b128 a[152:155], v40 offset:40960
    v_mfma_f32_16x16x32_bf16 v[232:235], a[116:119], a[48:51], v[232:235]
    buffer_store_dwordx4 v[92:95], v25, s[16:19], s5 offen sc1
    v_mul_f32 v204, v204, v76
    v_mfma_f32_16x16x32_bf16 v[136:139], a[68:71], a[56:59], v[136:139]
    v_mul_f32 v205, v205, v77
    v_mul_f32 v206, v206, v78
    v_mfma_f32_16x16x32_bf16 v[136:139], a[80:83], a[184:187], v[136:139]
    s_waitcnt lgkmcnt(2)
    buffer_store_dwordx4 v[96:99], v25, s[16:19], s6 offen sc1
    v_mul_f32 v207, v207, v79
    v_mfma_f32_16x16x32_bf16 v[136:139], a[140:143], a[144:147], v[136:139]
    ds_read_b128 a[128:131], v41 offset:40960
    v_cvt_pk_bf16_f32 v120, v140, v172
    v_mfma_f32_16x16x32_bf16 v[136:139], a[20:23], a[216:219], v[136:139]
    v_cvt_pk_bf16_f32 v121, v204, v141
    v_cvt_pk_bf16_f32 v122, v173, v205
    v_mfma_f32_16x16x32_bf16 v[136:139], a[248:251], a[36:39], v[136:139]
    ds_write_b64 v27, v[120:121] offset:14848
    v_cvt_pk_bf16_f32 v123, v142, v174
    v_mfma_f32_16x16x32_bf16 v[136:139], a[220:223], a[48:51], v[136:139]
    ds_read_b128 a[0:3], v44 offset:8192
    v_cvt_pk_bf16_f32 v64, v206, v143
    v_mfma_f32_16x16x32_bf16 v[136:139], a[136:139], a[252:255], v[136:139]
    ds_write_b64 v27, v[122:123] offset:14856
    v_cvt_pk_bf16_f32 v65, v175, v207
    v_mfma_f32_16x16x32_bf16 v[136:139], a[72:75], a[176:179], v[136:139]
    ds_write_b64 v27, v[64:65] offset:14864
    v_add_f32 v232, v232, v100
    v_mfma_f32_16x16x32_bf16 v[168:171], a[236:239], a[56:59], v[168:171]
    v_add_f32 v233, v233, v101
    v_add_f32 v234, v234, v102
    v_mfma_f32_16x16x32_bf16 v[168:171], a[92:95], a[184:187], v[168:171]
    ds_read_b128 a[24:27], v45 offset:8192
    v_add_f32 v235, v235, v103
    v_mfma_f32_16x16x32_bf16 v[168:171], a[40:43], a[144:147], v[168:171]
    v_mul_f32 v232, v232, v116
    v_mul_f32 v233, v233, v117
    v_mfma_f32_16x16x32_bf16 v[168:171], a[64:67], a[216:219], v[168:171]
    v_mul_f32 v234, v234, v118
    v_mul_f32 v235, v235, v119
    v_mfma_f32_16x16x32_bf16 v[168:171], a[96:99], a[36:39], v[168:171]
    ds_read_b128 a[160:163], v42 offset:43008
    v_cvt_pk_bf16_f32 v100, v232, v233
    v_mfma_f32_16x16x32_bf16 v[168:171], a[16:19], a[48:51], v[168:171]
    v_cvt_pk_bf16_f32 v101, v234, v235
    v_mul_f32 v136, v136, v104
    v_mfma_f32_16x16x32_bf16 v[168:171], a[132:135], a[252:255], v[168:171]
    ds_write_b64 v28, v[100:101] offset:14848
    v_mul_f32 v137, v137, v105
    v_mfma_f32_16x16x32_bf16 v[168:171], a[172:175], a[176:179], v[168:171]
    v_mul_f32 v138, v138, v106
    v_mul_f32 v139, v139, v107
    v_mfma_f32_16x16x32_bf16 v[200:203], a[156:159], a[56:59], v[200:203]
    ds_read_b128 a[164:167], v43 offset:43008
    v_mfma_f32_16x16x32_bf16 v[200:203], a[12:15], a[184:187], v[200:203]
    v_mfma_f32_16x16x32_bf16 v[200:203], a[32:35], a[144:147], v[200:203]
    v_mfma_f32_16x16x32_bf16 v[200:203], a[108:111], a[216:219], v[200:203]
    ds_read_b128 a[112:115], v46 offset:10240
    v_mul_f32 v168, v168, v72
    v_mfma_f32_16x16x32_bf16 v[200:203], a[100:103], a[36:39], v[200:203]
    v_mul_f32 v169, v169, v73
    v_mul_f32 v170, v170, v74
    v_mfma_f32_16x16x32_bf16 v[200:203], a[28:31], a[48:51], v[200:203]
    v_mul_f32 v171, v171, v75
    v_mfma_f32_16x16x32_bf16 v[200:203], a[148:151], a[252:255], v[200:203]
    v_mfma_f32_16x16x32_bf16 v[200:203], a[240:243], a[176:179], v[200:203]
    ds_read_b128 a[168:171], v47 offset:10240
    v_mfma_f32_16x16x32_bf16 v[244:247], a[244:247], a[44:47], v[244:247]
    v_mfma_f32_16x16x32_bf16 v[244:247], a[8:11], a[228:231], v[244:247]
    v_mfma_f32_16x16x32_bf16 v[244:247], a[120:123], a[192:195], v[244:247]
    ds_read_b128 a[104:107], v40 offset:47104
    v_mfma_f32_16x16x32_bf16 v[244:247], a[116:119], a[180:183], v[244:247]
    v_mul_f32 v200, v200, v76
    v_mul_f32 v201, v201, v77
    v_mfma_f32_16x16x32_bf16 v[148:151], a[68:71], a[44:47], v[148:151]
    v_mul_f32 v202, v202, v78
    v_mul_f32 v203, v203, v79
    v_mfma_f32_16x16x32_bf16 v[148:151], a[80:83], a[228:231], v[148:151]
    v_cvt_pk_bf16_f32 v84, v136, v168
    v_cvt_pk_bf16_f32 v85, v200, v137
    v_mfma_f32_16x16x32_bf16 v[148:151], a[140:143], a[60:63], v[148:151]
    ds_read_b128 a[212:215], v41 offset:47104
    v_cvt_pk_bf16_f32 v86, v169, v201
    v_mfma_f32_16x16x32_bf16 v[148:151], a[20:23], a[196:199], v[148:151]
    ds_write_b64 v26, v[84:85] offset:14848
    v_cvt_pk_bf16_f32 v87, v138, v170
    v_mfma_f32_16x16x32_bf16 v[148:151], a[248:251], a[192:195], v[148:151]
    ds_write_b64 v26, v[86:87] offset:14856
    v_cvt_pk_bf16_f32 v108, v202, v139
    v_mfma_f32_16x16x32_bf16 v[148:151], a[220:223], a[180:183], v[148:151]
    ds_read_b128 a[188:191], v44 offset:14336
    v_cvt_pk_bf16_f32 v109, v171, v203
    v_mfma_f32_16x16x32_bf16 v[148:151], a[136:139], a[88:91], v[148:151]
    s_waitcnt lgkmcnt(5)
    ds_write_b64 v26, v[108:109] offset:14864
    v_mfma_f32_16x16x32_bf16 v[148:151], a[72:75], a[200:203], v[148:151]
    ds_write_b128 v29, v[244:247] offset:8192
    v_mfma_f32_16x16x32_bf16 v[180:183], a[236:239], a[44:47], v[180:183]
    v_mfma_f32_16x16x32_bf16 v[180:183], a[92:95], a[228:231], v[180:183]
    ds_read_b128 a[84:87], v45 offset:14336
    v_mfma_f32_16x16x32_bf16 v[180:183], a[40:43], a[60:63], v[180:183]
    v_mfma_f32_16x16x32_bf16 v[180:183], a[64:67], a[196:199], v[180:183]
    v_mul_f32 v148, v148, v104
    v_mul_f32 v149, v149, v105
    v_mfma_f32_16x16x32_bf16 v[180:183], a[96:99], a[192:195], v[180:183]
    s_waitcnt lgkmcnt(1)
    s_barrier
    ds_read_b128 a[52:55], v42 offset:45056
    v_mul_f32 v150, v150, v106
    v_mfma_f32_16x16x32_bf16 v[180:183], a[16:19], a[180:183], v[180:183]
    ds_read_b128 v[80:83], v24 offset:14848
    v_mul_f32 v151, v151, v107
    v_mfma_f32_16x16x32_bf16 v[180:183], a[132:135], a[88:91], v[180:183]
    ds_read_b128 v[112:115], v24 offset:15776
    v_mfma_f32_16x16x32_bf16 v[180:183], a[172:175], a[200:203], v[180:183]
    ds_read_b128 v[124:127], v24 offset:16704
    v_mfma_f32_16x16x32_bf16 v[212:215], a[156:159], a[44:47], v[212:215]
    ds_read_b128 a[124:127], v43 offset:45056
    v_mfma_f32_16x16x32_bf16 v[212:215], a[12:15], a[228:231], v[212:215]
    ds_read_b128 v[88:91], v24 offset:17632
    v_mfma_f32_16x16x32_bf16 v[212:215], a[32:35], a[60:63], v[212:215]
    ds_read_b128 v[68:71], v30 offset:8192
    v_mfma_f32_16x16x32_bf16 v[212:215], a[108:111], a[196:199], v[212:215]
    ds_read_b128 a[4:7], v46 offset:12288
    v_mul_f32 v180, v180, v72
    v_mfma_f32_16x16x32_bf16 v[212:215], a[100:103], a[192:195], v[212:215]
    v_mul_f32 v181, v181, v73
    v_mul_f32 v182, v182, v74
    v_mfma_f32_16x16x32_bf16 v[212:215], a[28:31], a[180:183], v[212:215]
    s_waitcnt lgkmcnt(6)
    buffer_store_dwordx4 v[80:83], v25, s[16:19], s7 offen sc1
    v_mul_f32 v183, v183, v75
    v_mfma_f32_16x16x32_bf16 v[212:215], a[148:151], a[88:91], v[212:215]
    v_mfma_f32_16x16x32_bf16 v[212:215], a[240:243], a[200:203], v[212:215]
    ds_read_b128 a[208:211], v47 offset:12288
    v_mfma_f32_16x16x32_bf16 v[240:243], a[244:247], a[152:155], v[240:243]
    s_waitcnt lgkmcnt(5)
    buffer_store_dwordx4 v[112:115], v25, s[16:19], s24 offen sc1
    v_mfma_f32_16x16x32_bf16 v[240:243], a[8:11], a[128:131], v[240:243]
    v_mfma_f32_16x16x32_bf16 v[240:243], a[120:123], a[0:3], v[240:243]
    ds_read_b128 a[204:207], v40 offset:45056
    v_mfma_f32_16x16x32_bf16 v[240:243], a[116:119], a[24:27], v[240:243]
    buffer_store_dwordx4 v[124:127], v25, s[16:19], s25 offen sc1
    v_mul_f32 v212, v212, v76
    v_mfma_f32_16x16x32_bf16 v[144:147], a[68:71], a[152:155], v[144:147]
    v_mul_f32 v213, v213, v77
    v_mul_f32 v214, v214, v78
    v_mfma_f32_16x16x32_bf16 v[144:147], a[80:83], a[128:131], v[144:147]
    s_waitcnt lgkmcnt(2)
    buffer_store_dwordx4 v[88:91], v25, s[16:19], s26 offen sc1
    v_mul_f32 v215, v215, v79
    v_mfma_f32_16x16x32_bf16 v[144:147], a[140:143], a[160:163], v[144:147]
    ds_read_b128 a[232:235], v41 offset:45056
    v_cvt_pk_bf16_f32 v92, v148, v180
    v_mfma_f32_16x16x32_bf16 v[144:147], a[20:23], a[164:167], v[144:147]
    v_cvt_pk_bf16_f32 v93, v212, v149
    v_cvt_pk_bf16_f32 v94, v181, v213
    v_mfma_f32_16x16x32_bf16 v[144:147], a[248:251], a[0:3], v[144:147]
    ds_write_b64 v27, v[92:93] offset:29696
    v_cvt_pk_bf16_f32 v95, v150, v182
    v_mfma_f32_16x16x32_bf16 v[144:147], a[220:223], a[24:27], v[144:147]
    ds_read_b128 a[76:79], v44 offset:12288
    v_cvt_pk_bf16_f32 v96, v214, v151
    v_mfma_f32_16x16x32_bf16 v[144:147], a[136:139], a[112:115], v[144:147]
    ds_write_b64 v27, v[94:95] offset:29704
    v_cvt_pk_bf16_f32 v97, v183, v215
    v_mfma_f32_16x16x32_bf16 v[144:147], a[72:75], a[168:171], v[144:147]
    ds_write_b64 v27, v[96:97] offset:29712
    v_add_f32 v240, v240, v68
    v_mfma_f32_16x16x32_bf16 v[176:179], a[236:239], a[152:155], v[176:179]
    v_add_f32 v241, v241, v69
    v_add_f32 v242, v242, v70
    v_mfma_f32_16x16x32_bf16 v[176:179], a[92:95], a[128:131], v[176:179]
    ds_read_b128 a[224:227], v45 offset:12288
    v_add_f32 v243, v243, v71
    v_mfma_f32_16x16x32_bf16 v[176:179], a[40:43], a[160:163], v[176:179]
    v_mul_f32 v240, v240, v116
    v_mul_f32 v241, v241, v117
    v_mfma_f32_16x16x32_bf16 v[176:179], a[64:67], a[164:167], v[176:179]
    v_mul_f32 v242, v242, v118
    v_mul_f32 v243, v243, v119
    v_mfma_f32_16x16x32_bf16 v[176:179], a[96:99], a[0:3], v[176:179]
    ds_read_b128 a[56:59], v42 offset:47104
    v_cvt_pk_bf16_f32 v68, v240, v241
    v_mfma_f32_16x16x32_bf16 v[176:179], a[16:19], a[24:27], v[176:179]
    v_cvt_pk_bf16_f32 v69, v242, v243
    v_mul_f32 v144, v144, v104
    v_mfma_f32_16x16x32_bf16 v[176:179], a[132:135], a[112:115], v[176:179]
    ds_write_b64 v28, v[68:69] offset:29696
    v_mul_f32 v145, v145, v105
    v_mfma_f32_16x16x32_bf16 v[176:179], a[172:175], a[168:171], v[176:179]
    v_mul_f32 v146, v146, v106
    v_mul_f32 v147, v147, v107
    v_mfma_f32_16x16x32_bf16 v[208:211], a[156:159], a[152:155], v[208:211]
    ds_read_b128 a[184:187], v43 offset:47104
    v_mfma_f32_16x16x32_bf16 v[208:211], a[12:15], a[128:131], v[208:211]
    v_mfma_f32_16x16x32_bf16 v[208:211], a[32:35], a[160:163], v[208:211]
    v_mfma_f32_16x16x32_bf16 v[208:211], a[108:111], a[164:167], v[208:211]
    ds_read_b128 a[144:147], v46 offset:14336
    v_mul_f32 v176, v176, v72
    v_mfma_f32_16x16x32_bf16 v[208:211], a[100:103], a[0:3], v[208:211]
    v_mul_f32 v177, v177, v73
    v_mul_f32 v178, v178, v74
    v_mfma_f32_16x16x32_bf16 v[208:211], a[28:31], a[24:27], v[208:211]
    v_mul_f32 v179, v179, v75
    v_mfma_f32_16x16x32_bf16 v[208:211], a[148:151], a[112:115], v[208:211]
    v_mfma_f32_16x16x32_bf16 v[208:211], a[240:243], a[168:171], v[208:211]
    ds_read_b128 a[216:219], v47 offset:14336
    v_mfma_f32_16x16x32_bf16 v[252:255], a[244:247], a[104:107], v[252:255]
    v_mfma_f32_16x16x32_bf16 v[252:255], a[8:11], a[212:215], v[252:255]
    v_mfma_f32_16x16x32_bf16 v[252:255], a[120:123], a[188:191], v[252:255]
    v_mfma_f32_16x16x32_bf16 v[252:255], a[116:119], a[84:87], v[252:255]
    v_mul_f32 v208, v208, v76
    v_mul_f32 v209, v209, v77
    v_mfma_f32_16x16x32_bf16 v[156:159], a[68:71], a[104:107], v[156:159]
    v_mul_f32 v210, v210, v78
    v_mul_f32 v211, v211, v79
    v_mfma_f32_16x16x32_bf16 v[156:159], a[80:83], a[212:215], v[156:159]
    v_cvt_pk_bf16_f32 v120, v144, v176
    v_cvt_pk_bf16_f32 v121, v208, v145
    v_mfma_f32_16x16x32_bf16 v[156:159], a[140:143], a[52:55], v[156:159]
    ds_write_b64 v26, v[120:121] offset:29696
    v_cvt_pk_bf16_f32 v122, v177, v209
    v_mfma_f32_16x16x32_bf16 v[156:159], a[20:23], a[124:127], v[156:159]
    v_cvt_pk_bf16_f32 v123, v146, v178
    v_cvt_pk_bf16_f32 v64, v210, v147
    v_mfma_f32_16x16x32_bf16 v[156:159], a[248:251], a[188:191], v[156:159]
    ds_write_b64 v26, v[122:123] offset:29704
    v_cvt_pk_bf16_f32 v65, v179, v211
    v_mfma_f32_16x16x32_bf16 v[156:159], a[220:223], a[84:87], v[156:159]
    ds_write_b64 v26, v[64:65] offset:29712
    v_mfma_f32_16x16x32_bf16 v[156:159], a[136:139], a[4:7], v[156:159]
    s_waitcnt lgkmcnt(3)
    ds_write_b128 v29, v[252:255] offset:12288
    v_mfma_f32_16x16x32_bf16 v[156:159], a[72:75], a[208:211], v[156:159]
    v_mfma_f32_16x16x32_bf16 v[188:191], a[236:239], a[104:107], v[188:191]
    v_mfma_f32_16x16x32_bf16 v[188:191], a[92:95], a[212:215], v[188:191]
    v_mfma_f32_16x16x32_bf16 v[188:191], a[40:43], a[52:55], v[188:191]
    v_mfma_f32_16x16x32_bf16 v[188:191], a[64:67], a[124:127], v[188:191]
    s_waitcnt lgkmcnt(0)
    s_barrier
    v_mul_f32 v156, v156, v104
    v_mul_f32 v157, v157, v105
    v_mfma_f32_16x16x32_bf16 v[188:191], a[96:99], a[188:191], v[188:191]
    ds_read_b128 v[100:103], v24 offset:29696
    v_mul_f32 v158, v158, v106
    v_mfma_f32_16x16x32_bf16 v[188:191], a[16:19], a[84:87], v[188:191]
    ds_read_b128 v[84:87], v24 offset:30624
    v_mul_f32 v159, v159, v107
    v_mfma_f32_16x16x32_bf16 v[188:191], a[132:135], a[4:7], v[188:191]
    ds_read_b128 v[108:111], v24 offset:31552
    v_mfma_f32_16x16x32_bf16 v[188:191], a[172:175], a[208:211], v[188:191]
    ds_read_b128 v[80:83], v24 offset:32480
    v_mfma_f32_16x16x32_bf16 v[220:223], a[156:159], a[104:107], v[220:223]
    ds_read_b128 v[112:115], v30 offset:12288
    v_mfma_f32_16x16x32_bf16 v[220:223], a[12:15], a[212:215], v[220:223]
    v_mfma_f32_16x16x32_bf16 v[220:223], a[32:35], a[52:55], v[220:223]
    v_mfma_f32_16x16x32_bf16 v[220:223], a[108:111], a[124:127], v[220:223]
    v_mul_f32 v188, v188, v72
    v_mul_f32 v189, v189, v73
    v_mfma_f32_16x16x32_bf16 v[220:223], a[100:103], a[188:191], v[220:223]
    s_waitcnt lgkmcnt(4)
    buffer_store_dwordx4 v[100:103], v25, s[16:19], s27 offen sc1
    v_mul_f32 v190, v190, v74
    v_mfma_f32_16x16x32_bf16 v[220:223], a[28:31], a[84:87], v[220:223]
    v_mul_f32 v191, v191, v75
    v_mfma_f32_16x16x32_bf16 v[220:223], a[148:151], a[4:7], v[220:223]
    s_waitcnt lgkmcnt(3)
    buffer_store_dwordx4 v[84:87], v25, s[16:19], s48 offen sc1
    v_mfma_f32_16x16x32_bf16 v[220:223], a[240:243], a[208:211], v[220:223]
    v_mfma_f32_16x16x32_bf16 v[248:251], a[244:247], a[204:207], v[248:251]
    s_waitcnt lgkmcnt(1)
    buffer_store_dwordx4 v[108:111], v25, s[16:19], s49 offen sc1
    v_mfma_f32_16x16x32_bf16 v[248:251], a[8:11], a[232:235], v[248:251]
    v_mfma_f32_16x16x32_bf16 v[248:251], a[120:123], a[76:79], v[248:251]
    buffer_store_dwordx4 v[80:83], v25, s[16:19], s50 offen sc1
    v_mfma_f32_16x16x32_bf16 v[248:251], a[116:119], a[224:227], v[248:251]
    v_mul_f32 v220, v220, v76
    v_mul_f32 v221, v221, v77
    v_mfma_f32_16x16x32_bf16 v[152:155], a[68:71], a[204:207], v[152:155]
    v_mul_f32 v222, v222, v78
    v_mul_f32 v223, v223, v79
    v_mfma_f32_16x16x32_bf16 v[152:155], a[80:83], a[232:235], v[152:155]
    v_cvt_pk_bf16_f32 v124, v156, v188
    v_cvt_pk_bf16_f32 v125, v220, v157
    v_mfma_f32_16x16x32_bf16 v[152:155], a[140:143], a[56:59], v[152:155]
    ds_write_b64 v27, v[124:125] offset:44544
    v_cvt_pk_bf16_f32 v126, v189, v221
    v_mfma_f32_16x16x32_bf16 v[152:155], a[20:23], a[184:187], v[152:155]
    v_cvt_pk_bf16_f32 v127, v158, v190
    v_cvt_pk_bf16_f32 v88, v222, v159
    v_mfma_f32_16x16x32_bf16 v[152:155], a[248:251], a[76:79], v[152:155]
    ds_write_b64 v27, v[126:127] offset:44552
    v_cvt_pk_bf16_f32 v89, v191, v223
    v_mfma_f32_16x16x32_bf16 v[152:155], a[220:223], a[224:227], v[152:155]
    s_waitcnt lgkmcnt(2)
    ds_write_b64 v27, v[88:89] offset:44560
    v_add_f32 v248, v248, v112
    v_mfma_f32_16x16x32_bf16 v[152:155], a[136:139], a[144:147], v[152:155]
    v_add_f32 v249, v249, v113
    v_add_f32 v250, v250, v114
    v_mfma_f32_16x16x32_bf16 v[152:155], a[72:75], a[216:219], v[152:155]
    v_add_f32 v251, v251, v115
    v_mul_f32 v248, v248, v116
    v_mfma_f32_16x16x32_bf16 v[184:187], a[236:239], a[204:207], v[184:187]
    v_mul_f32 v249, v249, v117
    v_mul_f32 v250, v250, v118
    v_mfma_f32_16x16x32_bf16 v[184:187], a[92:95], a[232:235], v[184:187]
    v_mul_f32 v251, v251, v119
    v_cvt_pk_bf16_f32 v112, v248, v249
    v_mfma_f32_16x16x32_bf16 v[184:187], a[40:43], a[56:59], v[184:187]
    v_cvt_pk_bf16_f32 v113, v250, v251
    v_mfma_f32_16x16x32_bf16 v[184:187], a[64:67], a[184:187], v[184:187]
    ds_write_b64 v28, v[112:113] offset:44544
    v_mul_f32 v152, v152, v104
    v_mfma_f32_16x16x32_bf16 v[184:187], a[96:99], a[76:79], v[184:187]
    v_mul_f32 v153, v153, v105
    v_mul_f32 v154, v154, v106
    v_mfma_f32_16x16x32_bf16 v[184:187], a[16:19], a[224:227], v[184:187]
    v_mul_f32 v155, v155, v107
    v_mfma_f32_16x16x32_bf16 v[184:187], a[132:135], a[144:147], v[184:187]
    v_mfma_f32_16x16x32_bf16 v[184:187], a[172:175], a[216:219], v[184:187]
    v_mfma_f32_16x16x32_bf16 v[216:219], a[156:159], a[204:207], v[216:219]
    v_mfma_f32_16x16x32_bf16 v[216:219], a[12:15], a[232:235], v[216:219]
    v_mfma_f32_16x16x32_bf16 v[216:219], a[32:35], a[56:59], v[216:219]
    v_mfma_f32_16x16x32_bf16 v[216:219], a[108:111], a[184:187], v[216:219]
    v_mul_f32 v184, v184, v72
    v_mul_f32 v185, v185, v73
    v_mfma_f32_16x16x32_bf16 v[216:219], a[100:103], a[76:79], v[216:219]
    v_mul_f32 v186, v186, v74
    v_mul_f32 v187, v187, v75
    v_mfma_f32_16x16x32_bf16 v[216:219], a[28:31], a[224:227], v[216:219]
    v_mfma_f32_16x16x32_bf16 v[216:219], a[148:151], a[144:147], v[216:219]
    v_mfma_f32_16x16x32_bf16 v[216:219], a[240:243], a[216:219], v[216:219]
    s_nop 7
    v_mul_f32 v216, v216, v76
    v_mul_f32 v217, v217, v77
    v_mul_f32 v218, v218, v78
    v_mul_f32 v219, v219, v79
    v_cvt_pk_bf16_f32 v92, v152, v184
    v_cvt_pk_bf16_f32 v93, v216, v153
    v_cvt_pk_bf16_f32 v94, v185, v217
    v_cvt_pk_bf16_f32 v95, v154, v186
    v_cvt_pk_bf16_f32 v96, v218, v155
    v_cvt_pk_bf16_f32 v97, v187, v219
    ds_write_b64 v26, v[92:93] offset:44544
    ds_write_b64 v26, v[94:95] offset:44552
    ds_write_b64 v26, v[96:97] offset:44560
    s_waitcnt lgkmcnt(0)
    s_barrier
    ds_read_b128 v[68:71], v24 offset:44544
    ds_read_b128 v[120:123], v24 offset:45472
    ds_read_b128 v[64:67], v24 offset:46400
    ds_read_b128 v[100:103], v24 offset:47328
    s_waitcnt lgkmcnt(3)
    buffer_store_dwordx4 v[68:71], v25, s[16:19], s51 offen sc1
    s_waitcnt lgkmcnt(2)
    buffer_store_dwordx4 v[120:123], v25, s[16:19], s52 offen sc1
    s_waitcnt lgkmcnt(1)
    buffer_store_dwordx4 v[64:67], v25, s[16:19], s53 offen sc1
    s_waitcnt lgkmcnt(0)
    buffer_store_dwordx4 v[100:103], v25, s[16:19], s54 offen sc1
L_end:
    s_endpgm
L_slow1:
    s_mov_b32 s79, 0
L_poll1:
    buffer_load_dwordx2 v[6:7], v5, s[12:15], s78 offen sc1
    s_add_u32 s79, s79, 1
    s_cmp_gt_u32 s79, 20000
    s_cbranch_scc1 L_back1
    s_waitcnt vmcnt(0)
    v_cmp_ne_u64 vcc, s[76:77], v[6:7]
    s_cbranch_vccnz L_poll1
    s_branch L_back1
L_code_end:

.section .rodata,"a"
.p2align 6
.amdhsa_kernel standalone__normalfloat_lut_af4__prompt_kernel
  .amdhsa_next_free_vgpr 512
  .amdhsa_next_free_sgpr 102
  .amdhsa_accum_offset 256
  .amdhsa_group_segment_fixed_size 0
  .amdhsa_kernarg_size 56
  .amdhsa_user_sgpr_count 2
  .amdhsa_user_sgpr_kernarg_segment_ptr 1
  .amdhsa_system_sgpr_workgroup_id_x 1
.end_amdhsa_kernel
```

```asm
; @launch grid=(256,1,1) block=(256,1,1) lds=163840
.amdgcn_target "amdgcn-amd-amdhsa--gfx950"
.text
.globl standalone__normalfloat_lut_af4__prompt_kernel
.p2align 8
.type standalone__normalfloat_lut_af4__prompt_kernel,@function
standalone__normalfloat_lut_af4__prompt_kernel:
    s_cmp_ge_u32 s2, 256
    s_cbranch_scc1 L_end
    s_load_dwordx2 s[4:5], s[0:1], 8
    s_load_dwordx2 s[12:13], s[0:1], 48
    s_load_dwordx2 s[8:9], s[0:1], 0
    s_load_dwordx4 s[20:23], s[0:1], 16
    s_load_dwordx2 s[16:17], s[0:1], 32
    s_getpc_b64 s[72:73]
    s_mov_b32 s74, L_code_end-standalone__normalfloat_lut_af4__prompt_kernel-256
    s_mov_b32 s75, 0x20000
    v_lshlrev_b32 v10, 7, v0
    buffer_load_dword v1, v10, s[72:75], 0 offen offset:256
    v_lshrrev_b32 v5, 6, v0
    v_and_b32 v2, 63, v0
    s_and_b32 s60, s2, 7
    s_lshr_b32 s61, s2, 3
    v_readfirstlane_b32 s63, v5
    s_and_b32 s58, s60, 3
    s_lshl_b32 s58, s58, 2
    s_and_b32 s62, s61, 3
    s_add_u32 s58, s58, s62
    s_lshr_b32 s59, s60, 2
    s_lshl_b32 s59, s59, 3
    s_lshr_b32 s62, s61, 2
    s_add_u32 s59, s59, s62
    v_add_u32 v8, 8, v2
    v_lshrrev_b32 v8, 6, v8
    v_lshlrev_b32 v8, 30, v8
    v_lshl_add_u32 v18, v2, 4, v8
    s_lshl_b32 s60, s58, 2
    s_add_u32 s60, s60, s63
    s_mul_i32 s61, s60, 114688
    s_mul_i32 s62, s59, 896
    s_add_u32 s61, s61, s62
    s_mov_b32 s6, 14680064
    s_mov_b32 s7, 0x20000
    s_mov_b32 s14, 8388608
    s_mov_b32 s15, 0x20000
    s_mul_i32 s78, s59, 1152
    s_add_u32 s78, s78, 4194304
    s_waitcnt lgkmcnt(0)
    s_load_dwordx2 s[76:77], s[12:13], s78
    v_lshrrev_b32 v3, 4, v2
    v_and_b32 v4, 15, v2
    v_lshlrev_b32 v5, 1, v4
    v_lshrrev_b32 v6, 4, v0
    v_lshlrev_b32 v6, 1, v6
    s_mov_b32 s28, s20
    s_mov_b32 s29, s21
    s_mov_b32 s30, 32
    s_mov_b32 s31, 0x20000
    buffer_load_ushort v16, v5, s[28:31], 0 offen
    buffer_load_ushort v17, v6, s[28:31], 0 offen
    buffer_load_dwordx4 v[128:131], v18, s[4:7], s61 offen
    s_add_u32 s61, s61, 14336
    buffer_load_dwordx4 v[132:135], v18, s[4:7], s61 offen
    s_add_u32 s61, s61, 14336
    buffer_load_dwordx4 v[136:139], v18, s[4:7], s61 offen
    s_add_u32 s61, s61, 14336
    buffer_load_dwordx4 v[140:143], v18, s[4:7], s61 offen
    s_add_u32 s61, s61, 14336
    buffer_load_dwordx4 v[144:147], v18, s[4:7], s61 offen
    s_add_u32 s61, s61, 14336
    buffer_load_dwordx4 v[148:151], v18, s[4:7], s61 offen
    s_add_u32 s61, s61, 14336
    buffer_load_dwordx4 v[152:155], v18, s[4:7], s61 offen
    s_add_u32 s61, s61, 14336
    buffer_load_dwordx4 v[156:159], v18, s[4:7], s61 offen
    s_add_u32 s61, s61, 7239680
    v_lshrrev_b32 v8, 3, v0
    v_and_b32 v9, 7, v2
    v_xor_b32 v9, v9, v3
    s_mul_i32 s70, s63, 24
    v_add_lshl_u32 v8, v8, s70, 11
    v_lshl_add_u32 v36, v9, 4, v8
    v_xor_b32 v37, 64, v36
    v_add_u32 v38, 30720, v36
    v_add_u32 v37, 15360, v37
    v_add_u32 v39, 30720, v37
    s_mov_b32 s10, 4194304
    s_mov_b32 s11, 0x20000
    s_lshl_b32 s55, s58, 18
    s_lshl_b32 s57, s63, 12
    s_add_u32 s57, s57, 65536
    s_and_b32 s64, s63, 1
    s_lshr_b32 s65, s63, 1
    s_lshl_b32 s68, s59, 17
    s_lshl_b32 s62, s60, 10
    s_add_u32 s62, s62, s68
    s_mul_i32 s66, s65, 112
    s_mul_i32 s67, s64, 48
    s_add_u32 s67, s66, s67
    s_lshl_b32 s69, s64, 13
    v_lshlrev_b32 v7, 10, v3
    s_lshl_b32 s70, s67, 2
    s_add_u32 s70, s70, s68
    v_mad_u32_u24 v33, v4, 12, v7
    s_add_u32 s71, s70, s69
    v_add_u32 v32, s71, v33
    s_sub_u32 s71, 8192, s69
    s_add_u32 s71, s71, s70
    v_add_u32 v33, s71, v33
    s_add_u32 s71, s66, 96
    s_lshl_b32 s70, s71, 2
    s_add_u32 s70, s70, s68
    s_add_u32 s70, s70, s69
    v_lshl_add_u32 v34, v4, 2, v7
    v_add_u32 v34, s70, v34
    s_mul_i32 s70, s59, 224
    s_add_u32 s67, s67, s70
    s_add_u32 s71, s71, s70
    s_lshl_b32 s70, s67, 1
    v_mad_u32_u24 v22, v3, 24, s70
    s_lshl_b32 s70, s71, 1
    v_lshl_add_u32 v23, v3, 3, s70
    s_add_u32 s78, s78, 128
    s_mul_i32 s70, s60, 8
    s_add_u32 s70, s70, s78
    v_min_u32 v19, 1, v2
    v_lshlrev_b32 v19, 30, v19
    v_add_u32 v19, s70, v19
    v_mul_u32_u24 v5, 8, v2
    s_waitcnt lgkmcnt(0)
    s_add_u32 s76, s76, 2135587861
    s_addc_u32 s77, s77, 2654435769
    v_mov_b32 v20, s76
    v_mov_b32 v21, s77
    s_mov_b32 s32, s22
    s_mov_b32 s33, s23
    s_mov_b32 s34, 7168
    s_mov_b32 s35, 0x20000
    s_mov_b32 s18, 14680064
    s_mov_b32 s19, 0x20000
    s_mov_b32 s36, 202114048
    s_mov_b32 s37, 202114304
    s_mov_b32 s38, 202114560
    s_mov_b32 s39, 202114816
    v_and_b32 v8, 7, v0
    v_lshlrev_b32 v8, 4, v8
    v_lshl_add_u32 v8, v0, 8, v8
    s_waitcnt vmcnt(8)
    v_lshl_or_b32 v56, v17, 16, v16
    v_lshl_or_b32 v57, v17, 16, v16
    v_lshl_or_b32 v58, v17, 16, v16
    v_lshl_or_b32 v59, v17, 16, v16
    v_xor_b32 v9, 16, v8
    v_xor_b32 v10, 32, v8
    v_xor_b32 v11, 48, v8
    v_xor_b32 v12, 64, v8
    v_xor_b32 v13, 80, v8
    v_xor_b32 v14, 96, v8
    v_xor_b32 v15, 112, v8
    ds_write_b128 v8, v[56:59]
    ds_write_b128 v9, v[56:59]
    ds_write_b128 v10, v[56:59]
    ds_write_b128 v11, v[56:59]
    ds_write_b128 v12, v[56:59]
    ds_write_b128 v13, v[56:59]
    ds_write_b128 v14, v[56:59]
    ds_write_b128 v15, v[56:59]
    v_and_b32 v35, 31, v2
    v_lshlrev_b32 v35, 2, v35
    v_lshrrev_b32 v16, 1, v4
    v_xor_b32 v16, v16, v3
    v_lshlrev_b32 v16, 4, v16
    v_lshl_add_u32 v16, v4, 7, v16
    s_lshl_b32 s70, s64, 14
    s_add_u32 s72, s70, 65536
    s_sub_u32 s73, 81920, s70
    v_add_u32 v40, s72, v16
    v_add_u32 v42, s73, v16
    v_xor_b32 v41, 64, v40
    v_xor_b32 v43, 64, v42
    v_add_u32 v44, 65536, v40
    v_add_u32 v45, 65536, v41
    v_add_u32 v46, 65536, v42
    v_add_u32 v47, 65536, v43
    v_mul_u32_u24 v16, 464, v4
    s_mul_i32 s70, s64, 7424
    s_mul_i32 s72, s65, 224
    s_mul_i32 s73, s64, 96
    s_add_u32 s73, s73, s72
    v_mad_u32_u24 v17, v3, 24, v16
    s_add_u32 s74, s73, s70
    v_add_u32 v26, s74, v17
    s_sub_u32 s74, 7424, s70
    s_add_u32 s74, s74, s73
    v_add_u32 v27, s74, v17
    s_add_u32 s74, s72, s70
    s_add_u32 s74, s74, 192
    v_lshl_add_u32 v28, v3, 3, v16
    v_add_u32 v28, s74, v28
    v_lshlrev_b32 v29, 4, v0
    v_add_u32 v29, 65536, v29
    v_xor_b32 v30, 1024, v29
    v_mul_u32_u24 v16, 2341, v2
    v_lshrrev_b32 v16, 16, v16
    s_mul_i32 s73, s63, 3712
    v_add_lshl_u32 v24, v2, v16, 4
    v_add_u32 v24, s73, v24
    s_lshl_b32 s74, s58, 7
    s_lshl_b32 s75, s63, 3
    s_add_u32 s74, s74, s75
    s_mul_i32 s74, s74, 7168
    s_mul_i32 s75, s59, 448
    s_add_u32 s74, s74, s75
    v_mul_u32_u24 v17, 6720, v16
    v_lshl_add_u32 v25, v2, 4, v17
    v_lshrrev_b32 v16, 1, v16
    v_lshlrev_b32 v16, 30, v16
    v_add3_u32 v25, v25, v16, s74
    s_waitcnt vmcnt(6)
    v_lshl_or_b32 v128, v132, 4, v128
    v_lshl_or_b32 v129, v133, 4, v129
    v_lshl_or_b32 v130, v134, 4, v130
    v_lshl_or_b32 v131, v135, 4, v131
    s_waitcnt vmcnt(4)
    v_lshl_or_b32 v136, v140, 4, v136
    v_lshl_or_b32 v137, v141, 4, v137
    v_lshl_or_b32 v138, v142, 4, v138
    v_lshl_or_b32 v139, v143, 4, v139
    v_lshl_or_b32 v128, v136, 8, v128
    v_lshl_or_b32 v129, v137, 8, v129
    v_lshl_or_b32 v130, v138, 8, v130
    v_lshl_or_b32 v131, v139, 8, v131
    s_waitcnt vmcnt(2)
    v_lshl_or_b32 v144, v148, 4, v144
    v_lshl_or_b32 v145, v149, 4, v145
    v_lshl_or_b32 v146, v150, 4, v146
    v_lshl_or_b32 v147, v151, 4, v147
    s_waitcnt vmcnt(0)
    v_lshl_or_b32 v152, v156, 4, v152
    v_lshl_or_b32 v153, v157, 4, v153
    v_lshl_or_b32 v154, v158, 4, v154
    v_lshl_or_b32 v155, v159, 4, v155
    v_lshl_or_b32 v144, v152, 8, v144
    v_lshl_or_b32 v145, v153, 8, v145
    v_lshl_or_b32 v146, v154, 8, v146
    v_lshl_or_b32 v147, v155, 8, v147
    v_lshl_or_b32 v128, v144, 16, v128
    v_lshl_or_b32 v129, v145, 16, v129
    v_lshl_or_b32 v130, v146, 16, v130
    v_lshl_or_b32 v131, v147, 16, v131
    buffer_store_dwordx4 v[128:131], v18, s[12:15], s62 offen sc1
    s_add_u32 s62, s62, 65536
    s_add_u32 m0, s57, 32768
    s_add_u32 s56, s55, 0
    buffer_load_dwordx4 v36, s[8:11], s56 offen offset:0 lds
    buffer_load_dwordx4 v37, s[8:11], s56 offen offset:1024 lds
    buffer_load_dwordx4 v38, s[8:11], s56 offen offset:2048 lds
    buffer_load_dwordx4 v39, s[8:11], s56 offen offset:3072 lds
    s_add_u32 m0, s57, 51200
    s_add_u32 s56, s55, 128
    buffer_load_dwordx4 v36, s[8:11], s56 offen offset:0 lds
    buffer_load_dwordx4 v37, s[8:11], s56 offen offset:1024 lds
    s_add_u32 m0, s57, 47104
    s_nop 0
    buffer_load_dwordx4 v38, s[8:11], s56 offen offset:2048 lds
    buffer_load_dwordx4 v39, s[8:11], s56 offen offset:3072 lds
    s_waitcnt vmcnt(8)
    buffer_store_dwordx2 v[20:21], v19, s[12:15], 0 offen sc1
    buffer_load_dwordx4 v[160:163], v18, s[4:7], s61 offen
    s_add_u32 s61, s61, 14336
    buffer_load_dwordx4 v[164:167], v18, s[4:7], s61 offen
    s_add_u32 s61, s61, 14336
    buffer_load_dwordx4 v[168:171], v18, s[4:7], s61 offen
    s_add_u32 s61, s61, 14336
    buffer_load_dwordx4 v[172:175], v18, s[4:7], s61 offen
    s_add_u32 s61, s61, 14336
    buffer_load_dwordx4 v[176:179], v18, s[4:7], s61 offen
    s_add_u32 s61, s61, 14336
    buffer_load_dwordx4 v[180:183], v18, s[4:7], s61 offen
    s_add_u32 s61, s61, 14336
    buffer_load_dwordx4 v[184:187], v18, s[4:7], s61 offen
    s_add_u32 s61, s61, 14336
    buffer_load_dwordx4 v[188:191], v18, s[4:7], s61 offen
    s_add_u32 s61, s61, 7239680
    v_add_u32 v19, 512, v19
    s_waitcnt vmcnt(9) lgkmcnt(0)
    s_barrier
    ds_read_b128 a[0:3], v40 offset:32768
    ds_read_b128 a[4:7], v41 offset:32768
    ds_read_b128 a[8:11], v40 offset:34816
    ds_read_b128 a[12:15], v41 offset:34816
    ds_read_b128 a[16:19], v40 offset:36864
    ds_read_b128 a[20:23], v41 offset:36864
    ds_read_b128 a[24:27], v40 offset:38912
    ds_read_b128 a[28:31], v41 offset:38912
    ds_read_b128 a[36:39], v40 offset:40960
    ds_read_b128 a[40:43], v41 offset:40960
    ds_read_b128 a[44:47], v40 offset:43008
    ds_read_b128 a[52:55], v41 offset:43008
    ds_read_b128 a[56:59], v40 offset:45056
    ds_read_b128 a[60:63], v41 offset:45056
    ds_read_b128 a[68:71], v40 offset:47104
    ds_read_b128 a[72:75], v41 offset:47104
    s_mov_b32 s79, 0
L_poll0:
    buffer_load_dwordx2 v[6:7], v5, s[12:15], s78 offen sc1
    s_add_u32 s79, s79, 1
    s_cmp_gt_u32 s79, 20000
    s_cbranch_scc1 L_go0
    s_waitcnt vmcnt(0)
    v_cmp_ne_u64 vcc, s[76:77], v[6:7]
    s_cbranch_vccnz L_poll0
L_go0:
    s_mov_b32 s40, 0
    buffer_load_dwordx3 v[64:66], v32, s[12:15], s40 offen sc1
    buffer_load_dword v67, v34, s[12:15], s40 offen sc1
    s_mov_b32 s41, 4096
    buffer_load_dwordx3 v[68:70], v32, s[12:15], s41 offen sc1
    buffer_load_dword v71, v34, s[12:15], s41 offen sc1
    s_mov_b32 s42, 0
    buffer_load_dwordx3 v[72:74], v33, s[12:15], s42 offen sc1
    s_mov_b32 s43, 4096
    buffer_load_dwordx3 v[76:78], v33, s[12:15], s43 offen sc1
    s_sub_u32 s70, s78, 128
    v_or_b32 v16, s60, v2
    v_min_u32 v16, 1, v16
    v_lshlrev_b32 v16, 30, v16
    v_lshl_or_b32 v160, v164, 4, v160
    v_lshl_or_b32 v161, v165, 4, v161
    v_lshl_or_b32 v162, v166, 4, v162
    v_lshl_or_b32 v163, v167, 4, v163
    v_lshl_or_b32 v168, v172, 4, v168
    v_lshl_or_b32 v169, v173, 4, v169
    v_lshl_or_b32 v170, v174, 4, v170
    v_lshl_or_b32 v171, v175, 4, v171
    v_lshl_or_b32 v160, v168, 8, v160
    v_lshl_or_b32 v161, v169, 8, v161
    v_lshl_or_b32 v162, v170, 8, v162
    v_lshl_or_b32 v163, v171, 8, v163
    v_lshl_or_b32 v176, v180, 4, v176
    v_lshl_or_b32 v177, v181, 4, v177
    v_lshl_or_b32 v178, v182, 4, v178
    v_lshl_or_b32 v179, v183, 4, v179
    v_lshl_or_b32 v184, v188, 4, v184
    v_lshl_or_b32 v185, v189, 4, v185
    v_lshl_or_b32 v186, v190, 4, v186
    v_lshl_or_b32 v187, v191, 4, v187
    v_lshl_or_b32 v176, v184, 8, v176
    v_lshl_or_b32 v177, v185, 8, v177
    v_lshl_or_b32 v178, v186, 8, v178
    v_lshl_or_b32 v179, v187, 8, v179
    v_lshl_or_b32 v160, v176, 16, v160
    v_lshl_or_b32 v161, v177, 16, v161
    v_lshl_or_b32 v162, v178, 16, v162
    v_lshl_or_b32 v163, v179, 16, v163
    buffer_store_dwordx4 v[160:163], v18, s[12:15], s62 offen sc1
    s_add_u32 m0, s57, 65536
    s_add_u32 s56, s55, 256
    buffer_load_dwordx4 v36, s[8:11], s56 offen offset:0 lds
    buffer_load_dwordx4 v37, s[8:11], s56 offen offset:1024 lds
    buffer_load_dwordx4 v38, s[8:11], s56 offen offset:2048 lds
    buffer_load_dwordx4 v39, s[8:11], s56 offen offset:3072 lds
    s_add_u32 m0, s57, 83968
    s_add_u32 s56, s55, 384
    buffer_load_dwordx4 v36, s[8:11], s56 offen offset:0 lds
    buffer_load_dwordx4 v37, s[8:11], s56 offen offset:1024 lds
    s_add_u32 m0, s57, 79872
    s_nop 0
    buffer_load_dwordx4 v38, s[8:11], s56 offen offset:2048 lds
    buffer_load_dwordx4 v39, s[8:11], s56 offen offset:3072 lds
    s_mov_b32 s44, 16384
    buffer_load_dwordx3 v[80:82], v32, s[12:15], s44 offen sc1
    buffer_load_dword v83, v34, s[12:15], s44 offen sc1
    s_mov_b32 s45, 20480
    buffer_load_dwordx3 v[84:86], v32, s[12:15], s45 offen sc1
    buffer_load_dword v87, v34, s[12:15], s45 offen sc1
    buffer_store_dwordx2 v[20:21], v16, s[12:15], s70 offen sc1
    s_add_u32 s78, s78, 512
    s_waitcnt vmcnt(19)
    v_perm_b32 v56, v64, v35, s36
    v_perm_b32 v57, v64, v35, s37
    v_perm_b32 v58, v64, v35, s38
    v_perm_b32 v59, v64, v35, s39
    s_waitcnt vmcnt(17)
    v_perm_b32 v60, v68, v35, s36
    v_perm_b32 v61, v68, v35, s37
    v_perm_b32 v62, v68, v35, s38
    v_perm_b32 v63, v68, v35, s39
    ds_read_b32 a32, v56
    ds_read_b32 a33, v57
    ds_read_b32 a34, v58
    ds_read_b32 a35, v59
    ds_read_b32 a48, v60
    ds_read_b32 a49, v61
    ds_read_b32 a50, v62
    ds_read_b32 a51, v63
    v_perm_b32 v8, v65, v35, s36
    v_perm_b32 v9, v65, v35, s37
    v_perm_b32 v10, v65, v35, s38
    v_perm_b32 v11, v65, v35, s39
    v_perm_b32 v12, v69, v35, s36
    ds_read_b32 a64, v8
    ds_read_b32 a65, v9
    ds_read_b32 a66, v10
    ds_read_b32 a67, v11
    s_waitcnt lgkmcnt(8)
    v_mfma_f32_16x16x32_bf16 v[128:131], a[32:35], a[0:3], 0
    s_waitcnt lgkmcnt(4)
    ds_read_b32 a76, v12
    v_perm_b32 v13, v69, v35, s37
    v_mfma_f32_16x16x32_bf16 v[128:131], a[48:51], a[4:7], v[128:131]
    ds_read_b128 a[80:83], v42 offset:34816
    v_mfma_f32_16x16x32_bf16 v[132:135], a[32:35], a[8:11], 0
    ds_read_b32 a77, v13
    v_perm_b32 v14, v69, v35, s38
    v_mfma_f32_16x16x32_bf16 v[132:135], a[48:51], a[12:15], v[132:135]
    s_add_u32 s56, s55, 512
    ds_read_b128 a[84:87], v43 offset:34816
    v_mfma_f32_16x16x32_bf16 v[136:139], a[32:35], a[16:19], 0
    s_add_u32 m0, s57, 0
    ds_read_b32 a78, v14
    v_perm_b32 v15, v69, v35, s39
    v_mfma_f32_16x16x32_bf16 v[136:139], a[48:51], a[20:23], v[136:139]
    buffer_load_dwordx4 v36, s[8:11], s56 offen offset:0 lds
    v_mfma_f32_16x16x32_bf16 v[140:143], a[32:35], a[24:27], 0
    ds_read_b32 a79, v15
    v_perm_b32 v56, v66, v35, s36
    v_mfma_f32_16x16x32_bf16 v[140:143], a[48:51], a[28:31], v[140:143]
    ds_read_b128 a[88:91], v42 offset:32768
    v_mfma_f32_16x16x32_bf16 v[144:147], a[32:35], a[36:39], 0
    ds_read_b32 a92, v56
    v_perm_b32 v57, v66, v35, s37
    v_mfma_f32_16x16x32_bf16 v[144:147], a[48:51], a[40:43], v[144:147]
    ds_read_b128 a[96:99], v43 offset:32768
    v_mfma_f32_16x16x32_bf16 v[148:151], a[32:35], a[44:47], 0
    ds_read_b32 a93, v57
    v_perm_b32 v58, v66, v35, s38
    v_mfma_f32_16x16x32_bf16 v[148:151], a[48:51], a[52:55], v[148:151]
    buffer_load_dwordx4 v37, s[8:11], s56 offen offset:1024 lds
    v_mfma_f32_16x16x32_bf16 v[152:155], a[32:35], a[56:59], 0
    ds_read_b32 a94, v58
    v_perm_b32 v59, v66, v35, s39
    v_mfma_f32_16x16x32_bf16 v[152:155], a[48:51], a[60:63], v[152:155]
    ds_read_b128 a[100:103], v42 offset:38912
    v_mfma_f32_16x16x32_bf16 v[156:159], a[32:35], a[68:71], 0
    ds_read_b32 a95, v59
    v_perm_b32 v60, v70, v35, s36
    v_mfma_f32_16x16x32_bf16 v[156:159], a[48:51], a[72:75], v[156:159]
    s_waitcnt lgkmcnt(7)
    ds_read_b128 a[104:107], v43 offset:38912
    v_mfma_f32_16x16x32_bf16 v[160:163], a[64:67], a[0:3], 0
    ds_read_b32 a108, v60
    v_perm_b32 v61, v70, v35, s37
    v_mfma_f32_16x16x32_bf16 v[160:163], a[76:79], a[4:7], v[160:163]
    buffer_load_dwordx4 v38, s[8:11], s56 offen offset:2048 lds
    v_mfma_f32_16x16x32_bf16 v[164:167], a[64:67], a[8:11], 0
    ds_read_b32 a109, v61
    v_perm_b32 v62, v70, v35, s38
    v_mfma_f32_16x16x32_bf16 v[164:167], a[76:79], a[12:15], v[164:167]
    ds_read_b128 a[112:115], v42 offset:36864
    v_mfma_f32_16x16x32_bf16 v[168:171], a[64:67], a[16:19], 0
    ds_read_b32 a110, v62
    v_perm_b32 v63, v70, v35, s39
    v_mfma_f32_16x16x32_bf16 v[168:171], a[76:79], a[20:23], v[168:171]
    ds_read_b128 a[116:119], v43 offset:36864
    v_mfma_f32_16x16x32_bf16 v[172:175], a[64:67], a[24:27], 0
    ds_read_b32 a111, v63
    v_perm_b32 v8, v67, v35, s36
    v_mfma_f32_16x16x32_bf16 v[172:175], a[76:79], a[28:31], v[172:175]
    buffer_load_dwordx4 v39, s[8:11], s56 offen offset:3072 lds
    v_mfma_f32_16x16x32_bf16 v[176:179], a[64:67], a[36:39], 0
    ds_read_b32 a120, v8
    v_perm_b32 v9, v67, v35, s37
    v_mfma_f32_16x16x32_bf16 v[176:179], a[76:79], a[40:43], v[176:179]
    ds_read_b128 a[124:127], v42 offset:43008
    v_mfma_f32_16x16x32_bf16 v[180:183], a[64:67], a[44:47], 0
    ds_read_b32 a121, v9
    v_perm_b32 v10, v67, v35, s38
    v_mfma_f32_16x16x32_bf16 v[180:183], a[76:79], a[52:55], v[180:183]
    s_add_u32 s56, s55, 640
    ds_read_b128 a[128:131], v43 offset:43008
    v_mfma_f32_16x16x32_bf16 v[184:187], a[64:67], a[56:59], 0
    s_add_u32 m0, s57, 18432
    ds_read_b32 a122, v10
    v_perm_b32 v11, v67, v35, s39
    v_mfma_f32_16x16x32_bf16 v[184:187], a[76:79], a[60:63], v[184:187]
    buffer_load_dwordx4 v36, s[8:11], s56 offen offset:0 lds
    v_mfma_f32_16x16x32_bf16 v[188:191], a[64:67], a[68:71], 0
    s_waitcnt vmcnt(21)
    ds_read_b32 a123, v11
    v_perm_b32 v12, v71, v35, s36
    v_mfma_f32_16x16x32_bf16 v[188:191], a[76:79], a[72:75], v[188:191]
    s_waitcnt lgkmcnt(6)
    ds_read_b128 a[132:135], v42 offset:40960
    v_mfma_f32_16x16x32_bf16 v[192:195], a[92:95], a[0:3], 0
    ds_read_b32 a136, v12
    v_perm_b32 v13, v71, v35, s37
    v_mfma_f32_16x16x32_bf16 v[192:195], a[108:111], a[4:7], v[192:195]
    ds_read_b128 a[140:143], v43 offset:40960
    v_mfma_f32_16x16x32_bf16 v[196:199], a[92:95], a[8:11], 0
    ds_read_b32 a137, v13
    v_perm_b32 v14, v71, v35, s38
    v_mfma_f32_16x16x32_bf16 v[196:199], a[108:111], a[12:15], v[196:199]
    buffer_load_dwordx4 v37, s[8:11], s56 offen offset:1024 lds
    v_mfma_f32_16x16x32_bf16 v[200:203], a[92:95], a[16:19], 0
    ds_read_b32 a138, v14
    v_perm_b32 v15, v71, v35, s39
    v_mfma_f32_16x16x32_bf16 v[200:203], a[108:111], a[20:23], v[200:203]
    ds_read_b128 a[144:147], v42 offset:47104
    v_mfma_f32_16x16x32_bf16 v[204:207], a[92:95], a[24:27], 0
    s_waitcnt vmcnt(21)
    ds_read_b32 a139, v15
    v_perm_b32 v56, v72, v35, s36
    v_mfma_f32_16x16x32_bf16 v[204:207], a[108:111], a[28:31], v[204:207]
    ds_read_b128 a[148:151], v43 offset:47104
    v_mfma_f32_16x16x32_bf16 v[208:211], a[92:95], a[36:39], 0
    s_add_u32 m0, s57, 14336
    ds_read_b32 a152, v56
    v_perm_b32 v57, v72, v35, s37
    v_mfma_f32_16x16x32_bf16 v[208:211], a[108:111], a[40:43], v[208:211]
    buffer_load_dwordx4 v38, s[8:11], s56 offen offset:2048 lds
    v_mfma_f32_16x16x32_bf16 v[212:215], a[92:95], a[44:47], 0
    ds_read_b32 a153, v57
    v_perm_b32 v58, v72, v35, s38
    v_mfma_f32_16x16x32_bf16 v[212:215], a[108:111], a[52:55], v[212:215]
    ds_read_b128 a[156:159], v42 offset:45056
    v_mfma_f32_16x16x32_bf16 v[216:219], a[92:95], a[56:59], 0
    ds_read_b32 a154, v58
    v_perm_b32 v59, v72, v35, s39
    v_mfma_f32_16x16x32_bf16 v[216:219], a[108:111], a[60:63], v[216:219]
    ds_read_b128 a[160:163], v43 offset:45056
    v_mfma_f32_16x16x32_bf16 v[220:223], a[92:95], a[68:71], 0
    s_waitcnt vmcnt(21)
    ds_read_b32 a155, v59
    v_perm_b32 v60, v76, v35, s36
    v_mfma_f32_16x16x32_bf16 v[220:223], a[108:111], a[72:75], v[220:223]
    s_waitcnt lgkmcnt(7)
    buffer_load_dwordx4 v39, s[8:11], s56 offen offset:3072 lds
    v_mfma_f32_16x16x32_bf16 v[224:227], a[120:123], a[0:3], 0
    s_mov_b32 s46, 49152
    ds_read_b32 a164, v60
    v_perm_b32 v61, v76, v35, s37
    v_mfma_f32_16x16x32_bf16 v[224:227], a[136:139], a[4:7], v[224:227]
    buffer_load_dwordx3 v[88:90], v32, s[12:15], s46 offen sc1
    v_mfma_f32_16x16x32_bf16 v[228:231], a[120:123], a[8:11], 0
    ds_read_b32 a165, v61
    v_perm_b32 v62, v76, v35, s38
    v_mfma_f32_16x16x32_bf16 v[228:231], a[136:139], a[12:15], v[228:231]
    s_waitcnt vmcnt(22)
    buffer_store_dwordx2 v[20:21], v19, s[12:15], 0 offen offset:0 sc1
    v_mfma_f32_16x16x32_bf16 v[232:235], a[120:123], a[16:19], 0
    ds_read_b32 a166, v62
    v_perm_b32 v63, v76, v35, s39
    v_mfma_f32_16x16x32_bf16 v[232:235], a[136:139], a[20:23], v[232:235]
    buffer_load_dword v91, v34, s[12:15], s46 offen sc1
    v_mfma_f32_16x16x32_bf16 v[236:239], a[120:123], a[24:27], 0
    s_mov_b32 s47, 53248
    ds_read_b32 a167, v63
    v_perm_b32 v8, v73, v35, s36
    v_mfma_f32_16x16x32_bf16 v[236:239], a[136:139], a[28:31], v[236:239]
    buffer_load_dwordx3 v[92:94], v32, s[12:15], s47 offen sc1
    v_mfma_f32_16x16x32_bf16 v[240:243], a[120:123], a[36:39], 0
    ds_read_b32 a168, v8
    v_perm_b32 v9, v73, v35, s37
    v_mfma_f32_16x16x32_bf16 v[240:243], a[136:139], a[40:43], v[240:243]
    buffer_load_dword v95, v34, s[12:15], s47 offen sc1
    v_mfma_f32_16x16x32_bf16 v[244:247], a[120:123], a[44:47], 0
    s_mov_b32 s40, 16384
    ds_read_b32 a169, v9
    v_perm_b32 v10, v73, v35, s38
    v_mfma_f32_16x16x32_bf16 v[244:247], a[136:139], a[52:55], v[244:247]
    buffer_load_dwordx3 v[96:98], v33, s[12:15], s40 offen sc1
    v_mfma_f32_16x16x32_bf16 v[248:251], a[120:123], a[56:59], 0
    s_mov_b32 s41, 20480
    ds_read_b32 a170, v10
    v_perm_b32 v11, v73, v35, s39
    v_mfma_f32_16x16x32_bf16 v[248:251], a[136:139], a[60:63], v[248:251]
    buffer_load_dwordx3 v[100:102], v33, s[12:15], s41 offen sc1
    v_mfma_f32_16x16x32_bf16 v[252:255], a[120:123], a[68:71], 0
    s_mov_b32 s42, 49152
    ds_read_b32 a171, v11
    v_perm_b32 v12, v77, v35, s36
    v_mfma_f32_16x16x32_bf16 v[252:255], a[136:139], a[72:75], v[252:255]
    s_waitcnt vmcnt(20) lgkmcnt(4)
    s_barrier
    buffer_load_dwordx3 v[104:106], v33, s[12:15], s42 offen sc1
    v_mfma_f32_16x16x32_bf16 v[128:131], a[152:155], a[80:83], v[128:131]
    ds_read_b32 a172, v12
    v_perm_b32 v13, v77, v35, s37
    v_mfma_f32_16x16x32_bf16 v[128:131], a[164:167], a[84:87], v[128:131]
    ds_read_b128 a[176:179], v44 offset:0
    v_mfma_f32_16x16x32_bf16 v[132:135], a[152:155], a[88:91], v[132:135]
    ds_read_b32 a173, v13
    v_perm_b32 v14, v77, v35, s38
    v_mfma_f32_16x16x32_bf16 v[132:135], a[164:167], a[96:99], v[132:135]
    s_add_u32 s56, s55, 1024
    ds_read_b128 a[180:183], v45 offset:0
    v_mfma_f32_16x16x32_bf16 v[136:139], a[152:155], a[100:103], v[136:139]
    s_add_u32 m0, s57, 32768
    ds_read_b32 a174, v14
    v_perm_b32 v15, v77, v35, s39
    v_mfma_f32_16x16x32_bf16 v[136:139], a[164:167], a[104:107], v[136:139]
    buffer_load_dwordx4 v36, s[8:11], s56 offen offset:0 lds
    v_mfma_f32_16x16x32_bf16 v[140:143], a[152:155], a[112:115], v[140:143]
    ds_read_b32 a175, v15
    v_perm_b32 v56, v74, v35, s36
    v_mfma_f32_16x16x32_bf16 v[140:143], a[164:167], a[116:119], v[140:143]
    ds_read_b128 a[184:187], v44 offset:2048
    v_mfma_f32_16x16x32_bf16 v[144:147], a[152:155], a[124:127], v[144:147]
    ds_read_b32 a188, v56
    v_perm_b32 v57, v74, v35, s37
    v_mfma_f32_16x16x32_bf16 v[144:147], a[164:167], a[128:131], v[144:147]
    ds_read_b128 a[192:195], v45 offset:2048
    v_mfma_f32_16x16x32_bf16 v[148:151], a[152:155], a[132:135], v[148:151]
    ds_read_b32 a189, v57
    v_perm_b32 v58, v74, v35, s38
    v_mfma_f32_16x16x32_bf16 v[148:151], a[164:167], a[140:143], v[148:151]
    buffer_load_dwordx4 v37, s[8:11], s56 offen offset:1024 lds
    v_mfma_f32_16x16x32_bf16 v[152:155], a[152:155], a[144:147], v[152:155]
    ds_read_b32 a190, v58
    v_perm_b32 v59, v74, v35, s39
    v_mfma_f32_16x16x32_bf16 v[152:155], a[164:167], a[148:151], v[152:155]
    ds_read_b128 a[196:199], v44 offset:4096
    v_mfma_f32_16x16x32_bf16 v[156:159], a[152:155], a[156:159], v[156:159]
    ds_read_b32 a191, v59
    v_perm_b32 v60, v78, v35, s36
    v_mfma_f32_16x16x32_bf16 v[156:159], a[164:167], a[160:163], v[156:159]
    s_waitcnt lgkmcnt(7)
    ds_read_b128 a[200:203], v45 offset:4096
    v_mfma_f32_16x16x32_bf16 v[160:163], a[168:171], a[80:83], v[160:163]
    ds_read_b32 a204, v60
    v_perm_b32 v61, v78, v35, s37
    v_mfma_f32_16x16x32_bf16 v[160:163], a[172:175], a[84:87], v[160:163]
    buffer_load_dwordx4 v38, s[8:11], s56 offen offset:2048 lds
    v_mfma_f32_16x16x32_bf16 v[164:167], a[168:171], a[88:91], v[164:167]
    ds_read_b32 a205, v61
    v_perm_b32 v62, v78, v35, s38
    v_mfma_f32_16x16x32_bf16 v[164:167], a[172:175], a[96:99], v[164:167]
    ds_read_b128 a[208:211], v44 offset:6144
    v_mfma_f32_16x16x32_bf16 v[168:171], a[168:171], a[100:103], v[168:171]
    ds_read_b32 a206, v62
    v_perm_b32 v63, v78, v35, s39
    v_mfma_f32_16x16x32_bf16 v[168:171], a[172:175], a[104:107], v[168:171]
    ds_read_b128 a[212:215], v45 offset:6144
    v_mfma_f32_16x16x32_bf16 v[172:175], a[168:171], a[112:115], v[172:175]
    s_waitcnt vmcnt(23)
    ds_read_b32 a207, v63
    v_perm_b32 v8, v80, v35, s36
    v_mfma_f32_16x16x32_bf16 v[172:175], a[172:175], a[116:119], v[172:175]
    buffer_load_dwordx4 v39, s[8:11], s56 offen offset:3072 lds
    v_mfma_f32_16x16x32_bf16 v[176:179], a[168:171], a[124:127], v[176:179]
    ds_read_b32 a216, v8
    v_perm_b32 v9, v80, v35, s37
    v_mfma_f32_16x16x32_bf16 v[176:179], a[172:175], a[128:131], v[176:179]
    ds_read_b128 a[220:223], v44 offset:8192
    v_mfma_f32_16x16x32_bf16 v[180:183], a[168:171], a[132:135], v[180:183]
    ds_read_b32 a217, v9
    v_perm_b32 v10, v80, v35, s38
    v_mfma_f32_16x16x32_bf16 v[180:183], a[172:175], a[140:143], v[180:183]
    s_add_u32 s56, s55, 1152
    ds_read_b128 a[224:227], v45 offset:8192
    v_mfma_f32_16x16x32_bf16 v[184:187], a[168:171], a[144:147], v[184:187]
    s_add_u32 m0, s57, 51200
    ds_read_b32 a218, v10
    v_perm_b32 v11, v80, v35, s39
    v_mfma_f32_16x16x32_bf16 v[184:187], a[172:175], a[148:151], v[184:187]
    buffer_load_dwordx4 v36, s[8:11], s56 offen offset:0 lds
    v_mfma_f32_16x16x32_bf16 v[188:191], a[168:171], a[156:159], v[188:191]
    s_waitcnt vmcnt(23)
    ds_read_b32 a219, v11
    v_perm_b32 v12, v84, v35, s36
    v_mfma_f32_16x16x32_bf16 v[188:191], a[172:175], a[160:163], v[188:191]
    s_waitcnt lgkmcnt(6)
    ds_read_b128 a[228:231], v44 offset:10240
    v_mfma_f32_16x16x32_bf16 v[192:195], a[188:191], a[80:83], v[192:195]
    ds_read_b32 a232, v12
    v_perm_b32 v13, v84, v35, s37
    v_mfma_f32_16x16x32_bf16 v[192:195], a[204:207], a[84:87], v[192:195]
    ds_read_b128 a[236:239], v45 offset:10240
    v_mfma_f32_16x16x32_bf16 v[196:199], a[188:191], a[88:91], v[196:199]
    ds_read_b32 a233, v13
    v_perm_b32 v14, v84, v35, s38
    v_mfma_f32_16x16x32_bf16 v[196:199], a[204:207], a[96:99], v[196:199]
    s_waitcnt vmcnt(10)
    buffer_load_dwordx4 v37, s[8:11], s56 offen offset:1024 lds
    v_perm_b32 v15, v91, v35, s36
    v_mfma_f32_16x16x32_bf16 v[200:203], a[188:191], a[100:103], v[200:203]
    ds_read_b32 a234, v14
    v_perm_b32 v56, v84, v35, s39
    v_mfma_f32_16x16x32_bf16 v[200:203], a[204:207], a[104:107], v[200:203]
    ds_read_b128 a[240:243], v44 offset:12288
    ds_read_b32 a244, v15
    v_mfma_f32_16x16x32_bf16 v[204:207], a[188:191], a[112:115], v[204:207]
    ds_read_b32 a235, v56
    v_perm_b32 v57, v81, v35, s36
    v_mfma_f32_16x16x32_bf16 v[204:207], a[204:207], a[116:119], v[204:207]
    ds_read_b128 a[248:251], v45 offset:12288
    v_mfma_f32_16x16x32_bf16 v[208:211], a[188:191], a[124:127], v[208:211]
    s_add_u32 m0, s57, 47104
    ds_read_b32 a252, v57
    v_perm_b32 v58, v81, v35, s37
    v_mfma_f32_16x16x32_bf16 v[208:211], a[204:207], a[128:131], v[208:211]
    buffer_load_dwordx4 v38, s[8:11], s56 offen offset:2048 lds
    v_perm_b32 v59, v91, v35, s37
    v_mfma_f32_16x16x32_bf16 v[212:215], a[188:191], a[132:135], v[212:215]
    ds_read_b32 a253, v58
    ds_read_b32 a245, v59
    v_mfma_f32_16x16x32_bf16 v[212:215], a[204:207], a[140:143], v[212:215]
    ds_read_b128 a[32:35], v44 offset:14336
    v_perm_b32 v60, v81, v35, s38
    v_mfma_f32_16x16x32_bf16 v[216:219], a[188:191], a[144:147], v[216:219]
    ds_read_b32 a254, v60
    v_perm_b32 v61, v81, v35, s39
    v_mfma_f32_16x16x32_bf16 v[216:219], a[204:207], a[148:151], v[216:219]
    ds_read_b128 a[48:51], v45 offset:14336
    v_mfma_f32_16x16x32_bf16 v[220:223], a[188:191], a[156:159], v[220:223]
    ds_read_b32 a255, v61
    v_perm_b32 v62, v85, v35, s36
    v_mfma_f32_16x16x32_bf16 v[220:223], a[204:207], a[160:163], v[220:223]
    s_waitcnt lgkmcnt(8)
    buffer_load_dwordx4 v39, s[8:11], s56 offen offset:3072 lds
    v_perm_b32 v63, v91, v35, s38
    v_mfma_f32_16x16x32_bf16 v[128:131], a[216:219], a[176:179], v[128:131]
    ds_read_b32 a64, v62
    ds_read_b32 a246, v63
    v_mfma_f32_16x16x32_bf16 v[128:131], a[232:235], a[180:183], v[128:131]
    ds_read_b128 a[76:79], v46 offset:2048
    v_perm_b32 v8, v85, v35, s37
    v_mfma_f32_16x16x32_bf16 v[132:135], a[216:219], a[184:187], v[132:135]
    ds_read_b32 a65, v8
    v_perm_b32 v9, v85, v35, s38
    v_mfma_f32_16x16x32_bf16 v[132:135], a[232:235], a[192:195], v[132:135]
    ds_read_b128 a[92:95], v47 offset:2048
    v_perm_b32 v10, v91, v35, s39
    v_mfma_f32_16x16x32_bf16 v[136:139], a[216:219], a[196:199], v[136:139]
    ds_read_b32 a66, v9
    v_perm_b32 v11, v85, v35, s39
    v_mfma_f32_16x16x32_bf16 v[136:139], a[232:235], a[200:203], v[136:139]
    ds_read_b32 a247, v10
    v_mfma_f32_16x16x32_bf16 v[140:143], a[216:219], a[208:211], v[140:143]
    ds_read_b32 a67, v11
    v_perm_b32 v12, v82, v35, s36
    v_mfma_f32_16x16x32_bf16 v[140:143], a[232:235], a[212:215], v[140:143]
    ds_read_b128 a[108:111], v46 offset:0
    v_mfma_f32_16x16x32_bf16 v[144:147], a[216:219], a[220:223], v[144:147]
    ds_read_b32 a0, v12
    v_perm_b32 v13, v82, v35, s37
    v_mfma_f32_16x16x32_bf16 v[144:147], a[232:235], a[224:227], v[144:147]
    s_waitcnt vmcnt(11)
    ds_read_b128 a[4:7], v47 offset:0
    v_perm_b32 v14, v95, v35, s36
    v_mfma_f32_16x16x32_bf16 v[148:151], a[216:219], a[228:231], v[148:151]
    ds_read_b32 a1, v13
    v_perm_b32 v15, v82, v35, s38
    v_mfma_f32_16x16x32_bf16 v[148:151], a[232:235], a[236:239], v[148:151]
    ds_read_b32 a8, v14
    v_mfma_f32_16x16x32_bf16 v[152:155], a[216:219], a[240:243], v[152:155]
    s_waitcnt lgkmcnt(8)
    ds_read_b32 a2, v15
    v_perm_b32 v56, v82, v35, s39
    v_mfma_f32_16x16x32_bf16 v[152:155], a[232:235], a[248:251], v[152:155]
    ds_read_b128 a[12:15], v46 offset:6144
    v_mfma_f32_16x16x32_bf16 v[156:159], a[216:219], a[32:35], v[156:159]
    ds_read_b32 a3, v56
    v_perm_b32 v57, v86, v35, s36
    v_mfma_f32_16x16x32_bf16 v[156:159], a[232:235], a[48:51], v[156:159]
    ds_read_b128 a[16:19], v47 offset:6144
    v_perm_b32 v58, v95, v35, s37
    v_mfma_f32_16x16x32_bf16 v[160:163], a[252:255], a[176:179], v[160:163]
    s_waitcnt lgkmcnt(8)
    ds_read_b32 a20, v57
    v_perm_b32 v59, v86, v35, s37
    v_mfma_f32_16x16x32_bf16 v[160:163], a[64:67], a[180:183], v[160:163]
    ds_read_b32 a9, v58
    v_mfma_f32_16x16x32_bf16 v[164:167], a[252:255], a[184:187], v[164:167]
    ds_read_b32 a21, v59
    v_perm_b32 v60, v86, v35, s38
    v_mfma_f32_16x16x32_bf16 v[164:167], a[64:67], a[192:195], v[164:167]
    ds_read_b128 a[24:27], v46 offset:4096
    v_mfma_f32_16x16x32_bf16 v[168:171], a[252:255], a[196:199], v[168:171]
    ds_read_b32 a22, v60
    v_perm_b32 v61, v86, v35, s39
    v_mfma_f32_16x16x32_bf16 v[168:171], a[64:67], a[200:203], v[168:171]
    ds_read_b128 a[28:31], v47 offset:4096
    v_perm_b32 v62, v95, v35, s38
    v_mfma_f32_16x16x32_bf16 v[172:175], a[252:255], a[208:211], v[172:175]
    ds_read_b32 a23, v61
    v_perm_b32 v63, v83, v35, s36
    v_mfma_f32_16x16x32_bf16 v[172:175], a[64:67], a[212:215], v[172:175]
    ds_read_b32 a10, v62
    v_mfma_f32_16x16x32_bf16 v[176:179], a[252:255], a[220:223], v[176:179]
    ds_read_b32 a36, v63
    v_perm_b32 v8, v83, v35, s37
    v_mfma_f32_16x16x32_bf16 v[176:179], a[64:67], a[224:227], v[176:179]
    ds_read_b128 a[40:43], v46 offset:10240
    v_mfma_f32_16x16x32_bf16 v[180:183], a[252:255], a[228:231], v[180:183]
    ds_read_b32 a37, v8
    v_perm_b32 v9, v83, v35, s38
    v_mfma_f32_16x16x32_bf16 v[180:183], a[64:67], a[236:239], v[180:183]
    ds_read_b128 a[44:47], v47 offset:10240
    v_perm_b32 v10, v95, v35, s39
    v_mfma_f32_16x16x32_bf16 v[184:187], a[252:255], a[240:243], v[184:187]
    ds_read_b32 a38, v9
    v_perm_b32 v11, v83, v35, s39
    v_mfma_f32_16x16x32_bf16 v[184:187], a[64:67], a[248:251], v[184:187]
    ds_read_b32 a11, v10
    v_mfma_f32_16x16x32_bf16 v[188:191], a[252:255], a[32:35], v[188:191]
    ds_read_b32 a39, v11
    v_perm_b32 v12, v87, v35, s36
    v_mfma_f32_16x16x32_bf16 v[188:191], a[64:67], a[48:51], v[188:191]
    s_waitcnt lgkmcnt(8)
    ds_read_b128 a[52:55], v46 offset:8192
    v_mfma_f32_16x16x32_bf16 v[192:195], a[0:3], a[176:179], v[192:195]
    ds_read_b32 a56, v12
    v_perm_b32 v13, v87, v35, s37
    v_mfma_f32_16x16x32_bf16 v[192:195], a[20:23], a[180:183], v[192:195]
    ds_read_b128 a[60:63], v47 offset:8192
    v_perm_b32 v14, v88, v35, s36
    v_mfma_f32_16x16x32_bf16 v[196:199], a[0:3], a[184:187], v[196:199]
    ds_read_b32 a57, v13
    v_perm_b32 v15, v87, v35, s38
    v_mfma_f32_16x16x32_bf16 v[196:199], a[20:23], a[192:195], v[196:199]
    ds_read_b32 a68, v14
    v_mfma_f32_16x16x32_bf16 v[200:203], a[0:3], a[196:199], v[200:203]
    ds_read_b32 a58, v15
    v_perm_b32 v56, v87, v35, s39
    v_mfma_f32_16x16x32_bf16 v[200:203], a[20:23], a[200:203], v[200:203]
    ds_read_b128 a[120:123], v46 offset:14336
    v_mfma_f32_16x16x32_bf16 v[204:207], a[0:3], a[208:211], v[204:207]
    s_waitcnt vmcnt(10)
    ds_read_b32 a59, v56
    v_perm_b32 v57, v96, v35, s36
    v_mfma_f32_16x16x32_bf16 v[204:207], a[20:23], a[212:215], v[204:207]
    ds_read_b128 a[72:75], v47 offset:14336
    v_perm_b32 v58, v88, v35, s37
    v_mfma_f32_16x16x32_bf16 v[208:211], a[0:3], a[220:223], v[208:211]
    ds_read_b32 a136, v57
    v_perm_b32 v59, v96, v35, s37
    v_mfma_f32_16x16x32_bf16 v[208:211], a[20:23], a[224:227], v[208:211]
    ds_read_b32 a69, v58
    v_mfma_f32_16x16x32_bf16 v[212:215], a[0:3], a[228:231], v[212:215]
    ds_read_b32 a137, v59
    v_perm_b32 v60, v96, v35, s38
    v_mfma_f32_16x16x32_bf16 v[212:215], a[20:23], a[236:239], v[212:215]
    ds_read_b128 a[152:155], v46 offset:12288
    v_mfma_f32_16x16x32_bf16 v[216:219], a[0:3], a[240:243], v[216:219]
    ds_read_b32 a138, v60
    v_perm_b32 v61, v96, v35, s39
    v_mfma_f32_16x16x32_bf16 v[216:219], a[20:23], a[248:251], v[216:219]
    ds_read_b128 a[164:167], v47 offset:12288
    v_perm_b32 v62, v88, v35, s38
    v_mfma_f32_16x16x32_bf16 v[220:223], a[0:3], a[32:35], v[220:223]
    s_waitcnt vmcnt(9)
    ds_read_b32 a139, v61
    v_perm_b32 v63, v100, v35, s36
    v_mfma_f32_16x16x32_bf16 v[220:223], a[20:23], a[48:51], v[220:223]
    s_waitcnt lgkmcnt(8)
    ds_read_b32 a70, v62
    v_mfma_f32_16x16x32_bf16 v[224:227], a[36:39], a[176:179], v[224:227]
    ds_read_b32 a168, v63
    v_perm_b32 v8, v100, v35, s37
    v_mfma_f32_16x16x32_bf16 v[224:227], a[56:59], a[180:183], v[224:227]
    buffer_load_dwordx2 v[6:7], v5, s[12:15], s78 offen sc1
    v_mfma_f32_16x16x32_bf16 v[228:231], a[36:39], a[184:187], v[228:231]
    s_mov_b32 s43, 32768
    ds_read_b32 a169, v8
    v_perm_b32 v9, v100, v35, s38
    v_mfma_f32_16x16x32_bf16 v[228:231], a[56:59], a[192:195], v[228:231]
    buffer_load_dwordx3 v[108:110], v32, s[12:15], s43 offen sc1
    v_perm_b32 v10, v88, v35, s39
    v_mfma_f32_16x16x32_bf16 v[232:235], a[36:39], a[196:199], v[232:235]
    ds_read_b32 a170, v9
    v_perm_b32 v11, v100, v35, s39
    v_mfma_f32_16x16x32_bf16 v[232:235], a[56:59], a[200:203], v[232:235]
    ds_read_b32 a71, v10
    v_mfma_f32_16x16x32_bf16 v[236:239], a[36:39], a[208:211], v[236:239]
    ds_read_b32 a171, v11
    v_perm_b32 v12, v97, v35, s36
    v_mfma_f32_16x16x32_bf16 v[236:239], a[56:59], a[212:215], v[236:239]
    buffer_load_dword v111, v34, s[12:15], s43 offen sc1
    v_mfma_f32_16x16x32_bf16 v[240:243], a[36:39], a[220:223], v[240:243]
    s_mov_b32 s44, 36864
    ds_read_b32 a172, v12
    v_perm_b32 v13, v97, v35, s37
    v_mfma_f32_16x16x32_bf16 v[240:243], a[56:59], a[224:227], v[240:243]
    buffer_load_dwordx3 v[112:114], v32, s[12:15], s44 offen sc1
    v_perm_b32 v14, v92, v35, s36
    v_mfma_f32_16x16x32_bf16 v[244:247], a[36:39], a[228:231], v[244:247]
    ds_read_b32 a173, v13
    v_perm_b32 v15, v97, v35, s38
    v_mfma_f32_16x16x32_bf16 v[244:247], a[56:59], a[236:239], v[244:247]
    ds_read_b32 a80, v14
    v_mfma_f32_16x16x32_bf16 v[248:251], a[36:39], a[240:243], v[248:251]
    ds_read_b32 a174, v15
    v_perm_b32 v56, v97, v35, s39
    v_mfma_f32_16x16x32_bf16 v[248:251], a[56:59], a[248:251], v[248:251]
    s_waitcnt lgkmcnt(6)
    buffer_load_dword v115, v34, s[12:15], s44 offen sc1
    v_mfma_f32_16x16x32_bf16 v[252:255], a[36:39], a[32:35], v[252:255]
    s_mov_b32 s45, 53248
    ds_read_b32 a175, v56
    v_perm_b32 v57, v101, v35, s36
    v_mfma_f32_16x16x32_bf16 v[252:255], a[56:59], a[48:51], v[252:255]
    s_barrier
    buffer_load_dwordx3 v[116:118], v33, s[12:15], s45 offen sc1
    v_perm_b32 v58, v92, v35, s37
    v_mfma_f32_16x16x32_bf16 v[128:131], a[136:139], a[76:79], v[128:131]
    s_waitcnt lgkmcnt(5)
    ds_read_b32 a84, v57
    v_perm_b32 v59, v101, v35, s37
    v_mfma_f32_16x16x32_bf16 v[128:131], a[168:171], a[92:95], v[128:131]
    ds_read_b128 a[88:91], v40 offset:0
    ds_read_b32 a81, v58
    v_mfma_f32_16x16x32_bf16 v[132:135], a[136:139], a[108:111], v[132:135]
    ds_read_b32 a85, v59
    v_perm_b32 v60, v101, v35, s38
    v_mfma_f32_16x16x32_bf16 v[132:135], a[168:171], a[4:7], v[132:135]
    s_add_u32 s56, s55, 1280
    ds_read_b128 a[96:99], v41 offset:0
    v_mfma_f32_16x16x32_bf16 v[136:139], a[136:139], a[12:15], v[136:139]
    s_add_u32 m0, s57, 65536
    ds_read_b32 a86, v60
    v_perm_b32 v61, v101, v35, s39
    v_mfma_f32_16x16x32_bf16 v[136:139], a[168:171], a[16:19], v[136:139]
    buffer_load_dwordx4 v36, s[8:11], s56 offen offset:0 lds
    v_perm_b32 v62, v92, v35, s38
    v_mfma_f32_16x16x32_bf16 v[140:143], a[136:139], a[24:27], v[140:143]
    ds_read_b32 a87, v61
    v_perm_b32 v63, v98, v35, s36
    v_mfma_f32_16x16x32_bf16 v[140:143], a[168:171], a[28:31], v[140:143]
    ds_read_b128 a[100:103], v40 offset:2048
    ds_read_b32 a82, v62
    v_mfma_f32_16x16x32_bf16 v[144:147], a[136:139], a[40:43], v[144:147]
    ds_read_b32 a104, v63
    v_perm_b32 v8, v98, v35, s37
    v_mfma_f32_16x16x32_bf16 v[144:147], a[168:171], a[44:47], v[144:147]
    ds_read_b128 a[112:115], v41 offset:2048
    v_mfma_f32_16x16x32_bf16 v[148:151], a[136:139], a[52:55], v[148:151]
    ds_read_b32 a105, v8
    v_perm_b32 v9, v98, v35, s38
    v_mfma_f32_16x16x32_bf16 v[148:151], a[168:171], a[60:63], v[148:151]
    buffer_load_dwordx4 v37, s[8:11], s56 offen offset:1024 lds
    v_perm_b32 v10, v92, v35, s39
    v_mfma_f32_16x16x32_bf16 v[152:155], a[136:139], a[120:123], v[152:155]
    ds_read_b32 a106, v9
    v_perm_b32 v11, v98, v35, s39
    v_mfma_f32_16x16x32_bf16 v[152:155], a[168:171], a[72:75], v[152:155]
    ds_read_b128 a[116:119], v40 offset:4096
    ds_read_b32 a83, v10
    v_mfma_f32_16x16x32_bf16 v[156:159], a[136:139], a[152:155], v[156:159]
    ds_read_b32 a107, v11
    v_perm_b32 v12, v102, v35, s36
    v_mfma_f32_16x16x32_bf16 v[156:159], a[168:171], a[164:167], v[156:159]
    s_waitcnt lgkmcnt(9)
    ds_read_b128 a[124:127], v41 offset:4096
    v_mfma_f32_16x16x32_bf16 v[160:163], a[172:175], a[76:79], v[160:163]
    ds_read_b32 a128, v12
    v_perm_b32 v13, v102, v35, s37
    v_mfma_f32_16x16x32_bf16 v[160:163], a[84:87], a[92:95], v[160:163]
    s_waitcnt vmcnt(16)
    buffer_load_dwordx4 v38, s[8:11], s56 offen offset:2048 lds
    v_perm_b32 v14, v104, v35, s36
    v_mfma_f32_16x16x32_bf16 v[164:167], a[172:175], a[108:111], v[164:167]
    ds_read_b32 a129, v13
    v_perm_b32 v15, v102, v35, s38
    v_mfma_f32_16x16x32_bf16 v[164:167], a[84:87], a[4:7], v[164:167]
    ds_read_b128 a[132:135], v40 offset:6144
    ds_read_b32 a140, v14
    v_mfma_f32_16x16x32_bf16 v[168:171], a[172:175], a[12:15], v[168:171]
    ds_read_b32 a130, v15
    v_perm_b32 v56, v102, v35, s39
    v_mfma_f32_16x16x32_bf16 v[168:171], a[84:87], a[16:19], v[168:171]
    ds_read_b128 a[144:147], v41 offset:6144
    v_mfma_f32_16x16x32_bf16 v[172:175], a[172:175], a[24:27], v[172:175]
    s_waitcnt vmcnt(7)
    ds_read_b32 a131, v56
    v_perm_b32 v57, v108, v35, s36
    v_mfma_f32_16x16x32_bf16 v[172:175], a[84:87], a[28:31], v[172:175]
    buffer_load_dwordx4 v39, s[8:11], s56 offen offset:3072 lds
    v_perm_b32 v58, v104, v35, s37
    v_mfma_f32_16x16x32_bf16 v[176:179], a[172:175], a[40:43], v[176:179]
    ds_read_b32 a148, v57
    v_perm_b32 v59, v108, v35, s37
    v_mfma_f32_16x16x32_bf16 v[176:179], a[84:87], a[44:47], v[176:179]
    ds_read_b128 a[156:159], v40 offset:8192
    ds_read_b32 a141, v58
    v_mfma_f32_16x16x32_bf16 v[180:183], a[172:175], a[52:55], v[180:183]
    ds_read_b32 a149, v59
    v_perm_b32 v60, v108, v35, s38
    v_mfma_f32_16x16x32_bf16 v[180:183], a[84:87], a[60:63], v[180:183]
    s_add_u32 s56, s55, 1408
    ds_read_b128 a[188:191], v41 offset:8192
    v_perm_b32 v61, v104, v35, s38
    v_mfma_f32_16x16x32_bf16 v[184:187], a[172:175], a[120:123], v[184:187]
    s_add_u32 m0, s57, 83968
    ds_read_b32 a150, v60
    v_perm_b32 v62, v108, v35, s39
    v_mfma_f32_16x16x32_bf16 v[184:187], a[84:87], a[72:75], v[184:187]
    s_waitcnt vmcnt(6)
    buffer_load_dwordx4 v36, s[8:11], s56 offen offset:0 lds
    v_perm_b32 v63, v112, v35, s36
    v_mfma_f32_16x16x32_bf16 v[188:191], a[172:175], a[152:155], v[188:191]
    ds_read_b32 a151, v62
    v_cmp_ne_u64 vcc, s[76:77], v[6:7]
    v_mfma_f32_16x16x32_bf16 v[188:191], a[84:87], a[164:167], v[188:191]
    s_waitcnt lgkmcnt(7)
    ds_read_b128 a[160:163], v40 offset:10240
    ds_read_b32 a142, v61
    v_mfma_f32_16x16x32_bf16 v[192:195], a[104:107], a[76:79], v[192:195]
    s_cbranch_vccnz L_slow1
L_back1:
    ds_read_b32 a204, v63
    v_perm_b32 v8, v112, v35, s37
    v_mfma_f32_16x16x32_bf16 v[192:195], a[128:131], a[92:95], v[192:195]
    ds_read_b128 a[216:219], v41 offset:10240
    v_mfma_f32_16x16x32_bf16 v[196:199], a[104:107], a[108:111], v[196:199]
    ds_read_b32 a205, v8
    v_perm_b32 v9, v112, v35, s38
    v_mfma_f32_16x16x32_bf16 v[196:199], a[128:131], a[4:7], v[196:199]
    buffer_load_dwordx4 v37, s[8:11], s56 offen offset:1024 lds
    v_perm_b32 v10, v104, v35, s39
    v_mfma_f32_16x16x32_bf16 v[200:203], a[104:107], a[12:15], v[200:203]
    ds_read_b32 a206, v9
    v_perm_b32 v11, v112, v35, s39
    v_mfma_f32_16x16x32_bf16 v[200:203], a[128:131], a[16:19], v[200:203]
    ds_read_b128 a[232:235], v40 offset:12288
    ds_read_b32 a143, v10
    v_mfma_f32_16x16x32_bf16 v[204:207], a[104:107], a[24:27], v[204:207]
    ds_read_b32 a207, v11
    v_perm_b32 v12, v109, v35, s36
    v_mfma_f32_16x16x32_bf16 v[204:207], a[128:131], a[28:31], v[204:207]
    ds_read_b128 a[252:255], v41 offset:12288
    v_mfma_f32_16x16x32_bf16 v[208:211], a[104:107], a[40:43], v[208:211]
    s_add_u32 m0, s57, 79872
    ds_read_b32 a64, v12
    v_perm_b32 v13, v109, v35, s37
    v_mfma_f32_16x16x32_bf16 v[208:211], a[128:131], a[44:47], v[208:211]
    s_waitcnt vmcnt(6)
    buffer_load_dwordx4 v38, s[8:11], s56 offen offset:2048 lds
    v_perm_b32 v14, v116, v35, s36
    v_mfma_f32_16x16x32_bf16 v[212:215], a[104:107], a[52:55], v[212:215]
    ds_read_b32 a65, v13
    v_perm_b32 v15, v109, v35, s38
    v_mfma_f32_16x16x32_bf16 v[212:215], a[128:131], a[60:63], v[212:215]
    ds_read_b128 a[0:3], v40 offset:14336
    ds_read_b32 a20, v14
    v_mfma_f32_16x16x32_bf16 v[216:219], a[104:107], a[120:123], v[216:219]
    ds_read_b32 a66, v15
    v_perm_b32 v56, v109, v35, s39
    v_mfma_f32_16x16x32_bf16 v[216:219], a[128:131], a[72:75], v[216:219]
    ds_read_b128 a[176:179], v41 offset:14336
    v_mfma_f32_16x16x32_bf16 v[220:223], a[104:107], a[152:155], v[220:223]
    ds_read_b32 a67, v56
    v_perm_b32 v57, v113, v35, s36
    v_mfma_f32_16x16x32_bf16 v[220:223], a[128:131], a[164:167], v[220:223]
    s_waitcnt lgkmcnt(8)
    buffer_load_dwordx4 v39, s[8:11], s56 offen offset:3072 lds
    v_perm_b32 v58, v116, v35, s37
    v_mfma_f32_16x16x32_bf16 v[128:131], a[148:151], a[88:91], v[128:131]
    ds_read_b32 a180, v57
    v_perm_b32 v59, v113, v35, s37
    v_mfma_f32_16x16x32_bf16 v[128:131], a[204:207], a[96:99], v[128:131]
    ds_read_b128 a[184:187], v42 offset:2048
    ds_read_b32 a21, v58
    v_mfma_f32_16x16x32_bf16 v[132:135], a[148:151], a[100:103], v[132:135]
    ds_read_b32 a181, v59
    v_perm_b32 v60, v113, v35, s38
    v_mfma_f32_16x16x32_bf16 v[132:135], a[204:207], a[112:115], v[132:135]
    ds_read_b128 a[192:195], v43 offset:2048
    v_mfma_f32_16x16x32_bf16 v[136:139], a[148:151], a[116:119], v[136:139]
    s_mov_b32 s46, 32768
    ds_read_b32 a182, v60
    v_perm_b32 v62, v113, v35, s39
    v_mfma_f32_16x16x32_bf16 v[136:139], a[204:207], a[124:127], v[136:139]
    buffer_load_dwordx3 v[120:122], v33, s[12:15], s46 offen sc1
    v_perm_b32 v61, v116, v35, s38
    v_mfma_f32_16x16x32_bf16 v[140:143], a[148:151], a[132:135], v[140:143]
    ds_read_b32 a183, v62
    v_perm_b32 v63, v110, v35, s36
    v_mfma_f32_16x16x32_bf16 v[140:143], a[204:207], a[144:147], v[140:143]
    ds_read_b128 a[196:199], v42 offset:0
    ds_read_b32 a22, v61
    v_mfma_f32_16x16x32_bf16 v[144:147], a[148:151], a[156:159], v[144:147]
    ds_read_b32 a200, v63
    v_perm_b32 v8, v110, v35, s37
    v_mfma_f32_16x16x32_bf16 v[144:147], a[204:207], a[188:191], v[144:147]
    ds_read_b128 a[208:211], v43 offset:0
    v_mfma_f32_16x16x32_bf16 v[148:151], a[148:151], a[160:163], v[148:151]
    s_mov_b32 s47, 36864
    ds_read_b32 a201, v8
    v_perm_b32 v9, v110, v35, s38
    v_mfma_f32_16x16x32_bf16 v[148:151], a[204:207], a[216:219], v[148:151]
    buffer_load_dwordx3 v[124:126], v33, s[12:15], s47 offen sc1
    v_perm_b32 v10, v116, v35, s39
    v_mfma_f32_16x16x32_bf16 v[152:155], a[148:151], a[232:235], v[152:155]
    s_waitcnt lgkmcnt(7)
    ds_read_b32 a202, v9
    v_perm_b32 v11, v110, v35, s39
    v_mfma_f32_16x16x32_bf16 v[152:155], a[204:207], a[252:255], v[152:155]
    ds_read_b128 a[212:215], v42 offset:6144
    ds_read_b32 a23, v10
    v_mfma_f32_16x16x32_bf16 v[156:159], a[148:151], a[0:3], v[156:159]
    ds_read_b32 a203, v11
    v_perm_b32 v12, v114, v35, s36
    v_mfma_f32_16x16x32_bf16 v[156:159], a[204:207], a[176:179], v[156:159]
    s_waitcnt lgkmcnt(9)
    ds_read_b128 a[220:223], v43 offset:6144
    v_mfma_f32_16x16x32_bf16 v[160:163], a[64:67], a[88:91], v[160:163]
    s_mov_b32 s40, 65536
    ds_read_b32 a224, v12
    v_perm_b32 v13, v114, v35, s37
    v_mfma_f32_16x16x32_bf16 v[160:163], a[180:183], a[96:99], v[160:163]
    buffer_load_dwordx3 v[64:66], v32, s[12:15], s40 offen sc1
    v_perm_b32 v14, v89, v35, s36
    v_mfma_f32_16x16x32_bf16 v[164:167], a[64:67], a[100:103], v[164:167]
    ds_read_b32 a225, v13
    v_perm_b32 v15, v114, v35, s38
    v_mfma_f32_16x16x32_bf16 v[164:167], a[180:183], a[112:115], v[164:167]
    ds_read_b128 a[228:231], v42 offset:4096
    ds_read_b32 a236, v14
    v_mfma_f32_16x16x32_bf16 v[168:171], a[64:67], a[116:119], v[168:171]
    ds_read_b32 a226, v15
    v_perm_b32 v56, v114, v35, s39
    v_mfma_f32_16x16x32_bf16 v[168:171], a[180:183], a[124:127], v[168:171]
    ds_read_b128 a[240:243], v43 offset:4096
    v_mfma_f32_16x16x32_bf16 v[172:175], a[64:67], a[132:135], v[172:175]
    ds_read_b32 a227, v56
    v_perm_b32 v57, v111, v35, s36
    v_mfma_f32_16x16x32_bf16 v[172:175], a[180:183], a[144:147], v[172:175]
    buffer_load_dword v67, v34, s[12:15], s40 offen sc1
    v_perm_b32 v58, v89, v35, s37
    v_mfma_f32_16x16x32_bf16 v[176:179], a[64:67], a[156:159], v[176:179]
    ds_read_b32 a248, v57
    v_perm_b32 v59, v111, v35, s37
    v_mfma_f32_16x16x32_bf16 v[176:179], a[180:183], a[188:191], v[176:179]
    ds_read_b128 a[32:35], v42 offset:10240
    ds_read_b32 a237, v58
    v_mfma_f32_16x16x32_bf16 v[180:183], a[64:67], a[160:163], v[180:183]
    ds_read_b32 a249, v59
    v_perm_b32 v60, v111, v35, s38
    v_mfma_f32_16x16x32_bf16 v[180:183], a[180:183], a[216:219], v[180:183]
    ds_read_b128 a[36:39], v43 offset:10240
    v_mfma_f32_16x16x32_bf16 v[184:187], a[64:67], a[232:235], v[184:187]
    s_mov_b32 s41, 69632
    ds_read_b32 a250, v60
    v_perm_b32 v62, v111, v35, s39
    v_mfma_f32_16x16x32_bf16 v[184:187], a[180:183], a[252:255], v[184:187]
    buffer_load_dwordx3 v[68:70], v32, s[12:15], s41 offen sc1
    v_perm_b32 v61, v89, v35, s38
    v_mfma_f32_16x16x32_bf16 v[188:191], a[64:67], a[0:3], v[188:191]
    ds_read_b32 a251, v62
    v_perm_b32 v63, v115, v35, s36
    v_mfma_f32_16x16x32_bf16 v[188:191], a[180:183], a[176:179], v[188:191]
    s_waitcnt lgkmcnt(7)
    ds_read_b128 a[48:51], v42 offset:8192
    ds_read_b32 a238, v61
    v_mfma_f32_16x16x32_bf16 v[192:195], a[200:203], a[88:91], v[192:195]
    ds_read_b32 a56, v63
    v_perm_b32 v8, v115, v35, s37
    v_mfma_f32_16x16x32_bf16 v[192:195], a[224:227], a[96:99], v[192:195]
    ds_read_b128 a[136:139], v43 offset:8192
    v_mfma_f32_16x16x32_bf16 v[196:199], a[200:203], a[100:103], v[196:199]
    ds_read_b32 a57, v8
    v_perm_b32 v9, v115, v35, s38
    v_mfma_f32_16x16x32_bf16 v[196:199], a[224:227], a[112:115], v[196:199]
    buffer_load_dword v71, v34, s[12:15], s41 offen sc1
    v_perm_b32 v10, v89, v35, s39
    v_mfma_f32_16x16x32_bf16 v[200:203], a[200:203], a[116:119], v[200:203]
    ds_read_b32 a58, v9
    v_perm_b32 v11, v115, v35, s39
    v_mfma_f32_16x16x32_bf16 v[200:203], a[224:227], a[124:127], v[200:203]
    ds_read_b128 a[168:171], v42 offset:14336
    ds_read_b32 a239, v10
    v_mfma_f32_16x16x32_bf16 v[204:207], a[200:203], a[132:135], v[204:207]
    s_waitcnt vmcnt(5)
    ds_read_b32 a59, v11
    v_perm_b32 v12, v120, v35, s36
    v_mfma_f32_16x16x32_bf16 v[204:207], a[224:227], a[144:147], v[204:207]
    ds_read_b128 a[172:175], v43 offset:14336
    v_mfma_f32_16x16x32_bf16 v[208:211], a[200:203], a[156:159], v[208:211]
    s_mov_b32 s42, 65536
    ds_read_b32 a84, v12
    v_perm_b32 v13, v120, v35, s37
    v_mfma_f32_16x16x32_bf16 v[208:211], a[224:227], a[188:191], v[208:211]
    buffer_load_dwordx3 v[72:74], v33, s[12:15], s42 offen sc1
    v_perm_b32 v14, v93, v35, s36
    v_mfma_f32_16x16x32_bf16 v[212:215], a[200:203], a[160:163], v[212:215]
    ds_read_b32 a85, v13
    v_perm_b32 v15, v120, v35, s38
    v_mfma_f32_16x16x32_bf16 v[212:215], a[224:227], a[216:219], v[212:215]
    ds_read_b128 a[76:79], v42 offset:12288
    ds_read_b32 a92, v14
    v_mfma_f32_16x16x32_bf16 v[216:219], a[200:203], a[232:235], v[216:219]
    ds_read_b32 a86, v15
    v_perm_b32 v56, v120, v35, s39
    v_mfma_f32_16x16x32_bf16 v[216:219], a[224:227], a[252:255], v[216:219]
    s_waitcnt vmcnt(5)
    ds_read_b128 a[108:111], v43 offset:12288
    v_mfma_f32_16x16x32_bf16 v[220:223], a[200:203], a[0:3], v[220:223]
    s_mov_b32 s43, 69632
    ds_read_b32 a87, v56
    v_perm_b32 v57, v124, v35, s36
    v_mfma_f32_16x16x32_bf16 v[220:223], a[224:227], a[176:179], v[220:223]
    s_waitcnt lgkmcnt(8)
    buffer_load_dwordx3 v[76:78], v33, s[12:15], s43 offen sc1
    v_perm_b32 v58, v93, v35, s37
    v_mfma_f32_16x16x32_bf16 v[224:227], a[248:251], a[88:91], v[224:227]
    ds_read_b32 a4, v57
    v_perm_b32 v59, v124, v35, s37
    v_mfma_f32_16x16x32_bf16 v[224:227], a[56:59], a[96:99], v[224:227]
    ds_read_b32 a93, v58
    v_mfma_f32_16x16x32_bf16 v[228:231], a[248:251], a[100:103], v[228:231]
    s_mov_b32 s44, 81920
    ds_read_b32 a5, v59
    v_perm_b32 v60, v124, v35, s38
    v_mfma_f32_16x16x32_bf16 v[228:231], a[56:59], a[112:115], v[228:231]
    buffer_load_dwordx3 v[80:82], v32, s[12:15], s44 offen sc1
    v_mfma_f32_16x16x32_bf16 v[232:235], a[248:251], a[116:119], v[232:235]
    ds_read_b32 a6, v60
    v_perm_b32 v62, v124, v35, s39
    v_mfma_f32_16x16x32_bf16 v[232:235], a[56:59], a[124:127], v[232:235]
    buffer_load_dword v83, v34, s[12:15], s44 offen sc1
    v_perm_b32 v61, v93, v35, s38
    v_mfma_f32_16x16x32_bf16 v[236:239], a[248:251], a[132:135], v[236:239]
    ds_read_b32 a7, v62
    v_perm_b32 v63, v121, v35, s36
    v_mfma_f32_16x16x32_bf16 v[236:239], a[56:59], a[144:147], v[236:239]
    ds_read_b32 a94, v61
    v_mfma_f32_16x16x32_bf16 v[240:243], a[248:251], a[156:159], v[240:243]
    ds_read_b32 a12, v63
    v_perm_b32 v8, v121, v35, s37
    v_mfma_f32_16x16x32_bf16 v[240:243], a[56:59], a[188:191], v[240:243]
    buffer_load_dwordx4 v[48:51], v22, s[32:35], 0 offen
    v_mfma_f32_16x16x32_bf16 v[244:247], a[248:251], a[160:163], v[244:247]
    s_mov_b32 s45, 86016
    ds_read_b32 a13, v8
    v_perm_b32 v9, v121, v35, s38
    v_mfma_f32_16x16x32_bf16 v[244:247], a[56:59], a[216:219], v[244:247]
    buffer_load_dwordx3 v[84:86], v32, s[12:15], s45 offen sc1
    v_perm_b32 v10, v93, v35, s39
    v_mfma_f32_16x16x32_bf16 v[248:251], a[248:251], a[232:235], v[248:251]
    ds_read_b32 a14, v9
    v_perm_b32 v11, v121, v35, s39
    v_mfma_f32_16x16x32_bf16 v[248:251], a[56:59], a[252:255], v[248:251]
    ds_read_b32 a95, v10
    v_mfma_f32_16x16x32_bf16 v[252:255], a[248:251], a[0:3], v[252:255]
    ds_read_b32 a15, v11
    v_perm_b32 v12, v125, v35, s36
    v_mfma_f32_16x16x32_bf16 v[252:255], a[56:59], a[176:179], v[252:255]
    s_waitcnt lgkmcnt(6)
    s_barrier
    buffer_load_dword v87, v34, s[12:15], s45 offen sc1
    v_mfma_f32_16x16x32_bf16 v[128:131], a[84:87], a[184:187], v[128:131]
    ds_read_b32 a16, v12
    v_perm_b32 v13, v125, v35, s37
    v_mfma_f32_16x16x32_bf16 v[128:131], a[4:7], a[192:195], v[128:131]
    ds_read_b128 a[24:27], v40 offset:32768
    v_perm_b32 v14, v105, v35, s36
    v_mfma_f32_16x16x32_bf16 v[132:135], a[84:87], a[196:199], v[132:135]
    ds_read_b32 a17, v13
    v_perm_b32 v15, v125, v35, s38
    v_mfma_f32_16x16x32_bf16 v[132:135], a[4:7], a[208:211], v[132:135]
    s_add_u32 s56, s55, 1536
    ds_read_b128 a[28:31], v41 offset:32768
    ds_read_b32 a40, v14
    v_mfma_f32_16x16x32_bf16 v[136:139], a[84:87], a[212:215], v[136:139]
    s_add_u32 m0, s57, 0
    ds_read_b32 a18, v15
    v_perm_b32 v56, v125, v35, s39
    v_mfma_f32_16x16x32_bf16 v[136:139], a[4:7], a[220:223], v[136:139]
    buffer_load_dwordx4 v36, s[8:11], s56 offen offset:0 lds
    v_mfma_f32_16x16x32_bf16 v[140:143], a[84:87], a[228:231], v[140:143]
    ds_read_b32 a19, v56
    v_perm_b32 v57, v122, v35, s36
    v_mfma_f32_16x16x32_bf16 v[140:143], a[4:7], a[240:243], v[140:143]
    ds_read_b128 a[44:47], v40 offset:34816
    v_perm_b32 v58, v105, v35, s37
    v_mfma_f32_16x16x32_bf16 v[144:147], a[84:87], a[32:35], v[144:147]
    ds_read_b32 a52, v57
    v_perm_b32 v59, v122, v35, s37
    v_mfma_f32_16x16x32_bf16 v[144:147], a[4:7], a[36:39], v[144:147]
    ds_read_b128 a[60:63], v41 offset:34816
    ds_read_b32 a41, v58
    v_mfma_f32_16x16x32_bf16 v[148:151], a[84:87], a[48:51], v[148:151]
    ds_read_b32 a53, v59
    v_perm_b32 v60, v122, v35, s38
    v_mfma_f32_16x16x32_bf16 v[148:151], a[4:7], a[136:139], v[148:151]
    buffer_load_dwordx4 v37, s[8:11], s56 offen offset:1024 lds
    v_mfma_f32_16x16x32_bf16 v[152:155], a[84:87], a[168:171], v[152:155]
    ds_read_b32 a54, v60
    v_perm_b32 v62, v122, v35, s39
    v_mfma_f32_16x16x32_bf16 v[152:155], a[4:7], a[172:175], v[152:155]
    ds_read_b128 a[120:123], v40 offset:36864
    v_perm_b32 v61, v105, v35, s38
    v_mfma_f32_16x16x32_bf16 v[156:159], a[84:87], a[76:79], v[156:159]
    ds_read_b32 a55, v62
    v_perm_b32 v63, v126, v35, s36
    v_mfma_f32_16x16x32_bf16 v[156:159], a[4:7], a[108:111], v[156:159]
    s_waitcnt lgkmcnt(8)
    ds_read_b128 a[72:75], v41 offset:36864
    ds_read_b32 a42, v61
    v_mfma_f32_16x16x32_bf16 v[160:163], a[12:15], a[184:187], v[160:163]
    ds_read_b32 a152, v63
    v_perm_b32 v8, v126, v35, s37
    v_mfma_f32_16x16x32_bf16 v[160:163], a[16:19], a[192:195], v[160:163]
    buffer_load_dwordx4 v38, s[8:11], s56 offen offset:2048 lds
    v_mfma_f32_16x16x32_bf16 v[164:167], a[12:15], a[196:199], v[164:167]
    ds_read_b32 a153, v8
    v_perm_b32 v9, v126, v35, s38
    v_mfma_f32_16x16x32_bf16 v[164:167], a[16:19], a[208:211], v[164:167]
    ds_read_b128 a[104:107], v40 offset:38912
    v_perm_b32 v10, v105, v35, s39
    v_mfma_f32_16x16x32_bf16 v[168:171], a[12:15], a[212:215], v[168:171]
    ds_read_b32 a154, v9
    v_perm_b32 v11, v126, v35, s39
    v_mfma_f32_16x16x32_bf16 v[168:171], a[16:19], a[220:223], v[168:171]
    ds_read_b128 a[164:167], v41 offset:38912
    ds_read_b32 a43, v10
    v_mfma_f32_16x16x32_bf16 v[172:175], a[12:15], a[228:231], v[172:175]
    s_waitcnt vmcnt(13)
    ds_read_b32 a155, v11
    v_perm_b32 v12, v64, v35, s36
    v_mfma_f32_16x16x32_bf16 v[172:175], a[16:19], a[240:243], v[172:175]
    buffer_load_dwordx4 v39, s[8:11], s56 offen offset:3072 lds
    v_mfma_f32_16x16x32_bf16 v[176:179], a[12:15], a[32:35], v[176:179]
    ds_read_b32 a128, v12
    v_perm_b32 v13, v64, v35, s37
    v_mfma_f32_16x16x32_bf16 v[176:179], a[16:19], a[36:39], v[176:179]
    ds_read_b128 a[148:151], v40 offset:40960
    v_perm_b32 v14, v117, v35, s36
    v_mfma_f32_16x16x32_bf16 v[180:183], a[12:15], a[48:51], v[180:183]
    ds_read_b32 a129, v13
    v_perm_b32 v15, v64, v35, s38
    v_mfma_f32_16x16x32_bf16 v[180:183], a[16:19], a[136:139], v[180:183]
    s_add_u32 s56, s55, 1664
    ds_read_b128 a[204:207], v41 offset:40960
    ds_read_b32 a64, v14
    v_mfma_f32_16x16x32_bf16 v[184:187], a[12:15], a[168:171], v[184:187]
    s_add_u32 m0, s57, 18432
    ds_read_b32 a130, v15
    v_perm_b32 v56, v64, v35, s39
    v_mfma_f32_16x16x32_bf16 v[184:187], a[16:19], a[172:175], v[184:187]
    buffer_load_dwordx4 v36, s[8:11], s56 offen offset:0 lds
    v_mfma_f32_16x16x32_bf16 v[188:191], a[12:15], a[76:79], v[188:191]
    s_waitcnt vmcnt(13)
    ds_read_b32 a131, v56
    v_perm_b32 v57, v68, v35, s36
    v_mfma_f32_16x16x32_bf16 v[188:191], a[16:19], a[108:111], v[188:191]
    s_waitcnt lgkmcnt(7)
    ds_read_b128 a[180:183], v40 offset:43008
    v_perm_b32 v58, v117, v35, s37
    v_mfma_f32_16x16x32_bf16 v[192:195], a[52:55], a[184:187], v[192:195]
    ds_read_b32 a200, v57
    v_perm_b32 v59, v68, v35, s37
    v_mfma_f32_16x16x32_bf16 v[192:195], a[152:155], a[192:195], v[192:195]
    ds_read_b128 a[224:227], v41 offset:43008
    ds_read_b32 a65, v58
    v_mfma_f32_16x16x32_bf16 v[196:199], a[52:55], a[196:199], v[196:199]
    ds_read_b32 a201, v59
    v_perm_b32 v60, v68, v35, s38
    v_mfma_f32_16x16x32_bf16 v[196:199], a[152:155], a[208:211], v[196:199]
    buffer_load_dwordx4 v37, s[8:11], s56 offen offset:1024 lds
    v_mfma_f32_16x16x32_bf16 v[200:203], a[52:55], a[212:215], v[200:203]
    ds_read_b32 a202, v60
    v_perm_b32 v62, v68, v35, s39
    v_mfma_f32_16x16x32_bf16 v[200:203], a[152:155], a[220:223], v[200:203]
    ds_read_b128 a[88:91], v40 offset:45056
    v_perm_b32 v61, v117, v35, s38
    v_mfma_f32_16x16x32_bf16 v[204:207], a[52:55], a[228:231], v[204:207]
    ds_read_b32 a203, v62
    v_perm_b32 v63, v65, v35, s36
    v_mfma_f32_16x16x32_bf16 v[204:207], a[152:155], a[240:243], v[204:207]
    ds_read_b128 a[96:99], v41 offset:45056
    ds_read_b32 a66, v61
    v_mfma_f32_16x16x32_bf16 v[208:211], a[52:55], a[32:35], v[208:211]
    s_add_u32 m0, s57, 14336
    ds_read_b32 a100, v63
    v_perm_b32 v8, v65, v35, s37
    v_mfma_f32_16x16x32_bf16 v[208:211], a[152:155], a[36:39], v[208:211]
    buffer_load_dwordx4 v38, s[8:11], s56 offen offset:2048 lds
    v_mfma_f32_16x16x32_bf16 v[212:215], a[52:55], a[48:51], v[212:215]
    ds_read_b32 a101, v8
    v_perm_b32 v9, v65, v35, s38
    v_mfma_f32_16x16x32_bf16 v[212:215], a[152:155], a[136:139], v[212:215]
    ds_read_b128 a[112:115], v40 offset:47104
    v_perm_b32 v10, v117, v35, s39
    v_mfma_f32_16x16x32_bf16 v[216:219], a[52:55], a[168:171], v[216:219]
    ds_read_b32 a102, v9
    v_perm_b32 v11, v65, v35, s39
    v_mfma_f32_16x16x32_bf16 v[216:219], a[152:155], a[172:175], v[216:219]
    ds_read_b128 a[116:119], v41 offset:47104
    ds_read_b32 a67, v10
    v_mfma_f32_16x16x32_bf16 v[220:223], a[52:55], a[76:79], v[220:223]
    ds_read_b32 a103, v11
    v_perm_b32 v12, v69, v35, s36
    v_mfma_f32_16x16x32_bf16 v[220:223], a[152:155], a[108:111], v[220:223]
    s_waitcnt lgkmcnt(9)
    buffer_load_dwordx4 v39, s[8:11], s56 offen offset:3072 lds
    v_mfma_f32_16x16x32_bf16 v[128:131], a[128:131], a[24:27], v[128:131]
    ds_read_b32 a124, v12
    v_perm_b32 v13, v69, v35, s37
    v_mfma_f32_16x16x32_bf16 v[128:131], a[200:203], a[28:31], v[128:131]
    ds_read_b128 a[132:135], v42 offset:34816
    v_perm_b32 v14, v90, v35, s36
    v_mfma_f32_16x16x32_bf16 v[132:135], a[128:131], a[44:47], v[132:135]
    ds_read_b32 a125, v13
    v_perm_b32 v15, v69, v35, s38
    v_mfma_f32_16x16x32_bf16 v[132:135], a[200:203], a[60:63], v[132:135]
    ds_read_b128 a[144:147], v43 offset:34816
    ds_read_b32 a156, v14
    v_mfma_f32_16x16x32_bf16 v[136:139], a[128:131], a[120:123], v[136:139]
    s_mov_b32 s46, 114688
    ds_read_b32 a126, v15
    v_perm_b32 v56, v69, v35, s39
    v_mfma_f32_16x16x32_bf16 v[136:139], a[200:203], a[72:75], v[136:139]
    buffer_load_dwordx3 v[96:98], v32, s[12:15], s46 offen sc1
    v_mfma_f32_16x16x32_bf16 v[140:143], a[128:131], a[104:107], v[140:143]
    ds_read_b32 a127, v56
    v_perm_b32 v57, v66, v35, s36
    v_mfma_f32_16x16x32_bf16 v[140:143], a[200:203], a[164:167], v[140:143]
    ds_read_b128 a[188:191], v42 offset:32768
    v_perm_b32 v58, v90, v35, s37
    v_mfma_f32_16x16x32_bf16 v[144:147], a[128:131], a[148:151], v[144:147]
    ds_read_b32 a160, v57
    v_perm_b32 v59, v66, v35, s37
    v_mfma_f32_16x16x32_bf16 v[144:147], a[200:203], a[204:207], v[144:147]
    ds_read_b128 a[216:219], v43 offset:32768
    ds_read_b32 a157, v58
    v_mfma_f32_16x16x32_bf16 v[148:151], a[128:131], a[180:183], v[148:151]
    ds_read_b32 a161, v59
    v_perm_b32 v60, v66, v35, s38
    v_mfma_f32_16x16x32_bf16 v[148:151], a[200:203], a[224:227], v[148:151]
    buffer_load_dword v99, v34, s[12:15], s46 offen sc1
    v_mfma_f32_16x16x32_bf16 v[152:155], a[128:131], a[88:91], v[152:155]
    s_waitcnt lgkmcnt(7)
    ds_read_b32 a162, v60
    v_perm_b32 v62, v66, v35, s39
    v_mfma_f32_16x16x32_bf16 v[152:155], a[200:203], a[96:99], v[152:155]
    ds_read_b128 a[232:235], v42 offset:38912
    v_perm_b32 v61, v90, v35, s38
    v_mfma_f32_16x16x32_bf16 v[156:159], a[128:131], a[112:115], v[156:159]
    ds_read_b32 a163, v62
    v_perm_b32 v63, v70, v35, s36
    v_mfma_f32_16x16x32_bf16 v[156:159], a[200:203], a[116:119], v[156:159]
    s_waitcnt lgkmcnt(8)
    ds_read_b128 a[252:255], v43 offset:38912
    ds_read_b32 a158, v61
    v_mfma_f32_16x16x32_bf16 v[160:163], a[100:103], a[24:27], v[160:163]
    s_mov_b32 s47, 118784
    ds_read_b32 a0, v63
    v_perm_b32 v8, v70, v35, s37
    v_mfma_f32_16x16x32_bf16 v[160:163], a[124:127], a[28:31], v[160:163]
    buffer_load_dwordx3 v[100:102], v32, s[12:15], s47 offen sc1
    v_mfma_f32_16x16x32_bf16 v[164:167], a[100:103], a[44:47], v[164:167]
    ds_read_b32 a1, v8
    v_perm_b32 v9, v70, v35, s38
    v_mfma_f32_16x16x32_bf16 v[164:167], a[124:127], a[60:63], v[164:167]
    ds_read_b128 a[248:251], v42 offset:36864
    v_perm_b32 v10, v90, v35, s39
    v_mfma_f32_16x16x32_bf16 v[168:171], a[100:103], a[120:123], v[168:171]
    ds_read_b32 a2, v9
    v_perm_b32 v11, v70, v35, s39
    v_mfma_f32_16x16x32_bf16 v[168:171], a[124:127], a[72:75], v[168:171]
    ds_read_b128 a[176:179], v43 offset:36864
    ds_read_b32 a159, v10
    v_mfma_f32_16x16x32_bf16 v[172:175], a[100:103], a[104:107], v[172:175]
    ds_read_b32 a3, v11
    v_perm_b32 v12, v67, v35, s36
    v_mfma_f32_16x16x32_bf16 v[172:175], a[124:127], a[164:167], v[172:175]
    buffer_load_dword v103, v34, s[12:15], s47 offen sc1
    v_mfma_f32_16x16x32_bf16 v[176:179], a[100:103], a[148:151], v[176:179]
    ds_read_b32 a56, v12
    v_perm_b32 v13, v67, v35, s37
    v_mfma_f32_16x16x32_bf16 v[176:179], a[124:127], a[204:207], v[176:179]
    ds_read_b128 a[84:87], v42 offset:43008
    v_perm_b32 v14, v94, v35, s36
    v_mfma_f32_16x16x32_bf16 v[180:183], a[100:103], a[180:183], v[180:183]
    ds_read_b32 a57, v13
    v_perm_b32 v15, v67, v35, s38
    v_mfma_f32_16x16x32_bf16 v[180:183], a[124:127], a[224:227], v[180:183]
    ds_read_b128 a[4:7], v43 offset:43008
    ds_read_b32 a12, v14
    v_mfma_f32_16x16x32_bf16 v[184:187], a[100:103], a[88:91], v[184:187]
    s_mov_b32 s40, 81920
    ds_read_b32 a58, v15
    v_perm_b32 v56, v67, v35, s39
    v_mfma_f32_16x16x32_bf16 v[184:187], a[124:127], a[96:99], v[184:187]
    buffer_load_dwordx3 v[108:110], v33, s[12:15], s40 offen sc1
    v_mfma_f32_16x16x32_bf16 v[188:191], a[100:103], a[112:115], v[188:191]
    s_waitcnt vmcnt(20)
    ds_read_b32 a59, v56
    v_perm_b32 v57, v71, v35, s36
    v_mfma_f32_16x16x32_bf16 v[188:191], a[124:127], a[116:119], v[188:191]
    s_waitcnt lgkmcnt(7)
    ds_read_b128 a[16:19], v42 offset:40960
    v_perm_b32 v58, v94, v35, s37
    v_mfma_f32_16x16x32_bf16 v[192:195], a[160:163], a[24:27], v[192:195]
    ds_read_b32 a184, v57
    v_perm_b32 v59, v71, v35, s37
    v_mfma_f32_16x16x32_bf16 v[192:195], a[0:3], a[28:31], v[192:195]
    ds_read_b128 a[192:195], v43 offset:40960
    ds_read_b32 a13, v58
    v_mfma_f32_16x16x32_bf16 v[196:199], a[160:163], a[44:47], v[196:199]
    s_mov_b32 s41, 86016
    ds_read_b32 a185, v59
    v_perm_b32 v60, v71, v35, s38
    v_mfma_f32_16x16x32_bf16 v[196:199], a[0:3], a[60:63], v[196:199]
    buffer_load_dwordx3 v[112:114], v33, s[12:15], s41 offen sc1
    v_mfma_f32_16x16x32_bf16 v[200:203], a[160:163], a[120:123], v[200:203]
    ds_read_b32 a186, v60
    v_perm_b32 v62, v71, v35, s39
    v_mfma_f32_16x16x32_bf16 v[200:203], a[0:3], a[72:75], v[200:203]
    ds_read_b128 a[196:199], v42 offset:47104
    v_perm_b32 v61, v94, v35, s38
    v_mfma_f32_16x16x32_bf16 v[204:207], a[160:163], a[104:107], v[204:207]
    s_waitcnt vmcnt(20)
    ds_read_b32 a187, v62
    v_perm_b32 v63, v72, v35, s36
    v_mfma_f32_16x16x32_bf16 v[204:207], a[0:3], a[164:167], v[204:207]
    ds_read_b128 a[208:211], v43 offset:47104
    ds_read_b32 a14, v61
    v_mfma_f32_16x16x32_bf16 v[208:211], a[160:163], a[148:151], v[208:211]
    ds_read_b32 a212, v63
    v_perm_b32 v8, v72, v35, s37
    v_mfma_f32_16x16x32_bf16 v[208:211], a[0:3], a[204:207], v[208:211]
    buffer_load_dwordx2 v[52:53], v22, s[32:35], 0 offen offset:16
    v_perm_b32 v9, v94, v35, s39
    v_mfma_f32_16x16x32_bf16 v[212:215], a[160:163], a[180:183], v[212:215]
    ds_read_b32 a213, v8
    v_perm_b32 v10, v72, v35, s38
    v_mfma_f32_16x16x32_bf16 v[212:215], a[0:3], a[224:227], v[212:215]
    ds_read_b128 a[220:223], v42 offset:45056
    ds_read_b32 a15, v9
    v_mfma_f32_16x16x32_bf16 v[216:219], a[160:163], a[88:91], v[216:219]
    ds_read_b32 a214, v10
    v_perm_b32 v11, v72, v35, s39
    v_mfma_f32_16x16x32_bf16 v[216:219], a[0:3], a[96:99], v[216:219]
    s_waitcnt vmcnt(20)
    ds_read_b128 a[228:231], v43 offset:45056
    v_mfma_f32_16x16x32_bf16 v[220:223], a[160:163], a[112:115], v[220:223]
    s_mov_b32 s42, 114688
    ds_read_b32 a215, v11
    v_perm_b32 v12, v76, v35, s36
    v_mfma_f32_16x16x32_bf16 v[220:223], a[0:3], a[116:119], v[220:223]
    s_waitcnt lgkmcnt(9)
    buffer_load_dwordx3 v[120:122], v33, s[12:15], s42 offen sc1
    v_perm_b32 v13, v106, v35, s36
    v_mfma_f32_16x16x32_bf16 v[224:227], a[56:59], a[24:27], v[224:227]
    ds_read_b32 a240, v12
    v_perm_b32 v14, v76, v35, s37
    v_mfma_f32_16x16x32_bf16 v[224:227], a[184:187], a[28:31], v[224:227]
    ds_read_b32 a32, v13
    v_mfma_f32_16x16x32_bf16 v[228:231], a[56:59], a[44:47], v[228:231]
    s_mov_b32 s43, 98304
    ds_read_b32 a241, v14
    v_perm_b32 v15, v76, v35, s38
    v_mfma_f32_16x16x32_bf16 v[228:231], a[184:187], a[60:63], v[228:231]
    buffer_load_dwordx3 v[124:126], v32, s[12:15], s43 offen sc1
    v_mfma_f32_16x16x32_bf16 v[232:235], a[56:59], a[120:123], v[232:235]
    ds_read_b32 a242, v15
    v_perm_b32 v56, v76, v35, s39
    v_mfma_f32_16x16x32_bf16 v[232:235], a[184:187], a[72:75], v[232:235]
    buffer_load_dword v127, v34, s[12:15], s43 offen sc1
    v_perm_b32 v57, v106, v35, s37
    v_mfma_f32_16x16x32_bf16 v[236:239], a[56:59], a[104:107], v[236:239]
    ds_read_b32 a243, v56
    v_perm_b32 v58, v73, v35, s36
    v_mfma_f32_16x16x32_bf16 v[236:239], a[184:187], a[164:167], v[236:239]
    ds_read_b32 a33, v57
    v_mfma_f32_16x16x32_bf16 v[240:243], a[56:59], a[148:151], v[240:243]
    ds_read_b32 a36, v58
    v_perm_b32 v59, v73, v35, s37
    v_mfma_f32_16x16x32_bf16 v[240:243], a[184:187], a[204:207], v[240:243]
    buffer_load_dwordx2 v[54:55], v23, s[32:35], 0 offen
    v_mfma_f32_16x16x32_bf16 v[244:247], a[56:59], a[180:183], v[244:247]
    s_mov_b32 s44, 102400
    ds_read_b32 a37, v59
    v_perm_b32 v60, v73, v35, s38
    v_mfma_f32_16x16x32_bf16 v[244:247], a[184:187], a[224:227], v[244:247]
    buffer_load_dwordx3 v[88:90], v32, s[12:15], s44 offen sc1
    v_perm_b32 v62, v106, v35, s38
    v_mfma_f32_16x16x32_bf16 v[248:251], a[56:59], a[88:91], v[248:251]
    ds_read_b32 a38, v60
    v_perm_b32 v61, v73, v35, s39
    v_mfma_f32_16x16x32_bf16 v[248:251], a[184:187], a[96:99], v[248:251]
    ds_read_b32 a34, v62
    v_mfma_f32_16x16x32_bf16 v[252:255], a[56:59], a[112:115], v[252:255]
    ds_read_b32 a39, v61
    v_perm_b32 v63, v77, v35, s36
    v_mfma_f32_16x16x32_bf16 v[252:255], a[184:187], a[116:119], v[252:255]
    s_waitcnt lgkmcnt(6)
    s_barrier
    buffer_load_dword v91, v34, s[12:15], s44 offen sc1
    v_mfma_f32_16x16x32_bf16 v[128:131], a[212:215], a[132:135], v[128:131]
    ds_read_b32 a48, v63
    v_perm_b32 v8, v77, v35, s37
    v_mfma_f32_16x16x32_bf16 v[128:131], a[240:243], a[144:147], v[128:131]
    ds_read_b128 a[136:139], v44 offset:0
    v_perm_b32 v9, v106, v35, s39
    v_mfma_f32_16x16x32_bf16 v[132:135], a[212:215], a[188:191], v[132:135]
    ds_read_b32 a49, v8
    v_perm_b32 v10, v77, v35, s38
    v_mfma_f32_16x16x32_bf16 v[132:135], a[240:243], a[216:219], v[132:135]
    s_add_u32 s56, s55, 768
    ds_read_b128 a[168:171], v45 offset:0
    ds_read_b32 a35, v9
    v_mfma_f32_16x16x32_bf16 v[136:139], a[212:215], a[232:235], v[136:139]
    s_add_u32 m0, s57, 32768
    ds_read_b32 a50, v10
    v_perm_b32 v11, v77, v35, s39
    v_mfma_f32_16x16x32_bf16 v[136:139], a[240:243], a[252:255], v[136:139]
    buffer_load_dwordx4 v36, s[8:11], s56 offen offset:0 lds
    v_mfma_f32_16x16x32_bf16 v[140:143], a[212:215], a[248:251], v[140:143]
    ds_read_b32 a51, v11
    v_perm_b32 v12, v74, v35, s36
    v_mfma_f32_16x16x32_bf16 v[140:143], a[240:243], a[176:179], v[140:143]
    ds_read_b128 a[172:175], v44 offset:2048
    v_perm_b32 v13, v118, v35, s36
    v_mfma_f32_16x16x32_bf16 v[144:147], a[212:215], a[84:87], v[144:147]
    ds_read_b32 a76, v12
    v_perm_b32 v14, v74, v35, s37
    v_mfma_f32_16x16x32_bf16 v[144:147], a[240:243], a[4:7], v[144:147]
    ds_read_b128 a[52:55], v45 offset:2048
    ds_read_b32 a108, v13
    v_mfma_f32_16x16x32_bf16 v[148:151], a[212:215], a[16:19], v[148:151]
    ds_read_b32 a77, v14
    v_perm_b32 v15, v74, v35, s38
    v_mfma_f32_16x16x32_bf16 v[148:151], a[240:243], a[192:195], v[148:151]
    buffer_load_dwordx4 v37, s[8:11], s56 offen offset:1024 lds
    v_mfma_f32_16x16x32_bf16 v[152:155], a[212:215], a[196:199], v[152:155]
    ds_read_b32 a78, v15
    v_perm_b32 v56, v74, v35, s39
    v_mfma_f32_16x16x32_bf16 v[152:155], a[240:243], a[208:211], v[152:155]
    ds_read_b128 a[152:155], v44 offset:4096
    v_perm_b32 v57, v118, v35, s37
    v_mfma_f32_16x16x32_bf16 v[156:159], a[212:215], a[220:223], v[156:159]
    ds_read_b32 a79, v56
    v_perm_b32 v58, v78, v35, s36
    v_mfma_f32_16x16x32_bf16 v[156:159], a[240:243], a[228:231], v[156:159]
    s_waitcnt lgkmcnt(8)
    ds_read_b128 a[128:131], v45 offset:4096
    ds_read_b32 a109, v57
    v_mfma_f32_16x16x32_bf16 v[160:163], a[36:39], a[132:135], v[160:163]
    ds_read_b32 a200, v58
    v_perm_b32 v59, v78, v35, s37
    v_mfma_f32_16x16x32_bf16 v[160:163], a[48:51], a[144:147], v[160:163]
    buffer_load_dwordx4 v38, s[8:11], s56 offen offset:2048 lds
    v_mfma_f32_16x16x32_bf16 v[164:167], a[36:39], a[188:191], v[164:167]
    ds_read_b32 a201, v59
    v_perm_b32 v60, v78, v35, s38
    v_mfma_f32_16x16x32_bf16 v[164:167], a[48:51], a[216:219], v[164:167]
    ds_read_b128 a[100:103], v44 offset:6144
    v_perm_b32 v62, v118, v35, s38
    v_mfma_f32_16x16x32_bf16 v[168:171], a[36:39], a[232:235], v[168:171]
    ds_read_b32 a202, v60
    v_perm_b32 v61, v78, v35, s39
    v_mfma_f32_16x16x32_bf16 v[168:171], a[48:51], a[252:255], v[168:171]
    ds_read_b128 a[124:127], v45 offset:6144
    ds_read_b32 a110, v62
    v_mfma_f32_16x16x32_bf16 v[172:175], a[36:39], a[248:251], v[172:175]
    s_waitcnt vmcnt(28)
    ds_read_b32 a203, v61
    v_perm_b32 v63, v80, v35, s36
    v_mfma_f32_16x16x32_bf16 v[172:175], a[48:51], a[176:179], v[172:175]
    buffer_load_dwordx4 v39, s[8:11], s56 offen offset:3072 lds
    v_mfma_f32_16x16x32_bf16 v[176:179], a[36:39], a[84:87], v[176:179]
    ds_read_b32 a160, v63
    v_perm_b32 v8, v80, v35, s37
    v_mfma_f32_16x16x32_bf16 v[176:179], a[48:51], a[4:7], v[176:179]
    ds_read_b128 a[0:3], v44 offset:8192
    v_perm_b32 v9, v118, v35, s39
    v_mfma_f32_16x16x32_bf16 v[180:183], a[36:39], a[16:19], v[180:183]
    ds_read_b32 a161, v8
    v_perm_b32 v10, v80, v35, s38
    v_mfma_f32_16x16x32_bf16 v[180:183], a[48:51], a[192:195], v[180:183]
    s_add_u32 s56, s55, 896
    ds_read_b128 a[24:27], v45 offset:8192
    ds_read_b32 a111, v9
    v_mfma_f32_16x16x32_bf16 v[184:187], a[36:39], a[196:199], v[184:187]
    s_add_u32 m0, s57, 51200
    ds_read_b32 a162, v10
    v_perm_b32 v11, v80, v35, s39
    v_mfma_f32_16x16x32_bf16 v[184:187], a[48:51], a[208:211], v[184:187]
    buffer_load_dwordx4 v36, s[8:11], s56 offen offset:0 lds
    v_mfma_f32_16x16x32_bf16 v[188:191], a[36:39], a[220:223], v[188:191]
    s_waitcnt vmcnt(27)
    ds_read_b32 a163, v11
    v_perm_b32 v12, v84, v35, s36
    v_mfma_f32_16x16x32_bf16 v[188:191], a[48:51], a[228:231], v[188:191]
    s_waitcnt vmcnt(16) lgkmcnt(7)
    ds_read_b128 a[28:31], v44 offset:10240
    v_perm_b32 v13, v99, v35, s36
    v_mfma_f32_16x16x32_bf16 v[192:195], a[76:79], a[132:135], v[192:195]
    ds_read_b32 a44, v12
    v_perm_b32 v14, v84, v35, s37
    v_mfma_f32_16x16x32_bf16 v[192:195], a[200:203], a[144:147], v[192:195]
    ds_read_b128 a[60:63], v45 offset:10240
    ds_read_b32 a120, v13
    v_mfma_f32_16x16x32_bf16 v[196:199], a[76:79], a[188:191], v[196:199]
    ds_read_b32 a45, v14
    v_perm_b32 v15, v84, v35, s38
    v_mfma_f32_16x16x32_bf16 v[196:199], a[200:203], a[216:219], v[196:199]
    buffer_load_dwordx4 v37, s[8:11], s56 offen offset:1024 lds
    v_mfma_f32_16x16x32_bf16 v[200:203], a[76:79], a[232:235], v[200:203]
    ds_read_b32 a46, v15
    v_perm_b32 v56, v84, v35, s39
    v_mfma_f32_16x16x32_bf16 v[200:203], a[200:203], a[252:255], v[200:203]
    ds_read_b128 a[72:75], v44 offset:12288
    v_perm_b32 v57, v99, v35, s37
    v_mfma_f32_16x16x32_bf16 v[204:207], a[76:79], a[248:251], v[204:207]
    ds_read_b32 a47, v56
    v_perm_b32 v58, v81, v35, s36
    v_mfma_f32_16x16x32_bf16 v[204:207], a[200:203], a[176:179], v[204:207]
    ds_read_b128 a[104:107], v45 offset:12288
    ds_read_b32 a121, v57
    v_mfma_f32_16x16x32_bf16 v[208:211], a[76:79], a[84:87], v[208:211]
    s_add_u32 m0, s57, 47104
    ds_read_b32 a164, v58
    v_perm_b32 v59, v81, v35, s37
    v_mfma_f32_16x16x32_bf16 v[208:211], a[200:203], a[4:7], v[208:211]
    buffer_load_dwordx4 v38, s[8:11], s56 offen offset:2048 lds
    v_mfma_f32_16x16x32_bf16 v[212:215], a[76:79], a[16:19], v[212:215]
    ds_read_b32 a165, v59
    v_perm_b32 v60, v81, v35, s38
    v_mfma_f32_16x16x32_bf16 v[212:215], a[200:203], a[192:195], v[212:215]
    ds_read_b128 a[148:151], v44 offset:14336
    v_perm_b32 v62, v99, v35, s38
    v_mfma_f32_16x16x32_bf16 v[216:219], a[76:79], a[196:199], v[216:219]
    ds_read_b32 a166, v60
    v_perm_b32 v61, v81, v35, s39
    v_mfma_f32_16x16x32_bf16 v[216:219], a[200:203], a[208:211], v[216:219]
    ds_read_b128 a[204:207], v45 offset:14336
    ds_read_b32 a122, v62
    v_mfma_f32_16x16x32_bf16 v[220:223], a[76:79], a[220:223], v[220:223]
    ds_read_b32 a167, v61
    v_perm_b32 v63, v85, v35, s36
    v_mfma_f32_16x16x32_bf16 v[220:223], a[200:203], a[228:231], v[220:223]
    s_waitcnt lgkmcnt(9)
    buffer_load_dwordx4 v39, s[8:11], s56 offen offset:3072 lds
    v_mfma_f32_16x16x32_bf16 v[128:131], a[160:163], a[136:139], v[128:131]
    ds_read_b32 a180, v63
    v_perm_b32 v8, v85, v35, s37
    v_mfma_f32_16x16x32_bf16 v[128:131], a[44:47], a[168:171], v[128:131]
    ds_read_b128 a[224:227], v46 offset:2048
    v_perm_b32 v9, v99, v35, s39
    v_mfma_f32_16x16x32_bf16 v[132:135], a[160:163], a[172:175], v[132:135]
    ds_read_b32 a181, v8
    v_perm_b32 v10, v85, v35, s38
    v_mfma_f32_16x16x32_bf16 v[132:135], a[44:47], a[52:55], v[132:135]
    ds_read_b128 a[88:91], v47 offset:2048
    ds_read_b32 a123, v9
    v_mfma_f32_16x16x32_bf16 v[136:139], a[160:163], a[152:155], v[136:139]
    s_mov_b32 s45, 118784
    ds_read_b32 a182, v10
    v_perm_b32 v11, v85, v35, s39
    v_mfma_f32_16x16x32_bf16 v[136:139], a[44:47], a[128:131], v[136:139]
    buffer_load_dwordx3 v[64:66], v33, s[12:15], s45 offen sc1
    v_mfma_f32_16x16x32_bf16 v[140:143], a[160:163], a[100:103], v[140:143]
    ds_read_b32 a183, v11
    v_perm_b32 v12, v82, v35, s36
    v_mfma_f32_16x16x32_bf16 v[140:143], a[44:47], a[124:127], v[140:143]
    s_waitcnt vmcnt(18)
    ds_read_b128 a[96:99], v46 offset:0
    v_perm_b32 v13, v103, v35, s36
    v_mfma_f32_16x16x32_bf16 v[144:147], a[160:163], a[0:3], v[144:147]
    ds_read_b32 a112, v12
    v_perm_b32 v14, v82, v35, s37
    v_mfma_f32_16x16x32_bf16 v[144:147], a[44:47], a[24:27], v[144:147]
    ds_read_b128 a[56:59], v47 offset:0
    ds_read_b32 a116, v13
    v_mfma_f32_16x16x32_bf16 v[148:151], a[160:163], a[28:31], v[148:151]
    s_mov_b32 s46, 98304
    ds_read_b32 a113, v14
    v_perm_b32 v15, v82, v35, s38
    v_mfma_f32_16x16x32_bf16 v[148:151], a[44:47], a[60:63], v[148:151]
    buffer_load_dwordx3 v[68:70], v33, s[12:15], s46 offen sc1
    v_mfma_f32_16x16x32_bf16 v[152:155], a[160:163], a[72:75], v[152:155]
    s_waitcnt lgkmcnt(7)
    ds_read_b32 a114, v15
    v_perm_b32 v56, v82, v35, s39
    v_mfma_f32_16x16x32_bf16 v[152:155], a[44:47], a[104:107], v[152:155]
    ds_read_b128 a[184:187], v46 offset:6144
    v_perm_b32 v57, v103, v35, s37
    v_mfma_f32_16x16x32_bf16 v[156:159], a[160:163], a[148:151], v[156:159]
    ds_read_b32 a115, v56
    v_perm_b32 v58, v86, v35, s36
    v_mfma_f32_16x16x32_bf16 v[156:159], a[44:47], a[204:207], v[156:159]
    s_waitcnt lgkmcnt(8)
    ds_read_b128 a[212:215], v47 offset:6144
    ds_read_b32 a117, v57
    v_mfma_f32_16x16x32_bf16 v[160:163], a[164:167], a[136:139], v[160:163]
    s_mov_b32 s47, 102400
    ds_read_b32 a240, v58
    v_perm_b32 v59, v86, v35, s37
    v_mfma_f32_16x16x32_bf16 v[160:163], a[180:183], a[168:171], v[160:163]
    buffer_load_dwordx3 v[92:94], v33, s[12:15], s47 offen sc1
    v_mfma_f32_16x16x32_bf16 v[164:167], a[164:167], a[172:175], v[164:167]
    ds_read_b32 a241, v59
    v_perm_b32 v60, v86, v35, s38
    v_mfma_f32_16x16x32_bf16 v[164:167], a[180:183], a[52:55], v[164:167]
    ds_read_b128 a[36:39], v46 offset:4096
    v_perm_b32 v62, v103, v35, s38
    v_mfma_f32_16x16x32_bf16 v[168:171], a[164:167], a[152:155], v[168:171]
    ds_read_b32 a242, v60
    v_perm_b32 v61, v86, v35, s39
    v_mfma_f32_16x16x32_bf16 v[168:171], a[180:183], a[128:131], v[168:171]
    ds_read_b128 a[48:51], v47 offset:4096
    ds_read_b32 a118, v62
    v_mfma_f32_16x16x32_bf16 v[172:175], a[164:167], a[100:103], v[172:175]
    ds_read_b32 a243, v61
    v_perm_b32 v63, v83, v35, s36
    v_mfma_f32_16x16x32_bf16 v[172:175], a[180:183], a[124:127], v[172:175]
    v_mfma_f32_16x16x32_bf16 v[176:179], a[164:167], a[0:3], v[176:179]
    ds_read_b32 a132, v63
    v_perm_b32 v8, v83, v35, s37
    v_mfma_f32_16x16x32_bf16 v[176:179], a[180:183], a[24:27], v[176:179]
    ds_read_b128 a[144:147], v46 offset:10240
    v_perm_b32 v9, v103, v35, s39
    v_mfma_f32_16x16x32_bf16 v[180:183], a[164:167], a[28:31], v[180:183]
    ds_read_b32 a133, v8
    v_perm_b32 v10, v83, v35, s38
    v_mfma_f32_16x16x32_bf16 v[180:183], a[180:183], a[60:63], v[180:183]
    ds_read_b128 a[188:191], v47 offset:10240
    ds_read_b32 a119, v9
    v_mfma_f32_16x16x32_bf16 v[184:187], a[164:167], a[72:75], v[184:187]
    ds_read_b32 a134, v10
    v_perm_b32 v11, v83, v35, s39
    v_mfma_f32_16x16x32_bf16 v[184:187], a[180:183], a[104:107], v[184:187]
    v_mfma_f32_16x16x32_bf16 v[188:191], a[164:167], a[148:151], v[188:191]
    ds_read_b32 a135, v11
    v_perm_b32 v12, v87, v35, s36
    v_mfma_f32_16x16x32_bf16 v[188:191], a[180:183], a[204:207], v[188:191]
    s_waitcnt lgkmcnt(7)
    ds_read_b128 a[216:219], v46 offset:8192
    v_perm_b32 v13, v96, v35, s36
    v_mfma_f32_16x16x32_bf16 v[192:195], a[112:115], a[136:139], v[192:195]
    ds_read_b32 a232, v12
    v_perm_b32 v14, v87, v35, s37
    v_mfma_f32_16x16x32_bf16 v[192:195], a[240:243], a[168:171], v[192:195]
    ds_read_b128 a[252:255], v47 offset:8192
    ds_read_b32 a248, v13
    v_mfma_f32_16x16x32_bf16 v[196:199], a[112:115], a[172:175], v[196:199]
    ds_read_b32 a233, v14
    v_perm_b32 v15, v87, v35, s38
    v_mfma_f32_16x16x32_bf16 v[196:199], a[240:243], a[52:55], v[196:199]
    v_mfma_f32_16x16x32_bf16 v[200:203], a[112:115], a[152:155], v[200:203]
    ds_read_b32 a234, v15
    v_perm_b32 v56, v87, v35, s39
    v_mfma_f32_16x16x32_bf16 v[200:203], a[240:243], a[128:131], v[200:203]
    ds_read_b128 a[176:179], v46 offset:14336
    v_perm_b32 v57, v96, v35, s37
    v_mfma_f32_16x16x32_bf16 v[204:207], a[112:115], a[100:103], v[204:207]
    s_waitcnt vmcnt(19)
    ds_read_b32 a235, v56
    v_perm_b32 v58, v108, v35, s36
    v_mfma_f32_16x16x32_bf16 v[204:207], a[240:243], a[124:127], v[204:207]
    ds_read_b128 a[84:87], v47 offset:14336
    ds_read_b32 a249, v57
    v_mfma_f32_16x16x32_bf16 v[208:211], a[112:115], a[0:3], v[208:211]
    ds_read_b32 a4, v58
    v_perm_b32 v59, v108, v35, s37
    v_mfma_f32_16x16x32_bf16 v[208:211], a[240:243], a[24:27], v[208:211]
    v_mfma_f32_16x16x32_bf16 v[212:215], a[112:115], a[28:31], v[212:215]
    ds_read_b32 a5, v59
    v_perm_b32 v60, v108, v35, s38
    v_mfma_f32_16x16x32_bf16 v[212:215], a[240:243], a[60:63], v[212:215]
    ds_read_b128 a[16:19], v46 offset:12288
    v_perm_b32 v62, v96, v35, s38
    v_mfma_f32_16x16x32_bf16 v[216:219], a[112:115], a[72:75], v[216:219]
    ds_read_b32 a6, v60
    v_perm_b32 v61, v108, v35, s39
    v_mfma_f32_16x16x32_bf16 v[216:219], a[240:243], a[104:107], v[216:219]
    ds_read_b128 a[192:195], v47 offset:12288
    ds_read_b32 a250, v62
    v_mfma_f32_16x16x32_bf16 v[220:223], a[112:115], a[148:151], v[220:223]
    s_waitcnt vmcnt(18)
    ds_read_b32 a7, v61
    v_perm_b32 v63, v112, v35, s36
    v_mfma_f32_16x16x32_bf16 v[220:223], a[240:243], a[204:207], v[220:223]
    s_waitcnt lgkmcnt(9)
    v_mfma_f32_16x16x32_bf16 v[224:227], a[132:135], a[136:139], v[224:227]
    ds_read_b32 a196, v63
    v_perm_b32 v8, v112, v35, s37
    v_mfma_f32_16x16x32_bf16 v[224:227], a[232:235], a[168:171], v[224:227]
    v_perm_b32 v9, v96, v35, s39
    v_mfma_f32_16x16x32_bf16 v[228:231], a[132:135], a[172:175], v[228:231]
    ds_read_b32 a197, v8
    v_perm_b32 v10, v112, v35, s38
    v_mfma_f32_16x16x32_bf16 v[228:231], a[232:235], a[52:55], v[228:231]
    ds_read_b32 a251, v9
    v_mfma_f32_16x16x32_bf16 v[232:235], a[132:135], a[152:155], v[232:235]
    ds_read_b32 a198, v10
    v_perm_b32 v11, v112, v35, s39
    v_mfma_f32_16x16x32_bf16 v[232:235], a[232:235], a[128:131], v[232:235]
    v_mfma_f32_16x16x32_bf16 v[236:239], a[132:135], a[100:103], v[236:239]
    ds_read_b32 a199, v11
    v_perm_b32 v12, v109, v35, s36
    v_mfma_f32_16x16x32_bf16 v[236:239], a[232:235], a[124:127], v[236:239]
    v_perm_b32 v13, v100, v35, s36
    v_mfma_f32_16x16x32_bf16 v[240:243], a[132:135], a[0:3], v[240:243]
    ds_read_b32 a208, v12
    v_perm_b32 v14, v109, v35, s37
    v_mfma_f32_16x16x32_bf16 v[240:243], a[232:235], a[24:27], v[240:243]
    ds_read_b32 a220, v13
    v_mfma_f32_16x16x32_bf16 v[244:247], a[132:135], a[28:31], v[244:247]
    ds_read_b32 a209, v14
    v_perm_b32 v15, v109, v35, s38
    v_mfma_f32_16x16x32_bf16 v[244:247], a[232:235], a[60:63], v[244:247]
    v_mfma_f32_16x16x32_bf16 v[248:251], a[132:135], a[72:75], v[248:251]
    ds_read_b32 a210, v15
    v_perm_b32 v56, v109, v35, s39
    v_mfma_f32_16x16x32_bf16 v[248:251], a[232:235], a[104:107], v[248:251]
    v_perm_b32 v57, v100, v35, s37
    v_mfma_f32_16x16x32_bf16 v[252:255], a[132:135], a[148:151], v[252:255]
    ds_read_b32 a211, v56
    v_perm_b32 v58, v113, v35, s36
    v_mfma_f32_16x16x32_bf16 v[252:255], a[232:235], a[204:207], v[252:255]
    s_waitcnt lgkmcnt(5)
    s_barrier
    ds_read_b32 a221, v57
    v_mfma_f32_16x16x32_bf16 v[128:131], a[4:7], a[224:227], v[128:131]
    ds_read_b32 a76, v58
    v_perm_b32 v59, v113, v35, s37
    v_mfma_f32_16x16x32_bf16 v[128:131], a[196:199], a[88:91], v[128:131]
    ds_read_b128 a[228:231], v40 offset:0
    v_mfma_f32_16x16x32_bf16 v[132:135], a[4:7], a[96:99], v[132:135]
    ds_read_b32 a77, v59
    v_perm_b32 v60, v113, v35, s38
    v_mfma_f32_16x16x32_bf16 v[132:135], a[196:199], a[56:59], v[132:135]
    s_add_u32 s56, s55, 1792
    ds_read_b128 a[200:203], v41 offset:0
    v_mfma_f32_16x16x32_bf16 v[136:139], a[4:7], a[184:187], v[136:139]
    s_add_u32 m0, s57, 65536
    ds_read_b32 a78, v60
    v_perm_b32 v62, v113, v35, s39
    v_mfma_f32_16x16x32_bf16 v[136:139], a[196:199], a[212:215], v[136:139]
    buffer_load_dwordx4 v36, s[8:11], s56 offen offset:0 lds
    v_perm_b32 v61, v100, v35, s38
    v_mfma_f32_16x16x32_bf16 v[140:143], a[4:7], a[36:39], v[140:143]
    ds_read_b32 a79, v62
    ds_read_b32 a222, v61
    v_mfma_f32_16x16x32_bf16 v[140:143], a[196:199], a[48:51], v[140:143]
    ds_read_b128 a[160:163], v40 offset:2048
    v_perm_b32 v63, v110, v35, s36
    v_mfma_f32_16x16x32_bf16 v[144:147], a[4:7], a[144:147], v[144:147]
    ds_read_b32 a44, v63
    v_perm_b32 v8, v110, v35, s37
    v_mfma_f32_16x16x32_bf16 v[144:147], a[196:199], a[188:191], v[144:147]
    ds_read_b128 a[164:167], v41 offset:2048
    v_mfma_f32_16x16x32_bf16 v[148:151], a[4:7], a[216:219], v[148:151]
    ds_read_b32 a45, v8
    v_perm_b32 v9, v110, v35, s38
    v_mfma_f32_16x16x32_bf16 v[148:151], a[196:199], a[252:255], v[148:151]
    buffer_load_dwordx4 v37, s[8:11], s56 offen offset:1024 lds
    v_perm_b32 v10, v100, v35, s39
    v_mfma_f32_16x16x32_bf16 v[152:155], a[4:7], a[176:179], v[152:155]
    ds_read_b32 a46, v9
    ds_read_b32 a223, v10
    v_mfma_f32_16x16x32_bf16 v[152:155], a[196:199], a[84:87], v[152:155]
    ds_read_b128 a[180:183], v40 offset:4096
    v_perm_b32 v11, v110, v35, s39
    v_mfma_f32_16x16x32_bf16 v[156:159], a[4:7], a[16:19], v[156:159]
    ds_read_b32 a47, v11
    v_perm_b32 v12, v114, v35, s36
    v_mfma_f32_16x16x32_bf16 v[156:159], a[196:199], a[192:195], v[156:159]
    s_waitcnt lgkmcnt(8)
    ds_read_b128 a[112:115], v41 offset:4096
    v_mfma_f32_16x16x32_bf16 v[160:163], a[208:211], a[224:227], v[160:163]
    ds_read_b32 a240, v12
    v_perm_b32 v13, v114, v35, s37
    v_mfma_f32_16x16x32_bf16 v[160:163], a[76:79], a[88:91], v[160:163]
    s_waitcnt vmcnt(18)
    buffer_load_dwordx4 v38, s[8:11], s56 offen offset:2048 lds
    v_perm_b32 v14, v120, v35, s36
    v_mfma_f32_16x16x32_bf16 v[164:167], a[208:211], a[96:99], v[164:167]
    ds_read_b32 a241, v13
    ds_read_b32 a136, v14
    v_mfma_f32_16x16x32_bf16 v[164:167], a[76:79], a[56:59], v[164:167]
    ds_read_b128 a[168:171], v40 offset:6144
    v_perm_b32 v15, v114, v35, s38
    v_mfma_f32_16x16x32_bf16 v[168:171], a[208:211], a[184:187], v[168:171]
    ds_read_b32 a242, v15
    v_perm_b32 v56, v114, v35, s39
    v_mfma_f32_16x16x32_bf16 v[168:171], a[76:79], a[212:215], v[168:171]
    ds_read_b128 a[172:175], v41 offset:6144
    v_mfma_f32_16x16x32_bf16 v[172:175], a[208:211], a[36:39], v[172:175]
    s_waitcnt vmcnt(18)
    ds_read_b32 a243, v56
    v_perm_b32 v57, v124, v35, s36
    v_mfma_f32_16x16x32_bf16 v[172:175], a[76:79], a[48:51], v[172:175]
    buffer_load_dwordx4 v39, s[8:11], s56 offen offset:3072 lds
    v_perm_b32 v58, v120, v35, s37
    v_mfma_f32_16x16x32_bf16 v[176:179], a[208:211], a[144:147], v[176:179]
    ds_read_b32 a52, v57
    ds_read_b32 a137, v58
    v_mfma_f32_16x16x32_bf16 v[176:179], a[76:79], a[188:191], v[176:179]
    ds_read_b128 a[152:155], v40 offset:8192
    v_perm_b32 v59, v124, v35, s37
    v_mfma_f32_16x16x32_bf16 v[180:183], a[208:211], a[216:219], v[180:183]
    ds_read_b32 a53, v59
    v_perm_b32 v60, v124, v35, s38
    v_mfma_f32_16x16x32_bf16 v[180:183], a[76:79], a[252:255], v[180:183]
    s_add_u32 s56, s55, 1920
    ds_read_b128 a[128:131], v41 offset:8192
    v_mfma_f32_16x16x32_bf16 v[184:187], a[208:211], a[176:179], v[184:187]
    s_add_u32 m0, s57, 83968
    ds_read_b32 a54, v60
    v_perm_b32 v62, v124, v35, s39
    v_mfma_f32_16x16x32_bf16 v[184:187], a[76:79], a[84:87], v[184:187]
    buffer_load_dwordx4 v36, s[8:11], s56 offen offset:0 lds
    v_perm_b32 v61, v120, v35, s38
    v_mfma_f32_16x16x32_bf16 v[188:191], a[208:211], a[16:19], v[188:191]
    ds_read_b32 a55, v62
    ds_read_b32 a138, v61
    v_mfma_f32_16x16x32_bf16 v[188:191], a[76:79], a[192:195], v[188:191]
    s_waitcnt vmcnt(17) lgkmcnt(8)
    ds_read_b128 a[100:103], v40 offset:10240
    v_perm_b32 v63, v88, v35, s36
    v_mfma_f32_16x16x32_bf16 v[192:195], a[44:47], a[224:227], v[192:195]
    ds_read_b32 a124, v63
    v_perm_b32 v8, v88, v35, s37
    v_mfma_f32_16x16x32_bf16 v[192:195], a[240:243], a[88:91], v[192:195]
    ds_read_b128 a[0:3], v41 offset:10240
    v_mfma_f32_16x16x32_bf16 v[196:199], a[44:47], a[96:99], v[196:199]
    ds_read_b32 a125, v8
    v_perm_b32 v9, v88, v35, s38
    v_mfma_f32_16x16x32_bf16 v[196:199], a[240:243], a[56:59], v[196:199]
    buffer_load_dwordx4 v37, s[8:11], s56 offen offset:1024 lds
    v_perm_b32 v10, v120, v35, s39
    v_mfma_f32_16x16x32_bf16 v[200:203], a[44:47], a[184:187], v[200:203]
    ds_read_b32 a126, v9
    ds_read_b32 a139, v10
    v_mfma_f32_16x16x32_bf16 v[200:203], a[240:243], a[212:215], v[200:203]
    ds_read_b128 a[24:27], v40 offset:12288
    v_perm_b32 v11, v88, v35, s39
    v_mfma_f32_16x16x32_bf16 v[204:207], a[44:47], a[36:39], v[204:207]
    ds_read_b32 a127, v11
    v_perm_b32 v12, v125, v35, s36
    v_mfma_f32_16x16x32_bf16 v[204:207], a[240:243], a[48:51], v[204:207]
    ds_read_b128 a[28:31], v41 offset:12288
    v_mfma_f32_16x16x32_bf16 v[208:211], a[44:47], a[144:147], v[208:211]
    s_add_u32 m0, s57, 79872
    ds_read_b32 a60, v12
    v_perm_b32 v13, v125, v35, s37
    v_mfma_f32_16x16x32_bf16 v[208:211], a[240:243], a[188:191], v[208:211]
    s_waitcnt vmcnt(8)
    buffer_load_dwordx4 v38, s[8:11], s56 offen offset:2048 lds
    v_perm_b32 v14, v64, v35, s36
    v_mfma_f32_16x16x32_bf16 v[212:215], a[44:47], a[216:219], v[212:215]
    ds_read_b32 a61, v13
    ds_read_b32 a72, v14
    v_mfma_f32_16x16x32_bf16 v[212:215], a[240:243], a[252:255], v[212:215]
    ds_read_b128 a[104:107], v40 offset:14336
    v_perm_b32 v15, v125, v35, s38
    v_mfma_f32_16x16x32_bf16 v[216:219], a[44:47], a[176:179], v[216:219]
    ds_read_b32 a62, v15
    v_perm_b32 v56, v125, v35, s39
    v_mfma_f32_16x16x32_bf16 v[216:219], a[240:243], a[84:87], v[216:219]
    ds_read_b128 a[148:151], v41 offset:14336
    v_mfma_f32_16x16x32_bf16 v[220:223], a[44:47], a[16:19], v[220:223]
    ds_read_b32 a63, v56
    v_perm_b32 v57, v89, v35, s36
    v_mfma_f32_16x16x32_bf16 v[220:223], a[240:243], a[192:195], v[220:223]
    s_waitcnt lgkmcnt(8)
    buffer_load_dwordx4 v39, s[8:11], s56 offen offset:3072 lds
    v_perm_b32 v58, v64, v35, s37
    v_mfma_f32_16x16x32_bf16 v[128:131], a[52:55], a[228:231], v[128:131]
    ds_read_b32 a132, v57
    ds_read_b32 a73, v58
    v_mfma_f32_16x16x32_bf16 v[128:131], a[124:127], a[200:203], v[128:131]
    ds_read_b128 a[204:207], v42 offset:2048
    v_perm_b32 v59, v89, v35, s37
    v_mfma_f32_16x16x32_bf16 v[132:135], a[52:55], a[160:163], v[132:135]
    ds_read_b32 a133, v59
    v_perm_b32 v60, v89, v35, s38
    v_mfma_f32_16x16x32_bf16 v[132:135], a[124:127], a[164:167], v[132:135]
    ds_read_b128 a[232:235], v43 offset:2048
    v_perm_b32 v62, v64, v35, s38
    v_mfma_f32_16x16x32_bf16 v[136:139], a[52:55], a[180:183], v[136:139]
    ds_read_b32 a134, v60
    v_perm_b32 v61, v89, v35, s39
    v_mfma_f32_16x16x32_bf16 v[136:139], a[124:127], a[112:115], v[136:139]
    ds_read_b32 a74, v62
    v_mfma_f32_16x16x32_bf16 v[140:143], a[52:55], a[168:171], v[140:143]
    ds_read_b32 a135, v61
    v_perm_b32 v63, v126, v35, s36
    v_mfma_f32_16x16x32_bf16 v[140:143], a[124:127], a[172:175], v[140:143]
    ds_read_b128 a[4:7], v42 offset:0
    v_mfma_f32_16x16x32_bf16 v[144:147], a[52:55], a[152:155], v[144:147]
    ds_read_b32 a196, v63
    v_perm_b32 v8, v126, v35, s37
    v_mfma_f32_16x16x32_bf16 v[144:147], a[124:127], a[128:131], v[144:147]
    ds_read_b128 a[208:211], v43 offset:0
    v_perm_b32 v9, v64, v35, s39
    v_mfma_f32_16x16x32_bf16 v[148:151], a[52:55], a[100:103], v[148:151]
    ds_read_b32 a197, v8
    v_perm_b32 v10, v126, v35, s38
    v_mfma_f32_16x16x32_bf16 v[148:151], a[124:127], a[0:3], v[148:151]
    ds_read_b32 a75, v9
    v_mfma_f32_16x16x32_bf16 v[152:155], a[52:55], a[24:27], v[152:155]
    s_waitcnt lgkmcnt(8)
    ds_read_b32 a198, v10
    v_perm_b32 v11, v126, v35, s39
    v_mfma_f32_16x16x32_bf16 v[152:155], a[124:127], a[28:31], v[152:155]
    ds_read_b128 a[76:79], v42 offset:6144
    v_mfma_f32_16x16x32_bf16 v[156:159], a[52:55], a[104:107], v[156:159]
    ds_read_b32 a199, v11
    v_perm_b32 v12, v90, v35, s36
    v_mfma_f32_16x16x32_bf16 v[156:159], a[124:127], a[148:151], v[156:159]
    ds_read_b128 a[224:227], v43 offset:6144
    v_perm_b32 v13, v97, v35, s36
    v_mfma_f32_16x16x32_bf16 v[160:163], a[60:63], a[228:231], v[160:163]
    s_waitcnt lgkmcnt(8)
    ds_read_b32 a88, v12
    v_perm_b32 v14, v90, v35, s37
    v_mfma_f32_16x16x32_bf16 v[160:163], a[132:135], a[200:203], v[160:163]
    ds_read_b32 a96, v13
    v_mfma_f32_16x16x32_bf16 v[164:167], a[60:63], a[160:163], v[164:167]
    ds_read_b32 a89, v14
    v_perm_b32 v15, v90, v35, s38
    v_mfma_f32_16x16x32_bf16 v[164:167], a[132:135], a[164:167], v[164:167]
    ds_read_b128 a[56:59], v42 offset:4096
    v_mfma_f32_16x16x32_bf16 v[168:171], a[60:63], a[180:183], v[168:171]
    ds_read_b32 a90, v15
    v_perm_b32 v56, v90, v35, s39
    v_mfma_f32_16x16x32_bf16 v[168:171], a[132:135], a[112:115], v[168:171]
    ds_read_b128 a[184:187], v43 offset:4096
    v_perm_b32 v57, v97, v35, s37
    v_mfma_f32_16x16x32_bf16 v[172:175], a[60:63], a[168:171], v[172:175]
    ds_read_b32 a91, v56
    v_perm_b32 v58, v127, v35, s36
    v_mfma_f32_16x16x32_bf16 v[172:175], a[132:135], a[172:175], v[172:175]
    ds_read_b32 a97, v57
    v_mfma_f32_16x16x32_bf16 v[176:179], a[60:63], a[152:155], v[176:179]
    ds_read_b32 a212, v58
    v_perm_b32 v59, v127, v35, s37
    v_mfma_f32_16x16x32_bf16 v[176:179], a[132:135], a[128:131], v[176:179]
    ds_read_b128 a[36:39], v42 offset:10240
    v_mfma_f32_16x16x32_bf16 v[180:183], a[60:63], a[100:103], v[180:183]
    ds_read_b32 a213, v59
    v_perm_b32 v60, v127, v35, s38
    v_mfma_f32_16x16x32_bf16 v[180:183], a[132:135], a[0:3], v[180:183]
    ds_read_b128 a[48:51], v43 offset:10240
    v_perm_b32 v62, v97, v35, s38
    v_mfma_f32_16x16x32_bf16 v[184:187], a[60:63], a[24:27], v[184:187]
    ds_read_b32 a214, v60
    v_perm_b32 v61, v127, v35, s39
    v_mfma_f32_16x16x32_bf16 v[184:187], a[132:135], a[28:31], v[184:187]
    ds_read_b32 a98, v62
    v_mfma_f32_16x16x32_bf16 v[188:191], a[60:63], a[104:107], v[188:191]
    ds_read_b32 a215, v61
    v_perm_b32 v63, v91, v35, s36
    v_mfma_f32_16x16x32_bf16 v[188:191], a[132:135], a[148:151], v[188:191]
    s_waitcnt lgkmcnt(8)
    ds_read_b128 a[144:147], v42 offset:8192
    v_mfma_f32_16x16x32_bf16 v[192:195], a[196:199], a[228:231], v[192:195]
    ds_read_b32 a188, v63
    v_perm_b32 v8, v91, v35, s37
    v_mfma_f32_16x16x32_bf16 v[192:195], a[88:91], a[200:203], v[192:195]
    ds_read_b128 a[216:219], v43 offset:8192
    v_perm_b32 v9, v97, v35, s39
    v_mfma_f32_16x16x32_bf16 v[196:199], a[196:199], a[160:163], v[196:199]
    ds_read_b32 a189, v8
    v_perm_b32 v10, v91, v35, s38
    v_mfma_f32_16x16x32_bf16 v[196:199], a[88:91], a[164:167], v[196:199]
    ds_read_b32 a99, v9
    v_mfma_f32_16x16x32_bf16 v[200:203], a[196:199], a[180:183], v[200:203]
    ds_read_b32 a190, v10
    v_perm_b32 v11, v91, v35, s39
    v_mfma_f32_16x16x32_bf16 v[200:203], a[88:91], a[112:115], v[200:203]
    ds_read_b128 a[252:255], v42 offset:14336
    v_mfma_f32_16x16x32_bf16 v[204:207], a[196:199], a[168:171], v[204:207]
    s_waitcnt vmcnt(9)
    ds_read_b32 a191, v11
    v_perm_b32 v12, v68, v35, s36
    v_mfma_f32_16x16x32_bf16 v[204:207], a[88:91], a[172:175], v[204:207]
    ds_read_b128 a[176:179], v43 offset:14336
    v_perm_b32 v13, v101, v35, s36
    v_mfma_f32_16x16x32_bf16 v[208:211], a[196:199], a[152:155], v[208:211]
    ds_read_b32 a84, v12
    v_perm_b32 v14, v68, v35, s37
    v_mfma_f32_16x16x32_bf16 v[208:211], a[88:91], a[128:131], v[208:211]
    ds_read_b32 a16, v13
    v_mfma_f32_16x16x32_bf16 v[212:215], a[196:199], a[100:103], v[212:215]
    ds_read_b32 a85, v14
    v_perm_b32 v15, v68, v35, s38
    v_mfma_f32_16x16x32_bf16 v[212:215], a[88:91], a[0:3], v[212:215]
    ds_read_b128 a[44:47], v42 offset:12288
    v_mfma_f32_16x16x32_bf16 v[216:219], a[196:199], a[24:27], v[216:219]
    ds_read_b32 a86, v15
    v_perm_b32 v56, v68, v35, s39
    v_mfma_f32_16x16x32_bf16 v[216:219], a[88:91], a[28:31], v[216:219]
    ds_read_b128 a[192:195], v43 offset:12288
    v_perm_b32 v57, v101, v35, s37
    v_mfma_f32_16x16x32_bf16 v[220:223], a[196:199], a[104:107], v[220:223]
    s_waitcnt vmcnt(8)
    ds_read_b32 a87, v56
    v_perm_b32 v58, v92, v35, s36
    v_mfma_f32_16x16x32_bf16 v[220:223], a[88:91], a[148:151], v[220:223]
    s_waitcnt lgkmcnt(8)
    ds_read_b32 a17, v57
    v_mfma_f32_16x16x32_bf16 v[224:227], a[212:215], a[228:231], v[224:227]
    ds_read_b32 a240, v58
    v_perm_b32 v59, v92, v35, s37
    v_mfma_f32_16x16x32_bf16 v[224:227], a[188:191], a[200:203], v[224:227]
    v_mfma_f32_16x16x32_bf16 v[228:231], a[212:215], a[160:163], v[228:231]
    ds_read_b32 a241, v59
    v_perm_b32 v60, v92, v35, s38
    v_mfma_f32_16x16x32_bf16 v[228:231], a[188:191], a[164:167], v[228:231]
    v_perm_b32 v62, v101, v35, s38
    v_mfma_f32_16x16x32_bf16 v[232:235], a[212:215], a[180:183], v[232:235]
    s_mov_b32 s3, 0
    ds_read_b32 a242, v60
    v_perm_b32 v61, v92, v35, s39
    v_mfma_f32_16x16x32_bf16 v[232:235], a[188:191], a[112:115], v[232:235]
    ds_read_b32 a18, v62
    v_mfma_f32_16x16x32_bf16 v[236:239], a[212:215], a[168:171], v[236:239]
    ds_read_b32 a243, v61
    v_perm_b32 v63, v69, v35, s36
    v_mfma_f32_16x16x32_bf16 v[236:239], a[188:191], a[172:175], v[236:239]
    s_mov_b32 s4, 14336
    v_mfma_f32_16x16x32_bf16 v[240:243], a[212:215], a[152:155], v[240:243]
    ds_read_b32 a52, v63
    v_perm_b32 v8, v69, v35, s37
    v_mfma_f32_16x16x32_bf16 v[240:243], a[188:191], a[128:131], v[240:243]
    v_perm_b32 v9, v101, v35, s39
    v_mfma_f32_16x16x32_bf16 v[244:247], a[212:215], a[100:103], v[244:247]
    s_mov_b32 s5, 28672
    ds_read_b32 a53, v8
    v_perm_b32 v10, v69, v35, s38
    v_mfma_f32_16x16x32_bf16 v[244:247], a[188:191], a[0:3], v[244:247]
    ds_read_b32 a19, v9
    v_mfma_f32_16x16x32_bf16 v[248:251], a[212:215], a[24:27], v[248:251]
    ds_read_b32 a54, v10
    v_perm_b32 v11, v69, v35, s39
    v_mfma_f32_16x16x32_bf16 v[248:251], a[188:191], a[28:31], v[248:251]
    s_mov_b32 s6, 43008
    v_mfma_f32_16x16x32_bf16 v[252:255], a[212:215], a[104:107], v[252:255]
    ds_read_b32 a55, v11
    v_perm_b32 v12, v93, v35, s36
    v_mfma_f32_16x16x32_bf16 v[252:255], a[188:191], a[148:151], v[252:255]
    s_waitcnt lgkmcnt(5)
    s_barrier
    v_perm_b32 v13, v121, v35, s36
    v_mfma_f32_16x16x32_bf16 v[128:131], a[84:87], a[204:207], v[128:131]
    s_mov_b32 s7, 229376
    ds_read_b32 a124, v12
    v_perm_b32 v14, v93, v35, s37
    v_mfma_f32_16x16x32_bf16 v[128:131], a[240:243], a[232:235], v[128:131]
    ds_read_b128 a[60:63], v40 offset:34816
    ds_read_b32 a132, v13
    v_mfma_f32_16x16x32_bf16 v[132:135], a[84:87], a[4:7], v[132:135]
    ds_read_b32 a125, v14
    v_perm_b32 v15, v93, v35, s38
    v_mfma_f32_16x16x32_bf16 v[132:135], a[240:243], a[208:211], v[132:135]
    s_mov_b32 s24, 243712
    ds_read_b128 a[196:199], v41 offset:34816
    v_mfma_f32_16x16x32_bf16 v[136:139], a[84:87], a[76:79], v[136:139]
    ds_read_b32 a126, v15
    v_perm_b32 v56, v93, v35, s39
    v_mfma_f32_16x16x32_bf16 v[136:139], a[240:243], a[224:227], v[136:139]
    v_perm_b32 v57, v121, v35, s37
    v_mfma_f32_16x16x32_bf16 v[140:143], a[84:87], a[56:59], v[140:143]
    s_mov_b32 s25, 258048
    ds_read_b32 a127, v56
    v_perm_b32 v58, v70, v35, s36
    v_mfma_f32_16x16x32_bf16 v[140:143], a[240:243], a[184:187], v[140:143]
    ds_read_b128 a[88:91], v42 offset:32768
    ds_read_b32 a133, v57
    v_mfma_f32_16x16x32_bf16 v[144:147], a[84:87], a[36:39], v[144:147]
    ds_read_b32 a228, v58
    v_perm_b32 v59, v70, v35, s37
    v_mfma_f32_16x16x32_bf16 v[144:147], a[240:243], a[48:51], v[144:147]
    s_mov_b32 s26, 272384
    ds_read_b128 a[200:203], v43 offset:32768
    v_mfma_f32_16x16x32_bf16 v[148:151], a[84:87], a[144:147], v[148:151]
    ds_read_b32 a229, v59
    v_perm_b32 v60, v70, v35, s38
    v_mfma_f32_16x16x32_bf16 v[148:151], a[240:243], a[216:219], v[148:151]
    v_perm_b32 v62, v121, v35, s38
    v_mfma_f32_16x16x32_bf16 v[152:155], a[84:87], a[252:255], v[152:155]
    s_mov_b32 s27, 458752
    ds_read_b32 a230, v60
    v_perm_b32 v61, v70, v35, s39
    v_mfma_f32_16x16x32_bf16 v[152:155], a[240:243], a[176:179], v[152:155]
    ds_read_b128 a[160:163], v40 offset:32768
    ds_read_b32 a134, v62
    v_mfma_f32_16x16x32_bf16 v[156:159], a[84:87], a[44:47], v[156:159]
    ds_read_b32 a231, v61
    v_perm_b32 v63, v94, v35, s36
    v_mfma_f32_16x16x32_bf16 v[156:159], a[240:243], a[192:195], v[156:159]
    s_waitcnt lgkmcnt(9)
    s_mov_b32 s48, 473088
    ds_read_b128 a[164:167], v41 offset:32768
    v_mfma_f32_16x16x32_bf16 v[160:163], a[52:55], a[204:207], v[160:163]
    ds_read_b32 a180, v63
    v_perm_b32 v8, v94, v35, s37
    v_mfma_f32_16x16x32_bf16 v[160:163], a[124:127], a[232:235], v[160:163]
    v_perm_b32 v9, v121, v35, s39
    v_mfma_f32_16x16x32_bf16 v[164:167], a[52:55], a[4:7], v[164:167]
    s_mov_b32 s49, 487424
    ds_read_b32 a181, v8
    v_perm_b32 v10, v94, v35, s38
    v_mfma_f32_16x16x32_bf16 v[164:167], a[124:127], a[208:211], v[164:167]
    ds_read_b128 a[112:115], v42 offset:34816
    ds_read_b32 a135, v9
    v_mfma_f32_16x16x32_bf16 v[168:171], a[52:55], a[76:79], v[168:171]
    ds_read_b32 a182, v10
    v_perm_b32 v11, v94, v35, s39
    v_mfma_f32_16x16x32_bf16 v[168:171], a[124:127], a[224:227], v[168:171]
    s_mov_b32 s50, 501760
    ds_read_b128 a[168:171], v43 offset:34816
    v_mfma_f32_16x16x32_bf16 v[172:175], a[52:55], a[56:59], v[172:175]
    ds_read_b32 a183, v11
    v_perm_b32 v12, v65, v35, s36
    v_mfma_f32_16x16x32_bf16 v[172:175], a[124:127], a[184:187], v[172:175]
    s_waitcnt vmcnt(0)
    v_mfma_f32_16x16x32_bf16 v[176:179], a[52:55], a[36:39], v[176:179]
    s_barrier
    ds_read_b32 a172, v12
    v_perm_b32 v13, v65, v35, s37
    v_mfma_f32_16x16x32_bf16 v[176:179], a[124:127], a[48:51], v[176:179]
    s_mov_b32 s51, 688128
    ds_read_b128 a[152:155], v44 offset:2048
    ds_read_b32 a173, v13
    v_mfma_f32_16x16x32_bf16 v[180:183], a[52:55], a[144:147], v[180:183]
    v_perm_b32 v14, v65, v35, s38
    v_perm_b32 v15, v65, v35, s39
    v_mfma_f32_16x16x32_bf16 v[180:183], a[124:127], a[216:219], v[180:183]
    s_mov_b32 s52, 702464
    ds_read_b128 a[128:131], v45 offset:2048
    ds_read_b32 a174, v14
    v_mfma_f32_16x16x32_bf16 v[184:187], a[52:55], a[252:255], v[184:187]
    ds_read_b32 a175, v15
    v_perm_b32 v56, v98, v35, s36
    v_mfma_f32_16x16x32_bf16 v[184:187], a[124:127], a[176:179], v[184:187]
    v_lshlrev_b32 v104, 16, v48
    v_mfma_f32_16x16x32_bf16 v[188:191], a[52:55], a[44:47], v[188:191]
    s_mov_b32 s53, 716800
    ds_read_b32 a100, v56
    v_perm_b32 v57, v98, v35, s37
    v_mfma_f32_16x16x32_bf16 v[188:191], a[124:127], a[192:195], v[188:191]
    s_waitcnt lgkmcnt(7)
    ds_read_b128 a[0:3], v46 offset:0
    ds_read_b32 a101, v57
    v_mfma_f32_16x16x32_bf16 v[192:195], a[228:231], a[204:207], v[192:195]
    v_perm_b32 v58, v98, v35, s38
    v_perm_b32 v59, v98, v35, s39
    v_mfma_f32_16x16x32_bf16 v[192:195], a[180:183], a[232:235], v[192:195]
    s_mov_b32 s54, 731136
    ds_read_b128 a[24:27], v47 offset:0
    ds_read_b32 a102, v58
    v_mfma_f32_16x16x32_bf16 v[196:199], a[228:231], a[4:7], v[196:199]
    ds_read_b32 a103, v59
    v_perm_b32 v60, v102, v35, s36
    v_mfma_f32_16x16x32_bf16 v[196:199], a[180:183], a[208:211], v[196:199]
    v_and_b32 v105, 0xffff0000, v49
    v_lshlrev_b32 v106, 16, v51
    v_mfma_f32_16x16x32_bf16 v[200:203], a[228:231], a[76:79], v[200:203]
    ds_read_b32 a28, v60
    v_perm_b32 v62, v102, v35, s37
    v_mfma_f32_16x16x32_bf16 v[200:203], a[180:183], a[224:227], v[200:203]
    ds_read_b128 a[104:107], v44 offset:0
    ds_read_b32 a29, v62
    v_mfma_f32_16x16x32_bf16 v[204:207], a[228:231], a[56:59], v[204:207]
    v_perm_b32 v61, v102, v35, s38
    v_perm_b32 v63, v102, v35, s39
    v_mfma_f32_16x16x32_bf16 v[204:207], a[180:183], a[184:187], v[204:207]
    ds_read_b128 a[212:215], v45 offset:0
    ds_read_b32 a30, v61
    v_mfma_f32_16x16x32_bf16 v[208:211], a[228:231], a[36:39], v[208:211]
    ds_read_b32 a31, v63
    v_perm_b32 v8, v122, v35, s36
    v_mfma_f32_16x16x32_bf16 v[208:211], a[180:183], a[48:51], v[208:211]
    v_and_b32 v107, 0xffff0000, v52
    v_and_b32 v72, 0xffff0000, v48
    v_mfma_f32_16x16x32_bf16 v[212:215], a[228:231], a[144:147], v[212:215]
    ds_read_b32 a148, v8
    v_perm_b32 v9, v122, v35, s37
    v_mfma_f32_16x16x32_bf16 v[212:215], a[180:183], a[216:219], v[212:215]
    ds_read_b128 a[188:191], v46 offset:2048
    ds_read_b32 a149, v9
    v_mfma_f32_16x16x32_bf16 v[216:219], a[228:231], a[252:255], v[216:219]
    v_perm_b32 v10, v122, v35, s38
    v_perm_b32 v11, v122, v35, s39
    v_mfma_f32_16x16x32_bf16 v[216:219], a[180:183], a[176:179], v[216:219]
    ds_read_b128 a[84:87], v47 offset:2048
    ds_read_b32 a150, v10
    v_mfma_f32_16x16x32_bf16 v[220:223], a[228:231], a[44:47], v[220:223]
    ds_read_b32 a151, v11
    v_perm_b32 v12, v66, v35, s36
    v_mfma_f32_16x16x32_bf16 v[220:223], a[180:183], a[192:195], v[220:223]
    v_lshlrev_b32 v73, 16, v50
    v_and_b32 v74, 0xffff0000, v51
    v_mfma_f32_16x16x32_bf16 v[228:231], a[244:247], a[60:63], v[228:231]
    ds_read_b32 a240, v12
    v_perm_b32 v13, v66, v35, s37
    v_mfma_f32_16x16x32_bf16 v[228:231], a[8:11], a[196:199], v[228:231]
    s_waitcnt lgkmcnt(7)
    ds_read_b32 a241, v13
    v_perm_b32 v14, v66, v35, s38
    v_mfma_f32_16x16x32_bf16 v[228:231], a[120:123], a[152:155], v[228:231]
    ds_read_b128 a[52:55], v40 offset:38912
    v_perm_b32 v15, v66, v35, s39
    v_mfma_f32_16x16x32_bf16 v[228:231], a[116:119], a[128:131], v[228:231]
    ds_read_b32 a242, v14
    v_lshlrev_b32 v75, 16, v53
    v_mfma_f32_16x16x32_bf16 v[132:135], a[68:71], a[60:63], v[132:135]
    ds_read_b32 a243, v15
    v_lshlrev_b32 v76, 16, v49
    v_mfma_f32_16x16x32_bf16 v[132:135], a[80:83], a[196:199], v[132:135]
    v_and_b32 v77, 0xffff0000, v50
    v_lshlrev_b32 v78, 16, v52
    v_mfma_f32_16x16x32_bf16 v[132:135], a[140:143], a[88:91], v[132:135]
    ds_read_b128 a[124:127], v41 offset:38912
    v_and_b32 v79, 0xffff0000, v53
    v_mfma_f32_16x16x32_bf16 v[132:135], a[20:23], a[200:203], v[132:135]
    v_lshlrev_b32 v116, 16, v54
    v_and_b32 v117, 0xffff0000, v54
    v_mfma_f32_16x16x32_bf16 v[132:135], a[248:251], a[152:155], v[132:135]
    ds_write_b128 v29, v[228:231] offset:0
    v_lshlrev_b32 v118, 16, v55
    v_mfma_f32_16x16x32_bf16 v[132:135], a[220:223], a[128:131], v[132:135]
    ds_read_b128 a[204:207], v44 offset:6144
    v_mfma_f32_16x16x32_bf16 v[132:135], a[136:139], a[0:3], v[132:135]
    v_and_b32 v119, 0xffff0000, v55
    v_mfma_f32_16x16x32_bf16 v[132:135], a[72:75], a[24:27], v[132:135]
    v_mfma_f32_16x16x32_bf16 v[164:167], a[236:239], a[60:63], v[164:167]
    v_mfma_f32_16x16x32_bf16 v[164:167], a[92:95], a[196:199], v[164:167]
    s_waitcnt lgkmcnt(1)
    s_barrier
    ds_read_b128 a[232:235], v45 offset:6144
    v_mfma_f32_16x16x32_bf16 v[164:167], a[40:43], a[88:91], v[164:167]
    ds_read_b128 v[80:83], v30 offset:0
    v_mfma_f32_16x16x32_bf16 v[164:167], a[64:67], a[200:203], v[164:167]
    v_mul_f32 v132, v132, v104
    v_mul_f32 v133, v133, v105
    v_mfma_f32_16x16x32_bf16 v[164:167], a[96:99], a[152:155], v[164:167]
    ds_read_b128 a[4:7], v42 offset:36864
    v_mul_f32 v134, v134, v106
    v_mfma_f32_16x16x32_bf16 v[164:167], a[16:19], a[128:131], v[164:167]
    v_mul_f32 v135, v135, v107
    v_mfma_f32_16x16x32_bf16 v[164:167], a[132:135], a[0:3], v[164:167]
    v_mfma_f32_16x16x32_bf16 v[164:167], a[172:175], a[24:27], v[164:167]
    v_mfma_f32_16x16x32_bf16 v[196:199], a[156:159], a[60:63], v[196:199]
    ds_read_b128 a[208:211], v43 offset:36864
    v_mfma_f32_16x16x32_bf16 v[196:199], a[12:15], a[196:199], v[196:199]
    v_mfma_f32_16x16x32_bf16 v[196:199], a[32:35], a[88:91], v[196:199]
    v_mfma_f32_16x16x32_bf16 v[196:199], a[108:111], a[200:203], v[196:199]
    ds_read_b128 a[76:79], v46 offset:4096
    v_mul_f32 v164, v164, v72
    v_mfma_f32_16x16x32_bf16 v[196:199], a[100:103], a[152:155], v[196:199]
    v_mul_f32 v165, v165, v73
    v_mul_f32 v166, v166, v74
    v_mfma_f32_16x16x32_bf16 v[196:199], a[28:31], a[128:131], v[196:199]
    v_mul_f32 v167, v167, v75
    v_mfma_f32_16x16x32_bf16 v[196:199], a[148:151], a[0:3], v[196:199]
    v_mfma_f32_16x16x32_bf16 v[196:199], a[240:243], a[24:27], v[196:199]
    ds_read_b128 a[224:227], v47 offset:4096
    v_mfma_f32_16x16x32_bf16 v[224:227], a[244:247], a[160:163], v[224:227]
    v_mfma_f32_16x16x32_bf16 v[224:227], a[8:11], a[164:167], v[224:227]
    v_mfma_f32_16x16x32_bf16 v[224:227], a[120:123], a[104:107], v[224:227]
    ds_read_b128 a[56:59], v40 offset:36864
    v_mfma_f32_16x16x32_bf16 v[224:227], a[116:119], a[212:215], v[224:227]
    v_mul_f32 v196, v196, v76
    v_mul_f32 v197, v197, v77
    v_mfma_f32_16x16x32_bf16 v[128:131], a[68:71], a[160:163], v[128:131]
    v_mul_f32 v198, v198, v78
    v_mul_f32 v199, v199, v79
    v_mfma_f32_16x16x32_bf16 v[128:131], a[80:83], a[164:167], v[128:131]
    v_cvt_pk_bf16_f32 v84, v132, v164
    v_cvt_pk_bf16_f32 v85, v196, v133
    v_mfma_f32_16x16x32_bf16 v[128:131], a[140:143], a[112:115], v[128:131]
    ds_read_b128 a[184:187], v41 offset:36864
    v_cvt_pk_bf16_f32 v86, v165, v197
    v_mfma_f32_16x16x32_bf16 v[128:131], a[20:23], a[168:171], v[128:131]
    ds_write_b64 v27, v[84:85] offset:0
    v_cvt_pk_bf16_f32 v87, v134, v166
    v_mfma_f32_16x16x32_bf16 v[128:131], a[248:251], a[104:107], v[128:131]
    ds_write_b64 v27, v[86:87] offset:8
    v_cvt_pk_bf16_f32 v108, v198, v135
    v_mfma_f32_16x16x32_bf16 v[128:131], a[220:223], a[212:215], v[128:131]
    ds_read_b128 a[36:39], v44 offset:4096
    v_cvt_pk_bf16_f32 v109, v167, v199
    v_mfma_f32_16x16x32_bf16 v[128:131], a[136:139], a[188:191], v[128:131]
    s_waitcnt lgkmcnt(5)
    ds_write_b64 v27, v[108:109] offset:16
    v_add_f32 v224, v224, v80
    v_mfma_f32_16x16x32_bf16 v[128:131], a[72:75], a[84:87], v[128:131]
    v_add_f32 v225, v225, v81
    v_add_f32 v226, v226, v82
    v_mfma_f32_16x16x32_bf16 v[160:163], a[236:239], a[160:163], v[160:163]
    v_add_f32 v227, v227, v83
    v_mul_f32 v224, v224, v116
    v_mfma_f32_16x16x32_bf16 v[160:163], a[92:95], a[164:167], v[160:163]
    ds_read_b128 a[48:51], v45 offset:4096
    v_mul_f32 v225, v225, v117
    v_mfma_f32_16x16x32_bf16 v[160:163], a[40:43], a[112:115], v[160:163]
    v_mul_f32 v226, v226, v118
    v_mul_f32 v227, v227, v119
    v_mfma_f32_16x16x32_bf16 v[160:163], a[64:67], a[168:171], v[160:163]
    v_cvt_pk_bf16_f32 v80, v224, v225
    v_cvt_pk_bf16_f32 v81, v226, v227
    v_mfma_f32_16x16x32_bf16 v[160:163], a[96:99], a[104:107], v[160:163]
    ds_read_b128 a[144:147], v42 offset:38912
    v_mul_f32 v128, v128, v104
    v_mfma_f32_16x16x32_bf16 v[160:163], a[16:19], a[212:215], v[160:163]
    ds_write_b64 v28, v[80:81] offset:0
    v_mul_f32 v129, v129, v105
    v_mfma_f32_16x16x32_bf16 v[160:163], a[132:135], a[188:191], v[160:163]
    v_mul_f32 v130, v130, v106
    v_mul_f32 v131, v131, v107
    v_mfma_f32_16x16x32_bf16 v[160:163], a[172:175], a[84:87], v[160:163]
    v_mfma_f32_16x16x32_bf16 v[192:195], a[156:159], a[160:163], v[192:195]
    ds_read_b128 a[216:219], v43 offset:38912
    v_mfma_f32_16x16x32_bf16 v[192:195], a[12:15], a[164:167], v[192:195]
    v_mfma_f32_16x16x32_bf16 v[192:195], a[32:35], a[112:115], v[192:195]
    v_mfma_f32_16x16x32_bf16 v[192:195], a[108:111], a[168:171], v[192:195]
    ds_read_b128 a[252:255], v46 offset:6144
    v_mul_f32 v160, v160, v72
    v_mfma_f32_16x16x32_bf16 v[192:195], a[100:103], a[104:107], v[192:195]
    v_mul_f32 v161, v161, v73
    v_mul_f32 v162, v162, v74
    v_mfma_f32_16x16x32_bf16 v[192:195], a[28:31], a[212:215], v[192:195]
    v_mul_f32 v163, v163, v75
    v_mfma_f32_16x16x32_bf16 v[192:195], a[148:151], a[188:191], v[192:195]
    v_mfma_f32_16x16x32_bf16 v[192:195], a[240:243], a[84:87], v[192:195]
    ds_read_b128 a[176:179], v47 offset:6144
    v_mfma_f32_16x16x32_bf16 v[236:239], a[244:247], a[52:55], v[236:239]
    v_mfma_f32_16x16x32_bf16 v[236:239], a[8:11], a[124:127], v[236:239]
    v_mfma_f32_16x16x32_bf16 v[236:239], a[120:123], a[204:207], v[236:239]
    ds_read_b128 a[44:47], v40 offset:43008
    v_mfma_f32_16x16x32_bf16 v[236:239], a[116:119], a[232:235], v[236:239]
    v_mul_f32 v192, v192, v76
    v_mul_f32 v193, v193, v77
    v_mfma_f32_16x16x32_bf16 v[140:143], a[68:71], a[52:55], v[140:143]
    v_mul_f32 v194, v194, v78
    v_mul_f32 v195, v195, v79
    v_mfma_f32_16x16x32_bf16 v[140:143], a[80:83], a[124:127], v[140:143]
    v_cvt_pk_bf16_f32 v112, v128, v160
    v_cvt_pk_bf16_f32 v113, v192, v129
    v_mfma_f32_16x16x32_bf16 v[140:143], a[140:143], a[4:7], v[140:143]
    ds_read_b128 a[228:231], v41 offset:43008
    v_cvt_pk_bf16_f32 v114, v161, v193
    v_mfma_f32_16x16x32_bf16 v[140:143], a[20:23], a[208:211], v[140:143]
    ds_write_b64 v26, v[112:113] offset:0
    v_cvt_pk_bf16_f32 v115, v130, v162
    v_mfma_f32_16x16x32_bf16 v[140:143], a[248:251], a[204:207], v[140:143]
    ds_write_b64 v26, v[114:115] offset:8
    v_cvt_pk_bf16_f32 v124, v194, v131
    v_mfma_f32_16x16x32_bf16 v[140:143], a[220:223], a[232:235], v[140:143]
    ds_read_b128 a[192:195], v44 offset:10240
    v_cvt_pk_bf16_f32 v125, v163, v195
    v_mfma_f32_16x16x32_bf16 v[140:143], a[136:139], a[76:79], v[140:143]
    ds_write_b64 v26, v[124:125] offset:16
    v_mfma_f32_16x16x32_bf16 v[140:143], a[72:75], a[224:227], v[140:143]
    ds_write_b128 v29, v[236:239] offset:4096
    v_mfma_f32_16x16x32_bf16 v[172:175], a[236:239], a[52:55], v[172:175]
    v_mfma_f32_16x16x32_bf16 v[172:175], a[92:95], a[124:127], v[172:175]
    ds_read_b128 a[180:183], v45 offset:10240
    v_mfma_f32_16x16x32_bf16 v[172:175], a[40:43], a[4:7], v[172:175]
    v_mfma_f32_16x16x32_bf16 v[172:175], a[64:67], a[208:211], v[172:175]
    v_mul_f32 v140, v140, v104
    v_mul_f32 v141, v141, v105
    v_mfma_f32_16x16x32_bf16 v[172:175], a[96:99], a[204:207], v[172:175]
    s_waitcnt lgkmcnt(1)
    s_barrier
    ds_read_b128 a[60:63], v42 offset:40960
    v_mul_f32 v142, v142, v106
    v_mfma_f32_16x16x32_bf16 v[172:175], a[16:19], a[232:235], v[172:175]
    ds_read_b128 v[88:91], v24 offset:0
    v_mul_f32 v143, v143, v107
    v_mfma_f32_16x16x32_bf16 v[172:175], a[132:135], a[76:79], v[172:175]
    ds_read_b128 v[68:71], v24 offset:928
    v_mfma_f32_16x16x32_bf16 v[172:175], a[172:175], a[224:227], v[172:175]
    ds_read_b128 v[92:95], v24 offset:1856
    v_mfma_f32_16x16x32_bf16 v[204:207], a[156:159], a[52:55], v[204:207]
    ds_read_b128 a[196:199], v43 offset:40960
    v_mfma_f32_16x16x32_bf16 v[204:207], a[12:15], a[124:127], v[204:207]
    ds_read_b128 v[96:99], v24 offset:2784
    v_mfma_f32_16x16x32_bf16 v[204:207], a[32:35], a[4:7], v[204:207]
    ds_read_b128 v[100:103], v30 offset:4096
    v_mfma_f32_16x16x32_bf16 v[204:207], a[108:111], a[208:211], v[204:207]
    ds_read_b128 a[88:91], v46 offset:8192
    v_mul_f32 v172, v172, v72
    v_mfma_f32_16x16x32_bf16 v[204:207], a[100:103], a[204:207], v[204:207]
    v_mul_f32 v173, v173, v73
    v_mul_f32 v174, v174, v74
    v_mfma_f32_16x16x32_bf16 v[204:207], a[28:31], a[232:235], v[204:207]
    s_waitcnt lgkmcnt(6)
    buffer_store_dwordx4 v[88:91], v25, s[16:19], s3 offen sc1
    v_mul_f32 v175, v175, v75
    v_mfma_f32_16x16x32_bf16 v[204:207], a[148:151], a[76:79], v[204:207]
    v_mfma_f32_16x16x32_bf16 v[204:207], a[240:243], a[224:227], v[204:207]
    ds_read_b128 a[200:203], v47 offset:8192
    v_mfma_f32_16x16x32_bf16 v[232:235], a[244:247], a[56:59], v[232:235]
    s_waitcnt lgkmcnt(5)
    buffer_store_dwordx4 v[68:71], v25, s[16:19], s4 offen sc1
    v_mfma_f32_16x16x32_bf16 v[232:235], a[8:11], a[184:187], v[232:235]
    v_mfma_f32_16x16x32_bf16 v[232:235], a[120:123], a[36:39], v[232:235]
    ds_read_b128 a[152:155], v40 offset:40960
    v_mfma_f32_16x16x32_bf16 v[232:235], a[116:119], a[48:51], v[232:235]
    buffer_store_dwordx4 v[92:95], v25, s[16:19], s5 offen sc1
    v_mul_f32 v204, v204, v76
    v_mfma_f32_16x16x32_bf16 v[136:139], a[68:71], a[56:59], v[136:139]
    v_mul_f32 v205, v205, v77
    v_mul_f32 v206, v206, v78
    v_mfma_f32_16x16x32_bf16 v[136:139], a[80:83], a[184:187], v[136:139]
    s_waitcnt lgkmcnt(2)
    buffer_store_dwordx4 v[96:99], v25, s[16:19], s6 offen sc1
    v_mul_f32 v207, v207, v79
    v_mfma_f32_16x16x32_bf16 v[136:139], a[140:143], a[144:147], v[136:139]
    ds_read_b128 a[128:131], v41 offset:40960
    v_cvt_pk_bf16_f32 v120, v140, v172
    v_mfma_f32_16x16x32_bf16 v[136:139], a[20:23], a[216:219], v[136:139]
    v_cvt_pk_bf16_f32 v121, v204, v141
    v_cvt_pk_bf16_f32 v122, v173, v205
    v_mfma_f32_16x16x32_bf16 v[136:139], a[248:251], a[36:39], v[136:139]
    ds_write_b64 v27, v[120:121] offset:14848
    v_cvt_pk_bf16_f32 v123, v142, v174
    v_mfma_f32_16x16x32_bf16 v[136:139], a[220:223], a[48:51], v[136:139]
    ds_read_b128 a[0:3], v44 offset:8192
    v_cvt_pk_bf16_f32 v64, v206, v143
    v_mfma_f32_16x16x32_bf16 v[136:139], a[136:139], a[252:255], v[136:139]
    ds_write_b64 v27, v[122:123] offset:14856
    v_cvt_pk_bf16_f32 v65, v175, v207
    v_mfma_f32_16x16x32_bf16 v[136:139], a[72:75], a[176:179], v[136:139]
    ds_write_b64 v27, v[64:65] offset:14864
    v_add_f32 v232, v232, v100
    v_mfma_f32_16x16x32_bf16 v[168:171], a[236:239], a[56:59], v[168:171]
    v_add_f32 v233, v233, v101
    v_add_f32 v234, v234, v102
    v_mfma_f32_16x16x32_bf16 v[168:171], a[92:95], a[184:187], v[168:171]
    ds_read_b128 a[24:27], v45 offset:8192
    v_add_f32 v235, v235, v103
    v_mfma_f32_16x16x32_bf16 v[168:171], a[40:43], a[144:147], v[168:171]
    v_mul_f32 v232, v232, v116
    v_mul_f32 v233, v233, v117
    v_mfma_f32_16x16x32_bf16 v[168:171], a[64:67], a[216:219], v[168:171]
    v_mul_f32 v234, v234, v118
    v_mul_f32 v235, v235, v119
    v_mfma_f32_16x16x32_bf16 v[168:171], a[96:99], a[36:39], v[168:171]
    ds_read_b128 a[160:163], v42 offset:43008
    v_cvt_pk_bf16_f32 v100, v232, v233
    v_mfma_f32_16x16x32_bf16 v[168:171], a[16:19], a[48:51], v[168:171]
    v_cvt_pk_bf16_f32 v101, v234, v235
    v_mul_f32 v136, v136, v104
    v_mfma_f32_16x16x32_bf16 v[168:171], a[132:135], a[252:255], v[168:171]
    ds_write_b64 v28, v[100:101] offset:14848
    v_mul_f32 v137, v137, v105
    v_mfma_f32_16x16x32_bf16 v[168:171], a[172:175], a[176:179], v[168:171]
    v_mul_f32 v138, v138, v106
    v_mul_f32 v139, v139, v107
    v_mfma_f32_16x16x32_bf16 v[200:203], a[156:159], a[56:59], v[200:203]
    ds_read_b128 a[164:167], v43 offset:43008
    v_mfma_f32_16x16x32_bf16 v[200:203], a[12:15], a[184:187], v[200:203]
    v_mfma_f32_16x16x32_bf16 v[200:203], a[32:35], a[144:147], v[200:203]
    v_mfma_f32_16x16x32_bf16 v[200:203], a[108:111], a[216:219], v[200:203]
    ds_read_b128 a[112:115], v46 offset:10240
    v_mul_f32 v168, v168, v72
    v_mfma_f32_16x16x32_bf16 v[200:203], a[100:103], a[36:39], v[200:203]
    v_mul_f32 v169, v169, v73
    v_mul_f32 v170, v170, v74
    v_mfma_f32_16x16x32_bf16 v[200:203], a[28:31], a[48:51], v[200:203]
    v_mul_f32 v171, v171, v75
    v_mfma_f32_16x16x32_bf16 v[200:203], a[148:151], a[252:255], v[200:203]
    v_mfma_f32_16x16x32_bf16 v[200:203], a[240:243], a[176:179], v[200:203]
    ds_read_b128 a[168:171], v47 offset:10240
    v_mfma_f32_16x16x32_bf16 v[244:247], a[244:247], a[44:47], v[244:247]
    v_mfma_f32_16x16x32_bf16 v[244:247], a[8:11], a[228:231], v[244:247]
    v_mfma_f32_16x16x32_bf16 v[244:247], a[120:123], a[192:195], v[244:247]
    ds_read_b128 a[104:107], v40 offset:47104
    v_mfma_f32_16x16x32_bf16 v[244:247], a[116:119], a[180:183], v[244:247]
    v_mul_f32 v200, v200, v76
    v_mul_f32 v201, v201, v77
    v_mfma_f32_16x16x32_bf16 v[148:151], a[68:71], a[44:47], v[148:151]
    v_mul_f32 v202, v202, v78
    v_mul_f32 v203, v203, v79
    v_mfma_f32_16x16x32_bf16 v[148:151], a[80:83], a[228:231], v[148:151]
    v_cvt_pk_bf16_f32 v84, v136, v168
    v_cvt_pk_bf16_f32 v85, v200, v137
    v_mfma_f32_16x16x32_bf16 v[148:151], a[140:143], a[60:63], v[148:151]
    ds_read_b128 a[212:215], v41 offset:47104
    v_cvt_pk_bf16_f32 v86, v169, v201
    v_mfma_f32_16x16x32_bf16 v[148:151], a[20:23], a[196:199], v[148:151]
    ds_write_b64 v26, v[84:85] offset:14848
    v_cvt_pk_bf16_f32 v87, v138, v170
    v_mfma_f32_16x16x32_bf16 v[148:151], a[248:251], a[192:195], v[148:151]
    ds_write_b64 v26, v[86:87] offset:14856
    v_cvt_pk_bf16_f32 v108, v202, v139
    v_mfma_f32_16x16x32_bf16 v[148:151], a[220:223], a[180:183], v[148:151]
    ds_read_b128 a[188:191], v44 offset:14336
    v_cvt_pk_bf16_f32 v109, v171, v203
    v_mfma_f32_16x16x32_bf16 v[148:151], a[136:139], a[88:91], v[148:151]
    s_waitcnt lgkmcnt(5)
    ds_write_b64 v26, v[108:109] offset:14864
    v_mfma_f32_16x16x32_bf16 v[148:151], a[72:75], a[200:203], v[148:151]
    ds_write_b128 v29, v[244:247] offset:8192
    v_mfma_f32_16x16x32_bf16 v[180:183], a[236:239], a[44:47], v[180:183]
    v_mfma_f32_16x16x32_bf16 v[180:183], a[92:95], a[228:231], v[180:183]
    ds_read_b128 a[84:87], v45 offset:14336
    v_mfma_f32_16x16x32_bf16 v[180:183], a[40:43], a[60:63], v[180:183]
    v_mfma_f32_16x16x32_bf16 v[180:183], a[64:67], a[196:199], v[180:183]
    v_mul_f32 v148, v148, v104
    v_mul_f32 v149, v149, v105
    v_mfma_f32_16x16x32_bf16 v[180:183], a[96:99], a[192:195], v[180:183]
    s_waitcnt lgkmcnt(1)
    s_barrier
    ds_read_b128 a[52:55], v42 offset:45056
    v_mul_f32 v150, v150, v106
    v_mfma_f32_16x16x32_bf16 v[180:183], a[16:19], a[180:183], v[180:183]
    ds_read_b128 v[80:83], v24 offset:14848
    v_mul_f32 v151, v151, v107
    v_mfma_f32_16x16x32_bf16 v[180:183], a[132:135], a[88:91], v[180:183]
    ds_read_b128 v[112:115], v24 offset:15776
    v_mfma_f32_16x16x32_bf16 v[180:183], a[172:175], a[200:203], v[180:183]
    ds_read_b128 v[124:127], v24 offset:16704
    v_mfma_f32_16x16x32_bf16 v[212:215], a[156:159], a[44:47], v[212:215]
    ds_read_b128 a[124:127], v43 offset:45056
    v_mfma_f32_16x16x32_bf16 v[212:215], a[12:15], a[228:231], v[212:215]
    ds_read_b128 v[88:91], v24 offset:17632
    v_mfma_f32_16x16x32_bf16 v[212:215], a[32:35], a[60:63], v[212:215]
    ds_read_b128 v[68:71], v30 offset:8192
    v_mfma_f32_16x16x32_bf16 v[212:215], a[108:111], a[196:199], v[212:215]
    ds_read_b128 a[4:7], v46 offset:12288
    v_mul_f32 v180, v180, v72
    v_mfma_f32_16x16x32_bf16 v[212:215], a[100:103], a[192:195], v[212:215]
    v_mul_f32 v181, v181, v73
    v_mul_f32 v182, v182, v74
    v_mfma_f32_16x16x32_bf16 v[212:215], a[28:31], a[180:183], v[212:215]
    s_waitcnt lgkmcnt(6)
    buffer_store_dwordx4 v[80:83], v25, s[16:19], s7 offen sc1
    v_mul_f32 v183, v183, v75
    v_mfma_f32_16x16x32_bf16 v[212:215], a[148:151], a[88:91], v[212:215]
    v_mfma_f32_16x16x32_bf16 v[212:215], a[240:243], a[200:203], v[212:215]
    ds_read_b128 a[208:211], v47 offset:12288
    v_mfma_f32_16x16x32_bf16 v[240:243], a[244:247], a[152:155], v[240:243]
    s_waitcnt lgkmcnt(5)
    buffer_store_dwordx4 v[112:115], v25, s[16:19], s24 offen sc1
    v_mfma_f32_16x16x32_bf16 v[240:243], a[8:11], a[128:131], v[240:243]
    v_mfma_f32_16x16x32_bf16 v[240:243], a[120:123], a[0:3], v[240:243]
    ds_read_b128 a[204:207], v40 offset:45056
    v_mfma_f32_16x16x32_bf16 v[240:243], a[116:119], a[24:27], v[240:243]
    buffer_store_dwordx4 v[124:127], v25, s[16:19], s25 offen sc1
    v_mul_f32 v212, v212, v76
    v_mfma_f32_16x16x32_bf16 v[144:147], a[68:71], a[152:155], v[144:147]
    v_mul_f32 v213, v213, v77
    v_mul_f32 v214, v214, v78
    v_mfma_f32_16x16x32_bf16 v[144:147], a[80:83], a[128:131], v[144:147]
    s_waitcnt lgkmcnt(2)
    buffer_store_dwordx4 v[88:91], v25, s[16:19], s26 offen sc1
    v_mul_f32 v215, v215, v79
    v_mfma_f32_16x16x32_bf16 v[144:147], a[140:143], a[160:163], v[144:147]
    ds_read_b128 a[232:235], v41 offset:45056
    v_cvt_pk_bf16_f32 v92, v148, v180
    v_mfma_f32_16x16x32_bf16 v[144:147], a[20:23], a[164:167], v[144:147]
    v_cvt_pk_bf16_f32 v93, v212, v149
    v_cvt_pk_bf16_f32 v94, v181, v213
    v_mfma_f32_16x16x32_bf16 v[144:147], a[248:251], a[0:3], v[144:147]
    ds_write_b64 v27, v[92:93] offset:29696
    v_cvt_pk_bf16_f32 v95, v150, v182
    v_mfma_f32_16x16x32_bf16 v[144:147], a[220:223], a[24:27], v[144:147]
    ds_read_b128 a[76:79], v44 offset:12288
    v_cvt_pk_bf16_f32 v96, v214, v151
    v_mfma_f32_16x16x32_bf16 v[144:147], a[136:139], a[112:115], v[144:147]
    ds_write_b64 v27, v[94:95] offset:29704
    v_cvt_pk_bf16_f32 v97, v183, v215
    v_mfma_f32_16x16x32_bf16 v[144:147], a[72:75], a[168:171], v[144:147]
    ds_write_b64 v27, v[96:97] offset:29712
    v_add_f32 v240, v240, v68
    v_mfma_f32_16x16x32_bf16 v[176:179], a[236:239], a[152:155], v[176:179]
    v_add_f32 v241, v241, v69
    v_add_f32 v242, v242, v70
    v_mfma_f32_16x16x32_bf16 v[176:179], a[92:95], a[128:131], v[176:179]
    ds_read_b128 a[224:227], v45 offset:12288
    v_add_f32 v243, v243, v71
    v_mfma_f32_16x16x32_bf16 v[176:179], a[40:43], a[160:163], v[176:179]
    v_mul_f32 v240, v240, v116
    v_mul_f32 v241, v241, v117
    v_mfma_f32_16x16x32_bf16 v[176:179], a[64:67], a[164:167], v[176:179]
    v_mul_f32 v242, v242, v118
    v_mul_f32 v243, v243, v119
    v_mfma_f32_16x16x32_bf16 v[176:179], a[96:99], a[0:3], v[176:179]
    ds_read_b128 a[56:59], v42 offset:47104
    v_cvt_pk_bf16_f32 v68, v240, v241
    v_mfma_f32_16x16x32_bf16 v[176:179], a[16:19], a[24:27], v[176:179]
    v_cvt_pk_bf16_f32 v69, v242, v243
    v_mul_f32 v144, v144, v104
    v_mfma_f32_16x16x32_bf16 v[176:179], a[132:135], a[112:115], v[176:179]
    ds_write_b64 v28, v[68:69] offset:29696
    v_mul_f32 v145, v145, v105
    v_mfma_f32_16x16x32_bf16 v[176:179], a[172:175], a[168:171], v[176:179]
    v_mul_f32 v146, v146, v106
    v_mul_f32 v147, v147, v107
    v_mfma_f32_16x16x32_bf16 v[208:211], a[156:159], a[152:155], v[208:211]
    ds_read_b128 a[184:187], v43 offset:47104
    v_mfma_f32_16x16x32_bf16 v[208:211], a[12:15], a[128:131], v[208:211]
    v_mfma_f32_16x16x32_bf16 v[208:211], a[32:35], a[160:163], v[208:211]
    v_mfma_f32_16x16x32_bf16 v[208:211], a[108:111], a[164:167], v[208:211]
    ds_read_b128 a[144:147], v46 offset:14336
    v_mul_f32 v176, v176, v72
    v_mfma_f32_16x16x32_bf16 v[208:211], a[100:103], a[0:3], v[208:211]
    v_mul_f32 v177, v177, v73
    v_mul_f32 v178, v178, v74
    v_mfma_f32_16x16x32_bf16 v[208:211], a[28:31], a[24:27], v[208:211]
    v_mul_f32 v179, v179, v75
    v_mfma_f32_16x16x32_bf16 v[208:211], a[148:151], a[112:115], v[208:211]
    v_mfma_f32_16x16x32_bf16 v[208:211], a[240:243], a[168:171], v[208:211]
    ds_read_b128 a[216:219], v47 offset:14336
    v_mfma_f32_16x16x32_bf16 v[252:255], a[244:247], a[104:107], v[252:255]
    v_mfma_f32_16x16x32_bf16 v[252:255], a[8:11], a[212:215], v[252:255]
    v_mfma_f32_16x16x32_bf16 v[252:255], a[120:123], a[188:191], v[252:255]
    v_mfma_f32_16x16x32_bf16 v[252:255], a[116:119], a[84:87], v[252:255]
    v_mul_f32 v208, v208, v76
    v_mul_f32 v209, v209, v77
    v_mfma_f32_16x16x32_bf16 v[156:159], a[68:71], a[104:107], v[156:159]
    v_mul_f32 v210, v210, v78
    v_mul_f32 v211, v211, v79
    v_mfma_f32_16x16x32_bf16 v[156:159], a[80:83], a[212:215], v[156:159]
    v_cvt_pk_bf16_f32 v120, v144, v176
    v_cvt_pk_bf16_f32 v121, v208, v145
    v_mfma_f32_16x16x32_bf16 v[156:159], a[140:143], a[52:55], v[156:159]
    ds_write_b64 v26, v[120:121] offset:29696
    v_cvt_pk_bf16_f32 v122, v177, v209
    v_mfma_f32_16x16x32_bf16 v[156:159], a[20:23], a[124:127], v[156:159]
    v_cvt_pk_bf16_f32 v123, v146, v178
    v_cvt_pk_bf16_f32 v64, v210, v147
    v_mfma_f32_16x16x32_bf16 v[156:159], a[248:251], a[188:191], v[156:159]
    ds_write_b64 v26, v[122:123] offset:29704
    v_cvt_pk_bf16_f32 v65, v179, v211
    v_mfma_f32_16x16x32_bf16 v[156:159], a[220:223], a[84:87], v[156:159]
    ds_write_b64 v26, v[64:65] offset:29712
    v_mfma_f32_16x16x32_bf16 v[156:159], a[136:139], a[4:7], v[156:159]
    s_waitcnt lgkmcnt(3)
    ds_write_b128 v29, v[252:255] offset:12288
    v_mfma_f32_16x16x32_bf16 v[156:159], a[72:75], a[208:211], v[156:159]
    v_mfma_f32_16x16x32_bf16 v[188:191], a[236:239], a[104:107], v[188:191]
    v_mfma_f32_16x16x32_bf16 v[188:191], a[92:95], a[212:215], v[188:191]
    v_mfma_f32_16x16x32_bf16 v[188:191], a[40:43], a[52:55], v[188:191]
    v_mfma_f32_16x16x32_bf16 v[188:191], a[64:67], a[124:127], v[188:191]
    s_waitcnt lgkmcnt(0)
    s_barrier
    v_mul_f32 v156, v156, v104
    v_mul_f32 v157, v157, v105
    v_mfma_f32_16x16x32_bf16 v[188:191], a[96:99], a[188:191], v[188:191]
    ds_read_b128 v[100:103], v24 offset:29696
    v_mul_f32 v158, v158, v106
    v_mfma_f32_16x16x32_bf16 v[188:191], a[16:19], a[84:87], v[188:191]
    ds_read_b128 v[84:87], v24 offset:30624
    v_mul_f32 v159, v159, v107
    v_mfma_f32_16x16x32_bf16 v[188:191], a[132:135], a[4:7], v[188:191]
    ds_read_b128 v[108:111], v24 offset:31552
    v_mfma_f32_16x16x32_bf16 v[188:191], a[172:175], a[208:211], v[188:191]
    ds_read_b128 v[80:83], v24 offset:32480
    v_mfma_f32_16x16x32_bf16 v[220:223], a[156:159], a[104:107], v[220:223]
    ds_read_b128 v[112:115], v30 offset:12288
    v_mfma_f32_16x16x32_bf16 v[220:223], a[12:15], a[212:215], v[220:223]
    v_mfma_f32_16x16x32_bf16 v[220:223], a[32:35], a[52:55], v[220:223]
    v_mfma_f32_16x16x32_bf16 v[220:223], a[108:111], a[124:127], v[220:223]
    v_mul_f32 v188, v188, v72
    v_mul_f32 v189, v189, v73
    v_mfma_f32_16x16x32_bf16 v[220:223], a[100:103], a[188:191], v[220:223]
    s_waitcnt lgkmcnt(4)
    buffer_store_dwordx4 v[100:103], v25, s[16:19], s27 offen sc1
    v_mul_f32 v190, v190, v74
    v_mfma_f32_16x16x32_bf16 v[220:223], a[28:31], a[84:87], v[220:223]
    v_mul_f32 v191, v191, v75
    v_mfma_f32_16x16x32_bf16 v[220:223], a[148:151], a[4:7], v[220:223]
    s_waitcnt lgkmcnt(3)
    buffer_store_dwordx4 v[84:87], v25, s[16:19], s48 offen sc1
    v_mfma_f32_16x16x32_bf16 v[220:223], a[240:243], a[208:211], v[220:223]
    v_mfma_f32_16x16x32_bf16 v[248:251], a[244:247], a[204:207], v[248:251]
    s_waitcnt lgkmcnt(1)
    buffer_store_dwordx4 v[108:111], v25, s[16:19], s49 offen sc1
    v_mfma_f32_16x16x32_bf16 v[248:251], a[8:11], a[232:235], v[248:251]
    v_mfma_f32_16x16x32_bf16 v[248:251], a[120:123], a[76:79], v[248:251]
    buffer_store_dwordx4 v[80:83], v25, s[16:19], s50 offen sc1
    v_mfma_f32_16x16x32_bf16 v[248:251], a[116:119], a[224:227], v[248:251]
    v_mul_f32 v220, v220, v76
    v_mul_f32 v221, v221, v77
    v_mfma_f32_16x16x32_bf16 v[152:155], a[68:71], a[204:207], v[152:155]
    v_mul_f32 v222, v222, v78
    v_mul_f32 v223, v223, v79
    v_mfma_f32_16x16x32_bf16 v[152:155], a[80:83], a[232:235], v[152:155]
    v_cvt_pk_bf16_f32 v124, v156, v188
    v_cvt_pk_bf16_f32 v125, v220, v157
    v_mfma_f32_16x16x32_bf16 v[152:155], a[140:143], a[56:59], v[152:155]
    ds_write_b64 v27, v[124:125] offset:44544
    v_cvt_pk_bf16_f32 v126, v189, v221
    v_mfma_f32_16x16x32_bf16 v[152:155], a[20:23], a[184:187], v[152:155]
    v_cvt_pk_bf16_f32 v127, v158, v190
    v_cvt_pk_bf16_f32 v88, v222, v159
    v_mfma_f32_16x16x32_bf16 v[152:155], a[248:251], a[76:79], v[152:155]
    ds_write_b64 v27, v[126:127] offset:44552
    v_cvt_pk_bf16_f32 v89, v191, v223
    v_mfma_f32_16x16x32_bf16 v[152:155], a[220:223], a[224:227], v[152:155]
    s_waitcnt lgkmcnt(2)
    ds_write_b64 v27, v[88:89] offset:44560
    v_add_f32 v248, v248, v112
    v_mfma_f32_16x16x32_bf16 v[152:155], a[136:139], a[144:147], v[152:155]
    v_add_f32 v249, v249, v113
    v_add_f32 v250, v250, v114
    v_mfma_f32_16x16x32_bf16 v[152:155], a[72:75], a[216:219], v[152:155]
    v_add_f32 v251, v251, v115
    v_mul_f32 v248, v248, v116
    v_mfma_f32_16x16x32_bf16 v[184:187], a[236:239], a[204:207], v[184:187]
    v_mul_f32 v249, v249, v117
    v_mul_f32 v250, v250, v118
    v_mfma_f32_16x16x32_bf16 v[184:187], a[92:95], a[232:235], v[184:187]
    v_mul_f32 v251, v251, v119
    v_cvt_pk_bf16_f32 v112, v248, v249
    v_mfma_f32_16x16x32_bf16 v[184:187], a[40:43], a[56:59], v[184:187]
    v_cvt_pk_bf16_f32 v113, v250, v251
    v_mfma_f32_16x16x32_bf16 v[184:187], a[64:67], a[184:187], v[184:187]
    ds_write_b64 v28, v[112:113] offset:44544
    v_mul_f32 v152, v152, v104
    v_mfma_f32_16x16x32_bf16 v[184:187], a[96:99], a[76:79], v[184:187]
    v_mul_f32 v153, v153, v105
    v_mul_f32 v154, v154, v106
    v_mfma_f32_16x16x32_bf16 v[184:187], a[16:19], a[224:227], v[184:187]
    v_mul_f32 v155, v155, v107
    v_mfma_f32_16x16x32_bf16 v[184:187], a[132:135], a[144:147], v[184:187]
    v_mfma_f32_16x16x32_bf16 v[184:187], a[172:175], a[216:219], v[184:187]
    v_mfma_f32_16x16x32_bf16 v[216:219], a[156:159], a[204:207], v[216:219]
    v_mfma_f32_16x16x32_bf16 v[216:219], a[12:15], a[232:235], v[216:219]
    v_mfma_f32_16x16x32_bf16 v[216:219], a[32:35], a[56:59], v[216:219]
    v_mfma_f32_16x16x32_bf16 v[216:219], a[108:111], a[184:187], v[216:219]
    v_mul_f32 v184, v184, v72
    v_mul_f32 v185, v185, v73
    v_mfma_f32_16x16x32_bf16 v[216:219], a[100:103], a[76:79], v[216:219]
    v_mul_f32 v186, v186, v74
    v_mul_f32 v187, v187, v75
    v_mfma_f32_16x16x32_bf16 v[216:219], a[28:31], a[224:227], v[216:219]
    v_mfma_f32_16x16x32_bf16 v[216:219], a[148:151], a[144:147], v[216:219]
    v_mfma_f32_16x16x32_bf16 v[216:219], a[240:243], a[216:219], v[216:219]
    s_nop 7
    v_mul_f32 v216, v216, v76
    v_mul_f32 v217, v217, v77
    v_mul_f32 v218, v218, v78
    v_mul_f32 v219, v219, v79
    v_cvt_pk_bf16_f32 v92, v152, v184
    v_cvt_pk_bf16_f32 v93, v216, v153
    v_cvt_pk_bf16_f32 v94, v185, v217
    v_cvt_pk_bf16_f32 v95, v154, v186
    v_cvt_pk_bf16_f32 v96, v218, v155
    v_cvt_pk_bf16_f32 v97, v187, v219
    ds_write_b64 v26, v[92:93] offset:44544
    ds_write_b64 v26, v[94:95] offset:44552
    ds_write_b64 v26, v[96:97] offset:44560
    s_waitcnt lgkmcnt(0)
    s_barrier
    ds_read_b128 v[68:71], v24 offset:44544
    ds_read_b128 v[120:123], v24 offset:45472
    ds_read_b128 v[64:67], v24 offset:46400
    ds_read_b128 v[100:103], v24 offset:47328
    s_waitcnt lgkmcnt(3)
    buffer_store_dwordx4 v[68:71], v25, s[16:19], s51 offen sc1
    s_waitcnt lgkmcnt(2)
    buffer_store_dwordx4 v[120:123], v25, s[16:19], s52 offen sc1
    s_waitcnt lgkmcnt(1)
    buffer_store_dwordx4 v[64:67], v25, s[16:19], s53 offen sc1
    s_waitcnt lgkmcnt(0)
    buffer_store_dwordx4 v[100:103], v25, s[16:19], s54 offen sc1
L_end:
    s_endpgm
L_slow1:
    s_mov_b32 s79, 0
L_poll1:
    buffer_load_dwordx2 v[6:7], v5, s[12:15], s78 offen sc1
    s_add_u32 s79, s79, 1
    s_cmp_gt_u32 s79, 20000
    s_cbranch_scc1 L_back1
    s_waitcnt vmcnt(0)
    v_cmp_ne_u64 vcc, s[76:77], v[6:7]
    s_cbranch_vccnz L_poll1
    s_branch L_back1
L_code_end:

.section .rodata,"a"
.p2align 6
.amdhsa_kernel standalone__normalfloat_lut_af4__prompt_kernel
  .amdhsa_next_free_vgpr 512
  .amdhsa_next_free_sgpr 102
  .amdhsa_accum_offset 256
  .amdhsa_group_segment_fixed_size 0
  .amdhsa_kernarg_size 56
  .amdhsa_user_sgpr_count 2
  .amdhsa_user_sgpr_kernarg_segment_ptr 1
  .amdhsa_system_sgpr_workgroup_id_x 1
.end_amdhsa_kernel
```

```asm
; @launch grid=(256,1,1) block=(256,1,1) lds=163840
.amdgcn_target "amdgcn-amd-amdhsa--gfx950"
.text
.globl standalone__normalfloat_lut_af4__prompt_kernel
.p2align 8
.type standalone__normalfloat_lut_af4__prompt_kernel,@function
standalone__normalfloat_lut_af4__prompt_kernel:
    s_cmp_ge_u32 s2, 256
    s_cbranch_scc1 L_end
    s_load_dwordx2 s[4:5], s[0:1], 8
    s_load_dwordx2 s[12:13], s[0:1], 48
    s_load_dwordx2 s[8:9], s[0:1], 0
    s_load_dwordx4 s[20:23], s[0:1], 16
    s_load_dwordx4 s[24:27], s[0:1], 32
    s_getpc_b64 s[48:49]
    s_mov_b32 s50, L_end-standalone__normalfloat_lut_af4__prompt_kernel
    s_mov_b32 s51, 0x20000
    v_lshlrev_b32 v10, 7, v0
    buffer_load_dword v1, v10, s[48:51], 0 offen offset:256
    v_lshrrev_b32 v5, 6, v0
    v_and_b32 v2, 63, v0
    s_and_b32 s60, s2, 7
    s_lshr_b32 s61, s2, 3
    v_readfirstlane_b32 s63, v5
    s_and_b32 s58, s60, 3
    s_lshl_b32 s58, s58, 2
    s_and_b32 s62, s61, 3
    s_add_u32 s58, s58, s62
    s_lshr_b32 s59, s60, 2
    s_lshl_b32 s59, s59, 3
    s_lshr_b32 s62, s61, 2
    s_add_u32 s59, s59, s62
    v_mul_u32_u24 v18, 12, v2
    v_lshrrev_b32 v6, 3, v2
    v_and_b32 v7, 7, v2
    v_mul_u32_u24 v19, 14336, v6
    v_lshl_add_u32 v19, v7, 4, v19
    v_add_u32 v19, 768, v19
    s_lshl_b32 s60, s63, 4
    s_add_u32 s60, s60, s58
    s_mul_i32 s61, s60, 114688
    s_mul_i32 s79, s59, 896
    s_add_u32 s61, s61, s79
    s_mov_b32 s6, 14680064
    s_mov_b32 s7, 0x20000
    s_lshl_b32 s78, s59, 7
    s_add_u32 s78, s78, 2621440
    s_cmp_ge_u32 s63, 1
    s_cselect_b32 s46, 1, 0
    s_cmp_lg_u32 s46, 0
    s_waitcnt lgkmcnt(0)
    s_load_dword s76, s[12:13], s78
    s_cbranch_scc1 L_Y
L_X:
    buffer_load_dwordx4 v[160:163], v19, s[4:7], s61 offen
    buffer_load_dwordx3 v[128:130], v18, s[4:7], s61 offen
    s_add_u32 s61, s61, 14336
    buffer_load_dwordx3 v[132:134], v18, s[4:7], s61 offen
    s_add_u32 s61, s61, 14336
    buffer_load_dwordx3 v[136:138], v18, s[4:7], s61 offen
    s_add_u32 s61, s61, 14336
    buffer_load_dwordx3 v[140:142], v18, s[4:7], s61 offen
    s_add_u32 s61, s61, 14336
    buffer_load_dwordx3 v[144:146], v18, s[4:7], s61 offen
    s_add_u32 s61, s61, 14336
    buffer_load_dwordx3 v[148:150], v18, s[4:7], s61 offen
    s_add_u32 s61, s61, 14336
    buffer_load_dwordx3 v[152:154], v18, s[4:7], s61 offen
    s_add_u32 s61, s61, 14336
    buffer_load_dwordx3 v[156:158], v18, s[4:7], s61 offen
    s_add_u32 s61, s61, 7239680
    s_cmp_lg_u32 s46, 0
    s_cbranch_scc1 L_C
L_Y:
    v_lshrrev_b32 v3, 4, v2
    v_and_b32 v4, 15, v2
    v_lshlrev_b32 v8, 1, v4
    v_lshrrev_b32 v9, 4, v0
    v_lshlrev_b32 v9, 1, v9
    s_mov_b32 s28, s20
    s_mov_b32 s29, s21
    s_mov_b32 s30, 32
    s_mov_b32 s31, 0x20000
    buffer_load_ushort v16, v8, s[28:31], 0 offen
    buffer_load_ushort v17, v9, s[28:31], 0 offen
    v_xor_b32 v9, v7, v3
    s_lshl_b32 s70, s63, 5
    v_add_lshl_u32 v8, v6, s70, 11
    v_lshl_add_u32 v36, v9, 4, v8
    v_xor_b32 v37, 64, v36
    v_add_u32 v38, 30720, v36
    v_add_u32 v37, 15360, v37
    v_add_u32 v39, 30720, v37
    s_mov_b32 s10, 4194304
    s_mov_b32 s11, 0x20000
    s_lshl_b32 s55, s58, 18
    s_lshl_b32 s57, s63, 12
    s_add_u32 s57, s57, 65536
    s_add_u32 m0, s57, 32768
    s_add_u32 s56, s55, 0
    buffer_load_dwordx4 v36, s[8:11], s56 offen offset:0 lds
    buffer_load_dwordx4 v37, s[8:11], s56 offen offset:1024 lds
    buffer_load_dwordx4 v38, s[8:11], s56 offen offset:2048 lds
    buffer_load_dwordx4 v39, s[8:11], s56 offen offset:3072 lds
    s_add_u32 m0, s57, 51200
    s_add_u32 s3, s55, 128
    buffer_load_dwordx4 v36, s[8:11], s3 offen offset:0 lds
    buffer_load_dwordx4 v37, s[8:11], s3 offen offset:1024 lds
    s_add_u32 m0, s57, 47104
    s_nop 0
    buffer_load_dwordx4 v38, s[8:11], s3 offen offset:2048 lds
    buffer_load_dwordx4 v39, s[8:11], s3 offen offset:3072 lds
    s_cmp_lg_u32 s46, 0
    s_cbranch_scc1 L_X
L_C:
    s_mov_b32 s14, 2623488
    s_mov_b32 s15, 0x20000
    s_mul_i32 s68, s59, 163840
    s_mul_i32 s62, s60, 1280
    s_add_u32 s62, s62, s68
    v_lshlrev_b32 v5, 2, v6
    v_lshlrev_b32 v20, 4, v2
    v_and_b32 v8, 1, v6
    v_lshlrev_b32 v8, 30, v8
    v_lshl_add_u32 v21, v3, 3, v7
    v_lshl_add_u32 v21, v21, 3, v8
    v_add_u32 v21, 1024, v21
    s_waitcnt lgkmcnt(0)
    s_add_u32 s76, s76, 2654435769
    s_cmp_lg_u32 s46, 0
    s_cbranch_scc1 L_T
L_P:
    s_waitcnt vmcnt(18)
    v_lshlrev_b32 v160, v5, v160
    v_lshlrev_b32 v161, v5, v161
    v_lshlrev_b32 v162, v5, v162
    v_lshlrev_b32 v163, v5, v163
    v_permlane32_swap_b32 v160, v161
    s_nop 0
    v_permlane32_swap_b32 v162, v163
    v_or_b32 v160, v160, v161
    v_or_b32 v162, v162, v163
    v_mov_b32 v161, s76
    s_nop 0
    v_permlane16_swap_b32 v160, v162
    v_or_b32 v160, v160, v162
    s_nop 1
    v_or_b32_dpp v160, v160, v160 row_ror:8 row_mask:0xf bank_mask:0xf
    buffer_store_dwordx2 v[160:161], v21, s[12:15], s62 offen sc1
    v_mov_b32 v131, s76
    s_waitcnt vmcnt(17)
    v_lshl_or_b32 v128, v132, 4, v128
    v_lshl_or_b32 v129, v133, 4, v129
    v_lshl_or_b32 v130, v134, 4, v130
    s_waitcnt vmcnt(16)
    v_lshl_or_b32 v128, v136, 8, v128
    v_lshl_or_b32 v129, v137, 8, v129
    v_lshl_or_b32 v130, v138, 8, v130
    s_waitcnt vmcnt(15)
    v_lshl_or_b32 v128, v140, 12, v128
    v_lshl_or_b32 v129, v141, 12, v129
    v_lshl_or_b32 v130, v142, 12, v130
    s_waitcnt vmcnt(14)
    v_lshl_or_b32 v128, v144, 16, v128
    v_lshl_or_b32 v129, v145, 16, v129
    v_lshl_or_b32 v130, v146, 16, v130
    s_waitcnt vmcnt(13)
    v_lshl_or_b32 v128, v148, 20, v128
    v_lshl_or_b32 v129, v149, 20, v129
    v_lshl_or_b32 v130, v150, 20, v130
    s_waitcnt vmcnt(12)
    v_lshl_or_b32 v128, v152, 24, v128
    v_lshl_or_b32 v129, v153, 24, v129
    v_lshl_or_b32 v130, v154, 24, v130
    s_waitcnt vmcnt(11)
    v_lshl_or_b32 v128, v156, 28, v128
    v_lshl_or_b32 v129, v157, 28, v129
    v_lshl_or_b32 v130, v158, 28, v130
    buffer_store_dwordx4 v[128:131], v20, s[12:15], s62 offen sc1
    s_add_u32 s62, s62, 81920
    s_cmp_lg_u32 s46, 0
    s_cbranch_scc1 L_A
L_T:
    v_lshlrev_b32 v8, 4, v7
    v_lshl_add_u32 v8, v0, 8, v8
    v_xor_b32 v9, 16, v8
    v_xor_b32 v10, 32, v8
    v_xor_b32 v11, 48, v8
    v_xor_b32 v12, 64, v8
    v_xor_b32 v13, 80, v8
    v_xor_b32 v14, 96, v8
    v_xor_b32 v15, 112, v8
    s_waitcnt vmcnt(10)
    v_lshl_or_b32 v56, v17, 16, v16
    v_lshl_or_b32 v57, v17, 16, v16
    v_lshl_or_b32 v58, v17, 16, v16
    v_lshl_or_b32 v59, v17, 16, v16
    ds_write_b128 v8, v[56:59]
    ds_write_b128 v9, v[56:59]
    ds_write_b128 v10, v[56:59]
    ds_write_b128 v11, v[56:59]
    ds_write_b128 v12, v[56:59]
    ds_write_b128 v13, v[56:59]
    ds_write_b128 v14, v[56:59]
    ds_write_b128 v15, v[56:59]
    s_mov_b32 s28, s26
    s_mov_b32 s29, s27
    s_mov_b32 s30, 256
    s_and_b32 s64, s63, 1
    s_lshr_b32 s65, s63, 1
    s_mul_i32 s69, s64, 10240
    v_mul_u32_u24 v16, 1280, v3
    s_lshl_b32 s70, s63, 8
    s_add_u32 s70, s70, s68
    v_lshl_add_u32 v33, v4, 4, v16
    s_add_u32 s71, s70, s69
    v_add_u32 v32, s71, v33
    s_sub_u32 s71, 10240, s69
    s_add_u32 s71, s71, s70
    v_add_u32 v33, s71, v33
    v_and_b32 v17, 1, v4
    v_lshlrev_b32 v17, 7, v17
    v_and_b32 v31, 2, v4
    v_lshl_add_u32 v17, v31, 5, v17
    v_lshrrev_b32 v31, 2, v4
    v_lshl_add_u32 v17, v31, 3, v17
    s_lshl_b32 s70, s65, 5
    s_add_u32 s70, s70, s68
    s_add_u32 s70, s70, s69
    s_add_u32 s70, s70, 1024
    v_add3_u32 v34, v16, v17, s70
    s_mul_i32 s66, s63, 96
    s_lshl_b32 s67, s65, 5
    s_add_u32 s67, s67, 384
    s_mul_i32 s71, s59, 448
    s_add_u32 s70, s66, s71
    v_mad_u32_u24 v22, v3, 24, s70
    s_add_u32 s70, s67, s71
    v_lshl_add_u32 v23, v3, 3, s70
    s_mov_b32 s32, s22
    s_mov_b32 s33, s23
    s_mov_b32 s34, 7168
    s_mov_b32 s35, 0x20000
    s_mov_b32 s16, s24
    s_mov_b32 s17, s25
    s_mov_b32 s18, 14680064
    s_mov_b32 s19, 0x20000
    s_mov_b32 s36, 202114048
    s_mov_b32 s37, 202114304
    s_mov_b32 s38, 202114560
    s_mov_b32 s39, 202114816
    v_and_b32 v35, 31, v2
    v_lshlrev_b32 v35, 2, v35
    v_lshrrev_b32 v16, 1, v4
    v_xor_b32 v16, v16, v3
    v_lshlrev_b32 v16, 4, v16
    v_lshl_add_u32 v16, v4, 7, v16
    s_lshl_b32 s70, s64, 14
    s_add_u32 s72, s70, 65536
    s_sub_u32 s73, 81920, s70
    v_add_u32 v40, s72, v16
    v_add_u32 v42, s73, v16
    v_xor_b32 v41, 64, v40
    v_xor_b32 v43, 64, v42
    v_add_u32 v44, 65536, v40
    v_add_u32 v45, 65536, v41
    v_add_u32 v46, 65536, v42
    v_add_u32 v47, 65536, v43
    v_mul_u32_u24 v16, 464, v4
    s_mul_i32 s70, s64, 7424
    v_mad_u32_u24 v17, v3, 24, v16
    s_add_u32 s74, s66, s70
    v_add_u32 v26, s74, v17
    s_sub_u32 s74, 7424, s70
    s_add_u32 s74, s74, s66
    v_add_u32 v27, s74, v17
    s_add_u32 s74, s67, s70
    v_lshl_add_u32 v28, v3, 3, v16
    v_add_u32 v28, s74, v28
    v_lshlrev_b32 v29, 4, v0
    v_add_u32 v29, 65536, v29
    v_xor_b32 v30, 1024, v29
    v_mul_u32_u24 v16, 2341, v2
    v_lshrrev_b32 v16, 16, v16
    s_mul_i32 s73, s63, 3712
    v_add_lshl_u32 v24, v2, v16, 4
    v_add_u32 v24, s73, v24
    s_lshl_b32 s74, s58, 7
    s_lshl_b32 s75, s63, 3
    s_add_u32 s74, s74, s75
    s_mul_i32 s74, s74, 7168
    s_add_u32 s74, s74, s71
    v_mul_u32_u24 v17, 6720, v16
    v_lshl_add_u32 v25, v2, 4, v17
    v_lshrrev_b32 v16, 1, v16
    v_lshlrev_b32 v16, 30, v16
    v_add3_u32 v25, v25, v16, s74
    s_lshl_b32 s77, s59, 4
    s_mov_b32 s52, 0
    s_mov_b64 exec, 0
    s_cmp_eq_u32 s63, 1
    s_cbranch_scc1 L_pad0
    s_cmp_eq_u32 s63, 2
    s_cbranch_scc1 L_pad2
    s_cmp_eq_u32 s63, 3
    s_cbranch_scc1 L_pad4
L_warmed:
    s_mov_b64 exec, -1
    s_waitcnt vmcnt(9)
    s_cmp_lg_u32 s46, 0
    s_cbranch_scc1 L_B
    s_waitcnt vmcnt(0)
L_B:
    s_waitcnt lgkmcnt(0)
    s_barrier
    s_mov_b32 s40, 0
    s_mov_b32 s41, 5120
    s_mov_b32 s42, 0
    s_mov_b32 s43, 5120
    s_mov_b32 s44, 0
    s_mov_b32 s45, 5120
    buffer_load_dwordx4 v[64:67], v32, s[12:15], s40 offen sc1
    buffer_load_dwordx4 v[68:71], v32, s[12:15], s41 offen sc1
    buffer_load_dwordx2 v[72:73], v34, s[12:15], s42 offen sc1
    buffer_load_dwordx2 v[74:75], v34, s[12:15], s43 offen sc1
    buffer_load_dwordx4 v[76:79], v33, s[12:15], s44 offen sc1
    buffer_load_dwordx4 v[80:83], v33, s[12:15], s45 offen sc1
    ds_read_b128 a[0:3], v40 offset:32768
    ds_read_b128 a[4:7], v41 offset:32768
    ds_read_b128 a[8:11], v40 offset:34816
    ds_read_b128 a[12:15], v41 offset:34816
    ds_read_b128 a[16:19], v40 offset:36864
    ds_read_b128 a[20:23], v41 offset:36864
    ds_read_b128 a[24:27], v40 offset:38912
    ds_read_b128 a[28:31], v41 offset:38912
    ds_read_b128 a[36:39], v40 offset:40960
    ds_read_b128 a[40:43], v41 offset:40960
    ds_read_b128 a[44:47], v40 offset:43008
    ds_read_b128 a[52:55], v41 offset:43008
    ds_read_b128 a[56:59], v40 offset:45056
    ds_read_b128 a[60:63], v41 offset:45056
    ds_read_b128 a[68:71], v40 offset:47104
    ds_read_b128 a[72:75], v41 offset:47104
    s_add_u32 m0, s57, 65536
    s_add_u32 s56, s55, 256
    buffer_load_dwordx4 v36, s[8:11], s56 offen offset:0 lds
    buffer_load_dwordx4 v37, s[8:11], s56 offen offset:1024 lds
    buffer_load_dwordx4 v38, s[8:11], s56 offen offset:2048 lds
    buffer_load_dwordx4 v39, s[8:11], s56 offen offset:3072 lds
    s_cmp_lg_u32 s46, 0
    s_cbranch_scc1 L_P
L_A:
    s_add_u32 m0, s57, 83968
    s_add_u32 s3, s55, 384
    buffer_load_dwordx4 v36, s[8:11], s3 offen offset:0 lds
    buffer_load_dwordx4 v37, s[8:11], s3 offen offset:1024 lds
    s_add_u32 m0, s57, 79872
    s_nop 0
    buffer_load_dwordx4 v38, s[8:11], s3 offen offset:2048 lds
    buffer_load_dwordx4 v39, s[8:11], s3 offen offset:3072 lds
    s_waitcnt vmcnt(12)
    v_bitop3_b32 v67, v67, v71, s76 bitop3:0x7e
    v_cmp_ne_u32 vcc, 0, v67
    s_cbranch_vccnz L_slow0_0
L_back0_0:
    v_perm_b32 v56, v64, v35, s36
    v_perm_b32 v57, v64, v35, s37
    v_perm_b32 v58, v64, v35, s38
    v_perm_b32 v59, v64, v35, s39
    v_perm_b32 v60, v68, v35, s36
    v_perm_b32 v61, v68, v35, s37
    v_perm_b32 v62, v68, v35, s38
    v_perm_b32 v63, v68, v35, s39
    ds_read_b32 a32, v56
    ds_read_b32 a33, v57
    ds_read_b32 a34, v58
    ds_read_b32 a35, v59
    ds_read_b32 a48, v60
    ds_read_b32 a49, v61
    ds_read_b32 a50, v62
    ds_read_b32 a51, v63
    v_perm_b32 v56, v65, v35, s36
    v_perm_b32 v57, v65, v35, s37
    v_perm_b32 v58, v65, v35, s38
    v_perm_b32 v59, v65, v35, s39
    v_perm_b32 v60, v69, v35, s36
    ds_read_b32 a64, v56
    ds_read_b32 a65, v57
    ds_read_b32 a66, v58
    ds_read_b32 a67, v59
    s_branch L_main
.p2align 12
L_main:
L_pad0:
    s_cbranch_execz L_pad1
    s_waitcnt lgkmcnt(8)
    v_mfma_f32_16x16x32_bf16 v[128:131], a[32:35], a[0:3], 0
    s_waitcnt lgkmcnt(4)
    s_mov_b32 s40, 20480
    ds_read_b32 a76, v60
    v_perm_b32 v61, v69, v35, s37
    v_mfma_f32_16x16x32_bf16 v[128:131], a[48:51], a[4:7], v[128:131]
    s_mov_b32 s41, 25600
    ds_read_b128 a[80:83], v42 offset:34816
    v_mfma_f32_16x16x32_bf16 v[132:135], a[32:35], a[8:11], 0
    s_add_u32 m0, s57, 0
    ds_read_b32 a77, v61
    v_perm_b32 v62, v69, v35, s38
    v_mfma_f32_16x16x32_bf16 v[132:135], a[48:51], a[12:15], v[132:135]
    s_add_u32 s56, s55, 512
    v_mfma_f32_16x16x32_bf16 v[136:139], a[32:35], a[16:19], 0
    ds_read_b32 a78, v62
    buffer_load_dwordx4 v[84:87], v19, s[4:7], s61 offen
    v_mfma_f32_16x16x32_bf16 v[136:139], a[48:51], a[20:23], v[136:139]
    ds_read_b128 a[84:87], v43 offset:34816
    v_perm_b32 v63, v69, v35, s39
    v_mfma_f32_16x16x32_bf16 v[140:143], a[32:35], a[24:27], 0
    ds_read_b32 a79, v63
    buffer_load_dwordx4 v[88:91], v32, s[12:15], s40 offen sc1
    v_mfma_f32_16x16x32_bf16 v[140:143], a[48:51], a[28:31], v[140:143]
    ds_read_b128 a[88:91], v42 offset:32768
    buffer_load_dwordx4 v[92:95], v32, s[12:15], s41 offen sc1
    v_mfma_f32_16x16x32_bf16 v[144:147], a[32:35], a[36:39], 0
    v_perm_b32 v56, v66, v35, s36
    v_perm_b32 v57, v66, v35, s37
    v_mfma_f32_16x16x32_bf16 v[144:147], a[48:51], a[40:43], v[144:147]
    ds_read_b32 a92, v56
    buffer_load_dwordx4 v36, s[8:11], s56 offen offset:0 lds
    v_mfma_f32_16x16x32_bf16 v[148:151], a[32:35], a[44:47], 0
    ds_read_b32 a93, v57
    ds_read_b128 a[96:99], v43 offset:32768
    v_mfma_f32_16x16x32_bf16 v[148:151], a[48:51], a[52:55], v[148:151]
    s_waitcnt vmcnt(14)
    v_bitop3_b32 v73, v73, v75, s76 bitop3:0x7e
    v_perm_b32 v58, v66, v35, s38
    v_mfma_f32_16x16x32_bf16 v[152:155], a[32:35], a[56:59], 0
    ds_read_b32 a94, v58
    v_cmp_ne_u32 vcc, 0, v73
    v_mfma_f32_16x16x32_bf16 v[152:155], a[48:51], a[60:63], v[152:155]
    ds_read_b128 a[100:103], v42 offset:38912
    v_perm_b32 v59, v66, v35, s39
    v_mfma_f32_16x16x32_bf16 v[156:159], a[32:35], a[68:71], 0
    ds_read_b32 a95, v59
    s_cbranch_vccnz L_slow0_2
L_back0_2:
    v_mfma_f32_16x16x32_bf16 v[156:159], a[48:51], a[72:75], v[156:159]
    s_waitcnt lgkmcnt(7)
    v_perm_b32 v60, v70, v35, s36
    v_mfma_f32_16x16x32_bf16 v[160:163], a[64:67], a[0:3], 0
    ds_read_b32 a104, v60
    buffer_load_dwordx4 v37, s[8:11], s56 offen offset:1024 lds
    v_mfma_f32_16x16x32_bf16 v[160:163], a[76:79], a[4:7], v[160:163]
    ds_read_b128 a[108:111], v43 offset:38912
    buffer_load_dwordx3 v[96:98], v18, s[4:7], s61 offen
    v_mfma_f32_16x16x32_bf16 v[164:167], a[64:67], a[8:11], 0
    s_add_u32 s61, s61, 14336
    v_perm_b32 v61, v70, v35, s37
    v_perm_b32 v62, v70, v35, s38
    v_mfma_f32_16x16x32_bf16 v[164:167], a[76:79], a[12:15], v[164:167]
    ds_read_b32 a105, v61
    ds_read_b128 a[112:115], v42 offset:36864
    v_mfma_f32_16x16x32_bf16 v[168:171], a[64:67], a[16:19], 0
    ds_read_b32 a106, v62
    v_perm_b32 v63, v70, v35, s39
    v_mfma_f32_16x16x32_bf16 v[168:171], a[76:79], a[20:23], v[168:171]
    s_add_u32 s3, s55, 640
    v_mov_b32 v99, s76
    v_mfma_f32_16x16x32_bf16 v[172:175], a[64:67], a[24:27], 0
    ds_read_b32 a107, v63
    buffer_load_dwordx4 v38, s[8:11], s56 offen offset:2048 lds
    v_mfma_f32_16x16x32_bf16 v[172:175], a[76:79], a[28:31], v[172:175]
    ds_read_b128 a[116:119], v43 offset:36864
    v_perm_b32 v56, v72, v35, s36
    v_mfma_f32_16x16x32_bf16 v[176:179], a[64:67], a[36:39], 0
    ds_read_b32 a120, v56
    v_perm_b32 v57, v72, v35, s37
    v_mfma_f32_16x16x32_bf16 v[176:179], a[76:79], a[40:43], v[176:179]
    ds_read_b128 a[124:127], v42 offset:43008
    buffer_load_dwordx3 v[100:102], v18, s[4:7], s61 offen
    v_mfma_f32_16x16x32_bf16 v[180:183], a[64:67], a[44:47], 0
    s_add_u32 s61, s61, 14336
    ds_read_b32 a121, v57
    v_perm_b32 v58, v72, v35, s38
    v_mfma_f32_16x16x32_bf16 v[180:183], a[76:79], a[52:55], v[180:183]
    s_waitcnt vmcnt(16)
    v_bitop3_b32 v79, v79, v83, s76 bitop3:0x7e
    v_mfma_f32_16x16x32_bf16 v[184:187], a[64:67], a[56:59], 0
    ds_read_b32 a122, v58
    v_cmp_ne_u32 vcc, 0, v79
    v_mfma_f32_16x16x32_bf16 v[184:187], a[76:79], a[60:63], v[184:187]
    ds_read_b128 a[128:131], v43 offset:43008
    buffer_load_dwordx4 v39, s[8:11], s56 offen offset:3072 lds
    v_mfma_f32_16x16x32_bf16 v[188:191], a[64:67], a[68:71], 0
    s_add_u32 m0, s57, 18432
    v_perm_b32 v59, v72, v35, s39
    v_perm_b32 v60, v74, v35, s36
    v_mfma_f32_16x16x32_bf16 v[188:191], a[76:79], a[72:75], v[188:191]
    ds_read_b32 a123, v59
    s_cbranch_vccnz L_slow0_1
L_back0_1:
    s_waitcnt lgkmcnt(7)
    v_mfma_f32_16x16x32_bf16 v[192:195], a[92:95], a[0:3], 0
    s_mov_b32 s42, 20480
    ds_read_b32 a136, v60
    ds_read_b128 a[132:135], v42 offset:40960
    v_mfma_f32_16x16x32_bf16 v[192:195], a[104:107], a[4:7], v[192:195]
    v_perm_b32 v61, v74, v35, s37
    v_mfma_f32_16x16x32_bf16 v[196:199], a[92:95], a[8:11], 0
    ds_read_b32 a137, v61
    buffer_load_dwordx4 v36, s[8:11], s3 offen offset:0 lds
    v_mfma_f32_16x16x32_bf16 v[196:199], a[104:107], a[12:15], v[196:199]
    s_mov_b32 s43, 25600
    ds_read_b128 a[140:143], v43 offset:40960
    v_perm_b32 v62, v74, v35, s38
    v_mfma_f32_16x16x32_bf16 v[200:203], a[92:95], a[16:19], 0
    ds_read_b32 a138, v62
    v_perm_b32 v63, v74, v35, s39
    v_mfma_f32_16x16x32_bf16 v[200:203], a[104:107], a[20:23], v[200:203]
    ds_read_b128 a[144:147], v42 offset:47104
    buffer_load_dwordx3 v[104:106], v18, s[4:7], s61 offen
    v_mfma_f32_16x16x32_bf16 v[204:207], a[92:95], a[24:27], 0
    s_add_u32 s61, s61, 14336
    ds_read_b32 a139, v63
    v_perm_b32 v56, v76, v35, s36
    v_mfma_f32_16x16x32_bf16 v[204:207], a[104:107], a[28:31], v[204:207]
    buffer_load_dwordx4 v37, s[8:11], s3 offen offset:1024 lds
    v_mfma_f32_16x16x32_bf16 v[208:211], a[92:95], a[36:39], 0
    s_add_u32 m0, s57, 14336
    ds_read_b32 a152, v56
    ds_read_b128 a[148:151], v43 offset:47104
    v_mfma_f32_16x16x32_bf16 v[208:211], a[104:107], a[40:43], v[208:211]
    buffer_load_dwordx2 v[108:109], v34, s[12:15], s42 offen sc1
    v_mfma_f32_16x16x32_bf16 v[212:215], a[92:95], a[44:47], 0
    v_perm_b32 v57, v76, v35, s37
    v_perm_b32 v58, v76, v35, s38
    v_mfma_f32_16x16x32_bf16 v[212:215], a[104:107], a[52:55], v[212:215]
    ds_read_b32 a153, v57
    ds_read_b128 a[156:159], v42 offset:45056
    v_mfma_f32_16x16x32_bf16 v[216:219], a[92:95], a[56:59], 0
    ds_read_b32 a154, v58
    buffer_load_dwordx2 v[110:111], v34, s[12:15], s43 offen sc1
    v_mfma_f32_16x16x32_bf16 v[216:219], a[104:107], a[60:63], v[216:219]
    v_perm_b32 v59, v76, v35, s39
    v_mfma_f32_16x16x32_bf16 v[220:223], a[92:95], a[68:71], 0
    s_mov_b32 s44, 61440
    ds_read_b32 a155, v59
    ds_read_b128 a[160:163], v43 offset:45056
    v_mfma_f32_16x16x32_bf16 v[220:223], a[104:107], a[72:75], v[220:223]
    s_waitcnt lgkmcnt(7)
    buffer_load_dwordx4 v38, s[8:11], s3 offen offset:2048 lds
    v_mfma_f32_16x16x32_bf16 v[224:227], a[120:123], a[0:3], 0
    s_mov_b32 s40, 20480
    v_perm_b32 v60, v80, v35, s36
    v_perm_b32 v61, v80, v35, s37
    v_mfma_f32_16x16x32_bf16 v[224:227], a[136:139], a[4:7], v[224:227]
    s_mov_b32 s45, 66560
    ds_read_b32 a164, v60
    v_mfma_f32_16x16x32_bf16 v[228:231], a[120:123], a[8:11], 0
    ds_read_b32 a165, v61
    v_perm_b32 v62, v80, v35, s38
    v_mfma_f32_16x16x32_bf16 v[228:231], a[136:139], a[12:15], v[228:231]
    s_mov_b32 s41, 25600
    v_mfma_f32_16x16x32_bf16 v[232:235], a[120:123], a[16:19], 0
    ds_read_b32 a166, v62
    buffer_load_dwordx4 v39, s[8:11], s3 offen offset:3072 lds
    v_mfma_f32_16x16x32_bf16 v[232:235], a[136:139], a[20:23], v[232:235]
    buffer_load_dwordx3 v[112:114], v18, s[4:7], s61 offen
    v_mfma_f32_16x16x32_bf16 v[236:239], a[120:123], a[24:27], 0
    s_add_u32 s61, s61, 14336
    v_perm_b32 v63, v80, v35, s39
    v_perm_b32 v56, v77, v35, s36
    v_mfma_f32_16x16x32_bf16 v[236:239], a[136:139], a[28:31], v[236:239]
    ds_read_b32 a167, v63
    buffer_load_dwordx2 v[116:117], v34, s[12:15], s44 offen sc1
    v_mfma_f32_16x16x32_bf16 v[240:243], a[120:123], a[36:39], 0
    ds_read_b32 a168, v56
    buffer_load_dwordx4 v[120:123], v33, s[12:15], s40 offen sc1
    v_mfma_f32_16x16x32_bf16 v[240:243], a[136:139], a[40:43], v[240:243]
    v_perm_b32 v57, v77, v35, s37
    v_mfma_f32_16x16x32_bf16 v[244:247], a[120:123], a[44:47], 0
    ds_read_b32 a169, v57
    buffer_load_dwordx2 v[118:119], v34, s[12:15], s45 offen sc1
    v_mfma_f32_16x16x32_bf16 v[244:247], a[136:139], a[52:55], v[244:247]
    s_waitcnt vmcnt(19)
    v_perm_b32 v58, v77, v35, s38
    v_lshlrev_b32 v84, v5, v84
    v_mfma_f32_16x16x32_bf16 v[248:251], a[120:123], a[56:59], 0
    s_waitcnt lgkmcnt(4)
    s_barrier
    ds_read_b32 a170, v58
    v_mfma_f32_16x16x32_bf16 v[248:251], a[136:139], a[60:63], v[248:251]
    buffer_load_dwordx4 v[124:127], v33, s[12:15], s41 offen sc1
    v_mfma_f32_16x16x32_bf16 v[252:255], a[120:123], a[68:71], 0
    v_perm_b32 v59, v77, v35, s39
    v_perm_b32 v60, v81, v35, s36
    v_mfma_f32_16x16x32_bf16 v[252:255], a[136:139], a[72:75], v[252:255]
    s_waitcnt lgkmcnt(3)
    ds_read_b32 a171, v59
    buffer_load_dwordx3 v[48:50], v18, s[4:7], s61 offen
    v_mfma_f32_16x16x32_bf16 v[128:131], a[152:155], a[80:83], v[128:131]
    s_add_u32 s61, s61, 14336
    ds_read_b32 a172, v60
    v_perm_b32 v61, v81, v35, s37
    v_mfma_f32_16x16x32_bf16 v[128:131], a[164:167], a[84:87], v[128:131]
    ds_read_b128 a[176:179], v44 offset:0
    v_lshlrev_b32 v85, v5, v85
    v_mfma_f32_16x16x32_bf16 v[132:135], a[152:155], a[88:91], v[132:135]
    ds_read_b32 a173, v61
    v_perm_b32 v62, v81, v35, s38
    v_mfma_f32_16x16x32_bf16 v[132:135], a[164:167], a[96:99], v[132:135]
    v_lshlrev_b32 v86, v5, v86
    v_lshlrev_b32 v87, v5, v87
    v_mfma_f32_16x16x32_bf16 v[136:139], a[152:155], a[100:103], v[136:139]
    ds_read_b32 a174, v62
    v_perm_b32 v63, v81, v35, s39
    v_mfma_f32_16x16x32_bf16 v[136:139], a[164:167], a[108:111], v[136:139]
    ds_read_b128 a[180:183], v45 offset:0
    v_permlane32_swap_b32 v84, v85
    v_mfma_f32_16x16x32_bf16 v[140:143], a[152:155], a[112:115], v[140:143]
    ds_read_b32 a175, v63
    v_perm_b32 v56, v78, v35, s36
    v_mfma_f32_16x16x32_bf16 v[140:143], a[164:167], a[116:119], v[140:143]
    ds_read_b128 a[184:187], v44 offset:2048
    v_permlane32_swap_b32 v86, v87
    v_mfma_f32_16x16x32_bf16 v[144:147], a[152:155], a[124:127], v[144:147]
    ds_read_b32 a188, v56
    v_perm_b32 v57, v78, v35, s37
    v_mfma_f32_16x16x32_bf16 v[144:147], a[164:167], a[128:131], v[144:147]
    buffer_load_dwordx3 v[52:54], v18, s[4:7], s61 offen
    v_mfma_f32_16x16x32_bf16 v[148:151], a[152:155], a[132:135], v[148:151]
    s_add_u32 s61, s61, 14336
    ds_read_b32 a189, v57
    ds_read_b128 a[192:195], v45 offset:2048
    v_mfma_f32_16x16x32_bf16 v[148:151], a[164:167], a[140:143], v[148:151]
    s_waitcnt vmcnt(20)
    v_bitop3_b32 v91, v91, v95, s76 bitop3:0x7e
    v_perm_b32 v58, v78, v35, s38
    v_mfma_f32_16x16x32_bf16 v[152:155], a[152:155], a[144:147], v[152:155]
    ds_read_b32 a190, v58
    v_cmp_ne_u32 vcc, 0, v91
    v_mfma_f32_16x16x32_bf16 v[152:155], a[164:167], a[148:151], v[152:155]
    v_or_b32 v84, v84, v85
    v_or_b32 v86, v86, v87
    v_mfma_f32_16x16x32_bf16 v[156:159], a[152:155], a[156:159], v[156:159]
    v_mov_b32 v85, s76
    s_cbranch_vccnz L_slow1_0
L_back1_0:
    v_mfma_f32_16x16x32_bf16 v[156:159], a[164:167], a[160:163], v[156:159]
    s_waitcnt lgkmcnt(5)
    ds_read_b128 a[196:199], v44 offset:4096
    v_perm_b32 v59, v78, v35, s39
    v_mfma_f32_16x16x32_bf16 v[160:163], a[168:171], a[80:83], v[160:163]
    ds_read_b32 a191, v59
    v_permlane16_swap_b32 v84, v86
    v_mfma_f32_16x16x32_bf16 v[160:163], a[172:175], a[84:87], v[160:163]
    v_or_b32 v84, v84, v86
    v_perm_b32 v60, v82, v35, s36
    v_mfma_f32_16x16x32_bf16 v[164:167], a[168:171], a[88:91], v[164:167]
    ds_read_b32 a204, v60
    ds_read_b128 a[200:203], v45 offset:4096
    v_mfma_f32_16x16x32_bf16 v[164:167], a[172:175], a[96:99], v[164:167]
    v_or_b32_dpp v84, v84, v84 row_ror:8 row_mask:0xf bank_mask:0xf
    v_perm_b32 v61, v82, v35, s37
    v_mfma_f32_16x16x32_bf16 v[168:171], a[168:171], a[100:103], v[168:171]
    ds_read_b32 a205, v61
    buffer_store_dwordx2 v[84:85], v21, s[12:15], s62 offen sc1
    v_mfma_f32_16x16x32_bf16 v[168:171], a[172:175], a[108:111], v[168:171]
    s_mov_b32 s42, 61440
    ds_read_b128 a[208:211], v44 offset:6144
    v_perm_b32 v62, v82, v35, s38
    v_mfma_f32_16x16x32_bf16 v[172:175], a[168:171], a[112:115], v[172:175]
    ds_read_b32 a206, v62
    v_perm_b32 v63, v82, v35, s39
    v_mfma_f32_16x16x32_bf16 v[172:175], a[172:175], a[116:119], v[172:175]
    s_waitcnt vmcnt(16)
    ds_read_b32 a207, v63
    ds_read_b128 a[212:215], v45 offset:6144
    v_mfma_f32_16x16x32_bf16 v[176:179], a[168:171], a[124:127], v[176:179]
    s_mov_b32 s43, 66560
    v_lshl_or_b32 v96, v100, 4, v96
    v_lshl_or_b32 v97, v101, 4, v97
    v_mfma_f32_16x16x32_bf16 v[176:179], a[172:175], a[128:131], v[176:179]
    v_lshl_or_b32 v98, v102, 4, v98
    v_perm_b32 v56, v88, v35, s36
    v_mfma_f32_16x16x32_bf16 v[180:183], a[168:171], a[132:135], v[180:183]
    ds_read_b32 a216, v56
    buffer_load_dwordx3 v[64:66], v18, s[4:7], s61 offen
    v_mfma_f32_16x16x32_bf16 v[180:183], a[172:175], a[140:143], v[180:183]
    s_add_u32 s61, s61, 14336
    ds_read_b128 a[220:223], v44 offset:8192
    v_perm_b32 v57, v88, v35, s37
    v_mfma_f32_16x16x32_bf16 v[184:187], a[168:171], a[144:147], v[184:187]
    ds_read_b32 a217, v57
    v_perm_b32 v58, v88, v35, s38
    v_mfma_f32_16x16x32_bf16 v[184:187], a[172:175], a[148:151], v[184:187]
    ds_read_b32 a218, v58
    ds_read_b128 a[224:227], v45 offset:8192
    v_mfma_f32_16x16x32_bf16 v[188:191], a[168:171], a[156:159], v[188:191]
    v_perm_b32 v59, v88, v35, s39
    v_perm_b32 v60, v92, v35, s36
    v_mfma_f32_16x16x32_bf16 v[188:191], a[172:175], a[160:163], v[188:191]
    s_waitcnt lgkmcnt(6)
    ds_read_b32 a219, v59
    buffer_load_dwordx4 v[68:71], v32, s[12:15], s42 offen sc1
    v_mfma_f32_16x16x32_bf16 v[192:195], a[188:191], a[80:83], v[192:195]
    s_mov_b32 s44, 40960
    ds_read_b32 a232, v60
    ds_read_b128 a[228:231], v44 offset:10240
    v_mfma_f32_16x16x32_bf16 v[192:195], a[204:207], a[84:87], v[192:195]
    buffer_load_dwordx4 v[72:75], v32, s[12:15], s43 offen sc1
    v_mfma_f32_16x16x32_bf16 v[196:199], a[188:191], a[88:91], v[196:199]
    s_waitcnt vmcnt(16)
    ds_read_b128 a[236:239], v45 offset:10240
    v_perm_b32 v61, v92, v35, s37
    v_mfma_f32_16x16x32_bf16 v[196:199], a[204:207], a[96:99], v[196:199]
    s_mov_b32 s45, 46080
    ds_read_b32 a233, v61
    v_lshl_or_b32 v96, v104, 8, v96
    v_mfma_f32_16x16x32_bf16 v[200:203], a[188:191], a[100:103], v[200:203]
    v_lshl_or_b32 v97, v105, 8, v97
    v_lshl_or_b32 v98, v106, 8, v98
    v_mfma_f32_16x16x32_bf16 v[200:203], a[204:207], a[108:111], v[200:203]
    v_perm_b32 v62, v92, v35, s38
    v_perm_b32 v63, v92, v35, s39
    v_mfma_f32_16x16x32_bf16 v[204:207], a[188:191], a[112:115], v[204:207]
    ds_read_b32 a234, v62
    buffer_load_dwordx3 v[76:78], v18, s[4:7], s61 offen
    v_mfma_f32_16x16x32_bf16 v[204:207], a[204:207], a[116:119], v[204:207]
    ds_read_b32 a235, v63
    ds_read_b128 a[240:243], v44 offset:12288
    v_mfma_f32_16x16x32_bf16 v[208:211], a[188:191], a[124:127], v[208:211]
    ds_read_b128 a[244:247], v45 offset:12288
    v_perm_b32 v56, v89, v35, s36
    v_mfma_f32_16x16x32_bf16 v[208:211], a[204:207], a[128:131], v[208:211]
    ds_read_b32 a248, v56
    buffer_load_dwordx4 v[84:87], v32, s[12:15], s44 offen sc1
    v_mfma_f32_16x16x32_bf16 v[212:215], a[188:191], a[132:135], v[212:215]
    v_perm_b32 v57, v89, v35, s37
    v_perm_b32 v58, v89, v35, s38
    v_mfma_f32_16x16x32_bf16 v[212:215], a[204:207], a[140:143], v[212:215]
    ds_read_b32 a249, v57
    ds_read_b128 a[252:255], v44 offset:14336
    v_mfma_f32_16x16x32_bf16 v[216:219], a[188:191], a[144:147], v[216:219]
    s_add_u32 s56, s55, 1024
    ds_read_b32 a250, v58
    v_perm_b32 v59, v89, v35, s39
    v_mfma_f32_16x16x32_bf16 v[216:219], a[204:207], a[148:151], v[216:219]
    buffer_load_dwordx4 v[80:83], v32, s[12:15], s45 offen sc1
    v_mfma_f32_16x16x32_bf16 v[220:223], a[188:191], a[156:159], v[220:223]
    s_waitcnt vmcnt(13) lgkmcnt(8)
    ds_read_b32 a251, v59
    ds_read_b128 a[32:35], v45 offset:14336
    v_mfma_f32_16x16x32_bf16 v[220:223], a[204:207], a[160:163], v[220:223]
    s_add_u32 m0, s57, 32768
    v_lshl_or_b32 v96, v112, 12, v96
    v_lshl_or_b32 v97, v113, 12, v97
    v_mfma_f32_16x16x32_bf16 v[128:131], a[216:219], a[176:179], v[128:131]
    s_waitcnt lgkmcnt(7)
    v_lshl_or_b32 v98, v114, 12, v98
    v_perm_b32 v60, v93, v35, s36
    v_mfma_f32_16x16x32_bf16 v[128:131], a[232:235], a[180:183], v[128:131]
    ds_read_b32 a48, v60
    v_perm_b32 v61, v93, v35, s37
    v_mfma_f32_16x16x32_bf16 v[132:135], a[216:219], a[184:187], v[132:135]
    ds_read_b32 a49, v61
    ds_read_b128 a[64:67], v46 offset:2048
    v_mfma_f32_16x16x32_bf16 v[132:135], a[232:235], a[192:195], v[132:135]
    v_perm_b32 v62, v93, v35, s38
    v_mfma_f32_16x16x32_bf16 v[136:139], a[216:219], a[196:199], v[136:139]
    ds_read_b32 a50, v62
    v_perm_b32 v63, v93, v35, s39
    v_mfma_f32_16x16x32_bf16 v[136:139], a[232:235], a[200:203], v[136:139]
    ds_read_b128 a[76:79], v47 offset:2048
    buffer_load_dwordx4 v36, s[8:11], s56 offen offset:0 lds
    v_mfma_f32_16x16x32_bf16 v[140:143], a[216:219], a[208:211], v[140:143]
    ds_read_b32 a51, v63
    v_perm_b32 v56, v90, v35, s36
    v_mfma_f32_16x16x32_bf16 v[140:143], a[232:235], a[212:215], v[140:143]
    s_waitcnt vmcnt(9)
    ds_read_b128 a[92:95], v46 offset:0
    v_lshl_or_b32 v96, v48, 16, v96
    v_mfma_f32_16x16x32_bf16 v[144:147], a[216:219], a[220:223], v[144:147]
    ds_read_b32 a104, v56
    v_perm_b32 v57, v90, v35, s37
    v_mfma_f32_16x16x32_bf16 v[144:147], a[232:235], a[224:227], v[144:147]
    v_lshl_or_b32 v97, v49, 16, v97
    v_lshl_or_b32 v98, v50, 16, v98
    v_mfma_f32_16x16x32_bf16 v[148:151], a[216:219], a[228:231], v[148:151]
    ds_read_b32 a105, v57
    ds_read_b128 a[0:3], v47 offset:0
    v_mfma_f32_16x16x32_bf16 v[148:151], a[232:235], a[236:239], v[148:151]
    v_bitop3_b32 v109, v109, v111, s76 bitop3:0x7e
    v_perm_b32 v58, v90, v35, s38
    v_mfma_f32_16x16x32_bf16 v[152:155], a[216:219], a[240:243], v[152:155]
    s_waitcnt lgkmcnt(7)
    ds_read_b32 a106, v58
    v_cmp_ne_u32 vcc, 0, v109
    v_mfma_f32_16x16x32_bf16 v[152:155], a[232:235], a[244:247], v[152:155]
    ds_read_b128 a[4:7], v46 offset:6144
    v_perm_b32 v59, v90, v35, s39
    v_mfma_f32_16x16x32_bf16 v[156:159], a[216:219], a[252:255], v[156:159]
    ds_read_b32 a107, v59
    s_cbranch_vccnz L_slow1_2
L_back1_2:
    v_mfma_f32_16x16x32_bf16 v[156:159], a[232:235], a[32:35], v[156:159]
    buffer_load_dwordx4 v37, s[8:11], s56 offen offset:1024 lds
    v_mfma_f32_16x16x32_bf16 v[160:163], a[248:251], a[176:179], v[160:163]
    s_waitcnt lgkmcnt(6)
    ds_read_b128 a[8:11], v47 offset:6144
    v_perm_b32 v60, v94, v35, s36
    v_mfma_f32_16x16x32_bf16 v[160:163], a[48:51], a[180:183], v[160:163]
    ds_read_b32 a12, v60
    v_perm_b32 v61, v94, v35, s37
    v_mfma_f32_16x16x32_bf16 v[164:167], a[248:251], a[184:187], v[164:167]
    ds_read_b32 a13, v61
    v_perm_b32 v62, v94, v35, s38
    v_mfma_f32_16x16x32_bf16 v[164:167], a[48:51], a[192:195], v[164:167]
    ds_read_b128 a[16:19], v46 offset:4096
    buffer_load_dwordx4 v38, s[8:11], s56 offen offset:2048 lds
    v_mfma_f32_16x16x32_bf16 v[168:171], a[248:251], a[196:199], v[168:171]
    s_add_u32 s3, s55, 1152
    ds_read_b32 a14, v62
    v_perm_b32 v63, v94, v35, s39
    v_mfma_f32_16x16x32_bf16 v[168:171], a[48:51], a[200:203], v[168:171]
    s_waitcnt vmcnt(10)
    v_lshl_or_b32 v96, v52, 20, v96
    v_lshl_or_b32 v97, v53, 20, v97
    v_mfma_f32_16x16x32_bf16 v[172:175], a[248:251], a[208:211], v[172:175]
    ds_read_b32 a15, v63
    ds_read_b128 a[20:23], v47 offset:4096
    v_mfma_f32_16x16x32_bf16 v[172:175], a[48:51], a[212:215], v[172:175]
    v_lshl_or_b32 v98, v54, 20, v98
    v_perm_b32 v56, v108, v35, s36
    v_mfma_f32_16x16x32_bf16 v[176:179], a[248:251], a[220:223], v[176:179]
    ds_read_b32 a24, v56
    v_perm_b32 v57, v108, v35, s37
    v_mfma_f32_16x16x32_bf16 v[176:179], a[48:51], a[224:227], v[176:179]
    ds_read_b128 a[28:31], v46 offset:10240
    v_bitop3_b32 v117, v117, v119, s76 bitop3:0x7e
    v_mfma_f32_16x16x32_bf16 v[180:183], a[248:251], a[228:231], v[180:183]
    ds_read_b32 a25, v57
    v_cmp_ne_u32 vcc, 0, v117
    v_mfma_f32_16x16x32_bf16 v[180:183], a[48:51], a[236:239], v[180:183]
    v_bitop3_b32 v123, v123, v127, s76 bitop3:0x7e
    v_perm_b32 v58, v108, v35, s38
    v_mfma_f32_16x16x32_bf16 v[184:187], a[248:251], a[240:243], v[184:187]
    ds_read_b32 a26, v58
    s_cbranch_vccnz L_slow6_2
L_back6_2:
    v_mfma_f32_16x16x32_bf16 v[184:187], a[48:51], a[244:247], v[184:187]
    ds_read_b128 a[36:39], v47 offset:10240
    v_cmp_ne_u32 vcc, 0, v123
    v_mfma_f32_16x16x32_bf16 v[188:191], a[248:251], a[252:255], v[188:191]
    s_waitcnt lgkmcnt(7)
    buffer_load_dwordx4 v39, s[8:11], s56 offen offset:3072 lds
    v_mfma_f32_16x16x32_bf16 v[188:191], a[48:51], a[32:35], v[188:191]
    s_add_u32 m0, s57, 51200
    v_perm_b32 v59, v108, v35, s39
    v_perm_b32 v60, v110, v35, s36
    v_mfma_f32_16x16x32_bf16 v[192:195], a[104:107], a[176:179], v[192:195]
    ds_read_b32 a27, v59
    s_cbranch_vccnz L_slow1_1
L_back1_1:
    s_waitcnt lgkmcnt(6)
    v_mfma_f32_16x16x32_bf16 v[192:195], a[12:15], a[180:183], v[192:195]
    s_mov_b32 s40, 40960
    ds_read_b32 a44, v60
    ds_read_b128 a[40:43], v46 offset:8192
    v_mfma_f32_16x16x32_bf16 v[196:199], a[104:107], a[184:187], v[196:199]
    s_waitcnt vmcnt(9)
    ds_read_b128 a[52:55], v47 offset:8192
    buffer_load_dwordx4 v36, s[8:11], s3 offen offset:0 lds
    v_mfma_f32_16x16x32_bf16 v[196:199], a[12:15], a[192:195], v[196:199]
    s_mov_b32 s41, 46080
    v_perm_b32 v61, v110, v35, s37
    v_lshl_or_b32 v96, v64, 24, v96
    v_mfma_f32_16x16x32_bf16 v[200:203], a[104:107], a[196:199], v[200:203]
    ds_read_b32 a45, v61
    v_lshl_or_b32 v97, v65, 24, v97
    v_mfma_f32_16x16x32_bf16 v[200:203], a[12:15], a[200:203], v[200:203]
    v_lshl_or_b32 v98, v66, 24, v98
    v_perm_b32 v62, v110, v35, s38
    v_mfma_f32_16x16x32_bf16 v[204:207], a[104:107], a[208:211], v[204:207]
    ds_read_b32 a46, v62
    v_perm_b32 v63, v110, v35, s39
    v_mfma_f32_16x16x32_bf16 v[204:207], a[12:15], a[212:215], v[204:207]
    ds_read_b32 a47, v63
    ds_read_b128 a[56:59], v46 offset:14336
    v_mfma_f32_16x16x32_bf16 v[208:211], a[104:107], a[220:223], v[208:211]
    ds_read_b128 a[60:63], v47 offset:14336
    buffer_load_dwordx4 v37, s[8:11], s3 offen offset:1024 lds
    v_mfma_f32_16x16x32_bf16 v[208:211], a[12:15], a[224:227], v[208:211]
    s_add_u32 m0, s57, 47104
    v_perm_b32 v56, v120, v35, s36
    v_perm_b32 v57, v120, v35, s37
    v_mfma_f32_16x16x32_bf16 v[212:215], a[104:107], a[228:231], v[212:215]
    ds_read_b32 a68, v56
    ds_read_b32 a69, v57
    v_mfma_f32_16x16x32_bf16 v[212:215], a[12:15], a[236:239], v[212:215]
    ds_read_b128 a[120:123], v46 offset:12288
    buffer_load_dwordx2 v[100:101], v34, s[12:15], s40 offen sc1
    v_mfma_f32_16x16x32_bf16 v[216:219], a[104:107], a[240:243], v[216:219]
    v_perm_b32 v58, v120, v35, s38
    v_perm_b32 v59, v120, v35, s39
    v_mfma_f32_16x16x32_bf16 v[216:219], a[12:15], a[244:247], v[216:219]
    ds_read_b32 a70, v58
    buffer_load_dwordx2 v[102:103], v34, s[12:15], s41 offen sc1
    v_mfma_f32_16x16x32_bf16 v[220:223], a[104:107], a[252:255], v[220:223]
    ds_read_b32 a71, v59
    buffer_load_dwordx4 v38, s[8:11], s3 offen offset:2048 lds
    v_mfma_f32_16x16x32_bf16 v[220:223], a[12:15], a[32:35], v[220:223]
    s_waitcnt vmcnt(11) lgkmcnt(7)
    ds_read_b128 a[72:75], v47 offset:12288
    v_lshl_or_b32 v96, v76, 28, v96
    v_mfma_f32_16x16x32_bf16 v[224:227], a[24:27], a[176:179], v[224:227]
    s_mov_b32 s42, 40960
    v_lshl_or_b32 v97, v77, 28, v97
    v_lshl_or_b32 v98, v78, 28, v98
    v_mfma_f32_16x16x32_bf16 v[224:227], a[44:47], a[180:183], v[224:227]
    buffer_store_dwordx4 v[96:99], v20, s[12:15], s62 offen sc1
    v_mfma_f32_16x16x32_bf16 v[228:231], a[24:27], a[184:187], v[228:231]
    v_perm_b32 v60, v124, v35, s36
    v_perm_b32 v61, v124, v35, s37
    v_mfma_f32_16x16x32_bf16 v[228:231], a[44:47], a[192:195], v[228:231]
    s_mov_b32 s43, 46080
    ds_read_b32 a136, v60
    ds_read_b32 a137, v61
    v_mfma_f32_16x16x32_bf16 v[232:235], a[24:27], a[196:199], v[232:235]
    buffer_load_dwordx4 v39, s[8:11], s3 offen offset:3072 lds
    v_mfma_f32_16x16x32_bf16 v[232:235], a[44:47], a[200:203], v[232:235]
    v_perm_b32 v62, v124, v35, s38
    v_perm_b32 v63, v116, v35, s36
    v_mfma_f32_16x16x32_bf16 v[236:239], a[24:27], a[208:211], v[236:239]
    ds_read_b32 a152, v63
    ds_read_b32 a138, v62
    v_mfma_f32_16x16x32_bf16 v[236:239], a[44:47], a[212:215], v[236:239]
    v_perm_b32 v56, v124, v35, s39
    v_perm_b32 v57, v121, v35, s36
L_pad1:
    s_cbranch_execz L_warmed
    v_mfma_f32_16x16x32_bf16 v[240:243], a[24:27], a[220:223], v[240:243]
    ds_read_b32 a139, v56
    ds_read_b32 a164, v57
    v_mfma_f32_16x16x32_bf16 v[240:243], a[44:47], a[224:227], v[240:243]
    v_perm_b32 v59, v116, v35, s37
    v_perm_b32 v58, v121, v35, s37
    v_mfma_f32_16x16x32_bf16 v[244:247], a[24:27], a[228:231], v[244:247]
    ds_read_b32 a153, v59
    ds_read_b32 a165, v58
    v_mfma_f32_16x16x32_bf16 v[244:247], a[44:47], a[236:239], v[244:247]
    buffer_load_dwordx4 v[104:107], v33, s[12:15], s42 offen sc1
    v_mfma_f32_16x16x32_bf16 v[248:251], a[24:27], a[240:243], v[248:251]
    s_waitcnt lgkmcnt(6)
    s_barrier
    v_perm_b32 v60, v121, v35, s38
    v_mfma_f32_16x16x32_bf16 v[248:251], a[44:47], a[244:247], v[248:251]
    ds_read_b32 a166, v60
    buffer_load_dwordx4 v[112:115], v33, s[12:15], s43 offen sc1
    v_mfma_f32_16x16x32_bf16 v[252:255], a[24:27], a[252:255], v[252:255]
    v_perm_b32 v62, v116, v35, s38
    v_perm_b32 v61, v121, v35, s39
    v_mfma_f32_16x16x32_bf16 v[252:255], a[44:47], a[32:35], v[252:255]
    ds_read_b32 a154, v62
    ds_read_b32 a167, v61
    v_mfma_f32_16x16x32_bf16 v[128:131], a[68:71], a[64:67], v[128:131]
    s_waitcnt lgkmcnt(6)
    v_bitop3_b32 v71, v71, v75, s76 bitop3:0x7e
    v_perm_b32 v63, v125, v35, s36
    v_mfma_f32_16x16x32_bf16 v[128:131], a[136:139], a[76:79], v[128:131]
    ds_read_b32 a168, v63
    v_cmp_ne_u32 vcc, 0, v71
    v_mfma_f32_16x16x32_bf16 v[132:135], a[68:71], a[92:95], v[132:135]
    v_perm_b32 v56, v125, v35, s37
    v_perm_b32 v57, v116, v35, s39
    v_mfma_f32_16x16x32_bf16 v[132:135], a[136:139], a[0:3], v[132:135]
    ds_read_b32 a155, v57
    ds_read_b32 a169, v56
    v_mfma_f32_16x16x32_bf16 v[136:139], a[68:71], a[4:7], v[136:139]
    ds_read_b128 a[172:175], v40 offset:0
    s_cbranch_vccnz L_slow6_0
L_back6_0:
    v_mfma_f32_16x16x32_bf16 v[136:139], a[136:139], a[8:11], v[136:139]
    v_perm_b32 v58, v125, v35, s38
    v_perm_b32 v59, v125, v35, s39
    v_mfma_f32_16x16x32_bf16 v[140:143], a[68:71], a[16:19], v[140:143]
    ds_read_b32 a170, v58
    ds_read_b32 a171, v59
    v_mfma_f32_16x16x32_bf16 v[140:143], a[136:139], a[20:23], v[140:143]
    ds_read_b128 a[80:83], v41 offset:0
    v_perm_b32 v60, v118, v35, s36
    v_mfma_f32_16x16x32_bf16 v[144:147], a[68:71], a[28:31], v[144:147]
    ds_read_b32 a84, v60
    v_perm_b32 v61, v122, v35, s36
    v_mfma_f32_16x16x32_bf16 v[144:147], a[136:139], a[36:39], v[144:147]
    ds_read_b32 a96, v61
    ds_read_b128 a[88:91], v40 offset:2048
    v_mfma_f32_16x16x32_bf16 v[148:151], a[68:71], a[40:43], v[148:151]
    ds_read_b128 a[100:103], v41 offset:2048
    v_perm_b32 v62, v122, v35, s37
    v_mfma_f32_16x16x32_bf16 v[148:151], a[136:139], a[52:55], v[148:151]
    s_waitcnt vmcnt(13)
    ds_read_b32 a97, v62
    v_bitop3_b32 v87, v87, v83, s76 bitop3:0x7e
    v_mfma_f32_16x16x32_bf16 v[152:155], a[68:71], a[56:59], v[152:155]
    v_cmp_ne_u32 vcc, 0, v87
    v_perm_b32 v63, v122, v35, s38
    v_mfma_f32_16x16x32_bf16 v[152:155], a[136:139], a[60:63], v[152:155]
    ds_read_b32 a98, v63
    v_perm_b32 v56, v118, v35, s37
    v_mfma_f32_16x16x32_bf16 v[156:159], a[68:71], a[120:123], v[156:159]
    ds_read_b32 a85, v56
    s_cbranch_vccnz L_slow2_0
L_back2_0:
    v_mfma_f32_16x16x32_bf16 v[156:159], a[136:139], a[72:75], v[156:159]
    s_waitcnt lgkmcnt(8)
    ds_read_b128 a[108:111], v40 offset:4096
    v_perm_b32 v57, v122, v35, s39
    v_mfma_f32_16x16x32_bf16 v[160:163], a[164:167], a[64:67], v[160:163]
    ds_read_b32 a99, v57
    v_perm_b32 v58, v126, v35, s36
    v_mfma_f32_16x16x32_bf16 v[160:163], a[168:171], a[76:79], v[160:163]
    ds_read_b32 a112, v58
    v_perm_b32 v59, v118, v35, s38
    v_mfma_f32_16x16x32_bf16 v[164:167], a[164:167], a[92:95], v[164:167]
    ds_read_b32 a86, v59
    ds_read_b128 a[116:119], v41 offset:4096
    v_mfma_f32_16x16x32_bf16 v[164:167], a[168:171], a[0:3], v[164:167]
    v_perm_b32 v60, v126, v35, s37
    v_perm_b32 v61, v126, v35, s38
    v_mfma_f32_16x16x32_bf16 v[168:171], a[164:167], a[4:7], v[168:171]
    ds_read_b32 a113, v60
    ds_read_b32 a114, v61
    v_mfma_f32_16x16x32_bf16 v[168:171], a[168:171], a[8:11], v[168:171]
    ds_read_b128 a[124:127], v40 offset:6144
    v_perm_b32 v62, v126, v35, s39
    v_mfma_f32_16x16x32_bf16 v[172:175], a[164:167], a[16:19], v[172:175]
    ds_read_b32 a115, v62
    v_perm_b32 v63, v118, v35, s39
    v_mfma_f32_16x16x32_bf16 v[172:175], a[168:171], a[20:23], v[172:175]
    ds_read_b32 a87, v63
    ds_read_b128 a[128:131], v41 offset:6144
    v_mfma_f32_16x16x32_bf16 v[176:179], a[164:167], a[28:31], v[176:179]
    v_perm_b32 v56, v84, v35, s36
    v_perm_b32 v57, v84, v35, s37
    v_mfma_f32_16x16x32_bf16 v[176:179], a[168:171], a[36:39], v[176:179]
    ds_read_b32 a140, v56
    ds_read_b128 a[132:135], v40 offset:8192
    v_mfma_f32_16x16x32_bf16 v[180:183], a[164:167], a[40:43], v[180:183]
    ds_read_b32 a141, v57
    v_perm_b32 v58, v68, v35, s36
    v_mfma_f32_16x16x32_bf16 v[180:183], a[168:171], a[52:55], v[180:183]
    ds_read_b32 a144, v58
    v_perm_b32 v59, v84, v35, s38
    v_mfma_f32_16x16x32_bf16 v[184:187], a[164:167], a[56:59], v[184:187]
    ds_read_b32 a142, v59
    ds_read_b128 a[148:151], v41 offset:8192
    v_mfma_f32_16x16x32_bf16 v[184:187], a[168:171], a[60:63], v[184:187]
    s_mov_b32 s44, 61440
    v_perm_b32 v60, v84, v35, s39
    v_perm_b32 v61, v68, v35, s37
    v_mfma_f32_16x16x32_bf16 v[188:191], a[164:167], a[120:123], v[188:191]
    ds_read_b32 a145, v61
    ds_read_b32 a143, v60
    v_mfma_f32_16x16x32_bf16 v[188:191], a[168:171], a[72:75], v[188:191]
    s_waitcnt lgkmcnt(10)
    ds_read_b128 a[156:159], v40 offset:10240
    v_perm_b32 v62, v80, v35, s36
    v_mfma_f32_16x16x32_bf16 v[192:195], a[96:99], a[64:67], v[192:195]
    s_mov_b32 s45, 66560
    ds_read_b32 a188, v62
    v_perm_b32 v63, v80, v35, s37
    v_mfma_f32_16x16x32_bf16 v[192:195], a[112:115], a[76:79], v[192:195]
    s_mov_b32 s40, 81920
    v_perm_b32 v56, v68, v35, s38
    v_perm_b32 v57, v68, v35, s39
    v_mfma_f32_16x16x32_bf16 v[196:199], a[96:99], a[92:95], v[196:199]
    ds_read_b32 a146, v56
    ds_read_b32 a147, v57
    v_mfma_f32_16x16x32_bf16 v[196:199], a[112:115], a[0:3], v[196:199]
    s_mov_b32 s41, 87040
    ds_read_b32 a189, v63
    ds_read_b128 a[160:163], v41 offset:10240
    v_mfma_f32_16x16x32_bf16 v[200:203], a[96:99], a[4:7], v[200:203]
    v_perm_b32 v58, v80, v35, s38
    v_perm_b32 v59, v80, v35, s39
    v_mfma_f32_16x16x32_bf16 v[200:203], a[112:115], a[8:11], v[200:203]
    ds_read_b32 a190, v58
    ds_read_b128 a[204:207], v40 offset:12288
    v_mfma_f32_16x16x32_bf16 v[204:207], a[96:99], a[16:19], v[204:207]
    ds_read_b32 a191, v59
    buffer_load_dwordx4 v[48:51], v33, s[12:15], s44 offen sc1
    v_mfma_f32_16x16x32_bf16 v[204:207], a[112:115], a[20:23], v[204:207]
    v_perm_b32 v60, v85, v35, s36
    v_perm_b32 v61, v72, v35, s36
    v_mfma_f32_16x16x32_bf16 v[208:211], a[96:99], a[28:31], v[208:211]
    ds_read_b32 a232, v61
    ds_read_b32 a216, v60
    v_mfma_f32_16x16x32_bf16 v[208:211], a[112:115], a[36:39], v[208:211]
    ds_read_b128 a[248:251], v41 offset:12288
    buffer_load_dwordx4 v[88:91], v33, s[12:15], s45 offen sc1
    v_mfma_f32_16x16x32_bf16 v[212:215], a[96:99], a[40:43], v[212:215]
    buffer_load_dwordx4 v[92:95], v32, s[12:15], s40 offen sc1
    v_mfma_f32_16x16x32_bf16 v[212:215], a[112:115], a[52:55], v[212:215]
    v_perm_b32 v62, v85, v35, s37
    v_perm_b32 v56, v85, v35, s38
    v_mfma_f32_16x16x32_bf16 v[216:219], a[96:99], a[56:59], v[216:219]
    s_add_u32 s56, s55, 1280
    ds_read_b32 a217, v62
    ds_read_b32 a218, v56
    v_mfma_f32_16x16x32_bf16 v[216:219], a[112:115], a[60:63], v[216:219]
    ds_read_b128 a[48:51], v40 offset:14336
    buffer_load_dwordx4 v[52:55], v32, s[12:15], s41 offen sc1
    v_mfma_f32_16x16x32_bf16 v[220:223], a[96:99], a[120:123], v[220:223]
    s_waitcnt lgkmcnt(7)
    ds_read_b128 a[104:107], v41 offset:14336
    v_perm_b32 v57, v85, v35, s39
    v_mfma_f32_16x16x32_bf16 v[220:223], a[112:115], a[72:75], v[220:223]
    s_add_u32 m0, s57, 65536
    ds_read_b32 a219, v57
    v_perm_b32 v63, v81, v35, s36
    v_mfma_f32_16x16x32_bf16 v[128:131], a[140:143], a[172:175], v[128:131]
    s_waitcnt lgkmcnt(8)
    ds_read_b32 a12, v63
    v_perm_b32 v58, v81, v35, s37
    v_mfma_f32_16x16x32_bf16 v[128:131], a[188:191], a[80:83], v[128:131]
    ds_read_b128 a[176:179], v42 offset:2048
    v_perm_b32 v59, v72, v35, s37
    v_mfma_f32_16x16x32_bf16 v[132:135], a[140:143], a[88:91], v[132:135]
    ds_read_b32 a233, v59
    ds_read_b32 a13, v58
    v_mfma_f32_16x16x32_bf16 v[132:135], a[188:191], a[100:103], v[132:135]
    v_perm_b32 v60, v81, v35, s38
    v_perm_b32 v61, v72, v35, s38
    v_mfma_f32_16x16x32_bf16 v[136:139], a[140:143], a[108:111], v[136:139]
    ds_read_b32 a234, v61
    ds_read_b32 a14, v60
    v_mfma_f32_16x16x32_bf16 v[136:139], a[188:191], a[116:119], v[136:139]
    ds_read_b128 a[180:183], v43 offset:2048
    v_perm_b32 v62, v81, v35, s39
    v_mfma_f32_16x16x32_bf16 v[140:143], a[140:143], a[124:127], v[140:143]
    ds_read_b32 a15, v62
    v_perm_b32 v56, v86, v35, s36
    v_mfma_f32_16x16x32_bf16 v[140:143], a[188:191], a[128:131], v[140:143]
    ds_read_b128 a[184:187], v42 offset:0
    buffer_load_dwordx4 v36, s[8:11], s56 offen offset:0 lds
    v_mfma_f32_16x16x32_bf16 v[144:147], a[140:143], a[132:135], v[144:147]
    ds_read_b32 a192, v56
    v_perm_b32 v57, v86, v35, s37
    v_mfma_f32_16x16x32_bf16 v[144:147], a[188:191], a[148:151], v[144:147]
    v_perm_b32 v63, v72, v35, s39
    v_perm_b32 v58, v69, v35, s36
    v_mfma_f32_16x16x32_bf16 v[148:151], a[140:143], a[156:159], v[148:151]
    ds_read_b32 a235, v63
    ds_read_b32 a196, v58
    v_mfma_f32_16x16x32_bf16 v[148:151], a[188:191], a[160:163], v[148:151]
    s_waitcnt vmcnt(10)
    ds_read_b32 a193, v57
    v_bitop3_b32 v101, v101, v103, s76 bitop3:0x7e
    v_mfma_f32_16x16x32_bf16 v[152:155], a[140:143], a[204:207], v[152:155]
    s_waitcnt lgkmcnt(9)
    ds_read_b128 a[200:203], v43 offset:0
    v_cmp_ne_u32 vcc, 0, v101
    v_mfma_f32_16x16x32_bf16 v[152:155], a[188:191], a[248:251], v[152:155]
    v_perm_b32 v59, v86, v35, s38
    v_perm_b32 v60, v86, v35, s39
    v_mfma_f32_16x16x32_bf16 v[156:159], a[140:143], a[48:51], v[156:159]
    ds_read_b32 a194, v59
    s_cbranch_vccnz L_slow2_2
L_back2_2:
    v_mfma_f32_16x16x32_bf16 v[156:159], a[188:191], a[104:107], v[156:159]
    ds_read_b32 a195, v60
    ds_read_b128 a[208:211], v42 offset:6144
    v_mfma_f32_16x16x32_bf16 v[160:163], a[216:219], a[172:175], v[160:163]
    s_waitcnt lgkmcnt(8)
    ds_read_b128 a[212:215], v43 offset:6144
    buffer_load_dwordx4 v37, s[8:11], s56 offen offset:1024 lds
    v_mfma_f32_16x16x32_bf16 v[160:163], a[12:15], a[80:83], v[160:163]
    v_perm_b32 v61, v82, v35, s36
    v_perm_b32 v62, v82, v35, s37
    v_mfma_f32_16x16x32_bf16 v[164:167], a[216:219], a[88:91], v[164:167]
    ds_read_b32 a220, v61
    ds_read_b32 a221, v62
    v_mfma_f32_16x16x32_bf16 v[164:167], a[12:15], a[100:103], v[164:167]
    ds_read_b128 a[224:227], v42 offset:4096
    v_perm_b32 v56, v82, v35, s38
    v_mfma_f32_16x16x32_bf16 v[168:171], a[216:219], a[108:111], v[168:171]
    s_add_u32 s3, s55, 1408
    ds_read_b32 a222, v56
    v_perm_b32 v63, v82, v35, s39
    v_mfma_f32_16x16x32_bf16 v[168:171], a[12:15], a[116:119], v[168:171]
    buffer_load_dwordx4 v38, s[8:11], s56 offen offset:2048 lds
    v_mfma_f32_16x16x32_bf16 v[172:175], a[216:219], a[124:127], v[172:175]
    ds_read_b32 a223, v63
    ds_read_b128 a[228:231], v43 offset:4096
    v_mfma_f32_16x16x32_bf16 v[172:175], a[12:15], a[128:131], v[172:175]
    v_perm_b32 v58, v100, v35, s36
    v_perm_b32 v57, v69, v35, s37
    v_mfma_f32_16x16x32_bf16 v[176:179], a[216:219], a[132:135], v[176:179]
    ds_read_b32 a197, v57
    ds_read_b32 a236, v58
    v_mfma_f32_16x16x32_bf16 v[176:179], a[12:15], a[148:151], v[176:179]
    ds_read_b128 a[240:243], v42 offset:10240
    v_perm_b32 v59, v100, v35, s37
    v_mfma_f32_16x16x32_bf16 v[180:183], a[216:219], a[156:159], v[180:183]
    s_waitcnt vmcnt(7)
    ds_read_b32 a237, v59
    buffer_load_dwordx4 v39, s[8:11], s56 offen offset:3072 lds
    v_mfma_f32_16x16x32_bf16 v[180:183], a[12:15], a[160:163], v[180:183]
    s_add_u32 m0, s57, 83968
    v_bitop3_b32 v107, v107, v115, s76 bitop3:0x7e
    v_perm_b32 v60, v100, v35, s38
    v_mfma_f32_16x16x32_bf16 v[184:187], a[216:219], a[204:207], v[184:187]
    ds_read_b32 a238, v60
    v_cmp_ne_u32 vcc, 0, v107
    v_mfma_f32_16x16x32_bf16 v[184:187], a[12:15], a[248:251], v[184:187]
    ds_read_b128 a[244:247], v43 offset:10240
    v_perm_b32 v61, v69, v35, s38
    v_mfma_f32_16x16x32_bf16 v[188:191], a[216:219], a[48:51], v[188:191]
    ds_read_b32 a198, v61
    s_cbranch_vccnz L_slow2_1
L_back2_1:
    v_mfma_f32_16x16x32_bf16 v[188:191], a[12:15], a[104:107], v[188:191]
    s_waitcnt lgkmcnt(7)
    v_perm_b32 v62, v100, v35, s39
    v_perm_b32 v56, v102, v35, s36
    v_mfma_f32_16x16x32_bf16 v[192:195], a[192:195], a[172:175], v[192:195]
    s_mov_b32 s42, 81920
    ds_read_b32 a239, v62
    ds_read_b32 a252, v56
    v_mfma_f32_16x16x32_bf16 v[192:195], a[220:223], a[80:83], v[192:195]
    ds_read_b128 a[24:27], v42 offset:8192
    buffer_load_dwordx4 v36, s[8:11], s3 offen offset:0 lds
    v_mfma_f32_16x16x32_bf16 v[196:199], a[192:195], a[88:91], v[196:199]
    v_perm_b32 v63, v102, v35, s37
    v_perm_b32 v58, v69, v35, s39
    v_mfma_f32_16x16x32_bf16 v[196:199], a[220:223], a[100:103], v[196:199]
    s_mov_b32 s43, 87040
    ds_read_b32 a199, v58
    ds_read_b32 a253, v63
    v_mfma_f32_16x16x32_bf16 v[200:203], a[192:195], a[108:111], v[200:203]
    ds_read_b128 a[32:35], v43 offset:8192
    v_perm_b32 v57, v102, v35, s38
    v_mfma_f32_16x16x32_bf16 v[200:203], a[220:223], a[116:119], v[200:203]
    ds_read_b32 a254, v57
    v_perm_b32 v59, v102, v35, s39
    v_mfma_f32_16x16x32_bf16 v[204:207], a[192:195], a[124:127], v[204:207]
    ds_read_b32 a255, v59
    ds_read_b128 a[44:47], v42 offset:14336
    v_mfma_f32_16x16x32_bf16 v[204:207], a[220:223], a[128:131], v[204:207]
    v_perm_b32 v61, v73, v35, s36
    v_perm_b32 v60, v104, v35, s36
    v_mfma_f32_16x16x32_bf16 v[208:211], a[192:195], a[132:135], v[208:211]
    ds_read_b32 a136, v61
    ds_read_b32 a68, v60
    v_mfma_f32_16x16x32_bf16 v[208:211], a[220:223], a[148:151], v[208:211]
    ds_read_b128 a[164:167], v43 offset:14336
    buffer_load_dwordx4 v37, s[8:11], s3 offen offset:1024 lds
    v_mfma_f32_16x16x32_bf16 v[212:215], a[192:195], a[156:159], v[212:215]
    s_add_u32 m0, s57, 79872
    v_perm_b32 v62, v104, v35, s37
    v_perm_b32 v56, v104, v35, s38
    v_mfma_f32_16x16x32_bf16 v[212:215], a[220:223], a[160:163], v[212:215]
    ds_read_b32 a69, v62
    buffer_load_dwordx2 v[64:65], v34, s[12:15], s42 offen sc1
    v_mfma_f32_16x16x32_bf16 v[216:219], a[192:195], a[204:207], v[216:219]
    ds_read_b32 a70, v56
    v_perm_b32 v63, v73, v35, s37
    v_mfma_f32_16x16x32_bf16 v[216:219], a[220:223], a[248:251], v[216:219]
    ds_read_b32 a137, v63
    ds_read_b128 a[168:171], v42 offset:12288
    v_mfma_f32_16x16x32_bf16 v[220:223], a[192:195], a[48:51], v[220:223]
    ds_read_b128 a[64:67], v43 offset:12288
    buffer_load_dwordx2 v[66:67], v34, s[12:15], s43 offen sc1
    v_mfma_f32_16x16x32_bf16 v[220:223], a[220:223], a[104:107], v[220:223]
    s_waitcnt lgkmcnt(8)
    buffer_load_dwordx4 v38, s[8:11], s3 offen offset:2048 lds
    v_mfma_f32_16x16x32_bf16 v[224:227], a[236:239], a[172:175], v[224:227]
    s_mov_b32 s44, 81920
    v_perm_b32 v58, v104, v35, s39
    v_perm_b32 v57, v112, v35, s36
    v_mfma_f32_16x16x32_bf16 v[224:227], a[252:255], a[80:83], v[224:227]
    ds_read_b32 a71, v58
    ds_read_b32 a76, v57
    v_mfma_f32_16x16x32_bf16 v[228:231], a[236:239], a[88:91], v[228:231]
    v_perm_b32 v60, v73, v35, s38
    v_perm_b32 v59, v112, v35, s37
    v_mfma_f32_16x16x32_bf16 v[228:231], a[252:255], a[100:103], v[228:231]
    s_mov_b32 s45, 87040
    ds_read_b32 a138, v60
    ds_read_b32 a77, v59
    v_mfma_f32_16x16x32_bf16 v[232:235], a[236:239], a[108:111], v[232:235]
    buffer_load_dwordx4 v39, s[8:11], s3 offen offset:3072 lds
    v_mfma_f32_16x16x32_bf16 v[232:235], a[252:255], a[116:119], v[232:235]
    v_perm_b32 v61, v112, v35, s38
    v_perm_b32 v62, v112, v35, s39
    v_mfma_f32_16x16x32_bf16 v[236:239], a[236:239], a[124:127], v[236:239]
    ds_read_b32 a78, v61
    ds_read_b32 a79, v62
    v_mfma_f32_16x16x32_bf16 v[236:239], a[252:255], a[128:131], v[236:239]
    v_perm_b32 v63, v73, v35, s39
    v_perm_b32 v56, v105, v35, s36
    v_mfma_f32_16x16x32_bf16 v[240:243], a[236:239], a[132:135], v[240:243]
    ds_read_b32 a139, v63
    ds_read_b32 a92, v56
    v_mfma_f32_16x16x32_bf16 v[240:243], a[252:255], a[148:151], v[240:243]
    buffer_load_dwordx4 v[108:111], v33, s[12:15], s44 offen sc1
    v_mfma_f32_16x16x32_bf16 v[244:247], a[236:239], a[156:159], v[244:247]
    v_perm_b32 v58, v105, v35, s37
    v_perm_b32 v57, v70, v35, s36
    v_mfma_f32_16x16x32_bf16 v[244:247], a[252:255], a[160:163], v[244:247]
    ds_read_b32 a0, v57
    ds_read_b32 a93, v58
    v_mfma_f32_16x16x32_bf16 v[248:251], a[236:239], a[204:207], v[248:251]
    s_waitcnt lgkmcnt(6)
    s_barrier
    v_perm_b32 v59, v105, v35, s38
    v_mfma_f32_16x16x32_bf16 v[248:251], a[252:255], a[248:251], v[248:251]
    ds_read_b32 a94, v59
    buffer_load_dwordx4 v[76:79], v33, s[12:15], s45 offen sc1
    v_mfma_f32_16x16x32_bf16 v[252:255], a[236:239], a[48:51], v[252:255]
    v_perm_b32 v60, v105, v35, s39
    v_perm_b32 v61, v113, v35, s36
    v_mfma_f32_16x16x32_bf16 v[252:255], a[252:255], a[104:107], v[252:255]
    ds_read_b32 a95, v60
    v_perm_b32 v62, v70, v35, s37
    v_mfma_f32_16x16x32_bf16 v[128:131], a[68:71], a[176:179], v[128:131]
    s_waitcnt lgkmcnt(6)
    ds_read_b32 a1, v62
    ds_read_b32 a4, v61
    v_mfma_f32_16x16x32_bf16 v[128:131], a[76:79], a[180:183], v[128:131]
    ds_read_b128 a[8:11], v40 offset:32768
    v_perm_b32 v56, v113, v35, s37
    v_mfma_f32_16x16x32_bf16 v[132:135], a[68:71], a[184:187], v[132:135]
    ds_read_b32 a5, v56
    v_perm_b32 v63, v113, v35, s38
    v_mfma_f32_16x16x32_bf16 v[132:135], a[76:79], a[200:203], v[132:135]
    v_perm_b32 v58, v70, v35, s38
    v_perm_b32 v57, v70, v35, s39
    v_mfma_f32_16x16x32_bf16 v[136:139], a[68:71], a[208:211], v[136:139]
    ds_read_b32 a2, v58
    ds_read_b32 a3, v57
    v_mfma_f32_16x16x32_bf16 v[136:139], a[76:79], a[212:215], v[136:139]
    ds_read_b32 a6, v63
    v_perm_b32 v59, v113, v35, s39
    v_mfma_f32_16x16x32_bf16 v[140:143], a[68:71], a[224:227], v[140:143]
    ds_read_b32 a7, v59
    ds_read_b128 a[16:19], v41 offset:32768
    v_mfma_f32_16x16x32_bf16 v[140:143], a[76:79], a[228:231], v[140:143]
    ds_read_b128 a[20:23], v40 offset:34816
    v_perm_b32 v60, v106, v35, s36
    v_mfma_f32_16x16x32_bf16 v[144:147], a[68:71], a[240:243], v[144:147]
    s_waitcnt vmcnt(14)
    ds_read_b32 a28, v60
    v_bitop3_b32 v51, v51, v91, s76 bitop3:0x7e
    v_mfma_f32_16x16x32_bf16 v[144:147], a[76:79], a[244:247], v[144:147]
    v_cmp_ne_u32 vcc, 0, v51
    v_perm_b32 v61, v106, v35, s37
    v_mfma_f32_16x16x32_bf16 v[148:151], a[68:71], a[24:27], v[148:151]
    ds_read_b32 a29, v61
    ds_read_b128 a[36:39], v41 offset:34816
    v_mfma_f32_16x16x32_bf16 v[148:151], a[76:79], a[32:35], v[148:151]
    s_waitcnt vmcnt(12)
    v_bitop3_b32 v95, v95, v55, s76 bitop3:0x7e
    s_cbranch_vccnz L_slow6_1
L_back6_1:
    v_mfma_f32_16x16x32_bf16 v[152:155], a[68:71], a[44:47], v[152:155]
    v_cmp_ne_u32 vcc, 0, v95
    v_perm_b32 v62, v106, v35, s38
    v_mfma_f32_16x16x32_bf16 v[152:155], a[76:79], a[164:167], v[152:155]
    ds_read_b32 a30, v62
    v_perm_b32 v56, v106, v35, s39
    v_mfma_f32_16x16x32_bf16 v[156:159], a[68:71], a[168:171], v[156:159]
    ds_read_b32 a31, v56
    s_cbranch_vccnz L_slow3_0
L_back3_0:
    v_mfma_f32_16x16x32_bf16 v[156:159], a[76:79], a[64:67], v[156:159]
    s_waitcnt lgkmcnt(6)
    ds_read_b128 a[40:43], v40 offset:36864
    v_perm_b32 v58, v74, v35, s36
    v_mfma_f32_16x16x32_bf16 v[160:163], a[92:95], a[176:179], v[160:163]
    ds_read_b32 a52, v58
    v_perm_b32 v57, v114, v35, s36
    v_mfma_f32_16x16x32_bf16 v[160:163], a[4:7], a[180:183], v[160:163]
    ds_read_b32 a60, v57
    ds_read_b128 a[56:59], v41 offset:36864
    v_mfma_f32_16x16x32_bf16 v[164:167], a[92:95], a[184:187], v[164:167]
    v_perm_b32 v63, v114, v35, s37
    v_perm_b32 v59, v114, v35, s38
    v_mfma_f32_16x16x32_bf16 v[164:167], a[4:7], a[200:203], v[164:167]
    ds_read_b32 a61, v63
    v_perm_b32 v60, v74, v35, s37
    v_mfma_f32_16x16x32_bf16 v[168:171], a[92:95], a[208:211], v[168:171]
    ds_read_b32 a53, v60
    ds_read_b32 a62, v59
    v_mfma_f32_16x16x32_bf16 v[168:171], a[4:7], a[212:215], v[168:171]
    ds_read_b128 a[120:123], v40 offset:38912
    v_perm_b32 v61, v114, v35, s39
    v_mfma_f32_16x16x32_bf16 v[172:175], a[92:95], a[224:227], v[172:175]
    ds_read_b32 a63, v61
    ds_read_b128 a[96:99], v41 offset:38912
    v_mfma_f32_16x16x32_bf16 v[172:175], a[4:7], a[228:231], v[172:175]
    v_perm_b32 v62, v92, v35, s36
    v_perm_b32 v56, v74, v35, s38
    v_mfma_f32_16x16x32_bf16 v[176:179], a[92:95], a[240:243], v[176:179]
    ds_read_b32 a54, v56
    ds_read_b32 a72, v62
    v_mfma_f32_16x16x32_bf16 v[176:179], a[4:7], a[244:247], v[176:179]
    ds_read_b128 a[112:115], v40 offset:40960
    v_perm_b32 v58, v92, v35, s37
    v_mfma_f32_16x16x32_bf16 v[180:183], a[92:95], a[24:27], v[180:183]
    ds_read_b32 a73, v58
    v_perm_b32 v57, v92, v35, s38
    v_mfma_f32_16x16x32_bf16 v[180:183], a[4:7], a[32:35], v[180:183]
    v_perm_b32 v63, v74, v35, s39
    v_perm_b32 v59, v48, v35, s36
    v_mfma_f32_16x16x32_bf16 v[184:187], a[92:95], a[44:47], v[184:187]
    ds_read_b32 a55, v63
    ds_read_b32 a140, v59
    v_mfma_f32_16x16x32_bf16 v[184:187], a[4:7], a[164:167], v[184:187]
    ds_read_b32 a74, v57
    ds_read_b128 a[188:191], v41 offset:40960
    v_mfma_f32_16x16x32_bf16 v[188:191], a[92:95], a[168:171], v[188:191]
    v_perm_b32 v60, v92, v35, s39
    v_perm_b32 v61, v52, v35, s36
    v_mfma_f32_16x16x32_bf16 v[188:191], a[4:7], a[64:67], v[188:191]
    s_waitcnt lgkmcnt(8)
    ds_read_b32 a75, v60
    ds_read_b128 a[216:219], v40 offset:43008
    v_mfma_f32_16x16x32_bf16 v[192:195], a[28:31], a[176:179], v[192:195]
    s_mov_b32 s40, 102400
    ds_read_b32 a12, v61
    v_perm_b32 v62, v52, v35, s37
    v_mfma_f32_16x16x32_bf16 v[192:195], a[60:63], a[180:183], v[192:195]
    v_perm_b32 v56, v48, v35, s37
    v_perm_b32 v58, v48, v35, s38
    v_mfma_f32_16x16x32_bf16 v[196:199], a[28:31], a[184:187], v[196:199]
    ds_read_b32 a141, v56
    ds_read_b32 a142, v58
    v_mfma_f32_16x16x32_bf16 v[196:199], a[60:63], a[200:203], v[196:199]
    s_mov_b32 s41, 107520
    ds_read_b32 a13, v62
    ds_read_b128 a[192:195], v41 offset:43008
    v_mfma_f32_16x16x32_bf16 v[200:203], a[28:31], a[208:211], v[200:203]
    s_mov_b32 s42, 143360
    v_perm_b32 v63, v52, v35, s38
    v_perm_b32 v59, v52, v35, s39
    v_mfma_f32_16x16x32_bf16 v[200:203], a[60:63], a[212:215], v[200:203]
    ds_read_b32 a14, v63
    ds_read_b128 a[220:223], v40 offset:45056
    v_mfma_f32_16x16x32_bf16 v[204:207], a[28:31], a[224:227], v[204:207]
    ds_read_b32 a15, v59
    v_perm_b32 v57, v93, v35, s36
    v_mfma_f32_16x16x32_bf16 v[204:207], a[60:63], a[228:231], v[204:207]
    s_mov_b32 s43, 148480
    v_perm_b32 v60, v48, v35, s39
    v_perm_b32 v61, v88, v35, s36
    v_mfma_f32_16x16x32_bf16 v[208:211], a[28:31], a[240:243], v[208:211]
    ds_read_b32 a143, v60
    ds_read_b32 a172, v57
    v_mfma_f32_16x16x32_bf16 v[208:211], a[60:63], a[244:247], v[208:211]
    ds_read_b32 a88, v61
    ds_read_b128 a[80:83], v41 offset:45056
    v_mfma_f32_16x16x32_bf16 v[212:215], a[28:31], a[24:27], v[212:215]
    buffer_load_dwordx4 v[96:99], v32, s[12:15], s40 offen sc1
    v_mfma_f32_16x16x32_bf16 v[212:215], a[60:63], a[32:35], v[212:215]
    v_perm_b32 v56, v93, v35, s37
    v_perm_b32 v58, v93, v35, s38
    v_mfma_f32_16x16x32_bf16 v[216:219], a[28:31], a[44:47], v[216:219]
    s_add_u32 s56, s55, 1536
    ds_read_b32 a173, v56
    ds_read_b32 a174, v58
    v_mfma_f32_16x16x32_bf16 v[216:219], a[60:63], a[164:167], v[216:219]
    ds_read_b128 a[100:103], v40 offset:47104
    buffer_load_dwordx4 v[120:123], v32, s[12:15], s41 offen sc1
L_pad2:
    s_cbranch_execz L_pad3
    v_mfma_f32_16x16x32_bf16 v[220:223], a[28:31], a[168:171], v[220:223]
    s_waitcnt lgkmcnt(8)
    ds_read_b128 a[108:111], v41 offset:47104
    buffer_load_dwordx2 v[124:125], v34, s[12:15], s42 offen sc1
    v_mfma_f32_16x16x32_bf16 v[220:223], a[60:63], a[64:67], v[220:223]
    s_add_u32 m0, s57, 0
    v_perm_b32 v62, v93, v35, s39
    v_perm_b32 v63, v53, v35, s36
    v_mfma_f32_16x16x32_bf16 v[128:131], a[72:75], a[8:11], v[128:131]
    s_waitcnt lgkmcnt(8)
    ds_read_b32 a175, v62
    ds_read_b32 a116, v63
    v_mfma_f32_16x16x32_bf16 v[128:131], a[12:15], a[16:19], v[128:131]
    ds_read_b128 a[124:127], v42 offset:34816
    buffer_load_dwordx2 v[126:127], v34, s[12:15], s43 offen sc1
    v_mfma_f32_16x16x32_bf16 v[132:135], a[72:75], a[20:23], v[132:135]
    v_perm_b32 v59, v53, v35, s37
    v_perm_b32 v57, v53, v35, s38
    v_mfma_f32_16x16x32_bf16 v[132:135], a[12:15], a[36:39], v[132:135]
    ds_read_b32 a117, v59
    buffer_load_dwordx4 v36, s[8:11], s56 offen offset:0 lds
    v_mfma_f32_16x16x32_bf16 v[136:139], a[72:75], a[40:43], v[136:139]
    ds_read_b32 a118, v57
    v_perm_b32 v60, v53, v35, s39
    v_mfma_f32_16x16x32_bf16 v[136:139], a[12:15], a[56:59], v[136:139]
    ds_read_b128 a[128:131], v43 offset:34816
    v_perm_b32 v61, v88, v35, s37
    v_mfma_f32_16x16x32_bf16 v[140:143], a[72:75], a[120:123], v[140:143]
    ds_read_b32 a89, v61
    ds_read_b32 a119, v60
    v_mfma_f32_16x16x32_bf16 v[140:143], a[12:15], a[96:99], v[140:143]
    ds_read_b128 a[132:135], v42 offset:32768
    v_perm_b32 v56, v94, v35, s36
    v_mfma_f32_16x16x32_bf16 v[144:147], a[72:75], a[112:115], v[144:147]
    ds_read_b32 a148, v56
    v_perm_b32 v58, v94, v35, s37
    v_mfma_f32_16x16x32_bf16 v[144:147], a[12:15], a[188:191], v[144:147]
    buffer_load_dwordx4 v37, s[8:11], s56 offen offset:1024 lds
    v_mfma_f32_16x16x32_bf16 v[148:151], a[72:75], a[216:219], v[148:151]
    ds_read_b32 a149, v58
    ds_read_b128 a[156:159], v43 offset:32768
    v_mfma_f32_16x16x32_bf16 v[148:151], a[12:15], a[192:195], v[148:151]
    s_waitcnt vmcnt(10)
    v_bitop3_b32 v65, v65, v67, s76 bitop3:0x7e
    v_perm_b32 v62, v94, v35, s38
    v_mfma_f32_16x16x32_bf16 v[152:155], a[72:75], a[220:223], v[152:155]
    s_waitcnt lgkmcnt(8)
    ds_read_b32 a150, v62
    v_cmp_ne_u32 vcc, 0, v65
    v_mfma_f32_16x16x32_bf16 v[152:155], a[12:15], a[80:83], v[152:155]
    ds_read_b128 a[160:163], v42 offset:38912
    v_perm_b32 v63, v94, v35, s39
    v_mfma_f32_16x16x32_bf16 v[156:159], a[72:75], a[100:103], v[156:159]
    ds_read_b32 a151, v63
    s_cbranch_vccnz L_slow3_2
L_back3_2:
    v_mfma_f32_16x16x32_bf16 v[156:159], a[12:15], a[108:111], v[156:159]
    v_perm_b32 v59, v54, v35, s36
    v_perm_b32 v57, v88, v35, s38
    v_mfma_f32_16x16x32_bf16 v[160:163], a[172:175], a[8:11], v[160:163]
    s_waitcnt lgkmcnt(6)
    ds_read_b32 a90, v57
    ds_read_b32 a204, v59
    v_mfma_f32_16x16x32_bf16 v[160:163], a[116:119], a[16:19], v[160:163]
    ds_read_b128 a[248:251], v43 offset:38912
    v_perm_b32 v60, v54, v35, s37
    v_mfma_f32_16x16x32_bf16 v[164:167], a[172:175], a[20:23], v[164:167]
    ds_read_b32 a205, v60
    v_perm_b32 v61, v54, v35, s38
    v_mfma_f32_16x16x32_bf16 v[164:167], a[116:119], a[36:39], v[164:167]
    ds_read_b128 a[48:51], v42 offset:36864
    buffer_load_dwordx4 v38, s[8:11], s56 offen offset:2048 lds
    v_mfma_f32_16x16x32_bf16 v[168:171], a[172:175], a[40:43], v[168:171]
    s_add_u32 s3, s55, 1664
    ds_read_b32 a206, v61
    v_perm_b32 v56, v54, v35, s39
    v_mfma_f32_16x16x32_bf16 v[168:171], a[116:119], a[56:59], v[168:171]
    v_perm_b32 v58, v88, v35, s39
    v_perm_b32 v62, v49, v35, s36
    v_mfma_f32_16x16x32_bf16 v[172:175], a[172:175], a[120:123], v[172:175]
    ds_read_b32 a91, v58
    ds_read_b32 a236, v62
    v_mfma_f32_16x16x32_bf16 v[172:175], a[116:119], a[96:99], v[172:175]
    ds_read_b32 a207, v56
    ds_read_b128 a[104:107], v43 offset:36864
    v_mfma_f32_16x16x32_bf16 v[176:179], a[172:175], a[112:115], v[176:179]
    v_perm_b32 v63, v64, v35, s36
    v_perm_b32 v59, v64, v35, s37
    v_mfma_f32_16x16x32_bf16 v[176:179], a[116:119], a[188:191], v[176:179]
    ds_read_b32 a68, v63
    ds_read_b128 a[252:255], v42 offset:43008
    v_mfma_f32_16x16x32_bf16 v[180:183], a[172:175], a[216:219], v[180:183]
    s_waitcnt vmcnt(7)
    ds_read_b32 a69, v59
    buffer_load_dwordx4 v39, s[8:11], s56 offen offset:3072 lds
    v_mfma_f32_16x16x32_bf16 v[180:183], a[116:119], a[192:195], v[180:183]
    s_add_u32 m0, s57, 18432
    v_bitop3_b32 v111, v111, v79, s76 bitop3:0x7e
    v_perm_b32 v57, v64, v35, s38
    v_mfma_f32_16x16x32_bf16 v[184:187], a[172:175], a[220:223], v[184:187]
    s_mov_b32 s44, 143360
    ds_read_b32 a70, v57
    v_cmp_ne_u32 vcc, 0, v111
    v_mfma_f32_16x16x32_bf16 v[184:187], a[116:119], a[80:83], v[184:187]
    ds_read_b128 a[76:79], v43 offset:43008
    v_perm_b32 v60, v64, v35, s39
    v_mfma_f32_16x16x32_bf16 v[188:191], a[172:175], a[100:103], v[188:191]
    ds_read_b32 a71, v60
    s_cbranch_vccnz L_slow3_1
L_back3_1:
    v_mfma_f32_16x16x32_bf16 v[188:191], a[116:119], a[108:111], v[188:191]
    s_waitcnt lgkmcnt(7)
    s_mov_b32 s45, 148480
    v_perm_b32 v61, v66, v35, s36
    v_perm_b32 v58, v49, v35, s37
    v_mfma_f32_16x16x32_bf16 v[192:195], a[148:151], a[8:11], v[192:195]
    s_mov_b32 s40, 102400
    ds_read_b32 a237, v58
    ds_read_b32 a92, v61
    v_mfma_f32_16x16x32_bf16 v[192:195], a[204:207], a[16:19], v[192:195]
    ds_read_b128 a[4:7], v42 offset:40960
    buffer_load_dwordx4 v36, s[8:11], s3 offen offset:0 lds
    v_mfma_f32_16x16x32_bf16 v[196:199], a[148:151], a[20:23], v[196:199]
    ds_read_b128 a[176:179], v43 offset:40960
    v_perm_b32 v62, v66, v35, s37
    v_mfma_f32_16x16x32_bf16 v[196:199], a[204:207], a[36:39], v[196:199]
    s_mov_b32 s41, 107520
    ds_read_b32 a93, v62
    v_perm_b32 v56, v66, v35, s38
    v_mfma_f32_16x16x32_bf16 v[200:203], a[148:151], a[40:43], v[200:203]
    ds_read_b32 a94, v56
    v_perm_b32 v63, v66, v35, s39
    v_mfma_f32_16x16x32_bf16 v[200:203], a[204:207], a[56:59], v[200:203]
    ds_read_b128 a[180:183], v42 offset:47104
    v_perm_b32 v59, v49, v35, s38
    v_mfma_f32_16x16x32_bf16 v[204:207], a[148:151], a[120:123], v[204:207]
    ds_read_b32 a238, v59
    ds_read_b32 a95, v63
    v_mfma_f32_16x16x32_bf16 v[204:207], a[204:207], a[96:99], v[204:207]
    buffer_load_dwordx4 v[116:119], v32, s[12:15], s44 offen sc1
    v_mfma_f32_16x16x32_bf16 v[208:211], a[148:151], a[112:115], v[208:211]
    ds_read_b128 a[184:187], v43 offset:47104
    buffer_load_dwordx4 v37, s[8:11], s3 offen offset:1024 lds
    v_mfma_f32_16x16x32_bf16 v[208:211], a[204:207], a[188:191], v[208:211]
    s_add_u32 m0, s57, 14336
    v_perm_b32 v57, v108, v35, s36
    v_perm_b32 v60, v108, v35, s37
    v_mfma_f32_16x16x32_bf16 v[212:215], a[148:151], a[216:219], v[212:215]
    ds_read_b32 a200, v57
    buffer_load_dwordx4 v[84:87], v32, s[12:15], s45 offen sc1
    v_mfma_f32_16x16x32_bf16 v[212:215], a[204:207], a[192:195], v[212:215]
    ds_read_b32 a201, v60
    buffer_load_dwordx2 v[80:81], v34, s[12:15], s40 offen sc1
    v_mfma_f32_16x16x32_bf16 v[216:219], a[148:151], a[220:223], v[216:219]
    v_perm_b32 v58, v49, v35, s39
    v_perm_b32 v61, v108, v35, s38
    v_mfma_f32_16x16x32_bf16 v[216:219], a[204:207], a[80:83], v[216:219]
    ds_read_b32 a239, v58
    ds_read_b32 a202, v61
    v_mfma_f32_16x16x32_bf16 v[220:223], a[148:151], a[100:103], v[220:223]
    ds_read_b128 a[208:211], v42 offset:45056
    buffer_load_dwordx2 v[82:83], v34, s[12:15], s41 offen sc1
    v_mfma_f32_16x16x32_bf16 v[220:223], a[204:207], a[108:111], v[220:223]
    s_waitcnt lgkmcnt(6)
    ds_read_b128 a[212:215], v43 offset:45056
    buffer_load_dwordx4 v38, s[8:11], s3 offen offset:2048 lds
    v_mfma_f32_16x16x32_bf16 v[224:227], a[68:71], a[8:11], v[224:227]
    s_mov_b32 s42, 102400
    v_perm_b32 v62, v108, v35, s39
    v_perm_b32 v56, v89, v35, s36
    v_mfma_f32_16x16x32_bf16 v[224:227], a[92:95], a[16:19], v[224:227]
    ds_read_b32 a224, v56
    ds_read_b32 a203, v62
    v_mfma_f32_16x16x32_bf16 v[228:231], a[68:71], a[20:23], v[228:231]
    v_perm_b32 v63, v76, v35, s36
    v_perm_b32 v59, v76, v35, s37
    v_mfma_f32_16x16x32_bf16 v[228:231], a[92:95], a[36:39], v[228:231]
    s_mov_b32 s43, 107520
    ds_read_b32 a228, v63
    ds_read_b32 a229, v59
    v_mfma_f32_16x16x32_bf16 v[232:235], a[68:71], a[40:43], v[232:235]
    buffer_load_dwordx4 v39, s[8:11], s3 offen offset:3072 lds
    v_mfma_f32_16x16x32_bf16 v[232:235], a[92:95], a[56:59], v[232:235]
    v_perm_b32 v57, v76, v35, s38
    v_perm_b32 v60, v89, v35, s37
    v_mfma_f32_16x16x32_bf16 v[236:239], a[68:71], a[120:123], v[236:239]
    ds_read_b32 a225, v60
    ds_read_b32 a230, v57
    v_mfma_f32_16x16x32_bf16 v[236:239], a[92:95], a[96:99], v[236:239]
    v_perm_b32 v61, v76, v35, s39
    v_perm_b32 v58, v109, v35, s36
    v_mfma_f32_16x16x32_bf16 v[240:243], a[68:71], a[112:115], v[240:243]
    ds_read_b32 a231, v61
    ds_read_b32 a240, v58
    v_mfma_f32_16x16x32_bf16 v[240:243], a[92:95], a[188:191], v[240:243]
    v_perm_b32 v56, v89, v35, s38
    v_perm_b32 v62, v109, v35, s37
    v_mfma_f32_16x16x32_bf16 v[244:247], a[68:71], a[216:219], v[244:247]
    ds_read_b32 a226, v56
    ds_read_b32 a241, v62
    v_mfma_f32_16x16x32_bf16 v[244:247], a[92:95], a[192:195], v[244:247]
    buffer_load_dwordx4 v[100:103], v33, s[12:15], s42 offen sc1
    v_mfma_f32_16x16x32_bf16 v[248:251], a[68:71], a[220:223], v[248:251]
    s_waitcnt lgkmcnt(6)
    s_barrier
    v_perm_b32 v63, v109, v35, s38
    v_mfma_f32_16x16x32_bf16 v[248:251], a[92:95], a[80:83], v[248:251]
    ds_read_b32 a242, v63
    buffer_load_dwordx4 v[68:71], v33, s[12:15], s43 offen sc1
    v_mfma_f32_16x16x32_bf16 v[252:255], a[68:71], a[100:103], v[252:255]
    v_perm_b32 v59, v109, v35, s39
    v_perm_b32 v57, v89, v35, s39
    v_mfma_f32_16x16x32_bf16 v[252:255], a[92:95], a[108:111], v[252:255]
    ds_read_b32 a227, v57
    ds_read_b32 a243, v59
    v_mfma_f32_16x16x32_bf16 v[128:131], a[200:203], a[124:127], v[128:131]
    s_waitcnt lgkmcnt(6)
    v_perm_b32 v60, v77, v35, s36
    v_perm_b32 v61, v77, v35, s37
    v_mfma_f32_16x16x32_bf16 v[128:131], a[228:231], a[128:131], v[128:131]
    ds_read_b32 a24, v60
    ds_read_b128 a[244:247], v44 offset:0
    v_mfma_f32_16x16x32_bf16 v[132:135], a[200:203], a[132:135], v[132:135]
    ds_read_b32 a25, v61
    v_perm_b32 v58, v50, v35, s36
    v_mfma_f32_16x16x32_bf16 v[132:135], a[228:231], a[156:159], v[132:135]
    ds_read_b32 a32, v58
    v_perm_b32 v62, v77, v35, s38
    v_mfma_f32_16x16x32_bf16 v[136:139], a[200:203], a[160:163], v[136:139]
    ds_read_b32 a26, v62
    v_perm_b32 v56, v77, v35, s39
    v_mfma_f32_16x16x32_bf16 v[136:139], a[228:231], a[248:251], v[136:139]
    ds_read_b128 a[44:47], v45 offset:0
    v_perm_b32 v63, v50, v35, s37
    v_mfma_f32_16x16x32_bf16 v[140:143], a[200:203], a[48:51], v[140:143]
    ds_read_b32 a33, v63
    ds_read_b32 a27, v56
    v_mfma_f32_16x16x32_bf16 v[140:143], a[228:231], a[104:107], v[140:143]
    ds_read_b128 a[164:167], v44 offset:2048
    v_perm_b32 v59, v110, v35, s36
    v_mfma_f32_16x16x32_bf16 v[144:147], a[200:203], a[252:255], v[144:147]
    ds_read_b32 a168, v59
    v_perm_b32 v57, v110, v35, s37
    v_mfma_f32_16x16x32_bf16 v[144:147], a[228:231], a[76:79], v[144:147]
    v_perm_b32 v60, v50, v35, s38
    v_perm_b32 v61, v50, v35, s39
    v_mfma_f32_16x16x32_bf16 v[148:151], a[200:203], a[4:7], v[148:151]
    ds_read_b32 a34, v60
    ds_read_b32 a35, v61
    v_mfma_f32_16x16x32_bf16 v[148:151], a[228:231], a[176:179], v[148:151]
    s_waitcnt vmcnt(16)
    ds_read_b32 a169, v57
    v_bitop3_b32 v99, v99, v123, s76 bitop3:0x7e
    v_mfma_f32_16x16x32_bf16 v[152:155], a[200:203], a[180:183], v[152:155]
    ds_read_b128 a[28:31], v45 offset:2048
    v_cmp_ne_u32 vcc, 0, v99
    v_mfma_f32_16x16x32_bf16 v[152:155], a[228:231], a[184:187], v[152:155]
    v_perm_b32 v58, v110, v35, s38
    v_perm_b32 v62, v110, v35, s39
    v_mfma_f32_16x16x32_bf16 v[156:159], a[200:203], a[208:211], v[156:159]
    ds_read_b32 a170, v58
    s_cbranch_vccnz L_slow4_0
L_back4_0:
    v_mfma_f32_16x16x32_bf16 v[156:159], a[228:231], a[212:215], v[156:159]
    s_waitcnt lgkmcnt(7)
    ds_read_b32 a171, v62
    ds_read_b128 a[64:67], v44 offset:4096
    v_mfma_f32_16x16x32_bf16 v[160:163], a[240:243], a[124:127], v[160:163]
    s_waitcnt vmcnt(14)
    v_bitop3_b32 v125, v125, v127, s76 bitop3:0x7e
    v_perm_b32 v56, v78, v35, s36
    v_mfma_f32_16x16x32_bf16 v[160:163], a[24:27], a[128:131], v[160:163]
    ds_read_b32 a60, v56
    v_cmp_ne_u32 vcc, 0, v125
    v_mfma_f32_16x16x32_bf16 v[164:167], a[240:243], a[132:135], v[164:167]
    ds_read_b128 a[72:75], v45 offset:4096
    v_perm_b32 v63, v78, v35, s37
    v_mfma_f32_16x16x32_bf16 v[164:167], a[24:27], a[156:159], v[164:167]
    ds_read_b32 a61, v63
    s_cbranch_vccnz L_slow7_2
L_back7_2:
    v_mfma_f32_16x16x32_bf16 v[168:171], a[240:243], a[160:163], v[168:171]
    ds_read_b128 a[12:15], v44 offset:6144
    v_perm_b32 v59, v78, v35, s38
    v_mfma_f32_16x16x32_bf16 v[168:171], a[24:27], a[248:251], v[168:171]
    ds_read_b32 a62, v59
    v_perm_b32 v60, v78, v35, s39
    v_mfma_f32_16x16x32_bf16 v[172:175], a[240:243], a[48:51], v[172:175]
    ds_read_b32 a63, v60
    v_perm_b32 v61, v90, v35, s36
    v_mfma_f32_16x16x32_bf16 v[172:175], a[24:27], a[104:107], v[172:175]
    ds_read_b32 a116, v61
    ds_read_b128 a[172:175], v45 offset:6144
    v_mfma_f32_16x16x32_bf16 v[176:179], a[240:243], a[252:255], v[176:179]
    v_perm_b32 v57, v96, v35, s36
    v_perm_b32 v58, v96, v35, s37
    v_mfma_f32_16x16x32_bf16 v[176:179], a[24:27], a[76:79], v[176:179]
    ds_read_b32 a204, v57
    ds_read_b128 a[148:151], v44 offset:8192
    v_mfma_f32_16x16x32_bf16 v[180:183], a[240:243], a[4:7], v[180:183]
    ds_read_b32 a205, v58
    v_perm_b32 v62, v90, v35, s37
    v_mfma_f32_16x16x32_bf16 v[180:183], a[24:27], a[176:179], v[180:183]
    ds_read_b32 a117, v62
    v_perm_b32 v56, v96, v35, s38
    v_mfma_f32_16x16x32_bf16 v[184:187], a[240:243], a[180:183], v[184:187]
    ds_read_b32 a206, v56
    ds_read_b128 a[8:11], v45 offset:8192
    v_mfma_f32_16x16x32_bf16 v[184:187], a[24:27], a[184:187], v[184:187]
    v_perm_b32 v63, v96, v35, s39
    v_perm_b32 v59, v90, v35, s38
    v_mfma_f32_16x16x32_bf16 v[188:191], a[240:243], a[208:211], v[188:191]
    ds_read_b32 a118, v59
    ds_read_b32 a207, v63
    v_mfma_f32_16x16x32_bf16 v[188:191], a[24:27], a[212:215], v[188:191]
    s_waitcnt lgkmcnt(10)
    ds_read_b128 a[16:19], v44 offset:10240
    v_perm_b32 v60, v120, v35, s36
    v_mfma_f32_16x16x32_bf16 v[192:195], a[168:171], a[124:127], v[192:195]
    s_mov_b32 s44, 122880
    ds_read_b32 a20, v60
    v_perm_b32 v61, v120, v35, s37
    v_mfma_f32_16x16x32_bf16 v[192:195], a[60:63], a[128:131], v[192:195]
    v_perm_b32 v57, v90, v35, s39
    v_perm_b32 v58, v124, v35, s36
    v_mfma_f32_16x16x32_bf16 v[196:199], a[168:171], a[132:135], v[196:199]
    ds_read_b32 a119, v57
    ds_read_b32 a36, v58
    v_mfma_f32_16x16x32_bf16 v[196:199], a[60:63], a[156:159], v[196:199]
    s_mov_b32 s45, 128000
    ds_read_b32 a21, v61
    ds_read_b128 a[40:43], v45 offset:10240
    v_mfma_f32_16x16x32_bf16 v[200:203], a[168:171], a[160:163], v[200:203]
    v_perm_b32 v62, v120, v35, s38
    v_perm_b32 v56, v120, v35, s39
    v_mfma_f32_16x16x32_bf16 v[200:203], a[60:63], a[248:251], v[200:203]
    ds_read_b32 a22, v62
    ds_read_b128 a[56:59], v44 offset:12288
    v_mfma_f32_16x16x32_bf16 v[204:207], a[168:171], a[48:51], v[204:207]
    ds_read_b32 a23, v56
    v_perm_b32 v63, v97, v35, s36
    v_mfma_f32_16x16x32_bf16 v[204:207], a[60:63], a[104:107], v[204:207]
    buffer_load_dwordx4 v[104:107], v32, s[12:15], s44 offen sc1
    v_mfma_f32_16x16x32_bf16 v[208:211], a[168:171], a[252:255], v[208:211]
    ds_read_b32 a96, v63
    ds_read_b128 a[120:123], v45 offset:12288
    v_mfma_f32_16x16x32_bf16 v[208:211], a[60:63], a[76:79], v[208:211]
    v_perm_b32 v59, v97, v35, s37
    v_perm_b32 v60, v124, v35, s37
    v_mfma_f32_16x16x32_bf16 v[212:215], a[168:171], a[4:7], v[212:215]
    ds_read_b32 a37, v60
    ds_read_b32 a97, v59
    v_mfma_f32_16x16x32_bf16 v[212:215], a[60:63], a[176:179], v[212:215]
    ds_read_b128 a[112:115], v44 offset:14336
    v_perm_b32 v57, v97, v35, s38
    v_mfma_f32_16x16x32_bf16 v[216:219], a[168:171], a[180:183], v[216:219]
    s_add_u32 s56, s55, 768
    ds_read_b32 a98, v57
    v_perm_b32 v58, v97, v35, s39
    v_mfma_f32_16x16x32_bf16 v[216:219], a[60:63], a[184:187], v[216:219]
    buffer_load_dwordx4 v[112:115], v32, s[12:15], s45 offen sc1
    v_mfma_f32_16x16x32_bf16 v[220:223], a[168:171], a[208:211], v[220:223]
    s_waitcnt lgkmcnt(7)
    ds_read_b32 a99, v58
    ds_read_b128 a[188:191], v45 offset:14336
    v_mfma_f32_16x16x32_bf16 v[220:223], a[60:63], a[212:215], v[220:223]
    s_add_u32 m0, s57, 32768
    v_perm_b32 v61, v121, v35, s36
    v_perm_b32 v62, v124, v35, s38
    v_mfma_f32_16x16x32_bf16 v[128:131], a[204:207], a[244:247], v[128:131]
    s_waitcnt lgkmcnt(8)
    ds_read_b32 a38, v62
    ds_read_b32 a216, v61
    v_mfma_f32_16x16x32_bf16 v[128:131], a[20:23], a[44:47], v[128:131]
    ds_read_b128 a[192:195], v46 offset:2048
    v_perm_b32 v56, v121, v35, s37
    v_mfma_f32_16x16x32_bf16 v[132:135], a[204:207], a[164:167], v[132:135]
    ds_read_b32 a217, v56
    v_perm_b32 v63, v121, v35, s38
    v_mfma_f32_16x16x32_bf16 v[132:135], a[20:23], a[28:31], v[132:135]
    v_perm_b32 v59, v124, v35, s39
    v_perm_b32 v60, v126, v35, s36
    v_mfma_f32_16x16x32_bf16 v[136:139], a[204:207], a[64:67], v[136:139]
    ds_read_b32 a39, v59
    ds_read_b32 a220, v60
    v_mfma_f32_16x16x32_bf16 v[136:139], a[20:23], a[72:75], v[136:139]
    ds_read_b32 a218, v63
    v_perm_b32 v57, v121, v35, s39
    v_mfma_f32_16x16x32_bf16 v[140:143], a[204:207], a[12:15], v[140:143]
    ds_read_b32 a219, v57
    ds_read_b128 a[80:83], v47 offset:2048
    v_mfma_f32_16x16x32_bf16 v[140:143], a[20:23], a[172:175], v[140:143]
    s_waitcnt vmcnt(8)
    v_bitop3_b32 v119, v119, v87, s76 bitop3:0x7e
    v_perm_b32 v58, v98, v35, s36
    v_mfma_f32_16x16x32_bf16 v[144:147], a[204:207], a[148:151], v[144:147]
    ds_read_b32 a100, v58
    v_cmp_ne_u32 vcc, 0, v119
    v_mfma_f32_16x16x32_bf16 v[144:147], a[20:23], a[8:11], v[144:147]
    ds_read_b128 a[68:71], v46 offset:0
    buffer_load_dwordx4 v36, s[8:11], s56 offen offset:0 lds
    v_mfma_f32_16x16x32_bf16 v[148:151], a[204:207], a[16:19], v[148:151]
    v_perm_b32 v61, v98, v35, s37
    s_cbranch_vccnz L_slow7_0
L_back7_0:
    v_mfma_f32_16x16x32_bf16 v[148:151], a[20:23], a[40:43], v[148:151]
    s_waitcnt vmcnt(7)
    ds_read_b32 a101, v61
    v_bitop3_b32 v81, v81, v83, s76 bitop3:0x7e
    v_mfma_f32_16x16x32_bf16 v[152:155], a[204:207], a[56:59], v[152:155]
    s_waitcnt lgkmcnt(8)
    ds_read_b128 a[108:111], v47 offset:0
    v_cmp_ne_u32 vcc, 0, v81
    v_mfma_f32_16x16x32_bf16 v[152:155], a[20:23], a[120:123], v[152:155]
    v_perm_b32 v62, v98, v35, s38
    v_perm_b32 v56, v98, v35, s39
    v_mfma_f32_16x16x32_bf16 v[156:159], a[204:207], a[112:115], v[156:159]
    ds_read_b32 a102, v62
    s_cbranch_vccnz L_slow4_2
L_back4_2:
    v_mfma_f32_16x16x32_bf16 v[156:159], a[20:23], a[188:191], v[156:159]
    ds_read_b32 a103, v56
    ds_read_b128 a[92:95], v46 offset:6144
    v_mfma_f32_16x16x32_bf16 v[160:163], a[96:99], a[244:247], v[160:163]
    s_waitcnt lgkmcnt(7)
    ds_read_b128 a[200:203], v47 offset:6144
    buffer_load_dwordx4 v37, s[8:11], s56 offen offset:1024 lds
    v_mfma_f32_16x16x32_bf16 v[160:163], a[216:219], a[44:47], v[160:163]
    v_perm_b32 v59, v122, v35, s36
    v_perm_b32 v60, v122, v35, s37
    v_mfma_f32_16x16x32_bf16 v[164:167], a[96:99], a[164:167], v[164:167]
    ds_read_b32 a228, v59
    ds_read_b32 a229, v60
    v_mfma_f32_16x16x32_bf16 v[164:167], a[216:219], a[28:31], v[164:167]
    v_perm_b32 v57, v126, v35, s37
    v_perm_b32 v63, v122, v35, s38
    v_mfma_f32_16x16x32_bf16 v[168:171], a[96:99], a[64:67], v[168:171]
    s_add_u32 s3, s55, 896
    ds_read_b32 a221, v57
    ds_read_b32 a230, v63
    v_mfma_f32_16x16x32_bf16 v[168:171], a[216:219], a[72:75], v[168:171]
    ds_read_b128 a[240:243], v46 offset:4096
    v_perm_b32 v58, v122, v35, s39
    v_mfma_f32_16x16x32_bf16 v[172:175], a[96:99], a[12:15], v[172:175]
    ds_read_b32 a231, v58
    buffer_load_dwordx4 v38, s[8:11], s56 offen offset:2048 lds
    v_mfma_f32_16x16x32_bf16 v[172:175], a[216:219], a[172:175], v[172:175]
    ds_read_b128 a[24:27], v47 offset:4096
    v_perm_b32 v61, v80, v35, s36
    v_mfma_f32_16x16x32_bf16 v[176:179], a[96:99], a[148:151], v[176:179]
    ds_read_b32 a124, v61
    v_perm_b32 v62, v126, v35, s38
    v_mfma_f32_16x16x32_bf16 v[176:179], a[216:219], a[8:11], v[176:179]
    ds_read_b32 a222, v62
    v_perm_b32 v56, v80, v35, s37
    v_mfma_f32_16x16x32_bf16 v[180:183], a[96:99], a[16:19], v[180:183]
    ds_read_b32 a125, v56
    ds_read_b128 a[128:131], v46 offset:10240
    v_mfma_f32_16x16x32_bf16 v[180:183], a[216:219], a[40:43], v[180:183]
    s_waitcnt vmcnt(5)
    v_bitop3_b32 v103, v103, v71, s76 bitop3:0x7e
    v_perm_b32 v59, v80, v35, s38
    v_mfma_f32_16x16x32_bf16 v[184:187], a[96:99], a[56:59], v[184:187]
    ds_read_b32 a126, v59
    v_cmp_ne_u32 vcc, 0, v103
    v_mfma_f32_16x16x32_bf16 v[184:187], a[216:219], a[120:123], v[184:187]
    s_waitcnt lgkmcnt(8)
    ds_read_b128 a[132:135], v47 offset:10240
    buffer_load_dwordx4 v39, s[8:11], s56 offen offset:3072 lds
    v_mfma_f32_16x16x32_bf16 v[188:191], a[96:99], a[112:115], v[188:191]
    s_add_u32 s56, s55, 1792
    v_perm_b32 v63, v126, v35, s39
    v_perm_b32 v60, v80, v35, s39
    v_mfma_f32_16x16x32_bf16 v[188:191], a[216:219], a[188:191], v[188:191]
    s_add_u32 m0, s57, 51200
    ds_read_b32 a223, v63
    ds_read_b32 a127, v60
    v_mfma_f32_16x16x32_bf16 v[192:195], a[100:103], a[244:247], v[192:195]
    v_perm_b32 v57, v82, v35, s36
    s_cbranch_vccnz L_slow4_1
L_back4_1:
    s_waitcnt lgkmcnt(8)
    v_mfma_f32_16x16x32_bf16 v[192:195], a[228:231], a[44:47], v[192:195]
    s_mov_b32 s40, 122880
    ds_read_b32 a160, v57
    ds_read_b128 a[156:159], v46 offset:8192
    v_mfma_f32_16x16x32_bf16 v[196:199], a[100:103], a[164:167], v[196:199]
    ds_read_b128 a[248:251], v47 offset:8192
    buffer_load_dwordx4 v36, s[8:11], s3 offen offset:0 lds
    v_mfma_f32_16x16x32_bf16 v[196:199], a[228:231], a[28:31], v[196:199]
    s_mov_b32 s41, 128000
    v_perm_b32 v58, v82, v35, s37
    v_perm_b32 v61, v116, v35, s36
    v_mfma_f32_16x16x32_bf16 v[200:203], a[100:103], a[64:67], v[200:203]
    s_mov_b32 s42, 143360
    ds_read_b32 a48, v61
    ds_read_b32 a161, v58
    v_mfma_f32_16x16x32_bf16 v[200:203], a[228:231], a[72:75], v[200:203]
    v_perm_b32 v62, v82, v35, s38
    v_perm_b32 v56, v82, v35, s39
    v_mfma_f32_16x16x32_bf16 v[204:207], a[100:103], a[12:15], v[204:207]
    ds_read_b32 a162, v62
    ds_read_b32 a163, v56
    v_mfma_f32_16x16x32_bf16 v[204:207], a[228:231], a[172:175], v[204:207]
    s_mov_b32 s43, 148480
    ds_read_b128 a[104:107], v46 offset:14336
    v_perm_b32 v59, v116, v35, s37
    v_mfma_f32_16x16x32_bf16 v[208:211], a[100:103], a[148:151], v[208:211]
    ds_read_b32 a49, v59
    buffer_load_dwordx4 v37, s[8:11], s3 offen offset:1024 lds
    v_mfma_f32_16x16x32_bf16 v[208:211], a[228:231], a[8:11], v[208:211]
    s_add_u32 m0, s57, 47104
    ds_read_b128 a[252:255], v47 offset:14336
    v_perm_b32 v60, v100, v35, s36
    v_mfma_f32_16x16x32_bf16 v[212:215], a[100:103], a[16:19], v[212:215]
    ds_read_b32 a76, v60
    buffer_load_dwordx2 v[72:73], v34, s[12:15], s40 offen sc1
    v_mfma_f32_16x16x32_bf16 v[212:215], a[228:231], a[40:43], v[212:215]
    v_perm_b32 v63, v100, v35, s37
    v_perm_b32 v57, v100, v35, s38
    v_mfma_f32_16x16x32_bf16 v[216:219], a[100:103], a[56:59], v[216:219]
    ds_read_b32 a77, v63
    ds_read_b32 a78, v57
    v_mfma_f32_16x16x32_bf16 v[216:219], a[228:231], a[120:123], v[216:219]
    ds_read_b128 a[4:7], v46 offset:12288
    v_perm_b32 v58, v116, v35, s38
    v_mfma_f32_16x16x32_bf16 v[220:223], a[100:103], a[112:115], v[220:223]
    ds_read_b32 a50, v58
    buffer_load_dwordx2 v[74:75], v34, s[12:15], s41 offen sc1
    v_mfma_f32_16x16x32_bf16 v[220:223], a[228:231], a[188:191], v[220:223]
    s_waitcnt lgkmcnt(8)
    ds_read_b128 a[176:179], v47 offset:12288
    buffer_load_dwordx4 v38, s[8:11], s3 offen offset:2048 lds
    v_mfma_f32_16x16x32_bf16 v[224:227], a[124:127], a[244:247], v[224:227]
    buffer_load_dwordx4 v[92:95], v33, s[12:15], s42 offen sc1
    v_mfma_f32_16x16x32_bf16 v[224:227], a[160:163], a[44:47], v[224:227]
    s_mov_b32 s44, 122880
    v_perm_b32 v61, v100, v35, s39
    v_perm_b32 v62, v68, v35, s36
    v_mfma_f32_16x16x32_bf16 v[228:231], a[124:127], a[164:167], v[228:231]
    ds_read_b32 a79, v61
    ds_read_b32 a180, v62
    v_mfma_f32_16x16x32_bf16 v[228:231], a[160:163], a[28:31], v[228:231]
    buffer_load_dwordx4 v[52:55], v33, s[12:15], s43 offen sc1
L_pad3:
    s_cbranch_execz L_warmed
    v_mfma_f32_16x16x32_bf16 v[232:235], a[124:127], a[64:67], v[232:235]
    s_mov_b32 s45, 128000
    v_perm_b32 v59, v116, v35, s39
    v_perm_b32 v56, v68, v35, s37
    v_mfma_f32_16x16x32_bf16 v[232:235], a[160:163], a[72:75], v[232:235]
    ds_read_b32 a51, v59
    ds_read_b32 a181, v56
    v_mfma_f32_16x16x32_bf16 v[236:239], a[124:127], a[12:15], v[236:239]
    buffer_load_dwordx4 v39, s[8:11], s3 offen offset:3072 lds
    v_mfma_f32_16x16x32_bf16 v[236:239], a[160:163], a[172:175], v[236:239]
    s_add_u32 m0, s57, 65536
    v_perm_b32 v60, v68, v35, s38
    v_perm_b32 v63, v68, v35, s39
    v_mfma_f32_16x16x32_bf16 v[240:243], a[124:127], a[148:151], v[240:243]
    s_add_u32 s3, s55, 1920
    ds_read_b32 a182, v60
    ds_read_b32 a183, v63
    v_mfma_f32_16x16x32_bf16 v[240:243], a[160:163], a[8:11], v[240:243]
    v_perm_b32 v58, v84, v35, s36
    v_perm_b32 v57, v101, v35, s36
    v_mfma_f32_16x16x32_bf16 v[244:247], a[124:127], a[16:19], v[244:247]
    ds_read_b32 a208, v58
    ds_read_b32 a184, v57
    v_mfma_f32_16x16x32_bf16 v[244:247], a[160:163], a[40:43], v[244:247]
    buffer_load_dwordx4 v[64:67], v33, s[12:15], s44 offen sc1
    v_mfma_f32_16x16x32_bf16 v[248:251], a[124:127], a[56:59], v[248:251]
    s_waitcnt lgkmcnt(6)
    s_barrier
    v_perm_b32 v61, v101, v35, s37
    v_mfma_f32_16x16x32_bf16 v[248:251], a[160:163], a[120:123], v[248:251]
    ds_read_b32 a185, v61
    v_perm_b32 v62, v84, v35, s37
    v_mfma_f32_16x16x32_bf16 v[252:255], a[124:127], a[112:115], v[252:255]
    ds_read_b32 a209, v62
    v_perm_b32 v56, v101, v35, s38
    v_mfma_f32_16x16x32_bf16 v[252:255], a[160:163], a[188:191], v[252:255]
    ds_read_b32 a186, v56
    buffer_load_dwordx4 v[48:51], v33, s[12:15], s45 offen sc1
    v_mfma_f32_16x16x32_bf16 v[128:131], a[76:79], a[192:195], v[128:131]
    s_waitcnt lgkmcnt(5)
    v_perm_b32 v59, v101, v35, s39
    v_perm_b32 v60, v69, v35, s36
    v_mfma_f32_16x16x32_bf16 v[128:131], a[180:183], a[80:83], v[128:131]
    ds_read_b32 a187, v59
    ds_read_b32 a168, v60
    v_mfma_f32_16x16x32_bf16 v[132:135], a[76:79], a[68:71], v[132:135]
    v_perm_b32 v57, v84, v35, s38
    v_perm_b32 v63, v69, v35, s37
    v_mfma_f32_16x16x32_bf16 v[132:135], a[180:183], a[108:111], v[132:135]
    ds_read_b32 a210, v57
    ds_read_b32 a169, v63
    v_mfma_f32_16x16x32_bf16 v[136:139], a[76:79], a[92:95], v[136:139]
    ds_read_b128 a[212:215], v40 offset:0
    v_perm_b32 v58, v69, v35, s38
    v_mfma_f32_16x16x32_bf16 v[136:139], a[180:183], a[200:203], v[136:139]
    ds_read_b32 a170, v58
    buffer_load_dwordx4 v36, s[8:11], s56 offen offset:0 lds
    v_mfma_f32_16x16x32_bf16 v[140:143], a[76:79], a[240:243], v[140:143]
    v_perm_b32 v61, v69, v35, s39
    v_perm_b32 v62, v84, v35, s39
    v_mfma_f32_16x16x32_bf16 v[140:143], a[180:183], a[24:27], v[140:143]
    ds_read_b32 a211, v62
    ds_read_b32 a171, v61
    v_mfma_f32_16x16x32_bf16 v[144:147], a[76:79], a[128:131], v[144:147]
    ds_read_b128 a[60:63], v41 offset:0
    v_perm_b32 v56, v102, v35, s36
    v_mfma_f32_16x16x32_bf16 v[144:147], a[180:183], a[132:135], v[144:147]
    ds_read_b32 a20, v56
    ds_read_b128 a[204:207], v40 offset:2048
    v_mfma_f32_16x16x32_bf16 v[148:151], a[76:79], a[156:159], v[148:151]
    ds_read_b128 a[96:99], v41 offset:2048
    buffer_load_dwordx4 v37, s[8:11], s56 offen offset:1024 lds
    v_mfma_f32_16x16x32_bf16 v[148:151], a[180:183], a[248:251], v[148:151]
    v_perm_b32 v59, v102, v35, s37
    v_perm_b32 v60, v117, v35, s36
    v_mfma_f32_16x16x32_bf16 v[152:155], a[76:79], a[104:107], v[152:155]
    ds_read_b32 a216, v60
    ds_read_b32 a21, v59
    v_mfma_f32_16x16x32_bf16 v[152:155], a[180:183], a[252:255], v[152:155]
    s_waitcnt vmcnt(16)
    v_bitop3_b32 v107, v107, v115, s76 bitop3:0x7e
    v_perm_b32 v63, v102, v35, s38
    v_mfma_f32_16x16x32_bf16 v[156:159], a[76:79], a[4:7], v[156:159]
    ds_read_b32 a22, v63
    v_cmp_ne_u32 vcc, 0, v107
    v_mfma_f32_16x16x32_bf16 v[156:159], a[180:183], a[176:179], v[156:159]
    s_waitcnt lgkmcnt(9)
    ds_read_b128 a[100:103], v40 offset:4096
    buffer_load_dwordx4 v38, s[8:11], s56 offen offset:2048 lds
    v_mfma_f32_16x16x32_bf16 v[160:163], a[184:187], a[192:195], v[160:163]
    v_perm_b32 v57, v102, v35, s39
    s_cbranch_vccnz L_slow5_0
L_back5_0:
    s_waitcnt lgkmcnt(8)
    v_mfma_f32_16x16x32_bf16 v[160:163], a[168:171], a[80:83], v[160:163]
    ds_read_b32 a23, v57
    v_perm_b32 v58, v117, v35, s37
    v_mfma_f32_16x16x32_bf16 v[164:167], a[184:187], a[68:71], v[164:167]
    ds_read_b32 a217, v58
    v_perm_b32 v61, v70, v35, s36
    v_mfma_f32_16x16x32_bf16 v[164:167], a[168:171], a[108:111], v[164:167]
    ds_read_b32 a228, v61
    buffer_load_dwordx4 v39, s[8:11], s56 offen offset:3072 lds
    v_mfma_f32_16x16x32_bf16 v[168:171], a[184:187], a[92:95], v[168:171]
    s_add_u32 m0, s57, 83968
    ds_read_b128 a[244:247], v41 offset:4096
    v_perm_b32 v62, v70, v35, s37
    v_mfma_f32_16x16x32_bf16 v[168:171], a[168:171], a[200:203], v[168:171]
    ds_read_b32 a229, v62
    v_perm_b32 v56, v70, v35, s38
    v_mfma_f32_16x16x32_bf16 v[172:175], a[184:187], a[240:243], v[172:175]
    ds_read_b32 a230, v56
    v_perm_b32 v59, v117, v35, s38
    v_mfma_f32_16x16x32_bf16 v[172:175], a[168:171], a[24:27], v[172:175]
    ds_read_b32 a218, v59
    ds_read_b128 a[44:47], v40 offset:6144
    v_mfma_f32_16x16x32_bf16 v[176:179], a[184:187], a[128:131], v[176:179]
    ds_read_b128 a[164:167], v41 offset:6144
    buffer_load_dwordx4 v36, s[8:11], s3 offen offset:0 lds
    v_mfma_f32_16x16x32_bf16 v[176:179], a[168:171], a[132:135], v[176:179]
    v_perm_b32 v60, v70, v35, s39
    v_perm_b32 v63, v104, v35, s36
    v_mfma_f32_16x16x32_bf16 v[180:183], a[184:187], a[156:159], v[180:183]
    ds_read_b32 a231, v60
    ds_read_b32 a28, v63
    v_mfma_f32_16x16x32_bf16 v[180:183], a[168:171], a[248:251], v[180:183]
    v_perm_b32 v58, v117, v35, s39
    v_perm_b32 v57, v104, v35, s37
    v_mfma_f32_16x16x32_bf16 v[184:187], a[184:187], a[104:107], v[184:187]
    ds_read_b32 a219, v58
    buffer_load_dwordx4 v37, s[8:11], s3 offen offset:1024 lds
    v_mfma_f32_16x16x32_bf16 v[184:187], a[168:171], a[252:255], v[184:187]
    s_add_u32 m0, s57, 79872
    ds_read_b32 a29, v57
    ds_read_b128 a[64:67], v40 offset:8192
    v_mfma_f32_16x16x32_bf16 v[188:191], a[184:187], a[4:7], v[188:191]
    ds_read_b128 a[72:75], v41 offset:8192
    v_perm_b32 v61, v104, v35, s38
    v_mfma_f32_16x16x32_bf16 v[188:191], a[168:171], a[176:179], v[188:191]
    s_waitcnt lgkmcnt(9)
    ds_read_b32 a30, v61
    v_perm_b32 v62, v104, v35, s39
    v_mfma_f32_16x16x32_bf16 v[192:195], a[20:23], a[192:195], v[192:195]
    s_waitcnt lgkmcnt(6)
    ds_read_b32 a31, v62
    buffer_load_dwordx4 v38, s[8:11], s3 offen offset:2048 lds
    v_mfma_f32_16x16x32_bf16 v[192:195], a[228:231], a[80:83], v[192:195]
    v_perm_b32 v59, v85, v35, s36
    v_perm_b32 v56, v112, v35, s36
    v_mfma_f32_16x16x32_bf16 v[196:199], a[20:23], a[68:71], v[196:199]
    ds_read_b32 a172, v59
    ds_read_b32 a12, v56
    v_mfma_f32_16x16x32_bf16 v[196:199], a[228:231], a[108:111], v[196:199]
    ds_read_b128 a[148:151], v40 offset:10240
    v_perm_b32 v60, v112, v35, s37
    v_mfma_f32_16x16x32_bf16 v[200:203], a[20:23], a[92:95], v[200:203]
    ds_read_b32 a13, v60
    buffer_load_dwordx4 v39, s[8:11], s3 offen offset:3072 lds
    v_mfma_f32_16x16x32_bf16 v[200:203], a[228:231], a[200:203], v[200:203]
    ds_read_b128 a[8:11], v41 offset:10240
    v_perm_b32 v63, v85, v35, s37
    v_mfma_f32_16x16x32_bf16 v[204:207], a[20:23], a[240:243], v[204:207]
    ds_read_b32 a173, v63
    v_perm_b32 v58, v112, v35, s38
    v_mfma_f32_16x16x32_bf16 v[204:207], a[228:231], a[24:27], v[204:207]
    ds_read_b32 a14, v58
    v_perm_b32 v57, v112, v35, s39
    v_mfma_f32_16x16x32_bf16 v[208:211], a[20:23], a[128:131], v[208:211]
    ds_read_b32 a15, v57
    ds_read_b128 a[16:19], v40 offset:12288
    v_mfma_f32_16x16x32_bf16 v[208:211], a[228:231], a[132:135], v[208:211]
    v_perm_b32 v61, v105, v35, s36
    v_perm_b32 v62, v85, v35, s38
    v_mfma_f32_16x16x32_bf16 v[212:215], a[20:23], a[156:159], v[212:215]
    ds_read_b32 a174, v62
    ds_read_b32 a40, v61
    v_mfma_f32_16x16x32_bf16 v[212:215], a[228:231], a[248:251], v[212:215]
    ds_read_b128 a[56:59], v41 offset:12288
    v_perm_b32 v56, v105, v35, s37
    v_mfma_f32_16x16x32_bf16 v[216:219], a[20:23], a[104:107], v[216:219]
    ds_read_b32 a41, v56
    v_perm_b32 v59, v105, v35, s38
    v_mfma_f32_16x16x32_bf16 v[216:219], a[228:231], a[252:255], v[216:219]
    ds_read_b32 a42, v59
    ds_read_b128 a[120:123], v40 offset:14336
    v_mfma_f32_16x16x32_bf16 v[220:223], a[20:23], a[4:7], v[220:223]
    v_perm_b32 v63, v85, v35, s39
    v_perm_b32 v60, v105, v35, s39
    v_mfma_f32_16x16x32_bf16 v[220:223], a[228:231], a[176:179], v[220:223]
    s_waitcnt lgkmcnt(9)
    ds_read_b32 a175, v63
    ds_read_b32 a43, v60
    v_mfma_f32_16x16x32_bf16 v[128:131], a[28:31], a[212:215], v[128:131]
    s_waitcnt lgkmcnt(9)
    ds_read_b128 a[112:115], v41 offset:14336
    v_perm_b32 v58, v113, v35, s36
    v_mfma_f32_16x16x32_bf16 v[128:131], a[12:15], a[60:63], v[128:131]
    ds_read_b32 a124, v58
    v_perm_b32 v57, v113, v35, s37
    v_mfma_f32_16x16x32_bf16 v[132:135], a[28:31], a[204:207], v[132:135]
    ds_read_b32 a125, v57
    v_perm_b32 v61, v118, v35, s36
    v_mfma_f32_16x16x32_bf16 v[132:135], a[12:15], a[96:99], v[132:135]
    ds_read_b32 a160, v61
    ds_read_b128 a[188:191], v42 offset:2048
    v_mfma_f32_16x16x32_bf16 v[136:139], a[28:31], a[100:103], v[136:139]
    v_perm_b32 v62, v113, v35, s38
    v_perm_b32 v56, v113, v35, s39
    v_mfma_f32_16x16x32_bf16 v[136:139], a[12:15], a[244:247], v[136:139]
    ds_read_b32 a126, v62
    ds_read_b128 a[76:79], v43 offset:2048
    v_mfma_f32_16x16x32_bf16 v[140:143], a[28:31], a[44:47], v[140:143]
    ds_read_b32 a127, v56
    v_perm_b32 v59, v118, v35, s37
    v_mfma_f32_16x16x32_bf16 v[140:143], a[12:15], a[164:167], v[140:143]
    ds_read_b32 a161, v59
    v_perm_b32 v60, v106, v35, s36
    v_mfma_f32_16x16x32_bf16 v[144:147], a[28:31], a[64:67], v[144:147]
    ds_read_b32 a184, v60
    ds_read_b128 a[180:183], v42 offset:0
    v_mfma_f32_16x16x32_bf16 v[144:147], a[12:15], a[72:75], v[144:147]
    v_perm_b32 v63, v106, v35, s37
    v_perm_b32 v58, v118, v35, s38
    v_mfma_f32_16x16x32_bf16 v[148:151], a[28:31], a[148:151], v[148:151]
    ds_read_b32 a162, v58
    ds_read_b32 a185, v63
    v_mfma_f32_16x16x32_bf16 v[148:151], a[12:15], a[8:11], v[148:151]
    s_waitcnt vmcnt(14) lgkmcnt(10)
    ds_read_b128 a[168:171], v43 offset:0
    v_bitop3_b32 v73, v73, v75, s76 bitop3:0x7e
    v_mfma_f32_16x16x32_bf16 v[152:155], a[28:31], a[16:19], v[152:155]
    v_cmp_ne_u32 vcc, 0, v73
    v_perm_b32 v57, v106, v35, s38
    v_mfma_f32_16x16x32_bf16 v[152:155], a[12:15], a[56:59], v[152:155]
    ds_read_b32 a186, v57
    buffer_load_dwordx4 v[108:111], v22, s[32:35], 0 offen
    v_mfma_f32_16x16x32_bf16 v[156:159], a[28:31], a[120:123], v[156:159]
    v_perm_b32 v61, v106, v35, s39
    s_cbranch_vccnz L_slow5_2
L_back5_2:
    v_mfma_f32_16x16x32_bf16 v[156:159], a[12:15], a[112:115], v[156:159]
    ds_read_b32 a187, v61
    ds_read_b128 a[192:195], v42 offset:6144
    v_mfma_f32_16x16x32_bf16 v[160:163], a[40:43], a[212:215], v[160:163]
    s_waitcnt vmcnt(12) lgkmcnt(8)
    v_bitop3_b32 v95, v95, v55, s76 bitop3:0x7e
    v_perm_b32 v62, v114, v35, s36
    v_mfma_f32_16x16x32_bf16 v[160:163], a[124:127], a[60:63], v[160:163]
    ds_read_b32 a80, v62
    v_cmp_ne_u32 vcc, 0, v95
    v_mfma_f32_16x16x32_bf16 v[164:167], a[40:43], a[204:207], v[164:167]
    ds_read_b128 a[68:71], v43 offset:6144
    v_perm_b32 v56, v118, v35, s39
    v_mfma_f32_16x16x32_bf16 v[164:167], a[124:127], a[96:99], v[164:167]
    ds_read_b32 a163, v56
    s_cbranch_vccnz L_slow7_1
L_back7_1:
    v_mfma_f32_16x16x32_bf16 v[168:171], a[40:43], a[100:103], v[168:171]
    v_perm_b32 v59, v114, v35, s37
    v_perm_b32 v60, v114, v35, s38
    v_mfma_f32_16x16x32_bf16 v[168:171], a[124:127], a[244:247], v[168:171]
    ds_read_b32 a81, v59
    buffer_load_dwordx2 v[76:77], v22, s[32:35], 0 offen offset:16
    v_mfma_f32_16x16x32_bf16 v[172:175], a[40:43], a[44:47], v[172:175]
    ds_read_b32 a82, v60
    ds_read_b128 a[108:111], v42 offset:4096
    v_mfma_f32_16x16x32_bf16 v[172:175], a[124:127], a[164:167], v[172:175]
    v_perm_b32 v63, v114, v35, s39
    v_perm_b32 v58, v86, v35, s36
    v_mfma_f32_16x16x32_bf16 v[176:179], a[40:43], a[64:67], v[176:179]
    ds_read_b32 a92, v58
    ds_read_b32 a83, v63
    v_mfma_f32_16x16x32_bf16 v[176:179], a[124:127], a[72:75], v[176:179]
    ds_read_b128 a[200:203], v43 offset:4096
    v_perm_b32 v57, v72, v35, s36
    v_mfma_f32_16x16x32_bf16 v[180:183], a[40:43], a[148:151], v[180:183]
    ds_read_b32 a240, v57
    buffer_load_dwordx2 v[78:79], v23, s[32:35], 0 offen
    v_mfma_f32_16x16x32_bf16 v[180:183], a[124:127], a[8:11], v[180:183]
    ds_read_b128 a[24:27], v42 offset:10240
    v_perm_b32 v61, v72, v35, s37
    v_mfma_f32_16x16x32_bf16 v[184:187], a[40:43], a[16:19], v[184:187]
    s_waitcnt vmcnt(11)
    ds_read_b32 a241, v61
    v_bitop3_b32 v67, v67, v51, s76 bitop3:0x7e
    v_mfma_f32_16x16x32_bf16 v[184:187], a[124:127], a[56:59], v[184:187]
    v_cmp_ne_u32 vcc, 0, v67
    v_perm_b32 v62, v86, v35, s37
    v_mfma_f32_16x16x32_bf16 v[188:191], a[40:43], a[120:123], v[188:191]
    ds_read_b32 a93, v62
    v_perm_b32 v56, v72, v35, s38
    v_mfma_f32_16x16x32_bf16 v[188:191], a[124:127], a[112:115], v[188:191]
    ds_read_b32 a242, v56
    s_cbranch_vccnz L_slow5_1
L_back5_1:
    s_waitcnt lgkmcnt(8)
    v_mfma_f32_16x16x32_bf16 v[192:195], a[184:187], a[212:215], v[192:195]
    s_waitcnt lgkmcnt(6)
    ds_read_b128 a[128:131], v43 offset:10240
    v_perm_b32 v59, v72, v35, s39
    v_mfma_f32_16x16x32_bf16 v[192:195], a[80:83], a[60:63], v[192:195]
    ds_read_b32 a243, v59
    v_perm_b32 v60, v74, v35, s36
    v_mfma_f32_16x16x32_bf16 v[196:199], a[184:187], a[204:207], v[196:199]
    ds_read_b32 a132, v60
    v_perm_b32 v63, v86, v35, s38
    v_mfma_f32_16x16x32_bf16 v[196:199], a[80:83], a[96:99], v[196:199]
    ds_read_b32 a94, v63
    ds_read_b128 a[156:159], v42 offset:8192
    v_mfma_f32_16x16x32_bf16 v[200:203], a[184:187], a[100:103], v[200:203]
    ds_read_b128 a[248:251], v43 offset:8192
    v_perm_b32 v58, v74, v35, s37
    v_mfma_f32_16x16x32_bf16 v[200:203], a[80:83], a[244:247], v[200:203]
    ds_read_b32 a133, v58
    v_perm_b32 v57, v74, v35, s38
    v_mfma_f32_16x16x32_bf16 v[204:207], a[184:187], a[44:47], v[204:207]
    ds_read_b32 a134, v57
    v_perm_b32 v61, v74, v35, s39
    v_mfma_f32_16x16x32_bf16 v[204:207], a[80:83], a[164:167], v[204:207]
    ds_read_b32 a135, v61
    v_perm_b32 v62, v86, v35, s39
    v_mfma_f32_16x16x32_bf16 v[208:211], a[184:187], a[64:67], v[208:211]
    ds_read_b32 a95, v62
    ds_read_b128 a[104:107], v42 offset:14336
    v_mfma_f32_16x16x32_bf16 v[208:211], a[80:83], a[72:75], v[208:211]
    ds_read_b128 a[252:255], v43 offset:14336
    v_perm_b32 v56, v64, v35, s36
    v_mfma_f32_16x16x32_bf16 v[212:215], a[184:187], a[148:151], v[212:215]
    ds_read_b32 a4, v56
    v_perm_b32 v59, v64, v35, s37
    v_mfma_f32_16x16x32_bf16 v[212:215], a[80:83], a[8:11], v[212:215]
    ds_read_b32 a5, v59
    v_perm_b32 v60, v92, v35, s36
    v_mfma_f32_16x16x32_bf16 v[216:219], a[184:187], a[16:19], v[216:219]
    ds_read_b32 a20, v60
    v_perm_b32 v63, v64, v35, s38
    v_mfma_f32_16x16x32_bf16 v[216:219], a[80:83], a[56:59], v[216:219]
    ds_read_b32 a6, v63
    ds_read_b128 a[176:179], v42 offset:12288
    v_mfma_f32_16x16x32_bf16 v[220:223], a[184:187], a[120:123], v[220:223]
    v_perm_b32 v58, v64, v35, s39
    v_perm_b32 v57, v92, v35, s37
    v_mfma_f32_16x16x32_bf16 v[220:223], a[80:83], a[112:115], v[220:223]
    s_waitcnt lgkmcnt(9)
    ds_read_b32 a21, v57
    ds_read_b32 a7, v58
    v_mfma_f32_16x16x32_bf16 v[224:227], a[240:243], a[212:215], v[224:227]
    s_waitcnt lgkmcnt(10)
    ds_read_b128 a[228:231], v43 offset:12288
    v_perm_b32 v61, v48, v35, s36
    v_mfma_f32_16x16x32_bf16 v[224:227], a[132:135], a[60:63], v[224:227]
    ds_read_b32 a28, v61
    v_perm_b32 v62, v48, v35, s37
    v_mfma_f32_16x16x32_bf16 v[228:231], a[240:243], a[204:207], v[228:231]
    ds_read_b32 a29, v62
    v_perm_b32 v56, v48, v35, s38
    v_mfma_f32_16x16x32_bf16 v[228:231], a[132:135], a[96:99], v[228:231]
    v_perm_b32 v59, v92, v35, s38
    v_perm_b32 v60, v92, v35, s39
    v_mfma_f32_16x16x32_bf16 v[232:235], a[240:243], a[100:103], v[232:235]
    ds_read_b32 a22, v59
    ds_read_b32 a23, v60
    v_mfma_f32_16x16x32_bf16 v[232:235], a[132:135], a[244:247], v[232:235]
    ds_read_b32 a30, v56
    v_perm_b32 v63, v48, v35, s39
    v_mfma_f32_16x16x32_bf16 v[236:239], a[240:243], a[44:47], v[236:239]
    ds_read_b32 a31, v63
    v_perm_b32 v58, v65, v35, s36
    v_mfma_f32_16x16x32_bf16 v[236:239], a[132:135], a[164:167], v[236:239]
    v_perm_b32 v57, v52, v35, s36
    v_perm_b32 v61, v52, v35, s37
    v_mfma_f32_16x16x32_bf16 v[240:243], a[240:243], a[64:67], v[240:243]
    ds_read_b32 a12, v57
    ds_read_b32 a13, v61
    v_mfma_f32_16x16x32_bf16 v[240:243], a[132:135], a[72:75], v[240:243]
    ds_read_b32 a40, v58
    v_perm_b32 v62, v65, v35, s37
    v_mfma_f32_16x16x32_bf16 v[244:247], a[240:243], a[148:151], v[244:247]
    ds_read_b32 a41, v62
    v_perm_b32 v59, v65, v35, s38
    v_mfma_f32_16x16x32_bf16 v[244:247], a[132:135], a[8:11], v[244:247]
    v_perm_b32 v60, v52, v35, s38
    v_mfma_f32_16x16x32_bf16 v[248:251], a[240:243], a[16:19], v[248:251]
    s_waitcnt lgkmcnt(8)
    s_barrier
    ds_read_b32 a14, v60
    v_mfma_f32_16x16x32_bf16 v[248:251], a[132:135], a[56:59], v[248:251]
    ds_read_b32 a42, v59
    v_perm_b32 v56, v65, v35, s39
    v_mfma_f32_16x16x32_bf16 v[252:255], a[240:243], a[120:123], v[252:255]
    ds_read_b32 a43, v56
    v_perm_b32 v63, v49, v35, s36
    v_mfma_f32_16x16x32_bf16 v[252:255], a[132:135], a[112:115], v[252:255]
    v_perm_b32 v57, v52, v35, s39
    v_mfma_f32_16x16x32_bf16 v[128:131], a[4:7], a[188:191], v[128:131]
    s_waitcnt lgkmcnt(7)
    ds_read_b32 a15, v57
    ds_read_b32 a124, v63
    v_mfma_f32_16x16x32_bf16 v[128:131], a[28:31], a[76:79], v[128:131]
    ds_read_b128 a[184:187], v40 offset:34816
    v_perm_b32 v61, v49, v35, s37
    v_mfma_f32_16x16x32_bf16 v[132:135], a[4:7], a[180:183], v[132:135]
    ds_read_b32 a125, v61
    v_perm_b32 v58, v49, v35, s38
    v_mfma_f32_16x16x32_bf16 v[132:135], a[28:31], a[168:171], v[132:135]
    v_perm_b32 v62, v93, v35, s36
    v_mfma_f32_16x16x32_bf16 v[136:139], a[4:7], a[192:195], v[136:139]
    ds_read_b32 a126, v58
    ds_read_b32 a80, v62
    v_mfma_f32_16x16x32_bf16 v[136:139], a[28:31], a[68:71], v[136:139]
    ds_read_b128 a[212:215], v41 offset:34816
    v_perm_b32 v60, v49, v35, s39
    v_mfma_f32_16x16x32_bf16 v[140:143], a[4:7], a[108:111], v[140:143]
    ds_read_b32 a127, v60
    v_perm_b32 v59, v66, v35, s36
    v_mfma_f32_16x16x32_bf16 v[140:143], a[28:31], a[200:203], v[140:143]
    ds_read_b128 a[60:63], v42 offset:32768
    v_perm_b32 v56, v93, v35, s37
    v_mfma_f32_16x16x32_bf16 v[144:147], a[4:7], a[24:27], v[144:147]
    ds_read_b32 a204, v59
    v_perm_b32 v63, v66, v35, s37
    v_mfma_f32_16x16x32_bf16 v[144:147], a[28:31], a[128:131], v[144:147]
    ds_read_b32 a81, v56
    v_mfma_f32_16x16x32_bf16 v[148:151], a[4:7], a[156:159], v[148:151]
    ds_read_b32 a205, v63
    ds_read_b128 a[96:99], v43 offset:32768
    v_mfma_f32_16x16x32_bf16 v[148:151], a[28:31], a[248:251], v[148:151]
    v_perm_b32 v57, v66, v35, s38
    v_mfma_f32_16x16x32_bf16 v[152:155], a[4:7], a[104:107], v[152:155]
    ds_read_b32 a206, v57
    v_perm_b32 v61, v66, v35, s39
    v_mfma_f32_16x16x32_bf16 v[152:155], a[28:31], a[252:255], v[152:155]
    ds_read_b128 a[100:103], v40 offset:32768
    v_perm_b32 v58, v93, v35, s38
    v_mfma_f32_16x16x32_bf16 v[156:159], a[4:7], a[176:179], v[156:159]
    ds_read_b32 a207, v61
    ds_read_b32 a82, v58
    v_mfma_f32_16x16x32_bf16 v[156:159], a[28:31], a[228:231], v[156:159]
    s_waitcnt lgkmcnt(9)
    v_perm_b32 v62, v50, v35, s36
    v_mfma_f32_16x16x32_bf16 v[160:163], a[40:43], a[188:191], v[160:163]
    ds_read_b32 a44, v62
    ds_read_b128 a[244:247], v41 offset:32768
    v_mfma_f32_16x16x32_bf16 v[160:163], a[124:127], a[76:79], v[160:163]
    v_perm_b32 v60, v50, v35, s37
    v_perm_b32 v59, v93, v35, s39
    v_mfma_f32_16x16x32_bf16 v[164:167], a[40:43], a[180:183], v[164:167]
    ds_read_b32 a45, v60
    v_perm_b32 v56, v50, v35, s38
    v_mfma_f32_16x16x32_bf16 v[164:167], a[124:127], a[168:171], v[164:167]
    ds_read_b32 a83, v59
    ds_read_b128 a[164:167], v42 offset:34816
    v_mfma_f32_16x16x32_bf16 v[168:171], a[40:43], a[192:195], v[168:171]
    ds_read_b32 a46, v56
    v_perm_b32 v63, v50, v35, s39
    v_mfma_f32_16x16x32_bf16 v[168:171], a[124:127], a[68:71], v[168:171]
    v_mfma_f32_16x16x32_bf16 v[172:175], a[40:43], a[108:111], v[172:175]
    s_waitcnt vmcnt(3)
    s_barrier
    ds_read_b32 a47, v63
    v_mfma_f32_16x16x32_bf16 v[172:175], a[124:127], a[200:203], v[172:175]
    ds_read_b128 a[64:67], v43 offset:34816
    v_perm_b32 v57, v53, v35, s36
    v_mfma_f32_16x16x32_bf16 v[176:179], a[40:43], a[24:27], v[176:179]
    ds_read_b32 a72, v57
    v_perm_b32 v61, v53, v35, s37
    v_mfma_f32_16x16x32_bf16 v[176:179], a[124:127], a[128:131], v[176:179]
    ds_read_b32 a73, v61
    ds_read_b128 a[148:151], v44 offset:2048
    v_mfma_f32_16x16x32_bf16 v[180:183], a[40:43], a[156:159], v[180:183]
    v_perm_b32 v58, v53, v35, s38
    v_perm_b32 v62, v53, v35, s39
    v_mfma_f32_16x16x32_bf16 v[180:183], a[124:127], a[248:251], v[180:183]
    ds_read_b32 a74, v58
    v_mfma_f32_16x16x32_bf16 v[184:187], a[40:43], a[104:107], v[184:187]
    ds_read_b32 a75, v62
    ds_read_b128 a[8:11], v45 offset:2048
    v_mfma_f32_16x16x32_bf16 v[184:187], a[124:127], a[252:255], v[184:187]
    v_perm_b32 v60, v94, v35, s36
    v_perm_b32 v59, v94, v35, s37
    v_mfma_f32_16x16x32_bf16 v[188:191], a[40:43], a[176:179], v[188:191]
    ds_read_b32 a16, v60
    v_mfma_f32_16x16x32_bf16 v[188:191], a[124:127], a[228:231], v[188:191]
    s_waitcnt lgkmcnt(8)
    ds_read_b32 a17, v59
    ds_read_b128 a[56:59], v46 offset:0
    v_mfma_f32_16x16x32_bf16 v[192:195], a[204:207], a[188:191], v[192:195]
    v_perm_b32 v56, v94, v35, s38
    v_perm_b32 v63, v94, v35, s39
    v_mfma_f32_16x16x32_bf16 v[192:195], a[44:47], a[76:79], v[192:195]
    ds_read_b32 a18, v56
    v_mfma_f32_16x16x32_bf16 v[196:199], a[204:207], a[180:183], v[196:199]
    ds_read_b32 a19, v63
    ds_read_b128 a[120:123], v47 offset:0
    v_mfma_f32_16x16x32_bf16 v[196:199], a[44:47], a[168:171], v[196:199]
    v_perm_b32 v57, v54, v35, s36
    v_perm_b32 v61, v54, v35, s37
    v_mfma_f32_16x16x32_bf16 v[200:203], a[204:207], a[192:195], v[200:203]
    ds_read_b32 a240, v57
    v_mfma_f32_16x16x32_bf16 v[200:203], a[44:47], a[68:71], v[200:203]
    ds_read_b32 a241, v61
    ds_read_b128 a[112:115], v44 offset:0
    v_mfma_f32_16x16x32_bf16 v[204:207], a[204:207], a[108:111], v[204:207]
    v_perm_b32 v58, v54, v35, s38
    v_perm_b32 v62, v54, v35, s39
    v_mfma_f32_16x16x32_bf16 v[204:207], a[44:47], a[200:203], v[204:207]
    ds_read_b32 a242, v58
    v_mfma_f32_16x16x32_bf16 v[208:211], a[204:207], a[24:27], v[208:211]
    ds_read_b32 a243, v62
    ds_read_b128 a[132:135], v45 offset:0
    v_mfma_f32_16x16x32_bf16 v[208:211], a[44:47], a[128:131], v[208:211]
    v_mfma_f32_16x16x32_bf16 v[212:215], a[204:207], a[156:159], v[212:215]
    s_waitcnt vmcnt(2)
    v_lshlrev_b32 v88, 16, v108
    v_mfma_f32_16x16x32_bf16 v[212:215], a[44:47], a[248:251], v[212:215]
    ds_read_b128 a[4:7], v46 offset:2048
    v_and_b32 v89, 0xffff0000, v109
    v_mfma_f32_16x16x32_bf16 v[216:219], a[204:207], a[104:107], v[216:219]
    v_lshlrev_b32 v90, 16, v111
    v_mfma_f32_16x16x32_bf16 v[216:219], a[44:47], a[252:255], v[216:219]
    s_waitcnt vmcnt(1)
    v_and_b32 v91, 0xffff0000, v76
    v_mfma_f32_16x16x32_bf16 v[220:223], a[204:207], a[176:179], v[220:223]
    ds_read_b128 a[28:31], v47 offset:2048
    v_and_b32 v96, 0xffff0000, v108
    v_mfma_f32_16x16x32_bf16 v[220:223], a[44:47], a[228:231], v[220:223]
    v_lshlrev_b32 v97, 16, v110
    v_mfma_f32_16x16x32_bf16 v[228:231], a[152:155], a[184:187], v[228:231]
    s_mov_b32 s64, 0
    v_and_b32 v98, 0xffff0000, v111
    v_mov_b32 v8, 1
L_pad4:
    s_cbranch_execz L_warmed
    v_mfma_f32_16x16x32_bf16 v[228:231], a[84:87], a[212:215], v[228:231]
    s_waitcnt lgkmcnt(2)
    v_min_u32 v9, 1, v0
    v_lshlrev_b32 v9, 30, v9
    v_mfma_f32_16x16x32_bf16 v[228:231], a[36:39], a[148:151], v[228:231]
    s_mov_b32 s65, 14336
    ds_read_b128 a[40:43], v40 offset:38912
    v_lshlrev_b32 v99, 16, v77
    v_mfma_f32_16x16x32_bf16 v[228:231], a[220:223], a[8:11], v[228:231]
    v_lshlrev_b32 v120, 16, v109
    v_and_b32 v121, 0xffff0000, v110
    v_mfma_f32_16x16x32_bf16 v[132:135], a[144:147], a[184:187], v[132:135]
    s_mov_b32 s66, 28672
    v_lshlrev_b32 v122, 16, v76
    v_mfma_f32_16x16x32_bf16 v[132:135], a[232:235], a[212:215], v[132:135]
    s_waitcnt vmcnt(0)
    v_and_b32 v123, 0xffff0000, v77
    v_mfma_f32_16x16x32_bf16 v[132:135], a[140:143], a[60:63], v[132:135]
    s_mov_b32 s67, 43008
    ds_read_b128 a[124:127], v41 offset:38912
    v_lshlrev_b32 v124, 16, v78
    v_mfma_f32_16x16x32_bf16 v[132:135], a[88:91], a[96:99], v[132:135]
    ds_write_b128 v29, v[228:231] offset:0
    v_and_b32 v125, 0xffff0000, v78
    v_mfma_f32_16x16x32_bf16 v[132:135], a[48:51], a[148:151], v[132:135]
    s_mov_b32 s68, 229376
    v_lshlrev_b32 v126, 16, v79
    v_mfma_f32_16x16x32_bf16 v[132:135], a[208:211], a[8:11], v[132:135]
    ds_read_b128 a[188:191], v44 offset:6144
    v_and_b32 v127, 0xffff0000, v79
    v_mfma_f32_16x16x32_bf16 v[132:135], a[20:23], a[56:59], v[132:135]
    buffer_atomic_add v8, v9, s[28:31], s77 offen sc0 sc1
    v_mfma_f32_16x16x32_bf16 v[132:135], a[12:15], a[120:123], v[132:135]
    s_mov_b32 s69, 243712
    v_mfma_f32_16x16x32_bf16 v[164:167], a[196:199], a[184:187], v[164:167]
    s_waitcnt lgkmcnt(1)
    s_barrier
    v_mfma_f32_16x16x32_bf16 v[164:167], a[136:139], a[212:215], v[164:167]
    s_mov_b32 s70, 258048
    ds_read_b128 a[76:79], v45 offset:6144
    v_mfma_f32_16x16x32_bf16 v[164:167], a[236:239], a[60:63], v[164:167]
    s_mov_b32 s71, 272384
    v_mfma_f32_16x16x32_bf16 v[164:167], a[224:227], a[96:99], v[164:167]
    v_mul_f32 v132, v132, v88
    v_mul_f32 v133, v133, v89
    v_mfma_f32_16x16x32_bf16 v[164:167], a[216:219], a[148:151], v[164:167]
    s_mov_b32 s72, 458752
    ds_read_b128 a[180:183], v42 offset:36864
    v_mul_f32 v134, v134, v90
    v_mfma_f32_16x16x32_bf16 v[164:167], a[172:175], a[8:11], v[164:167]
    v_mul_f32 v135, v135, v91
    v_mfma_f32_16x16x32_bf16 v[164:167], a[80:83], a[56:59], v[164:167]
    s_mov_b32 s73, 473088
    v_mfma_f32_16x16x32_bf16 v[164:167], a[72:75], a[120:123], v[164:167]
    v_mfma_f32_16x16x32_bf16 v[196:199], a[0:3], a[184:187], v[196:199]
    s_mov_b32 s74, 487424
    ds_read_b128 a[168:171], v43 offset:36864
    v_mfma_f32_16x16x32_bf16 v[196:199], a[52:55], a[212:215], v[196:199]
    v_mfma_f32_16x16x32_bf16 v[196:199], a[32:35], a[60:63], v[196:199]
    s_mov_b32 s75, 501760
    v_mfma_f32_16x16x32_bf16 v[196:199], a[116:119], a[96:99], v[196:199]
    ds_read_b128 a[192:195], v46 offset:4096
    v_mul_f32 v164, v164, v96
    v_mfma_f32_16x16x32_bf16 v[196:199], a[160:163], a[148:151], v[196:199]
    s_mov_b32 s48, 688128
    ds_read_b128 v[80:83], v30 offset:0
    v_mul_f32 v165, v165, v97
    v_mfma_f32_16x16x32_bf16 v[196:199], a[92:95], a[8:11], v[196:199]
    v_mul_f32 v166, v166, v98
    v_mul_f32 v167, v167, v99
    v_mfma_f32_16x16x32_bf16 v[196:199], a[16:19], a[56:59], v[196:199]
    s_mov_b32 s49, 702464
    v_mfma_f32_16x16x32_bf16 v[196:199], a[240:243], a[120:123], v[196:199]
    ds_read_b128 a[68:71], v47 offset:4096
    v_mfma_f32_16x16x32_bf16 v[224:227], a[152:155], a[100:103], v[224:227]
    s_mov_b32 s50, 716800
    v_mfma_f32_16x16x32_bf16 v[224:227], a[84:87], a[244:247], v[224:227]
    v_mfma_f32_16x16x32_bf16 v[224:227], a[36:39], a[112:115], v[224:227]
    s_mov_b32 s51, 731136
    ds_read_b128 a[108:111], v40 offset:36864
    v_mfma_f32_16x16x32_bf16 v[224:227], a[220:223], a[132:135], v[224:227]
    v_mul_f32 v196, v196, v120
    v_mul_f32 v197, v197, v121
    v_mfma_f32_16x16x32_bf16 v[128:131], a[144:147], a[100:103], v[128:131]
    v_mul_f32 v198, v198, v122
    v_mul_f32 v199, v199, v123
    v_mfma_f32_16x16x32_bf16 v[128:131], a[232:235], a[244:247], v[128:131]
    v_cvt_pk_bf16_f32 v100, v132, v164
    v_cvt_pk_bf16_f32 v101, v196, v133
    v_mfma_f32_16x16x32_bf16 v[128:131], a[140:143], a[164:167], v[128:131]
    ds_write_b64 v27, v[100:101] offset:0
    v_cvt_pk_bf16_f32 v102, v165, v197
    v_mfma_f32_16x16x32_bf16 v[128:131], a[88:91], a[64:67], v[128:131]
    ds_read_b128 a[200:203], v41 offset:36864
    v_cvt_pk_bf16_f32 v103, v134, v166
    v_mfma_f32_16x16x32_bf16 v[128:131], a[48:51], a[112:115], v[128:131]
    ds_write_b64 v27, v[102:103] offset:8
    v_cvt_pk_bf16_f32 v68, v198, v135
    v_mfma_f32_16x16x32_bf16 v[128:131], a[208:211], a[132:135], v[128:131]
    ds_read_b128 a[24:27], v44 offset:4096
    v_cvt_pk_bf16_f32 v69, v167, v199
    v_mfma_f32_16x16x32_bf16 v[128:131], a[20:23], a[4:7], v[128:131]
    s_waitcnt lgkmcnt(5)
    ds_write_b64 v27, v[68:69] offset:16
    v_add_f32 v224, v224, v80
    v_mfma_f32_16x16x32_bf16 v[128:131], a[12:15], a[28:31], v[128:131]
    v_mul_f32 v224, v224, v124
    v_add_f32 v225, v225, v81
    v_mfma_f32_16x16x32_bf16 v[160:163], a[196:199], a[100:103], v[160:163]
    v_mul_f32 v225, v225, v125
    v_add_f32 v226, v226, v82
    v_mfma_f32_16x16x32_bf16 v[160:163], a[136:139], a[244:247], v[160:163]
    ds_read_b128 a[128:131], v45 offset:4096
    v_mul_f32 v226, v226, v126
    v_mfma_f32_16x16x32_bf16 v[160:163], a[236:239], a[164:167], v[160:163]
    v_add_f32 v227, v227, v83
    v_mul_f32 v227, v227, v127
    v_mfma_f32_16x16x32_bf16 v[160:163], a[224:227], a[64:67], v[160:163]
    v_cvt_pk_bf16_f32 v80, v224, v225
    v_cvt_pk_bf16_f32 v81, v226, v227
    v_mfma_f32_16x16x32_bf16 v[160:163], a[216:219], a[112:115], v[160:163]
    ds_write_b64 v28, v[80:81] offset:0
    v_mul_f32 v128, v128, v88
    v_mfma_f32_16x16x32_bf16 v[160:163], a[172:175], a[132:135], v[160:163]
    ds_read_b128 a[156:159], v42 offset:38912
    v_mul_f32 v129, v129, v89
    v_mfma_f32_16x16x32_bf16 v[160:163], a[80:83], a[4:7], v[160:163]
    v_mul_f32 v130, v130, v90
    v_mul_f32 v131, v131, v91
    v_mfma_f32_16x16x32_bf16 v[160:163], a[72:75], a[28:31], v[160:163]
    v_mfma_f32_16x16x32_bf16 v[192:195], a[0:3], a[100:103], v[192:195]
    ds_read_b128 a[248:251], v43 offset:38912
    v_mfma_f32_16x16x32_bf16 v[192:195], a[52:55], a[244:247], v[192:195]
    v_mfma_f32_16x16x32_bf16 v[192:195], a[32:35], a[164:167], v[192:195]
    v_mfma_f32_16x16x32_bf16 v[192:195], a[116:119], a[64:67], v[192:195]
    ds_read_b128 a[104:107], v46 offset:6144
    v_mul_f32 v160, v160, v96
    v_mfma_f32_16x16x32_bf16 v[192:195], a[160:163], a[112:115], v[192:195]
    v_mul_f32 v161, v161, v97
    v_mul_f32 v162, v162, v98
    v_mfma_f32_16x16x32_bf16 v[192:195], a[92:95], a[132:135], v[192:195]
    v_mul_f32 v163, v163, v99
    v_mfma_f32_16x16x32_bf16 v[192:195], a[16:19], a[4:7], v[192:195]
    v_mfma_f32_16x16x32_bf16 v[192:195], a[240:243], a[28:31], v[192:195]
    ds_read_b128 a[252:255], v47 offset:6144
    v_mfma_f32_16x16x32_bf16 v[236:239], a[152:155], a[40:43], v[236:239]
    v_mfma_f32_16x16x32_bf16 v[236:239], a[84:87], a[124:127], v[236:239]
    v_mfma_f32_16x16x32_bf16 v[236:239], a[36:39], a[188:191], v[236:239]
    ds_read_b128 a[176:179], v40 offset:43008
    v_mfma_f32_16x16x32_bf16 v[236:239], a[220:223], a[76:79], v[236:239]
    v_mul_f32 v192, v192, v120
    v_mul_f32 v193, v193, v121
    v_mfma_f32_16x16x32_bf16 v[140:143], a[144:147], a[40:43], v[140:143]
    v_mul_f32 v194, v194, v122
    v_mul_f32 v195, v195, v123
    v_mfma_f32_16x16x32_bf16 v[140:143], a[232:235], a[124:127], v[140:143]
    v_cvt_pk_bf16_f32 v104, v128, v160
    v_cvt_pk_bf16_f32 v105, v192, v129
    v_mfma_f32_16x16x32_bf16 v[140:143], a[140:143], a[180:183], v[140:143]
    ds_write_b64 v26, v[104:105] offset:0
    v_cvt_pk_bf16_f32 v106, v161, v193
    v_mfma_f32_16x16x32_bf16 v[140:143], a[88:91], a[168:171], v[140:143]
    ds_write_b128 v29, v[236:239] offset:4096
    v_cvt_pk_bf16_f32 v107, v130, v162
    v_mfma_f32_16x16x32_bf16 v[140:143], a[48:51], a[188:191], v[140:143]
    ds_write_b64 v26, v[106:107] offset:8
    v_cvt_pk_bf16_f32 v116, v194, v131
    v_mfma_f32_16x16x32_bf16 v[140:143], a[208:211], a[76:79], v[140:143]
    ds_read_b128 a[204:207], v41 offset:43008
    v_cvt_pk_bf16_f32 v117, v163, v195
    v_mfma_f32_16x16x32_bf16 v[140:143], a[20:23], a[192:195], v[140:143]
    ds_write_b64 v26, v[116:117] offset:16
    v_mfma_f32_16x16x32_bf16 v[140:143], a[12:15], a[68:71], v[140:143]
    ds_read_b128 a[228:231], v44 offset:10240
    v_mfma_f32_16x16x32_bf16 v[172:175], a[196:199], a[40:43], v[172:175]
    v_mfma_f32_16x16x32_bf16 v[172:175], a[136:139], a[124:127], v[172:175]
    ds_read_b128 a[44:47], v45 offset:10240
    v_mfma_f32_16x16x32_bf16 v[172:175], a[236:239], a[180:183], v[172:175]
    v_mfma_f32_16x16x32_bf16 v[172:175], a[224:227], a[168:171], v[172:175]
    s_waitcnt lgkmcnt(2)
    s_barrier
    ds_read_b128 v[112:115], v24 offset:0
    v_mfma_f32_16x16x32_bf16 v[172:175], a[216:219], a[188:191], v[172:175]
    ds_read_b128 v[72:75], v24 offset:928
    v_mul_f32 v140, v140, v88
    v_mfma_f32_16x16x32_bf16 v[172:175], a[172:175], a[76:79], v[172:175]
    ds_read_b128 v[84:87], v24 offset:1856
    v_mul_f32 v141, v141, v89
    v_mfma_f32_16x16x32_bf16 v[172:175], a[80:83], a[192:195], v[172:175]
    ds_read_b128 v[64:67], v24 offset:2784
    v_mul_f32 v142, v142, v90
    v_mfma_f32_16x16x32_bf16 v[172:175], a[72:75], a[68:71], v[172:175]
    ds_read_b128 a[184:187], v42 offset:40960
    v_mul_f32 v143, v143, v91
    v_mfma_f32_16x16x32_bf16 v[204:207], a[0:3], a[40:43], v[204:207]
    ds_read_b128 a[212:215], v43 offset:40960
    v_mfma_f32_16x16x32_bf16 v[204:207], a[52:55], a[124:127], v[204:207]
    v_mfma_f32_16x16x32_bf16 v[204:207], a[32:35], a[180:183], v[204:207]
    v_mfma_f32_16x16x32_bf16 v[204:207], a[116:119], a[168:171], v[204:207]
    s_waitcnt lgkmcnt(5)
    ds_read_b128 a[60:63], v46 offset:8192
    buffer_store_dwordx4 v[112:115], v25, s[16:19], s64 offen sc1
    v_mfma_f32_16x16x32_bf16 v[204:207], a[160:163], a[188:191], v[204:207]
    ds_read_b128 v[48:51], v30 offset:4096
    v_mul_f32 v172, v172, v96
    v_mfma_f32_16x16x32_bf16 v[204:207], a[92:95], a[76:79], v[204:207]
    v_mul_f32 v173, v173, v97
    v_mul_f32 v174, v174, v98
    v_mfma_f32_16x16x32_bf16 v[204:207], a[16:19], a[192:195], v[204:207]
    s_waitcnt lgkmcnt(5)
    buffer_store_dwordx4 v[72:75], v25, s[16:19], s65 offen sc1
    v_mfma_f32_16x16x32_bf16 v[204:207], a[240:243], a[68:71], v[204:207]
    ds_read_b128 a[96:99], v47 offset:8192
    v_mul_f32 v175, v175, v99
    v_mfma_f32_16x16x32_bf16 v[232:235], a[152:155], a[108:111], v[232:235]
    v_mfma_f32_16x16x32_bf16 v[232:235], a[84:87], a[200:203], v[232:235]
    buffer_store_dwordx4 v[84:87], v25, s[16:19], s66 offen sc1
    v_mfma_f32_16x16x32_bf16 v[232:235], a[36:39], a[24:27], v[232:235]
    ds_read_b128 a[148:151], v40 offset:40960
    v_mfma_f32_16x16x32_bf16 v[232:235], a[220:223], a[128:131], v[232:235]
    v_mul_f32 v204, v204, v120
    v_mul_f32 v205, v205, v121
    v_mfma_f32_16x16x32_bf16 v[136:139], a[144:147], a[108:111], v[136:139]
    s_waitcnt lgkmcnt(3)
    buffer_store_dwordx4 v[64:67], v25, s[16:19], s67 offen sc1
    v_mfma_f32_16x16x32_bf16 v[136:139], a[232:235], a[200:203], v[136:139]
    v_mul_f32 v206, v206, v122
    v_mul_f32 v207, v207, v123
    v_mfma_f32_16x16x32_bf16 v[136:139], a[140:143], a[156:159], v[136:139]
    ds_read_b128 a[8:11], v41 offset:40960
    v_cvt_pk_bf16_f32 v92, v140, v172
    v_mfma_f32_16x16x32_bf16 v[136:139], a[88:91], a[248:251], v[136:139]
    v_cvt_pk_bf16_f32 v93, v204, v141
    v_cvt_pk_bf16_f32 v94, v173, v205
    v_mfma_f32_16x16x32_bf16 v[136:139], a[48:51], a[24:27], v[136:139]
    ds_write_b64 v27, v[92:93] offset:14848
    v_cvt_pk_bf16_f32 v95, v142, v174
    v_mfma_f32_16x16x32_bf16 v[136:139], a[208:211], a[128:131], v[136:139]
    ds_write_b64 v27, v[94:95] offset:14856
    v_cvt_pk_bf16_f32 v52, v206, v143
    v_mfma_f32_16x16x32_bf16 v[136:139], a[20:23], a[104:107], v[136:139]
    ds_read_b128 a[56:59], v44 offset:8192
    v_cvt_pk_bf16_f32 v53, v175, v207
    v_mfma_f32_16x16x32_bf16 v[136:139], a[12:15], a[252:255], v[136:139]
    s_waitcnt lgkmcnt(4)
    ds_write_b64 v27, v[52:53] offset:14864
    v_add_f32 v232, v232, v48
    v_mfma_f32_16x16x32_bf16 v[168:171], a[196:199], a[108:111], v[168:171]
    v_mul_f32 v232, v232, v124
    v_add_f32 v233, v233, v49
    v_mfma_f32_16x16x32_bf16 v[168:171], a[136:139], a[200:203], v[168:171]
    ds_read_b128 a[120:123], v45 offset:8192
    v_mul_f32 v233, v233, v125
    v_mfma_f32_16x16x32_bf16 v[168:171], a[236:239], a[156:159], v[168:171]
    v_add_f32 v234, v234, v50
    v_mul_f32 v234, v234, v126
    v_mfma_f32_16x16x32_bf16 v[168:171], a[224:227], a[248:251], v[168:171]
    v_add_f32 v235, v235, v51
    v_mul_f32 v235, v235, v127
    v_mfma_f32_16x16x32_bf16 v[168:171], a[216:219], a[24:27], v[168:171]
    v_cvt_pk_bf16_f32 v48, v232, v233
    v_cvt_pk_bf16_f32 v49, v234, v235
    v_mfma_f32_16x16x32_bf16 v[168:171], a[172:175], a[128:131], v[168:171]
    ds_write_b64 v28, v[48:49] offset:14848
    v_mul_f32 v136, v136, v88
    v_mfma_f32_16x16x32_bf16 v[168:171], a[80:83], a[104:107], v[168:171]
    ds_read_b128 a[100:103], v42 offset:43008
    v_mul_f32 v137, v137, v89
    v_mfma_f32_16x16x32_bf16 v[168:171], a[72:75], a[252:255], v[168:171]
    v_mul_f32 v138, v138, v90
    v_mul_f32 v139, v139, v91
    v_mfma_f32_16x16x32_bf16 v[200:203], a[0:3], a[108:111], v[200:203]
    ds_read_b128 a[244:247], v43 offset:43008
    v_mfma_f32_16x16x32_bf16 v[200:203], a[52:55], a[200:203], v[200:203]
    v_mfma_f32_16x16x32_bf16 v[200:203], a[32:35], a[156:159], v[200:203]
    v_mfma_f32_16x16x32_bf16 v[200:203], a[116:119], a[248:251], v[200:203]
    ds_read_b128 a[164:167], v46 offset:10240
    v_mul_f32 v168, v168, v96
    v_mfma_f32_16x16x32_bf16 v[200:203], a[160:163], a[24:27], v[200:203]
    v_mul_f32 v169, v169, v97
    v_mul_f32 v170, v170, v98
    v_mfma_f32_16x16x32_bf16 v[200:203], a[92:95], a[128:131], v[200:203]
    v_mul_f32 v171, v171, v99
    v_mfma_f32_16x16x32_bf16 v[200:203], a[16:19], a[104:107], v[200:203]
    v_mfma_f32_16x16x32_bf16 v[200:203], a[240:243], a[252:255], v[200:203]
    ds_read_b128 a[64:67], v47 offset:10240
    v_mfma_f32_16x16x32_bf16 v[244:247], a[152:155], a[176:179], v[244:247]
    v_mfma_f32_16x16x32_bf16 v[244:247], a[84:87], a[204:207], v[244:247]
    v_mfma_f32_16x16x32_bf16 v[244:247], a[36:39], a[228:231], v[244:247]
    ds_read_b128 a[112:115], v40 offset:47104
    v_mfma_f32_16x16x32_bf16 v[244:247], a[220:223], a[44:47], v[244:247]
    v_mul_f32 v200, v200, v120
    v_mul_f32 v201, v201, v121
    v_mfma_f32_16x16x32_bf16 v[148:151], a[144:147], a[176:179], v[148:151]
    v_mul_f32 v202, v202, v122
    v_mul_f32 v203, v203, v123
    v_mfma_f32_16x16x32_bf16 v[148:151], a[232:235], a[204:207], v[148:151]
    v_cvt_pk_bf16_f32 v108, v136, v168
    v_cvt_pk_bf16_f32 v109, v200, v137
    v_mfma_f32_16x16x32_bf16 v[148:151], a[140:143], a[184:187], v[148:151]
    ds_write_b64 v26, v[108:109] offset:14848
    v_cvt_pk_bf16_f32 v110, v169, v201
    v_mfma_f32_16x16x32_bf16 v[148:151], a[88:91], a[212:215], v[148:151]
    ds_write_b128 v29, v[244:247] offset:8192
    v_cvt_pk_bf16_f32 v111, v138, v170
    v_mfma_f32_16x16x32_bf16 v[148:151], a[48:51], a[228:231], v[148:151]
    ds_write_b64 v26, v[110:111] offset:14856
    v_cvt_pk_bf16_f32 v76, v202, v139
    v_mfma_f32_16x16x32_bf16 v[148:151], a[208:211], a[44:47], v[148:151]
    ds_read_b128 a[132:135], v41 offset:47104
    v_cvt_pk_bf16_f32 v77, v171, v203
    v_mfma_f32_16x16x32_bf16 v[148:151], a[20:23], a[60:63], v[148:151]
    ds_write_b64 v26, v[76:77] offset:14864
    v_mfma_f32_16x16x32_bf16 v[148:151], a[12:15], a[96:99], v[148:151]
    ds_read_b128 a[4:7], v44 offset:14336
    v_mfma_f32_16x16x32_bf16 v[180:183], a[196:199], a[176:179], v[180:183]
    v_mfma_f32_16x16x32_bf16 v[180:183], a[136:139], a[204:207], v[180:183]
    ds_read_b128 a[28:31], v45 offset:14336
    v_mfma_f32_16x16x32_bf16 v[180:183], a[236:239], a[184:187], v[180:183]
    v_mfma_f32_16x16x32_bf16 v[180:183], a[224:227], a[212:215], v[180:183]
    s_waitcnt lgkmcnt(2)
    s_barrier
    ds_read_b128 v[100:103], v24 offset:14848
    v_mfma_f32_16x16x32_bf16 v[180:183], a[216:219], a[228:231], v[180:183]
    ds_read_b128 v[68:71], v24 offset:15776
    v_mul_f32 v148, v148, v88
    v_mfma_f32_16x16x32_bf16 v[180:183], a[172:175], a[44:47], v[180:183]
    ds_read_b128 v[80:83], v24 offset:16704
    v_mul_f32 v149, v149, v89
    v_mfma_f32_16x16x32_bf16 v[180:183], a[80:83], a[60:63], v[180:183]
    ds_read_b128 v[104:107], v24 offset:17632
    v_mul_f32 v150, v150, v90
    v_mfma_f32_16x16x32_bf16 v[180:183], a[72:75], a[96:99], v[180:183]
    ds_read_b128 a[40:43], v42 offset:45056
    v_mul_f32 v151, v151, v91
    v_mfma_f32_16x16x32_bf16 v[212:215], a[0:3], a[176:179], v[212:215]
    ds_read_b128 a[124:127], v43 offset:45056
    v_mfma_f32_16x16x32_bf16 v[212:215], a[52:55], a[204:207], v[212:215]
    v_mfma_f32_16x16x32_bf16 v[212:215], a[32:35], a[184:187], v[212:215]
    v_mfma_f32_16x16x32_bf16 v[212:215], a[116:119], a[212:215], v[212:215]
    s_waitcnt lgkmcnt(5)
    ds_read_b128 a[180:183], v46 offset:12288
    buffer_store_dwordx4 v[100:103], v25, s[16:19], s68 offen sc1
    v_mfma_f32_16x16x32_bf16 v[212:215], a[160:163], a[228:231], v[212:215]
    ds_read_b128 v[116:119], v30 offset:8192
    v_mul_f32 v180, v180, v96
    v_mfma_f32_16x16x32_bf16 v[212:215], a[92:95], a[44:47], v[212:215]
    v_mul_f32 v181, v181, v97
    v_mul_f32 v182, v182, v98
    v_mfma_f32_16x16x32_bf16 v[212:215], a[16:19], a[60:63], v[212:215]
    s_waitcnt lgkmcnt(5)
    buffer_store_dwordx4 v[68:71], v25, s[16:19], s69 offen sc1
    v_mfma_f32_16x16x32_bf16 v[212:215], a[240:243], a[96:99], v[212:215]
    ds_read_b128 a[168:171], v47 offset:12288
    v_mul_f32 v183, v183, v99
    v_mfma_f32_16x16x32_bf16 v[240:243], a[152:155], a[148:151], v[240:243]
    v_mfma_f32_16x16x32_bf16 v[240:243], a[84:87], a[8:11], v[240:243]
    buffer_store_dwordx4 v[80:83], v25, s[16:19], s70 offen sc1
    v_mfma_f32_16x16x32_bf16 v[240:243], a[36:39], a[56:59], v[240:243]
    ds_read_b128 a[188:191], v40 offset:45056
    v_mfma_f32_16x16x32_bf16 v[240:243], a[220:223], a[120:123], v[240:243]
    v_mul_f32 v212, v212, v120
    v_mul_f32 v213, v213, v121
    v_mfma_f32_16x16x32_bf16 v[144:147], a[144:147], a[148:151], v[144:147]
    s_waitcnt lgkmcnt(3)
    buffer_store_dwordx4 v[104:107], v25, s[16:19], s71 offen sc1
    v_mfma_f32_16x16x32_bf16 v[144:147], a[232:235], a[8:11], v[144:147]
    v_mul_f32 v214, v214, v122
    v_mul_f32 v215, v215, v123
    v_mfma_f32_16x16x32_bf16 v[144:147], a[140:143], a[100:103], v[144:147]
    ds_read_b128 a[76:79], v41 offset:45056
    v_cvt_pk_bf16_f32 v112, v148, v180
    v_mfma_f32_16x16x32_bf16 v[144:147], a[88:91], a[244:247], v[144:147]
    v_cvt_pk_bf16_f32 v113, v212, v149
    v_cvt_pk_bf16_f32 v114, v181, v213
    v_mfma_f32_16x16x32_bf16 v[144:147], a[48:51], a[56:59], v[144:147]
    ds_write_b64 v27, v[112:113] offset:29696
    v_cvt_pk_bf16_f32 v115, v150, v182
    v_mfma_f32_16x16x32_bf16 v[144:147], a[208:211], a[120:123], v[144:147]
    ds_write_b64 v27, v[114:115] offset:29704
    v_cvt_pk_bf16_f32 v72, v214, v151
    v_mfma_f32_16x16x32_bf16 v[144:147], a[20:23], a[164:167], v[144:147]
    ds_read_b128 a[192:195], v44 offset:12288
    v_cvt_pk_bf16_f32 v73, v183, v215
    v_mfma_f32_16x16x32_bf16 v[144:147], a[12:15], a[64:67], v[144:147]
    s_waitcnt lgkmcnt(4)
    ds_write_b64 v27, v[72:73] offset:29712
    v_add_f32 v240, v240, v116
    v_mfma_f32_16x16x32_bf16 v[176:179], a[196:199], a[148:151], v[176:179]
    v_mul_f32 v240, v240, v124
    v_add_f32 v241, v241, v117
    v_mfma_f32_16x16x32_bf16 v[176:179], a[136:139], a[8:11], v[176:179]
    ds_read_b128 a[68:71], v45 offset:12288
    v_mul_f32 v241, v241, v125
    v_mfma_f32_16x16x32_bf16 v[176:179], a[236:239], a[100:103], v[176:179]
    v_add_f32 v242, v242, v118
    v_mul_f32 v242, v242, v126
    v_mfma_f32_16x16x32_bf16 v[176:179], a[224:227], a[244:247], v[176:179]
    v_add_f32 v243, v243, v119
    v_mul_f32 v243, v243, v127
    v_mfma_f32_16x16x32_bf16 v[176:179], a[216:219], a[56:59], v[176:179]
    v_cvt_pk_bf16_f32 v116, v240, v241
    v_cvt_pk_bf16_f32 v117, v242, v243
    v_mfma_f32_16x16x32_bf16 v[176:179], a[172:175], a[120:123], v[176:179]
    ds_write_b64 v28, v[116:117] offset:29696
    v_mul_f32 v144, v144, v88
    v_mfma_f32_16x16x32_bf16 v[176:179], a[80:83], a[164:167], v[176:179]
    ds_read_b128 a[108:111], v42 offset:47104
    v_mul_f32 v145, v145, v89
    v_mfma_f32_16x16x32_bf16 v[176:179], a[72:75], a[64:67], v[176:179]
    v_mul_f32 v146, v146, v90
    v_mul_f32 v147, v147, v91
    v_mfma_f32_16x16x32_bf16 v[208:211], a[0:3], a[148:151], v[208:211]
    ds_read_b128 a[200:203], v43 offset:47104
    v_mfma_f32_16x16x32_bf16 v[208:211], a[52:55], a[8:11], v[208:211]
    v_mfma_f32_16x16x32_bf16 v[208:211], a[32:35], a[100:103], v[208:211]
    v_mfma_f32_16x16x32_bf16 v[208:211], a[116:119], a[244:247], v[208:211]
    ds_read_b128 a[156:159], v46 offset:14336
    v_mul_f32 v176, v176, v96
    v_mfma_f32_16x16x32_bf16 v[208:211], a[160:163], a[56:59], v[208:211]
    v_mul_f32 v177, v177, v97
    v_mul_f32 v178, v178, v98
    v_mfma_f32_16x16x32_bf16 v[208:211], a[92:95], a[120:123], v[208:211]
    v_mul_f32 v179, v179, v99
    v_mfma_f32_16x16x32_bf16 v[208:211], a[16:19], a[164:167], v[208:211]
    v_mfma_f32_16x16x32_bf16 v[208:211], a[240:243], a[64:67], v[208:211]
    ds_read_b128 a[248:251], v47 offset:14336
    v_mfma_f32_16x16x32_bf16 v[252:255], a[152:155], a[112:115], v[252:255]
    v_mfma_f32_16x16x32_bf16 v[252:255], a[84:87], a[132:135], v[252:255]
    v_mfma_f32_16x16x32_bf16 v[252:255], a[36:39], a[4:7], v[252:255]
    v_mfma_f32_16x16x32_bf16 v[252:255], a[220:223], a[28:31], v[252:255]
    v_mul_f32 v208, v208, v120
    v_mul_f32 v209, v209, v121
    v_mfma_f32_16x16x32_bf16 v[156:159], a[144:147], a[112:115], v[156:159]
    v_mul_f32 v210, v210, v122
    v_mul_f32 v211, v211, v123
    v_mfma_f32_16x16x32_bf16 v[156:159], a[232:235], a[132:135], v[156:159]
    v_cvt_pk_bf16_f32 v84, v144, v176
    v_cvt_pk_bf16_f32 v85, v208, v145
    v_mfma_f32_16x16x32_bf16 v[156:159], a[140:143], a[40:43], v[156:159]
    ds_write_b64 v26, v[84:85] offset:29696
    v_cvt_pk_bf16_f32 v86, v177, v209
    v_mfma_f32_16x16x32_bf16 v[156:159], a[88:91], a[124:127], v[156:159]
    ds_write_b128 v29, v[252:255] offset:12288
    v_cvt_pk_bf16_f32 v87, v146, v178
    v_mfma_f32_16x16x32_bf16 v[156:159], a[48:51], a[4:7], v[156:159]
    ds_write_b64 v26, v[86:87] offset:29704
    v_cvt_pk_bf16_f32 v64, v210, v147
    v_mfma_f32_16x16x32_bf16 v[156:159], a[208:211], a[28:31], v[156:159]
    v_cvt_pk_bf16_f32 v65, v179, v211
    v_mfma_f32_16x16x32_bf16 v[156:159], a[20:23], a[180:183], v[156:159]
    ds_write_b64 v26, v[64:65] offset:29712
    v_mfma_f32_16x16x32_bf16 v[156:159], a[12:15], a[168:171], v[156:159]
    v_mfma_f32_16x16x32_bf16 v[188:191], a[196:199], a[112:115], v[188:191]
    v_mfma_f32_16x16x32_bf16 v[188:191], a[136:139], a[132:135], v[188:191]
    v_mfma_f32_16x16x32_bf16 v[188:191], a[236:239], a[40:43], v[188:191]
    v_mfma_f32_16x16x32_bf16 v[188:191], a[224:227], a[124:127], v[188:191]
    s_waitcnt lgkmcnt(0)
    s_barrier
    ds_read_b128 v[92:95], v24 offset:29696
    v_mfma_f32_16x16x32_bf16 v[188:191], a[216:219], a[4:7], v[188:191]
    ds_read_b128 v[52:55], v24 offset:30624
    v_mul_f32 v156, v156, v88
    v_mfma_f32_16x16x32_bf16 v[188:191], a[172:175], a[28:31], v[188:191]
    ds_read_b128 v[48:51], v24 offset:31552
    v_mul_f32 v157, v157, v89
    v_mfma_f32_16x16x32_bf16 v[188:191], a[80:83], a[180:183], v[188:191]
    ds_read_b128 v[108:111], v24 offset:32480
    v_mul_f32 v158, v158, v90
    v_mfma_f32_16x16x32_bf16 v[188:191], a[72:75], a[168:171], v[188:191]
    v_mul_f32 v159, v159, v91
    v_mfma_f32_16x16x32_bf16 v[220:223], a[0:3], a[112:115], v[220:223]
    v_mfma_f32_16x16x32_bf16 v[220:223], a[52:55], a[132:135], v[220:223]
    v_mfma_f32_16x16x32_bf16 v[220:223], a[32:35], a[40:43], v[220:223]
    v_mfma_f32_16x16x32_bf16 v[220:223], a[116:119], a[124:127], v[220:223]
    s_waitcnt lgkmcnt(3)
    ds_read_b128 v[76:79], v30 offset:12288
    buffer_store_dwordx4 v[92:95], v25, s[16:19], s72 offen sc1
    v_mfma_f32_16x16x32_bf16 v[220:223], a[160:163], a[4:7], v[220:223]
    v_mul_f32 v188, v188, v96
    v_mul_f32 v189, v189, v97
    v_mfma_f32_16x16x32_bf16 v[220:223], a[92:95], a[28:31], v[220:223]
    v_mul_f32 v190, v190, v98
    v_mul_f32 v191, v191, v99
    v_mfma_f32_16x16x32_bf16 v[220:223], a[16:19], a[180:183], v[220:223]
    s_waitcnt lgkmcnt(2)
    buffer_store_dwordx4 v[52:55], v25, s[16:19], s73 offen sc1
    v_mfma_f32_16x16x32_bf16 v[220:223], a[240:243], a[168:171], v[220:223]
    v_mfma_f32_16x16x32_bf16 v[248:251], a[152:155], a[188:191], v[248:251]
    v_mfma_f32_16x16x32_bf16 v[248:251], a[84:87], a[76:79], v[248:251]
    buffer_store_dwordx4 v[48:51], v25, s[16:19], s74 offen sc1
    v_mfma_f32_16x16x32_bf16 v[248:251], a[36:39], a[192:195], v[248:251]
    v_mfma_f32_16x16x32_bf16 v[248:251], a[220:223], a[68:71], v[248:251]
    v_mul_f32 v220, v220, v120
    v_mul_f32 v221, v221, v121
    v_mfma_f32_16x16x32_bf16 v[152:155], a[144:147], a[188:191], v[152:155]
    s_waitcnt lgkmcnt(0)
    buffer_store_dwordx4 v[108:111], v25, s[16:19], s75 offen sc1
    v_mfma_f32_16x16x32_bf16 v[152:155], a[232:235], a[76:79], v[152:155]
    v_mul_f32 v222, v222, v122
    v_mul_f32 v223, v223, v123
    v_mfma_f32_16x16x32_bf16 v[152:155], a[140:143], a[108:111], v[152:155]
    v_cvt_pk_bf16_f32 v100, v156, v188
    v_cvt_pk_bf16_f32 v101, v220, v157
    v_mfma_f32_16x16x32_bf16 v[152:155], a[88:91], a[200:203], v[152:155]
    ds_write_b64 v27, v[100:101] offset:44544
    v_cvt_pk_bf16_f32 v102, v189, v221
    v_mfma_f32_16x16x32_bf16 v[152:155], a[48:51], a[192:195], v[152:155]
    v_cvt_pk_bf16_f32 v103, v158, v190
    v_cvt_pk_bf16_f32 v68, v222, v159
    v_mfma_f32_16x16x32_bf16 v[152:155], a[208:211], a[68:71], v[152:155]
    ds_write_b64 v27, v[102:103] offset:44552
    v_cvt_pk_bf16_f32 v69, v191, v223
    v_mfma_f32_16x16x32_bf16 v[152:155], a[20:23], a[156:159], v[152:155]
    ds_write_b64 v27, v[68:69] offset:44560
    v_add_f32 v248, v248, v76
    v_mfma_f32_16x16x32_bf16 v[152:155], a[12:15], a[248:251], v[152:155]
    v_mul_f32 v248, v248, v124
    v_add_f32 v249, v249, v77
    v_mfma_f32_16x16x32_bf16 v[184:187], a[196:199], a[188:191], v[184:187]
    v_mul_f32 v249, v249, v125
    v_add_f32 v250, v250, v78
    v_mfma_f32_16x16x32_bf16 v[184:187], a[136:139], a[76:79], v[184:187]
    v_mul_f32 v250, v250, v126
    v_add_f32 v251, v251, v79
    v_mfma_f32_16x16x32_bf16 v[184:187], a[236:239], a[108:111], v[184:187]
    v_mul_f32 v251, v251, v127
    v_cvt_pk_bf16_f32 v76, v248, v249
    v_mfma_f32_16x16x32_bf16 v[184:187], a[224:227], a[200:203], v[184:187]
    v_cvt_pk_bf16_f32 v77, v250, v251
    v_mul_f32 v152, v152, v88
    v_mfma_f32_16x16x32_bf16 v[184:187], a[216:219], a[192:195], v[184:187]
    ds_write_b64 v28, v[76:77] offset:44544
    v_mul_f32 v153, v153, v89
    v_mfma_f32_16x16x32_bf16 v[184:187], a[172:175], a[68:71], v[184:187]
    v_mul_f32 v154, v154, v90
    v_mul_f32 v155, v155, v91
    v_mfma_f32_16x16x32_bf16 v[184:187], a[80:83], a[156:159], v[184:187]
    s_waitcnt vmcnt(12)
    v_xor_b32 v8, 15, v8
    v_or_b32 v8, v8, v0
    v_mfma_f32_16x16x32_bf16 v[184:187], a[72:75], a[248:251], v[184:187]
    v_min_u32 v8, 1, v8
    v_lshlrev_b32 v8, 30, v8
    v_mfma_f32_16x16x32_bf16 v[216:219], a[0:3], a[188:191], v[216:219]
    v_mov_b32 v9, s76
    v_mfma_f32_16x16x32_bf16 v[216:219], a[52:55], a[76:79], v[216:219]
    buffer_store_dword v9, v8, s[12:15], s78 offen sc1
    v_mfma_f32_16x16x32_bf16 v[216:219], a[32:35], a[108:111], v[216:219]
    v_mfma_f32_16x16x32_bf16 v[216:219], a[116:119], a[200:203], v[216:219]
    v_mul_f32 v184, v184, v96
    v_mul_f32 v185, v185, v97
    v_mfma_f32_16x16x32_bf16 v[216:219], a[160:163], a[192:195], v[216:219]
    v_mul_f32 v186, v186, v98
    v_mul_f32 v187, v187, v99
    v_mfma_f32_16x16x32_bf16 v[216:219], a[92:95], a[68:71], v[216:219]
    v_mfma_f32_16x16x32_bf16 v[216:219], a[16:19], a[156:159], v[216:219]
    v_mfma_f32_16x16x32_bf16 v[216:219], a[240:243], a[248:251], v[216:219]
    s_nop 7
    v_mul_f32 v216, v216, v120
    v_mul_f32 v217, v217, v121
    v_mul_f32 v218, v218, v122
    v_mul_f32 v219, v219, v123
    v_cvt_pk_bf16_f32 v80, v152, v184
    v_cvt_pk_bf16_f32 v81, v216, v153
    v_cvt_pk_bf16_f32 v82, v185, v217
    v_cvt_pk_bf16_f32 v83, v154, v186
    v_cvt_pk_bf16_f32 v104, v218, v155
    v_cvt_pk_bf16_f32 v105, v187, v219
    ds_write_b64 v26, v[80:81] offset:44544
    ds_write_b64 v26, v[82:83] offset:44552
    ds_write_b64 v26, v[104:105] offset:44560
    s_waitcnt lgkmcnt(0)
    s_barrier
    ds_read_b128 v[112:115], v24 offset:44544
    ds_read_b128 v[72:75], v24 offset:45472
    ds_read_b128 v[116:119], v24 offset:46400
    ds_read_b128 v[84:87], v24 offset:47328
    s_waitcnt lgkmcnt(3)
    buffer_store_dwordx4 v[112:115], v25, s[16:19], s48 offen sc1
    s_waitcnt lgkmcnt(2)
    buffer_store_dwordx4 v[72:75], v25, s[16:19], s49 offen sc1
    s_waitcnt lgkmcnt(1)
    buffer_store_dwordx4 v[116:119], v25, s[16:19], s50 offen sc1
    s_waitcnt lgkmcnt(0)
    buffer_store_dwordx4 v[84:87], v25, s[16:19], s51 offen sc1
L_end:
    s_endpgm
L_slow0_0:
    s_mov_b32 s22, 0
    s_call_b64 s[20:21], L_tick
    s_mov_b32 s22, 0
    s_mov_b32 s23, 5120
    buffer_load_dwordx4 v[64:67], v32, s[12:15], s22 offen sc1
    buffer_load_dwordx4 v[68:71], v32, s[12:15], s23 offen sc1
    s_waitcnt vmcnt(0)
    v_bitop3_b32 v67, v67, v71, s76 bitop3:0x7e
    v_cmp_ne_u32 vcc, 0, v67
    s_cbranch_vccnz L_slow0_0
    s_branch L_back0_0
L_slow0_2:
    s_mov_b32 s22, 0
    s_call_b64 s[20:21], L_tick
    s_mov_b32 s22, 0
    s_mov_b32 s23, 5120
    buffer_load_dwordx2 v[72:73], v34, s[12:15], s22 offen sc1
    buffer_load_dwordx2 v[74:75], v34, s[12:15], s23 offen sc1
    s_waitcnt vmcnt(0)
    v_bitop3_b32 v73, v73, v75, s76 bitop3:0x7e
    v_cmp_ne_u32 vcc, 0, v73
    s_cbranch_vccnz L_slow0_2
    s_branch L_back0_2
L_slow0_1:
    s_mov_b32 s22, 0
    s_call_b64 s[20:21], L_tick
    s_mov_b32 s22, 0
    s_mov_b32 s23, 5120
    buffer_load_dwordx4 v[76:79], v33, s[12:15], s22 offen sc1
    buffer_load_dwordx4 v[80:83], v33, s[12:15], s23 offen sc1
    s_waitcnt vmcnt(0)
    v_bitop3_b32 v79, v79, v83, s76 bitop3:0x7e
    v_cmp_ne_u32 vcc, 0, v79
    s_cbranch_vccnz L_slow0_1
    s_branch L_back0_1
L_slow1_0:
    s_mov_b32 s22, 1
    s_call_b64 s[20:21], L_tick
    s_mov_b32 s22, 20480
    s_mov_b32 s23, 25600
    buffer_load_dwordx4 v[88:91], v32, s[12:15], s22 offen sc1
    buffer_load_dwordx4 v[92:95], v32, s[12:15], s23 offen sc1
    s_waitcnt vmcnt(0)
    v_bitop3_b32 v91, v91, v95, s76 bitop3:0x7e
    v_cmp_ne_u32 vcc, 0, v91
    s_cbranch_vccnz L_slow1_0
    s_branch L_back1_0
L_slow1_2:
    s_mov_b32 s22, 1
    s_call_b64 s[20:21], L_tick
    s_mov_b32 s22, 20480
    s_mov_b32 s23, 25600
    buffer_load_dwordx2 v[108:109], v34, s[12:15], s22 offen sc1
    buffer_load_dwordx2 v[110:111], v34, s[12:15], s23 offen sc1
    s_waitcnt vmcnt(0)
    v_bitop3_b32 v109, v109, v111, s76 bitop3:0x7e
    v_cmp_ne_u32 vcc, 0, v109
    s_cbranch_vccnz L_slow1_2
    s_branch L_back1_2
L_slow6_2:
    s_mov_b32 s22, 3
    s_call_b64 s[20:21], L_tick
    s_mov_b32 s22, 61440
    s_mov_b32 s23, 66560
    buffer_load_dwordx2 v[116:117], v34, s[12:15], s22 offen sc1
    buffer_load_dwordx2 v[118:119], v34, s[12:15], s23 offen sc1
    s_waitcnt vmcnt(0)
    v_bitop3_b32 v117, v117, v119, s76 bitop3:0x7e
    v_cmp_ne_u32 vcc, 0, v117
    s_cbranch_vccnz L_slow6_2
    s_branch L_back6_2
L_slow1_1:
    s_mov_b32 s22, 1
    s_call_b64 s[20:21], L_tick
    s_mov_b32 s22, 20480
    s_mov_b32 s23, 25600
    buffer_load_dwordx4 v[120:123], v33, s[12:15], s22 offen sc1
    buffer_load_dwordx4 v[124:127], v33, s[12:15], s23 offen sc1
    s_waitcnt vmcnt(0)
    v_bitop3_b32 v123, v123, v127, s76 bitop3:0x7e
    v_cmp_ne_u32 vcc, 0, v123
    s_cbranch_vccnz L_slow1_1
    s_branch L_back1_1
L_slow6_0:
    s_mov_b32 s22, 3
    s_call_b64 s[20:21], L_tick
    s_mov_b32 s22, 61440
    s_mov_b32 s23, 66560
    buffer_load_dwordx4 v[68:71], v32, s[12:15], s22 offen sc1
    buffer_load_dwordx4 v[72:75], v32, s[12:15], s23 offen sc1
    s_waitcnt vmcnt(0)
    v_bitop3_b32 v71, v71, v75, s76 bitop3:0x7e
    v_cmp_ne_u32 vcc, 0, v71
    s_cbranch_vccnz L_slow6_0
    s_branch L_back6_0
L_slow2_0:
    s_mov_b32 s22, 2
    s_call_b64 s[20:21], L_tick
    s_mov_b32 s22, 40960
    s_mov_b32 s23, 46080
    buffer_load_dwordx4 v[84:87], v32, s[12:15], s22 offen sc1
    buffer_load_dwordx4 v[80:83], v32, s[12:15], s23 offen sc1
    s_waitcnt vmcnt(0)
    v_bitop3_b32 v87, v87, v83, s76 bitop3:0x7e
    v_cmp_ne_u32 vcc, 0, v87
    s_cbranch_vccnz L_slow2_0
    s_branch L_back2_0
L_slow2_2:
    s_mov_b32 s22, 2
    s_call_b64 s[20:21], L_tick
    s_mov_b32 s22, 40960
    s_mov_b32 s23, 46080
    buffer_load_dwordx2 v[100:101], v34, s[12:15], s22 offen sc1
    buffer_load_dwordx2 v[102:103], v34, s[12:15], s23 offen sc1
    s_waitcnt vmcnt(0)
    v_bitop3_b32 v101, v101, v103, s76 bitop3:0x7e
    v_cmp_ne_u32 vcc, 0, v101
    s_cbranch_vccnz L_slow2_2
    s_branch L_back2_2
L_slow2_1:
    s_mov_b32 s22, 2
    s_call_b64 s[20:21], L_tick
    s_mov_b32 s22, 40960
    s_mov_b32 s23, 46080
    buffer_load_dwordx4 v[104:107], v33, s[12:15], s22 offen sc1
    buffer_load_dwordx4 v[112:115], v33, s[12:15], s23 offen sc1
    s_waitcnt vmcnt(0)
    v_bitop3_b32 v107, v107, v115, s76 bitop3:0x7e
    v_cmp_ne_u32 vcc, 0, v107
    s_cbranch_vccnz L_slow2_1
    s_branch L_back2_1
L_slow6_1:
    s_mov_b32 s22, 3
    s_call_b64 s[20:21], L_tick
    s_mov_b32 s22, 61440
    s_mov_b32 s23, 66560
    buffer_load_dwordx4 v[48:51], v33, s[12:15], s22 offen sc1
    buffer_load_dwordx4 v[88:91], v33, s[12:15], s23 offen sc1
    s_waitcnt vmcnt(0)
    v_bitop3_b32 v51, v51, v91, s76 bitop3:0x7e
    v_cmp_ne_u32 vcc, 0, v51
    s_cbranch_vccnz L_slow6_1
    s_branch L_back6_1
L_slow3_0:
    s_mov_b32 s22, 4
    s_call_b64 s[20:21], L_tick
    s_mov_b32 s22, 81920
    s_mov_b32 s23, 87040
    buffer_load_dwordx4 v[92:95], v32, s[12:15], s22 offen sc1
    buffer_load_dwordx4 v[52:55], v32, s[12:15], s23 offen sc1
    s_waitcnt vmcnt(0)
    v_bitop3_b32 v95, v95, v55, s76 bitop3:0x7e
    v_cmp_ne_u32 vcc, 0, v95
    s_cbranch_vccnz L_slow3_0
    s_branch L_back3_0
L_slow3_2:
    s_mov_b32 s22, 4
    s_call_b64 s[20:21], L_tick
    s_mov_b32 s22, 81920
    s_mov_b32 s23, 87040
    buffer_load_dwordx2 v[64:65], v34, s[12:15], s22 offen sc1
    buffer_load_dwordx2 v[66:67], v34, s[12:15], s23 offen sc1
    s_waitcnt vmcnt(0)
    v_bitop3_b32 v65, v65, v67, s76 bitop3:0x7e
    v_cmp_ne_u32 vcc, 0, v65
    s_cbranch_vccnz L_slow3_2
    s_branch L_back3_2
L_slow3_1:
    s_mov_b32 s22, 4
    s_call_b64 s[20:21], L_tick
    s_mov_b32 s22, 81920
    s_mov_b32 s23, 87040
    buffer_load_dwordx4 v[108:111], v33, s[12:15], s22 offen sc1
    buffer_load_dwordx4 v[76:79], v33, s[12:15], s23 offen sc1
    s_waitcnt vmcnt(0)
    v_bitop3_b32 v111, v111, v79, s76 bitop3:0x7e
    v_cmp_ne_u32 vcc, 0, v111
    s_cbranch_vccnz L_slow3_1
    s_branch L_back3_1
L_slow4_0:
    s_mov_b32 s22, 5
    s_call_b64 s[20:21], L_tick
    s_mov_b32 s22, 102400
    s_mov_b32 s23, 107520
    buffer_load_dwordx4 v[96:99], v32, s[12:15], s22 offen sc1
    buffer_load_dwordx4 v[120:123], v32, s[12:15], s23 offen sc1
    s_waitcnt vmcnt(0)
    v_bitop3_b32 v99, v99, v123, s76 bitop3:0x7e
    v_cmp_ne_u32 vcc, 0, v99
    s_cbranch_vccnz L_slow4_0
    s_branch L_back4_0
L_slow7_2:
    s_mov_b32 s22, 7
    s_call_b64 s[20:21], L_tick
    s_mov_b32 s22, 143360
    s_mov_b32 s23, 148480
    buffer_load_dwordx2 v[124:125], v34, s[12:15], s22 offen sc1
    buffer_load_dwordx2 v[126:127], v34, s[12:15], s23 offen sc1
    s_waitcnt vmcnt(0)
    v_bitop3_b32 v125, v125, v127, s76 bitop3:0x7e
    v_cmp_ne_u32 vcc, 0, v125
    s_cbranch_vccnz L_slow7_2
    s_branch L_back7_2
L_slow7_0:
    s_mov_b32 s22, 7
    s_call_b64 s[20:21], L_tick
    s_mov_b32 s22, 143360
    s_mov_b32 s23, 148480
    buffer_load_dwordx4 v[116:119], v32, s[12:15], s22 offen sc1
    buffer_load_dwordx4 v[84:87], v32, s[12:15], s23 offen sc1
    s_waitcnt vmcnt(0)
    v_bitop3_b32 v119, v119, v87, s76 bitop3:0x7e
    v_cmp_ne_u32 vcc, 0, v119
    s_cbranch_vccnz L_slow7_0
    s_branch L_back7_0
L_slow4_2:
    s_mov_b32 s22, 5
    s_call_b64 s[20:21], L_tick
    s_mov_b32 s22, 102400
    s_mov_b32 s23, 107520
    buffer_load_dwordx2 v[80:81], v34, s[12:15], s22 offen sc1
    buffer_load_dwordx2 v[82:83], v34, s[12:15], s23 offen sc1
    s_waitcnt vmcnt(0)
    v_bitop3_b32 v81, v81, v83, s76 bitop3:0x7e
    v_cmp_ne_u32 vcc, 0, v81
    s_cbranch_vccnz L_slow4_2
    s_branch L_back4_2
L_slow4_1:
    s_mov_b32 s22, 5
    s_call_b64 s[20:21], L_tick
    s_mov_b32 s22, 102400
    s_mov_b32 s23, 107520
    buffer_load_dwordx4 v[100:103], v33, s[12:15], s22 offen sc1
    buffer_load_dwordx4 v[68:71], v33, s[12:15], s23 offen sc1
    s_waitcnt vmcnt(0)
    v_bitop3_b32 v103, v103, v71, s76 bitop3:0x7e
    v_cmp_ne_u32 vcc, 0, v103
    s_cbranch_vccnz L_slow4_1
    s_branch L_back4_1
L_slow5_0:
    s_mov_b32 s22, 6
    s_call_b64 s[20:21], L_tick
    s_mov_b32 s22, 122880
    s_mov_b32 s23, 128000
    buffer_load_dwordx4 v[104:107], v32, s[12:15], s22 offen sc1
    buffer_load_dwordx4 v[112:115], v32, s[12:15], s23 offen sc1
    s_waitcnt vmcnt(0)
    v_bitop3_b32 v107, v107, v115, s76 bitop3:0x7e
    v_cmp_ne_u32 vcc, 0, v107
    s_cbranch_vccnz L_slow5_0
    s_branch L_back5_0
L_slow5_2:
    s_mov_b32 s22, 6
    s_call_b64 s[20:21], L_tick
    s_mov_b32 s22, 122880
    s_mov_b32 s23, 128000
    buffer_load_dwordx2 v[72:73], v34, s[12:15], s22 offen sc1
    buffer_load_dwordx2 v[74:75], v34, s[12:15], s23 offen sc1
    s_waitcnt vmcnt(0)
    v_bitop3_b32 v73, v73, v75, s76 bitop3:0x7e
    v_cmp_ne_u32 vcc, 0, v73
    s_cbranch_vccnz L_slow5_2
    s_branch L_back5_2
L_slow7_1:
    s_mov_b32 s22, 7
    s_call_b64 s[20:21], L_tick
    s_mov_b32 s22, 143360
    s_mov_b32 s23, 148480
    buffer_load_dwordx4 v[92:95], v33, s[12:15], s22 offen sc1
    buffer_load_dwordx4 v[52:55], v33, s[12:15], s23 offen sc1
    s_waitcnt vmcnt(0)
    v_bitop3_b32 v95, v95, v55, s76 bitop3:0x7e
    v_cmp_ne_u32 vcc, 0, v95
    s_cbranch_vccnz L_slow7_1
    s_branch L_back7_1
L_slow5_1:
    s_mov_b32 s22, 6
    s_call_b64 s[20:21], L_tick
    s_mov_b32 s22, 122880
    s_mov_b32 s23, 128000
    buffer_load_dwordx4 v[64:67], v33, s[12:15], s22 offen sc1
    buffer_load_dwordx4 v[48:51], v33, s[12:15], s23 offen sc1
    s_waitcnt vmcnt(0)
    v_bitop3_b32 v67, v67, v51, s76 bitop3:0x7e
    v_cmp_ne_u32 vcc, 0, v67
    s_cbranch_vccnz L_slow5_1
    s_branch L_back5_1
L_tick:
    s_add_u32 s52, s52, 1
    s_and_b32 s23, s52, 4095
    s_cbranch_scc1 L_tick_ret
    s_mov_b32 s53, s61
    s_mov_b32 s54, s62
    s_mul_i32 s61, s22, 1835008
    s_add_u32 s61, s61, s79
    s_mul_i32 s62, s22, 20480
    s_mul_i32 s23, s59, 163840
    s_add_u32 s62, s62, s23
    s_mov_b32 s22, 0
L_help_row:
    buffer_load_dwordx4 v[12:15], v19, s[4:7], s61 offen
    buffer_load_dwordx3 v[8:10], v18, s[4:7], s61 offen
    s_waitcnt vmcnt(0)
    v_lshlrev_b32 v12, v5, v12
    v_lshlrev_b32 v13, v5, v13
    v_lshlrev_b32 v14, v5, v14
    v_lshlrev_b32 v15, v5, v15
    v_permlane32_swap_b32 v12, v13
    s_nop 0
    v_permlane32_swap_b32 v14, v15
    v_or_b32 v12, v12, v13
    v_or_b32 v14, v14, v15
    v_mov_b32 v13, s76
    s_nop 0
    v_permlane16_swap_b32 v12, v14
    v_or_b32 v12, v12, v14
    s_nop 1
    v_or_b32_dpp v12, v12, v12 row_ror:8 row_mask:0xf bank_mask:0xf
    buffer_store_dwordx2 v[12:13], v21, s[12:15], s62 offen sc1
    v_mov_b32 v11, s76
    s_mov_b32 s23, 4
L_help_e:
    s_add_u32 s61, s61, 14336
    buffer_load_dwordx3 v[12:14], v18, s[4:7], s61 offen
    s_waitcnt vmcnt(0)
    v_lshl_or_b32 v8, v12, s23, v8
    v_lshl_or_b32 v9, v13, s23, v9
    v_lshl_or_b32 v10, v14, s23, v10
    s_add_u32 s23, s23, 4
    s_cmp_lt_u32 s23, 32
    s_cbranch_scc1 L_help_e
    buffer_store_dwordx4 v[8:11], v20, s[12:15], s62 offen sc1
    s_add_u32 s61, s61, 14336
    s_add_u32 s62, s62, 1280
    s_waitcnt vmcnt(0)
    s_add_u32 s22, s22, 1
    s_cmp_lt_u32 s22, 16
    s_cbranch_scc1 L_help_row
    s_mov_b32 s61, s53
    s_mov_b32 s62, s54
L_tick_ret:
    s_setpc_b64 s[20:21]

.section .rodata,"a"
.p2align 6
.amdhsa_kernel standalone__normalfloat_lut_af4__prompt_kernel
  .amdhsa_next_free_vgpr 512
  .amdhsa_next_free_sgpr 102
  .amdhsa_accum_offset 256
  .amdhsa_group_segment_fixed_size 0
  .amdhsa_kernarg_size 56
  .amdhsa_user_sgpr_count 2
  .amdhsa_user_sgpr_kernarg_segment_ptr 1
  .amdhsa_system_sgpr_workgroup_id_x 1
.end_amdhsa_kernel
```

```asm
; @launch grid=(256,1,1) block=(256,1,1) lds=163840
.amdgcn_target "amdgcn-amd-amdhsa--gfx950"
.text
.globl standalone__normalfloat_lut_af4__prompt_kernel
.p2align 8
.type standalone__normalfloat_lut_af4__prompt_kernel,@function
standalone__normalfloat_lut_af4__prompt_kernel:
    s_cmp_ge_u32 s2, 256
    s_cbranch_scc1 L_end
    s_load_dwordx2 s[4:5], s[0:1], 8
    s_load_dwordx2 s[12:13], s[0:1], 48
    s_load_dwordx2 s[8:9], s[0:1], 0
    s_load_dwordx2 s[28:29], s[0:1], 16
    s_getpc_b64 s[48:49]
    s_mov_b32 s50, L_code_end-standalone__normalfloat_lut_af4__prompt_kernel-256
    s_mov_b32 s51, 0x20000
    v_lshlrev_b32 v10, 7, v0
    buffer_load_dword v1, v10, s[48:51], 0 offen offset:256
    v_lshrrev_b32 v5, 6, v0
    v_and_b32 v2, 63, v0
    s_and_b32 s60, s2, 7
    s_lshr_b32 s61, s2, 3
    v_readfirstlane_b32 s63, v5
    s_and_b32 s58, s60, 1
    s_lshl_b32 s58, s58, 3
    s_and_b32 s62, s61, 7
    s_add_u32 s58, s58, s62
    s_lshr_b32 s59, s60, 1
    s_lshl_b32 s59, s59, 2
    s_lshr_b32 s62, s61, 3
    s_add_u32 s59, s59, s62
    v_mul_u32_u24 v18, 12, v2
    v_lshrrev_b32 v6, 3, v2
    v_and_b32 v7, 7, v2
    v_mul_u32_u24 v19, 14336, v6
    v_lshl_add_u32 v19, v7, 4, v19
    v_add_u32 v19, 768, v19
    s_lshl_b32 s60, s63, 4
    s_add_u32 s60, s60, s58
    s_mul_i32 s61, s60, 114688
    s_mul_i32 s79, s59, 896
    s_add_u32 s61, s61, s79
    s_mov_b32 s6, 14680064
    s_mov_b32 s7, 0x20000
    s_lshl_b32 s78, s59, 7
    s_add_u32 s78, s78, 2621440
    s_cmp_ge_u32 s63, 4
    s_cselect_b32 s46, 1, 0
    s_cmp_lg_u32 s46, 0
    s_waitcnt lgkmcnt(0)
    s_load_dword s76, s[12:13], s78
    s_cbranch_scc1 L_Y
L_X:
    buffer_load_dwordx4 v[160:163], v19, s[4:7], s61 offen
    buffer_load_dwordx3 v[128:130], v18, s[4:7], s61 offen
    s_add_u32 s61, s61, 14336
    buffer_load_dwordx3 v[132:134], v18, s[4:7], s61 offen
    s_add_u32 s61, s61, 14336
    buffer_load_dwordx3 v[136:138], v18, s[4:7], s61 offen
    s_add_u32 s61, s61, 14336
    buffer_load_dwordx3 v[140:142], v18, s[4:7], s61 offen
    s_add_u32 s61, s61, 14336
    buffer_load_dwordx3 v[144:146], v18, s[4:7], s61 offen
    s_add_u32 s61, s61, 14336
    buffer_load_dwordx3 v[148:150], v18, s[4:7], s61 offen
    s_add_u32 s61, s61, 14336
    buffer_load_dwordx3 v[152:154], v18, s[4:7], s61 offen
    s_add_u32 s61, s61, 14336
    buffer_load_dwordx3 v[156:158], v18, s[4:7], s61 offen
    s_add_u32 s61, s61, 7239680
    s_cmp_lg_u32 s46, 0
    s_cbranch_scc1 L_C
L_Y:
    s_load_dwordx2 s[32:33], s[0:1], 24
    s_load_dwordx2 s[16:17], s[0:1], 32
    s_load_dwordx2 s[24:25], s[0:1], 40
    v_lshrrev_b32 v3, 4, v2
    v_and_b32 v4, 15, v2
    v_lshlrev_b32 v8, 1, v4
    v_lshrrev_b32 v9, 4, v0
    v_lshlrev_b32 v9, 1, v9
    s_mov_b32 s30, 32
    s_mov_b32 s31, 0x20000
    buffer_load_ushort v16, v8, s[28:31], 0 offen
    buffer_load_ushort v17, v9, s[28:31], 0 offen
    v_xor_b32 v9, v7, v3
    s_lshl_b32 s70, s63, 5
    v_add_lshl_u32 v8, v6, s70, 11
    v_lshl_add_u32 v36, v9, 4, v8
    v_xor_b32 v37, 64, v36
    v_add_u32 v38, 30720, v36
    v_add_u32 v37, 15360, v37
    v_add_u32 v39, 30720, v37
    s_mov_b32 s10, 4194304
    s_mov_b32 s11, 0x20000
    s_lshl_b32 s55, s58, 18
    s_lshl_b32 s57, s63, 12
    s_add_u32 s57, s57, 65536
    s_add_u32 m0, s57, 32768
    s_add_u32 s56, s55, 0
    buffer_load_dwordx4 v36, s[8:11], s56 offen offset:0 lds
    buffer_load_dwordx4 v37, s[8:11], s56 offen offset:1024 lds
    buffer_load_dwordx4 v38, s[8:11], s56 offen offset:2048 lds
    buffer_load_dwordx4 v39, s[8:11], s56 offen offset:3072 lds
    s_add_u32 m0, s57, 51200
    s_add_u32 s3, s55, 128
    buffer_load_dwordx4 v36, s[8:11], s3 offen offset:0 lds
    buffer_load_dwordx4 v37, s[8:11], s3 offen offset:1024 lds
    s_add_u32 m0, s57, 47104
    s_nop 0
    buffer_load_dwordx4 v38, s[8:11], s3 offen offset:2048 lds
    buffer_load_dwordx4 v39, s[8:11], s3 offen offset:3072 lds
    s_cmp_lg_u32 s46, 0
    s_cbranch_scc1 L_X
L_C:
    s_mov_b32 s14, 2623488
    s_mov_b32 s15, 0x20000
    s_mul_i32 s68, s59, 163840
    s_mul_i32 s62, s60, 1280
    s_add_u32 s62, s62, s68
    v_lshlrev_b32 v5, 2, v6
    v_lshlrev_b32 v20, 4, v2
    v_and_b32 v8, 1, v6
    v_lshlrev_b32 v8, 30, v8
    v_lshl_add_u32 v21, v3, 3, v7
    v_lshl_add_u32 v21, v21, 3, v8
    v_add_u32 v21, 1024, v21
    s_waitcnt lgkmcnt(0)
    s_add_u32 s76, s76, 2654435769
    s_cmp_lg_u32 s46, 0
    s_cbranch_scc1 L_T
L_P:
    s_waitcnt vmcnt(18)
    v_lshlrev_b32 v160, v5, v160
    v_lshlrev_b32 v161, v5, v161
    v_lshlrev_b32 v162, v5, v162
    v_lshlrev_b32 v163, v5, v163
    v_permlane32_swap_b32 v160, v161
    s_nop 0
    v_permlane32_swap_b32 v162, v163
    v_or_b32 v160, v160, v161
    v_or_b32 v162, v162, v163
    v_mov_b32 v161, s76
    s_nop 0
    v_permlane16_swap_b32 v160, v162
    v_or_b32 v160, v160, v162
    s_nop 1
    v_or_b32_dpp v160, v160, v160 row_ror:8 row_mask:0xf bank_mask:0xf
    buffer_store_dwordx2 v[160:161], v21, s[12:15], s62 offen sc1
    v_mov_b32 v131, s76
    s_waitcnt vmcnt(17)
    v_lshl_or_b32 v128, v132, 4, v128
    v_lshl_or_b32 v129, v133, 4, v129
    v_lshl_or_b32 v130, v134, 4, v130
    s_waitcnt vmcnt(16)
    v_lshl_or_b32 v128, v136, 8, v128
    v_lshl_or_b32 v129, v137, 8, v129
    v_lshl_or_b32 v130, v138, 8, v130
    s_waitcnt vmcnt(15)
    v_lshl_or_b32 v128, v140, 12, v128
    v_lshl_or_b32 v129, v141, 12, v129
    v_lshl_or_b32 v130, v142, 12, v130
    s_waitcnt vmcnt(14)
    v_lshl_or_b32 v128, v144, 16, v128
    v_lshl_or_b32 v129, v145, 16, v129
    v_lshl_or_b32 v130, v146, 16, v130
    s_waitcnt vmcnt(13)
    v_lshl_or_b32 v128, v148, 20, v128
    v_lshl_or_b32 v129, v149, 20, v129
    v_lshl_or_b32 v130, v150, 20, v130
    s_waitcnt vmcnt(12)
    v_lshl_or_b32 v128, v152, 24, v128
    v_lshl_or_b32 v129, v153, 24, v129
    v_lshl_or_b32 v130, v154, 24, v130
    s_waitcnt vmcnt(11)
    v_lshl_or_b32 v128, v156, 28, v128
    v_lshl_or_b32 v129, v157, 28, v129
    v_lshl_or_b32 v130, v158, 28, v130
    buffer_store_dwordx4 v[128:131], v20, s[12:15], s62 offen sc1
    s_add_u32 s62, s62, 81920
    s_cmp_lg_u32 s46, 0
    s_cbranch_scc1 L_A
L_T:
    v_lshlrev_b32 v8, 4, v7
    v_lshl_add_u32 v8, v0, 8, v8
    v_xor_b32 v9, 16, v8
    v_xor_b32 v10, 32, v8
    v_xor_b32 v11, 48, v8
    v_xor_b32 v12, 64, v8
    v_xor_b32 v13, 80, v8
    v_xor_b32 v14, 96, v8
    v_xor_b32 v15, 112, v8
    s_waitcnt vmcnt(10)
    v_lshl_or_b32 v56, v17, 16, v16
    v_lshl_or_b32 v57, v17, 16, v16
    v_lshl_or_b32 v58, v17, 16, v16
    v_lshl_or_b32 v59, v17, 16, v16
    ds_write_b128 v8, v[56:59]
    ds_write_b128 v9, v[56:59]
    ds_write_b128 v10, v[56:59]
    ds_write_b128 v11, v[56:59]
    ds_write_b128 v12, v[56:59]
    ds_write_b128 v13, v[56:59]
    ds_write_b128 v14, v[56:59]
    ds_write_b128 v15, v[56:59]
    s_and_b32 s64, s63, 1
    s_lshr_b32 s65, s63, 1
    s_mul_i32 s69, s64, 10240
    v_mul_u32_u24 v16, 1280, v3
    s_lshl_b32 s70, s63, 8
    s_add_u32 s70, s70, s68
    v_lshl_add_u32 v33, v4, 4, v16
    s_add_u32 s71, s70, s69
    v_add_u32 v32, s71, v33
    s_sub_u32 s71, 10240, s69
    s_add_u32 s71, s71, s70
    v_add_u32 v33, s71, v33
    v_and_b32 v17, 1, v4
    v_lshlrev_b32 v17, 7, v17
    v_and_b32 v31, 2, v4
    v_lshl_add_u32 v17, v31, 5, v17
    v_lshrrev_b32 v31, 2, v4
    v_lshl_add_u32 v17, v31, 3, v17
    s_lshl_b32 s70, s65, 5
    s_add_u32 s70, s70, s68
    s_add_u32 s70, s70, s69
    s_add_u32 s70, s70, 1024
    v_add3_u32 v34, v16, v17, s70
    s_mov_b32 s36, 202114048
    s_mov_b32 s37, 202114304
    s_mov_b32 s38, 202114560
    s_mov_b32 s39, 202114816
    v_and_b32 v35, 31, v2
    v_lshlrev_b32 v35, 2, v35
    v_lshrrev_b32 v16, 1, v4
    v_xor_b32 v16, v16, v3
    v_lshlrev_b32 v16, 4, v16
    v_lshl_add_u32 v16, v4, 7, v16
    s_lshl_b32 s70, s64, 14
    s_add_u32 s72, s70, 65536
    s_sub_u32 s73, 81920, s70
    v_add_u32 v40, s72, v16
    v_add_u32 v42, s73, v16
    v_xor_b32 v41, 64, v40
    v_xor_b32 v43, 64, v42
    v_add_u32 v44, 65536, v40
    v_add_u32 v45, 65536, v41
    v_add_u32 v46, 65536, v42
    v_add_u32 v47, 65536, v43
    s_mov_b32 s52, 0
    s_mov_b32 s40, 0
    s_mov_b32 s41, 5120
    s_mov_b32 s42, 0
    s_mov_b32 s43, 5120
    s_mov_b32 s44, 0
    s_mov_b32 s45, 5120
    s_waitcnt vmcnt(9)
    s_cmp_lg_u32 s46, 0
    s_cbranch_scc1 L_B
    s_waitcnt vmcnt(2)
L_B:
    s_waitcnt lgkmcnt(0)
    s_barrier
    buffer_load_dwordx4 v[64:67], v32, s[12:15], s40 offen sc1
    buffer_load_dwordx4 v[68:71], v32, s[12:15], s41 offen sc1
    buffer_load_dwordx2 v[72:73], v34, s[12:15], s42 offen sc1
    buffer_load_dwordx2 v[74:75], v34, s[12:15], s43 offen sc1
    buffer_load_dwordx4 v[76:79], v33, s[12:15], s44 offen sc1
    buffer_load_dwordx4 v[80:83], v33, s[12:15], s45 offen sc1
    ds_read_b128 a[0:3], v40 offset:32768
    ds_read_b128 a[4:7], v41 offset:32768
    ds_read_b128 a[8:11], v40 offset:34816
    ds_read_b128 a[12:15], v41 offset:34816
    ds_read_b128 a[16:19], v40 offset:36864
    ds_read_b128 a[20:23], v41 offset:36864
    ds_read_b128 a[24:27], v40 offset:38912
    ds_read_b128 a[28:31], v41 offset:38912
    ds_read_b128 a[36:39], v40 offset:40960
    ds_read_b128 a[40:43], v41 offset:40960
    ds_read_b128 a[44:47], v40 offset:43008
    ds_read_b128 a[52:55], v41 offset:43008
    ds_read_b128 a[56:59], v40 offset:45056
    ds_read_b128 a[64:67], v41 offset:45056
    ds_read_b128 a[68:71], v40 offset:47104
    ds_read_b128 a[72:75], v41 offset:47104
    s_cmp_eq_u32 s46, 0
    s_cbranch_scc1 L_A
    s_waitcnt vmcnt(6)
    s_branch L_P
L_A:
    s_add_u32 m0, s57, 65536
    s_add_u32 s56, s55, 256
    buffer_load_dwordx4 v36, s[8:11], s56 offen offset:0 lds
    buffer_load_dwordx4 v37, s[8:11], s56 offen offset:1024 lds
    buffer_load_dwordx4 v38, s[8:11], s56 offen offset:2048 lds
    buffer_load_dwordx4 v39, s[8:11], s56 offen offset:3072 lds
    s_mov_b64 exec, 0
    s_cmp_eq_u32 s63, 0
    s_cbranch_scc1 L_pad0
    s_cmp_eq_u32 s63, 1
    s_cbranch_scc1 L_pad3
L_warmed:
    s_mov_b64 exec, -1
    s_waitcnt vmcnt(8)
    v_bitop3_b32 v67, v67, v71, s76 bitop3:0x7e
    v_cmp_ne_u32 vcc, 0, v67
    s_cbranch_vccnz L_slow0_0
L_back0_0:
    v_perm_b32 v56, v64, v35, s36
    v_perm_b32 v57, v64, v35, s37
    v_perm_b32 v58, v64, v35, s38
    v_perm_b32 v59, v64, v35, s39
    v_perm_b32 v60, v68, v35, s36
    v_perm_b32 v61, v68, v35, s37
    v_perm_b32 v62, v68, v35, s38
    v_perm_b32 v63, v68, v35, s39
    ds_read_b32 a32, v56
    ds_read_b32 a33, v57
    ds_read_b32 a34, v58
    ds_read_b32 a35, v59
    ds_read_b32 a48, v60
    ds_read_b32 a49, v61
    ds_read_b32 a50, v62
    ds_read_b32 a51, v63
    v_perm_b32 v56, v65, v35, s36
    v_perm_b32 v57, v65, v35, s37
    v_perm_b32 v58, v65, v35, s38
    v_perm_b32 v59, v65, v35, s39
    v_perm_b32 v60, v69, v35, s36
    ds_read_b32 a60, v56
    ds_read_b32 a61, v57
    ds_read_b32 a62, v58
    ds_read_b32 a63, v59
    s_branch L_main
.p2align 12
L_main:
L_pad0:
    s_cbranch_execz L_pad1
    s_waitcnt lgkmcnt(8)
    v_mfma_f32_16x16x32_bf16 v[128:131], a[32:35], a[0:3], 0
    s_waitcnt lgkmcnt(4)
    s_add_u32 m0, s57, 83968
    ds_read_b32 a76, v60
    v_perm_b32 v61, v69, v35, s37
    v_mfma_f32_16x16x32_bf16 v[128:131], a[48:51], a[4:7], v[128:131]
    s_add_u32 s3, s55, 384
    ds_read_b128 a[80:83], v42 offset:34816
    v_mfma_f32_16x16x32_bf16 v[132:135], a[32:35], a[8:11], 0
    ds_read_b32 a77, v61
    buffer_load_dwordx4 v36, s[8:11], s3 offen offset:0 lds
    v_mfma_f32_16x16x32_bf16 v[132:135], a[48:51], a[12:15], v[132:135]
    s_add_u32 s56, s55, 512
    v_perm_b32 v62, v69, v35, s38
    v_mfma_f32_16x16x32_bf16 v[136:139], a[32:35], a[16:19], 0
    s_mov_b32 s40, 20480
    ds_read_b32 a78, v62
    v_perm_b32 v63, v69, v35, s39
    v_mfma_f32_16x16x32_bf16 v[136:139], a[48:51], a[20:23], v[136:139]
    ds_read_b128 a[84:87], v43 offset:34816
    v_mfma_f32_16x16x32_bf16 v[140:143], a[32:35], a[24:27], 0
    ds_read_b32 a79, v63
    buffer_load_dwordx4 v37, s[8:11], s3 offen offset:1024 lds
    v_mfma_f32_16x16x32_bf16 v[140:143], a[48:51], a[28:31], v[140:143]
    s_add_u32 m0, s57, 79872
    ds_read_b128 a[88:91], v42 offset:32768
    v_perm_b32 v56, v66, v35, s36
    v_mfma_f32_16x16x32_bf16 v[144:147], a[32:35], a[36:39], 0
    s_mov_b32 s41, 25600
    ds_read_b32 a92, v56
    v_perm_b32 v57, v66, v35, s37
    v_mfma_f32_16x16x32_bf16 v[144:147], a[48:51], a[40:43], v[144:147]
    v_mfma_f32_16x16x32_bf16 v[148:151], a[32:35], a[44:47], 0
    ds_read_b32 a93, v57
    buffer_load_dwordx4 v38, s[8:11], s3 offen offset:2048 lds
    v_mfma_f32_16x16x32_bf16 v[148:151], a[48:51], a[52:55], v[148:151]
    s_waitcnt vmcnt(9)
    v_perm_b32 v58, v66, v35, s38
    v_bitop3_b32 v73, v73, v75, s76 bitop3:0x7e
    v_mfma_f32_16x16x32_bf16 v[152:155], a[32:35], a[56:59], 0
    ds_read_b32 a94, v58
    v_cmp_ne_u32 vcc, 0, v73
    v_mfma_f32_16x16x32_bf16 v[152:155], a[48:51], a[64:67], v[152:155]
    ds_read_b128 a[96:99], v43 offset:32768
    v_perm_b32 v59, v66, v35, s39
    v_mfma_f32_16x16x32_bf16 v[156:159], a[32:35], a[68:71], 0
    s_waitcnt lgkmcnt(6)
    ds_read_b32 a95, v59
    buffer_load_dwordx4 v39, s[8:11], s3 offen offset:3072 lds
    v_mfma_f32_16x16x32_bf16 v[156:159], a[48:51], a[72:75], v[156:159]
    s_add_u32 m0, s57, 0
    ds_read_b128 a[100:103], v42 offset:38912
    v_perm_b32 v60, v70, v35, s36
    v_mfma_f32_16x16x32_bf16 v[160:163], a[60:63], a[0:3], 0
    ds_read_b32 a104, v60
    s_cbranch_vccnz L_slow0_2
L_back0_2:
    s_waitcnt lgkmcnt(7)
    v_mfma_f32_16x16x32_bf16 v[160:163], a[76:79], a[4:7], v[160:163]
    ds_read_b128 a[108:111], v43 offset:38912
    v_perm_b32 v61, v70, v35, s37
    v_mfma_f32_16x16x32_bf16 v[164:167], a[60:63], a[8:11], 0
    ds_read_b32 a105, v61
    buffer_load_dwordx4 v[84:87], v32, s[12:15], s40 offen sc1
    v_mfma_f32_16x16x32_bf16 v[164:167], a[76:79], a[12:15], v[164:167]
    ds_read_b128 a[112:115], v42 offset:36864
    v_perm_b32 v62, v70, v35, s38
    v_mfma_f32_16x16x32_bf16 v[168:171], a[60:63], a[16:19], 0
    ds_read_b32 a106, v62
    v_perm_b32 v63, v70, v35, s39
    v_mfma_f32_16x16x32_bf16 v[168:171], a[76:79], a[20:23], v[168:171]
    s_add_u32 s3, s55, 640
    v_mfma_f32_16x16x32_bf16 v[172:175], a[60:63], a[24:27], 0
    ds_read_b32 a107, v63
    buffer_load_dwordx4 v[88:91], v32, s[12:15], s41 offen sc1
    v_mfma_f32_16x16x32_bf16 v[172:175], a[76:79], a[28:31], v[172:175]
    s_mov_b32 s42, 20480
    ds_read_b128 a[116:119], v43 offset:36864
    v_perm_b32 v56, v72, v35, s36
    v_mfma_f32_16x16x32_bf16 v[176:179], a[60:63], a[36:39], 0
    ds_read_b32 a120, v56
    v_perm_b32 v57, v72, v35, s37
    v_mfma_f32_16x16x32_bf16 v[176:179], a[76:79], a[40:43], v[176:179]
    s_mov_b32 s43, 25600
    ds_read_b128 a[124:127], v42 offset:43008
    v_mfma_f32_16x16x32_bf16 v[180:183], a[60:63], a[44:47], 0
    ds_read_b32 a121, v57
    buffer_load_dwordx4 v[92:95], v19, s[4:7], s61 offen
    v_mfma_f32_16x16x32_bf16 v[180:183], a[76:79], a[52:55], v[180:183]
    s_waitcnt vmcnt(11)
    v_perm_b32 v58, v72, v35, s38
    v_bitop3_b32 v79, v79, v83, s76 bitop3:0x7e
    v_mfma_f32_16x16x32_bf16 v[184:187], a[60:63], a[56:59], 0
    ds_read_b32 a122, v58
    v_cmp_ne_u32 vcc, 0, v79
    v_mfma_f32_16x16x32_bf16 v[184:187], a[76:79], a[64:67], v[184:187]
    ds_read_b128 a[128:131], v43 offset:43008
    v_perm_b32 v59, v72, v35, s39
    v_mfma_f32_16x16x32_bf16 v[188:191], a[60:63], a[68:71], 0
    ds_read_b32 a123, v59
    buffer_load_dwordx2 v[96:97], v34, s[12:15], s42 offen sc1
    v_mfma_f32_16x16x32_bf16 v[188:191], a[76:79], a[72:75], v[188:191]
    v_perm_b32 v60, v74, v35, s36
    s_cbranch_vccnz L_slow0_1
L_back0_1:
    s_waitcnt lgkmcnt(7)
    v_mfma_f32_16x16x32_bf16 v[192:195], a[92:95], a[0:3], 0
    ds_read_b32 a132, v60
    v_perm_b32 v61, v74, v35, s37
    v_mfma_f32_16x16x32_bf16 v[192:195], a[104:107], a[4:7], v[192:195]
    ds_read_b128 a[136:139], v42 offset:40960
    v_mfma_f32_16x16x32_bf16 v[196:199], a[92:95], a[8:11], 0
    ds_read_b32 a133, v61
    buffer_load_dwordx2 v[98:99], v34, s[12:15], s43 offen sc1
    v_mfma_f32_16x16x32_bf16 v[196:199], a[104:107], a[12:15], v[196:199]
    ds_read_b128 a[140:143], v43 offset:40960
    v_perm_b32 v62, v74, v35, s38
    v_mfma_f32_16x16x32_bf16 v[200:203], a[92:95], a[16:19], 0
    ds_read_b32 a134, v62
    v_perm_b32 v63, v74, v35, s39
    v_mfma_f32_16x16x32_bf16 v[200:203], a[104:107], a[20:23], v[200:203]
    ds_read_b128 a[144:147], v42 offset:47104
    v_mfma_f32_16x16x32_bf16 v[204:207], a[92:95], a[24:27], 0
    ds_read_b32 a135, v63
    buffer_load_dwordx3 v[100:102], v18, s[4:7], s61 offen
    v_mfma_f32_16x16x32_bf16 v[204:207], a[104:107], a[28:31], v[204:207]
    s_add_u32 s61, s61, 14336
    v_perm_b32 v56, v76, v35, s36
    v_mov_b32 v103, s76
    v_mfma_f32_16x16x32_bf16 v[208:211], a[92:95], a[36:39], 0
    s_mov_b32 s44, 20480
    ds_read_b32 a148, v56
    v_perm_b32 v57, v76, v35, s37
    v_mfma_f32_16x16x32_bf16 v[208:211], a[104:107], a[40:43], v[208:211]
    s_mov_b32 s45, 25600
    ds_read_b128 a[152:155], v43 offset:47104
    v_mfma_f32_16x16x32_bf16 v[212:215], a[92:95], a[44:47], 0
    ds_read_b32 a149, v57
    buffer_load_dwordx4 v[104:107], v33, s[12:15], s44 offen sc1
    v_mfma_f32_16x16x32_bf16 v[212:215], a[104:107], a[52:55], v[212:215]
    ds_read_b128 a[156:159], v42 offset:45056
    v_perm_b32 v58, v76, v35, s38
    v_mfma_f32_16x16x32_bf16 v[216:219], a[92:95], a[56:59], 0
    ds_read_b32 a150, v58
    v_perm_b32 v59, v76, v35, s39
    v_mfma_f32_16x16x32_bf16 v[216:219], a[104:107], a[64:67], v[216:219]
    v_mfma_f32_16x16x32_bf16 v[220:223], a[92:95], a[68:71], 0
    ds_read_b32 a151, v59
    buffer_load_dwordx4 v[108:111], v33, s[12:15], s45 offen sc1
    v_mfma_f32_16x16x32_bf16 v[220:223], a[104:107], a[72:75], v[220:223]
    s_waitcnt lgkmcnt(6)
    ds_read_b128 a[160:163], v43 offset:45056
    v_perm_b32 v60, v80, v35, s36
    v_mfma_f32_16x16x32_bf16 v[224:227], a[120:123], a[0:3], 0
    ds_read_b32 a164, v60
    v_perm_b32 v61, v80, v35, s37
    v_mfma_f32_16x16x32_bf16 v[224:227], a[132:135], a[4:7], v[224:227]
    v_mfma_f32_16x16x32_bf16 v[228:231], a[120:123], a[8:11], 0
    ds_read_b32 a165, v61
    buffer_load_dwordx4 v36, s[8:11], s56 offen offset:0 lds
    v_mfma_f32_16x16x32_bf16 v[228:231], a[132:135], a[12:15], v[228:231]
    v_perm_b32 v62, v80, v35, s38
    v_mfma_f32_16x16x32_bf16 v[232:235], a[120:123], a[16:19], 0
    ds_read_b32 a166, v62
    v_perm_b32 v63, v80, v35, s39
    v_mfma_f32_16x16x32_bf16 v[232:235], a[132:135], a[20:23], v[232:235]
    v_mfma_f32_16x16x32_bf16 v[236:239], a[120:123], a[24:27], 0
    ds_read_b32 a167, v63
    buffer_load_dwordx3 v[112:114], v18, s[4:7], s61 offen
    v_mfma_f32_16x16x32_bf16 v[236:239], a[132:135], a[28:31], v[236:239]
    s_add_u32 s61, s61, 14336
    v_perm_b32 v56, v77, v35, s36
    v_mfma_f32_16x16x32_bf16 v[240:243], a[120:123], a[36:39], 0
    ds_read_b32 a168, v56
    v_perm_b32 v57, v77, v35, s37
    v_mfma_f32_16x16x32_bf16 v[240:243], a[132:135], a[40:43], v[240:243]
    v_mfma_f32_16x16x32_bf16 v[244:247], a[120:123], a[44:47], 0
    ds_read_b32 a169, v57
    buffer_load_dwordx4 v37, s[8:11], s56 offen offset:1024 lds
    v_mfma_f32_16x16x32_bf16 v[244:247], a[132:135], a[52:55], v[244:247]
    v_perm_b32 v58, v77, v35, s38
    v_mfma_f32_16x16x32_bf16 v[248:251], a[120:123], a[56:59], 0
    ds_read_b32 a170, v58
    v_perm_b32 v59, v77, v35, s39
    v_mfma_f32_16x16x32_bf16 v[248:251], a[132:135], a[64:67], v[248:251]
    v_mfma_f32_16x16x32_bf16 v[252:255], a[120:123], a[68:71], 0
    ds_read_b32 a171, v59
    buffer_load_dwordx4 v38, s[8:11], s56 offen offset:2048 lds
    v_mfma_f32_16x16x32_bf16 v[252:255], a[132:135], a[72:75], v[252:255]
    s_waitcnt lgkmcnt(4)
    v_perm_b32 v60, v81, v35, s36
    v_mfma_f32_16x16x32_bf16 v[128:131], a[148:151], a[80:83], v[128:131]
    ds_read_b32 a172, v60
    v_perm_b32 v61, v81, v35, s37
    v_mfma_f32_16x16x32_bf16 v[128:131], a[164:167], a[84:87], v[128:131]
    v_mfma_f32_16x16x32_bf16 v[132:135], a[148:151], a[88:91], v[132:135]
    s_waitcnt vmcnt(12)
    s_barrier
    ds_read_b32 a173, v61
    v_mfma_f32_16x16x32_bf16 v[132:135], a[164:167], a[96:99], v[132:135]
    ds_read_b128 a[176:179], v44 offset:0
    buffer_load_dwordx4 v39, s[8:11], s56 offen offset:3072 lds
    v_mfma_f32_16x16x32_bf16 v[136:139], a[148:151], a[100:103], v[136:139]
    s_add_u32 m0, s57, 18432
    v_perm_b32 v62, v81, v35, s38
    v_perm_b32 v63, v81, v35, s39
    v_mfma_f32_16x16x32_bf16 v[136:139], a[164:167], a[108:111], v[136:139]
    ds_read_b32 a174, v62
    ds_read_b128 a[180:183], v45 offset:0
    v_mfma_f32_16x16x32_bf16 v[140:143], a[148:151], a[112:115], v[140:143]
    ds_read_b32 a175, v63
    v_perm_b32 v56, v78, v35, s36
    v_mfma_f32_16x16x32_bf16 v[140:143], a[164:167], a[116:119], v[140:143]
    ds_read_b128 a[184:187], v44 offset:2048
    buffer_load_dwordx3 v[116:118], v18, s[4:7], s61 offen
    v_mfma_f32_16x16x32_bf16 v[144:147], a[148:151], a[124:127], v[144:147]
    s_add_u32 s61, s61, 14336
    ds_read_b32 a188, v56
    v_perm_b32 v57, v78, v35, s37
    v_mfma_f32_16x16x32_bf16 v[144:147], a[164:167], a[128:131], v[144:147]
    v_mfma_f32_16x16x32_bf16 v[148:151], a[148:151], a[136:139], v[148:151]
    ds_read_b32 a189, v57
    v_perm_b32 v58, v78, v35, s38
    v_mfma_f32_16x16x32_bf16 v[148:151], a[164:167], a[140:143], v[148:151]
    ds_read_b128 a[192:195], v45 offset:2048
    buffer_load_dwordx4 v36, s[8:11], s3 offen offset:0 lds
    v_mfma_f32_16x16x32_bf16 v[152:155], a[148:151], a[144:147], v[152:155]
    s_waitcnt vmcnt(13)
    ds_read_b32 a190, v58
    v_bitop3_b32 v87, v87, v91, s76 bitop3:0x7e
    v_mfma_f32_16x16x32_bf16 v[152:155], a[164:167], a[152:155], v[152:155]
    v_cmp_ne_u32 vcc, 0, v87
    v_perm_b32 v59, v78, v35, s39
    v_mfma_f32_16x16x32_bf16 v[156:159], a[148:151], a[156:159], v[156:159]
    ds_read_b32 a191, v59
    v_perm_b32 v60, v82, v35, s36
    v_mfma_f32_16x16x32_bf16 v[156:159], a[164:167], a[160:163], v[156:159]
    s_waitcnt lgkmcnt(6)
    ds_read_b128 a[196:199], v44 offset:4096
    buffer_load_dwordx4 v37, s[8:11], s3 offen offset:1024 lds
    v_mfma_f32_16x16x32_bf16 v[160:163], a[168:171], a[80:83], v[160:163]
    s_add_u32 m0, s57, 14336
    ds_read_b32 a200, v60
    v_perm_b32 v61, v82, v35, s37
    v_mfma_f32_16x16x32_bf16 v[160:163], a[172:175], a[84:87], v[160:163]
    ds_read_b128 a[204:207], v45 offset:4096
    s_cbranch_vccnz L_slow1_0
L_back1_0:
    v_mfma_f32_16x16x32_bf16 v[164:167], a[168:171], a[88:91], v[164:167]
    ds_read_b32 a201, v61
    v_perm_b32 v62, v82, v35, s38
    v_mfma_f32_16x16x32_bf16 v[164:167], a[172:175], a[96:99], v[164:167]
    ds_read_b128 a[208:211], v44 offset:6144
    buffer_load_dwordx4 v38, s[8:11], s3 offen offset:2048 lds
    v_mfma_f32_16x16x32_bf16 v[168:171], a[168:171], a[100:103], v[168:171]
    ds_read_b32 a202, v62
    v_perm_b32 v63, v82, v35, s39
    v_mfma_f32_16x16x32_bf16 v[168:171], a[172:175], a[108:111], v[168:171]
    v_mfma_f32_16x16x32_bf16 v[172:175], a[168:171], a[112:115], v[172:175]
    s_mov_b32 s40, 40960
    ds_read_b32 a203, v63
    v_perm_b32 v56, v84, v35, s36
    v_mfma_f32_16x16x32_bf16 v[172:175], a[172:175], a[116:119], v[172:175]
    s_waitcnt vmcnt(14)
    ds_read_b128 a[212:215], v45 offset:6144
    buffer_load_dwordx3 v[120:122], v18, s[4:7], s61 offen
    v_mfma_f32_16x16x32_bf16 v[176:179], a[168:171], a[124:127], v[176:179]
    s_add_u32 s61, s61, 14336
    ds_read_b32 a216, v56
    v_perm_b32 v57, v84, v35, s37
    v_mfma_f32_16x16x32_bf16 v[176:179], a[172:175], a[128:131], v[176:179]
    s_mov_b32 s41, 46080
    ds_read_b128 a[220:223], v44 offset:8192
    v_lshlrev_b32 v92, v5, v92
    v_mfma_f32_16x16x32_bf16 v[180:183], a[168:171], a[136:139], v[180:183]
    ds_read_b32 a217, v57
    v_perm_b32 v58, v84, v35, s38
    v_mfma_f32_16x16x32_bf16 v[180:183], a[172:175], a[140:143], v[180:183]
    buffer_load_dwordx4 v39, s[8:11], s3 offen offset:3072 lds
    v_mfma_f32_16x16x32_bf16 v[184:187], a[168:171], a[144:147], v[184:187]
    ds_read_b32 a218, v58
    v_perm_b32 v59, v84, v35, s39
    v_mfma_f32_16x16x32_bf16 v[184:187], a[172:175], a[152:155], v[184:187]
    ds_read_b128 a[224:227], v45 offset:8192
    v_lshlrev_b32 v93, v5, v93
    v_mfma_f32_16x16x32_bf16 v[188:191], a[168:171], a[156:159], v[188:191]
    ds_read_b32 a219, v59
    v_perm_b32 v60, v88, v35, s36
    v_mfma_f32_16x16x32_bf16 v[188:191], a[172:175], a[160:163], v[188:191]
    s_waitcnt lgkmcnt(7)
    ds_read_b128 a[228:231], v44 offset:10240
    buffer_load_dwordx4 v[124:127], v32, s[12:15], s40 offen sc1
    v_mfma_f32_16x16x32_bf16 v[192:195], a[188:191], a[80:83], v[192:195]
    v_lshlrev_b32 v94, v5, v94
    v_lshlrev_b32 v95, v5, v95
    v_mfma_f32_16x16x32_bf16 v[192:195], a[200:203], a[84:87], v[192:195]
    ds_read_b32 a232, v60
    v_perm_b32 v61, v88, v35, s37
    v_mfma_f32_16x16x32_bf16 v[196:199], a[188:191], a[88:91], v[196:199]
    v_permlane32_swap_b32 v92, v93
    v_permlane32_swap_b32 v94, v95
    v_mfma_f32_16x16x32_bf16 v[196:199], a[200:203], a[96:99], v[196:199]
    ds_read_b32 a233, v61
    buffer_load_dwordx3 v[48:50], v18, s[4:7], s61 offen
    v_mfma_f32_16x16x32_bf16 v[200:203], a[188:191], a[100:103], v[200:203]
    s_add_u32 s61, s61, 14336
    v_perm_b32 v62, v88, v35, s38
    v_perm_b32 v63, v88, v35, s39
    v_mfma_f32_16x16x32_bf16 v[200:203], a[200:203], a[108:111], v[200:203]
    ds_read_b32 a234, v62
    v_or_b32 v92, v92, v93
    v_mfma_f32_16x16x32_bf16 v[204:207], a[188:191], a[112:115], v[204:207]
    ds_read_b32 a235, v63
    v_or_b32 v94, v94, v95
    v_mfma_f32_16x16x32_bf16 v[204:207], a[200:203], a[116:119], v[204:207]
    ds_read_b128 a[236:239], v45 offset:10240
    buffer_load_dwordx4 v[52:55], v32, s[12:15], s41 offen sc1
    v_mfma_f32_16x16x32_bf16 v[208:211], a[188:191], a[124:127], v[208:211]
    v_mov_b32 v93, s76
    v_perm_b32 v56, v85, v35, s36
    v_mfma_f32_16x16x32_bf16 v[208:211], a[200:203], a[128:131], v[208:211]
    ds_read_b128 a[240:243], v44 offset:12288
    ds_read_b32 a244, v56
    v_mfma_f32_16x16x32_bf16 v[212:215], a[188:191], a[136:139], v[212:215]
    v_permlane16_swap_b32 v92, v94
    v_or_b32 v92, v92, v94
    v_mfma_f32_16x16x32_bf16 v[212:215], a[200:203], a[140:143], v[212:215]
    ds_read_b128 a[248:251], v45 offset:12288
    buffer_load_dwordx3 v[64:66], v18, s[4:7], s61 offen
    v_mfma_f32_16x16x32_bf16 v[216:219], a[188:191], a[144:147], v[216:219]
    s_add_u32 s61, s61, 14336
    v_or_b32_dpp v92, v92, v92 row_ror:8 row_mask:0xf bank_mask:0xf
    v_perm_b32 v57, v85, v35, s37
    v_mfma_f32_16x16x32_bf16 v[216:219], a[200:203], a[152:155], v[216:219]
    s_add_u32 s56, s55, 768
    ds_read_b32 a245, v57
    v_perm_b32 v58, v85, v35, s38
    v_mfma_f32_16x16x32_bf16 v[220:223], a[188:191], a[156:159], v[220:223]
    ds_read_b32 a246, v58
    v_perm_b32 v59, v85, v35, s39
    v_mfma_f32_16x16x32_bf16 v[220:223], a[200:203], a[160:163], v[220:223]
    s_waitcnt lgkmcnt(6)
    ds_read_b128 a[252:255], v44 offset:14336
    buffer_store_dwordx2 v[92:93], v21, s[12:15], s62 offen sc1
    v_mfma_f32_16x16x32_bf16 v[128:131], a[216:219], a[176:179], v[128:131]
    s_add_u32 m0, s57, 32768
    ds_read_b32 a247, v59
    v_perm_b32 v60, v89, v35, s36
    v_mfma_f32_16x16x32_bf16 v[128:131], a[232:235], a[180:183], v[128:131]
    ds_read_b32 a32, v60
    v_perm_b32 v61, v89, v35, s37
    v_mfma_f32_16x16x32_bf16 v[132:135], a[216:219], a[184:187], v[132:135]
    s_waitcnt vmcnt(14)
    v_lshl_or_b32 v100, v112, 4, v100
    v_lshl_or_b32 v101, v113, 4, v101
    v_mfma_f32_16x16x32_bf16 v[132:135], a[232:235], a[192:195], v[132:135]
    ds_read_b128 a[48:51], v45 offset:14336
    buffer_load_dwordx3 v[68:70], v18, s[4:7], s61 offen
    v_mfma_f32_16x16x32_bf16 v[136:139], a[216:219], a[196:199], v[136:139]
    s_add_u32 s61, s61, 14336
    v_perm_b32 v62, v89, v35, s38
    v_perm_b32 v63, v89, v35, s39
    v_mfma_f32_16x16x32_bf16 v[136:139], a[232:235], a[204:207], v[136:139]
    ds_read_b32 a33, v61
    ds_read_b32 a34, v62
    v_mfma_f32_16x16x32_bf16 v[140:143], a[216:219], a[208:211], v[140:143]
    ds_read_b32 a35, v63
    v_lshl_or_b32 v102, v114, 4, v102
    v_mfma_f32_16x16x32_bf16 v[140:143], a[232:235], a[212:215], v[140:143]
    ds_read_b128 a[60:63], v46 offset:2048
    buffer_load_dwordx4 v36, s[8:11], s56 offen offset:0 lds
    v_mfma_f32_16x16x32_bf16 v[144:147], a[216:219], a[220:223], v[144:147]
    ds_read_b128 a[76:79], v47 offset:2048
    v_perm_b32 v56, v86, v35, s36
    v_mfma_f32_16x16x32_bf16 v[144:147], a[232:235], a[224:227], v[144:147]
    ds_read_b32 a92, v56
    v_perm_b32 v57, v86, v35, s37
    v_mfma_f32_16x16x32_bf16 v[148:151], a[216:219], a[228:231], v[148:151]
    s_waitcnt lgkmcnt(7)
    ds_read_b128 a[104:107], v46 offset:0
    ds_read_b32 a93, v57
    v_mfma_f32_16x16x32_bf16 v[148:151], a[232:235], a[236:239], v[148:151]
    ds_read_b128 a[0:3], v47 offset:0
    buffer_load_dwordx3 v[72:74], v18, s[4:7], s61 offen
    v_mfma_f32_16x16x32_bf16 v[152:155], a[216:219], a[240:243], v[152:155]
    v_perm_b32 v58, v86, v35, s38
    v_bitop3_b32 v97, v97, v99, s76 bitop3:0x7e
    v_mfma_f32_16x16x32_bf16 v[152:155], a[232:235], a[248:251], v[152:155]
    ds_read_b32 a94, v58
    v_cmp_ne_u32 vcc, 0, v97
    v_mfma_f32_16x16x32_bf16 v[156:159], a[216:219], a[252:255], v[156:159]
    s_waitcnt lgkmcnt(8)
    v_perm_b32 v59, v86, v35, s39
    v_perm_b32 v60, v90, v35, s36
    v_mfma_f32_16x16x32_bf16 v[156:159], a[232:235], a[48:51], v[156:159]
    ds_read_b32 a95, v59
    buffer_load_dwordx4 v37, s[8:11], s56 offen offset:1024 lds
    v_mfma_f32_16x16x32_bf16 v[160:163], a[244:247], a[176:179], v[160:163]
    ds_read_b128 a[4:7], v46 offset:6144
    s_cbranch_vccnz L_slow1_2
L_back1_2:
    s_waitcnt lgkmcnt(8)
    v_mfma_f32_16x16x32_bf16 v[160:163], a[32:35], a[180:183], v[160:163]
    ds_read_b32 a8, v60
    v_perm_b32 v61, v90, v35, s37
    v_mfma_f32_16x16x32_bf16 v[164:167], a[244:247], a[184:187], v[164:167]
    ds_read_b32 a9, v61
    v_perm_b32 v62, v90, v35, s38
    v_mfma_f32_16x16x32_bf16 v[164:167], a[32:35], a[192:195], v[164:167]
    s_waitcnt vmcnt(14)
    ds_read_b128 a[12:15], v47 offset:6144
    buffer_load_dwordx4 v38, s[8:11], s56 offen offset:2048 lds
    v_mfma_f32_16x16x32_bf16 v[168:171], a[244:247], a[196:199], v[168:171]
    s_add_u32 s3, s55, 896
    v_perm_b32 v63, v90, v35, s39
    v_lshl_or_b32 v100, v116, 8, v100
    v_mfma_f32_16x16x32_bf16 v[168:171], a[32:35], a[204:207], v[168:171]
    ds_read_b32 a10, v62
    v_lshl_or_b32 v101, v117, 8, v101
    v_mfma_f32_16x16x32_bf16 v[172:175], a[244:247], a[208:211], v[172:175]
    s_mov_b32 s42, 40960
    ds_read_b32 a11, v63
    v_lshl_or_b32 v102, v118, 8, v102
    v_mfma_f32_16x16x32_bf16 v[172:175], a[32:35], a[212:215], v[172:175]
    ds_read_b128 a[16:19], v46 offset:4096
    buffer_load_dwordx4 v39, s[8:11], s56 offen offset:3072 lds
    v_mfma_f32_16x16x32_bf16 v[176:179], a[244:247], a[220:223], v[176:179]
    s_add_u32 m0, s57, 51200
    v_perm_b32 v56, v96, v35, s36
    v_perm_b32 v57, v96, v35, s37
    v_mfma_f32_16x16x32_bf16 v[176:179], a[32:35], a[224:227], v[176:179]
    s_mov_b32 s43, 46080
    ds_read_b32 a24, v56
    ds_read_b128 a[20:23], v47 offset:4096
    v_mfma_f32_16x16x32_bf16 v[180:183], a[244:247], a[228:231], v[180:183]
    ds_read_b32 a25, v57
    v_perm_b32 v58, v96, v35, s38
    v_mfma_f32_16x16x32_bf16 v[180:183], a[32:35], a[236:239], v[180:183]
    ds_read_b128 a[28:31], v46 offset:10240
    buffer_load_dwordx2 v[76:77], v34, s[12:15], s42 offen sc1
    v_mfma_f32_16x16x32_bf16 v[184:187], a[244:247], a[240:243], v[184:187]
    ds_read_b32 a26, v58
    v_bitop3_b32 v107, v107, v111, s76 bitop3:0x7e
    v_mfma_f32_16x16x32_bf16 v[184:187], a[32:35], a[248:251], v[184:187]
    v_cmp_ne_u32 vcc, 0, v107
    v_perm_b32 v59, v96, v35, s39
    v_mfma_f32_16x16x32_bf16 v[188:191], a[244:247], a[252:255], v[188:191]
    ds_read_b32 a27, v59
    v_perm_b32 v60, v98, v35, s36
    v_mfma_f32_16x16x32_bf16 v[188:191], a[32:35], a[48:51], v[188:191]
    s_waitcnt lgkmcnt(7)
    ds_read_b128 a[36:39], v47 offset:10240
    buffer_load_dwordx2 v[78:79], v34, s[12:15], s43 offen sc1
    v_mfma_f32_16x16x32_bf16 v[192:195], a[92:95], a[176:179], v[192:195]
    ds_read_b32 a40, v60
    s_cbranch_vccnz L_slow1_1
L_back1_1:
    v_mfma_f32_16x16x32_bf16 v[192:195], a[8:11], a[180:183], v[192:195]
    ds_read_b128 a[44:47], v46 offset:8192
    v_perm_b32 v61, v98, v35, s37
    v_mfma_f32_16x16x32_bf16 v[196:199], a[92:95], a[184:187], v[196:199]
    ds_read_b32 a41, v61
    v_perm_b32 v62, v98, v35, s38
    v_mfma_f32_16x16x32_bf16 v[196:199], a[8:11], a[192:195], v[196:199]
    ds_read_b128 a[52:55], v47 offset:8192
    buffer_load_dwordx4 v36, s[8:11], s3 offen offset:0 lds
    v_mfma_f32_16x16x32_bf16 v[200:203], a[92:95], a[196:199], v[200:203]
    s_waitcnt vmcnt(15)
    v_perm_b32 v63, v98, v35, s39
    v_lshl_or_b32 v100, v120, 12, v100
    v_mfma_f32_16x16x32_bf16 v[200:203], a[8:11], a[204:207], v[200:203]
    ds_read_b32 a42, v62
    v_lshl_or_b32 v101, v121, 12, v101
    v_mfma_f32_16x16x32_bf16 v[204:207], a[92:95], a[208:211], v[204:207]
    s_mov_b32 s44, 40960
    ds_read_b32 a43, v63
    v_lshl_or_b32 v102, v122, 12, v102
    v_mfma_f32_16x16x32_bf16 v[204:207], a[8:11], a[212:215], v[204:207]
    ds_read_b128 a[56:59], v46 offset:14336
    buffer_load_dwordx4 v37, s[8:11], s3 offen offset:1024 lds
    v_mfma_f32_16x16x32_bf16 v[208:211], a[92:95], a[220:223], v[208:211]
    s_add_u32 m0, s57, 47104
    v_perm_b32 v56, v104, v35, s36
    v_perm_b32 v57, v104, v35, s37
    v_mfma_f32_16x16x32_bf16 v[208:211], a[8:11], a[224:227], v[208:211]
    s_mov_b32 s45, 46080
    ds_read_b32 a68, v56
    ds_read_b128 a[64:67], v47 offset:14336
    v_mfma_f32_16x16x32_bf16 v[212:215], a[92:95], a[228:231], v[212:215]
    ds_read_b32 a69, v57
    v_perm_b32 v58, v104, v35, s38
    v_mfma_f32_16x16x32_bf16 v[212:215], a[8:11], a[236:239], v[212:215]
    ds_read_b128 a[120:123], v46 offset:12288
    buffer_load_dwordx4 v[80:83], v33, s[12:15], s44 offen sc1
    v_mfma_f32_16x16x32_bf16 v[216:219], a[92:95], a[240:243], v[216:219]
    ds_read_b32 a70, v58
    v_perm_b32 v59, v104, v35, s39
    v_mfma_f32_16x16x32_bf16 v[216:219], a[8:11], a[248:251], v[216:219]
    v_mfma_f32_16x16x32_bf16 v[220:223], a[92:95], a[252:255], v[220:223]
    ds_read_b32 a71, v59
    v_perm_b32 v60, v108, v35, s36
    v_mfma_f32_16x16x32_bf16 v[220:223], a[8:11], a[48:51], v[220:223]
    s_waitcnt lgkmcnt(7)
    ds_read_b128 a[72:75], v47 offset:12288
    buffer_load_dwordx4 v[92:95], v33, s[12:15], s45 offen sc1
    v_mfma_f32_16x16x32_bf16 v[224:227], a[24:27], a[176:179], v[224:227]
    s_waitcnt vmcnt(15)
    v_lshl_or_b32 v100, v48, 16, v100
    v_lshl_or_b32 v101, v49, 16, v101
    v_mfma_f32_16x16x32_bf16 v[224:227], a[40:43], a[180:183], v[224:227]
    ds_read_b32 a132, v60
    v_lshl_or_b32 v102, v50, 16, v102
    v_mfma_f32_16x16x32_bf16 v[228:231], a[24:27], a[184:187], v[228:231]
    v_perm_b32 v61, v108, v35, s37
    v_perm_b32 v62, v108, v35, s38
    v_mfma_f32_16x16x32_bf16 v[228:231], a[40:43], a[192:195], v[228:231]
    ds_read_b32 a133, v61
    buffer_load_dwordx4 v38, s[8:11], s3 offen offset:2048 lds
    v_mfma_f32_16x16x32_bf16 v[232:235], a[24:27], a[196:199], v[232:235]
    ds_read_b32 a134, v62
    v_perm_b32 v63, v108, v35, s39
    v_mfma_f32_16x16x32_bf16 v[232:235], a[40:43], a[204:207], v[232:235]
    v_mfma_f32_16x16x32_bf16 v[236:239], a[24:27], a[208:211], v[236:239]
    ds_read_b32 a135, v63
    v_perm_b32 v56, v105, v35, s36
    v_mfma_f32_16x16x32_bf16 v[236:239], a[40:43], a[212:215], v[236:239]
    buffer_load_dwordx4 v39, s[8:11], s3 offen offset:3072 lds
    v_mfma_f32_16x16x32_bf16 v[240:243], a[24:27], a[220:223], v[240:243]
    s_waitcnt vmcnt(15)
    v_lshl_or_b32 v100, v64, 20, v100
    v_lshl_or_b32 v101, v65, 20, v101
    v_mfma_f32_16x16x32_bf16 v[240:243], a[40:43], a[224:227], v[240:243]
    ds_read_b32 a148, v56
    v_lshl_or_b32 v102, v66, 20, v102
    v_mfma_f32_16x16x32_bf16 v[244:247], a[24:27], a[228:231], v[244:247]
    v_perm_b32 v57, v105, v35, s37
    v_perm_b32 v58, v105, v35, s38
    v_mfma_f32_16x16x32_bf16 v[244:247], a[40:43], a[236:239], v[244:247]
    ds_read_b32 a149, v57
    v_mfma_f32_16x16x32_bf16 v[248:251], a[24:27], a[240:243], v[248:251]
    s_waitcnt lgkmcnt(4)
    s_barrier
    ds_read_b32 a150, v58
    v_mfma_f32_16x16x32_bf16 v[248:251], a[40:43], a[248:251], v[248:251]
    v_perm_b32 v59, v105, v35, s39
L_pad1:
    s_cbranch_execz L_pad2
    v_mfma_f32_16x16x32_bf16 v[252:255], a[24:27], a[252:255], v[252:255]
    ds_read_b32 a151, v59
    v_perm_b32 v60, v109, v35, s36
    v_mfma_f32_16x16x32_bf16 v[252:255], a[40:43], a[48:51], v[252:255]
    s_waitcnt vmcnt(13)
    v_lshl_or_b32 v100, v68, 24, v100
    v_lshl_or_b32 v101, v69, 24, v101
    v_mfma_f32_16x16x32_bf16 v[128:131], a[68:71], a[60:63], v[128:131]
    s_waitcnt lgkmcnt(4)
    ds_read_b32 a164, v60
    v_lshl_or_b32 v102, v70, 24, v102
    v_mfma_f32_16x16x32_bf16 v[128:131], a[132:135], a[76:79], v[128:131]
    ds_read_b128 a[168:171], v40 offset:0
    v_perm_b32 v61, v109, v35, s37
    v_mfma_f32_16x16x32_bf16 v[132:135], a[68:71], a[104:107], v[132:135]
    ds_read_b32 a165, v61
    v_perm_b32 v62, v109, v35, s38
    v_mfma_f32_16x16x32_bf16 v[132:135], a[132:135], a[0:3], v[132:135]
    v_mfma_f32_16x16x32_bf16 v[136:139], a[68:71], a[4:7], v[136:139]
    ds_read_b32 a166, v62
    v_perm_b32 v63, v109, v35, s39
    v_mfma_f32_16x16x32_bf16 v[136:139], a[132:135], a[12:15], v[136:139]
    ds_read_b128 a[172:175], v41 offset:0
    v_mfma_f32_16x16x32_bf16 v[140:143], a[68:71], a[16:19], v[140:143]
    ds_read_b32 a167, v63
    v_perm_b32 v56, v106, v35, s36
    v_mfma_f32_16x16x32_bf16 v[140:143], a[132:135], a[20:23], v[140:143]
    s_waitcnt vmcnt(11)
    ds_read_b128 a[80:83], v40 offset:2048
    v_lshl_or_b32 v100, v72, 28, v100
    v_mfma_f32_16x16x32_bf16 v[144:147], a[68:71], a[28:31], v[144:147]
    ds_read_b32 a84, v56
    v_perm_b32 v57, v106, v35, s37
    v_mfma_f32_16x16x32_bf16 v[144:147], a[132:135], a[36:39], v[144:147]
    v_lshl_or_b32 v101, v73, 28, v101
    v_lshl_or_b32 v102, v74, 28, v102
    v_mfma_f32_16x16x32_bf16 v[148:151], a[68:71], a[44:47], v[148:151]
    ds_read_b32 a85, v57
    buffer_store_dwordx4 v[100:103], v20, s[12:15], s62 offen sc1
    v_mfma_f32_16x16x32_bf16 v[148:151], a[132:135], a[52:55], v[148:151]
    v_perm_b32 v58, v106, v35, s38
    v_bitop3_b32 v127, v127, v55, s76 bitop3:0x7e
    v_mfma_f32_16x16x32_bf16 v[152:155], a[68:71], a[56:59], v[152:155]
    ds_read_b32 a86, v58
    v_cmp_ne_u32 vcc, 0, v127
    v_mfma_f32_16x16x32_bf16 v[152:155], a[132:135], a[64:67], v[152:155]
    ds_read_b128 a[88:91], v41 offset:2048
    v_perm_b32 v59, v106, v35, s39
    v_mfma_f32_16x16x32_bf16 v[156:159], a[68:71], a[120:123], v[156:159]
    ds_read_b32 a87, v59
    s_cbranch_vccnz L_slow2_0
L_back2_0:
    v_mfma_f32_16x16x32_bf16 v[156:159], a[132:135], a[72:75], v[156:159]
    s_waitcnt lgkmcnt(6)
    s_mul_i32 s66, s63, 96
    ds_read_b128 a[96:99], v40 offset:4096
    v_perm_b32 v60, v110, v35, s36
    v_mfma_f32_16x16x32_bf16 v[160:163], a[148:151], a[60:63], v[160:163]
    s_lshl_b32 s67, s65, 5
    ds_read_b32 a100, v60
    v_perm_b32 v61, v110, v35, s37
    v_mfma_f32_16x16x32_bf16 v[160:163], a[164:167], a[76:79], v[160:163]
    ds_read_b128 a[108:111], v41 offset:4096
    v_mfma_f32_16x16x32_bf16 v[164:167], a[148:151], a[104:107], v[164:167]
    s_add_u32 s67, s67, 384
    ds_read_b32 a101, v61
    v_perm_b32 v62, v110, v35, s38
    v_mfma_f32_16x16x32_bf16 v[164:167], a[164:167], a[0:3], v[164:167]
    ds_read_b128 a[112:115], v40 offset:6144
    v_mfma_f32_16x16x32_bf16 v[168:171], a[148:151], a[4:7], v[168:171]
    s_mul_i32 s71, s59, 448
    ds_read_b32 a102, v62
    v_perm_b32 v63, v110, v35, s39
    v_mfma_f32_16x16x32_bf16 v[168:171], a[164:167], a[12:15], v[168:171]
    v_mfma_f32_16x16x32_bf16 v[172:175], a[148:151], a[16:19], v[172:175]
    s_mov_b32 s40, 61440
    ds_read_b32 a103, v63
    v_perm_b32 v56, v124, v35, s36
    v_mfma_f32_16x16x32_bf16 v[172:175], a[164:167], a[20:23], v[172:175]
    s_add_u32 s70, s66, s71
    ds_read_b128 a[116:119], v41 offset:6144
    v_mfma_f32_16x16x32_bf16 v[176:179], a[148:151], a[28:31], v[176:179]
    ds_read_b32 a124, v56
    v_perm_b32 v57, v124, v35, s37
    v_mfma_f32_16x16x32_bf16 v[176:179], a[164:167], a[36:39], v[176:179]
    s_mov_b32 s41, 66560
    ds_read_b128 a[128:131], v40 offset:8192
    v_mad_u32_u24 v22, v3, 24, s70
    v_mfma_f32_16x16x32_bf16 v[180:183], a[148:151], a[44:47], v[180:183]
    ds_read_b32 a125, v57
    buffer_load_dwordx4 v[112:115], v32, s[12:15], s40 offen sc1
    v_mfma_f32_16x16x32_bf16 v[180:183], a[164:167], a[52:55], v[180:183]
    s_add_u32 s70, s67, s71
    v_perm_b32 v58, v124, v35, s38
    v_mfma_f32_16x16x32_bf16 v[184:187], a[148:151], a[56:59], v[184:187]
    ds_read_b32 a126, v58
    v_perm_b32 v59, v124, v35, s39
    v_mfma_f32_16x16x32_bf16 v[184:187], a[164:167], a[64:67], v[184:187]
    ds_read_b128 a[136:139], v41 offset:8192
    v_lshl_add_u32 v23, v3, 3, s70
    v_mfma_f32_16x16x32_bf16 v[188:191], a[148:151], a[120:123], v[188:191]
    s_waitcnt lgkmcnt(6)
    ds_read_b32 a127, v59
    buffer_load_dwordx4 v[84:87], v32, s[12:15], s41 offen sc1
    v_mfma_f32_16x16x32_bf16 v[188:191], a[164:167], a[72:75], v[188:191]
    s_mov_b32 s34, 7168
    ds_read_b128 a[140:143], v40 offset:10240
    v_perm_b32 v60, v52, v35, s36
    v_mfma_f32_16x16x32_bf16 v[192:195], a[84:87], a[60:63], v[192:195]
    s_mov_b32 s35, 0x20000
    ds_read_b32 a144, v60
    v_perm_b32 v61, v52, v35, s37
    v_mfma_f32_16x16x32_bf16 v[192:195], a[100:103], a[76:79], v[192:195]
    v_mfma_f32_16x16x32_bf16 v[196:199], a[84:87], a[104:107], v[196:199]
    s_mov_b32 s26, 256
    ds_read_b32 a145, v61
    v_perm_b32 v62, v52, v35, s38
    v_mfma_f32_16x16x32_bf16 v[196:199], a[100:103], a[0:3], v[196:199]
    ds_read_b128 a[152:155], v41 offset:10240
    v_mfma_f32_16x16x32_bf16 v[200:203], a[84:87], a[4:7], v[200:203]
    s_mov_b32 s27, 0x20000
    ds_read_b32 a146, v62
    v_perm_b32 v63, v52, v35, s39
    v_mfma_f32_16x16x32_bf16 v[200:203], a[100:103], a[12:15], v[200:203]
    ds_read_b128 a[156:159], v40 offset:12288
    v_mfma_f32_16x16x32_bf16 v[204:207], a[84:87], a[16:19], v[204:207]
    s_lshl_b32 s77, s59, 4
    ds_read_b32 a147, v63
    v_perm_b32 v56, v125, v35, s36
    v_mfma_f32_16x16x32_bf16 v[204:207], a[100:103], a[20:23], v[204:207]
    v_mfma_f32_16x16x32_bf16 v[208:211], a[84:87], a[28:31], v[208:211]
    s_mov_b32 s18, 14680064
    ds_read_b32 a188, v56
    v_perm_b32 v57, v125, v35, s37
    v_mfma_f32_16x16x32_bf16 v[208:211], a[100:103], a[36:39], v[208:211]
    ds_read_b128 a[160:163], v41 offset:12288
    v_mfma_f32_16x16x32_bf16 v[212:215], a[84:87], a[44:47], v[212:215]
    s_mov_b32 s19, 0x20000
    ds_read_b32 a189, v57
    v_perm_b32 v58, v125, v35, s38
    v_mfma_f32_16x16x32_bf16 v[212:215], a[100:103], a[52:55], v[212:215]
    ds_read_b128 a[200:203], v40 offset:14336
    v_mfma_f32_16x16x32_bf16 v[216:219], a[84:87], a[56:59], v[216:219]
    s_add_u32 s56, s55, 1024
    ds_read_b32 a190, v58
    v_perm_b32 v59, v125, v35, s39
    v_mfma_f32_16x16x32_bf16 v[216:219], a[100:103], a[64:67], v[216:219]
    v_mul_u32_u24 v16, 464, v4
    v_mfma_f32_16x16x32_bf16 v[220:223], a[84:87], a[120:123], v[220:223]
    s_mul_i32 s70, s64, 7424
    ds_read_b32 a191, v59
    v_perm_b32 v60, v53, v35, s36
    v_mfma_f32_16x16x32_bf16 v[220:223], a[100:103], a[72:75], v[220:223]
    s_waitcnt lgkmcnt(6)
    s_add_u32 m0, s57, 65536
    ds_read_b128 a[216:219], v41 offset:14336
    v_mfma_f32_16x16x32_bf16 v[128:131], a[124:127], a[168:171], v[128:131]
    ds_read_b32 a232, v60
    v_perm_b32 v61, v53, v35, s37
    v_mfma_f32_16x16x32_bf16 v[128:131], a[144:147], a[172:175], v[128:131]
    ds_read_b128 a[244:247], v42 offset:2048
    v_mad_u32_u24 v17, v3, 24, v16
    v_mfma_f32_16x16x32_bf16 v[132:135], a[124:127], a[80:83], v[132:135]
    ds_read_b32 a233, v61
    buffer_load_dwordx4 v36, s[8:11], s56 offen offset:0 lds
    v_mfma_f32_16x16x32_bf16 v[132:135], a[144:147], a[88:91], v[132:135]
    s_add_u32 s74, s66, s70
    v_perm_b32 v62, v53, v35, s38
    v_mfma_f32_16x16x32_bf16 v[136:139], a[124:127], a[96:99], v[136:139]
    ds_read_b32 a234, v62
    v_perm_b32 v63, v53, v35, s39
    v_mfma_f32_16x16x32_bf16 v[136:139], a[144:147], a[108:111], v[136:139]
    ds_read_b128 a[32:35], v43 offset:2048
    v_add_u32 v26, s74, v17
    v_mfma_f32_16x16x32_bf16 v[140:143], a[124:127], a[112:115], v[140:143]
    s_sub_u32 s74, 7424, s70
    ds_read_b32 a235, v63
    v_perm_b32 v56, v126, v35, s36
    v_mfma_f32_16x16x32_bf16 v[140:143], a[144:147], a[116:119], v[140:143]
    ds_read_b128 a[92:95], v42 offset:0
    v_mfma_f32_16x16x32_bf16 v[144:147], a[124:127], a[128:131], v[144:147]
    ds_read_b32 a8, v56
    buffer_load_dwordx4 v37, s[8:11], s56 offen offset:1024 lds
    v_mfma_f32_16x16x32_bf16 v[144:147], a[144:147], a[136:139], v[144:147]
    s_add_u32 s74, s74, s66
    v_perm_b32 v57, v126, v35, s37
    v_mfma_f32_16x16x32_bf16 v[148:151], a[124:127], a[140:143], v[148:151]
    ds_read_b32 a9, v57
    v_perm_b32 v58, v126, v35, s38
    v_mfma_f32_16x16x32_bf16 v[148:151], a[144:147], a[152:155], v[148:151]
    s_waitcnt vmcnt(11) lgkmcnt(6)
    ds_read_b128 a[176:179], v43 offset:0
    v_bitop3_b32 v77, v77, v79, s76 bitop3:0x7e
    v_mfma_f32_16x16x32_bf16 v[152:155], a[124:127], a[156:159], v[152:155]
    s_mov_b32 s42, 122880
    ds_read_b32 a10, v58
    v_cmp_ne_u32 vcc, 0, v77
    v_mfma_f32_16x16x32_bf16 v[152:155], a[144:147], a[160:163], v[152:155]
    ds_read_b128 a[180:183], v42 offset:6144
    v_perm_b32 v59, v126, v35, s39
    v_mfma_f32_16x16x32_bf16 v[156:159], a[124:127], a[200:203], v[156:159]
    ds_read_b32 a11, v59
    buffer_load_dwordx4 v38, s[8:11], s56 offen offset:2048 lds
    v_mfma_f32_16x16x32_bf16 v[156:159], a[144:147], a[216:219], v[156:159]
    v_perm_b32 v60, v54, v35, s36
    s_cbranch_vccnz L_slow2_2
L_back2_2:
    v_mfma_f32_16x16x32_bf16 v[160:163], a[188:191], a[168:171], v[160:163]
    s_waitcnt lgkmcnt(6)
    s_mov_b32 s43, 128000
    ds_read_b32 a184, v60
    v_perm_b32 v61, v54, v35, s37
    v_mfma_f32_16x16x32_bf16 v[160:163], a[232:235], a[172:175], v[160:163]
    ds_read_b128 a[192:195], v43 offset:6144
    v_add_u32 v27, s74, v17
    v_mfma_f32_16x16x32_bf16 v[164:167], a[188:191], a[80:83], v[164:167]
    s_add_u32 s74, s67, s70
    ds_read_b32 a185, v61
    v_perm_b32 v62, v54, v35, s38
    v_mfma_f32_16x16x32_bf16 v[164:167], a[232:235], a[88:91], v[164:167]
    ds_read_b128 a[196:199], v42 offset:4096
    v_lshl_add_u32 v28, v3, 3, v16
    v_mfma_f32_16x16x32_bf16 v[168:171], a[188:191], a[96:99], v[168:171]
    ds_read_b32 a186, v62
    buffer_load_dwordx4 v39, s[8:11], s56 offen offset:3072 lds
    v_mfma_f32_16x16x32_bf16 v[168:171], a[232:235], a[108:111], v[168:171]
    s_add_u32 s3, s55, 1152
    v_perm_b32 v63, v54, v35, s39
    v_add_u32 v28, s74, v28
    v_mfma_f32_16x16x32_bf16 v[172:175], a[188:191], a[112:115], v[172:175]
    s_mov_b32 s44, 61440
    ds_read_b32 a187, v63
    v_perm_b32 v56, v76, v35, s36
    v_mfma_f32_16x16x32_bf16 v[172:175], a[232:235], a[116:119], v[172:175]
    s_add_u32 m0, s57, 83968
    ds_read_b128 a[204:207], v43 offset:4096
    v_lshlrev_b32 v29, 4, v0
    v_mfma_f32_16x16x32_bf16 v[176:179], a[188:191], a[128:131], v[176:179]
    ds_read_b32 a208, v56
    v_perm_b32 v57, v76, v35, s37
    v_mfma_f32_16x16x32_bf16 v[176:179], a[232:235], a[136:139], v[176:179]
    s_mov_b32 s45, 66560
    ds_read_b128 a[212:215], v42 offset:10240
    v_add_u32 v29, 65536, v29
    v_mfma_f32_16x16x32_bf16 v[180:183], a[188:191], a[140:143], v[180:183]
    ds_read_b32 a209, v57
    buffer_load_dwordx2 v[88:89], v34, s[12:15], s44 offen sc1
    v_mfma_f32_16x16x32_bf16 v[180:183], a[232:235], a[152:155], v[180:183]
    s_waitcnt vmcnt(10)
    v_perm_b32 v58, v76, v35, s38
    v_bitop3_b32 v83, v83, v95, s76 bitop3:0x7e
    v_mfma_f32_16x16x32_bf16 v[184:187], a[188:191], a[156:159], v[184:187]
    ds_read_b32 a210, v58
    v_cmp_ne_u32 vcc, 0, v83
    v_mfma_f32_16x16x32_bf16 v[184:187], a[232:235], a[160:163], v[184:187]
    ds_read_b128 a[220:223], v43 offset:10240
    v_perm_b32 v59, v76, v35, s39
    v_mfma_f32_16x16x32_bf16 v[188:191], a[188:191], a[200:203], v[188:191]
    ds_read_b32 a211, v59
    buffer_load_dwordx2 v[90:91], v34, s[12:15], s45 offen sc1
    v_mfma_f32_16x16x32_bf16 v[188:191], a[232:235], a[216:219], v[188:191]
    v_perm_b32 v60, v78, v35, s36
    s_cbranch_vccnz L_slow2_1
L_back2_1:
    s_waitcnt lgkmcnt(7)
    v_mfma_f32_16x16x32_bf16 v[192:195], a[8:11], a[168:171], v[192:195]
    ds_read_b32 a224, v60
    v_perm_b32 v61, v78, v35, s37
    v_mfma_f32_16x16x32_bf16 v[192:195], a[184:187], a[172:175], v[192:195]
    ds_read_b128 a[228:231], v42 offset:8192
    v_xor_b32 v30, 1024, v29
    v_mfma_f32_16x16x32_bf16 v[196:199], a[8:11], a[80:83], v[196:199]
    ds_read_b32 a225, v61
    buffer_load_dwordx4 v36, s[8:11], s3 offen offset:0 lds
    v_mfma_f32_16x16x32_bf16 v[196:199], a[184:187], a[88:91], v[196:199]
    ds_read_b128 a[236:239], v43 offset:8192
    v_perm_b32 v62, v78, v35, s38
    v_mfma_f32_16x16x32_bf16 v[200:203], a[8:11], a[96:99], v[200:203]
    ds_read_b32 a226, v62
    v_perm_b32 v63, v78, v35, s39
    v_mfma_f32_16x16x32_bf16 v[200:203], a[184:187], a[108:111], v[200:203]
    ds_read_b128 a[240:243], v42 offset:14336
    v_mul_u32_u24 v16, 2341, v2
    v_mfma_f32_16x16x32_bf16 v[204:207], a[8:11], a[112:115], v[204:207]
    ds_read_b32 a227, v63
    buffer_load_dwordx4 v37, s[8:11], s3 offen offset:1024 lds
    v_mfma_f32_16x16x32_bf16 v[204:207], a[184:187], a[116:119], v[204:207]
    s_add_u32 m0, s57, 79872
    v_perm_b32 v56, v80, v35, s36
    v_lshrrev_b32 v16, 16, v16
    v_mfma_f32_16x16x32_bf16 v[208:211], a[8:11], a[128:131], v[208:211]
    s_mov_b32 s40, 61440
    ds_read_b32 a248, v56
    v_perm_b32 v57, v80, v35, s37
    v_mfma_f32_16x16x32_bf16 v[208:211], a[184:187], a[136:139], v[208:211]
    s_mov_b32 s41, 66560
    ds_read_b128 a[252:255], v43 offset:14336
    v_mfma_f32_16x16x32_bf16 v[212:215], a[8:11], a[140:143], v[212:215]
    ds_read_b32 a249, v57
    buffer_load_dwordx4 v[116:119], v33, s[12:15], s40 offen sc1
    v_mfma_f32_16x16x32_bf16 v[212:215], a[184:187], a[152:155], v[212:215]
    s_mul_i32 s73, s63, 3712
    ds_read_b128 a[24:27], v42 offset:12288
    v_perm_b32 v58, v80, v35, s38
    v_mfma_f32_16x16x32_bf16 v[216:219], a[8:11], a[156:159], v[216:219]
    ds_read_b32 a250, v58
    v_perm_b32 v59, v80, v35, s39
    v_mfma_f32_16x16x32_bf16 v[216:219], a[184:187], a[160:163], v[216:219]
    v_add_lshl_u32 v24, v2, v16, 4
    v_add_u32 v24, s73, v24
    v_mfma_f32_16x16x32_bf16 v[220:223], a[8:11], a[200:203], v[220:223]
    s_waitcnt lgkmcnt(5)
    ds_read_b32 a251, v59
    buffer_load_dwordx4 v[96:99], v33, s[12:15], s41 offen sc1
    v_mfma_f32_16x16x32_bf16 v[220:223], a[184:187], a[216:219], v[220:223]
    s_lshl_b32 s74, s58, 7
    ds_read_b128 a[48:51], v43 offset:12288
    v_perm_b32 v60, v92, v35, s36
    v_mfma_f32_16x16x32_bf16 v[224:227], a[208:211], a[168:171], v[224:227]
    s_lshl_b32 s75, s63, 3
    ds_read_b32 a40, v60
    v_perm_b32 v61, v92, v35, s37
    v_mfma_f32_16x16x32_bf16 v[224:227], a[224:227], a[172:175], v[224:227]
    s_add_u32 s74, s74, s75
    v_mfma_f32_16x16x32_bf16 v[228:231], a[208:211], a[80:83], v[228:231]
    ds_read_b32 a41, v61
    buffer_load_dwordx4 v38, s[8:11], s3 offen offset:2048 lds
    v_mfma_f32_16x16x32_bf16 v[228:231], a[224:227], a[88:91], v[228:231]
    s_mul_i32 s74, s74, 7168
    v_perm_b32 v62, v92, v35, s38
    v_mfma_f32_16x16x32_bf16 v[232:235], a[208:211], a[96:99], v[232:235]
    s_add_u32 s74, s74, s71
    ds_read_b32 a42, v62
    v_perm_b32 v63, v92, v35, s39
    v_mfma_f32_16x16x32_bf16 v[232:235], a[224:227], a[108:111], v[232:235]
    v_mul_u32_u24 v17, 6720, v16
    v_lshl_add_u32 v25, v2, 4, v17
    v_mfma_f32_16x16x32_bf16 v[236:239], a[208:211], a[112:115], v[236:239]
    ds_read_b32 a43, v63
    buffer_load_dwordx4 v39, s[8:11], s3 offen offset:3072 lds
    v_mfma_f32_16x16x32_bf16 v[236:239], a[224:227], a[116:119], v[236:239]
    v_perm_b32 v56, v81, v35, s36
    v_lshrrev_b32 v16, 1, v16
    v_mfma_f32_16x16x32_bf16 v[240:243], a[208:211], a[128:131], v[240:243]
    ds_read_b32 a68, v56
    v_perm_b32 v57, v81, v35, s37
    v_mfma_f32_16x16x32_bf16 v[240:243], a[224:227], a[136:139], v[240:243]
    v_lshlrev_b32 v16, 30, v16
    v_add3_u32 v25, v25, v16, s74
    v_mfma_f32_16x16x32_bf16 v[244:247], a[208:211], a[140:143], v[244:247]
    ds_read_b32 a69, v57
    v_perm_b32 v58, v81, v35, s38
    v_mfma_f32_16x16x32_bf16 v[244:247], a[224:227], a[152:155], v[244:247]
    v_mfma_f32_16x16x32_bf16 v[248:251], a[208:211], a[156:159], v[248:251]
    s_waitcnt vmcnt(15) lgkmcnt(4)
    s_barrier
    ds_read_b32 a70, v58
    v_mfma_f32_16x16x32_bf16 v[248:251], a[224:227], a[160:163], v[248:251]
    v_perm_b32 v59, v81, v35, s39
    v_mfma_f32_16x16x32_bf16 v[252:255], a[208:211], a[200:203], v[252:255]
    ds_read_b32 a71, v59
    buffer_load_dwordx2 v[120:121], v34, s[12:15], s42 offen sc1
    v_mfma_f32_16x16x32_bf16 v[252:255], a[224:227], a[216:219], v[252:255]
    s_mov_b32 s42, 122880
    v_perm_b32 v60, v93, v35, s36
    v_mfma_f32_16x16x32_bf16 v[128:131], a[248:251], a[244:247], v[128:131]
    s_waitcnt lgkmcnt(4)
    ds_read_b32 a132, v60
    v_perm_b32 v61, v93, v35, s37
    v_mfma_f32_16x16x32_bf16 v[128:131], a[40:43], a[32:35], v[128:131]
    ds_read_b128 a[148:151], v40 offset:32768
    v_mfma_f32_16x16x32_bf16 v[132:135], a[248:251], a[92:95], v[132:135]
    ds_read_b32 a133, v61
    buffer_load_dwordx2 v[122:123], v34, s[12:15], s43 offen sc1
    v_mfma_f32_16x16x32_bf16 v[132:135], a[40:43], a[176:179], v[132:135]
    s_mov_b32 s43, 128000
    v_perm_b32 v62, v93, v35, s38
    v_mfma_f32_16x16x32_bf16 v[136:139], a[248:251], a[180:183], v[136:139]
    ds_read_b32 a134, v62
    v_perm_b32 v63, v93, v35, s39
    v_mfma_f32_16x16x32_bf16 v[136:139], a[40:43], a[192:195], v[136:139]
    ds_read_b128 a[164:167], v41 offset:32768
    v_mfma_f32_16x16x32_bf16 v[140:143], a[248:251], a[196:199], v[140:143]
    ds_read_b32 a135, v63
    buffer_load_dwordx4 v[48:51], v32, s[12:15], s42 offen sc1
    v_mfma_f32_16x16x32_bf16 v[140:143], a[40:43], a[204:207], v[140:143]
    ds_read_b128 a[60:63], v40 offset:34816
    v_perm_b32 v56, v82, v35, s36
    v_mfma_f32_16x16x32_bf16 v[144:147], a[248:251], a[212:215], v[144:147]
    ds_read_b32 a76, v56
    v_perm_b32 v57, v82, v35, s37
    v_mfma_f32_16x16x32_bf16 v[144:147], a[40:43], a[220:223], v[144:147]
    v_mfma_f32_16x16x32_bf16 v[148:151], a[248:251], a[228:231], v[148:151]
    ds_read_b32 a77, v57
    buffer_load_dwordx4 v[64:67], v32, s[12:15], s43 offen sc1
    v_mfma_f32_16x16x32_bf16 v[148:151], a[40:43], a[236:239], v[148:151]
    s_waitcnt vmcnt(16)
    v_perm_b32 v58, v82, v35, s38
    v_bitop3_b32 v115, v115, v87, s76 bitop3:0x7e
    v_mfma_f32_16x16x32_bf16 v[152:155], a[248:251], a[240:243], v[152:155]
    s_mov_b32 s44, 122880
    ds_read_b32 a78, v58
    v_cmp_ne_u32 vcc, 0, v115
    v_mfma_f32_16x16x32_bf16 v[152:155], a[40:43], a[252:255], v[152:155]
    ds_read_b128 a[104:107], v41 offset:34816
    v_perm_b32 v59, v82, v35, s39
    v_mfma_f32_16x16x32_bf16 v[156:159], a[248:251], a[24:27], v[156:159]
    ds_read_b32 a79, v59
    s_cbranch_vccnz L_slow3_0
L_back3_0:
    v_mfma_f32_16x16x32_bf16 v[156:159], a[40:43], a[48:51], v[156:159]
    s_waitcnt lgkmcnt(6)
    s_mov_b32 s45, 128000
    ds_read_b128 a[0:3], v40 offset:36864
    v_perm_b32 v60, v94, v35, s36
    v_mfma_f32_16x16x32_bf16 v[160:163], a[68:71], a[244:247], v[160:163]
    ds_read_b32 a4, v60
    buffer_load_dwordx4 v[68:71], v33, s[12:15], s44 offen sc1
    v_mfma_f32_16x16x32_bf16 v[160:163], a[132:135], a[32:35], v[160:163]
    ds_read_b128 a[12:15], v41 offset:36864
    v_perm_b32 v61, v94, v35, s37
    v_mfma_f32_16x16x32_bf16 v[164:167], a[68:71], a[92:95], v[164:167]
    ds_read_b32 a5, v61
    v_perm_b32 v62, v94, v35, s38
    v_mfma_f32_16x16x32_bf16 v[164:167], a[132:135], a[176:179], v[164:167]
    ds_read_b128 a[16:19], v40 offset:38912
    v_mfma_f32_16x16x32_bf16 v[168:171], a[68:71], a[180:183], v[168:171]
    ds_read_b32 a6, v62
    buffer_load_dwordx4 v[72:75], v33, s[12:15], s45 offen sc1
    v_mfma_f32_16x16x32_bf16 v[168:171], a[132:135], a[192:195], v[168:171]
    v_perm_b32 v63, v94, v35, s39
    v_mfma_f32_16x16x32_bf16 v[172:175], a[68:71], a[196:199], v[172:175]
    s_mov_b32 s40, 81920
    ds_read_b32 a7, v63
    v_perm_b32 v56, v112, v35, s36
    v_mfma_f32_16x16x32_bf16 v[172:175], a[132:135], a[204:207], v[172:175]
    ds_read_b128 a[20:23], v41 offset:38912
    v_mfma_f32_16x16x32_bf16 v[176:179], a[68:71], a[212:215], v[176:179]
    ds_read_b32 a28, v56
    v_perm_b32 v57, v112, v35, s37
    v_mfma_f32_16x16x32_bf16 v[176:179], a[132:135], a[220:223], v[176:179]
    s_mov_b32 s41, 87040
    ds_read_b128 a[36:39], v40 offset:40960
    v_mfma_f32_16x16x32_bf16 v[180:183], a[68:71], a[228:231], v[180:183]
    ds_read_b32 a29, v57
    buffer_load_dwordx4 v[100:103], v32, s[12:15], s40 offen sc1
    v_mfma_f32_16x16x32_bf16 v[180:183], a[132:135], a[236:239], v[180:183]
    v_perm_b32 v58, v112, v35, s38
    v_mfma_f32_16x16x32_bf16 v[184:187], a[68:71], a[240:243], v[184:187]
    ds_read_b32 a30, v58
    v_perm_b32 v59, v112, v35, s39
    v_mfma_f32_16x16x32_bf16 v[184:187], a[132:135], a[252:255], v[184:187]
    ds_read_b128 a[44:47], v41 offset:40960
    v_mfma_f32_16x16x32_bf16 v[188:191], a[68:71], a[24:27], v[188:191]
    ds_read_b32 a31, v59
    buffer_load_dwordx4 v[104:107], v32, s[12:15], s41 offen sc1
    v_mfma_f32_16x16x32_bf16 v[188:191], a[132:135], a[48:51], v[188:191]
    s_waitcnt lgkmcnt(7)
    ds_read_b128 a[52:55], v40 offset:43008
    v_perm_b32 v60, v84, v35, s36
    v_mfma_f32_16x16x32_bf16 v[192:195], a[76:79], a[244:247], v[192:195]
    ds_read_b32 a56, v60
    v_perm_b32 v61, v84, v35, s37
    v_mfma_f32_16x16x32_bf16 v[192:195], a[4:7], a[32:35], v[192:195]
    v_mfma_f32_16x16x32_bf16 v[196:199], a[76:79], a[92:95], v[196:199]
    ds_read_b32 a57, v61
    v_perm_b32 v62, v84, v35, s38
    v_mfma_f32_16x16x32_bf16 v[196:199], a[4:7], a[176:179], v[196:199]
    ds_read_b128 a[64:67], v41 offset:43008
    v_mfma_f32_16x16x32_bf16 v[200:203], a[76:79], a[180:183], v[200:203]
    ds_read_b32 a58, v62
    v_perm_b32 v63, v84, v35, s39
    v_mfma_f32_16x16x32_bf16 v[200:203], a[4:7], a[192:195], v[200:203]
    ds_read_b128 a[120:123], v40 offset:45056
    v_mfma_f32_16x16x32_bf16 v[204:207], a[76:79], a[196:199], v[204:207]
    ds_read_b32 a59, v63
    v_perm_b32 v56, v113, v35, s36
    v_mfma_f32_16x16x32_bf16 v[204:207], a[4:7], a[204:207], v[204:207]
    v_mfma_f32_16x16x32_bf16 v[208:211], a[76:79], a[212:215], v[208:211]
    ds_read_b32 a84, v56
    v_perm_b32 v57, v113, v35, s37
    v_mfma_f32_16x16x32_bf16 v[208:211], a[4:7], a[220:223], v[208:211]
    ds_read_b128 a[72:75], v41 offset:45056
    v_mfma_f32_16x16x32_bf16 v[212:215], a[76:79], a[228:231], v[212:215]
    ds_read_b32 a85, v57
    v_perm_b32 v58, v113, v35, s38
    v_mfma_f32_16x16x32_bf16 v[212:215], a[4:7], a[236:239], v[212:215]
    ds_read_b128 a[100:103], v40 offset:47104
    v_mfma_f32_16x16x32_bf16 v[216:219], a[76:79], a[240:243], v[216:219]
    s_add_u32 s56, s55, 1280
    ds_read_b32 a86, v58
    v_perm_b32 v59, v113, v35, s39
    v_mfma_f32_16x16x32_bf16 v[216:219], a[4:7], a[252:255], v[216:219]
    v_mfma_f32_16x16x32_bf16 v[220:223], a[76:79], a[24:27], v[220:223]
    ds_read_b32 a87, v59
    v_perm_b32 v60, v85, v35, s36
    v_mfma_f32_16x16x32_bf16 v[220:223], a[4:7], a[48:51], v[220:223]
    s_waitcnt lgkmcnt(6)
    s_add_u32 m0, s57, 0
    ds_read_b128 a[124:127], v41 offset:47104
    v_mfma_f32_16x16x32_bf16 v[128:131], a[28:31], a[148:151], v[128:131]
    ds_read_b32 a144, v60
    v_perm_b32 v61, v85, v35, s37
    v_mfma_f32_16x16x32_bf16 v[128:131], a[56:59], a[164:167], v[128:131]
    ds_read_b128 a[188:191], v42 offset:34816
    v_mfma_f32_16x16x32_bf16 v[132:135], a[28:31], a[60:63], v[132:135]
    ds_read_b32 a145, v61
    buffer_load_dwordx4 v36, s[8:11], s56 offen offset:0 lds
    v_mfma_f32_16x16x32_bf16 v[132:135], a[56:59], a[104:107], v[132:135]
    v_perm_b32 v62, v85, v35, s38
    v_mfma_f32_16x16x32_bf16 v[136:139], a[28:31], a[0:3], v[136:139]
    s_waitcnt vmcnt(7)
    v_perm_b32 v63, v85, v35, s39
    v_bitop3_b32 v121, v121, v123, s76 bitop3:0x7e
    v_mfma_f32_16x16x32_bf16 v[136:139], a[56:59], a[12:15], v[136:139]
    ds_read_b32 a146, v62
    v_cmp_ne_u32 vcc, 0, v121
    v_mfma_f32_16x16x32_bf16 v[140:143], a[28:31], a[16:19], v[140:143]
    ds_read_b32 a147, v63
    v_perm_b32 v56, v114, v35, s36
    v_mfma_f32_16x16x32_bf16 v[140:143], a[56:59], a[20:23], v[140:143]
    ds_read_b128 a[232:235], v43 offset:34816
    s_cbranch_vccnz L_slow6_2
L_back6_2:
    v_mfma_f32_16x16x32_bf16 v[144:147], a[28:31], a[36:39], v[144:147]
    ds_read_b32 a8, v56
    buffer_load_dwordx4 v37, s[8:11], s56 offen offset:1024 lds
    v_mfma_f32_16x16x32_bf16 v[144:147], a[56:59], a[44:47], v[144:147]
    ds_read_b128 a[184:187], v42 offset:32768
    v_perm_b32 v57, v114, v35, s37
    v_mfma_f32_16x16x32_bf16 v[148:151], a[28:31], a[52:55], v[148:151]
    ds_read_b32 a9, v57
    v_perm_b32 v58, v114, v35, s38
    v_mfma_f32_16x16x32_bf16 v[148:151], a[56:59], a[64:67], v[148:151]
    ds_read_b128 a[168:171], v43 offset:32768
    v_bitop3_b32 v89, v89, v91, s76 bitop3:0x7e
    v_mfma_f32_16x16x32_bf16 v[152:155], a[28:31], a[120:123], v[152:155]
    s_waitcnt lgkmcnt(7)
    ds_read_b32 a10, v58
    v_cmp_ne_u32 vcc, 0, v89
    v_mfma_f32_16x16x32_bf16 v[152:155], a[56:59], a[72:75], v[152:155]
    ds_read_b128 a[172:175], v42 offset:38912
    v_perm_b32 v59, v114, v35, s39
L_pad2:
    s_cbranch_execz L_warmed
    v_mfma_f32_16x16x32_bf16 v[156:159], a[28:31], a[100:103], v[156:159]
    ds_read_b32 a11, v59
    buffer_load_dwordx4 v38, s[8:11], s56 offen offset:2048 lds
    v_mfma_f32_16x16x32_bf16 v[156:159], a[56:59], a[124:127], v[156:159]
    v_perm_b32 v60, v86, v35, s36
    s_cbranch_vccnz L_slow3_2
L_back3_2:
    v_mfma_f32_16x16x32_bf16 v[160:163], a[84:87], a[148:151], v[160:163]
    s_waitcnt lgkmcnt(7)
    ds_read_b32 a80, v60
    v_perm_b32 v61, v86, v35, s37
    v_mfma_f32_16x16x32_bf16 v[160:163], a[144:147], a[164:167], v[160:163]
    ds_read_b128 a[88:91], v43 offset:38912
    v_perm_b32 v62, v120, v35, s36
    v_mfma_f32_16x16x32_bf16 v[164:167], a[84:87], a[60:63], v[164:167]
    ds_read_b32 a96, v62
    ds_read_b32 a81, v61
    v_mfma_f32_16x16x32_bf16 v[164:167], a[144:147], a[104:107], v[164:167]
    ds_read_b128 a[108:111], v42 offset:36864
    v_perm_b32 v63, v86, v35, s38
    v_mfma_f32_16x16x32_bf16 v[168:171], a[84:87], a[0:3], v[168:171]
    ds_read_b32 a82, v63
    buffer_load_dwordx4 v39, s[8:11], s56 offen offset:3072 lds
    v_mfma_f32_16x16x32_bf16 v[168:171], a[144:147], a[12:15], v[168:171]
    s_add_u32 s3, s55, 1408
    v_perm_b32 v56, v86, v35, s39
    v_perm_b32 v57, v120, v35, s37
    v_mfma_f32_16x16x32_bf16 v[172:175], a[84:87], a[16:19], v[172:175]
    s_mov_b32 s42, 81920
    ds_read_b32 a83, v56
    ds_read_b32 a97, v57
    v_mfma_f32_16x16x32_bf16 v[172:175], a[144:147], a[20:23], v[172:175]
    s_add_u32 m0, s57, 18432
    ds_read_b128 a[112:115], v43 offset:36864
    v_perm_b32 v58, v88, v35, s36
    v_mfma_f32_16x16x32_bf16 v[176:179], a[84:87], a[36:39], v[176:179]
    ds_read_b32 a116, v58
    v_perm_b32 v59, v88, v35, s37
    v_mfma_f32_16x16x32_bf16 v[176:179], a[144:147], a[44:47], v[176:179]
    s_mov_b32 s43, 87040
    ds_read_b128 a[128:131], v42 offset:43008
    v_perm_b32 v60, v120, v35, s38
    v_mfma_f32_16x16x32_bf16 v[180:183], a[84:87], a[52:55], v[180:183]
    ds_read_b32 a98, v60
    buffer_load_dwordx2 v[108:109], v34, s[12:15], s42 offen sc1
    v_mfma_f32_16x16x32_bf16 v[180:183], a[144:147], a[64:67], v[180:183]
    ds_read_b32 a117, v59
    v_perm_b32 v61, v88, v35, s38
    v_mfma_f32_16x16x32_bf16 v[184:187], a[84:87], a[120:123], v[184:187]
    ds_read_b32 a118, v61
    v_bitop3_b32 v119, v119, v99, s76 bitop3:0x7e
    v_mfma_f32_16x16x32_bf16 v[184:187], a[144:147], a[72:75], v[184:187]
    v_cmp_ne_u32 vcc, 0, v119
    v_perm_b32 v62, v88, v35, s39
    v_mfma_f32_16x16x32_bf16 v[188:191], a[84:87], a[100:103], v[188:191]
    ds_read_b32 a119, v62
    buffer_load_dwordx2 v[110:111], v34, s[12:15], s43 offen sc1
    v_mfma_f32_16x16x32_bf16 v[188:191], a[144:147], a[124:127], v[188:191]
    v_perm_b32 v63, v90, v35, s36
    s_cbranch_vccnz L_slow3_1
L_back3_1:
    s_waitcnt lgkmcnt(7)
    v_mfma_f32_16x16x32_bf16 v[192:195], a[8:11], a[148:151], v[192:195]
    ds_read_b128 a[136:139], v43 offset:43008
    ds_read_b32 a140, v63
    v_mfma_f32_16x16x32_bf16 v[192:195], a[80:83], a[164:167], v[192:195]
    ds_read_b128 a[152:155], v42 offset:40960
    v_perm_b32 v56, v90, v35, s37
    v_mfma_f32_16x16x32_bf16 v[196:199], a[8:11], a[60:63], v[196:199]
    ds_read_b32 a141, v56
    buffer_load_dwordx4 v36, s[8:11], s3 offen offset:0 lds
    v_mfma_f32_16x16x32_bf16 v[196:199], a[80:83], a[104:107], v[196:199]
    s_waitcnt vmcnt(11)
    v_bitop3_b32 v51, v51, v67, s76 bitop3:0x7e
    v_perm_b32 v57, v90, v35, s38
    v_mfma_f32_16x16x32_bf16 v[200:203], a[8:11], a[0:3], v[200:203]
    v_perm_b32 v58, v90, v35, s39
    v_cmp_ne_u32 vcc, 0, v51
    v_mfma_f32_16x16x32_bf16 v[200:203], a[80:83], a[12:15], v[200:203]
    ds_read_b32 a142, v57
    ds_read_b128 a[156:159], v43 offset:40960
    v_mfma_f32_16x16x32_bf16 v[204:207], a[8:11], a[16:19], v[204:207]
    ds_read_b32 a143, v58
    buffer_load_dwordx4 v37, s[8:11], s3 offen offset:1024 lds
    v_mfma_f32_16x16x32_bf16 v[204:207], a[80:83], a[20:23], v[204:207]
    s_add_u32 m0, s57, 14336
    ds_read_b128 a[160:163], v42 offset:47104
    v_perm_b32 v60, v116, v35, s36
    v_mfma_f32_16x16x32_bf16 v[208:211], a[8:11], a[36:39], v[208:211]
    ds_read_b32 a200, v60
    s_cbranch_vccnz L_slow6_0
L_back6_0:
    v_mfma_f32_16x16x32_bf16 v[208:211], a[80:83], a[44:47], v[208:211]
    s_mov_b32 s44, 81920
    ds_read_b128 a[208:211], v43 offset:47104
    v_perm_b32 v59, v116, v35, s37
    v_mfma_f32_16x16x32_bf16 v[212:215], a[8:11], a[52:55], v[212:215]
    ds_read_b32 a201, v59
    buffer_load_dwordx4 v[124:127], v33, s[12:15], s44 offen sc1
    v_mfma_f32_16x16x32_bf16 v[212:215], a[80:83], a[64:67], v[212:215]
    s_mov_b32 s45, 87040
    ds_read_b128 a[216:219], v42 offset:45056
    v_perm_b32 v61, v116, v35, s38
    v_mfma_f32_16x16x32_bf16 v[216:219], a[8:11], a[120:123], v[216:219]
    ds_read_b32 a202, v61
    v_perm_b32 v62, v116, v35, s39
    v_mfma_f32_16x16x32_bf16 v[216:219], a[80:83], a[72:75], v[216:219]
    v_perm_b32 v63, v120, v35, s39
    v_perm_b32 v56, v122, v35, s36
    v_mfma_f32_16x16x32_bf16 v[220:223], a[8:11], a[100:103], v[220:223]
    ds_read_b32 a99, v63
    buffer_load_dwordx4 v[52:55], v33, s[12:15], s45 offen sc1
    v_mfma_f32_16x16x32_bf16 v[220:223], a[80:83], a[124:127], v[220:223]
    s_waitcnt lgkmcnt(7)
    ds_read_b32 a224, v56
    ds_read_b32 a203, v62
    v_mfma_f32_16x16x32_bf16 v[224:227], a[116:119], a[148:151], v[224:227]
    v_perm_b32 v57, v96, v35, s36
    v_perm_b32 v58, v96, v35, s37
    v_mfma_f32_16x16x32_bf16 v[224:227], a[140:143], a[164:167], v[224:227]
    ds_read_b32 a40, v57
    ds_read_b128 a[248:251], v43 offset:45056
    v_mfma_f32_16x16x32_bf16 v[228:231], a[116:119], a[60:63], v[228:231]
    ds_read_b32 a41, v58
    buffer_load_dwordx4 v38, s[8:11], s3 offen offset:2048 lds
    v_mfma_f32_16x16x32_bf16 v[228:231], a[140:143], a[104:107], v[228:231]
    v_perm_b32 v60, v96, v35, s38
    v_perm_b32 v59, v122, v35, s37
    v_mfma_f32_16x16x32_bf16 v[232:235], a[116:119], a[0:3], v[232:235]
    ds_read_b32 a225, v59
    v_perm_b32 v61, v96, v35, s39
    v_mfma_f32_16x16x32_bf16 v[232:235], a[140:143], a[12:15], v[232:235]
    ds_read_b32 a42, v60
    v_perm_b32 v63, v122, v35, s38
    v_mfma_f32_16x16x32_bf16 v[236:239], a[116:119], a[16:19], v[236:239]
    ds_read_b32 a43, v61
    buffer_load_dwordx4 v39, s[8:11], s3 offen offset:3072 lds
    v_mfma_f32_16x16x32_bf16 v[236:239], a[140:143], a[20:23], v[236:239]
    ds_read_b32 a226, v63
    v_perm_b32 v62, v117, v35, s36
    v_mfma_f32_16x16x32_bf16 v[240:243], a[116:119], a[36:39], v[240:243]
    ds_read_b32 a68, v62
    v_perm_b32 v56, v117, v35, s37
    v_mfma_f32_16x16x32_bf16 v[240:243], a[140:143], a[44:47], v[240:243]
    v_perm_b32 v57, v122, v35, s39
    v_perm_b32 v58, v48, v35, s36
    v_mfma_f32_16x16x32_bf16 v[244:247], a[116:119], a[52:55], v[244:247]
    ds_read_b32 a227, v57
    ds_read_b32 a132, v58
    v_mfma_f32_16x16x32_bf16 v[244:247], a[140:143], a[64:67], v[244:247]
    ds_read_b32 a69, v56
    v_perm_b32 v59, v117, v35, s38
    v_mfma_f32_16x16x32_bf16 v[248:251], a[116:119], a[120:123], v[248:251]
    s_waitcnt lgkmcnt(8)
    s_barrier
    ds_read_b32 a70, v59
    v_mfma_f32_16x16x32_bf16 v[248:251], a[140:143], a[72:75], v[248:251]
    v_perm_b32 v60, v117, v35, s39
    v_perm_b32 v61, v48, v35, s37
    v_mfma_f32_16x16x32_bf16 v[252:255], a[116:119], a[100:103], v[252:255]
    ds_read_b32 a133, v61
    ds_read_b32 a71, v60
    v_mfma_f32_16x16x32_bf16 v[252:255], a[140:143], a[124:127], v[252:255]
    v_perm_b32 v63, v97, v35, s36
    v_perm_b32 v62, v48, v35, s38
    v_mfma_f32_16x16x32_bf16 v[128:131], a[200:203], a[188:191], v[128:131]
    s_waitcnt lgkmcnt(7)
    ds_read_b32 a134, v62
    ds_read_b32 a244, v63
    v_mfma_f32_16x16x32_bf16 v[128:131], a[40:43], a[232:235], v[128:131]
    s_waitcnt vmcnt(14)
    v_perm_b32 v57, v97, v35, s37
    v_bitop3_b32 v71, v71, v75, s76 bitop3:0x7e
    v_mfma_f32_16x16x32_bf16 v[132:135], a[200:203], a[184:187], v[132:135]
    ds_read_b32 a245, v57
    v_cmp_ne_u32 vcc, 0, v71
    v_mfma_f32_16x16x32_bf16 v[132:135], a[40:43], a[168:171], v[132:135]
    ds_read_b128 a[32:35], v44 offset:0
    v_perm_b32 v58, v97, v35, s38
    v_mfma_f32_16x16x32_bf16 v[136:139], a[200:203], a[172:175], v[136:139]
    v_perm_b32 v56, v97, v35, s39
    s_cbranch_vccnz L_slow6_1
L_back6_1:
    v_mfma_f32_16x16x32_bf16 v[136:139], a[40:43], a[88:91], v[136:139]
    ds_read_b32 a246, v58
    ds_read_b128 a[92:95], v45 offset:0
    v_mfma_f32_16x16x32_bf16 v[140:143], a[200:203], a[108:111], v[140:143]
    ds_read_b32 a247, v56
    v_perm_b32 v59, v118, v35, s36
    v_mfma_f32_16x16x32_bf16 v[140:143], a[40:43], a[112:115], v[140:143]
    ds_read_b128 a[176:179], v44 offset:2048
    v_perm_b32 v60, v48, v35, s39
    v_mfma_f32_16x16x32_bf16 v[144:147], a[200:203], a[128:131], v[144:147]
    ds_read_b32 a135, v60
    ds_read_b32 a180, v59
    v_mfma_f32_16x16x32_bf16 v[144:147], a[40:43], a[136:139], v[144:147]
    v_perm_b32 v61, v118, v35, s37
    v_perm_b32 v63, v64, v35, s36
    v_mfma_f32_16x16x32_bf16 v[148:151], a[200:203], a[152:155], v[148:151]
    ds_read_b32 a192, v63
    ds_read_b32 a181, v61
    v_mfma_f32_16x16x32_bf16 v[148:151], a[40:43], a[156:159], v[148:151]
    s_waitcnt vmcnt(12)
    v_perm_b32 v62, v118, v35, s38
    v_bitop3_b32 v103, v103, v107, s76 bitop3:0x7e
    v_mfma_f32_16x16x32_bf16 v[152:155], a[200:203], a[160:163], v[152:155]
    ds_read_b32 a182, v62
    v_cmp_ne_u32 vcc, 0, v103
    v_mfma_f32_16x16x32_bf16 v[152:155], a[40:43], a[208:211], v[152:155]
    ds_read_b128 a[196:199], v45 offset:2048
    v_perm_b32 v57, v118, v35, s39
    v_mfma_f32_16x16x32_bf16 v[156:159], a[200:203], a[216:219], v[156:159]
    ds_read_b32 a183, v57
    s_cbranch_vccnz L_slow4_0
L_back4_0:
    v_mfma_f32_16x16x32_bf16 v[156:159], a[40:43], a[248:251], v[156:159]
    s_waitcnt lgkmcnt(8)
    ds_read_b128 a[204:207], v44 offset:4096
    v_perm_b32 v58, v98, v35, s36
    v_mfma_f32_16x16x32_bf16 v[160:163], a[68:71], a[188:191], v[160:163]
    ds_read_b32 a212, v58
    v_perm_b32 v56, v98, v35, s37
    v_mfma_f32_16x16x32_bf16 v[160:163], a[244:247], a[232:235], v[160:163]
    ds_read_b128 a[220:223], v45 offset:4096
    v_perm_b32 v59, v64, v35, s37
    v_mfma_f32_16x16x32_bf16 v[164:167], a[68:71], a[184:187], v[164:167]
    ds_read_b32 a193, v59
    ds_read_b32 a213, v56
    v_mfma_f32_16x16x32_bf16 v[164:167], a[244:247], a[168:171], v[164:167]
    ds_read_b128 a[228:231], v44 offset:6144
    v_perm_b32 v60, v98, v35, s38
    v_mfma_f32_16x16x32_bf16 v[168:171], a[68:71], a[172:175], v[168:171]
    ds_read_b32 a214, v60
    v_perm_b32 v61, v98, v35, s39
    v_mfma_f32_16x16x32_bf16 v[168:171], a[244:247], a[88:91], v[168:171]
    v_perm_b32 v63, v64, v35, s38
    v_perm_b32 v62, v64, v35, s39
    v_mfma_f32_16x16x32_bf16 v[172:175], a[68:71], a[108:111], v[172:175]
    s_mov_b32 s40, 102400
    ds_read_b32 a215, v61
    ds_read_b32 a194, v63
    v_mfma_f32_16x16x32_bf16 v[172:175], a[244:247], a[112:115], v[172:175]
    ds_read_b32 a195, v62
    v_perm_b32 v57, v100, v35, s36
    v_mfma_f32_16x16x32_bf16 v[176:179], a[68:71], a[128:131], v[176:179]
    ds_read_b32 a236, v57
    v_perm_b32 v58, v100, v35, s37
    v_mfma_f32_16x16x32_bf16 v[176:179], a[244:247], a[136:139], v[176:179]
    s_mov_b32 s41, 107520
    ds_read_b128 a[240:243], v45 offset:6144
    v_perm_b32 v56, v68, v35, s36
    v_mfma_f32_16x16x32_bf16 v[180:183], a[68:71], a[152:155], v[180:183]
    ds_read_b32 a252, v56
    buffer_load_dwordx4 v[76:79], v32, s[12:15], s40 offen sc1
    v_mfma_f32_16x16x32_bf16 v[180:183], a[244:247], a[156:159], v[180:183]
    ds_read_b32 a237, v58
    v_perm_b32 v59, v100, v35, s38
    v_mfma_f32_16x16x32_bf16 v[184:187], a[68:71], a[160:163], v[184:187]
    ds_read_b128 a[24:27], v44 offset:8192
    ds_read_b32 a238, v59
    v_mfma_f32_16x16x32_bf16 v[184:187], a[244:247], a[208:211], v[184:187]
    ds_read_b128 a[76:79], v45 offset:8192
    v_perm_b32 v60, v100, v35, s39
    v_mfma_f32_16x16x32_bf16 v[188:191], a[68:71], a[216:219], v[188:191]
    ds_read_b32 a239, v60
    buffer_load_dwordx4 v[80:83], v32, s[12:15], s41 offen sc1
    v_mfma_f32_16x16x32_bf16 v[188:191], a[244:247], a[248:251], v[188:191]
    s_waitcnt lgkmcnt(9)
    ds_read_b128 a[48:51], v44 offset:10240
    v_perm_b32 v61, v104, v35, s36
    v_mfma_f32_16x16x32_bf16 v[192:195], a[180:183], a[188:191], v[192:195]
    ds_read_b32 a4, v61
    v_perm_b32 v63, v104, v35, s37
    v_mfma_f32_16x16x32_bf16 v[192:195], a[212:215], a[232:235], v[192:195]
    v_perm_b32 v62, v68, v35, s37
    v_perm_b32 v57, v68, v35, s38
    v_mfma_f32_16x16x32_bf16 v[196:199], a[180:183], a[184:187], v[196:199]
    ds_read_b32 a253, v62
    ds_read_b32 a254, v57
    v_mfma_f32_16x16x32_bf16 v[196:199], a[212:215], a[168:171], v[196:199]
    ds_read_b32 a5, v63
    v_perm_b32 v56, v104, v35, s38
    v_mfma_f32_16x16x32_bf16 v[200:203], a[180:183], a[172:175], v[200:203]
    ds_read_b32 a6, v56
    v_perm_b32 v58, v104, v35, s39
    v_mfma_f32_16x16x32_bf16 v[200:203], a[212:215], a[88:91], v[200:203]
    ds_read_b128 a[28:31], v45 offset:10240
    v_perm_b32 v59, v68, v35, s39
    v_mfma_f32_16x16x32_bf16 v[204:207], a[180:183], a[108:111], v[204:207]
    ds_read_b32 a7, v58
    ds_read_b32 a255, v59
    v_mfma_f32_16x16x32_bf16 v[204:207], a[212:215], a[112:115], v[204:207]
    ds_read_b128 a[56:59], v44 offset:12288
    v_perm_b32 v60, v101, v35, s36
    v_mfma_f32_16x16x32_bf16 v[208:211], a[180:183], a[128:131], v[208:211]
    ds_read_b32 a84, v60
    v_perm_b32 v61, v101, v35, s37
    v_mfma_f32_16x16x32_bf16 v[208:211], a[212:215], a[136:139], v[208:211]
    ds_read_b128 a[144:147], v45 offset:12288
    v_perm_b32 v62, v72, v35, s36
    v_mfma_f32_16x16x32_bf16 v[212:215], a[180:183], a[152:155], v[212:215]
    ds_read_b32 a8, v62
    ds_read_b32 a85, v61
    v_mfma_f32_16x16x32_bf16 v[212:215], a[212:215], a[156:159], v[212:215]
    ds_read_b128 a[80:83], v44 offset:14336
    v_perm_b32 v57, v101, v35, s38
    v_mfma_f32_16x16x32_bf16 v[216:219], a[180:183], a[160:163], v[216:219]
    s_add_u32 s56, s55, 1536
    ds_read_b32 a86, v57
    v_perm_b32 v63, v101, v35, s39
    v_mfma_f32_16x16x32_bf16 v[216:219], a[212:215], a[208:211], v[216:219]
    v_perm_b32 v56, v72, v35, s37
    v_perm_b32 v58, v72, v35, s38
    v_mfma_f32_16x16x32_bf16 v[220:223], a[180:183], a[216:219], v[220:223]
    s_waitcnt lgkmcnt(9)
    ds_read_b32 a9, v56
    ds_read_b32 a10, v58
    v_mfma_f32_16x16x32_bf16 v[220:223], a[212:215], a[248:251], v[220:223]
    s_add_u32 m0, s57, 32768
    ds_read_b32 a87, v63
    v_perm_b32 v59, v105, v35, s36
    v_mfma_f32_16x16x32_bf16 v[128:131], a[236:239], a[32:35], v[128:131]
    s_waitcnt lgkmcnt(9)
    ds_read_b32 a148, v59
    v_perm_b32 v60, v105, v35, s37
    v_mfma_f32_16x16x32_bf16 v[128:131], a[4:7], a[92:95], v[128:131]
    ds_read_b128 a[164:167], v45 offset:14336
    v_perm_b32 v61, v72, v35, s39
    v_mfma_f32_16x16x32_bf16 v[132:135], a[236:239], a[176:179], v[132:135]
    ds_read_b32 a11, v61
    buffer_load_dwordx4 v36, s[8:11], s56 offen offset:0 lds
    v_mfma_f32_16x16x32_bf16 v[132:135], a[4:7], a[196:199], v[132:135]
    ds_read_b32 a149, v60
    v_perm_b32 v62, v105, v35, s38
    v_mfma_f32_16x16x32_bf16 v[136:139], a[236:239], a[204:207], v[136:139]
    ds_read_b128 a[60:63], v46 offset:2048
    v_perm_b32 v57, v105, v35, s39
    v_mfma_f32_16x16x32_bf16 v[136:139], a[4:7], a[220:223], v[136:139]
    ds_read_b32 a150, v62
    ds_read_b128 a[104:107], v47 offset:2048
    v_mfma_f32_16x16x32_bf16 v[140:143], a[236:239], a[228:231], v[140:143]
    ds_read_b32 a151, v57
    v_perm_b32 v56, v102, v35, s36
    v_mfma_f32_16x16x32_bf16 v[140:143], a[4:7], a[240:243], v[140:143]
    ds_read_b128 a[0:3], v46 offset:0
    v_perm_b32 v58, v49, v35, s36
    v_mfma_f32_16x16x32_bf16 v[144:147], a[236:239], a[24:27], v[144:147]
    ds_read_b32 a12, v58
    buffer_load_dwordx4 v37, s[8:11], s56 offen offset:1024 lds
    v_mfma_f32_16x16x32_bf16 v[144:147], a[4:7], a[76:79], v[144:147]
    ds_read_b32 a16, v56
    v_perm_b32 v63, v102, v35, s37
    v_mfma_f32_16x16x32_bf16 v[148:151], a[236:239], a[48:51], v[148:151]
    ds_read_b32 a17, v63
    v_perm_b32 v59, v102, v35, s38
    v_mfma_f32_16x16x32_bf16 v[148:151], a[4:7], a[28:31], v[148:151]
    s_waitcnt vmcnt(10)
    ds_read_b128 a[20:23], v47 offset:0
    v_bitop3_b32 v109, v109, v111, s76 bitop3:0x7e
    v_mfma_f32_16x16x32_bf16 v[152:155], a[236:239], a[56:59], v[152:155]
    s_waitcnt lgkmcnt(9)
    ds_read_b32 a18, v59
    v_cmp_ne_u32 vcc, 0, v109
    v_mfma_f32_16x16x32_bf16 v[152:155], a[4:7], a[144:147], v[152:155]
    s_mov_b32 s42, 143360
    ds_read_b128 a[36:39], v46 offset:6144
    v_perm_b32 v61, v102, v35, s39
    v_mfma_f32_16x16x32_bf16 v[156:159], a[236:239], a[80:83], v[156:159]
    ds_read_b32 a19, v61
    buffer_load_dwordx4 v38, s[8:11], s56 offen offset:2048 lds
    v_mfma_f32_16x16x32_bf16 v[156:159], a[4:7], a[164:167], v[156:159]
    v_perm_b32 v60, v106, v35, s36
    s_cbranch_vccnz L_slow4_2
L_back4_2:
    v_mfma_f32_16x16x32_bf16 v[160:163], a[84:87], a[32:35], v[160:163]
    s_waitcnt lgkmcnt(7)
    s_mov_b32 s43, 148480
    ds_read_b32 a44, v60
    v_perm_b32 v62, v106, v35, s37
    v_mfma_f32_16x16x32_bf16 v[160:163], a[148:151], a[92:95], v[160:163]
    ds_read_b128 a[52:55], v47 offset:6144
    v_perm_b32 v57, v49, v35, s37
    v_mfma_f32_16x16x32_bf16 v[164:167], a[84:87], a[176:179], v[164:167]
    ds_read_b32 a13, v57
    buffer_load_dwordx2 v[92:93], v34, s[12:15], s42 offen sc1
    v_mfma_f32_16x16x32_bf16 v[164:167], a[148:151], a[196:199], v[164:167]
    ds_read_b32 a45, v62
    v_perm_b32 v58, v106, v35, s38
    v_mfma_f32_16x16x32_bf16 v[168:171], a[84:87], a[204:207], v[168:171]
    s_add_u32 s3, s55, 1664
    ds_read_b32 a46, v58
    v_perm_b32 v56, v106, v35, s39
    v_mfma_f32_16x16x32_bf16 v[168:171], a[148:151], a[220:223], v[168:171]
    ds_read_b128 a[64:67], v46 offset:4096
    v_perm_b32 v63, v49, v35, s38
    v_mfma_f32_16x16x32_bf16 v[172:175], a[84:87], a[228:231], v[172:175]
    ds_read_b32 a47, v56
    buffer_load_dwordx2 v[94:95], v34, s[12:15], s43 offen sc1
    v_mfma_f32_16x16x32_bf16 v[172:175], a[148:151], a[240:243], v[172:175]
    s_mov_b32 s44, 102400
    ds_read_b32 a14, v63
    v_perm_b32 v59, v108, v35, s36
    v_mfma_f32_16x16x32_bf16 v[176:179], a[84:87], a[24:27], v[176:179]
    ds_read_b32 a120, v59
    v_perm_b32 v61, v108, v35, s37
    v_mfma_f32_16x16x32_bf16 v[176:179], a[148:151], a[76:79], v[176:179]
    s_mov_b32 s45, 107520
    ds_read_b128 a[72:75], v47 offset:4096
    v_perm_b32 v60, v49, v35, s39
    v_mfma_f32_16x16x32_bf16 v[180:183], a[84:87], a[48:51], v[180:183]
    ds_read_b32 a15, v60
    buffer_load_dwordx2 v[112:113], v34, s[12:15], s44 offen sc1
    v_mfma_f32_16x16x32_bf16 v[180:183], a[148:151], a[28:31], v[180:183]
    ds_read_b32 a121, v61
    v_perm_b32 v57, v108, v35, s38
    v_mfma_f32_16x16x32_bf16 v[184:187], a[84:87], a[56:59], v[184:187]
    s_waitcnt vmcnt(10)
    ds_read_b128 a[100:103], v46 offset:10240
    v_bitop3_b32 v127, v127, v55, s76 bitop3:0x7e
    v_mfma_f32_16x16x32_bf16 v[184:187], a[148:151], a[144:147], v[184:187]
    ds_read_b32 a122, v57
    v_cmp_ne_u32 vcc, 0, v127
    v_mfma_f32_16x16x32_bf16 v[188:191], a[84:87], a[80:83], v[188:191]
    ds_read_b128 a[116:119], v47 offset:10240
    buffer_load_dwordx2 v[114:115], v34, s[12:15], s45 offen sc1
    v_mfma_f32_16x16x32_bf16 v[188:191], a[148:151], a[164:167], v[188:191]
    v_perm_b32 v62, v108, v35, s39
    s_cbranch_vccnz L_slow4_1
L_back4_1:
    s_waitcnt lgkmcnt(8)
    v_mfma_f32_16x16x32_bf16 v[192:195], a[16:19], a[32:35], v[192:195]
    ds_read_b32 a123, v62
    v_perm_b32 v58, v110, v35, s36
    v_mfma_f32_16x16x32_bf16 v[192:195], a[44:47], a[92:95], v[192:195]
    ds_read_b32 a124, v58
    v_perm_b32 v56, v110, v35, s37
    v_mfma_f32_16x16x32_bf16 v[196:199], a[16:19], a[176:179], v[196:199]
    ds_read_b128 a[140:143], v46 offset:8192
    buffer_load_dwordx4 v39, s[8:11], s56 offen offset:3072 lds
    v_mfma_f32_16x16x32_bf16 v[196:199], a[44:47], a[196:199], v[196:199]
    s_add_u32 m0, s57, 51200
    ds_read_b32 a125, v56
    v_perm_b32 v63, v110, v35, s38
    v_mfma_f32_16x16x32_bf16 v[200:203], a[16:19], a[204:207], v[200:203]
    ds_read_b32 a126, v63
    v_perm_b32 v59, v110, v35, s39
    v_mfma_f32_16x16x32_bf16 v[200:203], a[44:47], a[220:223], v[200:203]
    ds_read_b128 a[200:203], v47 offset:8192
    v_perm_b32 v60, v65, v35, s36
    v_mfma_f32_16x16x32_bf16 v[204:207], a[16:19], a[228:231], v[204:207]
    ds_read_b32 a127, v59
    buffer_load_dwordx4 v36, s[8:11], s3 offen offset:0 lds
    v_mfma_f32_16x16x32_bf16 v[204:207], a[44:47], a[240:243], v[204:207]
    s_mov_b32 s40, 102400
    ds_read_b32 a40, v60
    v_perm_b32 v61, v124, v35, s36
    v_mfma_f32_16x16x32_bf16 v[208:211], a[16:19], a[24:27], v[208:211]
    ds_read_b128 a[68:71], v46 offset:14336
    ds_read_b32 a244, v61
    v_mfma_f32_16x16x32_bf16 v[208:211], a[44:47], a[76:79], v[208:211]
    s_mov_b32 s41, 107520
    ds_read_b128 a[188:191], v47 offset:14336
    v_perm_b32 v57, v124, v35, s37
    v_mfma_f32_16x16x32_bf16 v[212:215], a[16:19], a[48:51], v[212:215]
    ds_read_b32 a245, v57
    buffer_load_dwordx4 v[84:87], v33, s[12:15], s40 offen sc1
    v_mfma_f32_16x16x32_bf16 v[212:215], a[44:47], a[28:31], v[212:215]
    s_add_u32 s56, s55, 1792
    ds_read_b128 a[232:235], v46 offset:12288
    v_perm_b32 v62, v124, v35, s38
    v_mfma_f32_16x16x32_bf16 v[216:219], a[16:19], a[56:59], v[216:219]
    ds_read_b32 a246, v62
    v_perm_b32 v58, v124, v35, s39
    v_mfma_f32_16x16x32_bf16 v[216:219], a[44:47], a[144:147], v[216:219]
    s_mov_b32 s42, 143360
    v_perm_b32 v56, v65, v35, s37
    v_perm_b32 v63, v65, v35, s38
    v_mfma_f32_16x16x32_bf16 v[220:223], a[16:19], a[80:83], v[220:223]
    ds_read_b32 a41, v56
    buffer_load_dwordx4 v[88:91], v33, s[12:15], s41 offen sc1
    v_mfma_f32_16x16x32_bf16 v[220:223], a[44:47], a[164:167], v[220:223]
    s_waitcnt lgkmcnt(8)
    ds_read_b32 a42, v63
    ds_read_b32 a247, v58
    v_mfma_f32_16x16x32_bf16 v[224:227], a[120:123], a[32:35], v[224:227]
    s_mov_b32 s43, 148480
    v_perm_b32 v59, v52, v35, s36
    v_perm_b32 v60, v52, v35, s37
    v_mfma_f32_16x16x32_bf16 v[224:227], a[124:127], a[92:95], v[224:227]
    ds_read_b32 a168, v59
    ds_read_b128 a[184:187], v47 offset:12288
    v_mfma_f32_16x16x32_bf16 v[228:231], a[120:123], a[176:179], v[228:231]
    ds_read_b32 a169, v60
    buffer_load_dwordx4 v[120:123], v32, s[12:15], s42 offen sc1
    v_mfma_f32_16x16x32_bf16 v[228:231], a[124:127], a[196:199], v[228:231]
    v_perm_b32 v61, v52, v35, s38
    v_perm_b32 v57, v65, v35, s39
    v_mfma_f32_16x16x32_bf16 v[232:235], a[120:123], a[204:207], v[232:235]
    ds_read_b32 a43, v57
    v_perm_b32 v62, v52, v35, s39
    v_mfma_f32_16x16x32_bf16 v[232:235], a[124:127], a[220:223], v[232:235]
    ds_read_b32 a170, v61
    v_perm_b32 v56, v69, v35, s36
    v_mfma_f32_16x16x32_bf16 v[236:239], a[120:123], a[228:231], v[236:239]
    ds_read_b32 a171, v62
    buffer_load_dwordx4 v[116:119], v32, s[12:15], s43 offen sc1
    v_mfma_f32_16x16x32_bf16 v[236:239], a[124:127], a[240:243], v[236:239]
    ds_read_b32 a172, v56
    v_perm_b32 v58, v125, v35, s36
    v_mfma_f32_16x16x32_bf16 v[240:243], a[120:123], a[24:27], v[240:243]
    ds_read_b32 a88, v58
    v_perm_b32 v63, v125, v35, s37
    v_mfma_f32_16x16x32_bf16 v[240:243], a[124:127], a[76:79], v[240:243]
    v_perm_b32 v59, v69, v35, s37
    v_perm_b32 v60, v69, v35, s38
    v_mfma_f32_16x16x32_bf16 v[244:247], a[120:123], a[48:51], v[244:247]
    ds_read_b32 a173, v59
    buffer_load_dwordx4 v37, s[8:11], s3 offen offset:1024 lds
    v_mfma_f32_16x16x32_bf16 v[244:247], a[124:127], a[28:31], v[244:247]
    s_add_u32 m0, s57, 47104
    ds_read_b32 a174, v60
    ds_read_b32 a89, v63
    v_mfma_f32_16x16x32_bf16 v[248:251], a[120:123], a[56:59], v[248:251]
    s_waitcnt vmcnt(16) lgkmcnt(8)
    s_barrier
    v_perm_b32 v57, v125, v35, s38
    v_mfma_f32_16x16x32_bf16 v[248:251], a[124:127], a[144:147], v[248:251]
    ds_read_b32 a90, v57
    v_perm_b32 v61, v125, v35, s39
    v_mfma_f32_16x16x32_bf16 v[252:255], a[120:123], a[80:83], v[252:255]
    ds_read_b32 a91, v61
    buffer_load_dwordx4 v38, s[8:11], s3 offen offset:2048 lds
L_pad3:
    s_cbranch_execz L_pad4
    v_mfma_f32_16x16x32_bf16 v[252:255], a[124:127], a[164:167], v[252:255]
    v_perm_b32 v62, v53, v35, s36
    v_perm_b32 v56, v69, v35, s39
    v_mfma_f32_16x16x32_bf16 v[128:131], a[244:247], a[60:63], v[128:131]
    s_waitcnt lgkmcnt(6)
    ds_read_b32 a175, v56
    ds_read_b32 a108, v62
    v_mfma_f32_16x16x32_bf16 v[128:131], a[168:171], a[104:107], v[128:131]
    ds_read_b128 a[112:115], v40 offset:0
    v_perm_b32 v58, v53, v35, s37
    v_mfma_f32_16x16x32_bf16 v[132:135], a[244:247], a[0:3], v[132:135]
    ds_read_b32 a109, v58
    buffer_load_dwordx4 v39, s[8:11], s3 offen offset:3072 lds
    v_mfma_f32_16x16x32_bf16 v[132:135], a[168:171], a[20:23], v[132:135]
    s_add_u32 m0, s57, 65536
    v_perm_b32 v59, v53, v35, s38
    v_perm_b32 v63, v73, v35, s36
    v_mfma_f32_16x16x32_bf16 v[136:139], a[244:247], a[36:39], v[136:139]
    s_add_u32 s3, s55, 1920
    ds_read_b32 a128, v63
    v_perm_b32 v60, v53, v35, s39
    v_mfma_f32_16x16x32_bf16 v[136:139], a[168:171], a[52:55], v[136:139]
    ds_read_b32 a110, v59
    ds_read_b128 a[136:139], v41 offset:0
    v_mfma_f32_16x16x32_bf16 v[140:143], a[244:247], a[64:67], v[140:143]
    ds_read_b32 a111, v60
    buffer_load_dwordx4 v36, s[8:11], s56 offen offset:0 lds
    v_mfma_f32_16x16x32_bf16 v[140:143], a[168:171], a[72:75], v[140:143]
    ds_read_b128 a[152:155], v40 offset:2048
    v_perm_b32 v57, v126, v35, s36
    v_mfma_f32_16x16x32_bf16 v[144:147], a[244:247], a[100:103], v[144:147]
    ds_read_b32 a156, v57
    v_perm_b32 v61, v126, v35, s37
    v_mfma_f32_16x16x32_bf16 v[144:147], a[168:171], a[116:119], v[144:147]
    v_perm_b32 v62, v73, v35, s37
    v_perm_b32 v56, v73, v35, s38
    v_mfma_f32_16x16x32_bf16 v[148:151], a[244:247], a[140:143], v[148:151]
    ds_read_b32 a129, v62
    buffer_load_dwordx4 v37, s[8:11], s56 offen offset:1024 lds
    v_mfma_f32_16x16x32_bf16 v[148:151], a[168:171], a[200:203], v[148:151]
    ds_read_b32 a130, v56
    ds_read_b32 a157, v61
    v_mfma_f32_16x16x32_bf16 v[152:155], a[244:247], a[68:71], v[152:155]
    s_waitcnt vmcnt(18)
    v_perm_b32 v58, v126, v35, s38
    v_bitop3_b32 v79, v79, v83, s76 bitop3:0x7e
    v_mfma_f32_16x16x32_bf16 v[152:155], a[168:171], a[188:191], v[152:155]
    s_mov_b32 s44, 143360
    ds_read_b32 a158, v58
    v_cmp_ne_u32 vcc, 0, v79
    v_mfma_f32_16x16x32_bf16 v[156:159], a[244:247], a[232:235], v[156:159]
    ds_read_b128 a[160:163], v41 offset:2048
    buffer_load_dwordx4 v38, s[8:11], s56 offen offset:2048 lds
    v_mfma_f32_16x16x32_bf16 v[156:159], a[168:171], a[184:187], v[156:159]
    v_perm_b32 v63, v126, v35, s39
    s_cbranch_vccnz L_slow5_0
L_back5_0:
    s_waitcnt lgkmcnt(7)
    v_mfma_f32_16x16x32_bf16 v[160:163], a[88:91], a[60:63], v[160:163]
    s_mov_b32 s45, 148480
    ds_read_b32 a159, v63
    v_perm_b32 v59, v54, v35, s36
    v_mfma_f32_16x16x32_bf16 v[160:163], a[108:111], a[104:107], v[160:163]
    ds_read_b128 a[208:211], v40 offset:4096
    ds_read_b32 a216, v59
    v_mfma_f32_16x16x32_bf16 v[164:167], a[88:91], a[0:3], v[164:167]
    ds_read_b128 a[180:183], v41 offset:4096
    buffer_load_dwordx4 v[96:99], v33, s[12:15], s44 offen sc1
    v_mfma_f32_16x16x32_bf16 v[164:167], a[108:111], a[20:23], v[164:167]
    v_perm_b32 v60, v54, v35, s37
    v_perm_b32 v57, v54, v35, s38
    v_mfma_f32_16x16x32_bf16 v[168:171], a[88:91], a[36:39], v[168:171]
    ds_read_b32 a217, v60
    v_perm_b32 v62, v54, v35, s39
    v_mfma_f32_16x16x32_bf16 v[168:171], a[108:111], a[52:55], v[168:171]
    ds_read_b32 a218, v57
    ds_read_b128 a[248:251], v40 offset:6144
    v_mfma_f32_16x16x32_bf16 v[172:175], a[88:91], a[64:67], v[172:175]
    ds_read_b32 a219, v62
    buffer_load_dwordx4 v[100:103], v33, s[12:15], s45 offen sc1
    v_mfma_f32_16x16x32_bf16 v[172:175], a[108:111], a[72:75], v[172:175]
    ds_read_b128 a[212:215], v41 offset:6144
    v_perm_b32 v61, v76, v35, s36
    v_mfma_f32_16x16x32_bf16 v[176:179], a[88:91], a[100:103], v[176:179]
    ds_read_b32 a236, v61
    v_perm_b32 v56, v76, v35, s37
    v_mfma_f32_16x16x32_bf16 v[176:179], a[108:111], a[116:119], v[176:179]
    ds_read_b128 a[4:7], v40 offset:8192
    v_perm_b32 v58, v73, v35, s39
    v_mfma_f32_16x16x32_bf16 v[180:183], a[88:91], a[140:143], v[180:183]
    ds_read_b32 a131, v58
    buffer_load_dwordx4 v39, s[8:11], s56 offen offset:3072 lds
    v_mfma_f32_16x16x32_bf16 v[180:183], a[108:111], a[200:203], v[180:183]
    s_add_u32 m0, s57, 83968
    ds_read_b32 a237, v56
    v_perm_b32 v63, v76, v35, s38
    v_mfma_f32_16x16x32_bf16 v[184:187], a[88:91], a[68:71], v[184:187]
    ds_read_b32 a238, v63
    v_perm_b32 v59, v76, v35, s39
    v_mfma_f32_16x16x32_bf16 v[184:187], a[108:111], a[188:191], v[184:187]
    ds_read_b128 a[84:87], v41 offset:8192
    v_perm_b32 v60, v50, v35, s36
    v_mfma_f32_16x16x32_bf16 v[188:191], a[88:91], a[232:235], v[188:191]
    ds_read_b32 a148, v60
    buffer_load_dwordx4 v36, s[8:11], s3 offen offset:0 lds
    v_mfma_f32_16x16x32_bf16 v[188:191], a[108:111], a[184:187], v[188:191]
    s_waitcnt lgkmcnt(8)
    ds_read_b32 a239, v59
    v_perm_b32 v57, v80, v35, s36
    v_mfma_f32_16x16x32_bf16 v[192:195], a[156:159], a[60:63], v[192:195]
    ds_read_b32 a16, v57
    v_perm_b32 v62, v80, v35, s37
    v_mfma_f32_16x16x32_bf16 v[192:195], a[216:219], a[104:107], v[192:195]
    ds_read_b128 a[44:47], v40 offset:10240
    v_perm_b32 v61, v50, v35, s37
    v_mfma_f32_16x16x32_bf16 v[196:199], a[156:159], a[0:3], v[196:199]
    ds_read_b32 a149, v61
    buffer_load_dwordx4 v37, s[8:11], s3 offen offset:1024 lds
    v_mfma_f32_16x16x32_bf16 v[196:199], a[216:219], a[20:23], v[196:199]
    s_add_u32 m0, s57, 79872
    ds_read_b32 a17, v62
    v_perm_b32 v58, v80, v35, s38
    v_mfma_f32_16x16x32_bf16 v[200:203], a[156:159], a[36:39], v[200:203]
    ds_read_b32 a18, v58
    v_perm_b32 v56, v80, v35, s39
    v_mfma_f32_16x16x32_bf16 v[200:203], a[216:219], a[52:55], v[200:203]
    ds_read_b128 a[32:35], v41 offset:10240
    v_perm_b32 v63, v50, v35, s38
    v_mfma_f32_16x16x32_bf16 v[204:207], a[156:159], a[64:67], v[204:207]
    ds_read_b32 a19, v56
    buffer_load_dwordx4 v38, s[8:11], s3 offen offset:2048 lds
    v_mfma_f32_16x16x32_bf16 v[204:207], a[216:219], a[72:75], v[204:207]
    ds_read_b32 a150, v63
    v_perm_b32 v60, v77, v35, s36
    v_mfma_f32_16x16x32_bf16 v[208:211], a[156:159], a[100:103], v[208:211]
    ds_read_b128 a[92:95], v40 offset:12288
    ds_read_b32 a176, v60
    v_mfma_f32_16x16x32_bf16 v[208:211], a[216:219], a[116:119], v[208:211]
    ds_read_b128 a[196:199], v41 offset:12288
    v_perm_b32 v59, v77, v35, s37
    v_mfma_f32_16x16x32_bf16 v[212:215], a[156:159], a[140:143], v[212:215]
    ds_read_b32 a177, v59
    buffer_load_dwordx4 v[104:107], v22, s[32:35], 0 offen
    v_mfma_f32_16x16x32_bf16 v[212:215], a[216:219], a[200:203], v[212:215]
    ds_read_b128 a[204:207], v40 offset:14336
    v_perm_b32 v57, v77, v35, s38
    v_mfma_f32_16x16x32_bf16 v[216:219], a[156:159], a[68:71], v[216:219]
    ds_read_b32 a178, v57
    v_perm_b32 v61, v77, v35, s39
    v_mfma_f32_16x16x32_bf16 v[216:219], a[216:219], a[188:191], v[216:219]
    v_perm_b32 v62, v50, v35, s39
    v_perm_b32 v58, v66, v35, s36
    v_mfma_f32_16x16x32_bf16 v[220:223], a[156:159], a[232:235], v[220:223]
    ds_read_b32 a151, v62
    buffer_load_dwordx2 v[108:109], v22, s[32:35], 0 offen offset:16
    v_mfma_f32_16x16x32_bf16 v[220:223], a[216:219], a[184:187], v[220:223]
    s_waitcnt lgkmcnt(8)
    ds_read_b32 a220, v58
    ds_read_b32 a179, v61
    v_mfma_f32_16x16x32_bf16 v[128:131], a[236:239], a[112:115], v[128:131]
    v_perm_b32 v56, v81, v35, s36
    v_perm_b32 v63, v81, v35, s37
    v_mfma_f32_16x16x32_bf16 v[128:131], a[16:19], a[136:139], v[128:131]
    ds_read_b32 a240, v56
    ds_read_b128 a[228:231], v41 offset:14336
    v_mfma_f32_16x16x32_bf16 v[132:135], a[236:239], a[152:155], v[132:135]
    ds_read_b32 a241, v63
    buffer_load_dwordx4 v39, s[8:11], s3 offen offset:3072 lds
    v_mfma_f32_16x16x32_bf16 v[132:135], a[16:19], a[160:163], v[132:135]
    s_waitcnt vmcnt(23)
    v_perm_b32 v60, v81, v35, s38
    v_bitop3_b32 v93, v93, v95, s76 bitop3:0x7e
    v_mfma_f32_16x16x32_bf16 v[136:139], a[236:239], a[208:211], v[136:139]
    v_perm_b32 v59, v81, v35, s39
    v_cmp_ne_u32 vcc, 0, v93
    v_mfma_f32_16x16x32_bf16 v[136:139], a[16:19], a[180:183], v[136:139]
    ds_read_b32 a242, v60
    ds_read_b128 a[24:27], v42 offset:2048
    v_mfma_f32_16x16x32_bf16 v[140:143], a[236:239], a[248:251], v[140:143]
    ds_read_b32 a243, v59
    buffer_load_dwordx2 v[110:111], v23, s[32:35], 0 offen
    v_mfma_f32_16x16x32_bf16 v[140:143], a[16:19], a[212:215], v[140:143]
    v_perm_b32 v57, v78, v35, s36
    s_cbranch_vccnz L_slow7_2
L_back7_2:
    v_mfma_f32_16x16x32_bf16 v[144:147], a[236:239], a[4:7], v[144:147]
    ds_read_b128 a[76:79], v43 offset:2048
    ds_read_b32 a48, v57
    v_mfma_f32_16x16x32_bf16 v[144:147], a[16:19], a[84:87], v[144:147]
    ds_read_b128 a[28:31], v42 offset:0
    v_perm_b32 v62, v78, v35, s37
    v_mfma_f32_16x16x32_bf16 v[148:151], a[236:239], a[44:47], v[148:151]
    ds_read_b32 a49, v62
    v_perm_b32 v61, v78, v35, s38
    v_mfma_f32_16x16x32_bf16 v[148:151], a[16:19], a[32:35], v[148:151]
    s_waitcnt vmcnt(22) lgkmcnt(7)
    ds_read_b128 a[56:59], v43 offset:0
    v_bitop3_b32 v113, v113, v115, s76 bitop3:0x7e
    v_mfma_f32_16x16x32_bf16 v[152:155], a[236:239], a[92:95], v[152:155]
    ds_read_b32 a50, v61
    v_cmp_ne_u32 vcc, 0, v113
    v_mfma_f32_16x16x32_bf16 v[152:155], a[16:19], a[196:199], v[152:155]
    ds_read_b128 a[144:147], v42 offset:6144
    v_perm_b32 v58, v78, v35, s39
    v_mfma_f32_16x16x32_bf16 v[156:159], a[236:239], a[204:207], v[156:159]
    ds_read_b32 a51, v58
    s_cbranch_vccnz L_slow5_2
L_back5_2:
    v_mfma_f32_16x16x32_bf16 v[156:159], a[16:19], a[228:231], v[156:159]
    v_perm_b32 v56, v82, v35, s36
    v_perm_b32 v63, v66, v35, s37
    v_mfma_f32_16x16x32_bf16 v[160:163], a[176:179], a[112:115], v[160:163]
    s_waitcnt lgkmcnt(8)
    ds_read_b32 a221, v63
    ds_read_b32 a80, v56
    v_mfma_f32_16x16x32_bf16 v[160:163], a[240:243], a[136:139], v[160:163]
    ds_read_b128 a[120:123], v43 offset:6144
    v_perm_b32 v60, v82, v35, s37
    v_mfma_f32_16x16x32_bf16 v[164:167], a[176:179], a[152:155], v[164:167]
    ds_read_b32 a81, v60
    v_perm_b32 v59, v82, v35, s38
    v_mfma_f32_16x16x32_bf16 v[164:167], a[240:243], a[160:163], v[164:167]
    ds_read_b128 a[164:167], v42 offset:4096
    v_perm_b32 v57, v66, v35, s38
    v_mfma_f32_16x16x32_bf16 v[168:171], a[176:179], a[208:211], v[168:171]
    ds_read_b32 a222, v57
    v_perm_b32 v62, v82, v35, s39
    v_mfma_f32_16x16x32_bf16 v[168:171], a[240:243], a[180:183], v[168:171]
    ds_read_b32 a82, v59
    v_perm_b32 v61, v66, v35, s39
    v_mfma_f32_16x16x32_bf16 v[172:175], a[176:179], a[248:251], v[172:175]
    ds_read_b32 a83, v62
    ds_read_b32 a223, v61
    v_mfma_f32_16x16x32_bf16 v[172:175], a[240:243], a[212:215], v[172:175]
    ds_read_b128 a[124:127], v43 offset:4096
    v_perm_b32 v58, v112, v35, s36
    v_mfma_f32_16x16x32_bf16 v[176:179], a[176:179], a[4:7], v[176:179]
    ds_read_b32 a244, v58
    v_perm_b32 v56, v112, v35, s37
    v_mfma_f32_16x16x32_bf16 v[176:179], a[240:243], a[84:87], v[176:179]
    ds_read_b128 a[168:171], v42 offset:10240
    v_perm_b32 v63, v70, v35, s36
    v_mfma_f32_16x16x32_bf16 v[180:183], a[176:179], a[44:47], v[180:183]
    ds_read_b32 a88, v63
    ds_read_b32 a245, v56
    v_mfma_f32_16x16x32_bf16 v[180:183], a[240:243], a[32:35], v[180:183]
    s_waitcnt vmcnt(18)
    v_perm_b32 v60, v112, v35, s38
    v_bitop3_b32 v87, v87, v91, s76 bitop3:0x7e
    v_mfma_f32_16x16x32_bf16 v[184:187], a[176:179], a[92:95], v[184:187]
    ds_read_b32 a246, v60
    v_cmp_ne_u32 vcc, 0, v87
    v_mfma_f32_16x16x32_bf16 v[184:187], a[240:243], a[196:199], v[184:187]
    ds_read_b128 a[108:111], v43 offset:10240
    v_perm_b32 v57, v112, v35, s39
    v_mfma_f32_16x16x32_bf16 v[188:191], a[176:179], a[204:207], v[188:191]
    ds_read_b32 a247, v57
    s_cbranch_vccnz L_slow5_1
L_back5_1:
    v_mfma_f32_16x16x32_bf16 v[188:191], a[240:243], a[228:231], v[188:191]
    s_waitcnt lgkmcnt(8)
    ds_read_b128 a[60:63], v42 offset:8192
    v_perm_b32 v59, v114, v35, s36
    v_mfma_f32_16x16x32_bf16 v[192:195], a[48:51], a[112:115], v[192:195]
    ds_read_b32 a104, v59
    v_perm_b32 v62, v114, v35, s37
    v_mfma_f32_16x16x32_bf16 v[192:195], a[80:83], a[136:139], v[192:195]
    v_perm_b32 v61, v70, v35, s37
    v_perm_b32 v58, v70, v35, s38
    v_mfma_f32_16x16x32_bf16 v[196:199], a[48:51], a[152:155], v[196:199]
    ds_read_b32 a89, v61
    ds_read_b32 a90, v58
    v_mfma_f32_16x16x32_bf16 v[196:199], a[80:83], a[160:163], v[196:199]
    ds_read_b32 a105, v62
    v_perm_b32 v56, v114, v35, s38
    v_mfma_f32_16x16x32_bf16 v[200:203], a[48:51], a[208:211], v[200:203]
    s_waitcnt vmcnt(16)
    v_perm_b32 v63, v114, v35, s39
    v_bitop3_b32 v123, v123, v119, s76 bitop3:0x7e
    v_mfma_f32_16x16x32_bf16 v[200:203], a[80:83], a[180:183], v[200:203]
    ds_read_b32 a106, v56
    v_cmp_ne_u32 vcc, 0, v123
    v_mfma_f32_16x16x32_bf16 v[204:207], a[48:51], a[248:251], v[204:207]
    ds_read_b32 a107, v63
    ds_read_b128 a[0:3], v43 offset:8192
    v_mfma_f32_16x16x32_bf16 v[204:207], a[80:83], a[212:215], v[204:207]
    v_perm_b32 v60, v84, v35, s36
    s_cbranch_vccnz L_slow7_0
L_back7_0:
    v_mfma_f32_16x16x32_bf16 v[208:211], a[48:51], a[4:7], v[208:211]
    ds_read_b128 a[20:23], v42 offset:14336
    ds_read_b32 a36, v60
    v_mfma_f32_16x16x32_bf16 v[208:211], a[80:83], a[84:87], v[208:211]
    ds_read_b128 a[52:55], v43 offset:14336
    v_perm_b32 v57, v84, v35, s37
    v_mfma_f32_16x16x32_bf16 v[212:215], a[48:51], a[44:47], v[212:215]
    ds_read_b32 a37, v57
    v_perm_b32 v59, v84, v35, s38
    v_mfma_f32_16x16x32_bf16 v[212:215], a[80:83], a[32:35], v[212:215]
    ds_read_b128 a[64:67], v42 offset:12288
    v_perm_b32 v61, v70, v35, s39
    v_mfma_f32_16x16x32_bf16 v[216:219], a[48:51], a[92:95], v[216:219]
    ds_read_b32 a91, v61
    ds_read_b32 a38, v59
    v_mfma_f32_16x16x32_bf16 v[216:219], a[80:83], a[196:199], v[216:219]
    v_perm_b32 v58, v84, v35, s39
    v_perm_b32 v62, v74, v35, s36
    v_mfma_f32_16x16x32_bf16 v[220:223], a[48:51], a[204:207], v[220:223]
    ds_read_b32 a72, v62
    ds_read_b32 a39, v58
    v_mfma_f32_16x16x32_bf16 v[220:223], a[80:83], a[228:231], v[220:223]
    s_waitcnt lgkmcnt(9)
    ds_read_b128 a[100:103], v43 offset:12288
    v_perm_b32 v56, v88, v35, s36
    v_mfma_f32_16x16x32_bf16 v[224:227], a[244:247], a[112:115], v[224:227]
    ds_read_b32 a116, v56
    v_perm_b32 v63, v88, v35, s37
    v_mfma_f32_16x16x32_bf16 v[224:227], a[104:107], a[136:139], v[224:227]
    v_perm_b32 v60, v74, v35, s37
    v_perm_b32 v57, v74, v35, s38
    v_mfma_f32_16x16x32_bf16 v[228:231], a[244:247], a[152:155], v[228:231]
    ds_read_b32 a73, v60
    ds_read_b32 a74, v57
    v_mfma_f32_16x16x32_bf16 v[228:231], a[104:107], a[160:163], v[228:231]
    ds_read_b32 a117, v63
    v_perm_b32 v59, v88, v35, s38
    v_mfma_f32_16x16x32_bf16 v[232:235], a[244:247], a[208:211], v[232:235]
    ds_read_b32 a118, v59
    v_perm_b32 v61, v88, v35, s39
    v_mfma_f32_16x16x32_bf16 v[232:235], a[104:107], a[180:183], v[232:235]
    v_perm_b32 v58, v74, v35, s39
    v_perm_b32 v62, v92, v35, s36
    v_mfma_f32_16x16x32_bf16 v[236:239], a[244:247], a[248:251], v[236:239]
    ds_read_b32 a119, v61
    ds_read_b32 a75, v58
    v_mfma_f32_16x16x32_bf16 v[236:239], a[104:107], a[212:215], v[236:239]
    ds_read_b32 a140, v62
    v_perm_b32 v56, v85, v35, s36
    v_mfma_f32_16x16x32_bf16 v[240:243], a[244:247], a[4:7], v[240:243]
    ds_read_b32 a200, v56
    v_perm_b32 v60, v85, v35, s37
    v_mfma_f32_16x16x32_bf16 v[240:243], a[104:107], a[84:87], v[240:243]
    v_perm_b32 v57, v92, v35, s37
    v_perm_b32 v63, v92, v35, s38
    v_mfma_f32_16x16x32_bf16 v[244:247], a[244:247], a[44:47], v[244:247]
    ds_read_b32 a141, v57
    ds_read_b32 a142, v63
    v_mfma_f32_16x16x32_bf16 v[244:247], a[104:107], a[32:35], v[244:247]
    ds_read_b32 a201, v60
    v_perm_b32 v59, v85, v35, s38
    v_mfma_f32_16x16x32_bf16 v[248:251], a[244:247], a[92:95], v[248:251]
    s_waitcnt vmcnt(13) lgkmcnt(8)
    s_barrier
    ds_read_b32 a202, v59
    v_mfma_f32_16x16x32_bf16 v[248:251], a[104:107], a[196:199], v[248:251]
    v_perm_b32 v61, v85, v35, s39
    v_perm_b32 v58, v92, v35, s39
    v_mfma_f32_16x16x32_bf16 v[252:255], a[244:247], a[204:207], v[252:255]
    ds_read_b32 a143, v58
    ds_read_b32 a203, v61
    v_mfma_f32_16x16x32_bf16 v[252:255], a[104:107], a[228:231], v[252:255]
    v_perm_b32 v62, v89, v35, s36
    v_perm_b32 v56, v94, v35, s36
    v_mfma_f32_16x16x32_bf16 v[128:131], a[36:39], a[24:27], v[128:131]
    s_waitcnt lgkmcnt(7)
    ds_read_b32 a188, v56
    ds_read_b32 a68, v62
    v_mfma_f32_16x16x32_bf16 v[128:131], a[116:119], a[76:79], v[128:131]
    ds_read_b128 a[232:235], v40 offset:34816
    v_perm_b32 v57, v89, v35, s37
    v_mfma_f32_16x16x32_bf16 v[132:135], a[36:39], a[28:31], v[132:135]
    ds_read_b32 a69, v57
    v_perm_b32 v63, v89, v35, s38
    v_mfma_f32_16x16x32_bf16 v[132:135], a[116:119], a[56:59], v[132:135]
    s_waitcnt vmcnt(8)
    v_bitop3_b32 v99, v99, v103, s76 bitop3:0x7e
    v_perm_b32 v60, v94, v35, s37
    v_mfma_f32_16x16x32_bf16 v[136:139], a[36:39], a[144:147], v[136:139]
    ds_read_b32 a189, v60
    v_perm_b32 v59, v89, v35, s39
    v_mfma_f32_16x16x32_bf16 v[136:139], a[116:119], a[120:123], v[136:139]
    ds_read_b32 a70, v63
    v_cmp_ne_u32 vcc, 0, v99
    v_mfma_f32_16x16x32_bf16 v[140:143], a[36:39], a[164:167], v[140:143]
    ds_read_b32 a71, v59
    v_perm_b32 v61, v86, v35, s36
    v_mfma_f32_16x16x32_bf16 v[140:143], a[116:119], a[124:127], v[140:143]
    ds_read_b128 a[156:159], v41 offset:34816
    s_cbranch_vccnz L_slow7_1
L_back7_1:
    v_mfma_f32_16x16x32_bf16 v[144:147], a[36:39], a[168:171], v[144:147]
    ds_read_b32 a184, v61
    v_perm_b32 v58, v86, v35, s37
    v_mfma_f32_16x16x32_bf16 v[144:147], a[116:119], a[108:111], v[144:147]
    v_perm_b32 v62, v94, v35, s38
    v_perm_b32 v56, v94, v35, s39
    v_mfma_f32_16x16x32_bf16 v[148:151], a[36:39], a[60:63], v[148:151]
    ds_read_b32 a190, v62
    ds_read_b32 a191, v56
    v_mfma_f32_16x16x32_bf16 v[148:151], a[116:119], a[0:3], v[148:151]
    ds_read_b32 a185, v58
    v_perm_b32 v57, v86, v35, s38
    v_mfma_f32_16x16x32_bf16 v[152:155], a[36:39], a[20:23], v[152:155]
    ds_read_b32 a186, v57
    v_perm_b32 v60, v86, v35, s39
    v_mfma_f32_16x16x32_bf16 v[152:155], a[116:119], a[52:55], v[152:155]
    ds_read_b128 a[216:219], v42 offset:32768
    v_perm_b32 v63, v120, v35, s36
    v_mfma_f32_16x16x32_bf16 v[156:159], a[36:39], a[64:67], v[156:159]
    ds_read_b32 a236, v63
    ds_read_b32 a187, v60
    v_mfma_f32_16x16x32_bf16 v[156:159], a[116:119], a[100:103], v[156:159]
    s_waitcnt lgkmcnt(9)
    v_perm_b32 v59, v90, v35, s36
    v_perm_b32 v61, v120, v35, s37
    v_mfma_f32_16x16x32_bf16 v[160:163], a[200:203], a[24:27], v[160:163]
    ds_read_b32 a237, v61
    ds_read_b32 a16, v59
    v_mfma_f32_16x16x32_bf16 v[160:163], a[68:71], a[76:79], v[160:163]
    ds_read_b128 a[176:179], v43 offset:32768
    v_perm_b32 v62, v90, v35, s37
    v_mfma_f32_16x16x32_bf16 v[164:167], a[200:203], a[28:31], v[164:167]
    ds_read_b32 a17, v62
    v_perm_b32 v56, v90, v35, s38
    v_mfma_f32_16x16x32_bf16 v[164:167], a[68:71], a[56:59], v[164:167]
    v_perm_b32 v58, v120, v35, s38
    v_perm_b32 v57, v120, v35, s39
    v_mfma_f32_16x16x32_bf16 v[168:171], a[200:203], a[144:147], v[168:171]
    ds_read_b32 a238, v58
    v_perm_b32 v60, v90, v35, s39
    v_mfma_f32_16x16x32_bf16 v[168:171], a[68:71], a[120:123], v[168:171]
    ds_read_b32 a18, v56
    ds_read_b32 a239, v57
    v_mfma_f32_16x16x32_bf16 v[172:175], a[200:203], a[164:167], v[172:175]
    ds_read_b32 a19, v60
    ds_read_b128 a[240:243], v40 offset:32768
    v_mfma_f32_16x16x32_bf16 v[172:175], a[68:71], a[124:127], v[172:175]
    v_perm_b32 v63, v116, v35, s36
    v_perm_b32 v59, v116, v35, s37
    v_mfma_f32_16x16x32_bf16 v[176:179], a[200:203], a[168:171], v[176:179]
    ds_read_b32 a48, v63
    ds_read_b32 a49, v59
    v_mfma_f32_16x16x32_bf16 v[176:179], a[68:71], a[108:111], v[176:179]
    v_perm_b32 v61, v116, v35, s38
    v_perm_b32 v62, v116, v35, s39
    v_mfma_f32_16x16x32_bf16 v[180:183], a[200:203], a[60:63], v[180:183]
    ds_read_b32 a50, v61
    ds_read_b32 a51, v62
    v_mfma_f32_16x16x32_bf16 v[180:183], a[68:71], a[0:3], v[180:183]
    ds_read_b128 a[80:83], v41 offset:32768
    v_perm_b32 v58, v96, v35, s36
    v_mfma_f32_16x16x32_bf16 v[184:187], a[200:203], a[20:23], v[184:187]
    ds_read_b32 a112, v58
    v_perm_b32 v56, v96, v35, s37
    v_mfma_f32_16x16x32_bf16 v[184:187], a[68:71], a[52:55], v[184:187]
    ds_read_b32 a113, v56
    v_perm_b32 v57, v96, v35, s38
    v_mfma_f32_16x16x32_bf16 v[188:191], a[200:203], a[64:67], v[188:191]
    ds_read_b32 a114, v57
    v_perm_b32 v60, v96, v35, s39
    v_mfma_f32_16x16x32_bf16 v[188:191], a[68:71], a[100:103], v[188:191]
    s_waitcnt lgkmcnt(8)
    ds_read_b32 a115, v60
    ds_read_b128 a[136:139], v42 offset:34816
    v_mfma_f32_16x16x32_bf16 v[192:195], a[184:187], a[24:27], v[192:195]
    v_perm_b32 v63, v100, v35, s36
    v_perm_b32 v59, v100, v35, s37
    v_mfma_f32_16x16x32_bf16 v[192:195], a[16:19], a[76:79], v[192:195]
    ds_read_b32 a152, v63
    ds_read_b32 a153, v59
    v_mfma_f32_16x16x32_bf16 v[196:199], a[184:187], a[28:31], v[196:199]
    v_perm_b32 v61, v100, v35, s38
    v_perm_b32 v62, v100, v35, s39
    v_mfma_f32_16x16x32_bf16 v[196:199], a[16:19], a[56:59], v[196:199]
    ds_read_b32 a154, v61
    ds_read_b32 a155, v62
    v_mfma_f32_16x16x32_bf16 v[200:203], a[184:187], a[144:147], v[200:203]
    ds_read_b128 a[160:163], v43 offset:34816
    v_perm_b32 v58, v121, v35, s36
    v_mfma_f32_16x16x32_bf16 v[200:203], a[16:19], a[120:123], v[200:203]
    ds_read_b32 a208, v58
    v_perm_b32 v56, v121, v35, s37
    v_mfma_f32_16x16x32_bf16 v[204:207], a[184:187], a[164:167], v[204:207]
    ds_read_b32 a209, v56
    v_perm_b32 v57, v121, v35, s38
    v_mfma_f32_16x16x32_bf16 v[204:207], a[16:19], a[124:127], v[204:207]
    ds_read_b32 a210, v57
    v_perm_b32 v60, v121, v35, s39
    v_mfma_f32_16x16x32_bf16 v[208:211], a[184:187], a[168:171], v[208:211]
    ds_read_b32 a211, v60
    v_perm_b32 v63, v117, v35, s36
    v_mfma_f32_16x16x32_bf16 v[208:211], a[16:19], a[108:111], v[208:211]
    ds_read_b32 a180, v63
    v_perm_b32 v59, v117, v35, s37
    v_mfma_f32_16x16x32_bf16 v[212:215], a[184:187], a[60:63], v[212:215]
    s_waitcnt vmcnt(1)
    s_barrier
    ds_read_b32 a181, v59
    v_mfma_f32_16x16x32_bf16 v[212:215], a[16:19], a[0:3], v[212:215]
    ds_read_b128 a[248:251], v44 offset:2048
    v_lshlrev_b32 v124, 16, v104
    v_mfma_f32_16x16x32_bf16 v[216:219], a[184:187], a[20:23], v[216:219]
    v_and_b32 v125, 0xffff0000, v105
    v_lshlrev_b32 v126, 16, v107
    v_mfma_f32_16x16x32_bf16 v[216:219], a[16:19], a[52:55], v[216:219]
    v_and_b32 v127, 0xffff0000, v108
    v_perm_b32 v61, v117, v35, s38
    v_mfma_f32_16x16x32_bf16 v[220:223], a[184:187], a[64:67], v[220:223]
    ds_read_b32 a182, v61
    ds_read_b128 a[212:215], v45 offset:2048
    v_mfma_f32_16x16x32_bf16 v[220:223], a[16:19], a[100:103], v[220:223]
    v_and_b32 v52, 0xffff0000, v104
    v_lshlrev_b32 v53, 16, v106
    v_mfma_f32_16x16x32_bf16 v[228:231], a[96:99], a[232:235], v[228:231]
    s_mov_b32 s64, 0
    v_and_b32 v54, 0xffff0000, v107
    v_mov_b32 v8, 1
    v_mfma_f32_16x16x32_bf16 v[228:231], a[224:227], a[156:159], v[228:231]
    ds_read_b128 a[4:7], v46 offset:0
    v_min_u32 v9, 1, v0
    v_mfma_f32_16x16x32_bf16 v[132:135], a[132:135], a[232:235], v[132:135]
    s_mov_b32 s65, 14336
    v_lshlrev_b32 v9, 30, v9
    v_lshlrev_b32 v55, 16, v109
    v_mfma_f32_16x16x32_bf16 v[132:135], a[192:195], a[156:159], v[132:135]
    v_lshlrev_b32 v48, 16, v105
    v_perm_b32 v62, v117, v35, s39
    v_mfma_f32_16x16x32_bf16 v[132:135], a[252:255], a[216:219], v[132:135]
    s_mov_b32 s66, 28672
    ds_read_b32 a183, v62
    ds_read_b128 a[84:87], v47 offset:0
    v_mfma_f32_16x16x32_bf16 v[132:135], a[8:11], a[176:179], v[132:135]
    v_and_b32 v49, 0xffff0000, v106
    v_perm_b32 v58, v97, v35, s36
    v_mfma_f32_16x16x32_bf16 v[164:167], a[12:15], a[232:235], v[164:167]
    s_mov_b32 s67, 43008
    ds_read_b32 a44, v58
    v_perm_b32 v56, v97, v35, s37
    v_mfma_f32_16x16x32_bf16 v[164:167], a[40:43], a[156:159], v[164:167]
    ds_read_b32 a45, v56
    ds_read_b128 a[32:35], v44 offset:0
L_pad4:
    s_cbranch_execz L_pad5
    v_mfma_f32_16x16x32_bf16 v[164:167], a[172:175], a[216:219], v[164:167]
    s_mov_b32 s68, 229376
    v_perm_b32 v57, v97, v35, s38
    v_perm_b32 v60, v97, v35, s39
    v_mfma_f32_16x16x32_bf16 v[164:167], a[128:131], a[176:179], v[164:167]
    ds_read_b32 a46, v57
    ds_read_b32 a47, v60
    v_mfma_f32_16x16x32_bf16 v[196:199], a[148:151], a[232:235], v[196:199]
    s_mov_b32 s69, 243712
    ds_read_b128 a[92:95], v45 offset:0
    v_lshlrev_b32 v50, 16, v108
    v_mfma_f32_16x16x32_bf16 v[196:199], a[220:223], a[156:159], v[196:199]
    v_perm_b32 v63, v101, v35, s36
    v_perm_b32 v59, v101, v35, s37
    v_mfma_f32_16x16x32_bf16 v[196:199], a[88:91], a[216:219], v[196:199]
    s_mov_b32 s70, 258048
    ds_read_b32 a196, v63
    ds_read_b32 a197, v59
    v_mfma_f32_16x16x32_bf16 v[196:199], a[72:75], a[176:179], v[196:199]
    s_waitcnt lgkmcnt(8)
    ds_read_b128 a[204:207], v46 offset:2048
    v_perm_b32 v61, v101, v35, s38
    v_mfma_f32_16x16x32_bf16 v[224:227], a[96:99], a[240:243], v[224:227]
    s_mov_b32 s71, 272384
    ds_read_b32 a198, v61
    v_perm_b32 v62, v101, v35, s39
    v_mfma_f32_16x16x32_bf16 v[224:227], a[224:227], a[80:83], v[224:227]
    ds_read_b32 a199, v62
    v_and_b32 v51, 0xffff0000, v109
    v_mfma_f32_16x16x32_bf16 v[128:131], a[132:135], a[240:243], v[128:131]
    s_mov_b32 s72, 458752
    ds_read_b128 a[244:247], v47 offset:2048
    v_perm_b32 v58, v122, v35, s36
    v_mfma_f32_16x16x32_bf16 v[128:131], a[192:195], a[80:83], v[128:131]
    ds_read_b32 a228, v58
    v_perm_b32 v56, v122, v35, s37
    v_mfma_f32_16x16x32_bf16 v[128:131], a[252:255], a[136:139], v[128:131]
    s_mov_b32 s73, 473088
    ds_read_b32 a229, v56
    ds_read_b128 a[104:107], v40 offset:38912
    v_mfma_f32_16x16x32_bf16 v[128:131], a[8:11], a[160:163], v[128:131]
    v_perm_b32 v57, v122, v35, s38
    v_perm_b32 v60, v122, v35, s39
    v_mfma_f32_16x16x32_bf16 v[160:163], a[12:15], a[240:243], v[160:163]
    s_mov_b32 s74, 487424
    ds_read_b32 a230, v57
    ds_read_b32 a231, v60
    v_mfma_f32_16x16x32_bf16 v[160:163], a[40:43], a[80:83], v[160:163]
    s_waitcnt vmcnt(0)
    ds_read_b128 a[36:39], v41 offset:38912
    v_lshlrev_b32 v76, 16, v110
    v_mfma_f32_16x16x32_bf16 v[160:163], a[172:175], a[136:139], v[160:163]
    s_mov_b32 s75, 501760
    ds_read_b128 a[116:119], v44 offset:6144
    v_perm_b32 v63, v118, v35, s36
    v_mfma_f32_16x16x32_bf16 v[160:163], a[128:131], a[160:163], v[160:163]
    ds_read_b32 a200, v63
    v_perm_b32 v59, v118, v35, s37
    v_mfma_f32_16x16x32_bf16 v[192:195], a[148:151], a[240:243], v[192:195]
    s_mov_b32 s48, 688128
    ds_read_b32 a201, v59
    ds_read_b128 a[68:71], v45 offset:6144
    v_mfma_f32_16x16x32_bf16 v[192:195], a[220:223], a[80:83], v[192:195]
    v_perm_b32 v61, v118, v35, s38
    v_perm_b32 v62, v118, v35, s39
    v_mfma_f32_16x16x32_bf16 v[192:195], a[88:91], a[136:139], v[192:195]
    s_mov_b32 s49, 702464
    ds_read_b32 a202, v61
    ds_read_b32 a203, v62
    v_mfma_f32_16x16x32_bf16 v[192:195], a[72:75], a[160:163], v[192:195]
    v_perm_b32 v58, v98, v35, s36
    v_perm_b32 v56, v98, v35, s37
    v_mfma_f32_16x16x32_bf16 v[228:231], a[140:143], a[248:251], v[228:231]
    s_mov_b32 s50, 716800
    v_perm_b32 v57, v98, v35, s38
    v_perm_b32 v60, v98, v35, s39
    v_mfma_f32_16x16x32_bf16 v[228:231], a[188:191], a[212:215], v[228:231]
    ds_read_b32 a24, v58
    ds_read_b32 a25, v56
    v_mfma_f32_16x16x32_bf16 v[132:135], a[236:239], a[248:251], v[132:135]
    s_mov_b32 s51, 731136
    ds_read_b32 a26, v57
    ds_read_b32 a27, v60
    v_mfma_f32_16x16x32_bf16 v[132:135], a[48:51], a[212:215], v[132:135]
    v_perm_b32 v63, v102, v35, s36
    v_perm_b32 v59, v102, v35, s37
    v_mfma_f32_16x16x32_bf16 v[132:135], a[112:115], a[4:7], v[132:135]
    v_perm_b32 v61, v102, v35, s38
    v_perm_b32 v62, v102, v35, s39
    v_mfma_f32_16x16x32_bf16 v[132:135], a[152:155], a[84:87], v[132:135]
    ds_read_b32 a76, v63
    ds_read_b32 a77, v59
    v_mfma_f32_16x16x32_bf16 v[164:167], a[208:211], a[248:251], v[164:167]
    ds_read_b32 a78, v61
    ds_read_b32 a79, v62
    v_mfma_f32_16x16x32_bf16 v[164:167], a[180:183], a[212:215], v[164:167]
    s_waitcnt lgkmcnt(8)
    ds_read_b128 a[28:31], v42 offset:36864
    v_and_b32 v77, 0xffff0000, v110
    v_mfma_f32_16x16x32_bf16 v[164:167], a[44:47], a[4:7], v[164:167]
    v_lshlrev_b32 v78, 16, v111
    v_and_b32 v79, 0xffff0000, v111
    v_mfma_f32_16x16x32_bf16 v[164:167], a[196:199], a[84:87], v[164:167]
    ds_read_b128 a[56:59], v43 offset:36864
    buffer_atomic_add v8, v9, s[24:27], s77 offen sc0 sc1
    v_mfma_f32_16x16x32_bf16 v[196:199], a[228:231], a[248:251], v[196:199]
    ds_read_b128 a[144:147], v46 offset:4096
    v_mul_f32 v132, v132, v124
    v_mfma_f32_16x16x32_bf16 v[196:199], a[200:203], a[212:215], v[196:199]
    s_waitcnt lgkmcnt(7)
    ds_write_b128 v29, v[228:231] offset:0
    v_mul_f32 v133, v133, v125
    v_mfma_f32_16x16x32_bf16 v[196:199], a[24:27], a[4:7], v[196:199]
    s_waitcnt lgkmcnt(4)
    ds_read_b128 a[120:123], v47 offset:4096
    v_mul_f32 v134, v134, v126
    v_mfma_f32_16x16x32_bf16 v[196:199], a[76:79], a[84:87], v[196:199]
    ds_read_b128 a[164:167], v40 offset:36864
    v_mul_f32 v135, v135, v127
    v_mfma_f32_16x16x32_bf16 v[224:227], a[140:143], a[32:35], v[224:227]
    ds_read_b128 a[124:127], v41 offset:36864
    v_mul_f32 v164, v164, v52
    v_mfma_f32_16x16x32_bf16 v[224:227], a[188:191], a[92:95], v[224:227]
    ds_read_b128 a[168:171], v44 offset:4096
    v_mul_f32 v165, v165, v53
    v_mfma_f32_16x16x32_bf16 v[128:131], a[236:239], a[32:35], v[128:131]
    s_waitcnt lgkmcnt(4)
    s_barrier
    ds_read_b128 v[80:83], v30 offset:0
    v_mfma_f32_16x16x32_bf16 v[128:131], a[48:51], a[92:95], v[128:131]
    ds_read_b128 a[108:111], v45 offset:4096
    v_mul_f32 v166, v166, v54
    v_mfma_f32_16x16x32_bf16 v[128:131], a[112:115], a[204:207], v[128:131]
    ds_read_b128 a[60:63], v42 offset:38912
    v_mul_f32 v167, v167, v55
    v_mfma_f32_16x16x32_bf16 v[128:131], a[152:155], a[244:247], v[128:131]
    v_mul_f32 v196, v196, v48
    v_mul_f32 v197, v197, v49
    v_mfma_f32_16x16x32_bf16 v[160:163], a[208:211], a[32:35], v[160:163]
    v_mul_f32 v198, v198, v50
    v_mul_f32 v199, v199, v51
    v_mfma_f32_16x16x32_bf16 v[160:163], a[180:183], a[92:95], v[160:163]
    ds_read_b128 a[0:3], v43 offset:38912
    v_cvt_pk_bf16_f32 v64, v132, v164
    v_mfma_f32_16x16x32_bf16 v[160:163], a[44:47], a[204:207], v[160:163]
    v_cvt_pk_bf16_f32 v65, v196, v133
    v_cvt_pk_bf16_f32 v66, v165, v197
    v_mfma_f32_16x16x32_bf16 v[160:163], a[196:199], a[244:247], v[160:163]
    ds_write_b64 v27, v[64:65] offset:0
    v_cvt_pk_bf16_f32 v67, v134, v166
    v_mfma_f32_16x16x32_bf16 v[192:195], a[228:231], a[32:35], v[192:195]
    ds_write_b64 v27, v[66:67] offset:8
    v_cvt_pk_bf16_f32 v112, v198, v135
    v_mfma_f32_16x16x32_bf16 v[192:195], a[200:203], a[92:95], v[192:195]
    ds_read_b128 a[20:23], v46 offset:6144
    v_cvt_pk_bf16_f32 v113, v167, v199
    v_mfma_f32_16x16x32_bf16 v[192:195], a[24:27], a[204:207], v[192:195]
    s_waitcnt lgkmcnt(5)
    ds_write_b64 v27, v[112:113] offset:16
    v_add_f32 v224, v224, v80
    v_mfma_f32_16x16x32_bf16 v[192:195], a[76:79], a[244:247], v[192:195]
    v_mul_f32 v224, v224, v76
    v_add_f32 v225, v225, v81
    v_mfma_f32_16x16x32_bf16 v[236:239], a[96:99], a[104:107], v[236:239]
    v_mul_f32 v225, v225, v77
    v_add_f32 v226, v226, v82
    v_mfma_f32_16x16x32_bf16 v[236:239], a[224:227], a[36:39], v[236:239]
    v_mul_f32 v226, v226, v78
    v_add_f32 v227, v227, v83
    v_mfma_f32_16x16x32_bf16 v[236:239], a[140:143], a[116:119], v[236:239]
    v_mul_f32 v227, v227, v79
    v_cvt_pk_bf16_f32 v80, v224, v225
    v_mfma_f32_16x16x32_bf16 v[236:239], a[188:191], a[68:71], v[236:239]
    v_cvt_pk_bf16_f32 v81, v226, v227
    v_mul_f32 v128, v128, v124
    v_mfma_f32_16x16x32_bf16 v[140:143], a[132:135], a[104:107], v[140:143]
    v_mul_f32 v129, v129, v125
    v_mul_f32 v130, v130, v126
    v_mfma_f32_16x16x32_bf16 v[140:143], a[192:195], a[36:39], v[140:143]
    ds_write_b64 v28, v[80:81] offset:0
    v_mul_f32 v131, v131, v127
    v_mfma_f32_16x16x32_bf16 v[140:143], a[252:255], a[28:31], v[140:143]
    ds_read_b128 a[52:55], v47 offset:6144
    v_mul_f32 v160, v160, v52
    v_mfma_f32_16x16x32_bf16 v[140:143], a[8:11], a[56:59], v[140:143]
    v_mul_f32 v161, v161, v53
    v_mul_f32 v162, v162, v54
    v_mfma_f32_16x16x32_bf16 v[140:143], a[236:239], a[116:119], v[140:143]
    ds_read_b128 a[64:67], v40 offset:43008
    v_mul_f32 v163, v163, v55
    v_mfma_f32_16x16x32_bf16 v[140:143], a[48:51], a[68:71], v[140:143]
    ds_write_b128 v29, v[236:239] offset:4096
    v_mul_f32 v192, v192, v48
    v_mfma_f32_16x16x32_bf16 v[140:143], a[112:115], a[144:147], v[140:143]
    v_mul_f32 v193, v193, v49
    v_mul_f32 v194, v194, v50
    v_mfma_f32_16x16x32_bf16 v[140:143], a[152:155], a[120:123], v[140:143]
    ds_read_b128 a[184:187], v41 offset:43008
    v_mul_f32 v195, v195, v51
    v_mfma_f32_16x16x32_bf16 v[172:175], a[12:15], a[104:107], v[172:175]
    v_cvt_pk_bf16_f32 v68, v128, v160
    v_cvt_pk_bf16_f32 v69, v192, v129
    v_mfma_f32_16x16x32_bf16 v[172:175], a[40:43], a[36:39], v[172:175]
    ds_write_b64 v26, v[68:69] offset:0
    v_cvt_pk_bf16_f32 v70, v161, v193
    v_mfma_f32_16x16x32_bf16 v[172:175], a[172:175], a[28:31], v[172:175]
    v_cvt_pk_bf16_f32 v71, v130, v162
    v_cvt_pk_bf16_f32 v72, v194, v131
    v_mfma_f32_16x16x32_bf16 v[172:175], a[128:131], a[56:59], v[172:175]
    ds_write_b64 v26, v[70:71] offset:8
    v_cvt_pk_bf16_f32 v73, v163, v195
    v_mfma_f32_16x16x32_bf16 v[172:175], a[208:211], a[116:119], v[172:175]
    ds_write_b64 v26, v[72:73] offset:16
    v_mul_f32 v140, v140, v124
    v_mfma_f32_16x16x32_bf16 v[172:175], a[180:183], a[68:71], v[172:175]
    ds_read_b128 a[100:103], v44 offset:10240
    v_mul_f32 v141, v141, v125
    v_mfma_f32_16x16x32_bf16 v[172:175], a[44:47], a[144:147], v[172:175]
    ds_read_b128 a[16:19], v45 offset:10240
    v_mul_f32 v142, v142, v126
    v_mfma_f32_16x16x32_bf16 v[172:175], a[196:199], a[120:123], v[172:175]
    ds_read_b128 a[232:235], v42 offset:40960
    v_mul_f32 v143, v143, v127
    v_mfma_f32_16x16x32_bf16 v[204:207], a[148:151], a[104:107], v[204:207]
    ds_read_b128 a[156:159], v43 offset:40960
    v_mfma_f32_16x16x32_bf16 v[204:207], a[220:223], a[36:39], v[204:207]
    s_waitcnt lgkmcnt(4)
    s_barrier
    ds_read_b128 v[92:95], v24 offset:0
    v_mfma_f32_16x16x32_bf16 v[204:207], a[88:91], a[28:31], v[204:207]
    ds_read_b128 v[84:87], v24 offset:928
    v_mfma_f32_16x16x32_bf16 v[204:207], a[72:75], a[56:59], v[204:207]
    ds_read_b128 v[88:91], v24 offset:1856
    v_mul_f32 v172, v172, v52
    v_mfma_f32_16x16x32_bf16 v[204:207], a[228:231], a[116:119], v[204:207]
    ds_read_b128 v[120:123], v24 offset:2784
    v_mul_f32 v173, v173, v53
    v_mfma_f32_16x16x32_bf16 v[204:207], a[200:203], a[68:71], v[204:207]
    ds_read_b128 a[216:219], v46 offset:8192
    v_mul_f32 v174, v174, v54
    v_mfma_f32_16x16x32_bf16 v[204:207], a[24:27], a[144:147], v[204:207]
    ds_read_b128 v[116:119], v30 offset:4096
    v_mul_f32 v175, v175, v55
    v_mfma_f32_16x16x32_bf16 v[204:207], a[76:79], a[120:123], v[204:207]
    ds_read_b128 a[176:179], v47 offset:8192
    v_mfma_f32_16x16x32_bf16 v[232:235], a[96:99], a[164:167], v[232:235]
    v_mfma_f32_16x16x32_bf16 v[232:235], a[224:227], a[124:127], v[232:235]
    s_waitcnt lgkmcnt(6)
    buffer_store_dwordx4 v[92:95], v25, s[16:19], s64 offen sc1
    v_mfma_f32_16x16x32_bf16 v[232:235], a[140:143], a[168:171], v[232:235]
    ds_read_b128 a[240:243], v40 offset:40960
    v_mfma_f32_16x16x32_bf16 v[232:235], a[188:191], a[108:111], v[232:235]
    v_mul_f32 v204, v204, v48
    v_mul_f32 v205, v205, v49
    v_mfma_f32_16x16x32_bf16 v[136:139], a[132:135], a[164:167], v[136:139]
    v_mul_f32 v206, v206, v50
    v_mul_f32 v207, v207, v51
    v_mfma_f32_16x16x32_bf16 v[136:139], a[192:195], a[124:127], v[136:139]
    s_waitcnt lgkmcnt(4)
    buffer_store_dwordx4 v[84:87], v25, s[16:19], s65 offen sc1
    v_mfma_f32_16x16x32_bf16 v[136:139], a[252:255], a[60:63], v[136:139]
    ds_read_b128 a[80:83], v41 offset:40960
    v_cvt_pk_bf16_f32 v96, v140, v172
    v_mfma_f32_16x16x32_bf16 v[136:139], a[8:11], a[0:3], v[136:139]
    v_cvt_pk_bf16_f32 v97, v204, v141
    v_cvt_pk_bf16_f32 v98, v173, v205
    v_mfma_f32_16x16x32_bf16 v[136:139], a[236:239], a[168:171], v[136:139]
    ds_write_b64 v27, v[96:97] offset:14848
    v_cvt_pk_bf16_f32 v99, v142, v174
    v_mfma_f32_16x16x32_bf16 v[136:139], a[48:51], a[108:111], v[136:139]
    ds_read_b128 a[136:139], v44 offset:8192
    buffer_store_dwordx4 v[88:91], v25, s[16:19], s66 offen sc1
    v_mfma_f32_16x16x32_bf16 v[136:139], a[112:115], a[20:23], v[136:139]
    ds_write_b64 v27, v[98:99] offset:14856
    v_cvt_pk_bf16_f32 v100, v206, v143
    v_mfma_f32_16x16x32_bf16 v[136:139], a[152:155], a[52:55], v[136:139]
    s_waitcnt lgkmcnt(4)
    v_cvt_pk_bf16_f32 v101, v175, v207
    v_add_f32 v232, v232, v116
    v_mfma_f32_16x16x32_bf16 v[168:171], a[12:15], a[164:167], v[168:171]
    ds_write_b64 v27, v[100:101] offset:14864
    v_mul_f32 v232, v232, v76
    v_mfma_f32_16x16x32_bf16 v[168:171], a[40:43], a[124:127], v[168:171]
    ds_read_b128 a[160:163], v45 offset:8192
    buffer_store_dwordx4 v[120:123], v25, s[16:19], s67 offen sc1
    v_mfma_f32_16x16x32_bf16 v[168:171], a[172:175], a[60:63], v[168:171]
    v_add_f32 v233, v233, v117
    v_mul_f32 v233, v233, v77
    v_mfma_f32_16x16x32_bf16 v[168:171], a[128:131], a[0:3], v[168:171]
    v_add_f32 v234, v234, v118
    v_mul_f32 v234, v234, v78
    v_mfma_f32_16x16x32_bf16 v[168:171], a[208:211], a[168:171], v[168:171]
    v_add_f32 v235, v235, v119
    v_mul_f32 v235, v235, v79
    v_mfma_f32_16x16x32_bf16 v[168:171], a[180:183], a[108:111], v[168:171]
    v_cvt_pk_bf16_f32 v116, v232, v233
    v_cvt_pk_bf16_f32 v117, v234, v235
    v_mfma_f32_16x16x32_bf16 v[168:171], a[44:47], a[20:23], v[168:171]
    ds_write_b64 v28, v[116:117] offset:14848
    v_mul_f32 v136, v136, v124
    v_mfma_f32_16x16x32_bf16 v[168:171], a[196:199], a[52:55], v[168:171]
    ds_read_b128 a[248:251], v42 offset:43008
    v_mul_f32 v137, v137, v125
    v_mfma_f32_16x16x32_bf16 v[200:203], a[148:151], a[164:167], v[200:203]
    v_mul_f32 v138, v138, v126
    v_mul_f32 v139, v139, v127
    v_mfma_f32_16x16x32_bf16 v[200:203], a[220:223], a[124:127], v[200:203]
    ds_read_b128 a[212:215], v43 offset:43008
    v_mfma_f32_16x16x32_bf16 v[200:203], a[88:91], a[60:63], v[200:203]
    v_mfma_f32_16x16x32_bf16 v[200:203], a[72:75], a[0:3], v[200:203]
    ds_read_b128 a[4:7], v46 offset:10240
    v_mul_f32 v168, v168, v52
    v_mfma_f32_16x16x32_bf16 v[200:203], a[228:231], a[168:171], v[200:203]
    v_mul_f32 v169, v169, v53
    v_mul_f32 v170, v170, v54
    v_mfma_f32_16x16x32_bf16 v[200:203], a[200:203], a[108:111], v[200:203]
    v_mul_f32 v171, v171, v55
    v_mfma_f32_16x16x32_bf16 v[200:203], a[24:27], a[20:23], v[200:203]
    v_mfma_f32_16x16x32_bf16 v[200:203], a[76:79], a[52:55], v[200:203]
    ds_read_b128 a[84:87], v47 offset:10240
    v_mfma_f32_16x16x32_bf16 v[244:247], a[96:99], a[64:67], v[244:247]
    v_mfma_f32_16x16x32_bf16 v[244:247], a[224:227], a[184:187], v[244:247]
    v_mfma_f32_16x16x32_bf16 v[244:247], a[140:143], a[100:103], v[244:247]
    ds_read_b128 a[32:35], v40 offset:47104
    v_mfma_f32_16x16x32_bf16 v[244:247], a[188:191], a[16:19], v[244:247]
    v_mul_f32 v200, v200, v48
    v_mul_f32 v201, v201, v49
    v_mfma_f32_16x16x32_bf16 v[148:151], a[132:135], a[64:67], v[148:151]
    v_mul_f32 v202, v202, v50
    v_mul_f32 v203, v203, v51
    v_mfma_f32_16x16x32_bf16 v[148:151], a[192:195], a[184:187], v[148:151]
    v_cvt_pk_bf16_f32 v104, v136, v168
    v_cvt_pk_bf16_f32 v105, v200, v137
    v_mfma_f32_16x16x32_bf16 v[148:151], a[252:255], a[232:235], v[148:151]
    ds_write_b64 v26, v[104:105] offset:14848
    v_cvt_pk_bf16_f32 v106, v169, v201
    v_mfma_f32_16x16x32_bf16 v[148:151], a[8:11], a[156:159], v[148:151]
    ds_write_b128 v29, v[244:247] offset:8192
    v_cvt_pk_bf16_f32 v107, v138, v170
    v_mfma_f32_16x16x32_bf16 v[148:151], a[236:239], a[100:103], v[148:151]
    ds_write_b64 v26, v[106:107] offset:14856
    v_cvt_pk_bf16_f32 v108, v202, v139
    v_mfma_f32_16x16x32_bf16 v[148:151], a[48:51], a[16:19], v[148:151]
    ds_read_b128 a[92:95], v41 offset:47104
    v_cvt_pk_bf16_f32 v109, v171, v203
    v_mfma_f32_16x16x32_bf16 v[148:151], a[112:115], a[216:219], v[148:151]
    ds_write_b64 v26, v[108:109] offset:14864
    v_mfma_f32_16x16x32_bf16 v[148:151], a[152:155], a[176:179], v[148:151]
    ds_read_b128 a[204:207], v44 offset:14336
    v_mfma_f32_16x16x32_bf16 v[180:183], a[12:15], a[64:67], v[180:183]
    v_mfma_f32_16x16x32_bf16 v[180:183], a[40:43], a[184:187], v[180:183]
    ds_read_b128 a[244:247], v45 offset:14336
    v_mfma_f32_16x16x32_bf16 v[180:183], a[172:175], a[232:235], v[180:183]
    v_mfma_f32_16x16x32_bf16 v[180:183], a[128:131], a[156:159], v[180:183]
    s_waitcnt lgkmcnt(2)
    s_barrier
    ds_read_b128 v[64:67], v24 offset:14848
    v_mfma_f32_16x16x32_bf16 v[180:183], a[208:211], a[100:103], v[180:183]
    ds_read_b128 v[112:115], v24 offset:15776
    v_mul_f32 v148, v148, v124
    v_mfma_f32_16x16x32_bf16 v[180:183], a[180:183], a[16:19], v[180:183]
    ds_read_b128 v[80:83], v24 offset:16704
    v_mul_f32 v149, v149, v125
    v_mfma_f32_16x16x32_bf16 v[180:183], a[44:47], a[216:219], v[180:183]
    ds_read_b128 v[68:71], v24 offset:17632
    v_mul_f32 v150, v150, v126
    v_mfma_f32_16x16x32_bf16 v[180:183], a[196:199], a[176:179], v[180:183]
    ds_read_b128 a[104:107], v42 offset:45056
    v_mul_f32 v151, v151, v127
    v_mfma_f32_16x16x32_bf16 v[212:215], a[148:151], a[64:67], v[212:215]
    ds_read_b128 a[36:39], v43 offset:45056
    v_mfma_f32_16x16x32_bf16 v[212:215], a[220:223], a[184:187], v[212:215]
    v_mfma_f32_16x16x32_bf16 v[212:215], a[88:91], a[232:235], v[212:215]
    v_mfma_f32_16x16x32_bf16 v[212:215], a[72:75], a[156:159], v[212:215]
    s_waitcnt lgkmcnt(5)
    ds_read_b128 a[28:31], v46 offset:12288
    buffer_store_dwordx4 v[64:67], v25, s[16:19], s68 offen sc1
    v_mfma_f32_16x16x32_bf16 v[212:215], a[228:231], a[100:103], v[212:215]
    ds_read_b128 v[72:75], v30 offset:8192
    v_mul_f32 v180, v180, v52
    v_mfma_f32_16x16x32_bf16 v[212:215], a[200:203], a[16:19], v[212:215]
    v_mul_f32 v181, v181, v53
    v_mul_f32 v182, v182, v54
    v_mfma_f32_16x16x32_bf16 v[212:215], a[24:27], a[216:219], v[212:215]
    v_mul_f32 v183, v183, v55
    v_mfma_f32_16x16x32_bf16 v[212:215], a[76:79], a[176:179], v[212:215]
    s_waitcnt lgkmcnt(4)
    ds_read_b128 a[56:59], v47 offset:12288
    buffer_store_dwordx4 v[112:115], v25, s[16:19], s69 offen sc1
    v_mfma_f32_16x16x32_bf16 v[240:243], a[96:99], a[240:243], v[240:243]
    v_mfma_f32_16x16x32_bf16 v[240:243], a[224:227], a[80:83], v[240:243]
    v_mfma_f32_16x16x32_bf16 v[240:243], a[140:143], a[136:139], v[240:243]
    ds_read_b128 a[116:119], v40 offset:45056
    v_mfma_f32_16x16x32_bf16 v[240:243], a[188:191], a[160:163], v[240:243]
    buffer_store_dwordx4 v[80:83], v25, s[16:19], s70 offen sc1
    v_mfma_f32_16x16x32_bf16 v[144:147], a[132:135], a[240:243], v[144:147]
    v_mul_f32 v212, v212, v48
    v_mul_f32 v213, v213, v49
    v_mfma_f32_16x16x32_bf16 v[144:147], a[192:195], a[80:83], v[144:147]
    v_mul_f32 v214, v214, v50
    v_mul_f32 v215, v215, v51
    v_mfma_f32_16x16x32_bf16 v[144:147], a[252:255], a[248:251], v[144:147]
    ds_read_b128 a[68:71], v41 offset:45056
    v_cvt_pk_bf16_f32 v92, v148, v180
    v_mfma_f32_16x16x32_bf16 v[144:147], a[8:11], a[212:215], v[144:147]
    buffer_store_dwordx4 v[68:71], v25, s[16:19], s71 offen sc1
    v_mfma_f32_16x16x32_bf16 v[144:147], a[236:239], a[136:139], v[144:147]
    v_cvt_pk_bf16_f32 v93, v212, v149
    v_cvt_pk_bf16_f32 v94, v181, v213
    v_mfma_f32_16x16x32_bf16 v[144:147], a[48:51], a[160:163], v[144:147]
    ds_write_b64 v27, v[92:93] offset:29696
    v_cvt_pk_bf16_f32 v95, v150, v182
    v_mfma_f32_16x16x32_bf16 v[144:147], a[112:115], a[4:7], v[144:147]
    ds_write_b64 v27, v[94:95] offset:29704
    v_cvt_pk_bf16_f32 v84, v214, v151
    v_mfma_f32_16x16x32_bf16 v[144:147], a[152:155], a[84:87], v[144:147]
    ds_read_b128 a[144:147], v44 offset:12288
    v_cvt_pk_bf16_f32 v85, v183, v215
    v_mfma_f32_16x16x32_bf16 v[176:179], a[12:15], a[240:243], v[176:179]
    s_waitcnt lgkmcnt(4)
    ds_write_b64 v27, v[84:85] offset:29712
    v_add_f32 v240, v240, v72
    v_mfma_f32_16x16x32_bf16 v[176:179], a[40:43], a[80:83], v[176:179]
    ds_read_b128 a[120:123], v45 offset:12288
    v_mul_f32 v240, v240, v76
    v_mfma_f32_16x16x32_bf16 v[176:179], a[172:175], a[248:251], v[176:179]
    v_add_f32 v241, v241, v73
    v_mul_f32 v241, v241, v77
    v_mfma_f32_16x16x32_bf16 v[176:179], a[128:131], a[212:215], v[176:179]
    v_add_f32 v242, v242, v74
    v_mul_f32 v242, v242, v78
    v_mfma_f32_16x16x32_bf16 v[176:179], a[208:211], a[136:139], v[176:179]
    v_add_f32 v243, v243, v75
    v_mul_f32 v243, v243, v79
    v_mfma_f32_16x16x32_bf16 v[176:179], a[180:183], a[160:163], v[176:179]
    v_cvt_pk_bf16_f32 v72, v240, v241
    v_cvt_pk_bf16_f32 v73, v242, v243
    v_mfma_f32_16x16x32_bf16 v[176:179], a[44:47], a[4:7], v[176:179]
    ds_write_b64 v28, v[72:73] offset:29696
    v_mul_f32 v144, v144, v124
    v_mfma_f32_16x16x32_bf16 v[176:179], a[196:199], a[84:87], v[176:179]
    ds_read_b128 a[164:167], v42 offset:47104
    v_mul_f32 v145, v145, v125
    v_mfma_f32_16x16x32_bf16 v[208:211], a[148:151], a[240:243], v[208:211]
    v_mul_f32 v146, v146, v126
    v_mul_f32 v147, v147, v127
    v_mfma_f32_16x16x32_bf16 v[208:211], a[220:223], a[80:83], v[208:211]
    ds_read_b128 a[124:127], v43 offset:47104
    v_mfma_f32_16x16x32_bf16 v[208:211], a[88:91], a[248:251], v[208:211]
    v_mfma_f32_16x16x32_bf16 v[208:211], a[72:75], a[212:215], v[208:211]
    ds_read_b128 a[60:63], v46 offset:14336
    v_mul_f32 v176, v176, v52
    v_mfma_f32_16x16x32_bf16 v[208:211], a[228:231], a[136:139], v[208:211]
    v_mul_f32 v177, v177, v53
    v_mul_f32 v178, v178, v54
    v_mfma_f32_16x16x32_bf16 v[208:211], a[200:203], a[160:163], v[208:211]
    v_mul_f32 v179, v179, v55
    v_mfma_f32_16x16x32_bf16 v[208:211], a[24:27], a[4:7], v[208:211]
    v_mfma_f32_16x16x32_bf16 v[208:211], a[76:79], a[84:87], v[208:211]
    ds_read_b128 a[0:3], v47 offset:14336
    v_mfma_f32_16x16x32_bf16 v[252:255], a[96:99], a[32:35], v[252:255]
    v_mfma_f32_16x16x32_bf16 v[252:255], a[224:227], a[92:95], v[252:255]
    v_mfma_f32_16x16x32_bf16 v[252:255], a[140:143], a[204:207], v[252:255]
    v_mfma_f32_16x16x32_bf16 v[252:255], a[188:191], a[244:247], v[252:255]
    v_mul_f32 v208, v208, v48
    v_mul_f32 v209, v209, v49
    v_mfma_f32_16x16x32_bf16 v[156:159], a[132:135], a[32:35], v[156:159]
    v_mul_f32 v210, v210, v50
    v_mul_f32 v211, v211, v51
    v_mfma_f32_16x16x32_bf16 v[156:159], a[192:195], a[92:95], v[156:159]
    v_cvt_pk_bf16_f32 v88, v144, v176
    v_cvt_pk_bf16_f32 v89, v208, v145
    v_mfma_f32_16x16x32_bf16 v[156:159], a[252:255], a[104:107], v[156:159]
    ds_write_b64 v26, v[88:89] offset:29696
    v_cvt_pk_bf16_f32 v90, v177, v209
    v_mfma_f32_16x16x32_bf16 v[156:159], a[8:11], a[36:39], v[156:159]
    ds_write_b128 v29, v[252:255] offset:12288
    v_cvt_pk_bf16_f32 v91, v146, v178
    v_mfma_f32_16x16x32_bf16 v[156:159], a[236:239], a[204:207], v[156:159]
    ds_write_b64 v26, v[90:91] offset:29704
    v_cvt_pk_bf16_f32 v96, v210, v147
    v_mfma_f32_16x16x32_bf16 v[156:159], a[48:51], a[244:247], v[156:159]
    v_cvt_pk_bf16_f32 v97, v179, v211
    v_mfma_f32_16x16x32_bf16 v[156:159], a[112:115], a[28:31], v[156:159]
    ds_write_b64 v26, v[96:97] offset:29712
    v_mfma_f32_16x16x32_bf16 v[156:159], a[152:155], a[56:59], v[156:159]
    v_mfma_f32_16x16x32_bf16 v[188:191], a[12:15], a[32:35], v[188:191]
    v_mfma_f32_16x16x32_bf16 v[188:191], a[40:43], a[92:95], v[188:191]
    v_mfma_f32_16x16x32_bf16 v[188:191], a[172:175], a[104:107], v[188:191]
    v_mfma_f32_16x16x32_bf16 v[188:191], a[128:131], a[36:39], v[188:191]
    s_waitcnt lgkmcnt(0)
    s_barrier
    ds_read_b128 v[100:103], v24 offset:29696
    v_mfma_f32_16x16x32_bf16 v[188:191], a[208:211], a[204:207], v[188:191]
    ds_read_b128 v[120:123], v24 offset:30624
    v_mul_f32 v156, v156, v124
    v_mfma_f32_16x16x32_bf16 v[188:191], a[180:183], a[244:247], v[188:191]
    ds_read_b128 v[116:119], v24 offset:31552
    v_mul_f32 v157, v157, v125
    v_mfma_f32_16x16x32_bf16 v[188:191], a[44:47], a[28:31], v[188:191]
    ds_read_b128 v[104:107], v24 offset:32480
    v_mul_f32 v158, v158, v126
    v_mfma_f32_16x16x32_bf16 v[188:191], a[196:199], a[56:59], v[188:191]
    v_mul_f32 v159, v159, v127
    v_mfma_f32_16x16x32_bf16 v[220:223], a[148:151], a[32:35], v[220:223]
    v_mfma_f32_16x16x32_bf16 v[220:223], a[220:223], a[92:95], v[220:223]
    v_mfma_f32_16x16x32_bf16 v[220:223], a[88:91], a[104:107], v[220:223]
    v_mfma_f32_16x16x32_bf16 v[220:223], a[72:75], a[36:39], v[220:223]
    s_waitcnt lgkmcnt(3)
    ds_read_b128 v[108:111], v30 offset:12288
    buffer_store_dwordx4 v[100:103], v25, s[16:19], s72 offen sc1
    v_mfma_f32_16x16x32_bf16 v[220:223], a[228:231], a[204:207], v[220:223]
    v_mul_f32 v188, v188, v52
    v_mul_f32 v189, v189, v53
    v_mfma_f32_16x16x32_bf16 v[220:223], a[200:203], a[244:247], v[220:223]
    v_mul_f32 v190, v190, v54
    v_mul_f32 v191, v191, v55
    v_mfma_f32_16x16x32_bf16 v[220:223], a[24:27], a[28:31], v[220:223]
    v_mfma_f32_16x16x32_bf16 v[220:223], a[76:79], a[56:59], v[220:223]
    s_waitcnt lgkmcnt(1)
    buffer_store_dwordx4 v[120:123], v25, s[16:19], s73 offen sc1
    v_mfma_f32_16x16x32_bf16 v[248:251], a[96:99], a[116:119], v[248:251]
    v_mfma_f32_16x16x32_bf16 v[248:251], a[224:227], a[68:71], v[248:251]
    v_mfma_f32_16x16x32_bf16 v[248:251], a[140:143], a[144:147], v[248:251]
    v_mfma_f32_16x16x32_bf16 v[248:251], a[188:191], a[120:123], v[248:251]
    buffer_store_dwordx4 v[116:119], v25, s[16:19], s74 offen sc1
    v_mfma_f32_16x16x32_bf16 v[152:155], a[132:135], a[116:119], v[152:155]
    v_mul_f32 v220, v220, v48
    v_mul_f32 v221, v221, v49
    v_mfma_f32_16x16x32_bf16 v[152:155], a[192:195], a[68:71], v[152:155]
    v_mul_f32 v222, v222, v50
    v_mul_f32 v223, v223, v51
    v_mfma_f32_16x16x32_bf16 v[152:155], a[252:255], a[164:167], v[152:155]
    v_cvt_pk_bf16_f32 v64, v156, v188
    v_cvt_pk_bf16_f32 v65, v220, v157
    v_mfma_f32_16x16x32_bf16 v[152:155], a[8:11], a[124:127], v[152:155]
    buffer_store_dwordx4 v[104:107], v25, s[16:19], s75 offen sc1
    v_mfma_f32_16x16x32_bf16 v[152:155], a[236:239], a[144:147], v[152:155]
    ds_write_b64 v27, v[64:65] offset:44544
    v_cvt_pk_bf16_f32 v66, v189, v221
    v_mfma_f32_16x16x32_bf16 v[152:155], a[48:51], a[120:123], v[152:155]
    v_cvt_pk_bf16_f32 v67, v158, v190
    v_cvt_pk_bf16_f32 v112, v222, v159
    v_mfma_f32_16x16x32_bf16 v[152:155], a[112:115], a[60:63], v[152:155]
    ds_write_b64 v27, v[66:67] offset:44552
    v_cvt_pk_bf16_f32 v113, v191, v223
    v_mfma_f32_16x16x32_bf16 v[152:155], a[152:155], a[0:3], v[152:155]
    s_waitcnt lgkmcnt(2)
    ds_write_b64 v27, v[112:113] offset:44560
    v_add_f32 v248, v248, v108
    v_mfma_f32_16x16x32_bf16 v[184:187], a[12:15], a[116:119], v[184:187]
    v_mul_f32 v248, v248, v76
    v_add_f32 v249, v249, v109
    v_mfma_f32_16x16x32_bf16 v[184:187], a[40:43], a[68:71], v[184:187]
    v_mul_f32 v249, v249, v77
    v_add_f32 v250, v250, v110
    v_mfma_f32_16x16x32_bf16 v[184:187], a[172:175], a[164:167], v[184:187]
    v_mul_f32 v250, v250, v78
    v_add_f32 v251, v251, v111
    v_mfma_f32_16x16x32_bf16 v[184:187], a[128:131], a[124:127], v[184:187]
    v_mul_f32 v251, v251, v79
    v_cvt_pk_bf16_f32 v108, v248, v249
    v_mfma_f32_16x16x32_bf16 v[184:187], a[208:211], a[144:147], v[184:187]
    v_cvt_pk_bf16_f32 v109, v250, v251
    v_mul_f32 v152, v152, v124
    v_mfma_f32_16x16x32_bf16 v[184:187], a[180:183], a[120:123], v[184:187]
    ds_write_b64 v28, v[108:109] offset:44544
    v_mul_f32 v153, v153, v125
    v_mfma_f32_16x16x32_bf16 v[184:187], a[44:47], a[60:63], v[184:187]
    v_mul_f32 v154, v154, v126
    v_mul_f32 v155, v155, v127
    v_mfma_f32_16x16x32_bf16 v[184:187], a[196:199], a[0:3], v[184:187]
    s_waitcnt vmcnt(12)
    v_xor_b32 v8, 15, v8
    v_or_b32 v8, v8, v0
    v_mfma_f32_16x16x32_bf16 v[216:219], a[148:151], a[116:119], v[216:219]
    v_min_u32 v8, 1, v8
    v_lshlrev_b32 v8, 30, v8
    v_mfma_f32_16x16x32_bf16 v[216:219], a[220:223], a[68:71], v[216:219]
    v_mov_b32 v9, s76
    v_mfma_f32_16x16x32_bf16 v[216:219], a[88:91], a[164:167], v[216:219]
    buffer_store_dword v9, v8, s[12:15], s78 offen sc1
    v_mfma_f32_16x16x32_bf16 v[216:219], a[72:75], a[124:127], v[216:219]
L_pad5:
    s_cbranch_execz L_warmed
    v_mul_f32 v184, v184, v52
    v_mul_f32 v185, v185, v53
    v_mfma_f32_16x16x32_bf16 v[216:219], a[228:231], a[144:147], v[216:219]
    v_mul_f32 v186, v186, v54
    v_mul_f32 v187, v187, v55
    v_mfma_f32_16x16x32_bf16 v[216:219], a[200:203], a[120:123], v[216:219]
    v_mfma_f32_16x16x32_bf16 v[216:219], a[24:27], a[60:63], v[216:219]
    v_mfma_f32_16x16x32_bf16 v[216:219], a[76:79], a[0:3], v[216:219]
    s_nop 7
    v_mul_f32 v216, v216, v48
    v_mul_f32 v217, v217, v49
    v_mul_f32 v218, v218, v50
    v_mul_f32 v219, v219, v51
    v_cvt_pk_bf16_f32 v80, v152, v184
    v_cvt_pk_bf16_f32 v81, v216, v153
    v_cvt_pk_bf16_f32 v82, v185, v217
    v_cvt_pk_bf16_f32 v83, v154, v186
    v_cvt_pk_bf16_f32 v68, v218, v155
    v_cvt_pk_bf16_f32 v69, v187, v219
    ds_write_b64 v26, v[80:81] offset:44544
    ds_write_b64 v26, v[82:83] offset:44552
    ds_write_b64 v26, v[68:69] offset:44560
    s_waitcnt lgkmcnt(0)
    s_barrier
    ds_read_b128 v[92:95], v24 offset:44544
    ds_read_b128 v[84:87], v24 offset:45472
    ds_read_b128 v[72:75], v24 offset:46400
    ds_read_b128 v[88:91], v24 offset:47328
    s_waitcnt lgkmcnt(3)
    buffer_store_dwordx4 v[92:95], v25, s[16:19], s48 offen sc1
    s_waitcnt lgkmcnt(2)
    buffer_store_dwordx4 v[84:87], v25, s[16:19], s49 offen sc1
    s_waitcnt lgkmcnt(1)
    buffer_store_dwordx4 v[72:75], v25, s[16:19], s50 offen sc1
    s_waitcnt lgkmcnt(0)
    buffer_store_dwordx4 v[88:91], v25, s[16:19], s51 offen sc1
L_end:
    s_endpgm
L_slow0_0:
    s_mov_b32 s22, 0
    s_call_b64 s[20:21], L_tick
    s_mov_b32 s22, 0
    s_mov_b32 s23, 5120
    buffer_load_dwordx4 v[64:67], v32, s[12:15], s22 offen sc1
    buffer_load_dwordx4 v[68:71], v32, s[12:15], s23 offen sc1
    s_waitcnt vmcnt(0)
    v_bitop3_b32 v67, v67, v71, s76 bitop3:0x7e
    v_cmp_ne_u32 vcc, 0, v67
    s_cbranch_vccnz L_slow0_0
    s_branch L_back0_0
L_slow0_2:
    s_mov_b32 s22, 0
    s_call_b64 s[20:21], L_tick
    s_mov_b32 s22, 0
    s_mov_b32 s23, 5120
    buffer_load_dwordx2 v[72:73], v34, s[12:15], s22 offen sc1
    buffer_load_dwordx2 v[74:75], v34, s[12:15], s23 offen sc1
    s_waitcnt vmcnt(0)
    v_bitop3_b32 v73, v73, v75, s76 bitop3:0x7e
    v_cmp_ne_u32 vcc, 0, v73
    s_cbranch_vccnz L_slow0_2
    s_branch L_back0_2
L_slow0_1:
    s_mov_b32 s22, 0
    s_call_b64 s[20:21], L_tick
    s_mov_b32 s22, 0
    s_mov_b32 s23, 5120
    buffer_load_dwordx4 v[76:79], v33, s[12:15], s22 offen sc1
    buffer_load_dwordx4 v[80:83], v33, s[12:15], s23 offen sc1
    s_waitcnt vmcnt(0)
    v_bitop3_b32 v79, v79, v83, s76 bitop3:0x7e
    v_cmp_ne_u32 vcc, 0, v79
    s_cbranch_vccnz L_slow0_1
    s_branch L_back0_1
L_slow1_0:
    s_mov_b32 s22, 1
    s_call_b64 s[20:21], L_tick
    s_mov_b32 s22, 20480
    s_mov_b32 s23, 25600
    buffer_load_dwordx4 v[84:87], v32, s[12:15], s22 offen sc1
    buffer_load_dwordx4 v[88:91], v32, s[12:15], s23 offen sc1
    s_waitcnt vmcnt(0)
    v_bitop3_b32 v87, v87, v91, s76 bitop3:0x7e
    v_cmp_ne_u32 vcc, 0, v87
    s_cbranch_vccnz L_slow1_0
    s_branch L_back1_0
L_slow1_2:
    s_mov_b32 s22, 1
    s_call_b64 s[20:21], L_tick
    s_mov_b32 s22, 20480
    s_mov_b32 s23, 25600
    buffer_load_dwordx2 v[96:97], v34, s[12:15], s22 offen sc1
    buffer_load_dwordx2 v[98:99], v34, s[12:15], s23 offen sc1
    s_waitcnt vmcnt(0)
    v_bitop3_b32 v97, v97, v99, s76 bitop3:0x7e
    v_cmp_ne_u32 vcc, 0, v97
    s_cbranch_vccnz L_slow1_2
    s_branch L_back1_2
L_slow1_1:
    s_mov_b32 s22, 1
    s_call_b64 s[20:21], L_tick
    s_mov_b32 s22, 20480
    s_mov_b32 s23, 25600
    buffer_load_dwordx4 v[104:107], v33, s[12:15], s22 offen sc1
    buffer_load_dwordx4 v[108:111], v33, s[12:15], s23 offen sc1
    s_waitcnt vmcnt(0)
    v_bitop3_b32 v107, v107, v111, s76 bitop3:0x7e
    v_cmp_ne_u32 vcc, 0, v107
    s_cbranch_vccnz L_slow1_1
    s_branch L_back1_1
L_slow2_0:
    s_mov_b32 s22, 2
    s_call_b64 s[20:21], L_tick
    s_mov_b32 s22, 40960
    s_mov_b32 s23, 46080
    buffer_load_dwordx4 v[124:127], v32, s[12:15], s22 offen sc1
    buffer_load_dwordx4 v[52:55], v32, s[12:15], s23 offen sc1
    s_waitcnt vmcnt(0)
    v_bitop3_b32 v127, v127, v55, s76 bitop3:0x7e
    v_cmp_ne_u32 vcc, 0, v127
    s_cbranch_vccnz L_slow2_0
    s_branch L_back2_0
L_slow2_2:
    s_mov_b32 s22, 2
    s_call_b64 s[20:21], L_tick
    s_mov_b32 s22, 40960
    s_mov_b32 s23, 46080
    buffer_load_dwordx2 v[76:77], v34, s[12:15], s22 offen sc1
    buffer_load_dwordx2 v[78:79], v34, s[12:15], s23 offen sc1
    s_waitcnt vmcnt(0)
    v_bitop3_b32 v77, v77, v79, s76 bitop3:0x7e
    v_cmp_ne_u32 vcc, 0, v77
    s_cbranch_vccnz L_slow2_2
    s_branch L_back2_2
L_slow2_1:
    s_mov_b32 s22, 2
    s_call_b64 s[20:21], L_tick
    s_mov_b32 s22, 40960
    s_mov_b32 s23, 46080
    buffer_load_dwordx4 v[80:83], v33, s[12:15], s22 offen sc1
    buffer_load_dwordx4 v[92:95], v33, s[12:15], s23 offen sc1
    s_waitcnt vmcnt(0)
    v_bitop3_b32 v83, v83, v95, s76 bitop3:0x7e
    v_cmp_ne_u32 vcc, 0, v83
    s_cbranch_vccnz L_slow2_1
    s_branch L_back2_1
L_slow3_0:
    s_mov_b32 s22, 3
    s_call_b64 s[20:21], L_tick
    s_mov_b32 s22, 61440
    s_mov_b32 s23, 66560
    buffer_load_dwordx4 v[112:115], v32, s[12:15], s22 offen sc1
    buffer_load_dwordx4 v[84:87], v32, s[12:15], s23 offen sc1
    s_waitcnt vmcnt(0)
    v_bitop3_b32 v115, v115, v87, s76 bitop3:0x7e
    v_cmp_ne_u32 vcc, 0, v115
    s_cbranch_vccnz L_slow3_0
    s_branch L_back3_0
L_slow6_2:
    s_mov_b32 s22, 6
    s_call_b64 s[20:21], L_tick
    s_mov_b32 s22, 122880
    s_mov_b32 s23, 128000
    buffer_load_dwordx2 v[120:121], v34, s[12:15], s22 offen sc1
    buffer_load_dwordx2 v[122:123], v34, s[12:15], s23 offen sc1
    s_waitcnt vmcnt(0)
    v_bitop3_b32 v121, v121, v123, s76 bitop3:0x7e
    v_cmp_ne_u32 vcc, 0, v121
    s_cbranch_vccnz L_slow6_2
    s_branch L_back6_2
L_slow3_2:
    s_mov_b32 s22, 3
    s_call_b64 s[20:21], L_tick
    s_mov_b32 s22, 61440
    s_mov_b32 s23, 66560
    buffer_load_dwordx2 v[88:89], v34, s[12:15], s22 offen sc1
    buffer_load_dwordx2 v[90:91], v34, s[12:15], s23 offen sc1
    s_waitcnt vmcnt(0)
    v_bitop3_b32 v89, v89, v91, s76 bitop3:0x7e
    v_cmp_ne_u32 vcc, 0, v89
    s_cbranch_vccnz L_slow3_2
    s_branch L_back3_2
L_slow3_1:
    s_mov_b32 s22, 3
    s_call_b64 s[20:21], L_tick
    s_mov_b32 s22, 61440
    s_mov_b32 s23, 66560
    buffer_load_dwordx4 v[116:119], v33, s[12:15], s22 offen sc1
    buffer_load_dwordx4 v[96:99], v33, s[12:15], s23 offen sc1
    s_waitcnt vmcnt(0)
    v_bitop3_b32 v119, v119, v99, s76 bitop3:0x7e
    v_cmp_ne_u32 vcc, 0, v119
    s_cbranch_vccnz L_slow3_1
    s_branch L_back3_1
L_slow6_0:
    s_mov_b32 s22, 6
    s_call_b64 s[20:21], L_tick
    s_mov_b32 s22, 122880
    s_mov_b32 s23, 128000
    buffer_load_dwordx4 v[48:51], v32, s[12:15], s22 offen sc1
    buffer_load_dwordx4 v[64:67], v32, s[12:15], s23 offen sc1
    s_waitcnt vmcnt(0)
    v_bitop3_b32 v51, v51, v67, s76 bitop3:0x7e
    v_cmp_ne_u32 vcc, 0, v51
    s_cbranch_vccnz L_slow6_0
    s_branch L_back6_0
L_slow6_1:
    s_mov_b32 s22, 6
    s_call_b64 s[20:21], L_tick
    s_mov_b32 s22, 122880
    s_mov_b32 s23, 128000
    buffer_load_dwordx4 v[68:71], v33, s[12:15], s22 offen sc1
    buffer_load_dwordx4 v[72:75], v33, s[12:15], s23 offen sc1
    s_waitcnt vmcnt(0)
    v_bitop3_b32 v71, v71, v75, s76 bitop3:0x7e
    v_cmp_ne_u32 vcc, 0, v71
    s_cbranch_vccnz L_slow6_1
    s_branch L_back6_1
L_slow4_0:
    s_mov_b32 s22, 4
    s_call_b64 s[20:21], L_tick
    s_mov_b32 s22, 81920
    s_mov_b32 s23, 87040
    buffer_load_dwordx4 v[100:103], v32, s[12:15], s22 offen sc1
    buffer_load_dwordx4 v[104:107], v32, s[12:15], s23 offen sc1
    s_waitcnt vmcnt(0)
    v_bitop3_b32 v103, v103, v107, s76 bitop3:0x7e
    v_cmp_ne_u32 vcc, 0, v103
    s_cbranch_vccnz L_slow4_0
    s_branch L_back4_0
L_slow4_2:
    s_mov_b32 s22, 4
    s_call_b64 s[20:21], L_tick
    s_mov_b32 s22, 81920
    s_mov_b32 s23, 87040
    buffer_load_dwordx2 v[108:109], v34, s[12:15], s22 offen sc1
    buffer_load_dwordx2 v[110:111], v34, s[12:15], s23 offen sc1
    s_waitcnt vmcnt(0)
    v_bitop3_b32 v109, v109, v111, s76 bitop3:0x7e
    v_cmp_ne_u32 vcc, 0, v109
    s_cbranch_vccnz L_slow4_2
    s_branch L_back4_2
L_slow4_1:
    s_mov_b32 s22, 4
    s_call_b64 s[20:21], L_tick
    s_mov_b32 s22, 81920
    s_mov_b32 s23, 87040
    buffer_load_dwordx4 v[124:127], v33, s[12:15], s22 offen sc1
    buffer_load_dwordx4 v[52:55], v33, s[12:15], s23 offen sc1
    s_waitcnt vmcnt(0)
    v_bitop3_b32 v127, v127, v55, s76 bitop3:0x7e
    v_cmp_ne_u32 vcc, 0, v127
    s_cbranch_vccnz L_slow4_1
    s_branch L_back4_1
L_slow5_0:
    s_mov_b32 s22, 5
    s_call_b64 s[20:21], L_tick
    s_mov_b32 s22, 102400
    s_mov_b32 s23, 107520
    buffer_load_dwordx4 v[76:79], v32, s[12:15], s22 offen sc1
    buffer_load_dwordx4 v[80:83], v32, s[12:15], s23 offen sc1
    s_waitcnt vmcnt(0)
    v_bitop3_b32 v79, v79, v83, s76 bitop3:0x7e
    v_cmp_ne_u32 vcc, 0, v79
    s_cbranch_vccnz L_slow5_0
    s_branch L_back5_0
L_slow7_2:
    s_mov_b32 s22, 7
    s_call_b64 s[20:21], L_tick
    s_mov_b32 s22, 143360
    s_mov_b32 s23, 148480
    buffer_load_dwordx2 v[92:93], v34, s[12:15], s22 offen sc1
    buffer_load_dwordx2 v[94:95], v34, s[12:15], s23 offen sc1
    s_waitcnt vmcnt(0)
    v_bitop3_b32 v93, v93, v95, s76 bitop3:0x7e
    v_cmp_ne_u32 vcc, 0, v93
    s_cbranch_vccnz L_slow7_2
    s_branch L_back7_2
L_slow5_2:
    s_mov_b32 s22, 5
    s_call_b64 s[20:21], L_tick
    s_mov_b32 s22, 102400
    s_mov_b32 s23, 107520
    buffer_load_dwordx2 v[112:113], v34, s[12:15], s22 offen sc1
    buffer_load_dwordx2 v[114:115], v34, s[12:15], s23 offen sc1
    s_waitcnt vmcnt(0)
    v_bitop3_b32 v113, v113, v115, s76 bitop3:0x7e
    v_cmp_ne_u32 vcc, 0, v113
    s_cbranch_vccnz L_slow5_2
    s_branch L_back5_2
L_slow5_1:
    s_mov_b32 s22, 5
    s_call_b64 s[20:21], L_tick
    s_mov_b32 s22, 102400
    s_mov_b32 s23, 107520
    buffer_load_dwordx4 v[84:87], v33, s[12:15], s22 offen sc1
    buffer_load_dwordx4 v[88:91], v33, s[12:15], s23 offen sc1
    s_waitcnt vmcnt(0)
    v_bitop3_b32 v87, v87, v91, s76 bitop3:0x7e
    v_cmp_ne_u32 vcc, 0, v87
    s_cbranch_vccnz L_slow5_1
    s_branch L_back5_1
L_slow7_0:
    s_mov_b32 s22, 7
    s_call_b64 s[20:21], L_tick
    s_mov_b32 s22, 143360
    s_mov_b32 s23, 148480
    buffer_load_dwordx4 v[120:123], v32, s[12:15], s22 offen sc1
    buffer_load_dwordx4 v[116:119], v32, s[12:15], s23 offen sc1
    s_waitcnt vmcnt(0)
    v_bitop3_b32 v123, v123, v119, s76 bitop3:0x7e
    v_cmp_ne_u32 vcc, 0, v123
    s_cbranch_vccnz L_slow7_0
    s_branch L_back7_0
L_slow7_1:
    s_mov_b32 s22, 7
    s_call_b64 s[20:21], L_tick
    s_mov_b32 s22, 143360
    s_mov_b32 s23, 148480
    buffer_load_dwordx4 v[96:99], v33, s[12:15], s22 offen sc1
    buffer_load_dwordx4 v[100:103], v33, s[12:15], s23 offen sc1
    s_waitcnt vmcnt(0)
    v_bitop3_b32 v99, v99, v103, s76 bitop3:0x7e
    v_cmp_ne_u32 vcc, 0, v99
    s_cbranch_vccnz L_slow7_1
    s_branch L_back7_1
L_tick:
    s_add_u32 s52, s52, 1
    s_and_b32 s23, s52, 4095
    s_cbranch_scc1 L_tick_ret
    s_mov_b32 s53, s61
    s_mov_b32 s54, s62
    s_mul_i32 s61, s22, 1835008
    s_add_u32 s61, s61, s79
    s_mul_i32 s62, s22, 20480
    s_mul_i32 s23, s59, 163840
    s_add_u32 s62, s62, s23
    s_mov_b32 s22, 0
L_help_row:
    buffer_load_dwordx4 v[12:15], v19, s[4:7], s61 offen
    buffer_load_dwordx3 v[8:10], v18, s[4:7], s61 offen
    s_waitcnt vmcnt(0)
    v_lshlrev_b32 v12, v5, v12
    v_lshlrev_b32 v13, v5, v13
    v_lshlrev_b32 v14, v5, v14
    v_lshlrev_b32 v15, v5, v15
    v_permlane32_swap_b32 v12, v13
    s_nop 0
    v_permlane32_swap_b32 v14, v15
    v_or_b32 v12, v12, v13
    v_or_b32 v14, v14, v15
    v_mov_b32 v13, s76
    s_nop 0
    v_permlane16_swap_b32 v12, v14
    v_or_b32 v12, v12, v14
    s_nop 1
    v_or_b32_dpp v12, v12, v12 row_ror:8 row_mask:0xf bank_mask:0xf
    buffer_store_dwordx2 v[12:13], v21, s[12:15], s62 offen sc1
    v_mov_b32 v11, s76
    s_mov_b32 s23, 4
L_help_e:
    s_add_u32 s61, s61, 14336
    buffer_load_dwordx3 v[12:14], v18, s[4:7], s61 offen
    s_waitcnt vmcnt(0)
    v_lshl_or_b32 v8, v12, s23, v8
    v_lshl_or_b32 v9, v13, s23, v9
    v_lshl_or_b32 v10, v14, s23, v10
    s_add_u32 s23, s23, 4
    s_cmp_lt_u32 s23, 32
    s_cbranch_scc1 L_help_e
    buffer_store_dwordx4 v[8:11], v20, s[12:15], s62 offen sc1
    s_add_u32 s61, s61, 14336
    s_add_u32 s62, s62, 1280
    s_waitcnt vmcnt(0)
    s_add_u32 s22, s22, 1
    s_cmp_lt_u32 s22, 16
    s_cbranch_scc1 L_help_row
    s_mov_b32 s61, s53
    s_mov_b32 s62, s54
L_tick_ret:
    s_setpc_b64 s[20:21]
L_code_end:

.section .rodata,"a"
.p2align 6
.amdhsa_kernel standalone__normalfloat_lut_af4__prompt_kernel
  .amdhsa_next_free_vgpr 512
  .amdhsa_next_free_sgpr 102
  .amdhsa_accum_offset 256
  .amdhsa_group_segment_fixed_size 0
  .amdhsa_kernarg_size 56
  .amdhsa_user_sgpr_count 2
  .amdhsa_user_sgpr_kernarg_segment_ptr 1
  .amdhsa_system_sgpr_workgroup_id_x 1
.end_amdhsa_kernel
```

```asm
; @launch grid=(256,1,1) block=(256,1,1) lds=163840
.amdgcn_target "amdgcn-amd-amdhsa--gfx950"
.text
.globl standalone__normalfloat_lut_af4__prompt_kernel
.p2align 8
.type standalone__normalfloat_lut_af4__prompt_kernel,@function
standalone__normalfloat_lut_af4__prompt_kernel:
    s_cmp_ge_u32 s2, 256
    s_cbranch_scc1 L_end
    s_load_dwordx2 s[4:5], s[0:1], 8
    s_load_dwordx2 s[12:13], s[0:1], 48
    s_load_dwordx2 s[8:9], s[0:1], 0
    s_load_dwordx2 s[28:29], s[0:1], 16
    s_getpc_b64 s[48:49]
    s_mov_b32 s50, L_code_end-standalone__normalfloat_lut_af4__prompt_kernel-256
    s_mov_b32 s51, 0x20000
    v_lshlrev_b32 v10, 7, v0
    buffer_load_dword v1, v10, s[48:51], 0 offen offset:256
    v_lshrrev_b32 v5, 6, v0
    v_and_b32 v2, 63, v0
    s_and_b32 s60, s2, 7
    s_lshr_b32 s61, s2, 3
    v_readfirstlane_b32 s63, v5
    s_and_b32 s58, s60, 1
    s_lshl_b32 s58, s58, 3
    s_and_b32 s62, s61, 7
    s_add_u32 s58, s58, s62
    s_lshr_b32 s59, s60, 1
    s_lshl_b32 s59, s59, 2
    s_lshr_b32 s62, s61, 3
    s_add_u32 s59, s59, s62
    v_mul_u32_u24 v18, 12, v2
    v_lshrrev_b32 v6, 3, v2
    v_and_b32 v7, 7, v2
    v_mul_u32_u24 v19, 14336, v6
    v_lshl_add_u32 v19, v7, 4, v19
    v_add_u32 v19, 768, v19
    s_lshl_b32 s60, s63, 4
    s_add_u32 s60, s60, s58
    s_mul_i32 s61, s60, 114688
    s_mul_i32 s79, s59, 896
    s_add_u32 s61, s61, s79
    s_mov_b32 s6, 14680064
    s_mov_b32 s7, 0x20000
    s_lshl_b32 s78, s59, 7
    s_add_u32 s78, s78, 2621440
    s_cmp_ge_u32 s63, 2
    s_cselect_b32 s46, 1, 0
    v_and_b32 v4, 15, v2
    v_lshlrev_b32 v8, 1, v4
    v_bfe_u32 v9, v0, 4, 3
    v_lshlrev_b32 v9, 1, v9
    s_mov_b32 s30, 32
    s_mov_b32 s31, 0x20000
    s_cmp_lg_u32 s46, 0
    s_waitcnt lgkmcnt(0)
    s_load_dword s76, s[12:13], s78
    s_cbranch_scc1 L_Y
L_X:
    buffer_load_dwordx4 v[160:163], v19, s[4:7], s61 offen
    buffer_load_dwordx3 v[128:130], v18, s[4:7], s61 offen
    s_add_u32 s61, s61, 14336
    buffer_load_dwordx3 v[132:134], v18, s[4:7], s61 offen
    s_add_u32 s61, s61, 14336
    buffer_load_dwordx3 v[136:138], v18, s[4:7], s61 offen
    s_add_u32 s61, s61, 14336
    buffer_load_dwordx3 v[140:142], v18, s[4:7], s61 offen
    s_add_u32 s61, s61, 14336
    buffer_load_dwordx3 v[144:146], v18, s[4:7], s61 offen
    s_add_u32 s61, s61, 14336
    buffer_load_dwordx3 v[148:150], v18, s[4:7], s61 offen
    s_add_u32 s61, s61, 14336
    buffer_load_dwordx3 v[152:154], v18, s[4:7], s61 offen
    s_add_u32 s61, s61, 14336
    buffer_load_dwordx3 v[156:158], v18, s[4:7], s61 offen
    s_add_u32 s61, s61, 7239680
    s_cmp_eq_u32 s46, 1
    s_cbranch_scc1 L_C
L_L:
    buffer_load_ushort v16, v8, s[28:31], 0 offen
    buffer_load_ushort v17, v9, s[28:31], 0 offen
    buffer_load_ushort v22, v9, s[28:31], 0 offen offset:16
L_Y:
    s_load_dwordx2 s[32:33], s[0:1], 24
    s_load_dwordx2 s[16:17], s[0:1], 32
    s_load_dwordx2 s[24:25], s[0:1], 40
    v_lshrrev_b32 v3, 4, v2
    v_xor_b32 v9, v7, v3
    s_lshl_b32 s70, s63, 5
    v_add_lshl_u32 v8, v6, s70, 11
    v_lshl_add_u32 v36, v9, 4, v8
    v_xor_b32 v37, 64, v36
    v_add_u32 v38, 30720, v36
    v_add_u32 v37, 15360, v37
    v_add_u32 v39, 30720, v37
    s_mov_b32 s10, 4194304
    s_mov_b32 s11, 0x20000
    s_lshl_b32 s55, s58, 18
    s_lshl_b32 s57, s63, 12
    s_add_u32 s57, s57, 65536
    s_add_u32 m0, s57, 32768
    s_add_u32 s56, s55, 0
    buffer_load_dwordx4 v36, s[8:11], s56 offen offset:0 lds
    buffer_load_dwordx4 v37, s[8:11], s56 offen offset:1024 lds
    buffer_load_dwordx4 v38, s[8:11], s56 offen offset:2048 lds
    buffer_load_dwordx4 v39, s[8:11], s56 offen offset:3072 lds
    s_add_u32 m0, s57, 51200
    s_add_u32 s3, s55, 128
    buffer_load_dwordx4 v36, s[8:11], s3 offen offset:0 lds
    buffer_load_dwordx4 v37, s[8:11], s3 offen offset:1024 lds
    s_add_u32 m0, s57, 47104
    s_nop 0
    buffer_load_dwordx4 v38, s[8:11], s3 offen offset:2048 lds
    buffer_load_dwordx4 v39, s[8:11], s3 offen offset:3072 lds
    s_cmp_eq_u32 s46, 1
    s_cbranch_scc1 L_X
L_C:
    s_mov_b32 s14, 2623488
    s_mov_b32 s15, 0x20000
    s_mul_i32 s68, s59, 163840
    s_mul_i32 s62, s60, 1280
    s_add_u32 s62, s62, s68
    v_lshlrev_b32 v5, 2, v6
    v_lshlrev_b32 v20, 4, v2
    v_and_b32 v8, 1, v6
    v_lshlrev_b32 v8, 30, v8
    v_lshl_add_u32 v21, v3, 3, v7
    v_lshl_add_u32 v21, v21, 3, v8
    v_add_u32 v21, 1024, v21
    s_waitcnt lgkmcnt(0)
    s_add_u32 s76, s76, 2654435769
    s_cmp_eq_u32 s46, 1
    s_cbranch_scc1 L_S
L_P:
    s_waitcnt vmcnt(19)
    v_lshlrev_b32 v160, v5, v160
    v_lshlrev_b32 v161, v5, v161
    v_lshlrev_b32 v162, v5, v162
    v_lshlrev_b32 v163, v5, v163
    v_permlane32_swap_b32 v160, v161
    s_nop 0
    v_permlane32_swap_b32 v162, v163
    v_or_b32 v160, v160, v161
    v_or_b32 v162, v162, v163
    v_mov_b32 v161, s76
    s_nop 0
    v_permlane16_swap_b32 v160, v162
    v_or_b32 v160, v160, v162
    s_nop 1
    v_or_b32_dpp v160, v160, v160 row_ror:8 row_mask:0xf bank_mask:0xf
    buffer_store_dwordx2 v[160:161], v21, s[12:15], s62 offen sc1
    v_mov_b32 v131, s76
    s_waitcnt vmcnt(18)
    v_lshl_or_b32 v128, v132, 4, v128
    v_lshl_or_b32 v129, v133, 4, v129
    v_lshl_or_b32 v130, v134, 4, v130
    s_waitcnt vmcnt(17)
    v_lshl_or_b32 v128, v136, 8, v128
    v_lshl_or_b32 v129, v137, 8, v129
    v_lshl_or_b32 v130, v138, 8, v130
    s_waitcnt vmcnt(16)
    v_lshl_or_b32 v128, v140, 12, v128
    v_lshl_or_b32 v129, v141, 12, v129
    v_lshl_or_b32 v130, v142, 12, v130
    s_waitcnt vmcnt(15)
    v_lshl_or_b32 v128, v144, 16, v128
    v_lshl_or_b32 v129, v145, 16, v129
    v_lshl_or_b32 v130, v146, 16, v130
    s_waitcnt vmcnt(14)
    v_lshl_or_b32 v128, v148, 20, v128
    v_lshl_or_b32 v129, v149, 20, v129
    v_lshl_or_b32 v130, v150, 20, v130
    s_waitcnt vmcnt(13)
    v_lshl_or_b32 v128, v152, 24, v128
    v_lshl_or_b32 v129, v153, 24, v129
    v_lshl_or_b32 v130, v154, 24, v130
    s_waitcnt vmcnt(12)
    v_lshl_or_b32 v128, v156, 28, v128
    v_lshl_or_b32 v129, v157, 28, v129
    v_lshl_or_b32 v130, v158, 28, v130
    buffer_store_dwordx4 v[128:131], v20, s[12:15], s62 offen sc1
    s_add_u32 s62, s62, 81920
    s_cmp_eq_u32 s46, 1
    s_cbranch_scc1 L_A
L_T:
    v_lshlrev_b32 v8, 4, v7
    v_and_b32 v9, 127, v0
    v_lshl_add_u32 v8, v9, 8, v8
    v_xor_b32 v9, 16, v8
    v_xor_b32 v10, 32, v8
    v_xor_b32 v11, 48, v8
    v_xor_b32 v12, 64, v8
    v_xor_b32 v13, 80, v8
    v_xor_b32 v14, 96, v8
    v_xor_b32 v15, 112, v8
    s_waitcnt vmcnt(11)
    v_lshl_or_b32 v56, v17, 16, v16
    v_lshl_or_b32 v57, v17, 16, v16
    v_lshl_or_b32 v58, v17, 16, v16
    v_lshl_or_b32 v59, v17, 16, v16
    s_waitcnt vmcnt(10)
    v_lshl_or_b32 v60, v22, 16, v16
    v_lshl_or_b32 v61, v22, 16, v16
    v_lshl_or_b32 v62, v22, 16, v16
    v_lshl_or_b32 v63, v22, 16, v16
    ds_write_b128 v8, v[56:59]
    ds_write_b128 v9, v[56:59]
    ds_write_b128 v10, v[56:59]
    ds_write_b128 v11, v[56:59]
    ds_write_b128 v12, v[56:59]
    ds_write_b128 v13, v[56:59]
    ds_write_b128 v14, v[56:59]
    ds_write_b128 v15, v[56:59]
    ds_write_b128 v8, v[60:63] offset:32768
    ds_write_b128 v9, v[60:63] offset:32768
    ds_write_b128 v10, v[60:63] offset:32768
    ds_write_b128 v11, v[60:63] offset:32768
    ds_write_b128 v12, v[60:63] offset:32768
    ds_write_b128 v13, v[60:63] offset:32768
    ds_write_b128 v14, v[60:63] offset:32768
    ds_write_b128 v15, v[60:63] offset:32768
    s_mov_b64 exec, 0
    s_cmp_eq_u32 s63, 0
    s_cbranch_scc1 L_pad0
    s_cmp_eq_u32 s63, 1
    s_cbranch_scc1 L_pad3
L_warmed:
    s_mov_b64 exec, -1
L_S:
    s_and_b32 s64, s63, 1
    s_lshr_b32 s65, s63, 1
    s_mul_i32 s69, s64, 10240
    v_mul_u32_u24 v14, 1280, v3
    s_lshl_b32 s70, s63, 8
    s_add_u32 s70, s70, s68
    v_lshl_add_u32 v33, v4, 4, v14
    s_add_u32 s71, s70, s69
    v_add_u32 v32, s71, v33
    s_sub_u32 s71, 10240, s69
    s_add_u32 s71, s71, s70
    v_add_u32 v33, s71, v33
    v_and_b32 v15, 1, v4
    v_lshlrev_b32 v15, 7, v15
    v_and_b32 v31, 2, v4
    v_lshl_add_u32 v15, v31, 5, v15
    v_lshrrev_b32 v31, 2, v4
    v_lshl_add_u32 v15, v31, 3, v15
    s_lshl_b32 s70, s65, 5
    s_add_u32 s70, s70, s68
    s_add_u32 s70, s70, s69
    s_add_u32 s70, s70, 1024
    v_add3_u32 v34, v14, v15, s70
    s_mov_b32 s36, 202114048
    s_mov_b32 s37, 202114304
    s_mov_b32 s38, 202114560
    s_mov_b32 s39, 202114816
    v_and_b32 v35, 31, v2
    v_lshlrev_b32 v35, 2, v35
    v_lshrrev_b32 v14, 1, v4
    v_xor_b32 v14, v14, v3
    v_lshlrev_b32 v14, 4, v14
    v_lshl_add_u32 v14, v4, 7, v14
    s_lshl_b32 s70, s64, 14
    s_add_u32 s72, s70, 65536
    s_sub_u32 s73, 81920, s70
    v_add_u32 v40, s72, v14
    v_add_u32 v42, s73, v14
    v_xor_b32 v41, 64, v40
    v_xor_b32 v43, 64, v42
    v_add_u32 v44, 65536, v40
    v_add_u32 v45, 65536, v41
    v_add_u32 v46, 65536, v42
    v_add_u32 v47, 65536, v43
    s_mov_b32 s52, 0
    s_mov_b32 s40, 0
    s_mov_b32 s41, 5120
    s_mov_b32 s42, 0
    s_mov_b32 s43, 5120
    s_mov_b32 s44, 0
    s_mov_b32 s45, 5120
    s_mul_i32 s66, s63, 96
    s_lshl_b32 s67, s65, 5
    s_add_u32 s67, s67, 384
    s_mul_i32 s71, s59, 448
    s_add_u32 s70, s66, s71
    v_mad_u32_u24 v22, v3, 24, s70
    s_add_u32 s70, s67, s71
    v_lshl_add_u32 v23, v3, 3, s70
    s_mov_b32 s34, 7168
    s_mov_b32 s35, 0x20000
    s_mov_b32 s26, 256
    s_mov_b32 s27, 0x20000
    s_lshl_b32 s77, s59, 4
    s_mov_b32 s18, 14680064
    s_mov_b32 s19, 0x20000
    v_mul_u32_u24 v16, 464, v4
    s_mul_i32 s70, s64, 7424
    v_mad_u32_u24 v17, v3, 24, v16
    s_add_u32 s74, s66, s70
    v_add_u32 v26, s74, v17
    s_sub_u32 s74, 7424, s70
    s_add_u32 s74, s74, s66
    v_add_u32 v27, s74, v17
    s_add_u32 s74, s67, s70
    v_lshl_add_u32 v28, v3, 3, v16
    v_add_u32 v28, s74, v28
    v_lshlrev_b32 v29, 4, v0
    v_add_u32 v29, 65536, v29
    v_xor_b32 v30, 1024, v29
    v_mul_u32_u24 v16, 2341, v2
    v_lshrrev_b32 v16, 16, v16
    s_mul_i32 s73, s63, 3712
    v_add_lshl_u32 v24, v2, v16, 4
    v_add_u32 v24, s73, v24
    s_lshl_b32 s74, s58, 7
    s_lshl_b32 s75, s63, 3
    s_add_u32 s74, s74, s75
    s_mul_i32 s74, s74, 7168
    s_add_u32 s74, s74, s71
    v_mul_u32_u24 v17, 6720, v16
    v_lshl_add_u32 v25, v2, 4, v17
    v_lshrrev_b32 v16, 1, v16
    v_lshlrev_b32 v16, 30, v16
    v_add3_u32 v25, v25, v16, s74
    s_waitcnt vmcnt(9)
    s_cmp_eq_u32 s46, 0
    s_cbranch_scc1 L_W0
    s_waitcnt vmcnt(1)
    s_branch L_B
L_W0:
    s_waitcnt vmcnt(2)
L_B:
    s_waitcnt lgkmcnt(0)
    s_barrier
    buffer_load_dwordx4 v[64:67], v32, s[12:15], s40 offen sc1
    buffer_load_dwordx4 v[68:71], v32, s[12:15], s41 offen sc1
    buffer_load_dwordx2 v[72:73], v34, s[12:15], s42 offen sc1
    buffer_load_dwordx2 v[74:75], v34, s[12:15], s43 offen sc1
    buffer_load_dwordx4 v[76:79], v33, s[12:15], s44 offen sc1
    buffer_load_dwordx4 v[80:83], v33, s[12:15], s45 offen sc1
    ds_read_b128 a[0:3], v40 offset:32768
    ds_read_b128 a[4:7], v41 offset:32768
    ds_read_b128 a[8:11], v40 offset:34816
    ds_read_b128 a[12:15], v41 offset:34816
    ds_read_b128 a[16:19], v40 offset:36864
    ds_read_b128 a[20:23], v41 offset:36864
    ds_read_b128 a[24:27], v40 offset:38912
    ds_read_b128 a[28:31], v41 offset:38912
    ds_read_b128 a[36:39], v40 offset:40960
    ds_read_b128 a[40:43], v41 offset:40960
    ds_read_b128 a[44:47], v40 offset:43008
    ds_read_b128 a[52:55], v41 offset:43008
    ds_read_b128 a[56:59], v40 offset:45056
    ds_read_b128 a[64:67], v41 offset:45056
    ds_read_b128 a[68:71], v40 offset:47104
    ds_read_b128 a[72:75], v41 offset:47104
    s_cmp_eq_u32 s46, 0
    s_cbranch_scc1 L_A
    s_waitcnt vmcnt(6)
    s_branch L_P
L_A:
    s_add_u32 m0, s57, 65536
    s_add_u32 s56, s55, 256
    buffer_load_dwordx4 v36, s[8:11], s56 offen offset:0 lds
    buffer_load_dwordx4 v37, s[8:11], s56 offen offset:1024 lds
    buffer_load_dwordx4 v38, s[8:11], s56 offen offset:2048 lds
    buffer_load_dwordx4 v39, s[8:11], s56 offen offset:3072 lds
    s_add_u32 m0, s57, 83968
    s_add_u32 s3, s55, 384
    buffer_load_dwordx4 v36, s[8:11], s3 offen offset:0 lds
    buffer_load_dwordx4 v37, s[8:11], s3 offen offset:1024 lds
    s_add_u32 m0, s57, 79872
    s_nop 0
    buffer_load_dwordx4 v38, s[8:11], s3 offen offset:2048 lds
    buffer_load_dwordx4 v39, s[8:11], s3 offen offset:3072 lds
    s_waitcnt vmcnt(12)
    v_bitop3_b32 v67, v67, v71, s76 bitop3:0x7e
    v_cmp_ne_u32 vcc, 0, v67
    s_cbranch_vccnz L_slow0_0
L_back0_0:
    v_perm_b32 v56, v64, v35, s36
    v_perm_b32 v57, v64, v35, s37
    v_perm_b32 v58, v64, v35, s38
    v_perm_b32 v59, v64, v35, s39
    v_perm_b32 v60, v68, v35, s36
    v_perm_b32 v61, v68, v35, s37
    v_perm_b32 v62, v68, v35, s38
    v_perm_b32 v63, v68, v35, s39
    ds_read_b32 a32, v56
    ds_read_b32 a33, v57
    ds_read_b32 a34, v58
    ds_read_b32 a35, v59
    ds_read_b32 a48, v60
    ds_read_b32 a49, v61
    ds_read_b32 a50, v62
    ds_read_b32 a51, v63
    v_perm_b32 v56, v65, v35, s36
    v_perm_b32 v57, v65, v35, s37
    v_perm_b32 v58, v65, v35, s38
    v_perm_b32 v59, v65, v35, s39
    v_perm_b32 v60, v69, v35, s36
    ds_read_b32 a60, v56
    ds_read_b32 a61, v57
    ds_read_b32 a62, v58
    ds_read_b32 a63, v59
    s_branch L_main
.p2align 12
L_main:
L_pad0:
    s_cbranch_execz L_pad1
    s_waitcnt lgkmcnt(8)
    v_mfma_f32_16x16x32_bf16 v[128:131], a[32:35], a[0:3], 0
    s_waitcnt lgkmcnt(4)
    ds_read_b32 a76, v60
    v_perm_b32 v61, v69, v35, s37
    v_mfma_f32_16x16x32_bf16 v[128:131], a[48:51], a[4:7], v[128:131]
    ds_read_b128 a[80:83], v42 offset:34816
    v_mfma_f32_16x16x32_bf16 v[132:135], a[32:35], a[8:11], 0
    ds_read_b32 a77, v61
    v_perm_b32 v62, v69, v35, s38
    v_mfma_f32_16x16x32_bf16 v[132:135], a[48:51], a[12:15], v[132:135]
    v_mfma_f32_16x16x32_bf16 v[136:139], a[32:35], a[16:19], 0
    s_mov_b32 s40, 20480
    ds_read_b32 a78, v62
    v_perm_b32 v63, v69, v35, s39
    v_mfma_f32_16x16x32_bf16 v[136:139], a[48:51], a[20:23], v[136:139]
    ds_read_b128 a[84:87], v43 offset:34816
    v_mfma_f32_16x16x32_bf16 v[140:143], a[32:35], a[24:27], 0
    ds_read_b32 a79, v63
    v_perm_b32 v56, v66, v35, s36
    v_mfma_f32_16x16x32_bf16 v[140:143], a[48:51], a[28:31], v[140:143]
    ds_read_b128 a[88:91], v42 offset:32768
    v_mfma_f32_16x16x32_bf16 v[144:147], a[32:35], a[36:39], 0
    buffer_load_dwordx4 v[84:87], v32, s[12:15], s40 offen sc1
    v_mfma_f32_16x16x32_bf16 v[144:147], a[48:51], a[40:43], v[144:147]
    s_mov_b32 s41, 25600
    ds_read_b32 a92, v56
    v_perm_b32 v57, v66, v35, s37
    v_mfma_f32_16x16x32_bf16 v[148:151], a[32:35], a[44:47], 0
    ds_read_b32 a93, v57
    v_perm_b32 v58, v66, v35, s38
    v_mfma_f32_16x16x32_bf16 v[148:151], a[48:51], a[52:55], v[148:151]
    ds_read_b128 a[96:99], v43 offset:32768
    v_mfma_f32_16x16x32_bf16 v[152:155], a[32:35], a[56:59], 0
    buffer_load_dwordx4 v[88:91], v32, s[12:15], s41 offen sc1
    v_mfma_f32_16x16x32_bf16 v[152:155], a[48:51], a[64:67], v[152:155]
    s_waitcnt vmcnt(12)
    ds_read_b32 a94, v58
    v_bitop3_b32 v73, v73, v75, s76 bitop3:0x7e
    v_mfma_f32_16x16x32_bf16 v[156:159], a[32:35], a[68:71], 0
    v_cmp_ne_u32 vcc, 0, v73
    v_perm_b32 v59, v66, v35, s39
    v_mfma_f32_16x16x32_bf16 v[156:159], a[48:51], a[72:75], v[156:159]
    s_waitcnt lgkmcnt(5)
    ds_read_b32 a95, v59
    ds_read_b128 a[100:103], v42 offset:38912
    v_mfma_f32_16x16x32_bf16 v[160:163], a[60:63], a[0:3], 0
    buffer_load_dwordx4 v[92:95], v19, s[4:7], s61 offen
    v_mfma_f32_16x16x32_bf16 v[160:163], a[76:79], a[4:7], v[160:163]
    v_perm_b32 v60, v70, v35, s36
    s_cbranch_vccnz L_slow0_2
L_back0_2:
    v_mfma_f32_16x16x32_bf16 v[164:167], a[60:63], a[8:11], 0
    ds_read_b32 a104, v60
    v_perm_b32 v61, v70, v35, s37
    v_mfma_f32_16x16x32_bf16 v[164:167], a[76:79], a[12:15], v[164:167]
    ds_read_b32 a105, v61
    v_perm_b32 v62, v70, v35, s38
    v_mfma_f32_16x16x32_bf16 v[168:171], a[60:63], a[16:19], 0
    ds_read_b128 a[108:111], v43 offset:38912
    v_perm_b32 v63, v70, v35, s39
    v_mfma_f32_16x16x32_bf16 v[168:171], a[76:79], a[20:23], v[168:171]
    ds_read_b32 a106, v62
    ds_read_b128 a[112:115], v42 offset:36864
    v_mfma_f32_16x16x32_bf16 v[172:175], a[60:63], a[24:27], 0
    buffer_load_dwordx3 v[96:98], v18, s[4:7], s61 offen
    v_mfma_f32_16x16x32_bf16 v[172:175], a[76:79], a[28:31], v[172:175]
    s_add_u32 s61, s61, 14336
    ds_read_b32 a107, v63
    v_perm_b32 v56, v72, v35, s36
    v_mfma_f32_16x16x32_bf16 v[176:179], a[60:63], a[36:39], 0
    s_mov_b32 s42, 20480
    ds_read_b32 a116, v56
    v_perm_b32 v57, v72, v35, s37
    v_mfma_f32_16x16x32_bf16 v[176:179], a[76:79], a[40:43], v[176:179]
    s_mov_b32 s43, 25600
    ds_read_b128 a[120:123], v43 offset:36864
    v_mfma_f32_16x16x32_bf16 v[180:183], a[60:63], a[44:47], 0
    buffer_load_dwordx2 v[100:101], v34, s[12:15], s42 offen sc1
    v_mfma_f32_16x16x32_bf16 v[180:183], a[76:79], a[52:55], v[180:183]
    ds_read_b32 a117, v57
    v_perm_b32 v58, v72, v35, s38
    v_mfma_f32_16x16x32_bf16 v[184:187], a[60:63], a[56:59], 0
    s_waitcnt vmcnt(13)
    ds_read_b128 a[124:127], v42 offset:43008
    v_bitop3_b32 v79, v79, v83, s76 bitop3:0x7e
    v_mfma_f32_16x16x32_bf16 v[184:187], a[76:79], a[64:67], v[184:187]
    ds_read_b32 a118, v58
    ds_read_b128 a[128:131], v43 offset:43008
    v_mfma_f32_16x16x32_bf16 v[188:191], a[60:63], a[68:71], 0
    buffer_load_dwordx2 v[102:103], v34, s[12:15], s43 offen sc1
    v_mfma_f32_16x16x32_bf16 v[188:191], a[76:79], a[72:75], v[188:191]
    s_waitcnt lgkmcnt(7)
    v_cmp_ne_u32 vcc, 0, v79
    v_perm_b32 v59, v72, v35, s39
    v_mfma_f32_16x16x32_bf16 v[192:195], a[92:95], a[0:3], 0
    s_waitcnt lgkmcnt(6)
    ds_read_b32 a119, v59
    v_perm_b32 v60, v74, v35, s36
    v_mfma_f32_16x16x32_bf16 v[192:195], a[104:107], a[4:7], v[192:195]
    ds_read_b32 a132, v60
    s_cbranch_vccnz L_slow0_1
L_back0_1:
    v_mfma_f32_16x16x32_bf16 v[196:199], a[92:95], a[8:11], 0
    ds_read_b128 a[136:139], v42 offset:40960
    v_perm_b32 v61, v74, v35, s37
    v_mfma_f32_16x16x32_bf16 v[196:199], a[104:107], a[12:15], v[196:199]
    ds_read_b32 a133, v61
    ds_read_b128 a[140:143], v43 offset:40960
    v_mfma_f32_16x16x32_bf16 v[200:203], a[92:95], a[16:19], 0
    buffer_load_dwordx3 v[104:106], v18, s[4:7], s61 offen
    v_mfma_f32_16x16x32_bf16 v[200:203], a[104:107], a[20:23], v[200:203]
    s_add_u32 s61, s61, 14336
    v_perm_b32 v62, v74, v35, s38
    v_perm_b32 v63, v74, v35, s39
    v_mfma_f32_16x16x32_bf16 v[204:207], a[92:95], a[24:27], 0
    s_add_u32 s56, s55, 512
    ds_read_b32 a134, v62
    ds_read_b32 a135, v63
    v_mfma_f32_16x16x32_bf16 v[204:207], a[104:107], a[28:31], v[204:207]
    s_mov_b32 s44, 20480
    ds_read_b128 a[144:147], v42 offset:47104
    v_perm_b32 v56, v76, v35, s36
    v_mfma_f32_16x16x32_bf16 v[208:211], a[92:95], a[36:39], 0
    s_add_u32 m0, s57, 0
    ds_read_b32 a148, v56
    v_perm_b32 v57, v76, v35, s37
    v_mfma_f32_16x16x32_bf16 v[208:211], a[104:107], a[40:43], v[208:211]
    s_mov_b32 s45, 25600
    ds_read_b128 a[152:155], v43 offset:47104
    v_mfma_f32_16x16x32_bf16 v[212:215], a[92:95], a[44:47], 0
    buffer_load_dwordx4 v[108:111], v33, s[12:15], s44 offen sc1
    v_mfma_f32_16x16x32_bf16 v[212:215], a[104:107], a[52:55], v[212:215]
    ds_read_b32 a149, v57
    v_perm_b32 v58, v76, v35, s38
    v_mfma_f32_16x16x32_bf16 v[216:219], a[92:95], a[56:59], 0
    ds_read_b32 a150, v58
    v_mov_b32 v99, s76
    v_mfma_f32_16x16x32_bf16 v[216:219], a[104:107], a[64:67], v[216:219]
    ds_read_b128 a[156:159], v42 offset:45056
    v_mfma_f32_16x16x32_bf16 v[220:223], a[92:95], a[68:71], 0
    buffer_load_dwordx4 v[112:115], v33, s[12:15], s45 offen sc1
    v_mfma_f32_16x16x32_bf16 v[220:223], a[104:107], a[72:75], v[220:223]
    s_waitcnt lgkmcnt(6)
    v_perm_b32 v59, v76, v35, s39
    v_perm_b32 v60, v80, v35, s36
    v_mfma_f32_16x16x32_bf16 v[224:227], a[116:119], a[0:3], 0
    ds_read_b32 a151, v59
    ds_read_b32 a160, v60
    v_mfma_f32_16x16x32_bf16 v[224:227], a[132:135], a[4:7], v[224:227]
    ds_read_b128 a[164:167], v43 offset:45056
    v_mfma_f32_16x16x32_bf16 v[228:231], a[116:119], a[8:11], 0
    buffer_load_dwordx3 v[116:118], v18, s[4:7], s61 offen
    v_mfma_f32_16x16x32_bf16 v[228:231], a[132:135], a[12:15], v[228:231]
    s_add_u32 s61, s61, 14336
    v_perm_b32 v61, v80, v35, s37
    v_perm_b32 v62, v80, v35, s38
    v_mfma_f32_16x16x32_bf16 v[232:235], a[116:119], a[16:19], 0
    ds_read_b32 a161, v61
    v_perm_b32 v63, v80, v35, s39
    v_mfma_f32_16x16x32_bf16 v[232:235], a[132:135], a[20:23], v[232:235]
    ds_read_b32 a162, v62
    v_mfma_f32_16x16x32_bf16 v[236:239], a[116:119], a[24:27], 0
    buffer_load_dwordx4 v36, s[8:11], s56 offen offset:0 lds
    v_mfma_f32_16x16x32_bf16 v[236:239], a[132:135], a[28:31], v[236:239]
    ds_read_b32 a163, v63
    v_perm_b32 v56, v77, v35, s36
    v_mfma_f32_16x16x32_bf16 v[240:243], a[116:119], a[36:39], 0
    ds_read_b32 a168, v56
    v_perm_b32 v57, v77, v35, s37
    v_mfma_f32_16x16x32_bf16 v[240:243], a[132:135], a[40:43], v[240:243]
    v_mfma_f32_16x16x32_bf16 v[244:247], a[116:119], a[44:47], 0
    buffer_load_dwordx4 v37, s[8:11], s56 offen offset:1024 lds
    v_mfma_f32_16x16x32_bf16 v[244:247], a[132:135], a[52:55], v[244:247]
    ds_read_b32 a169, v57
    v_perm_b32 v58, v77, v35, s38
    v_mfma_f32_16x16x32_bf16 v[248:251], a[116:119], a[56:59], 0
    s_add_u32 s3, s55, 640
    ds_read_b32 a170, v58
    v_perm_b32 v59, v77, v35, s39
    v_mfma_f32_16x16x32_bf16 v[248:251], a[132:135], a[64:67], v[248:251]
    v_mfma_f32_16x16x32_bf16 v[252:255], a[116:119], a[68:71], 0
    buffer_load_dwordx4 v38, s[8:11], s56 offen offset:2048 lds
    v_mfma_f32_16x16x32_bf16 v[252:255], a[132:135], a[72:75], v[252:255]
    s_waitcnt lgkmcnt(4)
    ds_read_b32 a171, v59
    v_perm_b32 v60, v81, v35, s36
    v_mfma_f32_16x16x32_bf16 v[128:131], a[148:151], a[80:83], v[128:131]
    s_waitcnt lgkmcnt(4)
    ds_read_b32 a172, v60
    v_perm_b32 v61, v81, v35, s37
    v_mfma_f32_16x16x32_bf16 v[128:131], a[160:163], a[84:87], v[128:131]
    s_waitcnt vmcnt(13)
    v_mfma_f32_16x16x32_bf16 v[132:135], a[148:151], a[88:91], v[132:135]
    buffer_load_dwordx3 v[120:122], v18, s[4:7], s61 offen
    v_mfma_f32_16x16x32_bf16 v[132:135], a[160:163], a[96:99], v[132:135]
    s_barrier
    v_mfma_f32_16x16x32_bf16 v[136:139], a[148:151], a[100:103], v[136:139]
    s_add_u32 s61, s61, 14336
    v_perm_b32 v62, v81, v35, s38
    v_perm_b32 v63, v81, v35, s39
    v_mfma_f32_16x16x32_bf16 v[136:139], a[160:163], a[108:111], v[136:139]
    ds_read_b32 a173, v61
    ds_read_b32 a174, v62
    v_mfma_f32_16x16x32_bf16 v[140:143], a[148:151], a[112:115], v[140:143]
    buffer_load_dwordx4 v39, s[8:11], s56 offen offset:3072 lds
    v_mfma_f32_16x16x32_bf16 v[140:143], a[160:163], a[120:123], v[140:143]
    s_add_u32 m0, s57, 18432
    ds_read_b32 a175, v63
    ds_read_b128 a[176:179], v44 offset:0
    v_mfma_f32_16x16x32_bf16 v[144:147], a[148:151], a[124:127], v[144:147]
    ds_read_b128 a[180:183], v45 offset:0
    v_perm_b32 v56, v78, v35, s36
    v_mfma_f32_16x16x32_bf16 v[144:147], a[160:163], a[128:131], v[144:147]
    ds_read_b32 a188, v56
    ds_read_b128 a[184:187], v44 offset:2048
    v_mfma_f32_16x16x32_bf16 v[148:151], a[148:151], a[136:139], v[148:151]
    buffer_load_dwordx4 v36, s[8:11], s3 offen offset:0 lds
    v_mfma_f32_16x16x32_bf16 v[148:151], a[160:163], a[140:143], v[148:151]
    v_perm_b32 v57, v78, v35, s37
    v_perm_b32 v58, v78, v35, s38
    v_mfma_f32_16x16x32_bf16 v[152:155], a[148:151], a[144:147], v[152:155]
    s_waitcnt vmcnt(14)
    ds_read_b32 a189, v57
    v_bitop3_b32 v87, v87, v91, s76 bitop3:0x7e
    v_mfma_f32_16x16x32_bf16 v[152:155], a[160:163], a[152:155], v[152:155]
    s_waitcnt lgkmcnt(8)
    ds_read_b32 a190, v58
    ds_read_b128 a[192:195], v45 offset:2048
    v_mfma_f32_16x16x32_bf16 v[156:159], a[148:151], a[156:159], v[156:159]
    buffer_load_dwordx3 v[124:126], v18, s[4:7], s61 offen
    v_mfma_f32_16x16x32_bf16 v[156:159], a[160:163], a[164:167], v[156:159]
    s_add_u32 s61, s61, 14336
    v_cmp_ne_u32 vcc, 0, v87
    v_perm_b32 v59, v78, v35, s39
    v_mfma_f32_16x16x32_bf16 v[160:163], a[168:171], a[80:83], v[160:163]
    s_waitcnt lgkmcnt(6)
    ds_read_b32 a191, v59
    v_perm_b32 v60, v82, v35, s36
    v_mfma_f32_16x16x32_bf16 v[160:163], a[172:175], a[84:87], v[160:163]
    ds_read_b128 a[196:199], v44 offset:4096
    s_cbranch_vccnz L_slow1_0
L_back1_0:
    v_mfma_f32_16x16x32_bf16 v[164:167], a[168:171], a[88:91], v[164:167]
    buffer_load_dwordx4 v37, s[8:11], s3 offen offset:1024 lds
    v_mfma_f32_16x16x32_bf16 v[164:167], a[172:175], a[96:99], v[164:167]
    s_add_u32 m0, s57, 14336
    ds_read_b32 a200, v60
    v_perm_b32 v61, v82, v35, s37
    v_mfma_f32_16x16x32_bf16 v[168:171], a[168:171], a[100:103], v[168:171]
    v_perm_b32 v62, v82, v35, s38
    v_perm_b32 v63, v82, v35, s39
    v_mfma_f32_16x16x32_bf16 v[168:171], a[172:175], a[108:111], v[168:171]
    ds_read_b32 a201, v61
    ds_read_b32 a202, v62
    v_mfma_f32_16x16x32_bf16 v[172:175], a[168:171], a[112:115], v[172:175]
    buffer_load_dwordx4 v38, s[8:11], s3 offen offset:2048 lds
    v_mfma_f32_16x16x32_bf16 v[172:175], a[172:175], a[120:123], v[172:175]
    s_mov_b32 s40, 40960
    ds_read_b32 a203, v63
    ds_read_b128 a[204:207], v45 offset:4096
    v_mfma_f32_16x16x32_bf16 v[176:179], a[168:171], a[124:127], v[176:179]
    ds_read_b128 a[208:211], v44 offset:6144
    v_perm_b32 v56, v84, v35, s36
    v_mfma_f32_16x16x32_bf16 v[176:179], a[172:175], a[128:131], v[176:179]
    s_mov_b32 s41, 46080
    ds_read_b32 a216, v56
    ds_read_b128 a[212:215], v45 offset:6144
    v_mfma_f32_16x16x32_bf16 v[180:183], a[168:171], a[136:139], v[180:183]
    buffer_load_dwordx4 v[48:51], v32, s[12:15], s40 offen sc1
    v_mfma_f32_16x16x32_bf16 v[180:183], a[172:175], a[140:143], v[180:183]
    v_perm_b32 v57, v84, v35, s37
    v_perm_b32 v58, v84, v35, s38
    v_mfma_f32_16x16x32_bf16 v[184:187], a[168:171], a[144:147], v[184:187]
    ds_read_b32 a217, v57
    ds_read_b128 a[220:223], v44 offset:8192
    v_mfma_f32_16x16x32_bf16 v[184:187], a[172:175], a[152:155], v[184:187]
    ds_read_b32 a218, v58
    ds_read_b128 a[224:227], v45 offset:8192
    v_mfma_f32_16x16x32_bf16 v[188:191], a[168:171], a[156:159], v[188:191]
    buffer_load_dwordx4 v[52:55], v32, s[12:15], s41 offen sc1
    v_mfma_f32_16x16x32_bf16 v[188:191], a[172:175], a[164:167], v[188:191]
    s_waitcnt lgkmcnt(9)
    v_perm_b32 v59, v84, v35, s39
    v_perm_b32 v60, v88, v35, s36
    v_mfma_f32_16x16x32_bf16 v[192:195], a[188:191], a[80:83], v[192:195]
    s_waitcnt vmcnt(18) lgkmcnt(7)
    ds_read_b32 a219, v59
    v_lshlrev_b32 v92, v5, v92
    v_mfma_f32_16x16x32_bf16 v[192:195], a[200:203], a[84:87], v[192:195]
    ds_read_b32 a232, v60
    ds_read_b128 a[228:231], v44 offset:10240
    v_mfma_f32_16x16x32_bf16 v[196:199], a[188:191], a[88:91], v[196:199]
    buffer_load_dwordx3 v[64:66], v18, s[4:7], s61 offen
    v_mfma_f32_16x16x32_bf16 v[196:199], a[200:203], a[96:99], v[196:199]
    s_add_u32 s61, s61, 14336
    v_lshlrev_b32 v93, v5, v93
    v_lshlrev_b32 v94, v5, v94
    v_mfma_f32_16x16x32_bf16 v[200:203], a[188:191], a[100:103], v[200:203]
    v_perm_b32 v61, v88, v35, s37
    v_perm_b32 v62, v88, v35, s38
    v_mfma_f32_16x16x32_bf16 v[200:203], a[200:203], a[108:111], v[200:203]
    ds_read_b32 a233, v61
    ds_read_b32 a234, v62
    v_mfma_f32_16x16x32_bf16 v[204:207], a[188:191], a[112:115], v[204:207]
    buffer_load_dwordx4 v39, s[8:11], s3 offen offset:3072 lds
    v_mfma_f32_16x16x32_bf16 v[204:207], a[200:203], a[120:123], v[204:207]
    v_perm_b32 v63, v88, v35, s39
    v_lshlrev_b32 v95, v5, v95
    v_mfma_f32_16x16x32_bf16 v[208:211], a[188:191], a[124:127], v[208:211]
    ds_read_b32 a235, v63
    ds_read_b128 a[236:239], v45 offset:10240
    v_mfma_f32_16x16x32_bf16 v[208:211], a[200:203], a[128:131], v[208:211]
    ds_read_b128 a[240:243], v44 offset:12288
    v_mfma_f32_16x16x32_bf16 v[212:215], a[188:191], a[136:139], v[212:215]
    buffer_load_dwordx3 v[68:70], v18, s[4:7], s61 offen
    v_mfma_f32_16x16x32_bf16 v[212:215], a[200:203], a[140:143], v[212:215]
    s_add_u32 s61, s61, 14336
    v_permlane32_swap_b32 v92, v93
    v_permlane32_swap_b32 v94, v95
    v_mfma_f32_16x16x32_bf16 v[216:219], a[188:191], a[144:147], v[216:219]
    v_or_b32 v92, v92, v93
    v_or_b32 v94, v94, v95
    v_mfma_f32_16x16x32_bf16 v[216:219], a[200:203], a[152:155], v[216:219]
    v_mov_b32 v93, s76
    v_perm_b32 v56, v85, v35, s36
    v_mfma_f32_16x16x32_bf16 v[220:223], a[188:191], a[156:159], v[220:223]
    s_waitcnt vmcnt(17)
    v_lshl_or_b32 v96, v104, 4, v96
    v_lshl_or_b32 v97, v105, 4, v97
    v_mfma_f32_16x16x32_bf16 v[220:223], a[200:203], a[164:167], v[220:223]
    s_waitcnt lgkmcnt(3)
    v_permlane16_swap_b32 v92, v94
    v_or_b32 v92, v92, v94
    v_mfma_f32_16x16x32_bf16 v[128:131], a[216:219], a[176:179], v[128:131]
    s_waitcnt lgkmcnt(2)
    ds_read_b32 a244, v56
    v_lshl_or_b32 v98, v106, 4, v98
    v_mfma_f32_16x16x32_bf16 v[128:131], a[232:235], a[180:183], v[128:131]
    ds_read_b128 a[248:251], v45 offset:12288
    v_or_b32_dpp v92, v92, v92 row_ror:8 row_mask:0xf bank_mask:0xf
    v_perm_b32 v57, v85, v35, s37
    v_mfma_f32_16x16x32_bf16 v[132:135], a[216:219], a[184:187], v[132:135]
    ds_read_b128 a[252:255], v44 offset:14336
    ds_read_b32 a245, v57
    v_mfma_f32_16x16x32_bf16 v[132:135], a[232:235], a[192:195], v[132:135]
    buffer_store_dwordx2 v[92:93], v21, s[12:15], s62 offen sc1
    v_mfma_f32_16x16x32_bf16 v[136:139], a[216:219], a[196:199], v[136:139]
    ds_read_b128 a[32:35], v45 offset:14336
    v_perm_b32 v58, v85, v35, s38
    v_mfma_f32_16x16x32_bf16 v[136:139], a[232:235], a[204:207], v[136:139]
    ds_read_b32 a246, v58
    v_perm_b32 v59, v85, v35, s39
    v_mfma_f32_16x16x32_bf16 v[140:143], a[216:219], a[208:211], v[140:143]
    ds_read_b32 a247, v59
    v_perm_b32 v60, v89, v35, s36
    v_mfma_f32_16x16x32_bf16 v[140:143], a[232:235], a[212:215], v[140:143]
    v_perm_b32 v61, v89, v35, s37
    v_perm_b32 v62, v89, v35, s38
    v_mfma_f32_16x16x32_bf16 v[144:147], a[216:219], a[220:223], v[144:147]
    ds_read_b32 a48, v60
    v_perm_b32 v63, v89, v35, s39
    v_mfma_f32_16x16x32_bf16 v[144:147], a[232:235], a[224:227], v[144:147]
    s_waitcnt lgkmcnt(7)
    ds_read_b32 a49, v61
    ds_read_b32 a50, v62
    v_mfma_f32_16x16x32_bf16 v[148:151], a[216:219], a[228:231], v[148:151]
    buffer_load_dwordx3 v[72:74], v18, s[4:7], s61 offen
    v_mfma_f32_16x16x32_bf16 v[148:151], a[232:235], a[236:239], v[148:151]
    ds_read_b32 a51, v63
    ds_read_b128 a[60:63], v46 offset:2048
    v_mfma_f32_16x16x32_bf16 v[152:155], a[216:219], a[240:243], v[152:155]
    s_waitcnt vmcnt(16) lgkmcnt(8)
    v_lshl_or_b32 v96, v116, 8, v96
    v_lshl_or_b32 v97, v117, 8, v97
    v_mfma_f32_16x16x32_bf16 v[152:155], a[232:235], a[248:251], v[152:155]
    v_lshl_or_b32 v98, v118, 8, v98
    v_perm_b32 v56, v86, v35, s36
    v_mfma_f32_16x16x32_bf16 v[156:159], a[216:219], a[252:255], v[156:159]
    s_waitcnt lgkmcnt(6)
    ds_read_b128 a[76:79], v47 offset:2048
    ds_read_b32 a92, v56
    v_mfma_f32_16x16x32_bf16 v[156:159], a[232:235], a[32:35], v[156:159]
    s_waitcnt lgkmcnt(7)
    ds_read_b128 a[104:107], v46 offset:0
    v_perm_b32 v57, v86, v35, s37
    v_mfma_f32_16x16x32_bf16 v[160:163], a[244:247], a[176:179], v[160:163]
    s_waitcnt lgkmcnt(4)
    ds_read_b32 a93, v57
    v_perm_b32 v58, v86, v35, s38
    v_mfma_f32_16x16x32_bf16 v[160:163], a[48:51], a[180:183], v[160:163]
    ds_read_b32 a94, v58
    v_bitop3_b32 v101, v101, v103, s76 bitop3:0x7e
    v_mfma_f32_16x16x32_bf16 v[164:167], a[244:247], a[184:187], v[164:167]
    v_cmp_ne_u32 vcc, 0, v101
    v_perm_b32 v59, v86, v35, s39
    v_mfma_f32_16x16x32_bf16 v[164:167], a[48:51], a[192:195], v[164:167]
    ds_read_b128 a[0:3], v47 offset:0
    ds_read_b32 a95, v59
    v_mfma_f32_16x16x32_bf16 v[168:171], a[244:247], a[196:199], v[168:171]
    v_perm_b32 v60, v90, v35, s36
    v_perm_b32 v61, v90, v35, s37
    v_mfma_f32_16x16x32_bf16 v[168:171], a[48:51], a[204:207], v[168:171]
    v_perm_b32 v62, v90, v35, s38
    v_perm_b32 v63, v90, v35, s39
    v_mfma_f32_16x16x32_bf16 v[172:175], a[244:247], a[208:211], v[172:175]
    s_mov_b32 s42, 40960
    ds_read_b32 a4, v60
    ds_read_b32 a5, v61
    v_mfma_f32_16x16x32_bf16 v[172:175], a[48:51], a[212:215], v[172:175]
    ds_read_b32 a6, v62
    ds_read_b32 a7, v63
    v_mfma_f32_16x16x32_bf16 v[176:179], a[244:247], a[220:223], v[176:179]
    ds_read_b128 a[8:11], v46 offset:6144
    s_cbranch_vccnz L_slow1_2
L_back1_2:
    v_mfma_f32_16x16x32_bf16 v[176:179], a[48:51], a[224:227], v[176:179]
    s_mov_b32 s43, 46080
    ds_read_b128 a[12:15], v47 offset:6144
    v_mfma_f32_16x16x32_bf16 v[180:183], a[244:247], a[228:231], v[180:183]
    buffer_load_dwordx2 v[76:77], v34, s[12:15], s42 offen sc1
    v_mfma_f32_16x16x32_bf16 v[180:183], a[48:51], a[236:239], v[180:183]
    s_waitcnt vmcnt(13)
    v_lshl_or_b32 v96, v120, 12, v96
    v_lshl_or_b32 v97, v121, 12, v97
    v_mfma_f32_16x16x32_bf16 v[184:187], a[244:247], a[240:243], v[184:187]
    ds_read_b128 a[16:19], v46 offset:4096
    v_lshl_or_b32 v98, v122, 12, v98
    v_mfma_f32_16x16x32_bf16 v[184:187], a[48:51], a[248:251], v[184:187]
    ds_read_b128 a[20:23], v47 offset:4096
    v_mfma_f32_16x16x32_bf16 v[188:191], a[244:247], a[252:255], v[188:191]
    buffer_load_dwordx2 v[78:79], v34, s[12:15], s43 offen sc1
    v_mfma_f32_16x16x32_bf16 v[188:191], a[48:51], a[32:35], v[188:191]
    s_waitcnt lgkmcnt(6)
    v_perm_b32 v56, v100, v35, s36
    v_perm_b32 v57, v100, v35, s37
    v_mfma_f32_16x16x32_bf16 v[192:195], a[92:95], a[176:179], v[192:195]
    s_waitcnt lgkmcnt(4)
    ds_read_b32 a24, v56
    ds_read_b32 a25, v57
    v_mfma_f32_16x16x32_bf16 v[192:195], a[4:7], a[180:183], v[192:195]
    ds_read_b128 a[28:31], v46 offset:10240
    v_perm_b32 v58, v100, v35, s38
    v_mfma_f32_16x16x32_bf16 v[196:199], a[92:95], a[184:187], v[196:199]
    ds_read_b32 a26, v58
    v_bitop3_b32 v111, v111, v115, s76 bitop3:0x7e
    v_mfma_f32_16x16x32_bf16 v[196:199], a[4:7], a[192:195], v[196:199]
    v_perm_b32 v59, v100, v35, s39
    v_cmp_ne_u32 vcc, 0, v111
    v_mfma_f32_16x16x32_bf16 v[200:203], a[92:95], a[196:199], v[200:203]
    s_add_u32 s56, s55, 768
    ds_read_b32 a27, v59
    v_perm_b32 v60, v102, v35, s36
    v_mfma_f32_16x16x32_bf16 v[200:203], a[4:7], a[204:207], v[200:203]
    v_perm_b32 v61, v102, v35, s37
    v_perm_b32 v62, v102, v35, s38
    v_mfma_f32_16x16x32_bf16 v[204:207], a[92:95], a[208:211], v[204:207]
    s_mov_b32 s44, 40960
    ds_read_b32 a36, v60
    v_perm_b32 v63, v102, v35, s39
    v_mfma_f32_16x16x32_bf16 v[204:207], a[4:7], a[212:215], v[204:207]
    s_add_u32 m0, s57, 32768
    ds_read_b32 a37, v61
    ds_read_b32 a38, v62
    v_mfma_f32_16x16x32_bf16 v[208:211], a[92:95], a[220:223], v[208:211]
    ds_read_b32 a39, v63
    s_cbranch_vccnz L_slow1_1
L_back1_1:
    v_mfma_f32_16x16x32_bf16 v[208:211], a[4:7], a[224:227], v[208:211]
    s_mov_b32 s45, 46080
    ds_read_b128 a[40:43], v47 offset:10240
    v_mfma_f32_16x16x32_bf16 v[212:215], a[92:95], a[228:231], v[212:215]
    buffer_load_dwordx4 v[80:83], v33, s[12:15], s44 offen sc1
    v_mfma_f32_16x16x32_bf16 v[212:215], a[4:7], a[236:239], v[212:215]
    s_waitcnt vmcnt(12)
    v_lshl_or_b32 v96, v124, 16, v96
    v_lshl_or_b32 v97, v125, 16, v97
    v_mfma_f32_16x16x32_bf16 v[216:219], a[92:95], a[240:243], v[216:219]
    ds_read_b128 a[44:47], v46 offset:8192
    v_lshl_or_b32 v98, v126, 16, v98
    v_mfma_f32_16x16x32_bf16 v[216:219], a[4:7], a[248:251], v[216:219]
    ds_read_b128 a[52:55], v47 offset:8192
    v_mfma_f32_16x16x32_bf16 v[220:223], a[92:95], a[252:255], v[220:223]
    buffer_load_dwordx4 v[104:107], v33, s[12:15], s45 offen sc1
    v_mfma_f32_16x16x32_bf16 v[220:223], a[4:7], a[32:35], v[220:223]
    s_waitcnt lgkmcnt(6)
    ds_read_b128 a[56:59], v46 offset:14336
    v_perm_b32 v56, v108, v35, s36
    v_mfma_f32_16x16x32_bf16 v[224:227], a[24:27], a[176:179], v[224:227]
    s_waitcnt lgkmcnt(4)
    ds_read_b32 a64, v56
    v_perm_b32 v57, v108, v35, s37
    v_mfma_f32_16x16x32_bf16 v[224:227], a[36:39], a[180:183], v[224:227]
    ds_read_b32 a65, v57
    ds_read_b128 a[68:71], v47 offset:14336
    v_mfma_f32_16x16x32_bf16 v[228:231], a[24:27], a[184:187], v[228:231]
    buffer_load_dwordx4 v36, s[8:11], s56 offen offset:0 lds
    v_mfma_f32_16x16x32_bf16 v[228:231], a[36:39], a[192:195], v[228:231]
    v_perm_b32 v58, v108, v35, s38
    v_perm_b32 v59, v108, v35, s39
    v_mfma_f32_16x16x32_bf16 v[232:235], a[24:27], a[196:199], v[232:235]
    ds_read_b32 a66, v58
    ds_read_b32 a67, v59
    v_mfma_f32_16x16x32_bf16 v[232:235], a[36:39], a[204:207], v[232:235]
    ds_read_b128 a[116:119], v46 offset:12288
    v_mfma_f32_16x16x32_bf16 v[236:239], a[24:27], a[208:211], v[236:239]
    buffer_load_dwordx4 v37, s[8:11], s56 offen offset:1024 lds
    v_mfma_f32_16x16x32_bf16 v[236:239], a[36:39], a[212:215], v[236:239]
    v_perm_b32 v60, v112, v35, s36
    v_perm_b32 v61, v112, v35, s37
    v_mfma_f32_16x16x32_bf16 v[240:243], a[24:27], a[220:223], v[240:243]
    s_waitcnt vmcnt(10)
    v_perm_b32 v62, v112, v35, s38
    v_perm_b32 v63, v112, v35, s39
    v_mfma_f32_16x16x32_bf16 v[240:243], a[36:39], a[224:227], v[240:243]
    ds_read_b32 a72, v60
    ds_read_b32 a73, v61
    v_lshl_or_b32 v96, v64, 20, v96
    v_mfma_f32_16x16x32_bf16 v[244:247], a[24:27], a[228:231], v[244:247]
    ds_read_b32 a74, v62
    ds_read_b32 a75, v63
    v_lshl_or_b32 v97, v65, 20, v97
    v_mfma_f32_16x16x32_bf16 v[244:247], a[36:39], a[236:239], v[244:247]
    ds_read_b128 a[132:135], v47 offset:12288
    v_mfma_f32_16x16x32_bf16 v[248:251], a[24:27], a[240:243], v[248:251]
    buffer_load_dwordx4 v38, s[8:11], s56 offen offset:2048 lds
    v_mfma_f32_16x16x32_bf16 v[248:251], a[36:39], a[248:251], v[248:251]
    s_add_u32 s3, s55, 896
    v_lshl_or_b32 v98, v66, 20, v98
    v_perm_b32 v56, v109, v35, s36
    v_mfma_f32_16x16x32_bf16 v[252:255], a[24:27], a[252:255], v[252:255]
    ds_read_b32 a148, v56
    v_perm_b32 v57, v109, v35, s37
    v_mfma_f32_16x16x32_bf16 v[252:255], a[36:39], a[32:35], v[252:255]
    s_waitcnt lgkmcnt(6)
    ds_read_b32 a149, v57
    v_mfma_f32_16x16x32_bf16 v[128:131], a[64:67], a[60:63], v[128:131]
    s_waitcnt lgkmcnt(3)
    buffer_load_dwordx4 v39, s[8:11], s56 offen offset:3072 lds
    v_mfma_f32_16x16x32_bf16 v[128:131], a[72:75], a[76:79], v[128:131]
    s_add_u32 m0, s57, 51200
    v_perm_b32 v58, v109, v35, s38
    v_perm_b32 v59, v109, v35, s39
    v_mfma_f32_16x16x32_bf16 v[132:135], a[64:67], a[104:107], v[132:135]
    s_waitcnt vmcnt(10) lgkmcnt(2)
    ds_read_b32 a150, v58
    v_lshl_or_b32 v96, v68, 24, v96
    v_mfma_f32_16x16x32_bf16 v[132:135], a[72:75], a[0:3], v[132:135]
    s_barrier
L_pad1:
    s_cbranch_execz L_pad2
    v_mfma_f32_16x16x32_bf16 v[136:139], a[64:67], a[8:11], v[136:139]
    buffer_load_dwordx4 v36, s[8:11], s3 offen offset:0 lds
    v_mfma_f32_16x16x32_bf16 v[136:139], a[72:75], a[12:15], v[136:139]
    ds_read_b32 a151, v59
    v_perm_b32 v60, v113, v35, s36
    v_mfma_f32_16x16x32_bf16 v[140:143], a[64:67], a[16:19], v[140:143]
    v_perm_b32 v61, v113, v35, s37
    v_perm_b32 v62, v113, v35, s38
    v_mfma_f32_16x16x32_bf16 v[140:143], a[72:75], a[20:23], v[140:143]
    ds_read_b32 a160, v60
    ds_read_b32 a161, v61
    v_mfma_f32_16x16x32_bf16 v[144:147], a[64:67], a[28:31], v[144:147]
    buffer_load_dwordx4 v37, s[8:11], s3 offen offset:1024 lds
    v_mfma_f32_16x16x32_bf16 v[144:147], a[72:75], a[40:43], v[144:147]
    ds_read_b32 a162, v62
    v_perm_b32 v63, v113, v35, s39
    v_lshl_or_b32 v97, v69, 24, v97
    v_mfma_f32_16x16x32_bf16 v[148:151], a[64:67], a[44:47], v[148:151]
    ds_read_b32 a163, v63
    v_lshl_or_b32 v98, v70, 24, v98
    v_mfma_f32_16x16x32_bf16 v[148:151], a[72:75], a[52:55], v[148:151]
    s_add_u32 m0, s57, 47104
    ds_read_b128 a[168:171], v40 offset:0
    v_perm_b32 v56, v110, v35, s36
    v_mfma_f32_16x16x32_bf16 v[152:155], a[64:67], a[56:59], v[152:155]
    ds_read_b128 a[172:175], v41 offset:0
    ds_read_b32 a80, v56
    v_mfma_f32_16x16x32_bf16 v[152:155], a[72:75], a[68:71], v[152:155]
    ds_read_b128 a[84:87], v40 offset:2048
    v_mfma_f32_16x16x32_bf16 v[156:159], a[64:67], a[116:119], v[156:159]
    buffer_load_dwordx4 v38, s[8:11], s3 offen offset:2048 lds
    v_mfma_f32_16x16x32_bf16 v[156:159], a[72:75], a[132:135], v[156:159]
    s_waitcnt lgkmcnt(8)
    v_perm_b32 v57, v110, v35, s37
    v_perm_b32 v58, v110, v35, s38
    v_mfma_f32_16x16x32_bf16 v[160:163], a[148:151], a[60:63], v[160:163]
    s_waitcnt vmcnt(11) lgkmcnt(4)
    ds_read_b32 a81, v57
    v_lshl_or_b32 v96, v72, 28, v96
    v_mfma_f32_16x16x32_bf16 v[160:163], a[160:163], a[76:79], v[160:163]
    v_lshl_or_b32 v97, v73, 28, v97
    v_lshl_or_b32 v98, v74, 28, v98
    v_mfma_f32_16x16x32_bf16 v[164:167], a[148:151], a[104:107], v[164:167]
    ds_read_b32 a82, v58
    ds_read_b128 a[88:91], v41 offset:2048
    v_mfma_f32_16x16x32_bf16 v[164:167], a[160:163], a[0:3], v[164:167]
    buffer_store_dwordx4 v[96:99], v20, s[12:15], s62 offen sc1
    v_mfma_f32_16x16x32_bf16 v[168:171], a[148:151], a[8:11], v[168:171]
    v_perm_b32 v59, v110, v35, s39
    v_perm_b32 v60, v114, v35, s36
    v_mfma_f32_16x16x32_bf16 v[168:171], a[160:163], a[12:15], v[168:171]
    ds_read_b32 a83, v59
    v_perm_b32 v61, v114, v35, s37
    v_bitop3_b32 v51, v51, v55, s76 bitop3:0x7e
    v_mfma_f32_16x16x32_bf16 v[172:175], a[148:151], a[16:19], v[172:175]
    s_mov_b32 s40, 61440
    ds_read_b32 a96, v60
    ds_read_b32 a97, v61
    v_mfma_f32_16x16x32_bf16 v[172:175], a[160:163], a[20:23], v[172:175]
    buffer_load_dwordx4 v39, s[8:11], s3 offen offset:3072 lds
    v_mfma_f32_16x16x32_bf16 v[176:179], a[148:151], a[28:31], v[176:179]
    v_perm_b32 v62, v114, v35, s38
    v_perm_b32 v63, v114, v35, s39
    v_mfma_f32_16x16x32_bf16 v[176:179], a[160:163], a[40:43], v[176:179]
    s_mov_b32 s41, 66560
    ds_read_b32 a98, v62
    ds_read_b32 a99, v63
    v_mfma_f32_16x16x32_bf16 v[180:183], a[148:151], a[44:47], v[180:183]
    ds_read_b128 a[100:103], v40 offset:4096
    v_mfma_f32_16x16x32_bf16 v[180:183], a[160:163], a[52:55], v[180:183]
    buffer_load_dwordx4 v[92:95], v32, s[12:15], s40 offen sc1
    v_mfma_f32_16x16x32_bf16 v[184:187], a[148:151], a[56:59], v[184:187]
    ds_read_b128 a[108:111], v41 offset:4096
    v_cmp_ne_u32 vcc, 0, v51
    v_mfma_f32_16x16x32_bf16 v[184:187], a[160:163], a[68:71], v[184:187]
    ds_read_b128 a[112:115], v40 offset:6144
    v_mfma_f32_16x16x32_bf16 v[188:191], a[148:151], a[116:119], v[188:191]
    s_waitcnt lgkmcnt(7)
    ds_read_b128 a[120:123], v41 offset:6144
    s_cbranch_vccnz L_slow2_0
L_back2_0:
    v_mfma_f32_16x16x32_bf16 v[188:191], a[160:163], a[132:135], v[188:191]
    buffer_load_dwordx4 v[116:119], v32, s[12:15], s41 offen sc1
    v_mfma_f32_16x16x32_bf16 v[192:195], a[80:83], a[60:63], v[192:195]
    s_waitcnt lgkmcnt(4)
    v_perm_b32 v56, v48, v35, s36
    v_perm_b32 v57, v48, v35, s37
    v_mfma_f32_16x16x32_bf16 v[192:195], a[96:99], a[76:79], v[192:195]
    ds_read_b32 a124, v56
    ds_read_b32 a125, v57
    v_mfma_f32_16x16x32_bf16 v[196:199], a[80:83], a[104:107], v[196:199]
    ds_read_b128 a[128:131], v40 offset:8192
    v_perm_b32 v58, v48, v35, s38
    v_mfma_f32_16x16x32_bf16 v[196:199], a[96:99], a[0:3], v[196:199]
    ds_read_b32 a126, v58
    v_perm_b32 v59, v48, v35, s39
    v_mfma_f32_16x16x32_bf16 v[200:203], a[80:83], a[8:11], v[200:203]
    ds_read_b32 a127, v59
    v_perm_b32 v60, v52, v35, s36
    v_mfma_f32_16x16x32_bf16 v[200:203], a[96:99], a[12:15], v[200:203]
    v_perm_b32 v61, v52, v35, s37
    v_perm_b32 v62, v52, v35, s38
    v_mfma_f32_16x16x32_bf16 v[204:207], a[80:83], a[16:19], v[204:207]
    ds_read_b32 a136, v60
    v_perm_b32 v63, v52, v35, s39
    v_mfma_f32_16x16x32_bf16 v[204:207], a[96:99], a[20:23], v[204:207]
    ds_read_b32 a137, v61
    ds_read_b32 a138, v62
    v_mfma_f32_16x16x32_bf16 v[208:211], a[80:83], a[28:31], v[208:211]
    ds_read_b32 a139, v63
    ds_read_b128 a[140:143], v41 offset:8192
    v_mfma_f32_16x16x32_bf16 v[208:211], a[96:99], a[40:43], v[208:211]
    ds_read_b128 a[144:147], v40 offset:10240
    v_perm_b32 v56, v49, v35, s36
    v_mfma_f32_16x16x32_bf16 v[212:215], a[80:83], a[44:47], v[212:215]
    ds_read_b128 a[152:155], v41 offset:10240
    ds_read_b32 a156, v56
    v_mfma_f32_16x16x32_bf16 v[212:215], a[96:99], a[52:55], v[212:215]
    ds_read_b128 a[188:191], v40 offset:12288
    v_perm_b32 v57, v49, v35, s37
    v_mfma_f32_16x16x32_bf16 v[216:219], a[80:83], a[56:59], v[216:219]
    ds_read_b32 a157, v57
    v_perm_b32 v58, v49, v35, s38
    v_mfma_f32_16x16x32_bf16 v[216:219], a[96:99], a[68:71], v[216:219]
    ds_read_b128 a[164:167], v41 offset:12288
    ds_read_b32 a158, v58
    v_mfma_f32_16x16x32_bf16 v[220:223], a[80:83], a[116:119], v[220:223]
    ds_read_b128 a[200:203], v40 offset:14336
    v_perm_b32 v59, v49, v35, s39
    v_mfma_f32_16x16x32_bf16 v[220:223], a[96:99], a[132:135], v[220:223]
    s_waitcnt lgkmcnt(12)
    ds_read_b32 a159, v59
    v_perm_b32 v60, v53, v35, s36
    v_mfma_f32_16x16x32_bf16 v[128:131], a[124:127], a[168:171], v[128:131]
    s_waitcnt lgkmcnt(10)
    ds_read_b32 a216, v60
    v_perm_b32 v61, v53, v35, s37
    v_mfma_f32_16x16x32_bf16 v[128:131], a[136:139], a[172:175], v[128:131]
    ds_read_b128 a[232:235], v41 offset:14336
    v_mfma_f32_16x16x32_bf16 v[132:135], a[124:127], a[84:87], v[132:135]
    ds_read_b32 a217, v61
    v_perm_b32 v62, v53, v35, s38
    v_mfma_f32_16x16x32_bf16 v[132:135], a[136:139], a[88:91], v[132:135]
    ds_read_b128 a[244:247], v42 offset:2048
    v_mfma_f32_16x16x32_bf16 v[136:139], a[124:127], a[100:103], v[136:139]
    ds_read_b32 a218, v62
    v_perm_b32 v63, v53, v35, s39
    v_mfma_f32_16x16x32_bf16 v[136:139], a[136:139], a[108:111], v[136:139]
    ds_read_b128 a[48:51], v43 offset:2048
    v_mfma_f32_16x16x32_bf16 v[140:143], a[124:127], a[112:115], v[140:143]
    ds_read_b32 a219, v63
    v_perm_b32 v56, v50, v35, s36
    v_mfma_f32_16x16x32_bf16 v[140:143], a[136:139], a[120:123], v[140:143]
    ds_read_b128 a[92:95], v42 offset:0
    v_mfma_f32_16x16x32_bf16 v[144:147], a[124:127], a[128:131], v[144:147]
    s_waitcnt lgkmcnt(8)
    ds_read_b32 a4, v56
    v_perm_b32 v57, v50, v35, s37
    v_mfma_f32_16x16x32_bf16 v[144:147], a[136:139], a[140:143], v[144:147]
    v_mfma_f32_16x16x32_bf16 v[148:151], a[124:127], a[144:147], v[148:151]
    ds_read_b32 a5, v57
    v_perm_b32 v58, v50, v35, s38
    v_mfma_f32_16x16x32_bf16 v[148:151], a[136:139], a[152:155], v[148:151]
    s_waitcnt vmcnt(13)
    ds_read_b128 a[176:179], v43 offset:0
    v_bitop3_b32 v77, v77, v79, s76 bitop3:0x7e
    v_mfma_f32_16x16x32_bf16 v[152:155], a[124:127], a[188:191], v[152:155]
    s_mov_b32 s42, 122880
    ds_read_b32 a6, v58
    v_cmp_ne_u32 vcc, 0, v77
    v_mfma_f32_16x16x32_bf16 v[152:155], a[136:139], a[164:167], v[152:155]
    ds_read_b128 a[180:183], v42 offset:6144
    v_perm_b32 v59, v50, v35, s39
    v_mfma_f32_16x16x32_bf16 v[156:159], a[124:127], a[200:203], v[156:159]
    s_waitcnt lgkmcnt(7)
    ds_read_b32 a7, v59
    s_cbranch_vccnz L_slow2_2
L_back2_2:
    v_mfma_f32_16x16x32_bf16 v[156:159], a[136:139], a[232:235], v[156:159]
    s_mov_b32 s43, 128000
    v_perm_b32 v60, v54, v35, s36
    v_mfma_f32_16x16x32_bf16 v[160:163], a[156:159], a[168:171], v[160:163]
    s_waitcnt lgkmcnt(6)
    ds_read_b32 a184, v60
    v_perm_b32 v61, v54, v35, s37
    v_mfma_f32_16x16x32_bf16 v[160:163], a[216:219], a[172:175], v[160:163]
    ds_read_b128 a[192:195], v43 offset:6144
    v_mfma_f32_16x16x32_bf16 v[164:167], a[156:159], a[84:87], v[164:167]
    ds_read_b32 a185, v61
    v_perm_b32 v62, v54, v35, s38
    v_mfma_f32_16x16x32_bf16 v[164:167], a[216:219], a[88:91], v[164:167]
    ds_read_b128 a[196:199], v42 offset:4096
    v_mfma_f32_16x16x32_bf16 v[168:171], a[156:159], a[100:103], v[168:171]
    ds_read_b32 a186, v62
    v_perm_b32 v63, v54, v35, s39
    v_mfma_f32_16x16x32_bf16 v[168:171], a[216:219], a[108:111], v[168:171]
    v_mfma_f32_16x16x32_bf16 v[172:175], a[156:159], a[112:115], v[172:175]
    s_mov_b32 s44, 61440
    ds_read_b32 a187, v63
    v_perm_b32 v56, v76, v35, s36
    v_mfma_f32_16x16x32_bf16 v[172:175], a[216:219], a[120:123], v[172:175]
    ds_read_b128 a[204:207], v43 offset:4096
    v_mfma_f32_16x16x32_bf16 v[176:179], a[156:159], a[128:131], v[176:179]
    ds_read_b32 a208, v56
    v_perm_b32 v57, v76, v35, s37
    v_mfma_f32_16x16x32_bf16 v[176:179], a[216:219], a[140:143], v[176:179]
    s_mov_b32 s45, 66560
    ds_read_b128 a[212:215], v42 offset:10240
    v_mfma_f32_16x16x32_bf16 v[180:183], a[156:159], a[144:147], v[180:183]
    buffer_load_dwordx2 v[84:85], v34, s[12:15], s44 offen sc1
    v_mfma_f32_16x16x32_bf16 v[180:183], a[216:219], a[152:155], v[180:183]
    ds_read_b32 a209, v57
    v_perm_b32 v58, v76, v35, s38
    v_mfma_f32_16x16x32_bf16 v[184:187], a[156:159], a[188:191], v[184:187]
    s_waitcnt vmcnt(12)
    ds_read_b32 a210, v58
    v_bitop3_b32 v83, v83, v107, s76 bitop3:0x7e
    v_mfma_f32_16x16x32_bf16 v[184:187], a[216:219], a[164:167], v[184:187]
    ds_read_b128 a[220:223], v43 offset:10240
    v_mfma_f32_16x16x32_bf16 v[188:191], a[156:159], a[200:203], v[188:191]
    buffer_load_dwordx2 v[86:87], v34, s[12:15], s45 offen sc1
    v_mfma_f32_16x16x32_bf16 v[188:191], a[216:219], a[232:235], v[188:191]
    s_waitcnt lgkmcnt(6)
    v_cmp_ne_u32 vcc, 0, v83
    v_perm_b32 v59, v76, v35, s39
    v_mfma_f32_16x16x32_bf16 v[192:195], a[4:7], a[168:171], v[192:195]
    ds_read_b32 a211, v59
    v_perm_b32 v60, v78, v35, s36
    v_mfma_f32_16x16x32_bf16 v[192:195], a[184:187], a[172:175], v[192:195]
    ds_read_b32 a224, v60
    s_cbranch_vccnz L_slow2_1
L_back2_1:
    v_mfma_f32_16x16x32_bf16 v[196:199], a[4:7], a[84:87], v[196:199]
    ds_read_b128 a[228:231], v42 offset:8192
    v_perm_b32 v61, v78, v35, s37
    v_mfma_f32_16x16x32_bf16 v[196:199], a[184:187], a[88:91], v[196:199]
    ds_read_b32 a225, v61
    v_perm_b32 v62, v78, v35, s38
    v_mfma_f32_16x16x32_bf16 v[200:203], a[4:7], a[100:103], v[200:203]
    s_add_u32 s56, s55, 1024
    ds_read_b32 a226, v62
    v_perm_b32 v63, v78, v35, s39
    v_mfma_f32_16x16x32_bf16 v[200:203], a[184:187], a[108:111], v[200:203]
    ds_read_b128 a[236:239], v43 offset:8192
    v_mfma_f32_16x16x32_bf16 v[204:207], a[4:7], a[112:115], v[204:207]
    s_mov_b32 s40, 61440
    ds_read_b32 a227, v63
    v_perm_b32 v56, v80, v35, s36
    v_mfma_f32_16x16x32_bf16 v[204:207], a[184:187], a[120:123], v[204:207]
    s_add_u32 m0, s57, 65536
    ds_read_b128 a[240:243], v42 offset:14336
    v_mfma_f32_16x16x32_bf16 v[208:211], a[4:7], a[128:131], v[208:211]
    ds_read_b32 a248, v56
    v_perm_b32 v57, v80, v35, s37
    v_mfma_f32_16x16x32_bf16 v[208:211], a[184:187], a[140:143], v[208:211]
    s_mov_b32 s41, 66560
    ds_read_b128 a[252:255], v43 offset:14336
    v_mfma_f32_16x16x32_bf16 v[212:215], a[4:7], a[144:147], v[212:215]
    buffer_load_dwordx4 v[88:91], v33, s[12:15], s40 offen sc1
    v_mfma_f32_16x16x32_bf16 v[212:215], a[184:187], a[152:155], v[212:215]
    ds_read_b32 a249, v57
    v_perm_b32 v58, v80, v35, s38
    v_mfma_f32_16x16x32_bf16 v[216:219], a[4:7], a[188:191], v[216:219]
    ds_read_b32 a250, v58
    v_perm_b32 v59, v80, v35, s39
    v_mfma_f32_16x16x32_bf16 v[216:219], a[184:187], a[164:167], v[216:219]
    ds_read_b128 a[24:27], v42 offset:12288
    v_mfma_f32_16x16x32_bf16 v[220:223], a[4:7], a[200:203], v[220:223]
    buffer_load_dwordx4 v[120:123], v33, s[12:15], s41 offen sc1
    v_mfma_f32_16x16x32_bf16 v[220:223], a[184:187], a[232:235], v[220:223]
    s_waitcnt lgkmcnt(6)
    ds_read_b32 a251, v59
    v_perm_b32 v60, v104, v35, s36
    v_mfma_f32_16x16x32_bf16 v[224:227], a[208:211], a[168:171], v[224:227]
    ds_read_b32 a32, v60
    v_perm_b32 v61, v104, v35, s37
    v_mfma_f32_16x16x32_bf16 v[224:227], a[224:227], a[172:175], v[224:227]
    ds_read_b128 a[36:39], v43 offset:12288
    v_mfma_f32_16x16x32_bf16 v[228:231], a[208:211], a[84:87], v[228:231]
    buffer_load_dwordx4 v36, s[8:11], s56 offen offset:0 lds
    v_mfma_f32_16x16x32_bf16 v[228:231], a[224:227], a[88:91], v[228:231]
    ds_read_b32 a33, v61
    v_perm_b32 v62, v104, v35, s38
    v_mfma_f32_16x16x32_bf16 v[232:235], a[208:211], a[100:103], v[232:235]
    ds_read_b32 a34, v62
    v_perm_b32 v63, v104, v35, s39
    v_mfma_f32_16x16x32_bf16 v[232:235], a[224:227], a[108:111], v[232:235]
    v_mfma_f32_16x16x32_bf16 v[236:239], a[208:211], a[112:115], v[236:239]
    buffer_load_dwordx4 v37, s[8:11], s56 offen offset:1024 lds
    v_mfma_f32_16x16x32_bf16 v[236:239], a[224:227], a[120:123], v[236:239]
    ds_read_b32 a35, v63
    v_perm_b32 v56, v81, v35, s36
    v_mfma_f32_16x16x32_bf16 v[240:243], a[208:211], a[128:131], v[240:243]
    ds_read_b32 a64, v56
    v_perm_b32 v57, v81, v35, s37
    v_mfma_f32_16x16x32_bf16 v[240:243], a[224:227], a[140:143], v[240:243]
    v_mfma_f32_16x16x32_bf16 v[244:247], a[208:211], a[144:147], v[244:247]
    buffer_load_dwordx4 v38, s[8:11], s56 offen offset:2048 lds
    v_mfma_f32_16x16x32_bf16 v[244:247], a[224:227], a[152:155], v[244:247]
    s_waitcnt vmcnt(9) lgkmcnt(4)
    ds_read_b32 a65, v57
    v_perm_b32 v58, v81, v35, s38
    v_mfma_f32_16x16x32_bf16 v[248:251], a[208:211], a[188:191], v[248:251]
    s_barrier
    v_mfma_f32_16x16x32_bf16 v[248:251], a[224:227], a[164:167], v[248:251]
    s_add_u32 s3, s55, 1152
    ds_read_b32 a66, v58
    v_mfma_f32_16x16x32_bf16 v[252:255], a[208:211], a[200:203], v[252:255]
    buffer_load_dwordx4 v39, s[8:11], s56 offen offset:3072 lds
    v_mfma_f32_16x16x32_bf16 v[252:255], a[224:227], a[232:235], v[252:255]
    s_add_u32 m0, s57, 83968
    v_perm_b32 v59, v81, v35, s39
    v_perm_b32 v60, v105, v35, s36
    v_mfma_f32_16x16x32_bf16 v[128:131], a[248:251], a[244:247], v[128:131]
    s_waitcnt lgkmcnt(3)
    ds_read_b32 a67, v59
    ds_read_b32 a72, v60
    v_mfma_f32_16x16x32_bf16 v[128:131], a[32:35], a[48:51], v[128:131]
    ds_read_b128 a[148:151], v40 offset:32768
    v_mfma_f32_16x16x32_bf16 v[132:135], a[248:251], a[92:95], v[132:135]
    buffer_load_dwordx4 v36, s[8:11], s3 offen offset:0 lds
    v_mfma_f32_16x16x32_bf16 v[132:135], a[32:35], a[176:179], v[132:135]
    v_perm_b32 v61, v105, v35, s37
    v_perm_b32 v62, v105, v35, s38
    v_mfma_f32_16x16x32_bf16 v[136:139], a[248:251], a[180:183], v[136:139]
    ds_read_b32 a73, v61
    v_perm_b32 v63, v105, v35, s39
    v_mfma_f32_16x16x32_bf16 v[136:139], a[32:35], a[192:195], v[136:139]
    ds_read_b32 a74, v62
    ds_read_b128 a[160:163], v41 offset:32768
    v_mfma_f32_16x16x32_bf16 v[140:143], a[248:251], a[196:199], v[140:143]
    ds_read_b32 a75, v63
    v_mfma_f32_16x16x32_bf16 v[140:143], a[32:35], a[204:207], v[140:143]
    buffer_load_dwordx2 v[100:101], v34, s[12:15], s42 offen sc1
    v_mfma_f32_16x16x32_bf16 v[144:147], a[248:251], a[212:215], v[144:147]
    s_mov_b32 s42, 122880
    v_perm_b32 v56, v82, v35, s36
    v_perm_b32 v57, v82, v35, s37
    v_mfma_f32_16x16x32_bf16 v[144:147], a[32:35], a[220:223], v[144:147]
    ds_read_b32 a76, v56
    ds_read_b128 a[60:63], v40 offset:34816
    v_mfma_f32_16x16x32_bf16 v[148:151], a[248:251], a[228:231], v[148:151]
    s_waitcnt vmcnt(10)
    ds_read_b32 a77, v57
    ds_read_b128 a[104:107], v41 offset:34816
    v_mfma_f32_16x16x32_bf16 v[148:151], a[32:35], a[236:239], v[148:151]
    buffer_load_dwordx2 v[102:103], v34, s[12:15], s43 offen sc1
    v_mfma_f32_16x16x32_bf16 v[152:155], a[248:251], a[240:243], v[152:155]
    s_mov_b32 s43, 128000
    v_perm_b32 v58, v82, v35, s38
    v_bitop3_b32 v95, v95, v119, s76 bitop3:0x7e
    v_mfma_f32_16x16x32_bf16 v[152:155], a[32:35], a[252:255], v[152:155]
    s_mov_b32 s44, 122880
    ds_read_b32 a78, v58
    v_cmp_ne_u32 vcc, 0, v95
    v_mfma_f32_16x16x32_bf16 v[156:159], a[248:251], a[24:27], v[156:159]
    s_waitcnt lgkmcnt(6)
    ds_read_b128 a[0:3], v40 offset:36864
    v_mfma_f32_16x16x32_bf16 v[156:159], a[32:35], a[36:39], v[156:159]
    buffer_load_dwordx4 v[124:127], v32, s[12:15], s42 offen sc1
    v_mfma_f32_16x16x32_bf16 v[160:163], a[64:67], a[244:247], v[160:163]
    s_waitcnt lgkmcnt(6)
    v_perm_b32 v59, v82, v35, s39
    s_cbranch_vccnz L_slow3_0
L_back3_0:
    v_mfma_f32_16x16x32_bf16 v[160:163], a[72:75], a[48:51], v[160:163]
    s_mov_b32 s45, 128000
    ds_read_b32 a79, v59
    v_perm_b32 v60, v106, v35, s36
    v_mfma_f32_16x16x32_bf16 v[164:167], a[64:67], a[92:95], v[164:167]
    ds_read_b32 a12, v60
    ds_read_b128 a[8:11], v41 offset:36864
    v_mfma_f32_16x16x32_bf16 v[164:167], a[72:75], a[176:179], v[164:167]
    buffer_load_dwordx4 v[64:67], v32, s[12:15], s43 offen sc1
    v_mfma_f32_16x16x32_bf16 v[168:171], a[64:67], a[180:183], v[168:171]
    v_perm_b32 v61, v106, v35, s37
    v_perm_b32 v62, v106, v35, s38
    v_mfma_f32_16x16x32_bf16 v[168:171], a[72:75], a[192:195], v[168:171]
    ds_read_b32 a13, v61
    v_perm_b32 v63, v106, v35, s39
    v_mfma_f32_16x16x32_bf16 v[172:175], a[64:67], a[196:199], v[172:175]
    s_mov_b32 s40, 81920
    ds_read_b32 a14, v62
    ds_read_b32 a15, v63
    v_mfma_f32_16x16x32_bf16 v[172:175], a[72:75], a[204:207], v[172:175]
    buffer_load_dwordx4 v[68:71], v33, s[12:15], s44 offen sc1
    v_mfma_f32_16x16x32_bf16 v[176:179], a[64:67], a[212:215], v[176:179]
    ds_read_b128 a[16:19], v40 offset:38912
    v_perm_b32 v56, v92, v35, s36
    v_mfma_f32_16x16x32_bf16 v[176:179], a[72:75], a[220:223], v[176:179]
    s_mov_b32 s41, 87040
    ds_read_b32 a20, v56
    v_perm_b32 v57, v92, v35, s37
    v_mfma_f32_16x16x32_bf16 v[180:183], a[64:67], a[228:231], v[180:183]
    ds_read_b128 a[28:31], v41 offset:38912
    ds_read_b32 a21, v57
    v_mfma_f32_16x16x32_bf16 v[180:183], a[72:75], a[236:239], v[180:183]
    buffer_load_dwordx4 v[72:75], v33, s[12:15], s45 offen sc1
    v_mfma_f32_16x16x32_bf16 v[184:187], a[64:67], a[240:243], v[184:187]
    ds_read_b128 a[40:43], v40 offset:40960
    v_perm_b32 v58, v92, v35, s38
    v_mfma_f32_16x16x32_bf16 v[184:187], a[72:75], a[252:255], v[184:187]
    ds_read_b32 a22, v58
    v_perm_b32 v59, v92, v35, s39
    v_mfma_f32_16x16x32_bf16 v[188:191], a[64:67], a[24:27], v[188:191]
    s_waitcnt lgkmcnt(8)
    ds_read_b32 a23, v59
    ds_read_b128 a[44:47], v41 offset:40960
    v_mfma_f32_16x16x32_bf16 v[188:191], a[72:75], a[36:39], v[188:191]
    buffer_load_dwordx4 v[96:99], v32, s[12:15], s40 offen sc1
    v_mfma_f32_16x16x32_bf16 v[192:195], a[76:79], a[244:247], v[192:195]
    s_waitcnt lgkmcnt(8)
    v_perm_b32 v60, v116, v35, s36
    v_perm_b32 v61, v116, v35, s37
    v_mfma_f32_16x16x32_bf16 v[192:195], a[12:15], a[48:51], v[192:195]
    ds_read_b32 a56, v60
    ds_read_b128 a[52:55], v40 offset:43008
    v_mfma_f32_16x16x32_bf16 v[196:199], a[76:79], a[92:95], v[196:199]
    ds_read_b32 a57, v61
    ds_read_b128 a[68:71], v41 offset:43008
    v_mfma_f32_16x16x32_bf16 v[196:199], a[12:15], a[176:179], v[196:199]
    buffer_load_dwordx4 v[108:111], v32, s[12:15], s41 offen sc1
    v_mfma_f32_16x16x32_bf16 v[200:203], a[76:79], a[180:183], v[200:203]
    v_perm_b32 v62, v116, v35, s38
    v_perm_b32 v63, v116, v35, s39
    v_mfma_f32_16x16x32_bf16 v[200:203], a[12:15], a[192:195], v[200:203]
    ds_read_b32 a58, v62
    ds_read_b128 a[116:119], v40 offset:45056
    v_mfma_f32_16x16x32_bf16 v[204:207], a[76:79], a[196:199], v[204:207]
    ds_read_b32 a59, v63
    v_mfma_f32_16x16x32_bf16 v[204:207], a[12:15], a[204:207], v[204:207]
    buffer_load_dwordx4 v37, s[8:11], s3 offen offset:1024 lds
    v_mfma_f32_16x16x32_bf16 v[208:211], a[76:79], a[212:215], v[208:211]
    s_add_u32 m0, s57, 79872
    v_perm_b32 v56, v93, v35, s36
    v_perm_b32 v57, v93, v35, s37
    v_mfma_f32_16x16x32_bf16 v[208:211], a[12:15], a[220:223], v[208:211]
    ds_read_b32 a132, v56
    ds_read_b128 a[80:83], v41 offset:45056
    v_mfma_f32_16x16x32_bf16 v[212:215], a[76:79], a[228:231], v[212:215]
    ds_read_b32 a133, v57
    v_mfma_f32_16x16x32_bf16 v[212:215], a[12:15], a[236:239], v[212:215]
    buffer_load_dwordx4 v38, s[8:11], s3 offen offset:2048 lds
    v_mfma_f32_16x16x32_bf16 v[216:219], a[76:79], a[240:243], v[216:219]
    v_perm_b32 v58, v93, v35, s38
    v_perm_b32 v59, v93, v35, s39
    v_mfma_f32_16x16x32_bf16 v[216:219], a[12:15], a[252:255], v[216:219]
    ds_read_b32 a134, v58
    ds_read_b128 a[96:99], v40 offset:47104
    v_mfma_f32_16x16x32_bf16 v[220:223], a[76:79], a[24:27], v[220:223]
    s_waitcnt lgkmcnt(6)
    ds_read_b32 a135, v59
    ds_read_b128 a[124:127], v41 offset:47104
    v_mfma_f32_16x16x32_bf16 v[220:223], a[12:15], a[36:39], v[220:223]
    buffer_load_dwordx4 v39, s[8:11], s3 offen offset:3072 lds
    v_mfma_f32_16x16x32_bf16 v[128:131], a[20:23], a[148:151], v[128:131]
    s_waitcnt lgkmcnt(7)
    v_perm_b32 v60, v117, v35, s36
    v_perm_b32 v61, v117, v35, s37
    v_mfma_f32_16x16x32_bf16 v[128:131], a[56:59], a[160:163], v[128:131]
    ds_read_b32 a156, v60
    ds_read_b128 a[136:139], v42 offset:34816
    v_mfma_f32_16x16x32_bf16 v[132:135], a[20:23], a[60:63], v[132:135]
    ds_read_b32 a157, v61
    v_perm_b32 v62, v117, v35, s38
    v_mfma_f32_16x16x32_bf16 v[132:135], a[56:59], a[104:107], v[132:135]
    v_mfma_f32_16x16x32_bf16 v[136:139], a[20:23], a[0:3], v[136:139]
    ds_read_b32 a158, v62
    v_perm_b32 v63, v117, v35, s39
    v_mfma_f32_16x16x32_bf16 v[136:139], a[56:59], a[8:11], v[136:139]
    ds_read_b128 a[216:219], v43 offset:34816
    v_mfma_f32_16x16x32_bf16 v[140:143], a[20:23], a[16:19], v[140:143]
    ds_read_b32 a159, v63
    v_perm_b32 v56, v94, v35, s36
    v_mfma_f32_16x16x32_bf16 v[140:143], a[56:59], a[28:31], v[140:143]
    ds_read_b128 a[4:7], v42 offset:32768
    v_mfma_f32_16x16x32_bf16 v[144:147], a[20:23], a[40:43], v[144:147]
    ds_read_b32 a184, v56
    v_perm_b32 v57, v94, v35, s37
    v_mfma_f32_16x16x32_bf16 v[144:147], a[56:59], a[44:47], v[144:147]
    v_mfma_f32_16x16x32_bf16 v[148:151], a[20:23], a[52:55], v[148:151]
    ds_read_b32 a185, v57
    v_perm_b32 v58, v94, v35, s38
    v_mfma_f32_16x16x32_bf16 v[148:151], a[56:59], a[68:71], v[148:151]
    s_waitcnt vmcnt(18)
    ds_read_b128 a[168:171], v43 offset:32768
    v_bitop3_b32 v85, v85, v87, s76 bitop3:0x7e
    v_mfma_f32_16x16x32_bf16 v[152:155], a[20:23], a[116:119], v[152:155]
    s_waitcnt lgkmcnt(7)
    ds_read_b32 a186, v58
    v_perm_b32 v59, v94, v35, s39
    v_mfma_f32_16x16x32_bf16 v[152:155], a[56:59], a[80:83], v[152:155]
    s_waitcnt vmcnt(9)
    ds_read_b128 a[172:175], v42 offset:38912
    v_bitop3_b32 v101, v101, v103, s76 bitop3:0x7e
    v_mfma_f32_16x16x32_bf16 v[156:159], a[20:23], a[96:99], v[156:159]
    ds_read_b32 a187, v59
    v_cmp_ne_u32 vcc, 0, v101
    v_mfma_f32_16x16x32_bf16 v[156:159], a[56:59], a[124:127], v[156:159]
    v_perm_b32 v60, v118, v35, s36
    v_mfma_f32_16x16x32_bf16 v[160:163], a[132:135], a[148:151], v[160:163]
    s_waitcnt lgkmcnt(6)
    ds_read_b32 a84, v60
    s_cbranch_vccnz L_slow6_2
L_back6_2:
    v_mfma_f32_16x16x32_bf16 v[160:163], a[156:159], a[160:163], v[160:163]
    v_cmp_ne_u32 vcc, 0, v85
    v_perm_b32 v61, v118, v35, s37
    v_mfma_f32_16x16x32_bf16 v[164:167], a[132:135], a[60:63], v[164:167]
    ds_read_b32 a85, v61
    v_perm_b32 v62, v118, v35, s38
    v_mfma_f32_16x16x32_bf16 v[164:167], a[156:159], a[104:107], v[164:167]
    ds_read_b128 a[88:91], v43 offset:38912
    s_cbranch_vccnz L_slow3_2
L_back3_2:
    v_mfma_f32_16x16x32_bf16 v[168:171], a[132:135], a[0:3], v[168:171]
    ds_read_b32 a86, v62
    v_perm_b32 v63, v118, v35, s39
    v_mfma_f32_16x16x32_bf16 v[168:171], a[156:159], a[8:11], v[168:171]
    ds_read_b128 a[100:103], v42 offset:36864
    v_perm_b32 v56, v100, v35, s36
    v_mfma_f32_16x16x32_bf16 v[172:175], a[132:135], a[16:19], v[172:175]
    s_mov_b32 s42, 81920
    ds_read_b32 a87, v63
    ds_read_b32 a108, v56
    v_mfma_f32_16x16x32_bf16 v[172:175], a[156:159], a[28:31], v[172:175]
    ds_read_b128 a[112:115], v43 offset:36864
    v_perm_b32 v57, v84, v35, s36
    v_mfma_f32_16x16x32_bf16 v[176:179], a[132:135], a[40:43], v[176:179]
    ds_read_b32 a120, v57
    v_perm_b32 v58, v84, v35, s37
    v_mfma_f32_16x16x32_bf16 v[176:179], a[156:159], a[44:47], v[176:179]
    s_mov_b32 s43, 87040
    ds_read_b128 a[128:131], v42 offset:43008
    v_mfma_f32_16x16x32_bf16 v[180:183], a[132:135], a[52:55], v[180:183]
    buffer_load_dwordx2 v[112:113], v34, s[12:15], s42 offen sc1
L_pad2:
    s_cbranch_execz L_warmed
    v_mfma_f32_16x16x32_bf16 v[180:183], a[156:159], a[68:71], v[180:183]
    ds_read_b32 a121, v58
    v_perm_b32 v59, v84, v35, s38
    v_mfma_f32_16x16x32_bf16 v[184:187], a[132:135], a[116:119], v[184:187]
    ds_read_b32 a122, v59
    v_bitop3_b32 v91, v91, v123, s76 bitop3:0x7e
    v_mfma_f32_16x16x32_bf16 v[184:187], a[156:159], a[80:83], v[184:187]
    ds_read_b128 a[140:143], v43 offset:43008
    v_mfma_f32_16x16x32_bf16 v[188:191], a[132:135], a[96:99], v[188:191]
    buffer_load_dwordx2 v[114:115], v34, s[12:15], s43 offen sc1
    v_mfma_f32_16x16x32_bf16 v[188:191], a[156:159], a[124:127], v[188:191]
    s_waitcnt lgkmcnt(6)
    v_cmp_ne_u32 vcc, 0, v91
    v_perm_b32 v60, v84, v35, s39
    v_mfma_f32_16x16x32_bf16 v[192:195], a[184:187], a[148:151], v[192:195]
    ds_read_b32 a123, v60
    v_perm_b32 v61, v86, v35, s36
    v_mfma_f32_16x16x32_bf16 v[192:195], a[84:87], a[160:163], v[192:195]
    ds_read_b32 a144, v61
    s_cbranch_vccnz L_slow3_1
L_back3_1:
    v_mfma_f32_16x16x32_bf16 v[196:199], a[184:187], a[60:63], v[196:199]
    ds_read_b128 a[152:155], v42 offset:40960
    v_perm_b32 v62, v86, v35, s37
    v_mfma_f32_16x16x32_bf16 v[196:199], a[84:87], a[104:107], v[196:199]
    s_waitcnt vmcnt(9)
    ds_read_b32 a145, v62
    v_bitop3_b32 v127, v127, v67, s76 bitop3:0x7e
    v_mfma_f32_16x16x32_bf16 v[200:203], a[184:187], a[0:3], v[200:203]
    s_add_u32 s56, s55, 1280
    v_perm_b32 v63, v86, v35, s38
    v_perm_b32 v56, v86, v35, s39
    v_mfma_f32_16x16x32_bf16 v[200:203], a[84:87], a[8:11], v[200:203]
    ds_read_b32 a146, v63
    v_cmp_ne_u32 vcc, 0, v127
    v_mfma_f32_16x16x32_bf16 v[204:207], a[184:187], a[16:19], v[204:207]
    s_mov_b32 s44, 81920
    ds_read_b32 a147, v56
    ds_read_b128 a[188:191], v43 offset:40960
    v_mfma_f32_16x16x32_bf16 v[204:207], a[84:87], a[28:31], v[204:207]
    v_perm_b32 v57, v88, v35, s36
    s_cbranch_vccnz L_slow6_0
L_back6_0:
    v_mfma_f32_16x16x32_bf16 v[208:211], a[184:187], a[40:43], v[208:211]
    s_add_u32 m0, s57, 0
    ds_read_b128 a[164:167], v42 offset:47104
    ds_read_b32 a200, v57
    v_mfma_f32_16x16x32_bf16 v[208:211], a[84:87], a[44:47], v[208:211]
    s_mov_b32 s45, 87040
    ds_read_b128 a[208:211], v43 offset:47104
    v_mfma_f32_16x16x32_bf16 v[212:215], a[184:187], a[52:55], v[212:215]
    buffer_load_dwordx4 v[48:51], v33, s[12:15], s44 offen sc1
    v_mfma_f32_16x16x32_bf16 v[212:215], a[84:87], a[68:71], v[212:215]
    v_perm_b32 v58, v88, v35, s37
    v_perm_b32 v59, v88, v35, s38
    v_mfma_f32_16x16x32_bf16 v[216:219], a[184:187], a[116:119], v[216:219]
    ds_read_b32 a201, v58
    ds_read_b32 a202, v59
    v_mfma_f32_16x16x32_bf16 v[216:219], a[84:87], a[80:83], v[216:219]
    ds_read_b128 a[232:235], v42 offset:45056
    v_mfma_f32_16x16x32_bf16 v[220:223], a[184:187], a[96:99], v[220:223]
    buffer_load_dwordx4 v[52:55], v33, s[12:15], s45 offen sc1
    v_mfma_f32_16x16x32_bf16 v[220:223], a[84:87], a[124:127], v[220:223]
    s_waitcnt lgkmcnt(6)
    v_perm_b32 v60, v88, v35, s39
    v_perm_b32 v61, v120, v35, s36
    v_mfma_f32_16x16x32_bf16 v[224:227], a[120:123], a[148:151], v[224:227]
    ds_read_b32 a203, v60
    ds_read_b32 a224, v61
    v_mfma_f32_16x16x32_bf16 v[224:227], a[144:147], a[160:163], v[224:227]
    ds_read_b128 a[248:251], v43 offset:45056
    v_mfma_f32_16x16x32_bf16 v[228:231], a[120:123], a[60:63], v[228:231]
    buffer_load_dwordx4 v36, s[8:11], s56 offen offset:0 lds
    v_mfma_f32_16x16x32_bf16 v[228:231], a[144:147], a[104:107], v[228:231]
    v_perm_b32 v62, v120, v35, s37
    v_perm_b32 v63, v120, v35, s38
    v_mfma_f32_16x16x32_bf16 v[232:235], a[120:123], a[0:3], v[232:235]
    ds_read_b32 a225, v62
    v_perm_b32 v56, v120, v35, s39
    v_mfma_f32_16x16x32_bf16 v[232:235], a[144:147], a[8:11], v[232:235]
    ds_read_b32 a226, v63
    v_mfma_f32_16x16x32_bf16 v[236:239], a[120:123], a[16:19], v[236:239]
    buffer_load_dwordx4 v37, s[8:11], s56 offen offset:1024 lds
    v_mfma_f32_16x16x32_bf16 v[236:239], a[144:147], a[28:31], v[236:239]
    ds_read_b32 a227, v56
    v_perm_b32 v57, v89, v35, s36
    v_mfma_f32_16x16x32_bf16 v[240:243], a[120:123], a[40:43], v[240:243]
    ds_read_b32 a32, v57
    v_perm_b32 v58, v89, v35, s37
    v_mfma_f32_16x16x32_bf16 v[240:243], a[144:147], a[44:47], v[240:243]
    v_perm_b32 v59, v100, v35, s37
    v_mfma_f32_16x16x32_bf16 v[244:247], a[120:123], a[52:55], v[244:247]
    buffer_load_dwordx4 v38, s[8:11], s56 offen offset:2048 lds
    v_mfma_f32_16x16x32_bf16 v[244:247], a[144:147], a[68:71], v[244:247]
    s_waitcnt vmcnt(7) lgkmcnt(4)
    ds_read_b32 a109, v59
    ds_read_b32 a33, v58
    v_mfma_f32_16x16x32_bf16 v[248:251], a[120:123], a[116:119], v[248:251]
    s_barrier
    v_mfma_f32_16x16x32_bf16 v[248:251], a[144:147], a[80:83], v[248:251]
    s_add_u32 s3, s55, 1408
    v_perm_b32 v60, v89, v35, s38
    v_mfma_f32_16x16x32_bf16 v[252:255], a[120:123], a[96:99], v[252:255]
    buffer_load_dwordx4 v39, s[8:11], s56 offen offset:3072 lds
    v_mfma_f32_16x16x32_bf16 v[252:255], a[144:147], a[124:127], v[252:255]
    s_add_u32 m0, s57, 18432
    ds_read_b32 a34, v60
    v_perm_b32 v61, v89, v35, s39
    v_mfma_f32_16x16x32_bf16 v[128:131], a[200:203], a[136:139], v[128:131]
    s_waitcnt lgkmcnt(4)
    ds_read_b32 a35, v61
    v_perm_b32 v62, v121, v35, s36
    v_mfma_f32_16x16x32_bf16 v[128:131], a[224:227], a[216:219], v[128:131]
    ds_read_b32 a72, v62
    ds_read_b128 a[64:67], v44 offset:0
    v_mfma_f32_16x16x32_bf16 v[132:135], a[200:203], a[4:7], v[132:135]
    buffer_load_dwordx4 v36, s[8:11], s3 offen offset:0 lds
    v_mfma_f32_16x16x32_bf16 v[132:135], a[224:227], a[168:171], v[132:135]
    v_perm_b32 v63, v121, v35, s37
    v_bitop3_b32 v71, v71, v75, s76 bitop3:0x7e
    v_mfma_f32_16x16x32_bf16 v[136:139], a[200:203], a[172:175], v[136:139]
    v_perm_b32 v56, v121, v35, s38
    v_perm_b32 v57, v121, v35, s39
    v_mfma_f32_16x16x32_bf16 v[136:139], a[224:227], a[88:91], v[136:139]
    ds_read_b32 a73, v63
    ds_read_b32 a74, v56
    v_mfma_f32_16x16x32_bf16 v[140:143], a[200:203], a[100:103], v[140:143]
    ds_read_b32 a75, v57
    v_cmp_ne_u32 vcc, 0, v71
    v_mfma_f32_16x16x32_bf16 v[140:143], a[224:227], a[112:115], v[140:143]
    ds_read_b128 a[244:247], v45 offset:0
    v_mfma_f32_16x16x32_bf16 v[144:147], a[200:203], a[128:131], v[144:147]
    buffer_load_dwordx4 v37, s[8:11], s3 offen offset:1024 lds
    v_mfma_f32_16x16x32_bf16 v[144:147], a[224:227], a[140:143], v[144:147]
    v_perm_b32 v58, v90, v35, s36
    s_cbranch_vccnz L_slow6_1
L_back6_1:
    v_mfma_f32_16x16x32_bf16 v[148:151], a[200:203], a[152:155], v[148:151]
    ds_read_b32 a48, v58
    v_perm_b32 v59, v90, v35, s37
    v_mfma_f32_16x16x32_bf16 v[148:151], a[224:227], a[188:191], v[148:151]
    s_add_u32 m0, s57, 14336
    ds_read_b128 a[92:95], v44 offset:2048
    ds_read_b32 a49, v59
    v_mfma_f32_16x16x32_bf16 v[152:155], a[200:203], a[164:167], v[152:155]
    v_perm_b32 v60, v90, v35, s38
    v_bitop3_b32 v99, v99, v111, s76 bitop3:0x7e
    v_mfma_f32_16x16x32_bf16 v[152:155], a[224:227], a[208:211], v[152:155]
    ds_read_b32 a50, v60
    ds_read_b128 a[176:179], v45 offset:2048
    v_mfma_f32_16x16x32_bf16 v[156:159], a[200:203], a[232:235], v[156:159]
    buffer_load_dwordx4 v38, s[8:11], s3 offen offset:2048 lds
    v_mfma_f32_16x16x32_bf16 v[156:159], a[224:227], a[248:251], v[156:159]
    s_waitcnt lgkmcnt(6)
    v_cmp_ne_u32 vcc, 0, v99
    v_perm_b32 v61, v90, v35, s39
    v_mfma_f32_16x16x32_bf16 v[160:163], a[32:35], a[136:139], v[160:163]
    ds_read_b32 a51, v61
    v_perm_b32 v62, v100, v35, s38
    v_mfma_f32_16x16x32_bf16 v[160:163], a[72:75], a[216:219], v[160:163]
    ds_read_b32 a110, v62
    s_cbranch_vccnz L_slow4_0
L_back4_0:
    v_mfma_f32_16x16x32_bf16 v[164:167], a[32:35], a[4:7], v[164:167]
    ds_read_b128 a[180:183], v44 offset:4096
    v_perm_b32 v63, v122, v35, s36
    v_mfma_f32_16x16x32_bf16 v[164:167], a[72:75], a[168:171], v[164:167]
    ds_read_b32 a196, v63
    ds_read_b128 a[192:195], v45 offset:4096
    v_mfma_f32_16x16x32_bf16 v[168:171], a[32:35], a[172:175], v[168:171]
    buffer_load_dwordx4 v39, s[8:11], s3 offen offset:3072 lds
    v_mfma_f32_16x16x32_bf16 v[168:171], a[72:75], a[88:91], v[168:171]
    v_perm_b32 v56, v122, v35, s37
    v_perm_b32 v57, v122, v35, s38
    v_mfma_f32_16x16x32_bf16 v[172:175], a[32:35], a[100:103], v[172:175]
    s_mov_b32 s40, 102400
    ds_read_b32 a197, v56
    v_perm_b32 v58, v122, v35, s39
    v_mfma_f32_16x16x32_bf16 v[172:175], a[72:75], a[112:115], v[172:175]
    ds_read_b32 a198, v57
    ds_read_b32 a199, v58
    v_mfma_f32_16x16x32_bf16 v[176:179], a[32:35], a[128:131], v[176:179]
    v_perm_b32 v59, v100, v35, s39
    v_perm_b32 v60, v102, v35, s36
    v_mfma_f32_16x16x32_bf16 v[176:179], a[72:75], a[140:143], v[176:179]
    s_mov_b32 s41, 107520
    ds_read_b32 a111, v59
    ds_read_b32 a204, v60
    v_mfma_f32_16x16x32_bf16 v[180:183], a[32:35], a[152:155], v[180:183]
    buffer_load_dwordx4 v[76:79], v32, s[12:15], s40 offen sc1
    v_mfma_f32_16x16x32_bf16 v[180:183], a[72:75], a[188:191], v[180:183]
    ds_read_b128 a[212:215], v44 offset:6144
    v_perm_b32 v61, v96, v35, s36
    v_mfma_f32_16x16x32_bf16 v[184:187], a[32:35], a[164:167], v[184:187]
    ds_read_b32 a220, v61
    v_perm_b32 v62, v96, v35, s37
    v_mfma_f32_16x16x32_bf16 v[184:187], a[72:75], a[208:211], v[184:187]
    ds_read_b128 a[228:231], v45 offset:6144
    ds_read_b32 a221, v62
    v_mfma_f32_16x16x32_bf16 v[188:191], a[32:35], a[232:235], v[188:191]
    buffer_load_dwordx4 v[80:83], v32, s[12:15], s41 offen sc1
    v_mfma_f32_16x16x32_bf16 v[188:191], a[72:75], a[248:251], v[188:191]
    s_waitcnt lgkmcnt(8)
    v_perm_b32 v56, v102, v35, s37
    v_perm_b32 v63, v96, v35, s38
    v_mfma_f32_16x16x32_bf16 v[192:195], a[48:51], a[136:139], v[192:195]
    s_waitcnt lgkmcnt(6)
    ds_read_b32 a205, v56
    ds_read_b128 a[236:239], v44 offset:8192
    v_mfma_f32_16x16x32_bf16 v[192:195], a[196:199], a[216:219], v[192:195]
    ds_read_b32 a222, v63
    v_perm_b32 v57, v96, v35, s39
    v_mfma_f32_16x16x32_bf16 v[196:199], a[48:51], a[4:7], v[196:199]
    ds_read_b32 a223, v57
    v_perm_b32 v58, v102, v35, s38
    v_mfma_f32_16x16x32_bf16 v[196:199], a[196:199], a[168:171], v[196:199]
    ds_read_b32 a206, v58
    v_perm_b32 v59, v108, v35, s36
    v_mfma_f32_16x16x32_bf16 v[200:203], a[48:51], a[172:175], v[200:203]
    v_perm_b32 v60, v108, v35, s37
    v_perm_b32 v61, v108, v35, s38
    v_mfma_f32_16x16x32_bf16 v[200:203], a[196:199], a[88:91], v[200:203]
    ds_read_b32 a240, v59
    v_perm_b32 v62, v108, v35, s39
    v_mfma_f32_16x16x32_bf16 v[204:207], a[48:51], a[100:103], v[204:207]
    ds_read_b32 a241, v60
    ds_read_b32 a242, v61
    v_mfma_f32_16x16x32_bf16 v[204:207], a[196:199], a[112:115], v[204:207]
    ds_read_b32 a243, v62
    ds_read_b128 a[252:255], v45 offset:8192
    v_mfma_f32_16x16x32_bf16 v[208:211], a[48:51], a[128:131], v[208:211]
    ds_read_b128 a[24:27], v44 offset:10240
    v_perm_b32 v56, v102, v35, s39
    v_mfma_f32_16x16x32_bf16 v[208:211], a[196:199], a[140:143], v[208:211]
    ds_read_b32 a207, v56
    ds_read_b128 a[76:79], v45 offset:10240
    v_mfma_f32_16x16x32_bf16 v[212:215], a[48:51], a[152:155], v[212:215]
    v_perm_b32 v57, v124, v35, s36
    v_perm_b32 v63, v97, v35, s36
    v_mfma_f32_16x16x32_bf16 v[212:215], a[196:199], a[188:191], v[212:215]
    ds_read_b32 a12, v57
    ds_read_b128 a[36:39], v44 offset:12288
    v_mfma_f32_16x16x32_bf16 v[216:219], a[48:51], a[164:167], v[216:219]
    ds_read_b32 a20, v63
    v_perm_b32 v58, v97, v35, s37
    v_mfma_f32_16x16x32_bf16 v[216:219], a[196:199], a[208:211], v[216:219]
    ds_read_b32 a21, v58
    v_perm_b32 v59, v124, v35, s37
    v_mfma_f32_16x16x32_bf16 v[220:223], a[48:51], a[232:235], v[220:223]
    ds_read_b32 a13, v59
    v_perm_b32 v60, v97, v35, s38
    v_mfma_f32_16x16x32_bf16 v[220:223], a[196:199], a[248:251], v[220:223]
    s_waitcnt lgkmcnt(10)
    ds_read_b128 a[56:59], v45 offset:12288
    ds_read_b32 a22, v60
    v_mfma_f32_16x16x32_bf16 v[128:131], a[220:223], a[64:67], v[128:131]
    s_waitcnt lgkmcnt(10)
    v_perm_b32 v61, v97, v35, s39
    v_perm_b32 v62, v124, v35, s38
    v_mfma_f32_16x16x32_bf16 v[128:131], a[240:243], a[244:247], v[128:131]
    ds_read_b32 a14, v62
    ds_read_b128 a[132:135], v44 offset:14336
    v_mfma_f32_16x16x32_bf16 v[132:135], a[220:223], a[92:95], v[132:135]
    ds_read_b32 a23, v61
    v_perm_b32 v56, v109, v35, s36
    v_mfma_f32_16x16x32_bf16 v[132:135], a[240:243], a[176:179], v[132:135]
    ds_read_b128 a[156:159], v45 offset:14336
    ds_read_b32 a184, v56
    v_mfma_f32_16x16x32_bf16 v[136:139], a[220:223], a[180:183], v[136:139]
    v_perm_b32 v57, v109, v35, s37
    v_perm_b32 v63, v109, v35, s38
    v_mfma_f32_16x16x32_bf16 v[136:139], a[240:243], a[192:195], v[136:139]
    ds_read_b32 a185, v57
    v_perm_b32 v58, v109, v35, s39
    v_mfma_f32_16x16x32_bf16 v[140:143], a[220:223], a[212:215], v[140:143]
    ds_read_b32 a186, v63
    ds_read_b32 a187, v58
    v_mfma_f32_16x16x32_bf16 v[140:143], a[240:243], a[228:231], v[140:143]
    ds_read_b128 a[84:87], v46 offset:2048
    v_perm_b32 v59, v124, v35, s39
    v_mfma_f32_16x16x32_bf16 v[144:147], a[220:223], a[236:239], v[144:147]
    ds_read_b32 a15, v59
    v_perm_b32 v60, v64, v35, s36
    v_mfma_f32_16x16x32_bf16 v[144:147], a[240:243], a[252:255], v[144:147]
    s_waitcnt lgkmcnt(10)
    ds_read_b32 a148, v60
    v_perm_b32 v62, v98, v35, s36
    v_mfma_f32_16x16x32_bf16 v[148:151], a[220:223], a[24:27], v[148:151]
    ds_read_b128 a[160:163], v47 offset:2048
    ds_read_b32 a60, v62
    v_mfma_f32_16x16x32_bf16 v[148:151], a[240:243], a[76:79], v[148:151]
    v_perm_b32 v61, v98, v35, s37
    v_perm_b32 v56, v64, v35, s37
    v_mfma_f32_16x16x32_bf16 v[152:155], a[220:223], a[36:39], v[152:155]
    s_waitcnt lgkmcnt(8)
    ds_read_b32 a149, v56
    ds_read_b128 a[104:107], v46 offset:0
    v_mfma_f32_16x16x32_bf16 v[152:155], a[240:243], a[56:59], v[152:155]
    s_mov_b32 s42, 143360
    ds_read_b32 a61, v61
    v_perm_b32 v57, v98, v35, s38
    v_mfma_f32_16x16x32_bf16 v[156:159], a[220:223], a[132:135], v[156:159]
    s_waitcnt vmcnt(12)
    ds_read_b32 a62, v57
    v_bitop3_b32 v113, v113, v115, s76 bitop3:0x7e
    v_mfma_f32_16x16x32_bf16 v[156:159], a[240:243], a[156:159], v[156:159]
    s_waitcnt lgkmcnt(9)
    v_cmp_ne_u32 vcc, 0, v113
    v_perm_b32 v63, v98, v35, s39
    v_mfma_f32_16x16x32_bf16 v[160:163], a[20:23], a[64:67], v[160:163]
    s_mov_b32 s43, 148480
    ds_read_b128 a[0:3], v47 offset:0
    ds_read_b32 a63, v63
    v_mfma_f32_16x16x32_bf16 v[160:163], a[184:187], a[244:247], v[160:163]
    buffer_load_dwordx2 v[104:105], v34, s[12:15], s42 offen sc1
    v_mfma_f32_16x16x32_bf16 v[164:167], a[20:23], a[92:95], v[164:167]
    v_perm_b32 v58, v64, v35, s38
    s_cbranch_vccnz L_slow4_2
L_back4_2:
    v_mfma_f32_16x16x32_bf16 v[164:167], a[184:187], a[176:179], v[164:167]
    ds_read_b32 a150, v58
    v_perm_b32 v59, v110, v35, s36
    v_mfma_f32_16x16x32_bf16 v[168:171], a[20:23], a[180:183], v[168:171]
    ds_read_b128 a[8:11], v46 offset:6144
    ds_read_b32 a16, v59
    v_mfma_f32_16x16x32_bf16 v[168:171], a[184:187], a[192:195], v[168:171]
    buffer_load_dwordx2 v[106:107], v34, s[12:15], s43 offen sc1
    v_mfma_f32_16x16x32_bf16 v[172:175], a[20:23], a[212:215], v[172:175]
    s_mov_b32 s44, 102400
    v_perm_b32 v60, v110, v35, s37
    v_perm_b32 v62, v110, v35, s38
    v_mfma_f32_16x16x32_bf16 v[172:175], a[184:187], a[228:231], v[172:175]
    ds_read_b32 a17, v60
    v_perm_b32 v56, v110, v35, s39
    v_mfma_f32_16x16x32_bf16 v[176:179], a[20:23], a[236:239], v[176:179]
    ds_read_b32 a18, v62
    ds_read_b32 a19, v56
    v_mfma_f32_16x16x32_bf16 v[176:179], a[184:187], a[252:255], v[176:179]
    s_mov_b32 s45, 107520
    ds_read_b128 a[28:31], v47 offset:6144
    v_mfma_f32_16x16x32_bf16 v[180:183], a[20:23], a[24:27], v[180:183]
    buffer_load_dwordx2 v[92:93], v34, s[12:15], s44 offen sc1
    v_mfma_f32_16x16x32_bf16 v[180:183], a[184:187], a[76:79], v[180:183]
    v_perm_b32 v61, v64, v35, s39
    v_perm_b32 v57, v68, v35, s36
    v_mfma_f32_16x16x32_bf16 v[184:187], a[20:23], a[36:39], v[184:187]
    ds_read_b32 a151, v61
    ds_read_b32 a40, v57
    v_mfma_f32_16x16x32_bf16 v[184:187], a[184:187], a[56:59], v[184:187]
    ds_read_b128 a[44:47], v46 offset:4096
    v_mfma_f32_16x16x32_bf16 v[188:191], a[20:23], a[132:135], v[188:191]
    buffer_load_dwordx2 v[94:95], v34, s[12:15], s45 offen sc1
    v_mfma_f32_16x16x32_bf16 v[188:191], a[184:187], a[156:159], v[188:191]
    s_waitcnt lgkmcnt(7)
    v_perm_b32 v63, v112, v35, s36
    v_perm_b32 v58, v112, v35, s37
    v_mfma_f32_16x16x32_bf16 v[192:195], a[60:63], a[64:67], v[192:195]
    s_waitcnt lgkmcnt(4)
    ds_read_b32 a68, v63
    ds_read_b128 a[52:55], v47 offset:4096
    v_mfma_f32_16x16x32_bf16 v[192:195], a[16:19], a[244:247], v[192:195]
    ds_read_b32 a69, v58
    v_perm_b32 v59, v68, v35, s37
    v_mfma_f32_16x16x32_bf16 v[196:199], a[60:63], a[92:95], v[196:199]
    ds_read_b32 a41, v59
    v_perm_b32 v60, v112, v35, s38
    v_mfma_f32_16x16x32_bf16 v[196:199], a[16:19], a[176:179], v[196:199]
    ds_read_b128 a[116:119], v46 offset:10240
    v_perm_b32 v62, v112, v35, s39
    v_mfma_f32_16x16x32_bf16 v[200:203], a[60:63], a[180:183], v[200:203]
    s_add_u32 s56, s55, 1536
    ds_read_b32 a70, v60
    ds_read_b32 a71, v62
    v_mfma_f32_16x16x32_bf16 v[200:203], a[16:19], a[192:195], v[200:203]
    s_waitcnt vmcnt(14)
    v_perm_b32 v56, v114, v35, s36
    v_perm_b32 v61, v114, v35, s37
    v_mfma_f32_16x16x32_bf16 v[204:207], a[60:63], a[212:215], v[204:207]
    s_mov_b32 s40, 102400
    v_perm_b32 v57, v114, v35, s38
    v_perm_b32 v63, v114, v35, s39
    v_mfma_f32_16x16x32_bf16 v[204:207], a[16:19], a[228:231], v[204:207]
    s_add_u32 m0, s57, 32768
    ds_read_b32 a80, v56
    ds_read_b32 a81, v61
    v_mfma_f32_16x16x32_bf16 v[208:211], a[60:63], a[236:239], v[208:211]
    ds_read_b32 a82, v57
    ds_read_b32 a83, v63
    v_bitop3_b32 v51, v51, v55, s76 bitop3:0x7e
    v_mfma_f32_16x16x32_bf16 v[208:211], a[16:19], a[252:255], v[208:211]
    s_mov_b32 s41, 107520
    ds_read_b128 a[96:99], v47 offset:10240
    v_mfma_f32_16x16x32_bf16 v[212:215], a[60:63], a[24:27], v[212:215]
    buffer_load_dwordx4 v[116:119], v33, s[12:15], s40 offen sc1
    v_mfma_f32_16x16x32_bf16 v[212:215], a[16:19], a[76:79], v[212:215]
    v_cmp_ne_u32 vcc, 0, v51
    v_perm_b32 v58, v68, v35, s38
    v_mfma_f32_16x16x32_bf16 v[216:219], a[60:63], a[36:39], v[216:219]
    ds_read_b32 a42, v58
    v_perm_b32 v59, v68, v35, s39
    v_mfma_f32_16x16x32_bf16 v[216:219], a[16:19], a[56:59], v[216:219]
    s_waitcnt lgkmcnt(6)
    ds_read_b32 a43, v59
    s_cbranch_vccnz L_slow4_1
L_back4_1:
    v_mfma_f32_16x16x32_bf16 v[220:223], a[60:63], a[132:135], v[220:223]
    buffer_load_dwordx4 v[84:87], v33, s[12:15], s41 offen sc1
    v_mfma_f32_16x16x32_bf16 v[220:223], a[16:19], a[156:159], v[220:223]
    s_mov_b32 s42, 143360
    ds_read_b128 a[120:123], v46 offset:8192
    v_perm_b32 v60, v72, v35, s36
    v_mfma_f32_16x16x32_bf16 v[224:227], a[68:71], a[64:67], v[224:227]
    s_waitcnt lgkmcnt(4)
    s_mov_b32 s43, 148480
    ds_read_b32 a144, v60
    ds_read_b128 a[124:127], v47 offset:8192
    v_mfma_f32_16x16x32_bf16 v[224:227], a[80:83], a[244:247], v[224:227]
    ds_read_b128 a[200:203], v46 offset:14336
    v_mfma_f32_16x16x32_bf16 v[228:231], a[68:71], a[92:95], v[228:231]
    buffer_load_dwordx4 v[88:91], v32, s[12:15], s42 offen sc1
    v_mfma_f32_16x16x32_bf16 v[228:231], a[80:83], a[176:179], v[228:231]
    v_perm_b32 v62, v48, v35, s36
    v_perm_b32 v56, v48, v35, s37
    v_mfma_f32_16x16x32_bf16 v[232:235], a[68:71], a[180:183], v[232:235]
    ds_read_b32 a224, v62
    v_perm_b32 v61, v48, v35, s38
    v_perm_b32 v57, v48, v35, s39
    v_mfma_f32_16x16x32_bf16 v[232:235], a[80:83], a[192:195], v[232:235]
    ds_read_b32 a225, v56
    ds_read_b32 a226, v61
    v_mfma_f32_16x16x32_bf16 v[236:239], a[68:71], a[212:215], v[236:239]
    buffer_load_dwordx4 v[120:123], v32, s[12:15], s43 offen sc1
    v_mfma_f32_16x16x32_bf16 v[236:239], a[80:83], a[228:231], v[236:239]
    ds_read_b32 a227, v57
    v_perm_b32 v63, v52, v35, s36
    v_perm_b32 v58, v72, v35, s37
    v_mfma_f32_16x16x32_bf16 v[240:243], a[68:71], a[236:239], v[240:243]
    ds_read_b32 a145, v58
    v_perm_b32 v59, v52, v35, s37
    v_perm_b32 v60, v52, v35, s38
    v_mfma_f32_16x16x32_bf16 v[240:243], a[80:83], a[252:255], v[240:243]
    ds_read_b32 a32, v63
    v_perm_b32 v62, v52, v35, s39
    v_perm_b32 v56, v72, v35, s38
    v_mfma_f32_16x16x32_bf16 v[244:247], a[68:71], a[24:27], v[244:247]
    ds_read_b32 a33, v59
    ds_read_b32 a34, v60
    v_perm_b32 v61, v72, v35, s39
    v_mfma_f32_16x16x32_bf16 v[244:247], a[80:83], a[76:79], v[244:247]
    ds_read_b32 a35, v62
    ds_read_b32 a146, v56
    v_mfma_f32_16x16x32_bf16 v[248:251], a[68:71], a[36:39], v[248:251]
    buffer_load_dwordx4 v36, s[8:11], s56 offen offset:0 lds
    v_mfma_f32_16x16x32_bf16 v[248:251], a[80:83], a[56:59], v[248:251]
    s_add_u32 s3, s55, 1664
    ds_read_b32 a147, v61
    ds_read_b128 a[72:75], v47 offset:14336
    v_mfma_f32_16x16x32_bf16 v[252:255], a[68:71], a[132:135], v[252:255]
    ds_read_b128 a[136:139], v46 offset:12288
    v_perm_b32 v57, v125, v35, s36
    v_mfma_f32_16x16x32_bf16 v[252:255], a[80:83], a[156:159], v[252:255]
    s_waitcnt lgkmcnt(9)
    ds_read_b32 a4, v57
    ds_read_b128 a[216:219], v47 offset:12288
    v_mfma_f32_16x16x32_bf16 v[128:131], a[224:227], a[84:87], v[128:131]
    s_waitcnt lgkmcnt(6)
    buffer_load_dwordx4 v37, s[8:11], s56 offen offset:1024 lds
    v_mfma_f32_16x16x32_bf16 v[128:131], a[32:35], a[160:163], v[128:131]
    v_perm_b32 v58, v49, v35, s36
    v_perm_b32 v63, v49, v35, s37
    v_mfma_f32_16x16x32_bf16 v[132:135], a[224:227], a[104:107], v[132:135]
    ds_read_b32 a168, v58
    v_perm_b32 v59, v125, v35, s37
    v_mfma_f32_16x16x32_bf16 v[132:135], a[32:35], a[0:3], v[132:135]
    ds_read_b32 a5, v59
    ds_read_b32 a169, v63
    v_mfma_f32_16x16x32_bf16 v[136:139], a[224:227], a[8:11], v[136:139]
    buffer_load_dwordx4 v38, s[8:11], s56 offen offset:2048 lds
    v_mfma_f32_16x16x32_bf16 v[136:139], a[32:35], a[28:31], v[136:139]
    s_waitcnt vmcnt(13) lgkmcnt(3)
    v_perm_b32 v60, v49, v35, s38
    v_perm_b32 v62, v49, v35, s39
    v_mfma_f32_16x16x32_bf16 v[140:143], a[224:227], a[44:47], v[140:143]
    ds_read_b32 a170, v60
    ds_read_b32 a171, v62
    v_perm_b32 v56, v125, v35, s38
    v_mfma_f32_16x16x32_bf16 v[140:143], a[32:35], a[52:55], v[140:143]
    s_barrier
    v_mfma_f32_16x16x32_bf16 v[144:147], a[224:227], a[116:119], v[144:147]
    buffer_load_dwordx4 v39, s[8:11], s56 offen offset:3072 lds
    v_mfma_f32_16x16x32_bf16 v[144:147], a[32:35], a[96:99], v[144:147]
    s_add_u32 m0, s57, 51200
    v_perm_b32 v61, v53, v35, s36
    v_perm_b32 v57, v53, v35, s37
    v_mfma_f32_16x16x32_bf16 v[148:151], a[224:227], a[120:123], v[148:151]
    ds_read_b32 a172, v61
    v_perm_b32 v58, v53, v35, s38
    v_perm_b32 v63, v53, v35, s39
    v_mfma_f32_16x16x32_bf16 v[148:151], a[32:35], a[124:127], v[148:151]
    ds_read_b32 a173, v57
    ds_read_b32 a174, v58
    v_perm_b32 v59, v125, v35, s39
    v_mfma_f32_16x16x32_bf16 v[152:155], a[224:227], a[200:203], v[152:155]
    ds_read_b32 a175, v63
    ds_read_b32 a6, v56
    v_mfma_f32_16x16x32_bf16 v[152:155], a[32:35], a[72:75], v[152:155]
    buffer_load_dwordx4 v36, s[8:11], s3 offen offset:0 lds
    v_mfma_f32_16x16x32_bf16 v[156:159], a[224:227], a[136:139], v[156:159]
    s_mov_b32 s44, 143360
    ds_read_b32 a7, v59
    ds_read_b128 a[88:91], v40 offset:0
    v_mfma_f32_16x16x32_bf16 v[156:159], a[32:35], a[216:219], v[156:159]
    s_waitcnt lgkmcnt(7)
    v_perm_b32 v62, v65, v35, s36
    v_perm_b32 v60, v50, v35, s36
    v_mfma_f32_16x16x32_bf16 v[160:163], a[168:171], a[84:87], v[160:163]
    s_waitcnt lgkmcnt(3)
    s_mov_b32 s45, 148480
    ds_read_b32 a112, v62
    ds_read_b128 a[100:103], v41 offset:0
    v_mfma_f32_16x16x32_bf16 v[160:163], a[172:175], a[160:163], v[160:163]
    buffer_load_dwordx4 v[100:103], v33, s[12:15], s44 offen sc1
    v_mfma_f32_16x16x32_bf16 v[164:167], a[168:171], a[104:107], v[164:167]
    s_add_u32 s56, s55, 1792
    ds_read_b32 a128, v60
    v_perm_b32 v61, v50, v35, s37
    v_mfma_f32_16x16x32_bf16 v[164:167], a[172:175], a[0:3], v[164:167]
    ds_read_b32 a129, v61
    v_perm_b32 v57, v50, v35, s38
    v_perm_b32 v58, v50, v35, s39
    v_mfma_f32_16x16x32_bf16 v[168:171], a[168:171], a[8:11], v[168:171]
    ds_read_b32 a130, v57
    ds_read_b32 a131, v58
    v_mfma_f32_16x16x32_bf16 v[168:171], a[172:175], a[28:31], v[168:171]
    buffer_load_dwordx4 v[96:99], v33, s[12:15], s45 offen sc1
L_pad3:
    s_cbranch_execz L_pad4
    v_mfma_f32_16x16x32_bf16 v[172:175], a[168:171], a[44:47], v[172:175]
    v_perm_b32 v56, v54, v35, s36
    v_perm_b32 v63, v54, v35, s37
    v_mfma_f32_16x16x32_bf16 v[172:175], a[172:175], a[52:55], v[172:175]
    s_waitcnt vmcnt(15)
    v_perm_b32 v59, v54, v35, s38
    v_perm_b32 v62, v54, v35, s39
    v_mfma_f32_16x16x32_bf16 v[176:179], a[168:171], a[116:119], v[176:179]
    ds_read_b32 a140, v56
    ds_read_b32 a141, v63
    v_perm_b32 v60, v65, v35, s37
    v_mfma_f32_16x16x32_bf16 v[176:179], a[172:175], a[96:99], v[176:179]
    ds_read_b32 a142, v59
    ds_read_b32 a143, v62
    v_bitop3_b32 v79, v79, v83, s76 bitop3:0x7e
    v_mfma_f32_16x16x32_bf16 v[180:183], a[168:171], a[120:123], v[180:183]
    ds_read_b32 a113, v60
    ds_read_b128 a[152:155], v40 offset:2048
    v_mfma_f32_16x16x32_bf16 v[180:183], a[172:175], a[124:127], v[180:183]
    buffer_load_dwordx4 v37, s[8:11], s3 offen offset:1024 lds
    v_mfma_f32_16x16x32_bf16 v[184:187], a[168:171], a[200:203], v[184:187]
    s_add_u32 m0, s57, 47104
    ds_read_b128 a[188:191], v41 offset:2048
    v_cmp_ne_u32 vcc, 0, v79
    v_mfma_f32_16x16x32_bf16 v[184:187], a[172:175], a[72:75], v[184:187]
    ds_read_b128 a[164:167], v40 offset:4096
    v_perm_b32 v61, v65, v35, s38
    v_perm_b32 v57, v65, v35, s39
    v_mfma_f32_16x16x32_bf16 v[188:191], a[168:171], a[136:139], v[188:191]
    s_waitcnt lgkmcnt(8)
    ds_read_b32 a114, v61
    ds_read_b32 a115, v57
    v_mfma_f32_16x16x32_bf16 v[188:191], a[172:175], a[216:219], v[188:191]
    buffer_load_dwordx4 v38, s[8:11], s3 offen offset:2048 lds
    v_mfma_f32_16x16x32_bf16 v[192:195], a[128:131], a[84:87], v[192:195]
    s_waitcnt lgkmcnt(6)
    ds_read_b128 a[208:211], v41 offset:4096
    s_cbranch_vccnz L_slow5_0
L_back5_0:
    v_mfma_f32_16x16x32_bf16 v[192:195], a[140:143], a[160:163], v[192:195]
    ds_read_b128 a[232:235], v40 offset:6144
    v_perm_b32 v56, v69, v35, s36
    v_perm_b32 v58, v76, v35, s36
    v_mfma_f32_16x16x32_bf16 v[196:199], a[128:131], a[104:107], v[196:199]
    ds_read_b32 a248, v56
    ds_read_b32 a48, v58
    v_mfma_f32_16x16x32_bf16 v[196:199], a[140:143], a[0:3], v[196:199]
    buffer_load_dwordx4 v39, s[8:11], s3 offen offset:3072 lds
    v_mfma_f32_16x16x32_bf16 v[200:203], a[128:131], a[8:11], v[200:203]
    s_add_u32 m0, s57, 65536
    v_perm_b32 v63, v76, v35, s37
    v_perm_b32 v59, v76, v35, s38
    v_mfma_f32_16x16x32_bf16 v[200:203], a[140:143], a[28:31], v[200:203]
    ds_read_b32 a49, v63
    ds_read_b32 a50, v59
    v_perm_b32 v62, v76, v35, s39
    v_mfma_f32_16x16x32_bf16 v[204:207], a[128:131], a[44:47], v[204:207]
    ds_read_b32 a51, v62
    ds_read_b128 a[196:199], v41 offset:6144
    v_mfma_f32_16x16x32_bf16 v[204:207], a[140:143], a[52:55], v[204:207]
    buffer_load_dwordx4 v36, s[8:11], s56 offen offset:0 lds
    v_mfma_f32_16x16x32_bf16 v[208:211], a[128:131], a[116:119], v[208:211]
    v_perm_b32 v60, v80, v35, s36
    v_perm_b32 v61, v80, v35, s37
    v_mfma_f32_16x16x32_bf16 v[208:211], a[140:143], a[96:99], v[208:211]
    ds_read_b32 a220, v60
    v_perm_b32 v57, v80, v35, s38
    v_perm_b32 v58, v80, v35, s39
    v_mfma_f32_16x16x32_bf16 v[212:215], a[128:131], a[120:123], v[212:215]
    s_add_u32 s3, s55, 1920
    ds_read_b32 a221, v61
    ds_read_b32 a222, v57
    v_mfma_f32_16x16x32_bf16 v[212:215], a[140:143], a[124:127], v[212:215]
    buffer_load_dwordx4 v[108:111], v22, s[32:35], 0 offen
    v_mfma_f32_16x16x32_bf16 v[216:219], a[128:131], a[200:203], v[216:219]
    ds_read_b32 a223, v58
    ds_read_b128 a[240:243], v40 offset:8192
    v_perm_b32 v56, v69, v35, s37
    v_mfma_f32_16x16x32_bf16 v[216:219], a[140:143], a[72:75], v[216:219]
    ds_read_b128 a[20:23], v41 offset:8192
    ds_read_b32 a249, v56
    v_perm_b32 v63, v69, v35, s38
    v_mfma_f32_16x16x32_bf16 v[220:223], a[128:131], a[136:139], v[220:223]
    s_waitcnt lgkmcnt(8)
    ds_read_b128 a[184:187], v40 offset:10240
    ds_read_b32 a250, v63
    v_mfma_f32_16x16x32_bf16 v[220:223], a[140:143], a[216:219], v[220:223]
    buffer_load_dwordx2 v[112:113], v22, s[32:35], 0 offen offset:16
    v_mfma_f32_16x16x32_bf16 v[128:131], a[48:51], a[88:91], v[128:131]
    s_waitcnt lgkmcnt(5)
    ds_read_b128 a[60:63], v41 offset:10240
    v_perm_b32 v59, v69, v35, s39
    v_perm_b32 v62, v73, v35, s36
    v_mfma_f32_16x16x32_bf16 v[128:131], a[220:223], a[100:103], v[128:131]
    ds_read_b128 a[16:19], v40 offset:12288
    ds_read_b32 a251, v59
    v_perm_b32 v60, v77, v35, s36
    v_mfma_f32_16x16x32_bf16 v[132:135], a[48:51], a[152:155], v[132:135]
    ds_read_b128 a[64:67], v41 offset:12288
    ds_read_b32 a244, v62
    v_mfma_f32_16x16x32_bf16 v[132:135], a[220:223], a[188:191], v[132:135]
    buffer_load_dwordx4 v37, s[8:11], s56 offen offset:1024 lds
    v_mfma_f32_16x16x32_bf16 v[136:139], a[48:51], a[164:167], v[136:139]
    ds_read_b128 a[92:95], v40 offset:14336
    v_perm_b32 v61, v77, v35, s37
    v_perm_b32 v57, v77, v35, s38
    v_mfma_f32_16x16x32_bf16 v[136:139], a[220:223], a[208:211], v[136:139]
    ds_read_b128 a[176:179], v41 offset:14336
    ds_read_b32 a180, v60
    v_perm_b32 v58, v77, v35, s39
    v_mfma_f32_16x16x32_bf16 v[140:143], a[48:51], a[232:235], v[140:143]
    s_waitcnt lgkmcnt(9)
    ds_read_b32 a181, v61
    ds_read_b32 a182, v57
    v_mfma_f32_16x16x32_bf16 v[140:143], a[220:223], a[196:199], v[140:143]
    buffer_load_dwordx2 v[114:115], v23, s[32:35], 0 offen
    v_mfma_f32_16x16x32_bf16 v[144:147], a[48:51], a[240:243], v[144:147]
    ds_read_b32 a183, v58
    v_perm_b32 v56, v81, v35, s36
    v_perm_b32 v63, v73, v35, s37
    v_mfma_f32_16x16x32_bf16 v[144:147], a[220:223], a[20:23], v[144:147]
    ds_read_b32 a192, v56
    v_perm_b32 v59, v81, v35, s37
    v_perm_b32 v62, v81, v35, s38
    v_mfma_f32_16x16x32_bf16 v[148:151], a[48:51], a[184:187], v[148:151]
    s_waitcnt lgkmcnt(9)
    ds_read_b32 a193, v59
    ds_read_b32 a194, v62
    v_perm_b32 v60, v81, v35, s39
    v_mfma_f32_16x16x32_bf16 v[148:151], a[220:223], a[60:63], v[148:151]
    s_waitcnt lgkmcnt(9)
    ds_read_b32 a195, v60
    ds_read_b32 a245, v63
    v_mfma_f32_16x16x32_bf16 v[152:155], a[48:51], a[16:19], v[152:155]
    buffer_load_dwordx4 v38, s[8:11], s56 offen offset:2048 lds
    v_mfma_f32_16x16x32_bf16 v[152:155], a[220:223], a[64:67], v[152:155]
    s_waitcnt vmcnt(22) lgkmcnt(9)
    v_perm_b32 v61, v73, v35, s38
    v_perm_b32 v57, v73, v35, s39
    v_mfma_f32_16x16x32_bf16 v[156:159], a[48:51], a[92:95], v[156:159]
    ds_read_b32 a246, v61
    ds_read_b32 a247, v57
    v_bitop3_b32 v105, v105, v107, s76 bitop3:0x7e
    v_mfma_f32_16x16x32_bf16 v[156:159], a[220:223], a[176:179], v[156:159]
    s_waitcnt lgkmcnt(7)
    ds_read_b128 a[212:215], v42 offset:2048
    v_mfma_f32_16x16x32_bf16 v[160:163], a[180:183], a[88:91], v[160:163]
    s_waitcnt lgkmcnt(4)
    buffer_load_dwordx4 v39, s[8:11], s56 offen offset:3072 lds
    v_mfma_f32_16x16x32_bf16 v[160:163], a[192:195], a[100:103], v[160:163]
    s_add_u32 m0, s57, 83968
    v_cmp_ne_u32 vcc, 0, v105
    v_perm_b32 v58, v126, v35, s36
    v_mfma_f32_16x16x32_bf16 v[164:167], a[180:183], a[152:155], v[164:167]
    ds_read_b32 a228, v58
    v_perm_b32 v59, v126, v35, s37
    v_perm_b32 v56, v78, v35, s36
    v_mfma_f32_16x16x32_bf16 v[164:167], a[192:195], a[188:191], v[164:167]
    ds_read_b32 a229, v59
    s_cbranch_vccnz L_slow7_2
L_back7_2:
    v_mfma_f32_16x16x32_bf16 v[168:171], a[180:183], a[164:167], v[168:171]
    buffer_load_dwordx4 v36, s[8:11], s3 offen offset:0 lds
    v_mfma_f32_16x16x32_bf16 v[168:171], a[192:195], a[208:211], v[168:171]
    ds_read_b32 a236, v56
    v_perm_b32 v62, v78, v35, s37
    v_perm_b32 v63, v78, v35, s38
    v_mfma_f32_16x16x32_bf16 v[172:175], a[180:183], a[232:235], v[172:175]
    ds_read_b32 a237, v62
    ds_read_b32 a238, v63
    v_perm_b32 v60, v78, v35, s39
    v_mfma_f32_16x16x32_bf16 v[172:175], a[192:195], a[196:199], v[172:175]
    ds_read_b32 a239, v60
    v_perm_b32 v61, v82, v35, s36
    v_perm_b32 v57, v126, v35, s38
    v_mfma_f32_16x16x32_bf16 v[176:179], a[180:183], a[240:243], v[176:179]
    ds_read_b32 a230, v57
    v_perm_b32 v58, v82, v35, s37
    v_perm_b32 v59, v82, v35, s38
    v_mfma_f32_16x16x32_bf16 v[176:179], a[192:195], a[20:23], v[176:179]
    ds_read_b32 a252, v61
    v_perm_b32 v56, v82, v35, s39
    v_perm_b32 v62, v126, v35, s39
    v_mfma_f32_16x16x32_bf16 v[180:183], a[180:183], a[184:187], v[180:183]
    s_waitcnt vmcnt(22)
    ds_read_b32 a253, v58
    ds_read_b32 a254, v59
    v_bitop3_b32 v93, v93, v95, s76 bitop3:0x7e
    v_mfma_f32_16x16x32_bf16 v[180:183], a[192:195], a[60:63], v[180:183]
    ds_read_b32 a255, v56
    ds_read_b32 a231, v62
    v_mfma_f32_16x16x32_bf16 v[184:187], a[180:183], a[16:19], v[184:187]
    buffer_load_dwordx4 v37, s[8:11], s3 offen offset:1024 lds
    v_mfma_f32_16x16x32_bf16 v[184:187], a[192:195], a[64:67], v[184:187]
    s_add_u32 m0, s57, 79872
    ds_read_b128 a[24:27], v43 offset:2048
    v_cmp_ne_u32 vcc, 0, v93
    v_mfma_f32_16x16x32_bf16 v[188:191], a[180:183], a[92:95], v[188:191]
    ds_read_b128 a[76:79], v42 offset:0
    v_perm_b32 v63, v66, v35, s36
    v_perm_b32 v60, v66, v35, s37
    v_mfma_f32_16x16x32_bf16 v[188:191], a[192:195], a[176:179], v[188:191]
    s_waitcnt lgkmcnt(8)
    ds_read_b32 a36, v63
    ds_read_b32 a37, v60
    v_mfma_f32_16x16x32_bf16 v[192:195], a[236:239], a[88:91], v[192:195]
    s_waitcnt lgkmcnt(5)
    buffer_load_dwordx4 v38, s[8:11], s3 offen offset:2048 lds
    v_mfma_f32_16x16x32_bf16 v[192:195], a[252:255], a[100:103], v[192:195]
    ds_read_b128 a[56:59], v43 offset:0
    s_cbranch_vccnz L_slow5_2
L_back5_2:
    v_mfma_f32_16x16x32_bf16 v[196:199], a[236:239], a[152:155], v[196:199]
    ds_read_b128 a[132:135], v42 offset:6144
    v_perm_b32 v57, v66, v35, s38
    v_perm_b32 v61, v66, v35, s39
    v_mfma_f32_16x16x32_bf16 v[196:199], a[252:255], a[188:191], v[196:199]
    ds_read_b32 a38, v57
    ds_read_b32 a39, v61
    v_mfma_f32_16x16x32_bf16 v[200:203], a[236:239], a[164:167], v[200:203]
    buffer_load_dwordx4 v39, s[8:11], s3 offen offset:3072 lds
    v_mfma_f32_16x16x32_bf16 v[200:203], a[252:255], a[208:211], v[200:203]
    v_perm_b32 v58, v92, v35, s36
    v_perm_b32 v59, v92, v35, s37
    v_mfma_f32_16x16x32_bf16 v[204:207], a[236:239], a[232:235], v[204:207]
    ds_read_b32 a68, v58
    v_perm_b32 v56, v92, v35, s38
    v_perm_b32 v62, v92, v35, s39
    v_mfma_f32_16x16x32_bf16 v[204:207], a[252:255], a[196:199], v[204:207]
    ds_read_b32 a69, v59
    ds_read_b32 a70, v56
    v_perm_b32 v63, v94, v35, s36
    v_mfma_f32_16x16x32_bf16 v[208:211], a[236:239], a[240:243], v[208:211]
    ds_read_b32 a71, v62
    v_perm_b32 v60, v94, v35, s37
    v_perm_b32 v57, v70, v35, s36
    v_mfma_f32_16x16x32_bf16 v[208:211], a[252:255], a[20:23], v[208:211]
    ds_read_b32 a156, v63
    v_perm_b32 v61, v94, v35, s38
    v_perm_b32 v58, v94, v35, s39
    v_mfma_f32_16x16x32_bf16 v[212:215], a[236:239], a[184:187], v[212:215]
    ds_read_b32 a157, v60
    ds_read_b32 a158, v61
    v_perm_b32 v59, v70, v35, s37
    v_mfma_f32_16x16x32_bf16 v[212:215], a[252:255], a[60:63], v[212:215]
    s_waitcnt vmcnt(21)
    ds_read_b32 a159, v58
    ds_read_b32 a80, v57
    v_bitop3_b32 v119, v119, v87, s76 bitop3:0x7e
    v_mfma_f32_16x16x32_bf16 v[216:219], a[236:239], a[16:19], v[216:219]
    ds_read_b32 a81, v59
    ds_read_b128 a[224:227], v43 offset:6144
    v_cmp_ne_u32 vcc, 0, v119
    v_mfma_f32_16x16x32_bf16 v[216:219], a[252:255], a[64:67], v[216:219]
    ds_read_b128 a[32:35], v42 offset:4096
    v_perm_b32 v56, v70, v35, s38
    v_perm_b32 v62, v70, v35, s39
    v_mfma_f32_16x16x32_bf16 v[220:223], a[236:239], a[92:95], v[220:223]
    ds_read_b32 a82, v56
    ds_read_b32 a83, v62
    v_bitop3_b32 v91, v91, v123, s76 bitop3:0x7e
    v_mfma_f32_16x16x32_bf16 v[220:223], a[252:255], a[176:179], v[220:223]
    s_waitcnt lgkmcnt(10)
    ds_read_b128 a[168:171], v43 offset:4096
    s_cbranch_vccnz L_slow5_1
L_back5_1:
    v_mfma_f32_16x16x32_bf16 v[224:227], a[68:71], a[88:91], v[224:227]
    s_waitcnt lgkmcnt(7)
    ds_read_b128 a[172:175], v42 offset:10240
    v_cmp_ne_u32 vcc, 0, v91
    v_perm_b32 v63, v74, v35, s36
    v_mfma_f32_16x16x32_bf16 v[224:227], a[156:159], a[100:103], v[224:227]
    ds_read_b32 a160, v63
    ds_read_b128 a[84:87], v43 offset:10240
    v_perm_b32 v60, v74, v35, s37
    v_mfma_f32_16x16x32_bf16 v[228:231], a[68:71], a[152:155], v[228:231]
    ds_read_b32 a161, v60
    ds_read_b128 a[104:107], v42 offset:8192
    v_perm_b32 v61, v116, v35, s36
    v_mfma_f32_16x16x32_bf16 v[228:231], a[156:159], a[188:191], v[228:231]
    ds_read_b32 a0, v61
    v_perm_b32 v57, v116, v35, s37
    v_perm_b32 v58, v116, v35, s38
    v_mfma_f32_16x16x32_bf16 v[232:235], a[68:71], a[164:167], v[232:235]
    ds_read_b32 a1, v57
    v_perm_b32 v59, v116, v35, s39
    v_perm_b32 v56, v74, v35, s38
    v_mfma_f32_16x16x32_bf16 v[232:235], a[156:159], a[208:211], v[232:235]
    ds_read_b32 a2, v58
    ds_read_b32 a3, v59
    v_perm_b32 v62, v74, v35, s39
    v_mfma_f32_16x16x32_bf16 v[236:239], a[68:71], a[232:235], v[236:239]
    ds_read_b32 a162, v56
    v_perm_b32 v63, v84, v35, s36
    v_perm_b32 v60, v84, v35, s37
    v_mfma_f32_16x16x32_bf16 v[236:239], a[156:159], a[196:199], v[236:239]
    ds_read_b32 a163, v62
    v_perm_b32 v61, v84, v35, s38
    v_perm_b32 v57, v84, v35, s39
    v_mfma_f32_16x16x32_bf16 v[240:243], a[68:71], a[240:243], v[240:243]
    ds_read_b32 a8, v63
    ds_read_b32 a9, v60
    v_perm_b32 v58, v104, v35, s36
    v_mfma_f32_16x16x32_bf16 v[240:243], a[156:159], a[20:23], v[240:243]
    ds_read_b32 a10, v61
    ds_read_b32 a11, v57
    v_perm_b32 v59, v104, v35, s37
    v_mfma_f32_16x16x32_bf16 v[244:247], a[68:71], a[184:187], v[244:247]
    ds_read_b32 a28, v58
    ds_read_b32 a29, v59
    v_mfma_f32_16x16x32_bf16 v[244:247], a[156:159], a[60:63], v[244:247]
    ds_read_b128 a[44:47], v43 offset:8192
    s_cbranch_vccnz L_slow7_0
L_back7_0:
    v_mfma_f32_16x16x32_bf16 v[248:251], a[68:71], a[16:19], v[248:251]
    ds_read_b128 a[52:55], v42 offset:14336
    v_perm_b32 v56, v104, v35, s38
    v_mfma_f32_16x16x32_bf16 v[248:251], a[156:159], a[64:67], v[248:251]
    ds_read_b32 a30, v56
    ds_read_b128 a[116:119], v43 offset:14336
    v_mfma_f32_16x16x32_bf16 v[252:255], a[68:71], a[92:95], v[252:255]
    s_waitcnt lgkmcnt(12)
    ds_read_b128 a[96:99], v42 offset:12288
    v_perm_b32 v62, v104, v35, s39
    v_mfma_f32_16x16x32_bf16 v[252:255], a[156:159], a[176:179], v[252:255]
    ds_read_b32 a31, v62
    ds_read_b128 a[120:123], v43 offset:12288
    v_perm_b32 v63, v117, v35, s36
    v_mfma_f32_16x16x32_bf16 v[128:131], a[0:3], a[212:215], v[128:131]
    s_waitcnt lgkmcnt(9)
    ds_read_b32 a124, v63
    v_perm_b32 v60, v117, v35, s37
    v_mfma_f32_16x16x32_bf16 v[128:131], a[8:11], a[24:27], v[128:131]
    ds_read_b32 a125, v60
    v_perm_b32 v61, v106, v35, s36
    v_mfma_f32_16x16x32_bf16 v[132:135], a[0:3], a[76:79], v[132:135]
    ds_read_b32 a200, v61
    v_perm_b32 v57, v117, v35, s38
    v_mfma_f32_16x16x32_bf16 v[132:135], a[8:11], a[56:59], v[132:135]
    v_perm_b32 v58, v117, v35, s39
    v_perm_b32 v59, v106, v35, s37
    v_mfma_f32_16x16x32_bf16 v[136:139], a[0:3], a[132:135], v[136:139]
    ds_read_b32 a126, v57
    ds_read_b32 a127, v58
    v_mfma_f32_16x16x32_bf16 v[136:139], a[8:11], a[224:227], v[136:139]
    ds_read_b32 a201, v59
    v_perm_b32 v56, v85, v35, s36
    v_perm_b32 v62, v85, v35, s37
    v_mfma_f32_16x16x32_bf16 v[140:143], a[0:3], a[32:35], v[140:143]
    s_waitcnt vmcnt(11) lgkmcnt(6)
    v_perm_b32 v63, v85, v35, s38
    v_perm_b32 v60, v85, v35, s39
    v_mfma_f32_16x16x32_bf16 v[140:143], a[8:11], a[168:171], v[140:143]
    s_barrier
    v_mfma_f32_16x16x32_bf16 v[144:147], a[0:3], a[172:175], v[144:147]
    ds_read_b32 a72, v56
    ds_read_b32 a73, v62
    v_perm_b32 v61, v106, v35, s38
    v_mfma_f32_16x16x32_bf16 v[144:147], a[8:11], a[84:87], v[144:147]
    ds_read_b32 a74, v63
    ds_read_b32 a75, v60
    v_perm_b32 v57, v106, v35, s39
    v_mfma_f32_16x16x32_bf16 v[148:151], a[0:3], a[104:107], v[148:151]
    ds_read_b32 a202, v61
    ds_read_b32 a203, v57
    v_mfma_f32_16x16x32_bf16 v[148:151], a[8:11], a[44:47], v[148:151]
    v_bitop3_b32 v103, v103, v99, s76 bitop3:0x7e
    v_perm_b32 v58, v88, v35, s36
    v_mfma_f32_16x16x32_bf16 v[152:155], a[0:3], a[52:55], v[152:155]
    ds_read_b32 a136, v58
    v_cmp_ne_u32 vcc, 0, v103
    v_mfma_f32_16x16x32_bf16 v[152:155], a[8:11], a[116:119], v[152:155]
    ds_read_b128 a[128:131], v40 offset:34816
    v_perm_b32 v59, v88, v35, s37
    v_mfma_f32_16x16x32_bf16 v[156:159], a[0:3], a[96:99], v[156:159]
    ds_read_b32 a137, v59
    s_cbranch_vccnz L_slow7_1
L_back7_1:
    v_mfma_f32_16x16x32_bf16 v[156:159], a[8:11], a[120:123], v[156:159]
    s_waitcnt lgkmcnt(9)
    v_perm_b32 v56, v118, v35, s36
    v_perm_b32 v62, v118, v35, s37
    v_mfma_f32_16x16x32_bf16 v[160:163], a[124:127], a[212:215], v[160:163]
    s_waitcnt lgkmcnt(5)
    ds_read_b32 a216, v56
    v_perm_b32 v63, v88, v35, s38
    v_mfma_f32_16x16x32_bf16 v[160:163], a[72:75], a[24:27], v[160:163]
    ds_read_b32 a138, v63
    ds_read_b128 a[140:143], v41 offset:34816
    v_mfma_f32_16x16x32_bf16 v[164:167], a[124:127], a[76:79], v[164:167]
    ds_read_b32 a217, v62
    v_perm_b32 v60, v118, v35, s38
    v_mfma_f32_16x16x32_bf16 v[164:167], a[72:75], a[56:59], v[164:167]
    v_perm_b32 v61, v118, v35, s39
    v_perm_b32 v57, v88, v35, s39
    v_mfma_f32_16x16x32_bf16 v[168:171], a[124:127], a[132:135], v[168:171]
    ds_read_b32 a218, v60
    ds_read_b32 a219, v61
    v_mfma_f32_16x16x32_bf16 v[168:171], a[72:75], a[224:227], v[168:171]
    ds_read_b32 a139, v57
    v_perm_b32 v58, v86, v35, s36
    v_perm_b32 v59, v86, v35, s37
    v_mfma_f32_16x16x32_bf16 v[172:175], a[124:127], a[32:35], v[172:175]
    v_perm_b32 v56, v86, v35, s38
    v_perm_b32 v63, v86, v35, s39
    v_mfma_f32_16x16x32_bf16 v[172:175], a[72:75], a[168:171], v[172:175]
    ds_read_b32 a48, v58
    ds_read_b32 a49, v59
    v_perm_b32 v62, v120, v35, s36
    v_mfma_f32_16x16x32_bf16 v[176:179], a[124:127], a[172:175], v[176:179]
    ds_read_b32 a50, v56
    ds_read_b32 a51, v63
    v_mfma_f32_16x16x32_bf16 v[176:179], a[72:75], a[84:87], v[176:179]
    ds_read_b32 a180, v62
    ds_read_b128 a[220:223], v42 offset:32768
    v_perm_b32 v60, v120, v35, s37
    v_mfma_f32_16x16x32_bf16 v[180:183], a[124:127], a[104:107], v[180:183]
    ds_read_b32 a181, v60
    ds_read_b128 a[192:195], v43 offset:32768
    v_mfma_f32_16x16x32_bf16 v[180:183], a[72:75], a[44:47], v[180:183]
    v_perm_b32 v61, v120, v35, s38
    v_perm_b32 v57, v120, v35, s39
    v_mfma_f32_16x16x32_bf16 v[184:187], a[124:127], a[52:55], v[184:187]
    ds_read_b32 a182, v61
    ds_read_b32 a183, v57
    v_mfma_f32_16x16x32_bf16 v[184:187], a[72:75], a[116:119], v[184:187]
    ds_read_b128 a[236:239], v40 offset:32768
    v_perm_b32 v58, v100, v35, s36
    v_mfma_f32_16x16x32_bf16 v[188:191], a[124:127], a[96:99], v[188:191]
    ds_read_b32 a252, v58
    v_perm_b32 v59, v100, v35, s37
    v_mfma_f32_16x16x32_bf16 v[188:191], a[72:75], a[120:123], v[188:191]
    s_waitcnt lgkmcnt(12)
    ds_read_b32 a253, v59
    ds_read_b128 a[88:91], v41 offset:32768
    v_mfma_f32_16x16x32_bf16 v[192:195], a[216:219], a[212:215], v[192:195]
    s_waitcnt lgkmcnt(10)
    v_perm_b32 v56, v100, v35, s38
    v_perm_b32 v63, v100, v35, s39
    v_mfma_f32_16x16x32_bf16 v[192:195], a[48:51], a[24:27], v[192:195]
    ds_read_b32 a254, v56
    ds_read_b32 a255, v63
    v_mfma_f32_16x16x32_bf16 v[196:199], a[216:219], a[76:79], v[196:199]
    v_perm_b32 v62, v96, v35, s36
    v_perm_b32 v60, v96, v35, s37
    v_mfma_f32_16x16x32_bf16 v[196:199], a[48:51], a[56:59], v[196:199]
    ds_read_b32 a100, v62
    ds_read_b32 a101, v60
    v_mfma_f32_16x16x32_bf16 v[200:203], a[216:219], a[132:135], v[200:203]
    ds_read_b128 a[152:155], v42 offset:34816
    v_perm_b32 v61, v96, v35, s38
    v_mfma_f32_16x16x32_bf16 v[200:203], a[48:51], a[224:227], v[200:203]
    ds_read_b32 a102, v61
    v_perm_b32 v57, v96, v35, s39
    v_mfma_f32_16x16x32_bf16 v[204:207], a[216:219], a[32:35], v[204:207]
    ds_read_b32 a103, v57
    v_perm_b32 v58, v89, v35, s36
    v_mfma_f32_16x16x32_bf16 v[204:207], a[48:51], a[168:171], v[204:207]
    ds_read_b32 a188, v58
    v_perm_b32 v59, v89, v35, s37
    v_mfma_f32_16x16x32_bf16 v[208:211], a[216:219], a[172:175], v[208:211]
    ds_read_b32 a189, v59
    v_perm_b32 v56, v89, v35, s38
    v_mfma_f32_16x16x32_bf16 v[208:211], a[48:51], a[84:87], v[208:211]
    s_waitcnt vmcnt(0)
    ds_read_b32 a190, v56
    v_perm_b32 v63, v89, v35, s39
    v_mfma_f32_16x16x32_bf16 v[212:215], a[216:219], a[104:107], v[212:215]
    s_barrier
    v_mfma_f32_16x16x32_bf16 v[212:215], a[48:51], a[44:47], v[212:215]
    ds_read_b32 a191, v63
    v_perm_b32 v62, v121, v35, s36
    v_mfma_f32_16x16x32_bf16 v[216:219], a[216:219], a[52:55], v[216:219]
    ds_read_b32 a208, v62
    ds_read_b128 a[164:167], v43 offset:34816
    v_mfma_f32_16x16x32_bf16 v[216:219], a[48:51], a[116:119], v[216:219]
    v_perm_b32 v60, v121, v35, s37
    v_perm_b32 v61, v121, v35, s38
    v_mfma_f32_16x16x32_bf16 v[220:223], a[216:219], a[96:99], v[220:223]
    ds_read_b32 a209, v60
    ds_read_b32 a210, v61
    v_mfma_f32_16x16x32_bf16 v[220:223], a[48:51], a[120:123], v[220:223]
    v_perm_b32 v57, v121, v35, s39
    v_perm_b32 v58, v101, v35, s36
    v_mfma_f32_16x16x32_bf16 v[228:231], a[108:111], a[128:131], v[228:231]
    s_mov_b32 s64, 0
    ds_read_b32 a211, v57
    ds_read_b32 a232, v58
    v_mfma_f32_16x16x32_bf16 v[228:231], a[204:207], a[140:143], v[228:231]
    v_perm_b32 v59, v101, v35, s37
    v_perm_b32 v56, v101, v35, s38
    v_mfma_f32_16x16x32_bf16 v[132:135], a[12:15], a[128:131], v[132:135]
    s_mov_b32 s65, 14336
    ds_read_b32 a233, v59
    ds_read_b32 a234, v56
    v_mfma_f32_16x16x32_bf16 v[132:135], a[148:151], a[140:143], v[132:135]
    s_waitcnt lgkmcnt(9)
    v_perm_b32 v63, v101, v35, s39
    v_perm_b32 v62, v97, v35, s36
    v_mfma_f32_16x16x32_bf16 v[132:135], a[40:43], a[220:223], v[132:135]
    s_mov_b32 s66, 28672
    ds_read_b32 a235, v63
    ds_read_b128 a[196:199], v44 offset:2048
    v_mfma_f32_16x16x32_bf16 v[132:135], a[144:147], a[192:195], v[132:135]
    ds_read_b32 a240, v62
    v_perm_b32 v60, v97, v35, s37
    v_mfma_f32_16x16x32_bf16 v[164:167], a[4:7], a[128:131], v[164:167]
    s_mov_b32 s67, 43008
    ds_read_b32 a241, v60
    v_perm_b32 v61, v97, v35, s38
    v_mfma_f32_16x16x32_bf16 v[164:167], a[112:115], a[140:143], v[164:167]
    ds_read_b128 a[20:23], v45 offset:2048
    ds_read_b32 a242, v61
    v_mfma_f32_16x16x32_bf16 v[164:167], a[248:251], a[220:223], v[164:167]
    s_mov_b32 s68, 229376
    v_perm_b32 v57, v97, v35, s39
    v_perm_b32 v58, v90, v35, s36
    v_mfma_f32_16x16x32_bf16 v[164:167], a[244:247], a[192:195], v[164:167]
    ds_read_b32 a243, v57
    ds_read_b32 a184, v58
    v_mfma_f32_16x16x32_bf16 v[196:199], a[228:231], a[128:131], v[196:199]
    s_mov_b32 s69, 243712
    ds_read_b128 a[60:63], v46 offset:0
    v_perm_b32 v59, v90, v35, s37
    v_mfma_f32_16x16x32_bf16 v[196:199], a[36:39], a[140:143], v[196:199]
    ds_read_b32 a185, v59
    v_perm_b32 v56, v90, v35, s38
    v_mfma_f32_16x16x32_bf16 v[196:199], a[80:83], a[220:223], v[196:199]
    s_mov_b32 s70, 258048
    ds_read_b32 a186, v56
    v_perm_b32 v63, v90, v35, s39
    v_mfma_f32_16x16x32_bf16 v[196:199], a[160:163], a[192:195], v[196:199]
    ds_read_b128 a[16:19], v47 offset:0
    ds_read_b32 a187, v63
    v_mfma_f32_16x16x32_bf16 v[224:227], a[108:111], a[236:239], v[224:227]
    s_mov_b32 s71, 272384
    v_perm_b32 v62, v122, v35, s36
    v_perm_b32 v60, v122, v35, s37
    v_mfma_f32_16x16x32_bf16 v[224:227], a[204:207], a[88:91], v[224:227]
    ds_read_b32 a64, v62
    ds_read_b32 a65, v60
L_pad4:
    s_cbranch_execz L_warmed
    v_mfma_f32_16x16x32_bf16 v[128:131], a[12:15], a[236:239], v[128:131]
    s_mov_b32 s72, 458752
    ds_read_b128 a[92:95], v44 offset:0
    v_perm_b32 v61, v122, v35, s38
    v_mfma_f32_16x16x32_bf16 v[128:131], a[148:151], a[88:91], v[128:131]
    s_waitcnt lgkmcnt(10)
    ds_read_b32 a66, v61
    v_perm_b32 v57, v122, v35, s39
    v_mfma_f32_16x16x32_bf16 v[128:131], a[40:43], a[152:155], v[128:131]
    s_mov_b32 s73, 473088
    ds_read_b32 a67, v57
    v_perm_b32 v58, v102, v35, s36
    v_mfma_f32_16x16x32_bf16 v[128:131], a[144:147], a[164:167], v[128:131]
    ds_read_b128 a[68:71], v45 offset:0
    ds_read_b32 a176, v58
    v_mfma_f32_16x16x32_bf16 v[160:163], a[4:7], a[236:239], v[160:163]
    s_mov_b32 s74, 487424
    v_perm_b32 v59, v102, v35, s37
    v_perm_b32 v56, v102, v35, s38
    v_mfma_f32_16x16x32_bf16 v[160:163], a[112:115], a[88:91], v[160:163]
    ds_read_b32 a177, v59
    v_lshlrev_b32 v48, 16, v108
    v_mfma_f32_16x16x32_bf16 v[160:163], a[248:251], a[152:155], v[160:163]
    s_mov_b32 s75, 501760
    ds_read_b128 a[156:159], v46 offset:2048
    ds_read_b32 a178, v56
    v_mfma_f32_16x16x32_bf16 v[160:163], a[244:247], a[164:167], v[160:163]
    v_perm_b32 v63, v102, v35, s39
    v_and_b32 v49, 0xffff0000, v109
    v_mfma_f32_16x16x32_bf16 v[192:195], a[228:231], a[236:239], v[192:195]
    s_mov_b32 s48, 688128
    ds_read_b32 a179, v63
    v_perm_b32 v62, v98, v35, s36
    v_mfma_f32_16x16x32_bf16 v[192:195], a[36:39], a[88:91], v[192:195]
    ds_read_b32 a0, v62
    v_lshlrev_b32 v50, 16, v111
    v_mfma_f32_16x16x32_bf16 v[192:195], a[80:83], a[152:155], v[192:195]
    s_mov_b32 s49, 702464
    v_perm_b32 v60, v98, v35, s37
    v_and_b32 v51, 0xffff0000, v112
    v_mfma_f32_16x16x32_bf16 v[192:195], a[160:163], a[164:167], v[192:195]
    ds_read_b128 a[8:11], v47 offset:2048
    ds_read_b32 a1, v60
    v_mfma_f32_16x16x32_bf16 v[228:231], a[28:31], a[196:199], v[228:231]
    s_mov_b32 s50, 716800
    v_perm_b32 v61, v98, v35, s38
    v_perm_b32 v57, v98, v35, s39
    v_mfma_f32_16x16x32_bf16 v[228:231], a[200:203], a[20:23], v[228:231]
    ds_read_b32 a2, v61
    ds_read_b32 a3, v57
    v_and_b32 v52, 0xffff0000, v108
    v_mfma_f32_16x16x32_bf16 v[132:135], a[136:139], a[196:199], v[132:135]
    s_mov_b32 s51, 731136
    ds_read_b128 a[124:127], v40 offset:38912
    v_lshlrev_b32 v53, 16, v110
    v_mfma_f32_16x16x32_bf16 v[132:135], a[180:183], a[20:23], v[132:135]
    s_waitcnt lgkmcnt(7)
    v_and_b32 v54, 0xffff0000, v111
    v_mov_b32 v8, 1
    v_mfma_f32_16x16x32_bf16 v[132:135], a[252:255], a[60:63], v[132:135]
    v_min_u32 v9, 1, v0
    v_lshlrev_b32 v9, 30, v9
    v_mfma_f32_16x16x32_bf16 v[132:135], a[100:103], a[16:19], v[132:135]
    ds_read_b128 a[72:75], v41 offset:38912
    v_lshlrev_b32 v55, 16, v113
    v_lshlrev_b32 v76, 16, v109
    v_mfma_f32_16x16x32_bf16 v[164:167], a[188:191], a[196:199], v[164:167]
    ds_read_b128 a[212:215], v44 offset:6144
    v_and_b32 v77, 0xffff0000, v110
    v_lshlrev_b32 v78, 16, v112
    v_mfma_f32_16x16x32_bf16 v[164:167], a[208:211], a[20:23], v[164:167]
    ds_read_b128 a[24:27], v45 offset:6144
    v_and_b32 v79, 0xffff0000, v113
    v_mfma_f32_16x16x32_bf16 v[164:167], a[232:235], a[60:63], v[164:167]
    v_lshlrev_b32 v124, 16, v114
    v_and_b32 v125, 0xffff0000, v114
    v_mfma_f32_16x16x32_bf16 v[164:167], a[240:243], a[16:19], v[164:167]
    ds_read_b128 a[76:79], v42 offset:36864
    v_lshlrev_b32 v126, 16, v115
    v_mfma_f32_16x16x32_bf16 v[196:199], a[184:187], a[196:199], v[196:199]
    ds_read_b128 a[56:59], v43 offset:36864
    v_and_b32 v127, 0xffff0000, v115
    v_mfma_f32_16x16x32_bf16 v[196:199], a[64:67], a[20:23], v[196:199]
    s_waitcnt lgkmcnt(5)
    ds_read_b128 a[132:135], v46 offset:4096
    v_mfma_f32_16x16x32_bf16 v[196:199], a[176:179], a[60:63], v[196:199]
    buffer_atomic_add v8, v9, s[24:27], s77 offen sc0 sc1
    v_mfma_f32_16x16x32_bf16 v[196:199], a[0:3], a[16:19], v[196:199]
    ds_write_b128 v29, v[228:231] offset:0
    v_mul_f32 v132, v132, v48
    v_mfma_f32_16x16x32_bf16 v[224:227], a[28:31], a[92:95], v[224:227]
    ds_read_b128 a[224:227], v47 offset:4096
    v_mul_f32 v133, v133, v49
    v_mfma_f32_16x16x32_bf16 v[224:227], a[200:203], a[68:71], v[224:227]
    ds_read_b128 a[32:35], v40 offset:36864
    v_mul_f32 v134, v134, v50
    v_mfma_f32_16x16x32_bf16 v[128:131], a[136:139], a[92:95], v[128:131]
    ds_read_b128 a[168:171], v41 offset:36864
    v_mul_f32 v135, v135, v51
    v_mfma_f32_16x16x32_bf16 v[128:131], a[180:183], a[68:71], v[128:131]
    ds_read_b128 a[172:175], v44 offset:4096
    v_mul_f32 v164, v164, v52
    v_mfma_f32_16x16x32_bf16 v[128:131], a[252:255], a[156:159], v[128:131]
    s_waitcnt lgkmcnt(4)
    s_barrier
    v_mfma_f32_16x16x32_bf16 v[128:131], a[100:103], a[8:11], v[128:131]
    ds_read_b128 v[80:83], v30 offset:0
    v_mul_f32 v165, v165, v53
    v_mfma_f32_16x16x32_bf16 v[160:163], a[188:191], a[92:95], v[160:163]
    ds_read_b128 a[84:87], v45 offset:4096
    v_mul_f32 v166, v166, v54
    v_mfma_f32_16x16x32_bf16 v[160:163], a[208:211], a[68:71], v[160:163]
    ds_read_b128 a[104:107], v42 offset:38912
    v_mul_f32 v167, v167, v55
    v_mfma_f32_16x16x32_bf16 v[160:163], a[232:235], a[156:159], v[160:163]
    v_mul_f32 v196, v196, v76
    v_mul_f32 v197, v197, v77
    v_mfma_f32_16x16x32_bf16 v[160:163], a[240:243], a[8:11], v[160:163]
    v_mul_f32 v198, v198, v78
    v_mul_f32 v199, v199, v79
    v_mfma_f32_16x16x32_bf16 v[192:195], a[184:187], a[92:95], v[192:195]
    ds_read_b128 a[44:47], v43 offset:38912
    v_cvt_pk_bf16_f32 v64, v132, v164
    v_mfma_f32_16x16x32_bf16 v[192:195], a[64:67], a[68:71], v[192:195]
    v_cvt_pk_bf16_f32 v65, v196, v133
    v_cvt_pk_bf16_f32 v66, v165, v197
    v_mfma_f32_16x16x32_bf16 v[192:195], a[176:179], a[156:159], v[192:195]
    ds_write_b64 v27, v[64:65] offset:0
    v_cvt_pk_bf16_f32 v67, v134, v166
    v_mfma_f32_16x16x32_bf16 v[192:195], a[0:3], a[8:11], v[192:195]
    ds_write_b64 v27, v[66:67] offset:8
    v_cvt_pk_bf16_f32 v92, v198, v135
    v_mfma_f32_16x16x32_bf16 v[236:239], a[108:111], a[124:127], v[236:239]
    ds_read_b128 a[52:55], v46 offset:6144
    v_cvt_pk_bf16_f32 v93, v167, v199
    v_mfma_f32_16x16x32_bf16 v[236:239], a[204:207], a[72:75], v[236:239]
    s_waitcnt lgkmcnt(5)
    ds_write_b64 v27, v[92:93] offset:16
    v_add_f32 v224, v224, v80
    v_mfma_f32_16x16x32_bf16 v[236:239], a[28:31], a[212:215], v[236:239]
    v_mul_f32 v224, v224, v124
    v_add_f32 v225, v225, v81
    v_mfma_f32_16x16x32_bf16 v[236:239], a[200:203], a[24:27], v[236:239]
    v_mul_f32 v225, v225, v125
    v_add_f32 v226, v226, v82
    v_mfma_f32_16x16x32_bf16 v[140:143], a[12:15], a[124:127], v[140:143]
    v_mul_f32 v226, v226, v126
    v_add_f32 v227, v227, v83
    v_mfma_f32_16x16x32_bf16 v[140:143], a[148:151], a[72:75], v[140:143]
    v_mul_f32 v227, v227, v127
    v_cvt_pk_bf16_f32 v80, v224, v225
    v_mfma_f32_16x16x32_bf16 v[140:143], a[40:43], a[76:79], v[140:143]
    v_cvt_pk_bf16_f32 v81, v226, v227
    v_mul_f32 v128, v128, v48
    v_mfma_f32_16x16x32_bf16 v[140:143], a[144:147], a[56:59], v[140:143]
    v_mul_f32 v129, v129, v49
    v_mul_f32 v130, v130, v50
    v_mfma_f32_16x16x32_bf16 v[140:143], a[136:139], a[212:215], v[140:143]
    ds_write_b64 v28, v[80:81] offset:0
    v_mul_f32 v131, v131, v51
    v_mfma_f32_16x16x32_bf16 v[140:143], a[180:183], a[24:27], v[140:143]
    ds_read_b128 a[116:119], v47 offset:6144
    v_mul_f32 v160, v160, v52
    v_mfma_f32_16x16x32_bf16 v[140:143], a[252:255], a[132:135], v[140:143]
    v_mul_f32 v161, v161, v53
    v_mul_f32 v162, v162, v54
    v_mfma_f32_16x16x32_bf16 v[140:143], a[100:103], a[224:227], v[140:143]
    ds_read_b128 a[96:99], v40 offset:43008
    v_mul_f32 v163, v163, v55
    v_mfma_f32_16x16x32_bf16 v[172:175], a[4:7], a[124:127], v[172:175]
    ds_write_b128 v29, v[236:239] offset:4096
    v_mul_f32 v192, v192, v76
    v_mfma_f32_16x16x32_bf16 v[172:175], a[112:115], a[72:75], v[172:175]
    v_mul_f32 v193, v193, v77
    v_mul_f32 v194, v194, v78
    v_mfma_f32_16x16x32_bf16 v[172:175], a[248:251], a[76:79], v[172:175]
    ds_read_b128 a[216:219], v41 offset:43008
    v_mul_f32 v195, v195, v79
    v_mfma_f32_16x16x32_bf16 v[172:175], a[244:247], a[56:59], v[172:175]
    v_cvt_pk_bf16_f32 v68, v128, v160
    v_cvt_pk_bf16_f32 v69, v192, v129
    v_mfma_f32_16x16x32_bf16 v[172:175], a[188:191], a[212:215], v[172:175]
    ds_write_b64 v26, v[68:69] offset:0
    v_cvt_pk_bf16_f32 v70, v161, v193
    v_mfma_f32_16x16x32_bf16 v[172:175], a[208:211], a[24:27], v[172:175]
    v_cvt_pk_bf16_f32 v71, v130, v162
    v_cvt_pk_bf16_f32 v72, v194, v131
    v_mfma_f32_16x16x32_bf16 v[172:175], a[232:235], a[132:135], v[172:175]
    ds_write_b64 v26, v[70:71] offset:8
    v_cvt_pk_bf16_f32 v73, v163, v195
    v_mfma_f32_16x16x32_bf16 v[172:175], a[240:243], a[224:227], v[172:175]
    ds_write_b64 v26, v[72:73] offset:16
    v_mul_f32 v140, v140, v48
    v_mfma_f32_16x16x32_bf16 v[204:207], a[228:231], a[124:127], v[204:207]
    ds_read_b128 a[120:123], v44 offset:10240
    v_mul_f32 v141, v141, v49
    v_mfma_f32_16x16x32_bf16 v[204:207], a[36:39], a[72:75], v[204:207]
    ds_read_b128 a[48:51], v45 offset:10240
    v_mul_f32 v142, v142, v50
    v_mfma_f32_16x16x32_bf16 v[204:207], a[80:83], a[76:79], v[204:207]
    ds_read_b128 a[128:131], v42 offset:40960
    v_mul_f32 v143, v143, v51
    v_mfma_f32_16x16x32_bf16 v[204:207], a[160:163], a[56:59], v[204:207]
    ds_read_b128 a[140:143], v43 offset:40960
    v_mul_f32 v172, v172, v52
    v_mfma_f32_16x16x32_bf16 v[204:207], a[184:187], a[212:215], v[204:207]
    s_waitcnt lgkmcnt(4)
    s_barrier
    v_mfma_f32_16x16x32_bf16 v[204:207], a[64:67], a[24:27], v[204:207]
    ds_read_b128 v[104:107], v24 offset:0
    v_mul_f32 v173, v173, v53
    v_mfma_f32_16x16x32_bf16 v[204:207], a[176:179], a[132:135], v[204:207]
    ds_read_b128 v[116:119], v24 offset:928
    v_mul_f32 v174, v174, v54
    v_mfma_f32_16x16x32_bf16 v[204:207], a[0:3], a[224:227], v[204:207]
    ds_read_b128 v[84:87], v24 offset:1856
    v_mul_f32 v175, v175, v55
    v_mfma_f32_16x16x32_bf16 v[232:235], a[108:111], a[32:35], v[232:235]
    ds_read_b128 v[88:91], v24 offset:2784
    v_mfma_f32_16x16x32_bf16 v[232:235], a[204:207], a[168:171], v[232:235]
    ds_read_b128 a[220:223], v46 offset:8192
    v_mfma_f32_16x16x32_bf16 v[232:235], a[28:31], a[172:175], v[232:235]
    ds_read_b128 v[120:123], v30 offset:4096
    v_mfma_f32_16x16x32_bf16 v[232:235], a[200:203], a[84:87], v[232:235]
    ds_read_b128 a[192:195], v47 offset:8192
    v_mul_f32 v204, v204, v76
    v_mfma_f32_16x16x32_bf16 v[136:139], a[12:15], a[32:35], v[136:139]
    s_waitcnt lgkmcnt(6)
    ds_read_b128 a[236:239], v40 offset:40960
    v_mfma_f32_16x16x32_bf16 v[136:139], a[148:151], a[168:171], v[136:139]
    buffer_store_dwordx4 v[104:107], v25, s[16:19], s64 offen sc1
    v_mfma_f32_16x16x32_bf16 v[136:139], a[40:43], a[104:107], v[136:139]
    v_mul_f32 v205, v205, v77
    v_mul_f32 v206, v206, v78
    v_mfma_f32_16x16x32_bf16 v[136:139], a[144:147], a[44:47], v[136:139]
    ds_read_b128 a[88:91], v41 offset:40960
    v_mul_f32 v207, v207, v79
    v_mfma_f32_16x16x32_bf16 v[136:139], a[136:139], a[172:175], v[136:139]
    s_waitcnt lgkmcnt(6)
    v_cvt_pk_bf16_f32 v100, v140, v172
    v_mfma_f32_16x16x32_bf16 v[136:139], a[180:183], a[84:87], v[136:139]
    buffer_store_dwordx4 v[116:119], v25, s[16:19], s65 offen sc1
    v_mfma_f32_16x16x32_bf16 v[136:139], a[252:255], a[52:55], v[136:139]
    v_cvt_pk_bf16_f32 v101, v204, v141
    v_cvt_pk_bf16_f32 v102, v173, v205
    v_mfma_f32_16x16x32_bf16 v[136:139], a[100:103], a[116:119], v[136:139]
    ds_write_b64 v27, v[100:101] offset:14848
    v_cvt_pk_bf16_f32 v103, v142, v174
    v_mfma_f32_16x16x32_bf16 v[168:171], a[4:7], a[32:35], v[168:171]
    ds_write_b64 v27, v[102:103] offset:14856
    v_mfma_f32_16x16x32_bf16 v[168:171], a[112:115], a[168:171], v[168:171]
    buffer_store_dwordx4 v[84:87], v25, s[16:19], s66 offen sc1
    v_mfma_f32_16x16x32_bf16 v[168:171], a[248:251], a[104:107], v[168:171]
    v_cvt_pk_bf16_f32 v96, v206, v143
    v_cvt_pk_bf16_f32 v97, v175, v207
    v_mfma_f32_16x16x32_bf16 v[168:171], a[244:247], a[44:47], v[168:171]
    s_waitcnt lgkmcnt(3)
    ds_write_b64 v27, v[96:97] offset:14864
    v_add_f32 v232, v232, v120
    v_mfma_f32_16x16x32_bf16 v[168:171], a[188:191], a[172:175], v[168:171]
    ds_read_b128 a[152:155], v44 offset:8192
    v_mfma_f32_16x16x32_bf16 v[168:171], a[208:211], a[84:87], v[168:171]
    buffer_store_dwordx4 v[88:91], v25, s[16:19], s67 offen sc1
    v_mfma_f32_16x16x32_bf16 v[168:171], a[232:235], a[52:55], v[168:171]
    ds_read_b128 a[164:167], v45 offset:8192
    v_mul_f32 v232, v232, v124
    v_mfma_f32_16x16x32_bf16 v[168:171], a[240:243], a[116:119], v[168:171]
    v_add_f32 v233, v233, v121
    v_mul_f32 v233, v233, v125
    v_mfma_f32_16x16x32_bf16 v[200:203], a[228:231], a[32:35], v[200:203]
    v_add_f32 v234, v234, v122
    v_mul_f32 v234, v234, v126
    v_mfma_f32_16x16x32_bf16 v[200:203], a[36:39], a[168:171], v[200:203]
    v_add_f32 v235, v235, v123
    v_mul_f32 v235, v235, v127
    v_mfma_f32_16x16x32_bf16 v[200:203], a[80:83], a[104:107], v[200:203]
    v_cvt_pk_bf16_f32 v120, v232, v233
    v_cvt_pk_bf16_f32 v121, v234, v235
    v_mfma_f32_16x16x32_bf16 v[200:203], a[160:163], a[44:47], v[200:203]
    ds_write_b64 v28, v[120:121] offset:14848
    v_mul_f32 v136, v136, v48
    v_mfma_f32_16x16x32_bf16 v[200:203], a[184:187], a[172:175], v[200:203]
    ds_read_b128 a[196:199], v42 offset:43008
    v_mul_f32 v137, v137, v49
    v_mfma_f32_16x16x32_bf16 v[200:203], a[64:67], a[84:87], v[200:203]
    v_mul_f32 v138, v138, v50
    v_mul_f32 v139, v139, v51
    v_mfma_f32_16x16x32_bf16 v[200:203], a[176:179], a[52:55], v[200:203]
    ds_read_b128 a[20:23], v43 offset:43008
    v_mul_f32 v168, v168, v52
    v_mfma_f32_16x16x32_bf16 v[200:203], a[0:3], a[116:119], v[200:203]
    ds_read_b128 a[60:63], v46 offset:10240
    v_mul_f32 v169, v169, v53
    v_mfma_f32_16x16x32_bf16 v[244:247], a[108:111], a[96:99], v[244:247]
    v_mul_f32 v170, v170, v54
    v_mul_f32 v171, v171, v55
    v_mfma_f32_16x16x32_bf16 v[244:247], a[204:207], a[216:219], v[244:247]
    ds_read_b128 a[16:19], v47 offset:10240
    v_mfma_f32_16x16x32_bf16 v[244:247], a[28:31], a[120:123], v[244:247]
    ds_read_b128 a[92:95], v40 offset:47104
    v_mfma_f32_16x16x32_bf16 v[244:247], a[200:203], a[48:51], v[244:247]
    v_mul_f32 v200, v200, v76
    v_mul_f32 v201, v201, v77
    v_mfma_f32_16x16x32_bf16 v[148:151], a[12:15], a[96:99], v[148:151]
    v_mul_f32 v202, v202, v78
    v_mul_f32 v203, v203, v79
    v_mfma_f32_16x16x32_bf16 v[148:151], a[148:151], a[216:219], v[148:151]
    v_cvt_pk_bf16_f32 v108, v136, v168
    v_cvt_pk_bf16_f32 v109, v200, v137
    v_mfma_f32_16x16x32_bf16 v[148:151], a[40:43], a[128:131], v[148:151]
    ds_write_b64 v26, v[108:109] offset:14848
    v_cvt_pk_bf16_f32 v110, v169, v201
    v_mfma_f32_16x16x32_bf16 v[148:151], a[144:147], a[140:143], v[148:151]
    ds_write_b128 v29, v[244:247] offset:8192
    v_cvt_pk_bf16_f32 v111, v138, v170
    v_mfma_f32_16x16x32_bf16 v[148:151], a[136:139], a[120:123], v[148:151]
    ds_write_b64 v26, v[110:111] offset:14856
    v_cvt_pk_bf16_f32 v112, v202, v139
    v_mfma_f32_16x16x32_bf16 v[148:151], a[180:183], a[48:51], v[148:151]
    ds_read_b128 a[68:71], v41 offset:47104
    v_cvt_pk_bf16_f32 v113, v171, v203
    v_mfma_f32_16x16x32_bf16 v[148:151], a[252:255], a[220:223], v[148:151]
    ds_write_b64 v26, v[112:113] offset:14864
    v_mfma_f32_16x16x32_bf16 v[148:151], a[100:103], a[192:195], v[148:151]
    ds_read_b128 a[156:159], v44 offset:14336
    v_mfma_f32_16x16x32_bf16 v[180:183], a[4:7], a[96:99], v[180:183]
    v_mfma_f32_16x16x32_bf16 v[180:183], a[112:115], a[216:219], v[180:183]
    ds_read_b128 a[8:11], v45 offset:14336
    v_mfma_f32_16x16x32_bf16 v[180:183], a[248:251], a[128:131], v[180:183]
    v_mfma_f32_16x16x32_bf16 v[180:183], a[244:247], a[140:143], v[180:183]
    s_waitcnt lgkmcnt(2)
    s_barrier
    v_mfma_f32_16x16x32_bf16 v[180:183], a[188:191], a[120:123], v[180:183]
    ds_read_b128 v[64:67], v24 offset:14848
    v_mul_f32 v148, v148, v48
    v_mfma_f32_16x16x32_bf16 v[180:183], a[208:211], a[48:51], v[180:183]
    ds_read_b128 v[92:95], v24 offset:15776
    v_mul_f32 v149, v149, v49
    v_mfma_f32_16x16x32_bf16 v[180:183], a[232:235], a[220:223], v[180:183]
    ds_read_b128 v[80:83], v24 offset:16704
    v_mul_f32 v150, v150, v50
    v_mfma_f32_16x16x32_bf16 v[180:183], a[240:243], a[192:195], v[180:183]
    ds_read_b128 v[68:71], v24 offset:17632
    v_mul_f32 v151, v151, v51
    v_mfma_f32_16x16x32_bf16 v[212:215], a[228:231], a[96:99], v[212:215]
    ds_read_b128 a[124:127], v42 offset:45056
    v_mfma_f32_16x16x32_bf16 v[212:215], a[36:39], a[216:219], v[212:215]
    ds_read_b128 a[72:75], v43 offset:45056
    v_mfma_f32_16x16x32_bf16 v[212:215], a[80:83], a[128:131], v[212:215]
    v_mfma_f32_16x16x32_bf16 v[212:215], a[160:163], a[140:143], v[212:215]
    s_waitcnt lgkmcnt(5)
    ds_read_b128 a[76:79], v46 offset:12288
    v_mfma_f32_16x16x32_bf16 v[212:215], a[184:187], a[120:123], v[212:215]
    buffer_store_dwordx4 v[64:67], v25, s[16:19], s68 offen sc1
    v_mfma_f32_16x16x32_bf16 v[212:215], a[64:67], a[48:51], v[212:215]
    ds_read_b128 v[72:75], v30 offset:8192
    v_mul_f32 v180, v180, v52
    v_mfma_f32_16x16x32_bf16 v[212:215], a[176:179], a[220:223], v[212:215]
    v_mul_f32 v181, v181, v53
    v_mul_f32 v182, v182, v54
    v_mfma_f32_16x16x32_bf16 v[212:215], a[0:3], a[192:195], v[212:215]
    s_waitcnt lgkmcnt(5)
    ds_read_b128 a[56:59], v47 offset:12288
    v_mfma_f32_16x16x32_bf16 v[240:243], a[108:111], a[236:239], v[240:243]
    buffer_store_dwordx4 v[92:95], v25, s[16:19], s69 offen sc1
    v_mfma_f32_16x16x32_bf16 v[240:243], a[204:207], a[88:91], v[240:243]
    v_mul_f32 v183, v183, v55
    v_mfma_f32_16x16x32_bf16 v[240:243], a[28:31], a[152:155], v[240:243]
    ds_read_b128 a[212:215], v40 offset:45056
    v_mfma_f32_16x16x32_bf16 v[240:243], a[200:203], a[164:167], v[240:243]
    v_mul_f32 v212, v212, v76
    v_mfma_f32_16x16x32_bf16 v[144:147], a[12:15], a[236:239], v[144:147]
    buffer_store_dwordx4 v[80:83], v25, s[16:19], s70 offen sc1
    v_mfma_f32_16x16x32_bf16 v[144:147], a[148:151], a[88:91], v[144:147]
    v_mul_f32 v213, v213, v77
    v_mul_f32 v214, v214, v78
    v_mfma_f32_16x16x32_bf16 v[144:147], a[40:43], a[196:199], v[144:147]
    ds_read_b128 a[24:27], v41 offset:45056
    v_mul_f32 v215, v215, v79
    v_mfma_f32_16x16x32_bf16 v[144:147], a[144:147], a[20:23], v[144:147]
    s_waitcnt lgkmcnt(3)
    v_cvt_pk_bf16_f32 v104, v148, v180
    v_mfma_f32_16x16x32_bf16 v[144:147], a[136:139], a[152:155], v[144:147]
    buffer_store_dwordx4 v[68:71], v25, s[16:19], s71 offen sc1
    v_mfma_f32_16x16x32_bf16 v[144:147], a[180:183], a[164:167], v[144:147]
    v_cvt_pk_bf16_f32 v105, v212, v149
    v_cvt_pk_bf16_f32 v106, v181, v213
    v_mfma_f32_16x16x32_bf16 v[144:147], a[252:255], a[60:63], v[144:147]
    ds_write_b64 v27, v[104:105] offset:29696
    v_cvt_pk_bf16_f32 v107, v150, v182
    v_mfma_f32_16x16x32_bf16 v[144:147], a[100:103], a[16:19], v[144:147]
    ds_write_b64 v27, v[106:107] offset:29704
    v_cvt_pk_bf16_f32 v116, v214, v151
    v_mfma_f32_16x16x32_bf16 v[176:179], a[4:7], a[236:239], v[176:179]
    ds_read_b128 a[132:135], v44 offset:12288
    v_cvt_pk_bf16_f32 v117, v183, v215
    v_mfma_f32_16x16x32_bf16 v[176:179], a[112:115], a[88:91], v[176:179]
    ds_write_b64 v27, v[116:117] offset:29712
    v_add_f32 v240, v240, v72
    v_mfma_f32_16x16x32_bf16 v[176:179], a[248:251], a[196:199], v[176:179]
    ds_read_b128 a[224:227], v45 offset:12288
    v_mul_f32 v240, v240, v124
    v_mfma_f32_16x16x32_bf16 v[176:179], a[244:247], a[20:23], v[176:179]
    v_add_f32 v241, v241, v73
    v_mul_f32 v241, v241, v125
    v_mfma_f32_16x16x32_bf16 v[176:179], a[188:191], a[152:155], v[176:179]
    v_add_f32 v242, v242, v74
    v_mul_f32 v242, v242, v126
    v_mfma_f32_16x16x32_bf16 v[176:179], a[208:211], a[164:167], v[176:179]
    v_add_f32 v243, v243, v75
    v_mul_f32 v243, v243, v127
    v_mfma_f32_16x16x32_bf16 v[176:179], a[232:235], a[60:63], v[176:179]
    v_cvt_pk_bf16_f32 v72, v240, v241
    v_cvt_pk_bf16_f32 v73, v242, v243
    v_mfma_f32_16x16x32_bf16 v[176:179], a[240:243], a[16:19], v[176:179]
    ds_write_b64 v28, v[72:73] offset:29696
    v_mul_f32 v144, v144, v48
    v_mfma_f32_16x16x32_bf16 v[208:211], a[228:231], a[236:239], v[208:211]
    ds_read_b128 a[32:35], v42 offset:47104
    v_mul_f32 v145, v145, v49
    v_mfma_f32_16x16x32_bf16 v[208:211], a[36:39], a[88:91], v[208:211]
    v_mul_f32 v146, v146, v50
    v_mul_f32 v147, v147, v51
    v_mfma_f32_16x16x32_bf16 v[208:211], a[80:83], a[196:199], v[208:211]
    ds_read_b128 a[168:171], v43 offset:47104
    v_mfma_f32_16x16x32_bf16 v[208:211], a[160:163], a[20:23], v[208:211]
    ds_read_b128 a[104:107], v46 offset:14336
    v_mul_f32 v176, v176, v52
    v_mfma_f32_16x16x32_bf16 v[208:211], a[184:187], a[152:155], v[208:211]
    v_mul_f32 v177, v177, v53
    v_mul_f32 v178, v178, v54
    v_mfma_f32_16x16x32_bf16 v[208:211], a[64:67], a[164:167], v[208:211]
    v_mul_f32 v179, v179, v55
    v_mfma_f32_16x16x32_bf16 v[208:211], a[176:179], a[60:63], v[208:211]
    v_mfma_f32_16x16x32_bf16 v[208:211], a[0:3], a[16:19], v[208:211]
    ds_read_b128 a[44:47], v47 offset:14336
    v_mfma_f32_16x16x32_bf16 v[252:255], a[108:111], a[92:95], v[252:255]
    v_mfma_f32_16x16x32_bf16 v[252:255], a[204:207], a[68:71], v[252:255]
    v_mfma_f32_16x16x32_bf16 v[252:255], a[28:31], a[156:159], v[252:255]
    v_mfma_f32_16x16x32_bf16 v[252:255], a[200:203], a[8:11], v[252:255]
    v_mul_f32 v208, v208, v76
    v_mul_f32 v209, v209, v77
    v_mfma_f32_16x16x32_bf16 v[156:159], a[12:15], a[92:95], v[156:159]
    v_mul_f32 v210, v210, v78
    v_mul_f32 v211, v211, v79
    v_mfma_f32_16x16x32_bf16 v[156:159], a[148:151], a[68:71], v[156:159]
    v_cvt_pk_bf16_f32 v100, v144, v176
    v_cvt_pk_bf16_f32 v101, v208, v145
    v_mfma_f32_16x16x32_bf16 v[156:159], a[40:43], a[124:127], v[156:159]
    ds_write_b64 v26, v[100:101] offset:29696
    v_cvt_pk_bf16_f32 v102, v177, v209
    v_mfma_f32_16x16x32_bf16 v[156:159], a[144:147], a[72:75], v[156:159]
    ds_write_b128 v29, v[252:255] offset:12288
    v_cvt_pk_bf16_f32 v103, v146, v178
    v_mfma_f32_16x16x32_bf16 v[156:159], a[136:139], a[156:159], v[156:159]
    ds_write_b64 v26, v[102:103] offset:29704
    v_cvt_pk_bf16_f32 v84, v210, v147
    v_mfma_f32_16x16x32_bf16 v[156:159], a[180:183], a[8:11], v[156:159]
    v_cvt_pk_bf16_f32 v85, v179, v211
    v_mfma_f32_16x16x32_bf16 v[156:159], a[252:255], a[76:79], v[156:159]
    s_waitcnt lgkmcnt(3)
    ds_write_b64 v26, v[84:85] offset:29712
    v_mfma_f32_16x16x32_bf16 v[156:159], a[100:103], a[56:59], v[156:159]
    v_mfma_f32_16x16x32_bf16 v[188:191], a[4:7], a[92:95], v[188:191]
    v_mfma_f32_16x16x32_bf16 v[188:191], a[112:115], a[68:71], v[188:191]
    v_mfma_f32_16x16x32_bf16 v[188:191], a[248:251], a[124:127], v[188:191]
    v_mfma_f32_16x16x32_bf16 v[188:191], a[244:247], a[72:75], v[188:191]
    s_waitcnt lgkmcnt(0)
    s_barrier
    v_mfma_f32_16x16x32_bf16 v[188:191], a[188:191], a[156:159], v[188:191]
    ds_read_b128 v[96:99], v24 offset:29696
    v_mul_f32 v156, v156, v48
    v_mfma_f32_16x16x32_bf16 v[188:191], a[208:211], a[8:11], v[188:191]
    ds_read_b128 v[88:91], v24 offset:30624
    v_mul_f32 v157, v157, v49
    v_mfma_f32_16x16x32_bf16 v[188:191], a[232:235], a[76:79], v[188:191]
    ds_read_b128 v[120:123], v24 offset:31552
    v_mul_f32 v158, v158, v50
    v_mfma_f32_16x16x32_bf16 v[188:191], a[240:243], a[56:59], v[188:191]
    ds_read_b128 v[108:111], v24 offset:32480
    v_mul_f32 v159, v159, v51
    v_mfma_f32_16x16x32_bf16 v[220:223], a[228:231], a[92:95], v[220:223]
    v_mfma_f32_16x16x32_bf16 v[220:223], a[36:39], a[68:71], v[220:223]
    v_mfma_f32_16x16x32_bf16 v[220:223], a[80:83], a[124:127], v[220:223]
    v_mfma_f32_16x16x32_bf16 v[220:223], a[160:163], a[72:75], v[220:223]
    s_waitcnt lgkmcnt(3)
    ds_read_b128 v[112:115], v30 offset:12288
    v_mfma_f32_16x16x32_bf16 v[220:223], a[184:187], a[156:159], v[220:223]
    buffer_store_dwordx4 v[96:99], v25, s[16:19], s72 offen sc1
    v_mfma_f32_16x16x32_bf16 v[220:223], a[64:67], a[8:11], v[220:223]
    v_mul_f32 v188, v188, v52
    v_mul_f32 v189, v189, v53
    v_mfma_f32_16x16x32_bf16 v[220:223], a[176:179], a[76:79], v[220:223]
    v_mul_f32 v190, v190, v54
    v_mul_f32 v191, v191, v55
    v_mfma_f32_16x16x32_bf16 v[220:223], a[0:3], a[56:59], v[220:223]
    s_waitcnt lgkmcnt(2)
    v_mfma_f32_16x16x32_bf16 v[248:251], a[108:111], a[212:215], v[248:251]
    buffer_store_dwordx4 v[88:91], v25, s[16:19], s73 offen sc1
    v_mfma_f32_16x16x32_bf16 v[248:251], a[204:207], a[24:27], v[248:251]
    v_mfma_f32_16x16x32_bf16 v[248:251], a[28:31], a[132:135], v[248:251]
    v_mfma_f32_16x16x32_bf16 v[248:251], a[200:203], a[224:227], v[248:251]
    v_mul_f32 v220, v220, v76
    v_mfma_f32_16x16x32_bf16 v[152:155], a[12:15], a[212:215], v[152:155]
    buffer_store_dwordx4 v[120:123], v25, s[16:19], s74 offen sc1
    v_mfma_f32_16x16x32_bf16 v[152:155], a[148:151], a[24:27], v[152:155]
    v_mul_f32 v221, v221, v77
    v_mul_f32 v222, v222, v78
    v_mfma_f32_16x16x32_bf16 v[152:155], a[40:43], a[32:35], v[152:155]
    v_mul_f32 v223, v223, v79
    v_cvt_pk_bf16_f32 v64, v156, v188
    v_mfma_f32_16x16x32_bf16 v[152:155], a[144:147], a[168:171], v[152:155]
    s_waitcnt lgkmcnt(0)
    v_cvt_pk_bf16_f32 v65, v220, v157
    v_mfma_f32_16x16x32_bf16 v[152:155], a[136:139], a[132:135], v[152:155]
    buffer_store_dwordx4 v[108:111], v25, s[16:19], s75 offen sc1
    v_mfma_f32_16x16x32_bf16 v[152:155], a[180:183], a[224:227], v[152:155]
    ds_write_b64 v27, v[64:65] offset:44544
    v_cvt_pk_bf16_f32 v66, v189, v221
    v_mfma_f32_16x16x32_bf16 v[152:155], a[252:255], a[104:107], v[152:155]
    v_cvt_pk_bf16_f32 v67, v158, v190
    v_cvt_pk_bf16_f32 v92, v222, v159
    v_mfma_f32_16x16x32_bf16 v[152:155], a[100:103], a[44:47], v[152:155]
    ds_write_b64 v27, v[66:67] offset:44552
    v_cvt_pk_bf16_f32 v93, v191, v223
    v_mfma_f32_16x16x32_bf16 v[184:187], a[4:7], a[212:215], v[184:187]
    ds_write_b64 v27, v[92:93] offset:44560
    v_add_f32 v248, v248, v112
    v_mfma_f32_16x16x32_bf16 v[184:187], a[112:115], a[24:27], v[184:187]
    v_mul_f32 v248, v248, v124
    v_add_f32 v249, v249, v113
    v_mfma_f32_16x16x32_bf16 v[184:187], a[248:251], a[32:35], v[184:187]
    v_mul_f32 v249, v249, v125
    v_add_f32 v250, v250, v114
    v_mfma_f32_16x16x32_bf16 v[184:187], a[244:247], a[168:171], v[184:187]
    v_mul_f32 v250, v250, v126
    v_add_f32 v251, v251, v115
    v_mfma_f32_16x16x32_bf16 v[184:187], a[188:191], a[132:135], v[184:187]
    v_mul_f32 v251, v251, v127
    v_cvt_pk_bf16_f32 v112, v248, v249
    v_mfma_f32_16x16x32_bf16 v[184:187], a[208:211], a[224:227], v[184:187]
    v_cvt_pk_bf16_f32 v113, v250, v251
    v_mul_f32 v152, v152, v48
    v_mfma_f32_16x16x32_bf16 v[184:187], a[232:235], a[104:107], v[184:187]
    ds_write_b64 v28, v[112:113] offset:44544
    v_mul_f32 v153, v153, v49
    v_mfma_f32_16x16x32_bf16 v[184:187], a[240:243], a[44:47], v[184:187]
    v_mul_f32 v154, v154, v50
    v_mul_f32 v155, v155, v51
    v_mfma_f32_16x16x32_bf16 v[216:219], a[228:231], a[212:215], v[216:219]
    s_waitcnt vmcnt(12)
    v_xor_b32 v8, 15, v8
    v_or_b32 v8, v8, v0
    v_mfma_f32_16x16x32_bf16 v[216:219], a[36:39], a[24:27], v[216:219]
    v_min_u32 v8, 1, v8
    v_lshlrev_b32 v8, 30, v8
    v_mfma_f32_16x16x32_bf16 v[216:219], a[80:83], a[32:35], v[216:219]
    v_mov_b32 v9, s76
    v_mfma_f32_16x16x32_bf16 v[216:219], a[160:163], a[168:171], v[216:219]
    buffer_store_dword v9, v8, s[12:15], s78 offen sc1
    v_mfma_f32_16x16x32_bf16 v[216:219], a[184:187], a[132:135], v[216:219]
    v_mul_f32 v184, v184, v52
    v_mul_f32 v185, v185, v53
    v_mfma_f32_16x16x32_bf16 v[216:219], a[64:67], a[224:227], v[216:219]
    v_mul_f32 v186, v186, v54
    v_mul_f32 v187, v187, v55
    v_mfma_f32_16x16x32_bf16 v[216:219], a[176:179], a[104:107], v[216:219]
    v_mfma_f32_16x16x32_bf16 v[216:219], a[0:3], a[44:47], v[216:219]
    s_nop 7
    v_mul_f32 v216, v216, v76
    v_mul_f32 v217, v217, v77
    v_mul_f32 v218, v218, v78
    v_mul_f32 v219, v219, v79
    v_cvt_pk_bf16_f32 v80, v152, v184
    v_cvt_pk_bf16_f32 v81, v216, v153
    v_cvt_pk_bf16_f32 v82, v185, v217
    v_cvt_pk_bf16_f32 v83, v154, v186
    v_cvt_pk_bf16_f32 v68, v218, v155
    v_cvt_pk_bf16_f32 v69, v187, v219
    ds_write_b64 v26, v[80:81] offset:44544
    ds_write_b64 v26, v[82:83] offset:44552
    ds_write_b64 v26, v[68:69] offset:44560
    s_waitcnt lgkmcnt(0)
    s_barrier
    ds_read_b128 v[104:107], v24 offset:44544
    ds_read_b128 v[116:119], v24 offset:45472
    ds_read_b128 v[72:75], v24 offset:46400
    ds_read_b128 v[100:103], v24 offset:47328
    s_waitcnt lgkmcnt(3)
    buffer_store_dwordx4 v[104:107], v25, s[16:19], s48 offen sc1
    s_waitcnt lgkmcnt(2)
    buffer_store_dwordx4 v[116:119], v25, s[16:19], s49 offen sc1
    s_waitcnt lgkmcnt(1)
    buffer_store_dwordx4 v[72:75], v25, s[16:19], s50 offen sc1
    s_waitcnt lgkmcnt(0)
    buffer_store_dwordx4 v[100:103], v25, s[16:19], s51 offen sc1
L_end:
    s_endpgm
L_slow0_0:
    s_mov_b32 s22, 0
    s_call_b64 s[20:21], L_tick
    s_mov_b32 s22, 0
    s_mov_b32 s23, 5120
    buffer_load_dwordx4 v[64:67], v32, s[12:15], s22 offen sc1
    buffer_load_dwordx4 v[68:71], v32, s[12:15], s23 offen sc1
    s_waitcnt vmcnt(0)
    v_bitop3_b32 v67, v67, v71, s76 bitop3:0x7e
    v_cmp_ne_u32 vcc, 0, v67
    s_cbranch_vccnz L_slow0_0
    s_branch L_back0_0
L_slow0_2:
    s_mov_b32 s22, 0
    s_call_b64 s[20:21], L_tick
    s_mov_b32 s22, 0
    s_mov_b32 s23, 5120
    buffer_load_dwordx2 v[72:73], v34, s[12:15], s22 offen sc1
    buffer_load_dwordx2 v[74:75], v34, s[12:15], s23 offen sc1
    s_waitcnt vmcnt(0)
    v_bitop3_b32 v73, v73, v75, s76 bitop3:0x7e
    v_cmp_ne_u32 vcc, 0, v73
    s_cbranch_vccnz L_slow0_2
    s_branch L_back0_2
L_slow0_1:
    s_mov_b32 s22, 0
    s_call_b64 s[20:21], L_tick
    s_mov_b32 s22, 0
    s_mov_b32 s23, 5120
    buffer_load_dwordx4 v[76:79], v33, s[12:15], s22 offen sc1
    buffer_load_dwordx4 v[80:83], v33, s[12:15], s23 offen sc1
    s_waitcnt vmcnt(0)
    v_bitop3_b32 v79, v79, v83, s76 bitop3:0x7e
    v_cmp_ne_u32 vcc, 0, v79
    s_cbranch_vccnz L_slow0_1
    s_branch L_back0_1
L_slow1_0:
    s_mov_b32 s22, 1
    s_call_b64 s[20:21], L_tick
    s_mov_b32 s22, 20480
    s_mov_b32 s23, 25600
    buffer_load_dwordx4 v[84:87], v32, s[12:15], s22 offen sc1
    buffer_load_dwordx4 v[88:91], v32, s[12:15], s23 offen sc1
    s_waitcnt vmcnt(0)
    v_bitop3_b32 v87, v87, v91, s76 bitop3:0x7e
    v_cmp_ne_u32 vcc, 0, v87
    s_cbranch_vccnz L_slow1_0
    s_branch L_back1_0
L_slow1_2:
    s_mov_b32 s22, 1
    s_call_b64 s[20:21], L_tick
    s_mov_b32 s22, 20480
    s_mov_b32 s23, 25600
    buffer_load_dwordx2 v[100:101], v34, s[12:15], s22 offen sc1
    buffer_load_dwordx2 v[102:103], v34, s[12:15], s23 offen sc1
    s_waitcnt vmcnt(0)
    v_bitop3_b32 v101, v101, v103, s76 bitop3:0x7e
    v_cmp_ne_u32 vcc, 0, v101
    s_cbranch_vccnz L_slow1_2
    s_branch L_back1_2
L_slow1_1:
    s_mov_b32 s22, 1
    s_call_b64 s[20:21], L_tick
    s_mov_b32 s22, 20480
    s_mov_b32 s23, 25600
    buffer_load_dwordx4 v[108:111], v33, s[12:15], s22 offen sc1
    buffer_load_dwordx4 v[112:115], v33, s[12:15], s23 offen sc1
    s_waitcnt vmcnt(0)
    v_bitop3_b32 v111, v111, v115, s76 bitop3:0x7e
    v_cmp_ne_u32 vcc, 0, v111
    s_cbranch_vccnz L_slow1_1
    s_branch L_back1_1
L_slow2_0:
    s_mov_b32 s22, 2
    s_call_b64 s[20:21], L_tick
    s_mov_b32 s22, 40960
    s_mov_b32 s23, 46080
    buffer_load_dwordx4 v[48:51], v32, s[12:15], s22 offen sc1
    buffer_load_dwordx4 v[52:55], v32, s[12:15], s23 offen sc1
    s_waitcnt vmcnt(0)
    v_bitop3_b32 v51, v51, v55, s76 bitop3:0x7e
    v_cmp_ne_u32 vcc, 0, v51
    s_cbranch_vccnz L_slow2_0
    s_branch L_back2_0
L_slow2_2:
    s_mov_b32 s22, 2
    s_call_b64 s[20:21], L_tick
    s_mov_b32 s22, 40960
    s_mov_b32 s23, 46080
    buffer_load_dwordx2 v[76:77], v34, s[12:15], s22 offen sc1
    buffer_load_dwordx2 v[78:79], v34, s[12:15], s23 offen sc1
    s_waitcnt vmcnt(0)
    v_bitop3_b32 v77, v77, v79, s76 bitop3:0x7e
    v_cmp_ne_u32 vcc, 0, v77
    s_cbranch_vccnz L_slow2_2
    s_branch L_back2_2
L_slow2_1:
    s_mov_b32 s22, 2
    s_call_b64 s[20:21], L_tick
    s_mov_b32 s22, 40960
    s_mov_b32 s23, 46080
    buffer_load_dwordx4 v[80:83], v33, s[12:15], s22 offen sc1
    buffer_load_dwordx4 v[104:107], v33, s[12:15], s23 offen sc1
    s_waitcnt vmcnt(0)
    v_bitop3_b32 v83, v83, v107, s76 bitop3:0x7e
    v_cmp_ne_u32 vcc, 0, v83
    s_cbranch_vccnz L_slow2_1
    s_branch L_back2_1
L_slow3_0:
    s_mov_b32 s22, 3
    s_call_b64 s[20:21], L_tick
    s_mov_b32 s22, 61440
    s_mov_b32 s23, 66560
    buffer_load_dwordx4 v[92:95], v32, s[12:15], s22 offen sc1
    buffer_load_dwordx4 v[116:119], v32, s[12:15], s23 offen sc1
    s_waitcnt vmcnt(0)
    v_bitop3_b32 v95, v95, v119, s76 bitop3:0x7e
    v_cmp_ne_u32 vcc, 0, v95
    s_cbranch_vccnz L_slow3_0
    s_branch L_back3_0
L_slow6_2:
    s_mov_b32 s22, 6
    s_call_b64 s[20:21], L_tick
    s_mov_b32 s22, 122880
    s_mov_b32 s23, 128000
    buffer_load_dwordx2 v[100:101], v34, s[12:15], s22 offen sc1
    buffer_load_dwordx2 v[102:103], v34, s[12:15], s23 offen sc1
    s_waitcnt vmcnt(0)
    v_bitop3_b32 v101, v101, v103, s76 bitop3:0x7e
    v_cmp_ne_u32 vcc, 0, v101
    s_cbranch_vccnz L_slow6_2
    s_branch L_back6_2
L_slow3_2:
    s_mov_b32 s22, 3
    s_call_b64 s[20:21], L_tick
    s_mov_b32 s22, 61440
    s_mov_b32 s23, 66560
    buffer_load_dwordx2 v[84:85], v34, s[12:15], s22 offen sc1
    buffer_load_dwordx2 v[86:87], v34, s[12:15], s23 offen sc1
    s_waitcnt vmcnt(0)
    v_bitop3_b32 v85, v85, v87, s76 bitop3:0x7e
    v_cmp_ne_u32 vcc, 0, v85
    s_cbranch_vccnz L_slow3_2
    s_branch L_back3_2
L_slow3_1:
    s_mov_b32 s22, 3
    s_call_b64 s[20:21], L_tick
    s_mov_b32 s22, 61440
    s_mov_b32 s23, 66560
    buffer_load_dwordx4 v[88:91], v33, s[12:15], s22 offen sc1
    buffer_load_dwordx4 v[120:123], v33, s[12:15], s23 offen sc1
    s_waitcnt vmcnt(0)
    v_bitop3_b32 v91, v91, v123, s76 bitop3:0x7e
    v_cmp_ne_u32 vcc, 0, v91
    s_cbranch_vccnz L_slow3_1
    s_branch L_back3_1
L_slow6_0:
    s_mov_b32 s22, 6
    s_call_b64 s[20:21], L_tick
    s_mov_b32 s22, 122880
    s_mov_b32 s23, 128000
    buffer_load_dwordx4 v[124:127], v32, s[12:15], s22 offen sc1
    buffer_load_dwordx4 v[64:67], v32, s[12:15], s23 offen sc1
    s_waitcnt vmcnt(0)
    v_bitop3_b32 v127, v127, v67, s76 bitop3:0x7e
    v_cmp_ne_u32 vcc, 0, v127
    s_cbranch_vccnz L_slow6_0
    s_branch L_back6_0
L_slow6_1:
    s_mov_b32 s22, 6
    s_call_b64 s[20:21], L_tick
    s_mov_b32 s22, 122880
    s_mov_b32 s23, 128000
    buffer_load_dwordx4 v[68:71], v33, s[12:15], s22 offen sc1
    buffer_load_dwordx4 v[72:75], v33, s[12:15], s23 offen sc1
    s_waitcnt vmcnt(0)
    v_bitop3_b32 v71, v71, v75, s76 bitop3:0x7e
    v_cmp_ne_u32 vcc, 0, v71
    s_cbranch_vccnz L_slow6_1
    s_branch L_back6_1
L_slow4_0:
    s_mov_b32 s22, 4
    s_call_b64 s[20:21], L_tick
    s_mov_b32 s22, 81920
    s_mov_b32 s23, 87040
    buffer_load_dwordx4 v[96:99], v32, s[12:15], s22 offen sc1
    buffer_load_dwordx4 v[108:111], v32, s[12:15], s23 offen sc1
    s_waitcnt vmcnt(0)
    v_bitop3_b32 v99, v99, v111, s76 bitop3:0x7e
    v_cmp_ne_u32 vcc, 0, v99
    s_cbranch_vccnz L_slow4_0
    s_branch L_back4_0
L_slow4_2:
    s_mov_b32 s22, 4
    s_call_b64 s[20:21], L_tick
    s_mov_b32 s22, 81920
    s_mov_b32 s23, 87040
    buffer_load_dwordx2 v[112:113], v34, s[12:15], s22 offen sc1
    buffer_load_dwordx2 v[114:115], v34, s[12:15], s23 offen sc1
    s_waitcnt vmcnt(0)
    v_bitop3_b32 v113, v113, v115, s76 bitop3:0x7e
    v_cmp_ne_u32 vcc, 0, v113
    s_cbranch_vccnz L_slow4_2
    s_branch L_back4_2
L_slow4_1:
    s_mov_b32 s22, 4
    s_call_b64 s[20:21], L_tick
    s_mov_b32 s22, 81920
    s_mov_b32 s23, 87040
    buffer_load_dwordx4 v[48:51], v33, s[12:15], s22 offen sc1
    buffer_load_dwordx4 v[52:55], v33, s[12:15], s23 offen sc1
    s_waitcnt vmcnt(0)
    v_bitop3_b32 v51, v51, v55, s76 bitop3:0x7e
    v_cmp_ne_u32 vcc, 0, v51
    s_cbranch_vccnz L_slow4_1
    s_branch L_back4_1
L_slow5_0:
    s_mov_b32 s22, 5
    s_call_b64 s[20:21], L_tick
    s_mov_b32 s22, 102400
    s_mov_b32 s23, 107520
    buffer_load_dwordx4 v[76:79], v32, s[12:15], s22 offen sc1
    buffer_load_dwordx4 v[80:83], v32, s[12:15], s23 offen sc1
    s_waitcnt vmcnt(0)
    v_bitop3_b32 v79, v79, v83, s76 bitop3:0x7e
    v_cmp_ne_u32 vcc, 0, v79
    s_cbranch_vccnz L_slow5_0
    s_branch L_back5_0
L_slow7_2:
    s_mov_b32 s22, 7
    s_call_b64 s[20:21], L_tick
    s_mov_b32 s22, 143360
    s_mov_b32 s23, 148480
    buffer_load_dwordx2 v[104:105], v34, s[12:15], s22 offen sc1
    buffer_load_dwordx2 v[106:107], v34, s[12:15], s23 offen sc1
    s_waitcnt vmcnt(0)
    v_bitop3_b32 v105, v105, v107, s76 bitop3:0x7e
    v_cmp_ne_u32 vcc, 0, v105
    s_cbranch_vccnz L_slow7_2
    s_branch L_back7_2
L_slow5_2:
    s_mov_b32 s22, 5
    s_call_b64 s[20:21], L_tick
    s_mov_b32 s22, 102400
    s_mov_b32 s23, 107520
    buffer_load_dwordx2 v[92:93], v34, s[12:15], s22 offen sc1
    buffer_load_dwordx2 v[94:95], v34, s[12:15], s23 offen sc1
    s_waitcnt vmcnt(0)
    v_bitop3_b32 v93, v93, v95, s76 bitop3:0x7e
    v_cmp_ne_u32 vcc, 0, v93
    s_cbranch_vccnz L_slow5_2
    s_branch L_back5_2
L_slow5_1:
    s_mov_b32 s22, 5
    s_call_b64 s[20:21], L_tick
    s_mov_b32 s22, 102400
    s_mov_b32 s23, 107520
    buffer_load_dwordx4 v[116:119], v33, s[12:15], s22 offen sc1
    buffer_load_dwordx4 v[84:87], v33, s[12:15], s23 offen sc1
    s_waitcnt vmcnt(0)
    v_bitop3_b32 v119, v119, v87, s76 bitop3:0x7e
    v_cmp_ne_u32 vcc, 0, v119
    s_cbranch_vccnz L_slow5_1
    s_branch L_back5_1
L_slow7_0:
    s_mov_b32 s22, 7
    s_call_b64 s[20:21], L_tick
    s_mov_b32 s22, 143360
    s_mov_b32 s23, 148480
    buffer_load_dwordx4 v[88:91], v32, s[12:15], s22 offen sc1
    buffer_load_dwordx4 v[120:123], v32, s[12:15], s23 offen sc1
    s_waitcnt vmcnt(0)
    v_bitop3_b32 v91, v91, v123, s76 bitop3:0x7e
    v_cmp_ne_u32 vcc, 0, v91
    s_cbranch_vccnz L_slow7_0
    s_branch L_back7_0
L_slow7_1:
    s_mov_b32 s22, 7
    s_call_b64 s[20:21], L_tick
    s_mov_b32 s22, 143360
    s_mov_b32 s23, 148480
    buffer_load_dwordx4 v[100:103], v33, s[12:15], s22 offen sc1
    buffer_load_dwordx4 v[96:99], v33, s[12:15], s23 offen sc1
    s_waitcnt vmcnt(0)
    v_bitop3_b32 v103, v103, v99, s76 bitop3:0x7e
    v_cmp_ne_u32 vcc, 0, v103
    s_cbranch_vccnz L_slow7_1
    s_branch L_back7_1
L_tick:
    s_add_u32 s52, s52, 1
    s_and_b32 s23, s52, 4095
    s_cbranch_scc1 L_tick_ret
    s_mov_b32 s53, s61
    s_mov_b32 s54, s62
    s_mul_i32 s61, s22, 1835008
    s_add_u32 s61, s61, s79
    s_mul_i32 s62, s22, 20480
    s_mul_i32 s23, s59, 163840
    s_add_u32 s62, s62, s23
    s_mov_b32 s22, 0
L_help_row:
    buffer_load_dwordx4 v[12:15], v19, s[4:7], s61 offen
    buffer_load_dwordx3 v[8:10], v18, s[4:7], s61 offen
    s_waitcnt vmcnt(0)
    v_lshlrev_b32 v12, v5, v12
    v_lshlrev_b32 v13, v5, v13
    v_lshlrev_b32 v14, v5, v14
    v_lshlrev_b32 v15, v5, v15
    v_permlane32_swap_b32 v12, v13
    s_nop 0
    v_permlane32_swap_b32 v14, v15
    v_or_b32 v12, v12, v13
    v_or_b32 v14, v14, v15
    v_mov_b32 v13, s76
    s_nop 0
    v_permlane16_swap_b32 v12, v14
    v_or_b32 v12, v12, v14
    s_nop 1
    v_or_b32_dpp v12, v12, v12 row_ror:8 row_mask:0xf bank_mask:0xf
    buffer_store_dwordx2 v[12:13], v21, s[12:15], s62 offen sc1
    v_mov_b32 v11, s76
    s_mov_b32 s23, 4
L_help_e:
    s_add_u32 s61, s61, 14336
    buffer_load_dwordx3 v[12:14], v18, s[4:7], s61 offen
    s_waitcnt vmcnt(0)
    v_lshl_or_b32 v8, v12, s23, v8
    v_lshl_or_b32 v9, v13, s23, v9
    v_lshl_or_b32 v10, v14, s23, v10
    s_add_u32 s23, s23, 4
    s_cmp_lt_u32 s23, 32
    s_cbranch_scc1 L_help_e
    buffer_store_dwordx4 v[8:11], v20, s[12:15], s62 offen sc1
    s_add_u32 s61, s61, 14336
    s_add_u32 s62, s62, 1280
    s_waitcnt vmcnt(0)
    s_add_u32 s22, s22, 1
    s_cmp_lt_u32 s22, 16
    s_cbranch_scc1 L_help_row
    s_mov_b32 s61, s53
    s_mov_b32 s62, s54
L_tick_ret:
    s_setpc_b64 s[20:21]
L_code_end:

.section .rodata,"a"
.p2align 6
.amdhsa_kernel standalone__normalfloat_lut_af4__prompt_kernel
  .amdhsa_next_free_vgpr 512
  .amdhsa_next_free_sgpr 102
  .amdhsa_accum_offset 256
  .amdhsa_group_segment_fixed_size 0
  .amdhsa_kernarg_size 56
  .amdhsa_user_sgpr_count 2
  .amdhsa_user_sgpr_kernarg_segment_ptr 1
  .amdhsa_system_sgpr_workgroup_id_x 1
.end_amdhsa_kernel
```

```asm
; @launch grid=(256,1,1) block=(256,1,1) lds=163840
.amdgcn_target "amdgcn-amd-amdhsa--gfx950"
.text
.globl standalone__normalfloat_lut_af4__prompt_kernel
.p2align 8
.type standalone__normalfloat_lut_af4__prompt_kernel,@function
standalone__normalfloat_lut_af4__prompt_kernel:
    s_cmp_ge_u32 s2, 256
    s_cbranch_scc1 L_end
    s_load_dwordx2 s[4:5], s[0:1], 8
    s_load_dwordx2 s[12:13], s[0:1], 48
    s_load_dwordx2 s[8:9], s[0:1], 0
    s_load_dwordx2 s[28:29], s[0:1], 16
    s_getpc_b64 s[48:49]
    s_mov_b32 s50, L_code_end-standalone__normalfloat_lut_af4__prompt_kernel-256
    s_mov_b32 s51, 0x20000
    s_lshr_b32 s61, s2, 3
    v_lshl_add_u32 v10, v0, 5, s61
    v_lshlrev_b32 v10, 7, v10
    buffer_load_dword v1, v10, s[48:51], 0 offen offset:256
    v_lshrrev_b32 v5, 6, v0
    v_and_b32 v2, 63, v0
    s_and_b32 s60, s2, 7
    s_lshr_b32 s61, s2, 3
    v_readfirstlane_b32 s63, v5
    s_and_b32 s58, s60, 1
    s_lshl_b32 s58, s58, 3
    s_and_b32 s62, s61, 7
    s_add_u32 s58, s58, s62
    s_lshr_b32 s59, s60, 1
    s_lshl_b32 s59, s59, 2
    s_lshr_b32 s62, s61, 3
    s_add_u32 s59, s59, s62
    v_mul_u32_u24 v18, 12, v2
    v_lshrrev_b32 v6, 3, v2
    v_and_b32 v7, 7, v2
    v_mul_u32_u24 v19, 14336, v6
    v_lshl_add_u32 v19, v7, 4, v19
    v_add_u32 v19, 768, v19
    s_lshl_b32 s60, s63, 4
    s_add_u32 s60, s60, s58
    s_mul_i32 s61, s60, 114688
    s_mul_i32 s79, s59, 896
    s_add_u32 s61, s61, s79
    s_mov_b32 s6, 14680064
    s_mov_b32 s7, 0x20000
    s_lshl_b32 s78, s59, 7
    s_add_u32 s78, s78, 2621440
    s_cmp_ge_u32 s63, 2
    s_cselect_b32 s46, 1, 0
    s_cmp_lg_u32 s46, 0
    s_waitcnt lgkmcnt(0)
    s_load_dword s76, s[12:13], s78
    s_cbranch_scc1 L_Y
L_X:
    buffer_load_dwordx4 v[160:163], v19, s[4:7], s61 offen
    buffer_load_dwordx3 v[128:130], v18, s[4:7], s61 offen
    s_add_u32 s61, s61, 14336
    buffer_load_dwordx3 v[132:134], v18, s[4:7], s61 offen
    s_add_u32 s61, s61, 14336
    buffer_load_dwordx3 v[136:138], v18, s[4:7], s61 offen
    s_add_u32 s61, s61, 14336
    buffer_load_dwordx3 v[140:142], v18, s[4:7], s61 offen
    s_add_u32 s61, s61, 14336
    buffer_load_dwordx3 v[144:146], v18, s[4:7], s61 offen
    s_add_u32 s61, s61, 14336
    buffer_load_dwordx3 v[148:150], v18, s[4:7], s61 offen
    s_add_u32 s61, s61, 14336
    buffer_load_dwordx3 v[152:154], v18, s[4:7], s61 offen
    s_add_u32 s61, s61, 14336
    buffer_load_dwordx3 v[156:158], v18, s[4:7], s61 offen
    s_add_u32 s61, s61, 7239680
    s_cmp_eq_u32 s46, 1
    s_cbranch_scc1 L_C
L_Y:
    v_and_b32 v4, 15, v2
    v_lshlrev_b32 v8, 1, v4
    v_lshrrev_b32 v9, 4, v0
    v_lshlrev_b32 v9, 1, v9
    s_mov_b32 s30, 32
    s_mov_b32 s31, 0x20000
    buffer_load_ushort v16, v8, s[28:31], 0 offen
    buffer_load_ushort v17, v9, s[28:31], 0 offen
    s_load_dwordx2 s[32:33], s[0:1], 24
    s_load_dwordx2 s[16:17], s[0:1], 32
    s_load_dwordx2 s[24:25], s[0:1], 40
    v_lshrrev_b32 v3, 4, v2
    v_xor_b32 v9, v7, v3
    s_lshl_b32 s70, s63, 5
    v_add_lshl_u32 v8, v6, s70, 11
    v_lshl_add_u32 v36, v9, 4, v8
    v_xor_b32 v37, 64, v36
    v_add_u32 v38, 30720, v36
    v_add_u32 v37, 15360, v37
    v_add_u32 v39, 30720, v37
    s_mov_b32 s10, 4194304
    s_mov_b32 s11, 0x20000
    s_lshl_b32 s55, s58, 18
    s_lshl_b32 s57, s63, 12
    s_add_u32 s57, s57, 65536
    s_add_u32 m0, s57, 32768
    s_add_u32 s56, s55, 0
    buffer_load_dwordx4 v36, s[8:11], s56 offen offset:0 lds
    buffer_load_dwordx4 v37, s[8:11], s56 offen offset:1024 lds
    buffer_load_dwordx4 v38, s[8:11], s56 offen offset:2048 lds
    buffer_load_dwordx4 v39, s[8:11], s56 offen offset:3072 lds
    s_add_u32 m0, s57, 49152
    s_add_u32 s3, s55, 128
    buffer_load_dwordx4 v36, s[8:11], s3 offen offset:0 lds
    buffer_load_dwordx4 v37, s[8:11], s3 offen offset:1024 lds
    buffer_load_dwordx4 v38, s[8:11], s3 offen offset:2048 lds
    buffer_load_dwordx4 v39, s[8:11], s3 offen offset:3072 lds
    s_cmp_eq_u32 s46, 1
    s_cbranch_scc1 L_X
L_C:
    s_mov_b32 s14, 2623488
    s_mov_b32 s15, 0x20000
    s_mul_i32 s68, s59, 163840
    s_mul_i32 s62, s60, 1280
    s_add_u32 s62, s62, s68
    v_lshlrev_b32 v5, 2, v6
    v_lshlrev_b32 v20, 4, v2
    v_and_b32 v8, 1, v6
    v_lshlrev_b32 v8, 30, v8
    v_and_b32 v9, 4, v7
    v_mad_u32_u24 v21, v9, 3, v7
    v_lshl_add_u32 v21, v3, 2, v21
    v_lshl_add_u32 v21, v21, 3, v8
    v_add_u32 v21, 1024, v21
    s_waitcnt lgkmcnt(0)
    s_add_u32 s76, s76, 2654435769
    s_cmp_eq_u32 s46, 1
    s_cbranch_scc1 L_T
L_P:
    s_waitcnt vmcnt(18)
    v_lshlrev_b32 v160, v5, v160
    v_lshlrev_b32 v161, v5, v161
    v_lshlrev_b32 v162, v5, v162
    v_lshlrev_b32 v163, v5, v163
    v_permlane32_swap_b32 v160, v161
    s_nop 0
    v_permlane32_swap_b32 v162, v163
    v_or_b32 v160, v160, v161
    v_or_b32 v162, v162, v163
    v_mov_b32 v161, s76
    s_nop 0
    v_permlane16_swap_b32 v160, v162
    v_or_b32 v160, v160, v162
    s_nop 1
    v_or_b32_dpp v160, v160, v160 row_ror:8 row_mask:0xf bank_mask:0xf
    buffer_store_dwordx2 v[160:161], v21, s[12:15], s62 offen sc1
    v_mov_b32 v131, s76
    s_waitcnt vmcnt(17)
    v_lshl_or_b32 v128, v132, 4, v128
    v_lshl_or_b32 v129, v133, 4, v129
    v_lshl_or_b32 v130, v134, 4, v130
    s_waitcnt vmcnt(16)
    v_lshl_or_b32 v128, v136, 8, v128
    v_lshl_or_b32 v129, v137, 8, v129
    v_lshl_or_b32 v130, v138, 8, v130
    s_waitcnt vmcnt(15)
    v_lshl_or_b32 v128, v140, 12, v128
    v_lshl_or_b32 v129, v141, 12, v129
    v_lshl_or_b32 v130, v142, 12, v130
    s_waitcnt vmcnt(14)
    v_lshl_or_b32 v128, v144, 16, v128
    v_lshl_or_b32 v129, v145, 16, v129
    v_lshl_or_b32 v130, v146, 16, v130
    s_waitcnt vmcnt(13)
    v_lshl_or_b32 v128, v148, 20, v128
    v_lshl_or_b32 v129, v149, 20, v129
    v_lshl_or_b32 v130, v150, 20, v130
    s_waitcnt vmcnt(12)
    v_lshl_or_b32 v128, v152, 24, v128
    v_lshl_or_b32 v129, v153, 24, v129
    v_lshl_or_b32 v130, v154, 24, v130
    s_waitcnt vmcnt(11)
    v_lshl_or_b32 v128, v156, 28, v128
    v_lshl_or_b32 v129, v157, 28, v129
    v_lshl_or_b32 v130, v158, 28, v130
    buffer_store_dwordx4 v[128:131], v20, s[12:15], s62 offen sc1
    s_add_u32 s62, s62, 81920
    s_cmp_eq_u32 s46, 1
    s_cbranch_scc1 L_A
L_T:
    v_lshlrev_b32 v8, 4, v7
    v_lshl_add_u32 v8, v0, 8, v8
    v_xor_b32 v9, 16, v8
    v_xor_b32 v10, 32, v8
    v_xor_b32 v11, 48, v8
    v_xor_b32 v12, 64, v8
    v_xor_b32 v13, 80, v8
    v_xor_b32 v14, 96, v8
    v_xor_b32 v15, 112, v8
    s_waitcnt vmcnt(10)
    v_lshl_or_b32 v56, v17, 16, v16
    v_lshl_or_b32 v57, v17, 16, v16
    v_lshl_or_b32 v58, v17, 16, v16
    v_lshl_or_b32 v59, v17, 16, v16
    ds_write_b128 v8, v[56:59]
    ds_write_b128 v9, v[56:59]
    ds_write_b128 v10, v[56:59]
    ds_write_b128 v11, v[56:59]
    ds_write_b128 v12, v[56:59]
    ds_write_b128 v13, v[56:59]
    ds_write_b128 v14, v[56:59]
    ds_write_b128 v15, v[56:59]
    s_and_b32 s64, s63, 1
    s_lshr_b32 s65, s63, 1
    s_mul_i32 s69, s64, 10240
    v_mul_u32_u24 v16, 1280, v3
    s_lshl_b32 s70, s63, 8
    s_add_u32 s70, s70, s68
    v_lshl_add_u32 v33, v4, 4, v16
    s_add_u32 s71, s70, s69
    v_add_u32 v32, s71, v33
    s_sub_u32 s71, 10240, s69
    s_add_u32 s71, s71, s70
    v_add_u32 v33, s71, v33
    v_and_b32 v17, 1, v4
    v_lshlrev_b32 v17, 6, v17
    s_lshl_b32 s70, s64, 1
    v_xor_b32 v31, s70, v4
    v_and_b32 v31, 2, v31
    v_lshl_add_u32 v17, v31, 4, v17
    v_lshrrev_b32 v31, 2, v4
    v_lshl_add_u32 v17, v31, 3, v17
    s_lshl_b32 s70, s65, 7
    s_add_u32 s70, s70, s68
    s_add_u32 s70, s70, s69
    s_add_u32 s70, s70, 1024
    v_add3_u32 v34, v16, v17, s70
    s_mov_b32 s36, 202114048
    s_mov_b32 s37, 202114304
    s_mov_b32 s38, 202114560
    s_mov_b32 s39, 202114816
    v_and_b32 v35, 31, v2
    v_lshlrev_b32 v35, 2, v35
    v_lshrrev_b32 v16, 1, v4
    v_xor_b32 v16, v16, v3
    v_lshlrev_b32 v16, 4, v16
    v_lshl_add_u32 v16, v4, 7, v16
    s_lshl_b32 s70, s64, 14
    s_add_u32 s72, s70, 65536
    s_sub_u32 s73, 81920, s70
    v_add_u32 v40, s72, v16
    v_add_u32 v42, s73, v16
    v_xor_b32 v41, 64, v40
    v_xor_b32 v43, 64, v42
    v_add_u32 v44, 65536, v40
    v_add_u32 v45, 65536, v41
    v_add_u32 v46, 65536, v42
    v_add_u32 v47, 65536, v43
    s_mov_b32 s52, 0
    s_mov_b32 s40, 0
    s_mov_b32 s41, 5120
    s_cmp_eq_u32 s46, 1
    s_cbranch_scc1 L_W
    s_waitcnt vmcnt(2)
    s_branch L_B
L_W:
    s_mov_b64 exec, 0
    s_cmp_eq_u32 s63, 0
    s_cbranch_scc1 L_pad2
    s_cmp_eq_u32 s63, 1
    s_cbranch_scc1 L_pad4
    s_cmp_eq_u32 s63, 2
    s_cbranch_scc1 L_pad0
    s_cmp_eq_u32 s63, 3
    s_cbranch_scc1 L_pad1
L_warmed:
    s_mov_b64 exec, -1
L_L:
    s_cmp_eq_u32 s46, 0
    s_cbranch_scc1 L_A
    s_waitcnt vmcnt(0)
L_B:
    s_waitcnt lgkmcnt(0)
    s_barrier
    buffer_load_dwordx4 v[64:67], v32, s[12:15], s40 offen sc1
    buffer_load_dwordx4 v[68:71], v32, s[12:15], s41 offen sc1
    buffer_load_dwordx2 v[72:73], v34, s[12:15], s40 offen sc1
    buffer_load_dwordx2 v[74:75], v34, s[12:15], s41 offen sc1
    buffer_load_dwordx4 v[76:79], v33, s[12:15], s40 offen sc1
    buffer_load_dwordx4 v[80:83], v33, s[12:15], s41 offen sc1
    s_cmp_eq_u32 s46, 0
    s_cbranch_scc1 L_W
    s_waitcnt vmcnt(6)
    s_branch L_P
L_A:
    ds_read_b128 a[0:3], v40 offset:32768
    ds_read_b128 a[4:7], v41 offset:32768
    ds_read_b128 a[8:11], v40 offset:34816
    ds_read_b128 a[12:15], v41 offset:34816
    ds_read_b128 a[16:19], v40 offset:36864
    ds_read_b128 a[20:23], v41 offset:36864
    ds_read_b128 a[24:27], v40 offset:38912
    ds_read_b128 a[28:31], v41 offset:38912
    ds_read_b128 a[36:39], v40 offset:40960
    ds_read_b128 a[40:43], v41 offset:40960
    ds_read_b128 a[44:47], v40 offset:43008
    ds_read_b128 a[52:55], v41 offset:43008
    ds_read_b128 a[56:59], v40 offset:45056
    ds_read_b128 a[64:67], v41 offset:45056
    ds_read_b128 a[68:71], v40 offset:47104
    ds_read_b128 a[72:75], v41 offset:47104
    s_add_u32 m0, s57, 65536
    s_add_u32 s56, s55, 256
    buffer_load_dwordx4 v36, s[8:11], s56 offen offset:0 lds
    buffer_load_dwordx4 v37, s[8:11], s56 offen offset:1024 lds
    buffer_load_dwordx4 v38, s[8:11], s56 offen offset:2048 lds
    buffer_load_dwordx4 v39, s[8:11], s56 offen offset:3072 lds
    s_add_u32 m0, s57, 81920
    s_add_u32 s3, s55, 384
    buffer_load_dwordx4 v36, s[8:11], s3 offen offset:0 lds
    buffer_load_dwordx4 v37, s[8:11], s3 offen offset:1024 lds
    buffer_load_dwordx4 v38, s[8:11], s3 offen offset:2048 lds
    buffer_load_dwordx4 v39, s[8:11], s3 offen offset:3072 lds
L_chk0:
    s_waitcnt vmcnt(14)
    s_cmp_eq_u32 s46, 1
    s_cbranch_scc1 L_rw0
    s_waitcnt vmcnt(12)
L_rw0:
    v_bitop3_b32 v67, v67, v71, s76 bitop3:0x7e
    v_cmp_ne_u32 vcc, 0, v67
    s_cbranch_vccnz L_retry0
    v_perm_b32 v56, v64, v35, s36
    v_perm_b32 v57, v64, v35, s37
    v_perm_b32 v58, v64, v35, s38
    v_perm_b32 v59, v64, v35, s39
    v_perm_b32 v60, v68, v35, s36
    v_perm_b32 v61, v68, v35, s37
    v_perm_b32 v62, v68, v35, s38
    v_perm_b32 v63, v68, v35, s39
    ds_read_b32 a32, v56
    ds_read_b32 a33, v57
    ds_read_b32 a34, v58
    ds_read_b32 a35, v59
    ds_read_b32 a48, v60
    ds_read_b32 a49, v61
    ds_read_b32 a50, v62
    ds_read_b32 a51, v63
    v_perm_b32 v56, v65, v35, s36
    v_perm_b32 v57, v65, v35, s37
    v_perm_b32 v58, v65, v35, s38
    v_perm_b32 v59, v65, v35, s39
    v_perm_b32 v60, v69, v35, s36
    v_perm_b32 v61, v69, v35, s37
    ds_read_b32 a60, v56
    ds_read_b32 a61, v57
    ds_read_b32 a62, v58
    ds_read_b32 a63, v59
    s_waitcnt vmcnt(10)
    s_cmp_eq_u32 s46, 1
    s_cbranch_scc1 L_rw1
    s_waitcnt vmcnt(8)
L_rw1:
    v_bitop3_b32 v79, v79, v83, s76 bitop3:0x7e
    v_bitop3_b32 v73, v73, v75, s76 bitop3:0x7e
    v_or_b32 v79, v79, v73
    v_cmp_ne_u32 vcc, 0, v79
    s_cbranch_vccz L_main
L_retry0:
    s_add_u32 s52, s52, 1
    s_and_b32 s23, s52, 4095
    s_cbranch_scc1 L_retry0b
    s_mov_b32 s22, 0
    s_call_b64 s[20:21], L_help
L_retry0b:
    buffer_load_dwordx4 v[64:67], v32, s[12:15], s40 offen sc1
    buffer_load_dwordx4 v[68:71], v32, s[12:15], s41 offen sc1
    buffer_load_dwordx2 v[72:73], v34, s[12:15], s40 offen sc1
    buffer_load_dwordx2 v[74:75], v34, s[12:15], s41 offen sc1
    buffer_load_dwordx4 v[76:79], v33, s[12:15], s40 offen sc1
    buffer_load_dwordx4 v[80:83], v33, s[12:15], s41 offen sc1
    s_waitcnt vmcnt(0) lgkmcnt(0)
    s_branch L_chk0
.p2align 12
L_main:
L_pad0:
    s_cbranch_execz L_warmed
    s_waitcnt lgkmcnt(8)
    v_mfma_f32_16x16x32_bf16 v[128:131], a[32:35], a[0:3], 0
    s_waitcnt lgkmcnt(4)
    s_mov_b32 s40, 20480
    ds_read_b32 a76, v60
    v_mfma_f32_16x16x32_bf16 v[128:131], a[48:51], a[4:7], v[128:131]
    buffer_load_dwordx4 v[84:87], v32, s[12:15], s40 offen sc1
    v_mfma_f32_16x16x32_bf16 v[132:135], a[32:35], a[8:11], 0
    s_mov_b32 s41, 25600
    ds_read_b32 a77, v61
    v_perm_b32 v62, v69, v35, s38
    v_mfma_f32_16x16x32_bf16 v[132:135], a[48:51], a[12:15], v[132:135]
    ds_read_b32 a78, v62
    v_perm_b32 v63, v69, v35, s39
    v_mfma_f32_16x16x32_bf16 v[136:139], a[32:35], a[16:19], 0
    ds_read_b128 a[80:83], v42 offset:32768
    ds_read_b32 a79, v63
    v_mfma_f32_16x16x32_bf16 v[136:139], a[48:51], a[20:23], v[136:139]
    buffer_load_dwordx4 v[88:91], v32, s[12:15], s41 offen sc1
    v_mfma_f32_16x16x32_bf16 v[140:143], a[32:35], a[24:27], 0
    ds_read_b128 a[84:87], v43 offset:32768
    v_perm_b32 v56, v66, v35, s36
    v_mfma_f32_16x16x32_bf16 v[140:143], a[48:51], a[28:31], v[140:143]
    ds_read_b32 a88, v56
    v_perm_b32 v57, v66, v35, s37
    v_mfma_f32_16x16x32_bf16 v[144:147], a[32:35], a[36:39], 0
    ds_read_b32 a89, v57
    ds_read_b128 a[92:95], v42 offset:34816
    v_mfma_f32_16x16x32_bf16 v[144:147], a[48:51], a[40:43], v[144:147]
    buffer_load_dwordx4 v[92:95], v19, s[4:7], s61 offen
    v_mfma_f32_16x16x32_bf16 v[148:151], a[32:35], a[44:47], 0
    v_perm_b32 v58, v66, v35, s38
    v_perm_b32 v59, v66, v35, s39
    v_mfma_f32_16x16x32_bf16 v[148:151], a[48:51], a[52:55], v[148:151]
    ds_read_b32 a90, v58
    v_perm_b32 v60, v70, v35, s36
    v_mfma_f32_16x16x32_bf16 v[152:155], a[32:35], a[56:59], 0
    s_waitcnt lgkmcnt(7)
    ds_read_b32 a91, v59
    ds_read_b32 a96, v60
    v_mfma_f32_16x16x32_bf16 v[152:155], a[48:51], a[64:67], v[152:155]
    buffer_load_dwordx3 v[96:98], v18, s[4:7], s61 offen
    v_mfma_f32_16x16x32_bf16 v[156:159], a[32:35], a[68:71], 0
    s_add_u32 s61, s61, 14336
    ds_read_b128 a[100:103], v43 offset:34816
    v_perm_b32 v61, v70, v35, s37
    v_mfma_f32_16x16x32_bf16 v[156:159], a[48:51], a[72:75], v[156:159]
    s_mov_b32 s42, 20480
    ds_read_b32 a97, v61
    ds_read_b128 a[104:107], v42 offset:36864
    v_mfma_f32_16x16x32_bf16 v[160:163], a[60:63], a[0:3], 0
    s_waitcnt lgkmcnt(8)
    v_perm_b32 v62, v70, v35, s38
    v_perm_b32 v63, v70, v35, s39
    v_mfma_f32_16x16x32_bf16 v[160:163], a[76:79], a[4:7], v[160:163]
    ds_read_b32 a98, v62
    ds_read_b32 a99, v63
    v_mfma_f32_16x16x32_bf16 v[164:167], a[60:63], a[8:11], 0
    buffer_load_dwordx2 v[100:101], v34, s[12:15], s42 offen sc1
    v_mfma_f32_16x16x32_bf16 v[164:167], a[76:79], a[12:15], v[164:167]
    s_mov_b32 s43, 25600
    ds_read_b128 a[108:111], v43 offset:36864
    v_perm_b32 v56, v72, v35, s36
    v_mfma_f32_16x16x32_bf16 v[168:171], a[60:63], a[16:19], 0
    ds_read_b32 a112, v56
    v_perm_b32 v57, v72, v35, s37
    v_mfma_f32_16x16x32_bf16 v[168:171], a[76:79], a[20:23], v[168:171]
    ds_read_b32 a113, v57
    ds_read_b128 a[116:119], v42 offset:38912
    v_mfma_f32_16x16x32_bf16 v[172:175], a[60:63], a[24:27], 0
    buffer_load_dwordx2 v[102:103], v34, s[12:15], s43 offen sc1
    v_mfma_f32_16x16x32_bf16 v[172:175], a[76:79], a[28:31], v[172:175]
    ds_read_b128 a[120:123], v43 offset:38912
    v_perm_b32 v58, v72, v35, s38
    v_mfma_f32_16x16x32_bf16 v[176:179], a[60:63], a[36:39], 0
    ds_read_b32 a114, v58
    v_perm_b32 v59, v72, v35, s39
    v_mfma_f32_16x16x32_bf16 v[176:179], a[76:79], a[40:43], v[176:179]
    ds_read_b32 a115, v59
    ds_read_b128 a[124:127], v42 offset:40960
    v_mfma_f32_16x16x32_bf16 v[180:183], a[60:63], a[44:47], 0
    buffer_load_dwordx3 v[104:106], v18, s[4:7], s61 offen
    v_mfma_f32_16x16x32_bf16 v[180:183], a[76:79], a[52:55], v[180:183]
    s_add_u32 s61, s61, 14336
    v_perm_b32 v60, v74, v35, s36
    v_perm_b32 v61, v74, v35, s37
    v_mfma_f32_16x16x32_bf16 v[184:187], a[60:63], a[56:59], 0
    s_mov_b32 s44, 20480
    ds_read_b32 a128, v60
    v_perm_b32 v62, v74, v35, s38
    v_mfma_f32_16x16x32_bf16 v[184:187], a[76:79], a[64:67], v[184:187]
    s_waitcnt lgkmcnt(7)
    ds_read_b32 a129, v61
    ds_read_b32 a130, v62
    v_mfma_f32_16x16x32_bf16 v[188:191], a[60:63], a[68:71], 0
    buffer_load_dwordx3 v[108:110], v18, s[4:7], s61 offen
    v_mfma_f32_16x16x32_bf16 v[188:191], a[76:79], a[72:75], v[188:191]
    s_add_u32 s61, s61, 14336
    ds_read_b128 a[132:135], v43 offset:40960
    v_perm_b32 v63, v74, v35, s39
    v_mfma_f32_16x16x32_bf16 v[192:195], a[88:91], a[0:3], 0
    s_mov_b32 s45, 25600
    ds_read_b32 a131, v63
    v_perm_b32 v56, v76, v35, s36
    v_mfma_f32_16x16x32_bf16 v[192:195], a[96:99], a[4:7], v[192:195]
    ds_read_b32 a140, v56
    ds_read_b128 a[136:139], v42 offset:43008
    v_mfma_f32_16x16x32_bf16 v[196:199], a[88:91], a[8:11], 0
    buffer_load_dwordx4 v[112:115], v33, s[12:15], s44 offen sc1
    v_mfma_f32_16x16x32_bf16 v[196:199], a[96:99], a[12:15], v[196:199]
    ds_read_b128 a[144:147], v43 offset:43008
    v_perm_b32 v57, v76, v35, s37
    v_mfma_f32_16x16x32_bf16 v[200:203], a[88:91], a[16:19], 0
    ds_read_b32 a141, v57
    v_perm_b32 v58, v76, v35, s38
    v_mfma_f32_16x16x32_bf16 v[200:203], a[96:99], a[20:23], v[200:203]
    ds_read_b32 a142, v58
    ds_read_b128 a[148:151], v42 offset:45056
    v_mfma_f32_16x16x32_bf16 v[204:207], a[88:91], a[24:27], 0
    buffer_load_dwordx4 v[116:119], v33, s[12:15], s45 offen sc1
    v_mfma_f32_16x16x32_bf16 v[204:207], a[96:99], a[28:31], v[204:207]
    v_perm_b32 v59, v76, v35, s39
    v_perm_b32 v60, v80, v35, s36
    v_mfma_f32_16x16x32_bf16 v[208:211], a[88:91], a[36:39], 0
    ds_read_b32 a143, v59
    v_perm_b32 v61, v80, v35, s37
    v_mfma_f32_16x16x32_bf16 v[208:211], a[96:99], a[40:43], v[208:211]
    ds_read_b32 a152, v60
    ds_read_b32 a153, v61
    v_mfma_f32_16x16x32_bf16 v[212:215], a[88:91], a[44:47], 0
    buffer_load_dwordx3 v[120:122], v18, s[4:7], s61 offen
    v_mfma_f32_16x16x32_bf16 v[212:215], a[96:99], a[52:55], v[212:215]
    s_add_u32 s61, s61, 14336
    ds_read_b128 a[156:159], v43 offset:45056
    v_perm_b32 v62, v80, v35, s38
    v_mfma_f32_16x16x32_bf16 v[216:219], a[88:91], a[56:59], 0
    ds_read_b32 a154, v62
    v_perm_b32 v63, v80, v35, s39
    v_mfma_f32_16x16x32_bf16 v[216:219], a[96:99], a[64:67], v[216:219]
    s_waitcnt lgkmcnt(7)
    ds_read_b32 a155, v63
    ds_read_b128 a[160:163], v42 offset:47104
    v_mfma_f32_16x16x32_bf16 v[220:223], a[88:91], a[68:71], 0
    buffer_load_dwordx3 v[124:126], v18, s[4:7], s61 offen
    v_mfma_f32_16x16x32_bf16 v[220:223], a[96:99], a[72:75], v[220:223]
    s_add_u32 s61, s61, 14336
    ds_read_b128 a[164:167], v43 offset:47104
    v_perm_b32 v56, v77, v35, s36
    v_mfma_f32_16x16x32_bf16 v[224:227], a[112:115], a[0:3], 0
    s_add_u32 s56, s55, 512
    v_perm_b32 v57, v77, v35, s37
    v_perm_b32 v58, v77, v35, s38
    v_mfma_f32_16x16x32_bf16 v[224:227], a[128:131], a[4:7], v[224:227]
    s_add_u32 m0, s57, 0
    ds_read_b32 a168, v56
    ds_read_b32 a169, v57
    v_mfma_f32_16x16x32_bf16 v[228:231], a[112:115], a[8:11], 0
    buffer_load_dwordx3 v[48:50], v18, s[4:7], s61 offen
    v_mfma_f32_16x16x32_bf16 v[228:231], a[128:131], a[12:15], v[228:231]
    s_add_u32 s61, s61, 14336
    ds_read_b32 a170, v58
    v_perm_b32 v59, v77, v35, s39
    v_mfma_f32_16x16x32_bf16 v[232:235], a[112:115], a[16:19], 0
    v_perm_b32 v60, v81, v35, s36
    v_perm_b32 v61, v81, v35, s37
    v_mfma_f32_16x16x32_bf16 v[232:235], a[128:131], a[20:23], v[232:235]
    ds_read_b32 a171, v59
    ds_read_b32 a172, v60
    v_mfma_f32_16x16x32_bf16 v[236:239], a[112:115], a[24:27], 0
    buffer_load_dwordx4 v36, s[8:11], s56 offen offset:0 lds
    v_mfma_f32_16x16x32_bf16 v[236:239], a[128:131], a[28:31], v[236:239]
    ds_read_b32 a173, v61
    v_perm_b32 v62, v81, v35, s38
    v_mfma_f32_16x16x32_bf16 v[240:243], a[112:115], a[36:39], 0
    v_perm_b32 v63, v81, v35, s39
    v_perm_b32 v56, v78, v35, s36
    v_mfma_f32_16x16x32_bf16 v[240:243], a[128:131], a[40:43], v[240:243]
    ds_read_b32 a174, v62
    ds_read_b32 a175, v63
    v_mfma_f32_16x16x32_bf16 v[244:247], a[112:115], a[44:47], 0
    buffer_load_dwordx3 v[52:54], v18, s[4:7], s61 offen
    v_mfma_f32_16x16x32_bf16 v[244:247], a[128:131], a[52:55], v[244:247]
    s_add_u32 s61, s61, 14336
    ds_read_b32 a176, v56
    v_perm_b32 v57, v78, v35, s37
    v_mfma_f32_16x16x32_bf16 v[248:251], a[112:115], a[56:59], 0
    v_perm_b32 v58, v78, v35, s38
    v_perm_b32 v59, v78, v35, s39
    v_mfma_f32_16x16x32_bf16 v[248:251], a[128:131], a[64:67], v[248:251]
    ds_read_b32 a177, v57
    ds_read_b32 a178, v58
    v_mfma_f32_16x16x32_bf16 v[252:255], a[112:115], a[68:71], 0
    buffer_load_dwordx4 v37, s[8:11], s56 offen offset:1024 lds
    v_mfma_f32_16x16x32_bf16 v[252:255], a[128:131], a[72:75], v[252:255]
    s_waitcnt lgkmcnt(6)
    ds_read_b32 a179, v59
    v_perm_b32 v60, v82, v35, s36
    v_mfma_f32_16x16x32_bf16 v[128:131], a[140:143], a[80:83], v[128:131]
    ds_read_b32 a180, v60
    v_perm_b32 v61, v82, v35, s37
    v_mfma_f32_16x16x32_bf16 v[128:131], a[152:155], a[84:87], v[128:131]
    ds_read_b32 a181, v61
    v_mfma_f32_16x16x32_bf16 v[132:135], a[140:143], a[92:95], v[132:135]
    buffer_load_dwordx3 v[64:66], v18, s[4:7], s61 offen
    v_mfma_f32_16x16x32_bf16 v[132:135], a[152:155], a[100:103], v[132:135]
    s_waitcnt vmcnt(15)
    v_bitop3_b32 v87, v87, v91, s76 bitop3:0x7e
    v_perm_b32 v62, v82, v35, s38
    v_mfma_f32_16x16x32_bf16 v[136:139], a[140:143], a[104:107], v[136:139]
    v_cmp_ne_u32 vcc, 0, v87
    v_perm_b32 v63, v82, v35, s39
    v_mfma_f32_16x16x32_bf16 v[136:139], a[152:155], a[108:111], v[136:139]
    ds_read_b32 a182, v62
    ds_read_b32 a183, v63
    v_mfma_f32_16x16x32_bf16 v[140:143], a[140:143], a[116:119], v[140:143]
    buffer_load_dwordx4 v38, s[8:11], s56 offen offset:2048 lds
    v_mfma_f32_16x16x32_bf16 v[140:143], a[152:155], a[120:123], v[140:143]
    s_barrier
    v_mfma_f32_16x16x32_bf16 v[144:147], a[140:143], a[124:127], v[144:147]
    ds_read_b128 a[184:187], v44 offset:0
    s_cbranch_vccnz L_slow1_0
L_back1_0:
    v_mfma_f32_16x16x32_bf16 v[144:147], a[152:155], a[132:135], v[144:147]
    ds_read_b128 a[188:191], v45 offset:0
    v_perm_b32 v56, v84, v35, s36
    v_mfma_f32_16x16x32_bf16 v[148:151], a[140:143], a[136:139], v[148:151]
    ds_read_b32 a192, v56
    v_perm_b32 v57, v84, v35, s37
    v_mfma_f32_16x16x32_bf16 v[148:151], a[152:155], a[144:147], v[148:151]
    ds_read_b32 a193, v57
    ds_read_b128 a[196:199], v44 offset:2048
    v_mfma_f32_16x16x32_bf16 v[152:155], a[140:143], a[148:151], v[152:155]
    buffer_load_dwordx4 v39, s[8:11], s56 offen offset:3072 lds
    v_mfma_f32_16x16x32_bf16 v[152:155], a[152:155], a[156:159], v[152:155]
    ds_read_b128 a[200:203], v45 offset:2048
    v_perm_b32 v58, v84, v35, s38
    v_mfma_f32_16x16x32_bf16 v[156:159], a[140:143], a[160:163], v[156:159]
    s_add_u32 s3, s55, 640
    ds_read_b32 a194, v58
    ds_read_b128 a[204:207], v44 offset:4096
    v_mfma_f32_16x16x32_bf16 v[156:159], a[152:155], a[164:167], v[156:159]
    v_perm_b32 v59, v84, v35, s39
    v_perm_b32 v60, v88, v35, s36
    v_mfma_f32_16x16x32_bf16 v[160:163], a[168:171], a[80:83], v[160:163]
    s_waitcnt lgkmcnt(8)
    ds_read_b32 a195, v59
    ds_read_b32 a208, v60
    v_mfma_f32_16x16x32_bf16 v[160:163], a[172:175], a[84:87], v[160:163]
    s_add_u32 m0, s57, 16384
    ds_read_b128 a[212:215], v45 offset:4096
    v_perm_b32 v61, v88, v35, s37
    v_mfma_f32_16x16x32_bf16 v[164:167], a[168:171], a[92:95], v[164:167]
    ds_read_b32 a209, v61
    v_perm_b32 v62, v88, v35, s38
    v_mfma_f32_16x16x32_bf16 v[164:167], a[172:175], a[100:103], v[164:167]
    ds_read_b32 a210, v62
    ds_read_b128 a[216:219], v44 offset:6144
    v_mfma_f32_16x16x32_bf16 v[168:171], a[168:171], a[104:107], v[168:171]
    buffer_load_dwordx4 v36, s[8:11], s3 offen offset:0 lds
    v_mfma_f32_16x16x32_bf16 v[168:171], a[172:175], a[108:111], v[168:171]
    v_perm_b32 v63, v88, v35, s39
    v_perm_b32 v56, v85, v35, s36
    v_mfma_f32_16x16x32_bf16 v[172:175], a[168:171], a[116:119], v[172:175]
    ds_read_b32 a211, v63
    ds_read_b32 a220, v56
    v_mfma_f32_16x16x32_bf16 v[172:175], a[172:175], a[120:123], v[172:175]
    ds_read_b128 a[224:227], v45 offset:6144
    v_perm_b32 v57, v85, v35, s37
    v_mfma_f32_16x16x32_bf16 v[176:179], a[168:171], a[124:127], v[176:179]
    ds_read_b32 a221, v57
    v_perm_b32 v58, v85, v35, s38
    v_mfma_f32_16x16x32_bf16 v[176:179], a[172:175], a[132:135], v[176:179]
    ds_read_b32 a222, v58
    ds_read_b128 a[228:231], v44 offset:8192
    v_mfma_f32_16x16x32_bf16 v[180:183], a[168:171], a[136:139], v[180:183]
    v_perm_b32 v59, v85, v35, s39
    v_perm_b32 v60, v89, v35, s36
    v_mfma_f32_16x16x32_bf16 v[180:183], a[172:175], a[144:147], v[180:183]
    ds_read_b32 a223, v59
    ds_read_b32 a232, v60
    v_mfma_f32_16x16x32_bf16 v[184:187], a[168:171], a[148:151], v[184:187]
    buffer_load_dwordx4 v37, s[8:11], s3 offen offset:1024 lds
    v_mfma_f32_16x16x32_bf16 v[184:187], a[172:175], a[156:159], v[184:187]
    ds_read_b128 a[236:239], v45 offset:8192
    v_perm_b32 v61, v89, v35, s37
    v_mfma_f32_16x16x32_bf16 v[188:191], a[168:171], a[160:163], v[188:191]
    ds_read_b32 a233, v61
    v_perm_b32 v62, v89, v35, s38
    v_mfma_f32_16x16x32_bf16 v[188:191], a[172:175], a[164:167], v[188:191]
    s_waitcnt vmcnt(15)
    ds_read_b32 a234, v62
    v_bitop3_b32 v101, v101, v103, s76 bitop3:0x7e
    v_mfma_f32_16x16x32_bf16 v[192:195], a[176:179], a[80:83], v[192:195]
    ds_read_b128 a[240:243], v44 offset:10240
    v_cmp_ne_u32 vcc, 0, v101
    v_mfma_f32_16x16x32_bf16 v[192:195], a[180:183], a[84:87], v[192:195]
    v_perm_b32 v63, v89, v35, s39
    v_perm_b32 v56, v86, v35, s36
    v_mfma_f32_16x16x32_bf16 v[196:199], a[176:179], a[92:95], v[196:199]
    ds_read_b32 a235, v63
    s_cbranch_vccnz L_slow1_2
L_back1_2:
    v_mfma_f32_16x16x32_bf16 v[196:199], a[180:183], a[100:103], v[196:199]
    ds_read_b32 a248, v56
    ds_read_b128 a[244:247], v45 offset:10240
    v_mfma_f32_16x16x32_bf16 v[200:203], a[176:179], a[104:107], v[200:203]
    buffer_load_dwordx4 v38, s[8:11], s3 offen offset:2048 lds
    v_mfma_f32_16x16x32_bf16 v[200:203], a[180:183], a[108:111], v[200:203]
    ds_read_b128 a[252:255], v44 offset:12288
    v_perm_b32 v57, v86, v35, s37
    v_mfma_f32_16x16x32_bf16 v[204:207], a[176:179], a[116:119], v[204:207]
    ds_read_b32 a249, v57
    v_perm_b32 v58, v86, v35, s38
    v_mfma_f32_16x16x32_bf16 v[204:207], a[180:183], a[120:123], v[204:207]
    ds_read_b32 a250, v58
    v_perm_b32 v59, v86, v35, s39
    v_mfma_f32_16x16x32_bf16 v[208:211], a[176:179], a[124:127], v[208:211]
    ds_read_b32 a251, v59
    ds_read_b128 a[32:35], v45 offset:12288
    v_mfma_f32_16x16x32_bf16 v[208:211], a[180:183], a[132:135], v[208:211]
    v_perm_b32 v60, v90, v35, s36
    v_perm_b32 v61, v90, v35, s37
    v_mfma_f32_16x16x32_bf16 v[212:215], a[176:179], a[136:139], v[212:215]
    ds_read_b32 a48, v60
    v_perm_b32 v62, v90, v35, s38
    v_mfma_f32_16x16x32_bf16 v[212:215], a[180:183], a[144:147], v[212:215]
    ds_read_b32 a49, v61
    ds_read_b32 a50, v62
    v_mfma_f32_16x16x32_bf16 v[216:219], a[176:179], a[148:151], v[216:219]
    buffer_load_dwordx4 v39, s[8:11], s3 offen offset:3072 lds
    v_mfma_f32_16x16x32_bf16 v[216:219], a[180:183], a[156:159], v[216:219]
    s_waitcnt vmcnt(13)
    ds_read_b128 a[60:63], v44 offset:14336
    v_bitop3_b32 v115, v115, v119, s76 bitop3:0x7e
    v_mfma_f32_16x16x32_bf16 v[220:223], a[176:179], a[160:163], v[220:223]
    ds_read_b128 a[76:79], v45 offset:14336
    v_cmp_ne_u32 vcc, 0, v115
    v_mfma_f32_16x16x32_bf16 v[220:223], a[180:183], a[164:167], v[220:223]
    s_waitcnt lgkmcnt(8)
    v_perm_b32 v63, v90, v35, s39
    v_perm_b32 v56, v100, v35, s36
    v_mfma_f32_16x16x32_bf16 v[128:131], a[192:195], a[184:187], v[128:131]
    ds_read_b32 a51, v63
    ds_read_b32 a88, v56
    v_mfma_f32_16x16x32_bf16 v[128:131], a[208:211], a[188:191], v[128:131]
    ds_read_b128 a[96:99], v46 offset:0
    s_cbranch_vccnz L_slow1_1
L_back1_1:
    v_mfma_f32_16x16x32_bf16 v[132:135], a[192:195], a[196:199], v[132:135]
    v_perm_b32 v57, v100, v35, s37
    v_perm_b32 v58, v100, v35, s38
    v_mfma_f32_16x16x32_bf16 v[132:135], a[208:211], a[200:203], v[132:135]
    ds_read_b32 a89, v57
    ds_read_b32 a90, v58
    v_mfma_f32_16x16x32_bf16 v[136:139], a[192:195], a[204:207], v[136:139]
    ds_read_b128 a[0:3], v47 offset:0
    v_perm_b32 v59, v100, v35, s39
    v_mfma_f32_16x16x32_bf16 v[136:139], a[208:211], a[212:215], v[136:139]
    ds_read_b32 a91, v59
    v_perm_b32 v60, v102, v35, s36
    v_mfma_f32_16x16x32_bf16 v[140:143], a[192:195], a[216:219], v[140:143]
    ds_read_b32 a4, v60
    v_perm_b32 v61, v102, v35, s37
    v_mfma_f32_16x16x32_bf16 v[140:143], a[208:211], a[224:227], v[140:143]
    ds_read_b32 a5, v61
    ds_read_b128 a[8:11], v46 offset:2048
    v_mfma_f32_16x16x32_bf16 v[144:147], a[192:195], a[228:231], v[144:147]
    v_perm_b32 v62, v102, v35, s38
    v_perm_b32 v63, v102, v35, s39
    v_mfma_f32_16x16x32_bf16 v[144:147], a[208:211], a[236:239], v[144:147]
    s_waitcnt lgkmcnt(8)
    ds_read_b32 a6, v62
    ds_read_b32 a7, v63
    v_mfma_f32_16x16x32_bf16 v[148:151], a[192:195], a[240:243], v[148:151]
    s_mov_b32 s48, 40960
    ds_read_b128 a[12:15], v47 offset:2048
    v_perm_b32 v56, v112, v35, s36
    v_mfma_f32_16x16x32_bf16 v[148:151], a[208:211], a[244:247], v[148:151]
    s_mov_b32 s49, 40960
    v_perm_b32 v57, v112, v35, s37
    v_perm_b32 v58, v112, v35, s38
    v_mfma_f32_16x16x32_bf16 v[152:155], a[192:195], a[252:255], v[152:155]
    s_mov_b32 s50, 40960
    ds_read_b32 a16, v56
    ds_read_b32 a17, v57
    v_mfma_f32_16x16x32_bf16 v[152:155], a[208:211], a[32:35], v[152:155]
    buffer_load_dwordx4 v[68:71], v32, s[12:15], s48 offen sc1
    v_mfma_f32_16x16x32_bf16 v[156:159], a[192:195], a[60:63], v[156:159]
    s_mov_b32 s69, 46080
    ds_read_b32 a18, v58
    ds_read_b128 a[20:23], v46 offset:4096
    v_mfma_f32_16x16x32_bf16 v[156:159], a[208:211], a[76:79], v[156:159]
    s_mov_b32 s40, 46080
    v_perm_b32 v59, v112, v35, s39
    v_perm_b32 v60, v116, v35, s36
    v_mfma_f32_16x16x32_bf16 v[160:163], a[220:223], a[184:187], v[160:163]
    s_add_u32 s56, s55, 768
    ds_read_b32 a19, v59
    ds_read_b32 a24, v60
    v_mfma_f32_16x16x32_bf16 v[160:163], a[232:235], a[188:191], v[160:163]
    buffer_load_dwordx2 v[72:73], v34, s[12:15], s49 offen sc1
    v_mfma_f32_16x16x32_bf16 v[164:167], a[220:223], a[196:199], v[164:167]
    s_mov_b32 s41, 46080
    ds_read_b128 a[28:31], v47 offset:4096
    v_perm_b32 v61, v116, v35, s37
    v_mfma_f32_16x16x32_bf16 v[164:167], a[232:235], a[200:203], v[164:167]
    s_add_u32 m0, s57, 32768
    ds_read_b32 a25, v61
    v_perm_b32 v62, v116, v35, s38
    v_mfma_f32_16x16x32_bf16 v[168:171], a[220:223], a[204:207], v[168:171]
    ds_read_b32 a26, v62
    ds_read_b128 a[36:39], v46 offset:6144
    v_mfma_f32_16x16x32_bf16 v[168:171], a[232:235], a[212:215], v[168:171]
    buffer_load_dwordx4 v[76:79], v33, s[12:15], s50 offen sc1
    v_mfma_f32_16x16x32_bf16 v[172:175], a[220:223], a[216:219], v[172:175]
    ds_read_b128 a[40:43], v47 offset:6144
    v_perm_b32 v63, v116, v35, s39
    v_mfma_f32_16x16x32_bf16 v[172:175], a[232:235], a[224:227], v[172:175]
    v_lshlrev_b32 v92, v5, v92
    v_lshlrev_b32 v93, v5, v93
    v_lshlrev_b32 v94, v5, v94
    v_lshlrev_b32 v95, v5, v95
    v_mov_b32 v99, s76
    v_lshl_or_b32 v96, v104, 4, v96
    v_permlane32_swap_b32 v92, v93
    v_permlane32_swap_b32 v94, v95
    v_or_b32 v92, v92, v93
    v_or_b32 v94, v94, v95
    v_mov_b32 v93, s76
    v_lshl_or_b32 v97, v105, 4, v97
    v_lshl_or_b32 v98, v106, 4, v98
    v_permlane16_swap_b32 v92, v94
    v_or_b32 v92, v92, v94
    v_lshl_or_b32 v96, v108, 8, v96
    v_lshl_or_b32 v97, v109, 8, v97
    v_or_b32_dpp v92, v92, v92 row_ror:8 row_mask:0xf bank_mask:0xf
    v_lshl_or_b32 v98, v110, 8, v98
    s_waitcnt vmcnt(15)
    v_lshl_or_b32 v96, v120, 12, v96
    v_lshl_or_b32 v97, v121, 12, v97
    v_lshl_or_b32 v98, v122, 12, v98
    s_waitcnt vmcnt(14)
    v_lshl_or_b32 v96, v124, 16, v96
    v_lshl_or_b32 v97, v125, 16, v97
    v_lshl_or_b32 v98, v126, 16, v98
    s_waitcnt vmcnt(13)
    v_lshl_or_b32 v96, v48, 20, v96
    v_lshl_or_b32 v97, v49, 20, v97
    v_lshl_or_b32 v98, v50, 20, v98
    s_waitcnt vmcnt(11)
    v_lshl_or_b32 v96, v52, 24, v96
    v_lshl_or_b32 v97, v53, 24, v97
    v_lshl_or_b32 v98, v54, 24, v98
    s_waitcnt vmcnt(9)
    v_lshl_or_b32 v96, v64, 28, v96
    v_lshl_or_b32 v97, v65, 28, v97
    v_lshl_or_b32 v98, v66, 28, v98
    buffer_store_dwordx4 v[96:99], v20, s[12:15], s62 offen sc1
    buffer_store_dwordx2 v[92:93], v21, s[12:15], s62 offen sc1
    s_mul_i32 s66, s63, 96
    s_lshl_b32 s67, s65, 5
    s_lshl_b32 s70, s64, 2
    s_add_u32 s67, s67, s70
    s_add_u32 s67, s67, 384
    s_mul_i32 s71, s59, 448
    s_add_u32 s70, s66, s71
    v_mad_u32_u24 v22, v3, 24, s70
    s_add_u32 s70, s67, s71
    v_lshl_add_u32 v23, v3, 3, s70
    s_mov_b32 s34, 7168
    s_mov_b32 s35, 0x20000
    s_mov_b32 s26, 256
    s_mov_b32 s27, 0x20000
    s_lshl_b32 s77, s59, 4
    s_mov_b32 s18, 14680064
    s_mov_b32 s19, 0x20000
    s_sub_u32 s70, 65536, s71
    v_mul_u32_u24 v16, 464, v4
    v_add3_u32 v26, v22, v16, s70
    v_add3_u32 v28, v23, v16, s70
    v_lshlrev_b32 v29, 3, v0
    v_xor_b32 v30, 512, v29
    v_add_u32 v29, 87808, v29
    v_add_u32 v30, 87808, v30
    v_mul_u32_u24 v16, 2341, v2
    v_lshrrev_b32 v16, 16, v16
    s_mul_i32 s73, s63, 1856
    s_add_u32 s73, s73, 65536
    v_add_lshl_u32 v24, v2, v16, 4
    v_add_u32 v24, s73, v24
    s_lshl_b32 s74, s58, 7
    s_lshl_b32 s75, s63, 2
    s_add_u32 s74, s74, s75
    s_mul_i32 s74, s74, 7168
    s_add_u32 s74, s74, s71
    v_mul_u32_u24 v17, 6720, v16
    v_lshl_add_u32 v25, v2, 4, v17
    v_lshrrev_b32 v16, 1, v16
    v_lshlrev_b32 v16, 30, v16
    v_add3_u32 v25, v25, v16, s74
    v_mfma_f32_16x16x32_bf16 v[176:179], a[220:223], a[228:231], v[176:179]
    ds_read_b32 a27, v63
    v_mfma_f32_16x16x32_bf16 v[176:179], a[232:235], a[236:239], v[176:179]
    buffer_load_dwordx4 v[80:83], v32, s[12:15], s69 offen sc1
    v_mfma_f32_16x16x32_bf16 v[180:183], a[220:223], a[240:243], v[180:183]
    ds_read_b128 a[44:47], v46 offset:8192
    v_perm_b32 v56, v113, v35, s36
    v_mfma_f32_16x16x32_bf16 v[180:183], a[232:235], a[244:247], v[180:183]
    ds_read_b32 a52, v56
    v_perm_b32 v57, v113, v35, s37
    v_mfma_f32_16x16x32_bf16 v[184:187], a[220:223], a[252:255], v[184:187]
    ds_read_b32 a53, v57
    ds_read_b128 a[56:59], v47 offset:8192
    v_mfma_f32_16x16x32_bf16 v[184:187], a[232:235], a[32:35], v[184:187]
    buffer_load_dwordx2 v[74:75], v34, s[12:15], s40 offen sc1
    v_mfma_f32_16x16x32_bf16 v[188:191], a[220:223], a[60:63], v[188:191]
    v_perm_b32 v58, v113, v35, s38
    v_perm_b32 v59, v113, v35, s39
    v_mfma_f32_16x16x32_bf16 v[188:191], a[232:235], a[76:79], v[188:191]
    ds_read_b32 a54, v58
    v_perm_b32 v60, v117, v35, s36
    v_mfma_f32_16x16x32_bf16 v[192:195], a[248:251], a[184:187], v[192:195]
    ds_read_b32 a55, v59
    ds_read_b32 a64, v60
    v_mfma_f32_16x16x32_bf16 v[192:195], a[48:51], a[188:191], v[192:195]
    buffer_load_dwordx4 v[84:87], v33, s[12:15], s41 offen sc1
    v_mfma_f32_16x16x32_bf16 v[196:199], a[248:251], a[196:199], v[196:199]
    ds_read_b128 a[68:71], v46 offset:10240
    v_perm_b32 v61, v117, v35, s37
    v_mfma_f32_16x16x32_bf16 v[196:199], a[48:51], a[200:203], v[196:199]
    ds_read_b32 a65, v61
    v_perm_b32 v62, v117, v35, s38
    v_mfma_f32_16x16x32_bf16 v[200:203], a[248:251], a[204:207], v[200:203]
    ds_read_b32 a66, v62
    ds_read_b128 a[112:115], v47 offset:10240
    v_mfma_f32_16x16x32_bf16 v[200:203], a[48:51], a[212:215], v[200:203]
    buffer_load_dwordx4 v36, s[8:11], s56 offen offset:0 lds
    v_mfma_f32_16x16x32_bf16 v[204:207], a[248:251], a[216:219], v[204:207]
    ds_read_b128 a[72:75], v46 offset:12288
    v_perm_b32 v63, v117, v35, s39
    v_mfma_f32_16x16x32_bf16 v[204:207], a[48:51], a[224:227], v[204:207]
    ds_read_b32 a67, v63
    v_perm_b32 v56, v114, v35, s36
L_pad1:
    s_cbranch_execz L_warmed
    v_mfma_f32_16x16x32_bf16 v[208:211], a[248:251], a[228:231], v[208:211]
    ds_read_b32 a140, v56
    ds_read_b128 a[128:131], v47 offset:12288
    v_mfma_f32_16x16x32_bf16 v[208:211], a[48:51], a[236:239], v[208:211]
    v_perm_b32 v57, v114, v35, s37
    v_perm_b32 v58, v114, v35, s38
    v_mfma_f32_16x16x32_bf16 v[212:215], a[248:251], a[240:243], v[212:215]
    ds_read_b32 a141, v57
    ds_read_b32 a142, v58
    v_mfma_f32_16x16x32_bf16 v[212:215], a[48:51], a[244:247], v[212:215]
    buffer_load_dwordx4 v37, s[8:11], s56 offen offset:1024 lds
    v_mfma_f32_16x16x32_bf16 v[216:219], a[248:251], a[252:255], v[216:219]
    s_mov_b32 s42, 61440
    ds_read_b128 a[152:155], v46 offset:14336
    v_perm_b32 v59, v114, v35, s39
    v_mfma_f32_16x16x32_bf16 v[216:219], a[48:51], a[32:35], v[216:219]
    ds_read_b32 a143, v59
    v_perm_b32 v60, v118, v35, s36
    v_mfma_f32_16x16x32_bf16 v[220:223], a[248:251], a[60:63], v[220:223]
    s_waitcnt lgkmcnt(8)
    ds_read_b32 a172, v60
    ds_read_b128 a[168:171], v47 offset:14336
    v_mfma_f32_16x16x32_bf16 v[220:223], a[48:51], a[76:79], v[220:223]
    buffer_load_dwordx4 v[88:91], v32, s[12:15], s42 offen sc1
    v_mfma_f32_16x16x32_bf16 v[224:227], a[88:91], a[184:187], v[224:227]
    s_add_u32 s3, s55, 896
    v_perm_b32 v61, v118, v35, s37
    v_perm_b32 v62, v118, v35, s38
    v_mfma_f32_16x16x32_bf16 v[224:227], a[4:7], a[188:191], v[224:227]
    s_mov_b32 s43, 66560
    ds_read_b32 a173, v61
    v_perm_b32 v63, v118, v35, s39
    v_mfma_f32_16x16x32_bf16 v[228:231], a[88:91], a[196:199], v[228:231]
    ds_read_b32 a174, v62
    ds_read_b32 a175, v63
    v_mfma_f32_16x16x32_bf16 v[228:231], a[4:7], a[200:203], v[228:231]
    buffer_load_dwordx4 v[100:103], v32, s[12:15], s43 offen sc1
    v_mfma_f32_16x16x32_bf16 v[232:235], a[88:91], a[204:207], v[232:235]
    v_mfma_f32_16x16x32_bf16 v[232:235], a[4:7], a[212:215], v[232:235]
    v_mfma_f32_16x16x32_bf16 v[236:239], a[88:91], a[216:219], v[236:239]
    v_mfma_f32_16x16x32_bf16 v[236:239], a[4:7], a[224:227], v[236:239]
    buffer_load_dwordx4 v38, s[8:11], s56 offen offset:2048 lds
    v_mfma_f32_16x16x32_bf16 v[240:243], a[88:91], a[228:231], v[240:243]
    v_mfma_f32_16x16x32_bf16 v[240:243], a[4:7], a[236:239], v[240:243]
    v_mfma_f32_16x16x32_bf16 v[244:247], a[88:91], a[240:243], v[244:247]
    v_mfma_f32_16x16x32_bf16 v[244:247], a[4:7], a[244:247], v[244:247]
    s_waitcnt vmcnt(13) lgkmcnt(0)
    v_mfma_f32_16x16x32_bf16 v[248:251], a[88:91], a[252:255], v[248:251]
    s_barrier
    v_mfma_f32_16x16x32_bf16 v[248:251], a[4:7], a[32:35], v[248:251]
    buffer_load_dwordx4 v39, s[8:11], s56 offen offset:3072 lds
    v_mfma_f32_16x16x32_bf16 v[252:255], a[88:91], a[60:63], v[252:255]
    s_add_u32 m0, s57, 49152
    v_mfma_f32_16x16x32_bf16 v[252:255], a[4:7], a[76:79], v[252:255]
    v_mfma_f32_16x16x32_bf16 v[128:131], a[16:19], a[96:99], v[128:131]
    v_mfma_f32_16x16x32_bf16 v[128:131], a[24:27], a[0:3], v[128:131]
    ds_read_b128 a[80:83], v40 offset:0
    v_mfma_f32_16x16x32_bf16 v[132:135], a[16:19], a[8:11], v[132:135]
    v_mfma_f32_16x16x32_bf16 v[132:135], a[24:27], a[12:15], v[132:135]
    buffer_load_dwordx4 v36, s[8:11], s3 offen offset:0 lds
    v_mfma_f32_16x16x32_bf16 v[136:139], a[16:19], a[20:23], v[136:139]
    ds_read_b128 a[84:87], v41 offset:0
    v_mfma_f32_16x16x32_bf16 v[136:139], a[24:27], a[28:31], v[136:139]
    v_mfma_f32_16x16x32_bf16 v[140:143], a[16:19], a[36:39], v[140:143]
    v_mfma_f32_16x16x32_bf16 v[140:143], a[24:27], a[40:43], v[140:143]
    ds_read_b128 a[92:95], v40 offset:2048
    v_mfma_f32_16x16x32_bf16 v[144:147], a[16:19], a[44:47], v[144:147]
    v_mfma_f32_16x16x32_bf16 v[144:147], a[24:27], a[56:59], v[144:147]
    buffer_load_dwordx4 v37, s[8:11], s3 offen offset:1024 lds
    v_mfma_f32_16x16x32_bf16 v[148:151], a[16:19], a[68:71], v[148:151]
    ds_read_b128 a[100:103], v41 offset:2048
    v_mfma_f32_16x16x32_bf16 v[148:151], a[24:27], a[112:115], v[148:151]
    v_mfma_f32_16x16x32_bf16 v[152:155], a[16:19], a[72:75], v[152:155]
    v_mfma_f32_16x16x32_bf16 v[152:155], a[24:27], a[128:131], v[152:155]
    ds_read_b128 a[104:107], v40 offset:4096
    v_mfma_f32_16x16x32_bf16 v[156:159], a[16:19], a[152:155], v[156:159]
    v_mfma_f32_16x16x32_bf16 v[156:159], a[24:27], a[168:171], v[156:159]
    buffer_load_dwordx4 v38, s[8:11], s3 offen offset:2048 lds
    v_mfma_f32_16x16x32_bf16 v[160:163], a[52:55], a[96:99], v[160:163]
    ds_read_b128 a[108:111], v41 offset:4096
    v_mfma_f32_16x16x32_bf16 v[160:163], a[64:67], a[0:3], v[160:163]
    v_mfma_f32_16x16x32_bf16 v[164:167], a[52:55], a[8:11], v[164:167]
    v_mfma_f32_16x16x32_bf16 v[164:167], a[64:67], a[12:15], v[164:167]
    s_mov_b32 s44, 61440
    ds_read_b128 a[116:119], v40 offset:6144
    v_mfma_f32_16x16x32_bf16 v[168:171], a[52:55], a[20:23], v[168:171]
    s_waitcnt vmcnt(11)
    v_mfma_f32_16x16x32_bf16 v[168:171], a[64:67], a[28:31], v[168:171]
    buffer_load_dwordx4 v39, s[8:11], s3 offen offset:3072 lds
    v_mfma_f32_16x16x32_bf16 v[172:175], a[52:55], a[36:39], v[172:175]
    s_mov_b32 s45, 66560
    ds_read_b128 a[120:123], v41 offset:6144
    v_bitop3_b32 v71, v71, v83, s76 bitop3:0x7e
    v_mfma_f32_16x16x32_bf16 v[172:175], a[64:67], a[40:43], v[172:175]
    v_cmp_ne_u32 vcc, 0, v71
    v_mfma_f32_16x16x32_bf16 v[176:179], a[52:55], a[44:47], v[176:179]
    v_mfma_f32_16x16x32_bf16 v[176:179], a[64:67], a[56:59], v[176:179]
    buffer_load_dwordx2 v[92:93], v34, s[12:15], s44 offen sc1
    v_mfma_f32_16x16x32_bf16 v[180:183], a[52:55], a[68:71], v[180:183]
    s_waitcnt vmcnt(12)
    v_bitop3_b32 v73, v73, v75, s76 bitop3:0x7e
    s_cbranch_vccnz L_slow2_0
L_back2_0:
    v_mfma_f32_16x16x32_bf16 v[180:183], a[64:67], a[112:115], v[180:183]
    v_cmp_ne_u32 vcc, 0, v73
    v_perm_b32 v56, v68, v35, s36
    v_mfma_f32_16x16x32_bf16 v[184:187], a[52:55], a[72:75], v[184:187]
    ds_read_b32 a132, v56
    ds_read_b128 a[124:127], v40 offset:8192
    v_mfma_f32_16x16x32_bf16 v[184:187], a[64:67], a[128:131], v[184:187]
    buffer_load_dwordx2 v[94:95], v34, s[12:15], s45 offen sc1
    v_mfma_f32_16x16x32_bf16 v[188:191], a[52:55], a[152:155], v[188:191]
    v_perm_b32 v57, v68, v35, s37
    s_cbranch_vccnz L_slow2_2
L_back2_2:
    v_mfma_f32_16x16x32_bf16 v[188:191], a[64:67], a[168:171], v[188:191]
    ds_read_b32 a133, v57
    v_perm_b32 v58, v68, v35, s38
    v_mfma_f32_16x16x32_bf16 v[192:195], a[140:143], a[96:99], v[192:195]
    s_mov_b32 s48, 61440
    ds_read_b32 a134, v58
    v_perm_b32 v59, v68, v35, s39
    v_mfma_f32_16x16x32_bf16 v[192:195], a[172:175], a[0:3], v[192:195]
    ds_read_b32 a135, v59
    v_perm_b32 v60, v80, v35, s36
    v_mfma_f32_16x16x32_bf16 v[196:199], a[140:143], a[8:11], v[196:199]
    s_add_u32 s56, s55, 1024
    ds_read_b32 a144, v60
    ds_read_b128 a[136:139], v41 offset:8192
    v_mfma_f32_16x16x32_bf16 v[196:199], a[172:175], a[12:15], v[196:199]
    buffer_load_dwordx4 v[96:99], v33, s[12:15], s48 offen sc1
    v_mfma_f32_16x16x32_bf16 v[200:203], a[140:143], a[20:23], v[200:203]
    s_mov_b32 s49, 66560
    v_perm_b32 v61, v80, v35, s37
    v_perm_b32 v62, v80, v35, s38
    v_mfma_f32_16x16x32_bf16 v[200:203], a[172:175], a[28:31], v[200:203]
    s_add_u32 m0, s57, 65536
    ds_read_b32 a145, v61
    ds_read_b32 a146, v62
    v_mfma_f32_16x16x32_bf16 v[204:207], a[140:143], a[36:39], v[204:207]
    s_waitcnt vmcnt(13)
    ds_read_b128 a[148:151], v40 offset:10240
    v_mfma_f32_16x16x32_bf16 v[204:207], a[172:175], a[40:43], v[204:207]
    buffer_load_dwordx4 v[104:107], v33, s[12:15], s49 offen sc1
    v_mfma_f32_16x16x32_bf16 v[208:211], a[140:143], a[44:47], v[208:211]
    ds_read_b128 a[156:159], v41 offset:10240
    v_perm_b32 v63, v80, v35, s39
    v_bitop3_b32 v79, v79, v87, s76 bitop3:0x7e
    v_mfma_f32_16x16x32_bf16 v[208:211], a[172:175], a[56:59], v[208:211]
    ds_read_b32 a147, v63
    v_cmp_ne_u32 vcc, 0, v79
    v_mfma_f32_16x16x32_bf16 v[212:215], a[140:143], a[68:71], v[212:215]
    ds_read_b128 a[160:163], v40 offset:12288
    v_mfma_f32_16x16x32_bf16 v[212:215], a[172:175], a[112:115], v[212:215]
    buffer_load_dwordx4 v36, s[8:11], s56 offen offset:0 lds
    v_mfma_f32_16x16x32_bf16 v[216:219], a[140:143], a[72:75], v[216:219]
    ds_read_b128 a[176:179], v41 offset:12288
    s_cbranch_vccnz L_slow2_1
L_back2_1:
    v_mfma_f32_16x16x32_bf16 v[216:219], a[172:175], a[128:131], v[216:219]
    v_perm_b32 v56, v69, v35, s36
    v_perm_b32 v57, v69, v35, s37
    v_mfma_f32_16x16x32_bf16 v[220:223], a[140:143], a[152:155], v[220:223]
    ds_read_b32 a164, v56
    ds_read_b32 a165, v57
    v_mfma_f32_16x16x32_bf16 v[220:223], a[172:175], a[168:171], v[220:223]
    s_waitcnt lgkmcnt(6)
    v_perm_b32 v58, v69, v35, s38
    v_perm_b32 v59, v69, v35, s39
    v_mfma_f32_16x16x32_bf16 v[128:131], a[132:135], a[80:83], v[128:131]
    s_waitcnt lgkmcnt(4)
    ds_read_b32 a166, v58
    ds_read_b32 a167, v59
    v_mfma_f32_16x16x32_bf16 v[128:131], a[144:147], a[84:87], v[128:131]
    buffer_load_dwordx4 v37, s[8:11], s56 offen offset:1024 lds
    v_mfma_f32_16x16x32_bf16 v[132:135], a[132:135], a[92:95], v[132:135]
    ds_read_b128 a[180:183], v40 offset:14336
    v_perm_b32 v60, v81, v35, s36
    v_mfma_f32_16x16x32_bf16 v[132:135], a[144:147], a[100:103], v[132:135]
    ds_read_b32 a192, v60
    v_perm_b32 v61, v81, v35, s37
    v_mfma_f32_16x16x32_bf16 v[136:139], a[132:135], a[104:107], v[136:139]
    ds_read_b128 a[208:211], v41 offset:14336
    ds_read_b32 a193, v61
    v_mfma_f32_16x16x32_bf16 v[136:139], a[144:147], a[108:111], v[136:139]
    v_perm_b32 v62, v81, v35, s38
    v_perm_b32 v63, v81, v35, s39
    v_mfma_f32_16x16x32_bf16 v[140:143], a[132:135], a[116:119], v[140:143]
    ds_read_b32 a194, v62
    ds_read_b32 a195, v63
    v_mfma_f32_16x16x32_bf16 v[140:143], a[144:147], a[120:123], v[140:143]
    v_perm_b32 v56, v70, v35, s36
    v_perm_b32 v57, v70, v35, s37
    v_mfma_f32_16x16x32_bf16 v[144:147], a[132:135], a[124:127], v[144:147]
    ds_read_b32 a220, v56
    ds_read_b32 a221, v57
    v_mfma_f32_16x16x32_bf16 v[144:147], a[144:147], a[136:139], v[144:147]
    buffer_load_dwordx4 v38, s[8:11], s56 offen offset:2048 lds
    v_mfma_f32_16x16x32_bf16 v[148:151], a[132:135], a[148:151], v[148:151]
    s_waitcnt lgkmcnt(7)
    v_perm_b32 v58, v70, v35, s38
    v_perm_b32 v59, v70, v35, s39
    v_mfma_f32_16x16x32_bf16 v[148:151], a[144:147], a[156:159], v[148:151]
    ds_read_b32 a222, v58
    ds_read_b32 a223, v59
    v_perm_b32 v60, v82, v35, s36
    v_mfma_f32_16x16x32_bf16 v[152:155], a[132:135], a[160:163], v[152:155]
    ds_read_b32 a232, v60
    v_perm_b32 v61, v82, v35, s37
    v_perm_b32 v62, v82, v35, s38
    v_mfma_f32_16x16x32_bf16 v[152:155], a[144:147], a[176:179], v[152:155]
    ds_read_b32 a233, v61
    ds_read_b32 a234, v62
    v_perm_b32 v63, v82, v35, s39
    v_mfma_f32_16x16x32_bf16 v[156:159], a[132:135], a[180:183], v[156:159]
    s_waitcnt lgkmcnt(9)
    ds_read_b32 a235, v63
    v_perm_b32 v56, v72, v35, s36
    v_mfma_f32_16x16x32_bf16 v[156:159], a[144:147], a[208:211], v[156:159]
    ds_read_b32 a248, v56
    v_perm_b32 v57, v72, v35, s37
    v_mfma_f32_16x16x32_bf16 v[160:163], a[164:167], a[80:83], v[160:163]
    s_waitcnt lgkmcnt(9)
    ds_read_b32 a249, v57
    v_perm_b32 v58, v72, v35, s38
    v_mfma_f32_16x16x32_bf16 v[160:163], a[192:195], a[84:87], v[160:163]
    ds_read_b32 a250, v58
    v_perm_b32 v59, v72, v35, s39
    v_mfma_f32_16x16x32_bf16 v[164:167], a[164:167], a[92:95], v[164:167]
    s_add_u32 s3, s55, 1152
    ds_read_b32 a251, v59
    v_perm_b32 v60, v74, v35, s36
    v_mfma_f32_16x16x32_bf16 v[164:167], a[192:195], a[100:103], v[164:167]
    ds_read_b32 a184, v60
    ds_read_b128 a[48:51], v42 offset:0
    v_perm_b32 v61, v74, v35, s37
    v_mfma_f32_16x16x32_bf16 v[168:171], a[164:167], a[104:107], v[168:171]
    ds_read_b32 a185, v61
    v_perm_b32 v62, v74, v35, s38
    v_mfma_f32_16x16x32_bf16 v[168:171], a[192:195], a[108:111], v[168:171]
    ds_read_b32 a186, v62
    v_perm_b32 v63, v74, v35, s39
    v_mfma_f32_16x16x32_bf16 v[172:175], a[164:167], a[116:119], v[172:175]
    ds_read_b32 a187, v63
    ds_read_b128 a[188:191], v43 offset:0
    v_perm_b32 v56, v76, v35, s36
    v_mfma_f32_16x16x32_bf16 v[172:175], a[192:195], a[120:123], v[172:175]
    ds_read_b32 a196, v56
    v_perm_b32 v57, v76, v35, s37
    v_mfma_f32_16x16x32_bf16 v[176:179], a[164:167], a[124:127], v[176:179]
    ds_read_b32 a197, v57
    v_perm_b32 v58, v76, v35, s38
    v_mfma_f32_16x16x32_bf16 v[176:179], a[192:195], a[136:139], v[176:179]
    ds_read_b32 a198, v58
    ds_read_b128 a[200:203], v42 offset:2048
    v_perm_b32 v59, v76, v35, s39
    v_mfma_f32_16x16x32_bf16 v[180:183], a[164:167], a[148:151], v[180:183]
    ds_read_b32 a199, v59
    v_perm_b32 v60, v84, v35, s36
    v_mfma_f32_16x16x32_bf16 v[180:183], a[192:195], a[156:159], v[180:183]
    ds_read_b32 a204, v60
    v_perm_b32 v61, v84, v35, s37
    v_mfma_f32_16x16x32_bf16 v[184:187], a[164:167], a[160:163], v[184:187]
    ds_read_b32 a205, v61
    ds_read_b128 a[212:215], v43 offset:2048
    v_perm_b32 v62, v84, v35, s38
    v_mfma_f32_16x16x32_bf16 v[184:187], a[192:195], a[176:179], v[184:187]
    s_waitcnt vmcnt(13) lgkmcnt(11)
    ds_read_b32 a206, v62
    ds_read_b128 a[216:219], v42 offset:4096
    v_mfma_f32_16x16x32_bf16 v[188:191], a[164:167], a[180:183], v[188:191]
    buffer_load_dwordx4 v39, s[8:11], s56 offen offset:3072 lds
    v_mfma_f32_16x16x32_bf16 v[188:191], a[192:195], a[208:211], v[188:191]
    s_add_u32 m0, s57, 81920
    v_perm_b32 v63, v84, v35, s39
    v_bitop3_b32 v91, v91, v103, s76 bitop3:0x7e
    v_mfma_f32_16x16x32_bf16 v[192:195], a[220:223], a[80:83], v[192:195]
    ds_read_b32 a207, v63
    ds_read_b128 a[224:227], v43 offset:4096
    v_cmp_ne_u32 vcc, 0, v91
    v_mfma_f32_16x16x32_bf16 v[192:195], a[232:235], a[84:87], v[192:195]
    ds_read_b128 a[228:231], v42 offset:6144
    v_perm_b32 v56, v77, v35, s36
    v_mfma_f32_16x16x32_bf16 v[196:199], a[220:223], a[92:95], v[196:199]
    ds_read_b128 a[236:239], v43 offset:6144
    ds_read_b32 a240, v56
    v_mfma_f32_16x16x32_bf16 v[196:199], a[232:235], a[100:103], v[196:199]
    ds_read_b128 a[244:247], v42 offset:8192
    s_cbranch_vccnz L_slow3_0
L_back3_0:
    v_mfma_f32_16x16x32_bf16 v[200:203], a[220:223], a[104:107], v[200:203]
    buffer_load_dwordx4 v36, s[8:11], s3 offen offset:0 lds
    v_mfma_f32_16x16x32_bf16 v[200:203], a[232:235], a[108:111], v[200:203]
    ds_read_b128 a[252:255], v43 offset:8192
    v_perm_b32 v57, v77, v35, s37
    v_mfma_f32_16x16x32_bf16 v[204:207], a[220:223], a[116:119], v[204:207]
    ds_read_b128 a[32:35], v42 offset:10240
    ds_read_b32 a241, v57
    v_mfma_f32_16x16x32_bf16 v[204:207], a[232:235], a[120:123], v[204:207]
    ds_read_b128 a[60:63], v43 offset:10240
    v_perm_b32 v58, v77, v35, s38
    v_mfma_f32_16x16x32_bf16 v[208:211], a[220:223], a[124:127], v[208:211]
    ds_read_b32 a242, v58
    v_perm_b32 v59, v77, v35, s39
    v_mfma_f32_16x16x32_bf16 v[208:211], a[232:235], a[136:139], v[208:211]
    ds_read_b32 a243, v59
    v_perm_b32 v60, v85, v35, s36
    v_mfma_f32_16x16x32_bf16 v[212:215], a[220:223], a[148:151], v[212:215]
    ds_read_b128 a[88:91], v42 offset:12288
    ds_read_b32 a76, v60
    v_mfma_f32_16x16x32_bf16 v[212:215], a[232:235], a[156:159], v[212:215]
    buffer_load_dwordx4 v37, s[8:11], s3 offen offset:1024 lds
    v_mfma_f32_16x16x32_bf16 v[216:219], a[220:223], a[160:163], v[216:219]
    v_perm_b32 v61, v85, v35, s37
    v_perm_b32 v62, v85, v35, s38
    v_mfma_f32_16x16x32_bf16 v[216:219], a[232:235], a[176:179], v[216:219]
    ds_read_b128 a[4:7], v43 offset:12288
    ds_read_b32 a77, v61
    v_mfma_f32_16x16x32_bf16 v[220:223], a[220:223], a[180:183], v[220:223]
    ds_read_b32 a78, v62
    v_perm_b32 v63, v85, v35, s39
    v_mfma_f32_16x16x32_bf16 v[220:223], a[232:235], a[208:211], v[220:223]
    ds_read_b32 a79, v63
    v_perm_b32 v56, v78, v35, s36
    v_mfma_f32_16x16x32_bf16 v[224:227], a[248:251], a[80:83], v[224:227]
    s_waitcnt lgkmcnt(8)
    ds_read_b128 a[16:19], v42 offset:14336
    ds_read_b32 a24, v56
    v_mfma_f32_16x16x32_bf16 v[224:227], a[184:187], a[84:87], v[224:227]
    buffer_load_dwordx4 v38, s[8:11], s3 offen offset:2048 lds
    v_mfma_f32_16x16x32_bf16 v[228:231], a[248:251], a[92:95], v[228:231]
    v_perm_b32 v57, v78, v35, s37
    v_perm_b32 v58, v78, v35, s38
    v_mfma_f32_16x16x32_bf16 v[228:231], a[184:187], a[100:103], v[228:231]
    ds_read_b128 a[52:55], v43 offset:14336
    ds_read_b32 a25, v57
    v_mfma_f32_16x16x32_bf16 v[232:235], a[248:251], a[104:107], v[232:235]
    ds_read_b32 a26, v58
    v_perm_b32 v59, v78, v35, s39
    v_mfma_f32_16x16x32_bf16 v[232:235], a[184:187], a[108:111], v[232:235]
    ds_read_b32 a27, v59
    v_perm_b32 v60, v86, v35, s36
    v_perm_b32 v61, v86, v35, s37
    v_mfma_f32_16x16x32_bf16 v[236:239], a[248:251], a[116:119], v[236:239]
    ds_read_b32 a64, v60
    ds_read_b32 a65, v61
    v_mfma_f32_16x16x32_bf16 v[236:239], a[184:187], a[120:123], v[236:239]
    buffer_load_dwordx4 v39, s[8:11], s3 offen offset:3072 lds
    v_mfma_f32_16x16x32_bf16 v[240:243], a[248:251], a[124:127], v[240:243]
    v_perm_b32 v62, v86, v35, s38
    v_perm_b32 v63, v86, v35, s39
    v_mfma_f32_16x16x32_bf16 v[240:243], a[184:187], a[136:139], v[240:243]
    s_waitcnt vmcnt(10) lgkmcnt(5)
    ds_read_b32 a66, v62
    ds_read_b32 a67, v63
    v_mfma_f32_16x16x32_bf16 v[244:247], a[248:251], a[148:151], v[244:247]
    s_mov_b32 s50, 81920
    v_perm_b32 v56, v88, v35, s36
    v_bitop3_b32 v93, v93, v95, s76 bitop3:0x7e
    v_mfma_f32_16x16x32_bf16 v[244:247], a[184:187], a[156:159], v[244:247]
    s_mov_b32 s69, 87040
    v_cmp_ne_u32 vcc, 0, v93
    v_perm_b32 v57, v88, v35, s37
    v_mfma_f32_16x16x32_bf16 v[248:251], a[248:251], a[160:163], v[248:251]
    s_barrier
    v_mfma_f32_16x16x32_bf16 v[248:251], a[184:187], a[176:179], v[248:251]
    buffer_load_dwordx4 v[108:111], v32, s[12:15], s50 offen sc1
    v_mfma_f32_16x16x32_bf16 v[252:255], a[248:251], a[180:183], v[252:255]
    s_mov_b32 s40, 81920
    ds_read_b32 a96, v56
    ds_read_b32 a97, v57
    v_mfma_f32_16x16x32_bf16 v[252:255], a[184:187], a[208:211], v[252:255]
    v_perm_b32 v58, v88, v35, s38
    s_cbranch_vccnz L_slow3_2
L_back3_2:
    v_mfma_f32_16x16x32_bf16 v[128:131], a[196:199], a[48:51], v[128:131]
    s_mov_b32 s41, 87040
    ds_read_b32 a98, v58
    v_mfma_f32_16x16x32_bf16 v[128:131], a[204:207], a[188:191], v[128:131]
    buffer_load_dwordx4 v[120:123], v32, s[12:15], s69 offen sc1
    v_mfma_f32_16x16x32_bf16 v[132:135], a[196:199], a[200:203], v[132:135]
    v_perm_b32 v59, v88, v35, s39
    v_perm_b32 v60, v100, v35, s36
    v_mfma_f32_16x16x32_bf16 v[132:135], a[204:207], a[212:215], v[132:135]
    ds_read_b32 a99, v59
    ds_read_b32 a0, v60
    v_mfma_f32_16x16x32_bf16 v[136:139], a[196:199], a[216:219], v[136:139]
    ds_read_b128 a[8:11], v40 offset:32768
    v_mfma_f32_16x16x32_bf16 v[136:139], a[204:207], a[224:227], v[136:139]
    buffer_load_dwordx2 v[124:125], v34, s[12:15], s40 offen sc1
    v_mfma_f32_16x16x32_bf16 v[140:143], a[196:199], a[228:231], v[140:143]
    v_perm_b32 v61, v100, v35, s37
    v_perm_b32 v62, v100, v35, s38
    v_mfma_f32_16x16x32_bf16 v[140:143], a[204:207], a[236:239], v[140:143]
    ds_read_b32 a1, v61
    ds_read_b32 a2, v62
    v_mfma_f32_16x16x32_bf16 v[144:147], a[196:199], a[244:247], v[144:147]
    ds_read_b128 a[12:15], v41 offset:32768
    v_mfma_f32_16x16x32_bf16 v[144:147], a[204:207], a[252:255], v[144:147]
    buffer_load_dwordx2 v[126:127], v34, s[12:15], s41 offen sc1
    v_mfma_f32_16x16x32_bf16 v[148:151], a[196:199], a[32:35], v[148:151]
    s_mov_b32 s42, 81920
    v_perm_b32 v63, v100, v35, s39
    v_perm_b32 v56, v89, v35, s36
    v_mfma_f32_16x16x32_bf16 v[148:151], a[204:207], a[60:63], v[148:151]
    ds_read_b32 a3, v63
    ds_read_b32 a20, v56
    v_mfma_f32_16x16x32_bf16 v[152:155], a[196:199], a[88:91], v[152:155]
    s_waitcnt vmcnt(12)
    s_mov_b32 s43, 87040
    ds_read_b128 a[28:31], v40 offset:34816
    v_mfma_f32_16x16x32_bf16 v[152:155], a[204:207], a[4:7], v[152:155]
    buffer_load_dwordx4 v[48:51], v33, s[12:15], s42 offen sc1
    v_mfma_f32_16x16x32_bf16 v[156:159], a[196:199], a[16:19], v[156:159]
    s_add_u32 s56, s55, 1280
    v_bitop3_b32 v99, v99, v107, s76 bitop3:0x7e
    v_perm_b32 v57, v89, v35, s37
    v_mfma_f32_16x16x32_bf16 v[156:159], a[204:207], a[52:55], v[156:159]
    ds_read_b128 a[36:39], v41 offset:34816
    ds_read_b32 a21, v57
    v_cmp_ne_u32 vcc, 0, v99
    v_mfma_f32_16x16x32_bf16 v[160:163], a[240:243], a[48:51], v[160:163]
    ds_read_b128 a[40:43], v40 offset:36864
    v_mfma_f32_16x16x32_bf16 v[160:163], a[76:79], a[188:191], v[160:163]
    buffer_load_dwordx4 v[52:55], v33, s[12:15], s43 offen sc1
    v_mfma_f32_16x16x32_bf16 v[164:167], a[240:243], a[200:203], v[164:167]
    v_perm_b32 v58, v89, v35, s38
    s_cbranch_vccnz L_slow3_1
L_back3_1:
    v_mfma_f32_16x16x32_bf16 v[164:167], a[76:79], a[212:215], v[164:167]
    s_add_u32 m0, s57, 0
    ds_read_b32 a22, v58
    v_perm_b32 v59, v89, v35, s39
    v_mfma_f32_16x16x32_bf16 v[168:171], a[240:243], a[216:219], v[168:171]
    ds_read_b32 a23, v59
    ds_read_b128 a[44:47], v41 offset:36864
    v_mfma_f32_16x16x32_bf16 v[168:171], a[76:79], a[224:227], v[168:171]
    buffer_load_dwordx4 v36, s[8:11], s56 offen offset:0 lds
    v_mfma_f32_16x16x32_bf16 v[172:175], a[240:243], a[228:231], v[172:175]
    v_perm_b32 v60, v101, v35, s36
    v_perm_b32 v61, v101, v35, s37
    v_mfma_f32_16x16x32_bf16 v[172:175], a[76:79], a[236:239], v[172:175]
    ds_read_b32 a56, v60
    ds_read_b32 a57, v61
    v_mfma_f32_16x16x32_bf16 v[176:179], a[240:243], a[244:247], v[176:179]
    ds_read_b128 a[68:71], v40 offset:38912
    v_perm_b32 v62, v101, v35, s38
    v_mfma_f32_16x16x32_bf16 v[176:179], a[76:79], a[252:255], v[176:179]
    ds_read_b32 a58, v62
    v_perm_b32 v63, v101, v35, s39
    v_mfma_f32_16x16x32_bf16 v[180:183], a[240:243], a[32:35], v[180:183]
    ds_read_b32 a59, v63
    v_perm_b32 v56, v90, v35, s36
    v_mfma_f32_16x16x32_bf16 v[180:183], a[76:79], a[60:63], v[180:183]
    ds_read_b128 a[112:115], v41 offset:38912
    ds_read_b32 a72, v56
    v_mfma_f32_16x16x32_bf16 v[184:187], a[240:243], a[88:91], v[184:187]
    buffer_load_dwordx4 v37, s[8:11], s56 offen offset:1024 lds
    v_mfma_f32_16x16x32_bf16 v[184:187], a[76:79], a[4:7], v[184:187]
    v_perm_b32 v57, v90, v35, s37
    v_perm_b32 v58, v90, v35, s38
    v_mfma_f32_16x16x32_bf16 v[188:191], a[240:243], a[16:19], v[188:191]
    ds_read_b128 a[128:131], v40 offset:40960
    ds_read_b32 a73, v57
    v_mfma_f32_16x16x32_bf16 v[188:191], a[76:79], a[52:55], v[188:191]
    s_waitcnt lgkmcnt(9)
    ds_read_b32 a74, v58
    v_perm_b32 v59, v90, v35, s39
    v_mfma_f32_16x16x32_bf16 v[192:195], a[24:27], a[48:51], v[192:195]
    ds_read_b32 a75, v59
    v_perm_b32 v60, v102, v35, s36
    v_mfma_f32_16x16x32_bf16 v[192:195], a[64:67], a[188:191], v[192:195]
    ds_read_b128 a[140:143], v41 offset:40960
    ds_read_b32 a152, v60
    v_mfma_f32_16x16x32_bf16 v[196:199], a[24:27], a[200:203], v[196:199]
    v_perm_b32 v61, v102, v35, s37
    v_perm_b32 v62, v102, v35, s38
    v_mfma_f32_16x16x32_bf16 v[196:199], a[64:67], a[212:215], v[196:199]
    ds_read_b32 a153, v61
    ds_read_b32 a154, v62
    v_mfma_f32_16x16x32_bf16 v[200:203], a[24:27], a[216:219], v[200:203]
    buffer_load_dwordx4 v38, s[8:11], s56 offen offset:2048 lds
    v_mfma_f32_16x16x32_bf16 v[200:203], a[64:67], a[224:227], v[200:203]
    ds_read_b128 a[168:171], v40 offset:43008
    v_perm_b32 v63, v102, v35, s39
    v_mfma_f32_16x16x32_bf16 v[204:207], a[24:27], a[228:231], v[204:207]
    ds_read_b32 a155, v63
    v_perm_b32 v56, v92, v35, s36
    v_mfma_f32_16x16x32_bf16 v[204:207], a[64:67], a[236:239], v[204:207]
    ds_read_b128 a[172:175], v41 offset:43008
    ds_read_b32 a132, v56
    v_mfma_f32_16x16x32_bf16 v[208:211], a[24:27], a[244:247], v[208:211]
    v_perm_b32 v57, v92, v35, s37
    v_perm_b32 v58, v92, v35, s38
    v_mfma_f32_16x16x32_bf16 v[208:211], a[64:67], a[252:255], v[208:211]
    ds_read_b32 a133, v57
    ds_read_b32 a134, v58
    v_mfma_f32_16x16x32_bf16 v[212:215], a[24:27], a[32:35], v[212:215]
    ds_read_b128 a[144:147], v40 offset:45056
    v_perm_b32 v59, v92, v35, s39
    v_mfma_f32_16x16x32_bf16 v[212:215], a[64:67], a[60:63], v[212:215]
    ds_read_b32 a135, v59
    ds_read_b128 a[164:167], v41 offset:45056
    v_mfma_f32_16x16x32_bf16 v[216:219], a[24:27], a[88:91], v[216:219]
    buffer_load_dwordx4 v39, s[8:11], s56 offen offset:3072 lds
    v_mfma_f32_16x16x32_bf16 v[216:219], a[64:67], a[4:7], v[216:219]
    v_perm_b32 v60, v94, v35, s36
    v_perm_b32 v61, v94, v35, s37
    v_mfma_f32_16x16x32_bf16 v[220:223], a[24:27], a[16:19], v[220:223]
    s_add_u32 s3, s55, 1408
    ds_read_b32 a192, v60
    ds_read_b32 a193, v61
    v_mfma_f32_16x16x32_bf16 v[220:223], a[64:67], a[52:55], v[220:223]
    v_perm_b32 v62, v94, v35, s38
    v_perm_b32 v63, v94, v35, s39
    v_mfma_f32_16x16x32_bf16 v[128:131], a[96:99], a[8:11], v[128:131]
    s_mov_b32 s44, 102400
    ds_read_b128 a[220:223], v40 offset:47104
    ds_read_b32 a194, v62
    v_mfma_f32_16x16x32_bf16 v[128:131], a[0:3], a[12:15], v[128:131]
    s_add_u32 m0, s57, 16384
    ds_read_b32 a195, v63
    v_perm_b32 v56, v96, v35, s36
    v_mfma_f32_16x16x32_bf16 v[132:135], a[96:99], a[28:31], v[132:135]
    ds_read_b32 a80, v56
    ds_read_b128 a[232:235], v41 offset:47104
    v_mfma_f32_16x16x32_bf16 v[132:135], a[0:3], a[36:39], v[132:135]
    buffer_load_dwordx4 v[64:67], v32, s[12:15], s44 offen sc1
    v_mfma_f32_16x16x32_bf16 v[136:139], a[96:99], a[40:43], v[136:139]
    s_mov_b32 s45, 107520
    v_perm_b32 v57, v96, v35, s37
    v_perm_b32 v58, v96, v35, s38
    v_mfma_f32_16x16x32_bf16 v[136:139], a[0:3], a[44:47], v[136:139]
    s_waitcnt lgkmcnt(7)
    ds_read_b32 a81, v57
    ds_read_b32 a82, v58
    v_mfma_f32_16x16x32_bf16 v[140:143], a[96:99], a[68:71], v[140:143]
    ds_read_b128 a[84:87], v42 offset:32768
L_pad2:
    s_cbranch_execz L_pad3
    v_mfma_f32_16x16x32_bf16 v[140:143], a[0:3], a[112:115], v[140:143]
    buffer_load_dwordx4 v[112:115], v32, s[12:15], s45 offen sc1
    v_mfma_f32_16x16x32_bf16 v[144:147], a[96:99], a[128:131], v[144:147]
    v_perm_b32 v59, v96, v35, s39
    v_perm_b32 v60, v104, v35, s36
    v_mfma_f32_16x16x32_bf16 v[144:147], a[0:3], a[140:143], v[144:147]
    ds_read_b32 a83, v59
    ds_read_b32 a92, v60
    v_mfma_f32_16x16x32_bf16 v[148:151], a[96:99], a[168:171], v[148:151]
    ds_read_b128 a[100:103], v43 offset:32768
    v_mfma_f32_16x16x32_bf16 v[148:151], a[0:3], a[172:175], v[148:151]
    buffer_load_dwordx4 v36, s[8:11], s3 offen offset:0 lds
    v_mfma_f32_16x16x32_bf16 v[152:155], a[96:99], a[144:147], v[152:155]
    v_perm_b32 v61, v104, v35, s37
    v_perm_b32 v62, v104, v35, s38
    v_mfma_f32_16x16x32_bf16 v[152:155], a[0:3], a[164:167], v[152:155]
    s_waitcnt lgkmcnt(6)
    ds_read_b32 a93, v61
    ds_read_b32 a94, v62
    v_mfma_f32_16x16x32_bf16 v[156:159], a[96:99], a[220:223], v[156:159]
    v_perm_b32 v63, v104, v35, s39
    v_perm_b32 v56, v97, v35, s36
    v_mfma_f32_16x16x32_bf16 v[156:159], a[0:3], a[232:235], v[156:159]
    ds_read_b32 a95, v63
    ds_read_b32 a104, v56
    v_mfma_f32_16x16x32_bf16 v[160:163], a[20:23], a[8:11], v[160:163]
    ds_read_b128 a[108:111], v42 offset:34816
    v_mfma_f32_16x16x32_bf16 v[160:163], a[56:59], a[12:15], v[160:163]
    buffer_load_dwordx4 v37, s[8:11], s3 offen offset:1024 lds
    v_mfma_f32_16x16x32_bf16 v[164:167], a[20:23], a[28:31], v[164:167]
    v_perm_b32 v57, v97, v35, s37
    v_perm_b32 v58, v97, v35, s38
    v_mfma_f32_16x16x32_bf16 v[164:167], a[56:59], a[36:39], v[164:167]
    ds_read_b32 a105, v57
    ds_read_b32 a106, v58
    v_mfma_f32_16x16x32_bf16 v[168:171], a[20:23], a[40:43], v[168:171]
    v_perm_b32 v59, v97, v35, s39
    v_perm_b32 v60, v105, v35, s36
    v_mfma_f32_16x16x32_bf16 v[168:171], a[56:59], a[44:47], v[168:171]
    ds_read_b32 a107, v59
    ds_read_b32 a116, v60
    v_mfma_f32_16x16x32_bf16 v[172:175], a[20:23], a[68:71], v[172:175]
    ds_read_b128 a[120:123], v43 offset:34816
    v_mfma_f32_16x16x32_bf16 v[172:175], a[56:59], a[112:115], v[172:175]
    buffer_load_dwordx4 v38, s[8:11], s3 offen offset:2048 lds
    v_mfma_f32_16x16x32_bf16 v[176:179], a[20:23], a[128:131], v[176:179]
    s_waitcnt vmcnt(13)
    v_bitop3_b32 v111, v111, v123, s76 bitop3:0x7e
    v_perm_b32 v61, v105, v35, s37
    v_mfma_f32_16x16x32_bf16 v[176:179], a[56:59], a[140:143], v[176:179]
    ds_read_b32 a117, v61
    v_cmp_ne_u32 vcc, 0, v111
    v_mfma_f32_16x16x32_bf16 v[180:183], a[20:23], a[168:171], v[180:183]
    v_perm_b32 v62, v105, v35, s38
    v_perm_b32 v63, v105, v35, s39
    v_mfma_f32_16x16x32_bf16 v[180:183], a[56:59], a[172:175], v[180:183]
    ds_read_b32 a118, v62
    ds_read_b32 a119, v63
    v_mfma_f32_16x16x32_bf16 v[184:187], a[20:23], a[144:147], v[184:187]
    ds_read_b128 a[124:127], v42 offset:36864
    s_cbranch_vccnz L_slow4_0
L_back4_0:
    v_mfma_f32_16x16x32_bf16 v[184:187], a[56:59], a[164:167], v[184:187]
    buffer_load_dwordx4 v39, s[8:11], s3 offen offset:3072 lds
    v_mfma_f32_16x16x32_bf16 v[188:191], a[20:23], a[220:223], v[188:191]
    v_perm_b32 v56, v98, v35, s36
    v_perm_b32 v57, v98, v35, s37
    v_mfma_f32_16x16x32_bf16 v[188:191], a[56:59], a[232:235], v[188:191]
    ds_read_b32 a136, v56
    ds_read_b32 a137, v57
    v_mfma_f32_16x16x32_bf16 v[192:195], a[72:75], a[8:11], v[192:195]
    ds_read_b128 a[148:151], v43 offset:36864
    v_perm_b32 v58, v98, v35, s38
    v_mfma_f32_16x16x32_bf16 v[192:195], a[152:155], a[12:15], v[192:195]
    ds_read_b128 a[156:159], v42 offset:38912
    ds_read_b32 a138, v58
    v_mfma_f32_16x16x32_bf16 v[196:199], a[72:75], a[28:31], v[196:199]
    ds_read_b128 a[160:163], v43 offset:38912
    v_perm_b32 v59, v98, v35, s39
    v_mfma_f32_16x16x32_bf16 v[196:199], a[152:155], a[36:39], v[196:199]
    ds_read_b128 a[176:179], v42 offset:40960
    ds_read_b32 a139, v59
    v_mfma_f32_16x16x32_bf16 v[200:203], a[72:75], a[40:43], v[200:203]
    ds_read_b128 a[180:183], v43 offset:40960
    v_perm_b32 v60, v106, v35, s36
    v_mfma_f32_16x16x32_bf16 v[200:203], a[152:155], a[44:47], v[200:203]
    ds_read_b128 a[248:251], v42 offset:43008
    ds_read_b32 a208, v60
    v_mfma_f32_16x16x32_bf16 v[204:207], a[72:75], a[68:71], v[204:207]
    s_mov_b32 s48, 102400
    v_perm_b32 v61, v106, v35, s37
    v_perm_b32 v62, v106, v35, s38
    v_mfma_f32_16x16x32_bf16 v[204:207], a[152:155], a[112:115], v[204:207]
    ds_read_b128 a[184:187], v43 offset:43008
    ds_read_b32 a209, v61
    v_mfma_f32_16x16x32_bf16 v[208:211], a[72:75], a[128:131], v[208:211]
    s_waitcnt vmcnt(12)
    ds_read_b32 a210, v62
    ds_read_b128 a[196:199], v42 offset:45056
    v_mfma_f32_16x16x32_bf16 v[208:211], a[152:155], a[140:143], v[208:211]
    buffer_load_dwordx2 v[116:117], v34, s[12:15], s48 offen sc1
    v_mfma_f32_16x16x32_bf16 v[212:215], a[72:75], a[168:171], v[212:215]
    s_mov_b32 s49, 107520
    v_perm_b32 v63, v106, v35, s39
    v_bitop3_b32 v125, v125, v127, s76 bitop3:0x7e
    v_mfma_f32_16x16x32_bf16 v[212:215], a[152:155], a[172:175], v[212:215]
    ds_read_b32 a211, v63
    v_cmp_ne_u32 vcc, 0, v125
    v_mfma_f32_16x16x32_bf16 v[216:219], a[72:75], a[144:147], v[216:219]
    ds_read_b128 a[204:207], v43 offset:45056
    v_mfma_f32_16x16x32_bf16 v[216:219], a[152:155], a[164:167], v[216:219]
    buffer_load_dwordx2 v[118:119], v34, s[12:15], s49 offen sc1
    v_mfma_f32_16x16x32_bf16 v[220:223], a[72:75], a[220:223], v[220:223]
    v_perm_b32 v56, v108, v35, s36
    s_cbranch_vccnz L_slow4_2
L_back4_2:
    v_mfma_f32_16x16x32_bf16 v[220:223], a[152:155], a[232:235], v[220:223]
    ds_read_b32 a240, v56
    v_perm_b32 v57, v108, v35, s37
    v_mfma_f32_16x16x32_bf16 v[224:227], a[132:135], a[8:11], v[224:227]
    ds_read_b128 a[76:79], v42 offset:47104
    ds_read_b32 a241, v57
    v_mfma_f32_16x16x32_bf16 v[224:227], a[192:195], a[12:15], v[224:227]
    v_perm_b32 v58, v108, v35, s38
    v_perm_b32 v59, v108, v35, s39
    v_mfma_f32_16x16x32_bf16 v[228:231], a[132:135], a[28:31], v[228:231]
    ds_read_b32 a242, v58
    ds_read_b32 a243, v59
    v_mfma_f32_16x16x32_bf16 v[228:231], a[192:195], a[36:39], v[228:231]
    s_mov_b32 s50, 102400
    ds_read_b128 a[48:51], v43 offset:47104
    v_perm_b32 v60, v120, v35, s36
    v_mfma_f32_16x16x32_bf16 v[232:235], a[132:135], a[40:43], v[232:235]
    ds_read_b32 a188, v60
    v_perm_b32 v61, v120, v35, s37
    v_perm_b32 v62, v120, v35, s38
    v_mfma_f32_16x16x32_bf16 v[232:235], a[192:195], a[44:47], v[232:235]
    s_waitcnt vmcnt(12)
    ds_read_b32 a189, v61
    ds_read_b32 a190, v62
    v_mfma_f32_16x16x32_bf16 v[236:239], a[132:135], a[68:71], v[236:239]
    buffer_load_dwordx4 v[68:71], v33, s[12:15], s50 offen sc1
    v_mfma_f32_16x16x32_bf16 v[236:239], a[192:195], a[112:115], v[236:239]
    s_mov_b32 s69, 107520
    v_perm_b32 v63, v120, v35, s39
    v_perm_b32 v56, v109, v35, s36
    v_mfma_f32_16x16x32_bf16 v[240:243], a[132:135], a[128:131], v[240:243]
    ds_read_b32 a191, v63
    v_bitop3_b32 v51, v51, v55, s76 bitop3:0x7e
    v_perm_b32 v57, v109, v35, s37
    v_mfma_f32_16x16x32_bf16 v[240:243], a[192:195], a[140:143], v[240:243]
    s_waitcnt lgkmcnt(4)
    ds_read_b32 a200, v56
    ds_read_b32 a201, v57
    v_mfma_f32_16x16x32_bf16 v[244:247], a[132:135], a[168:171], v[244:247]
    buffer_load_dwordx4 v[80:83], v33, s[12:15], s69 offen sc1
    v_mfma_f32_16x16x32_bf16 v[244:247], a[192:195], a[172:175], v[244:247]
    s_add_u32 s56, s55, 1536
    v_cmp_ne_u32 vcc, 0, v51
    v_perm_b32 v58, v109, v35, s38
    v_mfma_f32_16x16x32_bf16 v[248:251], a[132:135], a[144:147], v[248:251]
    s_barrier
    v_mfma_f32_16x16x32_bf16 v[248:251], a[192:195], a[164:167], v[248:251]
    ds_read_b32 a202, v58
    s_cbranch_vccnz L_slow4_1
L_back4_1:
    v_mfma_f32_16x16x32_bf16 v[252:255], a[132:135], a[220:223], v[252:255]
    s_add_u32 m0, s57, 32768
    v_perm_b32 v59, v109, v35, s39
    v_perm_b32 v60, v121, v35, s36
    v_mfma_f32_16x16x32_bf16 v[252:255], a[192:195], a[232:235], v[252:255]
    ds_read_b32 a203, v59
    ds_read_b32 a212, v60
    v_mfma_f32_16x16x32_bf16 v[128:131], a[80:83], a[84:87], v[128:131]
    buffer_load_dwordx4 v36, s[8:11], s56 offen offset:0 lds
    v_mfma_f32_16x16x32_bf16 v[128:131], a[92:95], a[100:103], v[128:131]
    v_perm_b32 v61, v121, v35, s37
    v_perm_b32 v62, v121, v35, s38
    v_mfma_f32_16x16x32_bf16 v[132:135], a[80:83], a[108:111], v[132:135]
    ds_read_b32 a213, v61
    ds_read_b32 a214, v62
    v_mfma_f32_16x16x32_bf16 v[132:135], a[92:95], a[120:123], v[132:135]
    v_perm_b32 v63, v121, v35, s39
    v_perm_b32 v56, v110, v35, s36
    v_mfma_f32_16x16x32_bf16 v[136:139], a[80:83], a[124:127], v[136:139]
    ds_read_b32 a215, v63
    ds_read_b32 a216, v56
    v_mfma_f32_16x16x32_bf16 v[136:139], a[92:95], a[148:151], v[136:139]
    v_perm_b32 v57, v110, v35, s37
    v_perm_b32 v58, v110, v35, s38
    v_mfma_f32_16x16x32_bf16 v[140:143], a[80:83], a[156:159], v[140:143]
    ds_read_b32 a217, v57
    ds_read_b32 a218, v58
    v_mfma_f32_16x16x32_bf16 v[140:143], a[92:95], a[160:163], v[140:143]
    ds_read_b128 a[224:227], v44 offset:0
    v_mfma_f32_16x16x32_bf16 v[144:147], a[80:83], a[176:179], v[144:147]
    buffer_load_dwordx4 v37, s[8:11], s56 offen offset:1024 lds
    v_mfma_f32_16x16x32_bf16 v[144:147], a[92:95], a[180:183], v[144:147]
    v_perm_b32 v59, v110, v35, s39
    v_perm_b32 v60, v122, v35, s36
    v_mfma_f32_16x16x32_bf16 v[148:151], a[80:83], a[248:251], v[148:151]
    ds_read_b32 a219, v59
    ds_read_b32 a228, v60
    v_mfma_f32_16x16x32_bf16 v[148:151], a[92:95], a[184:187], v[148:151]
    v_perm_b32 v61, v122, v35, s37
    v_perm_b32 v62, v122, v35, s38
    v_mfma_f32_16x16x32_bf16 v[152:155], a[80:83], a[196:199], v[152:155]
    ds_read_b128 a[236:239], v45 offset:0
    ds_read_b32 a229, v61
    v_mfma_f32_16x16x32_bf16 v[152:155], a[92:95], a[204:207], v[152:155]
    ds_read_b128 a[244:247], v44 offset:2048
    ds_read_b32 a230, v62
    v_mfma_f32_16x16x32_bf16 v[156:159], a[80:83], a[76:79], v[156:159]
    v_perm_b32 v63, v122, v35, s39
    v_perm_b32 v56, v124, v35, s36
    v_mfma_f32_16x16x32_bf16 v[156:159], a[92:95], a[48:51], v[156:159]
    ds_read_b128 a[252:255], v45 offset:2048
    ds_read_b32 a231, v63
    v_mfma_f32_16x16x32_bf16 v[160:163], a[104:107], a[84:87], v[160:163]
    buffer_load_dwordx4 v38, s[8:11], s56 offen offset:2048 lds
    v_mfma_f32_16x16x32_bf16 v[160:163], a[116:119], a[100:103], v[160:163]
    ds_read_b32 a32, v56
    v_perm_b32 v57, v124, v35, s37
    v_mfma_f32_16x16x32_bf16 v[164:167], a[104:107], a[108:111], v[164:167]
    ds_read_b128 a[60:63], v44 offset:4096
    ds_read_b32 a33, v57
    v_mfma_f32_16x16x32_bf16 v[164:167], a[116:119], a[120:123], v[164:167]
    v_perm_b32 v58, v124, v35, s38
    v_perm_b32 v59, v124, v35, s39
    v_mfma_f32_16x16x32_bf16 v[168:171], a[104:107], a[124:127], v[168:171]
    ds_read_b32 a34, v58
    ds_read_b32 a35, v59
    v_mfma_f32_16x16x32_bf16 v[168:171], a[116:119], a[148:151], v[168:171]
    ds_read_b128 a[88:91], v45 offset:4096
    v_perm_b32 v60, v126, v35, s36
    v_mfma_f32_16x16x32_bf16 v[172:175], a[104:107], a[156:159], v[172:175]
    ds_read_b32 a4, v60
    v_perm_b32 v61, v126, v35, s37
    v_mfma_f32_16x16x32_bf16 v[172:175], a[116:119], a[160:163], v[172:175]
    ds_read_b32 a5, v61
    ds_read_b128 a[16:19], v44 offset:6144
    v_mfma_f32_16x16x32_bf16 v[176:179], a[104:107], a[176:179], v[176:179]
    buffer_load_dwordx4 v39, s[8:11], s56 offen offset:3072 lds
    v_mfma_f32_16x16x32_bf16 v[176:179], a[116:119], a[180:183], v[176:179]
    v_perm_b32 v62, v126, v35, s38
    v_perm_b32 v63, v126, v35, s39
    v_mfma_f32_16x16x32_bf16 v[180:183], a[104:107], a[248:251], v[180:183]
    s_add_u32 s3, s55, 1664
    ds_read_b32 a6, v62
    ds_read_b32 a7, v63
    v_mfma_f32_16x16x32_bf16 v[180:183], a[116:119], a[184:187], v[180:183]
    s_mov_b32 s40, 122880
    ds_read_b128 a[24:27], v45 offset:6144
    v_perm_b32 v56, v48, v35, s36
    v_mfma_f32_16x16x32_bf16 v[184:187], a[104:107], a[196:199], v[184:187]
    s_waitcnt vmcnt(12)
    ds_read_b32 a64, v56
    ds_read_b128 a[52:55], v44 offset:8192
    v_mfma_f32_16x16x32_bf16 v[184:187], a[116:119], a[204:207], v[184:187]
    buffer_load_dwordx2 v[72:73], v34, s[12:15], s40 offen sc1
    v_mfma_f32_16x16x32_bf16 v[188:191], a[104:107], a[76:79], v[188:191]
    s_add_u32 m0, s57, 49152
    v_bitop3_b32 v67, v67, v115, s76 bitop3:0x7e
    v_perm_b32 v57, v48, v35, s37
    v_mfma_f32_16x16x32_bf16 v[188:191], a[116:119], a[48:51], v[188:191]
    s_mov_b32 s41, 128000
    ds_read_b32 a65, v57
    v_cmp_ne_u32 vcc, 0, v67
    v_mfma_f32_16x16x32_bf16 v[192:195], a[136:139], a[84:87], v[192:195]
    ds_read_b128 a[96:99], v45 offset:8192
    v_mfma_f32_16x16x32_bf16 v[192:195], a[208:211], a[100:103], v[192:195]
    buffer_load_dwordx2 v[74:75], v34, s[12:15], s41 offen sc1
    v_mfma_f32_16x16x32_bf16 v[196:199], a[136:139], a[108:111], v[196:199]
    v_perm_b32 v58, v48, v35, s38
    s_cbranch_vccnz L_slow5_0
L_back5_0:
    v_mfma_f32_16x16x32_bf16 v[196:199], a[208:211], a[120:123], v[196:199]
    ds_read_b32 a66, v58
    v_perm_b32 v59, v48, v35, s39
    v_mfma_f32_16x16x32_bf16 v[200:203], a[136:139], a[124:127], v[200:203]
    ds_read_b128 a[0:3], v44 offset:10240
    ds_read_b32 a67, v59
    v_mfma_f32_16x16x32_bf16 v[200:203], a[208:211], a[148:151], v[200:203]
    buffer_load_dwordx4 v36, s[8:11], s3 offen offset:0 lds
    v_mfma_f32_16x16x32_bf16 v[204:207], a[136:139], a[156:159], v[204:207]
    s_mov_b32 s42, 122880
    v_perm_b32 v60, v52, v35, s36
    v_perm_b32 v61, v52, v35, s37
    v_mfma_f32_16x16x32_bf16 v[204:207], a[208:211], a[160:163], v[204:207]
    ds_read_b128 a[20:23], v45 offset:10240
    ds_read_b32 a56, v60
    v_mfma_f32_16x16x32_bf16 v[208:211], a[136:139], a[176:179], v[208:211]
    ds_read_b32 a57, v61
    ds_read_b128 a[72:75], v44 offset:12288
    v_mfma_f32_16x16x32_bf16 v[208:211], a[208:211], a[180:183], v[208:211]
    buffer_load_dwordx4 v[76:79], v32, s[12:15], s42 offen sc1
    v_mfma_f32_16x16x32_bf16 v[212:215], a[136:139], a[248:251], v[212:215]
    s_mov_b32 s43, 128000
    v_perm_b32 v62, v52, v35, s38
    v_perm_b32 v63, v52, v35, s39
    v_mfma_f32_16x16x32_bf16 v[212:215], a[208:211], a[184:187], v[212:215]
    ds_read_b32 a58, v62
    ds_read_b32 a59, v63
    v_perm_b32 v56, v49, v35, s36
    v_mfma_f32_16x16x32_bf16 v[216:219], a[136:139], a[196:199], v[216:219]
    ds_read_b32 a8, v56
    ds_read_b128 a[152:155], v45 offset:12288
    v_mfma_f32_16x16x32_bf16 v[216:219], a[208:211], a[204:207], v[216:219]
    buffer_load_dwordx4 v[84:87], v32, s[12:15], s43 offen sc1
    v_mfma_f32_16x16x32_bf16 v[220:223], a[136:139], a[76:79], v[220:223]
    v_perm_b32 v57, v49, v35, s37
    v_perm_b32 v58, v49, v35, s38
    v_mfma_f32_16x16x32_bf16 v[220:223], a[208:211], a[48:51], v[220:223]
    s_waitcnt lgkmcnt(8)
    ds_read_b32 a9, v57
    ds_read_b32 a10, v58
    v_mfma_f32_16x16x32_bf16 v[128:131], a[240:243], a[224:227], v[128:131]
    s_add_u32 s56, s55, 1792
    ds_read_b128 a[12:15], v44 offset:14336
    v_mfma_f32_16x16x32_bf16 v[128:131], a[188:191], a[236:239], v[128:131]
    buffer_load_dwordx4 v37, s[8:11], s3 offen offset:1024 lds
    v_mfma_f32_16x16x32_bf16 v[132:135], a[240:243], a[244:247], v[132:135]
    v_perm_b32 v59, v49, v35, s39
    v_perm_b32 v60, v53, v35, s36
    v_mfma_f32_16x16x32_bf16 v[132:135], a[188:191], a[252:255], v[132:135]
    s_mov_b32 s44, 122880
    ds_read_b128 a[28:31], v45 offset:14336
    ds_read_b32 a11, v59
    v_mfma_f32_16x16x32_bf16 v[136:139], a[240:243], a[60:63], v[136:139]
    ds_read_b32 a36, v60
    v_perm_b32 v61, v53, v35, s37
    v_mfma_f32_16x16x32_bf16 v[136:139], a[188:191], a[88:91], v[136:139]
    ds_read_b32 a37, v61
    ds_read_b128 a[40:43], v46 offset:0
    v_mfma_f32_16x16x32_bf16 v[140:143], a[240:243], a[16:19], v[140:143]
    buffer_load_dwordx4 v[88:91], v33, s[12:15], s44 offen sc1
    v_mfma_f32_16x16x32_bf16 v[140:143], a[188:191], a[24:27], v[140:143]
    s_mov_b32 s45, 128000
    v_perm_b32 v62, v53, v35, s38
    v_perm_b32 v63, v53, v35, s39
    v_mfma_f32_16x16x32_bf16 v[144:147], a[240:243], a[52:55], v[144:147]
    ds_read_b32 a38, v62
    ds_read_b32 a39, v63
    v_perm_b32 v56, v50, v35, s36
    v_mfma_f32_16x16x32_bf16 v[144:147], a[188:191], a[96:99], v[144:147]
    s_waitcnt lgkmcnt(7)
    ds_read_b32 a68, v56
    ds_read_b128 a[44:47], v47 offset:0
    v_mfma_f32_16x16x32_bf16 v[148:151], a[240:243], a[0:3], v[148:151]
    buffer_load_dwordx4 v[100:103], v33, s[12:15], s45 offen sc1
    v_mfma_f32_16x16x32_bf16 v[148:151], a[188:191], a[20:23], v[148:151]
    v_perm_b32 v57, v50, v35, s37
    v_perm_b32 v58, v50, v35, s38
    v_mfma_f32_16x16x32_bf16 v[152:155], a[240:243], a[72:75], v[152:155]
    ds_read_b32 a69, v57
    ds_read_b32 a70, v58
    v_mfma_f32_16x16x32_bf16 v[152:155], a[188:191], a[152:155], v[152:155]
    s_waitcnt lgkmcnt(8)
    ds_read_b128 a[112:115], v46 offset:2048
    v_mfma_f32_16x16x32_bf16 v[156:159], a[240:243], a[12:15], v[156:159]
    buffer_load_dwordx4 v38, s[8:11], s3 offen offset:2048 lds
    v_mfma_f32_16x16x32_bf16 v[156:159], a[188:191], a[28:31], v[156:159]
    v_perm_b32 v59, v50, v35, s39
    v_perm_b32 v60, v54, v35, s36
    v_mfma_f32_16x16x32_bf16 v[160:163], a[200:203], a[224:227], v[160:163]
    ds_read_b32 a71, v59
    ds_read_b32 a128, v60
    v_perm_b32 v61, v54, v35, s37
    v_mfma_f32_16x16x32_bf16 v[160:163], a[212:215], a[236:239], v[160:163]
    ds_read_b32 a129, v61
    v_perm_b32 v62, v54, v35, s38
    v_mfma_f32_16x16x32_bf16 v[164:167], a[200:203], a[244:247], v[164:167]
    ds_read_b32 a130, v62
    v_perm_b32 v63, v54, v35, s39
    v_mfma_f32_16x16x32_bf16 v[164:167], a[212:215], a[252:255], v[164:167]
    s_waitcnt vmcnt(15)
    ds_read_b32 a131, v63
    ds_read_b128 a[140:143], v47 offset:2048
    v_mfma_f32_16x16x32_bf16 v[168:171], a[200:203], a[60:63], v[168:171]
    buffer_load_dwordx4 v39, s[8:11], s3 offen offset:3072 lds
    v_mfma_f32_16x16x32_bf16 v[168:171], a[212:215], a[88:91], v[168:171]
    s_add_u32 m0, s57, 65536
    v_perm_b32 v56, v64, v35, s36
    v_bitop3_b32 v117, v117, v119, s76 bitop3:0x7e
    v_mfma_f32_16x16x32_bf16 v[172:175], a[200:203], a[16:19], v[172:175]
    ds_read_b32 a168, v56
    v_cmp_ne_u32 vcc, 0, v117
    v_mfma_f32_16x16x32_bf16 v[172:175], a[212:215], a[24:27], v[172:175]
    ds_read_b128 a[172:175], v46 offset:4096
    v_mfma_f32_16x16x32_bf16 v[176:179], a[200:203], a[52:55], v[176:179]
    buffer_load_dwordx4 v[92:95], v22, s[32:35], 0 offen
    v_mfma_f32_16x16x32_bf16 v[176:179], a[212:215], a[96:99], v[176:179]
    v_perm_b32 v57, v64, v35, s37
    s_cbranch_vccnz L_slow5_2
L_back5_2:
    v_mfma_f32_16x16x32_bf16 v[180:183], a[200:203], a[0:3], v[180:183]
    ds_read_b32 a169, v57
    v_perm_b32 v58, v64, v35, s38
    v_perm_b32 v59, v64, v35, s39
    v_mfma_f32_16x16x32_bf16 v[180:183], a[212:215], a[20:23], v[180:183]
    ds_read_b32 a170, v58
    ds_read_b32 a171, v59
    v_mfma_f32_16x16x32_bf16 v[184:187], a[200:203], a[72:75], v[184:187]
    buffer_load_dwordx2 v[96:97], v22, s[32:35], 0 offen offset:16
    v_mfma_f32_16x16x32_bf16 v[184:187], a[212:215], a[152:155], v[184:187]
    v_perm_b32 v60, v112, v35, s36
    v_perm_b32 v61, v112, v35, s37
    v_mfma_f32_16x16x32_bf16 v[188:191], a[200:203], a[12:15], v[188:191]
    ds_read_b32 a144, v60
    ds_read_b32 a145, v61
    v_mfma_f32_16x16x32_bf16 v[188:191], a[212:215], a[28:31], v[188:191]
    v_perm_b32 v62, v112, v35, s38
    v_perm_b32 v63, v112, v35, s39
    v_mfma_f32_16x16x32_bf16 v[192:195], a[216:219], a[224:227], v[192:195]
    s_add_u32 s3, s55, 1920
    ds_read_b128 a[164:167], v47 offset:4096
    ds_read_b32 a146, v62
    v_mfma_f32_16x16x32_bf16 v[192:195], a[228:231], a[236:239], v[192:195]
    s_waitcnt vmcnt(16)
    ds_read_b128 a[132:135], v46 offset:6144
    ds_read_b32 a147, v63
    v_mfma_f32_16x16x32_bf16 v[196:199], a[216:219], a[244:247], v[196:199]
    buffer_load_dword v98, v23, s[32:35], 0 offen
    v_mfma_f32_16x16x32_bf16 v[196:199], a[228:231], a[252:255], v[196:199]
    ds_read_b128 a[220:223], v47 offset:6144
    v_perm_b32 v56, v65, v35, s36
    v_bitop3_b32 v71, v71, v83, s76 bitop3:0x7e
    v_mfma_f32_16x16x32_bf16 v[200:203], a[216:219], a[60:63], v[200:203]
    ds_read_b128 a[192:195], v46 offset:8192
    ds_read_b32 a232, v56
    v_cmp_ne_u32 vcc, 0, v71
    v_mfma_f32_16x16x32_bf16 v[200:203], a[228:231], a[88:91], v[200:203]
    ds_read_b128 a[80:83], v47 offset:8192
    v_perm_b32 v57, v65, v35, s37
    v_perm_b32 v58, v65, v35, s38
    v_mfma_f32_16x16x32_bf16 v[204:207], a[216:219], a[16:19], v[204:207]
    ds_read_b128 a[92:95], v46 offset:10240
    ds_read_b32 a233, v57
    v_mfma_f32_16x16x32_bf16 v[204:207], a[228:231], a[24:27], v[204:207]
    ds_read_b128 a[104:107], v47 offset:10240
    ds_read_b32 a234, v58
    v_perm_b32 v59, v65, v35, s39
    v_mfma_f32_16x16x32_bf16 v[208:211], a[216:219], a[52:55], v[208:211]
    ds_read_b32 a235, v59
    s_cbranch_vccnz L_slow5_1
L_back5_1:
    v_mfma_f32_16x16x32_bf16 v[208:211], a[228:231], a[96:99], v[208:211]
    v_perm_b32 v60, v113, v35, s36
    v_perm_b32 v61, v113, v35, s37
    v_mfma_f32_16x16x32_bf16 v[212:215], a[216:219], a[0:3], v[212:215]
    ds_read_b128 a[116:119], v46 offset:12288
    ds_read_b32 a84, v60
    v_mfma_f32_16x16x32_bf16 v[212:215], a[228:231], a[20:23], v[212:215]
    ds_read_b32 a85, v61
    v_perm_b32 v62, v113, v35, s38
    v_mfma_f32_16x16x32_bf16 v[216:219], a[216:219], a[72:75], v[216:219]
    ds_read_b32 a86, v62
    v_perm_b32 v63, v113, v35, s39
    v_mfma_f32_16x16x32_bf16 v[216:219], a[228:231], a[152:155], v[216:219]
    ds_read_b128 a[100:103], v47 offset:12288
    ds_read_b32 a87, v63
    v_mfma_f32_16x16x32_bf16 v[220:223], a[216:219], a[12:15], v[220:223]
    v_perm_b32 v56, v66, v35, s36
    v_perm_b32 v57, v66, v35, s37
    v_mfma_f32_16x16x32_bf16 v[220:223], a[228:231], a[28:31], v[220:223]
    ds_read_b32 a108, v56
    ds_read_b32 a109, v57
    v_mfma_f32_16x16x32_bf16 v[224:227], a[32:35], a[224:227], v[224:227]
    ds_read_b128 a[120:123], v46 offset:14336
    v_perm_b32 v58, v66, v35, s38
    v_mfma_f32_16x16x32_bf16 v[224:227], a[4:7], a[236:239], v[224:227]
    ds_read_b32 a110, v58
    v_perm_b32 v59, v66, v35, s39
    v_mfma_f32_16x16x32_bf16 v[228:231], a[32:35], a[244:247], v[228:231]
    ds_read_b32 a111, v59
    v_perm_b32 v60, v114, v35, s36
    v_mfma_f32_16x16x32_bf16 v[228:231], a[4:7], a[252:255], v[228:231]
    ds_read_b128 a[124:127], v47 offset:14336
    ds_read_b32 a148, v60
    v_mfma_f32_16x16x32_bf16 v[232:235], a[32:35], a[60:63], v[232:235]
    v_perm_b32 v61, v114, v35, s37
    v_perm_b32 v62, v114, v35, s38
    v_mfma_f32_16x16x32_bf16 v[232:235], a[4:7], a[88:91], v[232:235]
    ds_read_b32 a149, v61
    ds_read_b32 a150, v62
    v_mfma_f32_16x16x32_bf16 v[236:239], a[32:35], a[16:19], v[236:239]
    v_perm_b32 v63, v114, v35, s39
    v_perm_b32 v56, v116, v35, s36
    v_mfma_f32_16x16x32_bf16 v[236:239], a[4:7], a[24:27], v[236:239]
    ds_read_b32 a151, v63
    ds_read_b32 a156, v56
    v_mfma_f32_16x16x32_bf16 v[240:243], a[32:35], a[52:55], v[240:243]
    v_perm_b32 v57, v116, v35, s37
    v_perm_b32 v58, v116, v35, s38
    v_mfma_f32_16x16x32_bf16 v[240:243], a[4:7], a[96:99], v[240:243]
    ds_read_b32 a157, v57
    ds_read_b32 a158, v58
    v_mfma_f32_16x16x32_bf16 v[244:247], a[32:35], a[0:3], v[244:247]
    v_perm_b32 v59, v116, v35, s39
    v_perm_b32 v60, v118, v35, s36
    v_mfma_f32_16x16x32_bf16 v[244:247], a[4:7], a[20:23], v[244:247]
    s_waitcnt lgkmcnt(7)
    ds_read_b32 a159, v59
    ds_read_b32 a160, v60
    v_mfma_f32_16x16x32_bf16 v[248:251], a[32:35], a[72:75], v[248:251]
    s_barrier
    v_mfma_f32_16x16x32_bf16 v[248:251], a[4:7], a[152:155], v[248:251]
    buffer_load_dwordx4 v36, s[8:11], s56 offen offset:0 lds
    v_mfma_f32_16x16x32_bf16 v[252:255], a[32:35], a[12:15], v[252:255]
    v_perm_b32 v61, v118, v35, s37
    v_perm_b32 v62, v118, v35, s38
    v_mfma_f32_16x16x32_bf16 v[252:255], a[4:7], a[28:31], v[252:255]
    ds_read_b32 a161, v61
    ds_read_b32 a162, v62
    v_mfma_f32_16x16x32_bf16 v[128:131], a[64:67], a[40:43], v[128:131]
    s_waitcnt vmcnt(12)
    v_perm_b32 v63, v118, v35, s39
    v_perm_b32 v56, v68, v35, s36
    v_mfma_f32_16x16x32_bf16 v[128:131], a[56:59], a[44:47], v[128:131]
    ds_read_b32 a163, v63
    ds_read_b32 a176, v56
    v_bitop3_b32 v73, v73, v75, s76 bitop3:0x7e
    v_mfma_f32_16x16x32_bf16 v[132:135], a[64:67], a[112:115], v[132:135]
    ds_read_b128 a[180:183], v40 offset:0
L_pad3:
    s_cbranch_execz L_warmed
    v_mfma_f32_16x16x32_bf16 v[132:135], a[56:59], a[140:143], v[132:135]
    buffer_load_dwordx4 v37, s[8:11], s56 offen offset:1024 lds
    v_mfma_f32_16x16x32_bf16 v[136:139], a[64:67], a[172:175], v[136:139]
    s_mov_b32 s48, 143360
    v_cmp_ne_u32 vcc, 0, v73
    v_perm_b32 v57, v68, v35, s37
    v_mfma_f32_16x16x32_bf16 v[136:139], a[56:59], a[164:167], v[136:139]
    ds_read_b32 a177, v57
    v_perm_b32 v58, v68, v35, s38
    v_mfma_f32_16x16x32_bf16 v[140:143], a[64:67], a[132:135], v[140:143]
    ds_read_b32 a178, v58
    s_cbranch_vccnz L_slow6_2
L_back6_2:
    v_mfma_f32_16x16x32_bf16 v[140:143], a[56:59], a[220:223], v[140:143]
    buffer_load_dwordx2 v[104:105], v34, s[12:15], s48 offen sc1
    v_mfma_f32_16x16x32_bf16 v[144:147], a[64:67], a[192:195], v[144:147]
    s_mov_b32 s49, 148480
    v_perm_b32 v59, v68, v35, s39
    v_perm_b32 v60, v80, v35, s36
    v_mfma_f32_16x16x32_bf16 v[144:147], a[56:59], a[80:83], v[144:147]
    ds_read_b32 a179, v59
    ds_read_b32 a248, v60
    v_mfma_f32_16x16x32_bf16 v[148:151], a[64:67], a[92:95], v[148:151]
    ds_read_b128 a[184:187], v41 offset:0
    v_mfma_f32_16x16x32_bf16 v[148:151], a[56:59], a[104:107], v[148:151]
    buffer_load_dwordx2 v[106:107], v34, s[12:15], s49 offen sc1
    v_mfma_f32_16x16x32_bf16 v[152:155], a[64:67], a[116:119], v[152:155]
    v_perm_b32 v61, v80, v35, s37
    v_perm_b32 v62, v80, v35, s38
    v_mfma_f32_16x16x32_bf16 v[152:155], a[56:59], a[100:103], v[152:155]
    ds_read_b128 a[196:199], v40 offset:2048
    ds_read_b32 a249, v61
    v_mfma_f32_16x16x32_bf16 v[156:159], a[64:67], a[120:123], v[156:159]
    ds_read_b32 a250, v62
    ds_read_b128 a[204:207], v41 offset:2048
    v_mfma_f32_16x16x32_bf16 v[156:159], a[56:59], a[124:127], v[156:159]
    buffer_load_dwordx4 v38, s[8:11], s56 offen offset:2048 lds
    v_mfma_f32_16x16x32_bf16 v[160:163], a[8:11], a[40:43], v[160:163]
    s_mov_b32 s50, 143360
    v_perm_b32 v63, v80, v35, s39
    v_perm_b32 v56, v69, v35, s36
    v_mfma_f32_16x16x32_bf16 v[160:163], a[36:39], a[44:47], v[160:163]
    ds_read_b32 a251, v63
    ds_read_b32 a136, v56
    v_mfma_f32_16x16x32_bf16 v[164:167], a[8:11], a[112:115], v[164:167]
    s_waitcnt vmcnt(13)
    ds_read_b128 a[76:79], v40 offset:4096
    v_mfma_f32_16x16x32_bf16 v[164:167], a[36:39], a[140:143], v[164:167]
    buffer_load_dwordx4 v[108:111], v32, s[12:15], s50 offen sc1
    v_mfma_f32_16x16x32_bf16 v[168:171], a[8:11], a[172:175], v[168:171]
    s_mov_b32 s69, 148480
    v_bitop3_b32 v79, v79, v87, s76 bitop3:0x7e
    v_perm_b32 v57, v69, v35, s37
    v_mfma_f32_16x16x32_bf16 v[168:171], a[36:39], a[164:167], v[168:171]
    ds_read_b128 a[208:211], v41 offset:4096
    ds_read_b32 a137, v57
    v_cmp_ne_u32 vcc, 0, v79
    v_mfma_f32_16x16x32_bf16 v[172:175], a[8:11], a[132:135], v[172:175]
    ds_read_b128 a[48:51], v40 offset:6144
    v_mfma_f32_16x16x32_bf16 v[172:175], a[36:39], a[220:223], v[172:175]
    buffer_load_dwordx4 v[120:123], v32, s[12:15], s69 offen sc1
    v_mfma_f32_16x16x32_bf16 v[176:179], a[8:11], a[192:195], v[176:179]
    v_perm_b32 v58, v69, v35, s38
    s_cbranch_vccnz L_slow6_0
L_back6_0:
    v_mfma_f32_16x16x32_bf16 v[176:179], a[36:39], a[80:83], v[176:179]
    ds_read_b32 a138, v58
    v_perm_b32 v59, v69, v35, s39
    v_mfma_f32_16x16x32_bf16 v[180:183], a[8:11], a[92:95], v[180:183]
    ds_read_b32 a139, v59
    ds_read_b128 a[240:243], v41 offset:6144
    v_mfma_f32_16x16x32_bf16 v[180:183], a[36:39], a[104:107], v[180:183]
    buffer_load_dwordx4 v39, s[8:11], s56 offen offset:3072 lds
    v_mfma_f32_16x16x32_bf16 v[184:187], a[8:11], a[116:119], v[184:187]
    s_add_u32 m0, s57, 81920
    v_perm_b32 v60, v81, v35, s36
    v_perm_b32 v61, v81, v35, s37
    v_mfma_f32_16x16x32_bf16 v[184:187], a[36:39], a[100:103], v[184:187]
    s_mov_b32 s40, 143360
    ds_read_b32 a188, v60
    ds_read_b32 a189, v61
    v_mfma_f32_16x16x32_bf16 v[188:191], a[8:11], a[120:123], v[188:191]
    ds_read_b128 a[200:203], v40 offset:8192
    v_perm_b32 v62, v81, v35, s38
    v_mfma_f32_16x16x32_bf16 v[188:191], a[36:39], a[124:127], v[188:191]
    ds_read_b32 a190, v62
    ds_read_b128 a[212:215], v41 offset:8192
    v_mfma_f32_16x16x32_bf16 v[192:195], a[68:71], a[40:43], v[192:195]
    buffer_load_dwordx4 v[124:127], v33, s[12:15], s40 offen sc1
    v_mfma_f32_16x16x32_bf16 v[192:195], a[128:131], a[44:47], v[192:195]
    s_mov_b32 s41, 148480
    v_perm_b32 v63, v81, v35, s39
    v_perm_b32 v56, v70, v35, s36
    v_mfma_f32_16x16x32_bf16 v[196:199], a[68:71], a[112:115], v[196:199]
    ds_read_b32 a191, v63
    ds_read_b32 a216, v56
    v_mfma_f32_16x16x32_bf16 v[196:199], a[128:131], a[140:143], v[196:199]
    ds_read_b128 a[228:231], v40 offset:10240
    v_mfma_f32_16x16x32_bf16 v[200:203], a[68:71], a[172:175], v[200:203]
    buffer_load_dwordx4 v[48:51], v33, s[12:15], s41 offen sc1
    v_mfma_f32_16x16x32_bf16 v[200:203], a[128:131], a[164:167], v[200:203]
    s_waitcnt vmcnt(15)
    v_bitop3_b32 v91, v91, v103, s76 bitop3:0x7e
    v_perm_b32 v57, v70, v35, s37
    v_mfma_f32_16x16x32_bf16 v[204:207], a[68:71], a[132:135], v[204:207]
    ds_read_b32 a217, v57
    v_cmp_ne_u32 vcc, 0, v91
    v_perm_b32 v58, v70, v35, s38
    v_mfma_f32_16x16x32_bf16 v[204:207], a[128:131], a[220:223], v[204:207]
    ds_read_b128 a[224:227], v41 offset:10240
    ds_read_b32 a218, v58
    v_mfma_f32_16x16x32_bf16 v[208:211], a[68:71], a[192:195], v[208:211]
    buffer_load_dwordx4 v36, s[8:11], s3 offen offset:0 lds
    v_mfma_f32_16x16x32_bf16 v[208:211], a[128:131], a[80:83], v[208:211]
    v_perm_b32 v59, v70, v35, s39
    s_cbranch_vccnz L_slow6_1
L_back6_1:
    v_mfma_f32_16x16x32_bf16 v[212:215], a[68:71], a[92:95], v[212:215]
    ds_read_b128 a[236:239], v40 offset:12288
    ds_read_b32 a219, v59
    v_perm_b32 v60, v82, v35, s36
    v_mfma_f32_16x16x32_bf16 v[212:215], a[128:131], a[104:107], v[212:215]
    ds_read_b32 a244, v60
    v_perm_b32 v61, v82, v35, s37
    v_perm_b32 v62, v82, v35, s38
    v_mfma_f32_16x16x32_bf16 v[216:219], a[68:71], a[116:119], v[216:219]
    ds_read_b32 a245, v61
    ds_read_b32 a246, v62
    v_mfma_f32_16x16x32_bf16 v[216:219], a[128:131], a[100:103], v[216:219]
    ds_read_b128 a[252:255], v41 offset:12288
    v_mfma_f32_16x16x32_bf16 v[220:223], a[68:71], a[120:123], v[220:223]
    buffer_load_dwordx4 v37, s[8:11], s3 offen offset:1024 lds
    v_mfma_f32_16x16x32_bf16 v[220:223], a[128:131], a[124:127], v[220:223]
    s_waitcnt lgkmcnt(8)
    v_perm_b32 v63, v82, v35, s39
    v_perm_b32 v56, v72, v35, s36
    v_mfma_f32_16x16x32_bf16 v[128:131], a[168:171], a[180:183], v[128:131]
    ds_read_b128 a[60:63], v40 offset:14336
    ds_read_b32 a247, v63
    v_perm_b32 v57, v72, v35, s37
    v_mfma_f32_16x16x32_bf16 v[128:131], a[144:147], a[184:187], v[128:131]
    ds_read_b32 a88, v56
    ds_read_b32 a89, v57
    v_mfma_f32_16x16x32_bf16 v[132:135], a[168:171], a[196:199], v[132:135]
    v_perm_b32 v58, v72, v35, s38
    v_perm_b32 v59, v72, v35, s39
    v_mfma_f32_16x16x32_bf16 v[132:135], a[144:147], a[204:207], v[132:135]
    ds_read_b128 a[16:19], v41 offset:14336
    ds_read_b32 a90, v58
    v_mfma_f32_16x16x32_bf16 v[136:139], a[168:171], a[76:79], v[136:139]
    buffer_load_dwordx4 v38, s[8:11], s3 offen offset:2048 lds
    v_mfma_f32_16x16x32_bf16 v[136:139], a[144:147], a[208:211], v[136:139]
    ds_read_b32 a91, v59
    v_perm_b32 v60, v74, v35, s36
    v_mfma_f32_16x16x32_bf16 v[140:143], a[168:171], a[48:51], v[140:143]
    ds_read_b32 a24, v60
    v_perm_b32 v61, v74, v35, s37
    v_mfma_f32_16x16x32_bf16 v[140:143], a[144:147], a[240:243], v[140:143]
    ds_read_b32 a25, v61
    v_perm_b32 v62, v74, v35, s38
    v_mfma_f32_16x16x32_bf16 v[144:147], a[168:171], a[200:203], v[144:147]
    ds_read_b32 a26, v62
    v_perm_b32 v63, v74, v35, s39
    v_mfma_f32_16x16x32_bf16 v[144:147], a[144:147], a[212:215], v[144:147]
    s_waitcnt lgkmcnt(8)
    ds_read_b32 a27, v63
    ds_read_b128 a[52:55], v42 offset:0
    v_mfma_f32_16x16x32_bf16 v[148:151], a[168:171], a[228:231], v[148:151]
    buffer_load_dwordx4 v39, s[8:11], s3 offen offset:3072 lds
    v_mfma_f32_16x16x32_bf16 v[148:151], a[144:147], a[224:227], v[148:151]
    v_perm_b32 v56, v76, v35, s36
    v_perm_b32 v57, v76, v35, s37
    v_mfma_f32_16x16x32_bf16 v[152:155], a[168:171], a[236:239], v[152:155]
    ds_read_b32 a96, v56
    ds_read_b32 a97, v57
    v_mfma_f32_16x16x32_bf16 v[152:155], a[144:147], a[252:255], v[152:155]
    v_perm_b32 v58, v76, v35, s38
    v_perm_b32 v59, v76, v35, s39
    v_mfma_f32_16x16x32_bf16 v[156:159], a[168:171], a[60:63], v[156:159]
    s_waitcnt lgkmcnt(7)
    ds_read_b32 a98, v58
    ds_read_b32 a99, v59
    v_mfma_f32_16x16x32_bf16 v[156:159], a[144:147], a[16:19], v[156:159]
    v_perm_b32 v60, v84, v35, s36
    v_perm_b32 v61, v84, v35, s37
    v_mfma_f32_16x16x32_bf16 v[160:163], a[232:235], a[180:183], v[160:163]
    ds_read_b32 a0, v60
    ds_read_b32 a1, v61
    v_mfma_f32_16x16x32_bf16 v[160:163], a[84:87], a[184:187], v[160:163]
    ds_read_b128 a[20:23], v43 offset:0
    v_perm_b32 v62, v84, v35, s38
    v_mfma_f32_16x16x32_bf16 v[164:167], a[232:235], a[196:199], v[164:167]
    ds_read_b32 a2, v62
    v_perm_b32 v63, v84, v35, s39
    v_mfma_f32_16x16x32_bf16 v[164:167], a[84:87], a[204:207], v[164:167]
    ds_read_b32 a3, v63
    v_perm_b32 v56, v88, v35, s36
    v_mfma_f32_16x16x32_bf16 v[168:171], a[232:235], a[76:79], v[168:171]
    ds_read_b32 a152, v56
    ds_read_b128 a[72:75], v42 offset:2048
    v_mfma_f32_16x16x32_bf16 v[168:171], a[84:87], a[208:211], v[168:171]
    v_perm_b32 v57, v88, v35, s37
    v_perm_b32 v58, v88, v35, s38
    v_mfma_f32_16x16x32_bf16 v[172:175], a[232:235], a[48:51], v[172:175]
    ds_read_b32 a153, v57
    ds_read_b32 a154, v58
    v_mfma_f32_16x16x32_bf16 v[172:175], a[84:87], a[240:243], v[172:175]
    ds_read_b128 a[32:35], v43 offset:2048
    v_perm_b32 v59, v88, v35, s39
    v_mfma_f32_16x16x32_bf16 v[176:179], a[232:235], a[200:203], v[176:179]
    ds_read_b32 a155, v59
    ds_read_b128 a[12:15], v42 offset:4096
    v_mfma_f32_16x16x32_bf16 v[176:179], a[84:87], a[212:215], v[176:179]
    v_perm_b32 v60, v100, v35, s36
    v_perm_b32 v61, v100, v35, s37
    v_mfma_f32_16x16x32_bf16 v[180:183], a[232:235], a[228:231], v[180:183]
    ds_read_b32 a4, v60
    ds_read_b32 a5, v61
    v_mfma_f32_16x16x32_bf16 v[180:183], a[84:87], a[224:227], v[180:183]
    ds_read_b128 a[28:31], v43 offset:4096
    v_perm_b32 v62, v100, v35, s38
    v_mfma_f32_16x16x32_bf16 v[184:187], a[232:235], a[236:239], v[184:187]
    ds_read_b32 a6, v62
    v_perm_b32 v63, v100, v35, s39
    v_mfma_f32_16x16x32_bf16 v[184:187], a[84:87], a[252:255], v[184:187]
    ds_read_b32 a7, v63
    ds_read_b128 a[64:67], v42 offset:6144
    v_mfma_f32_16x16x32_bf16 v[188:191], a[232:235], a[60:63], v[188:191]
    v_perm_b32 v56, v77, v35, s36
    v_perm_b32 v57, v77, v35, s37
    v_mfma_f32_16x16x32_bf16 v[188:191], a[84:87], a[16:19], v[188:191]
    ds_read_b32 a56, v56
    ds_read_b32 a57, v57
    v_mfma_f32_16x16x32_bf16 v[192:195], a[108:111], a[180:183], v[192:195]
    ds_read_b128 a[8:11], v43 offset:6144
    v_perm_b32 v58, v77, v35, s38
    v_mfma_f32_16x16x32_bf16 v[192:195], a[148:151], a[184:187], v[192:195]
    ds_read_b32 a58, v58
    v_perm_b32 v59, v77, v35, s39
    v_mfma_f32_16x16x32_bf16 v[196:199], a[108:111], a[196:199], v[196:199]
    ds_read_b32 a59, v59
    ds_read_b128 a[36:39], v42 offset:8192
    v_mfma_f32_16x16x32_bf16 v[196:199], a[148:151], a[204:207], v[196:199]
    v_perm_b32 v60, v85, v35, s36
    v_perm_b32 v61, v85, v35, s37
    v_mfma_f32_16x16x32_bf16 v[200:203], a[108:111], a[76:79], v[200:203]
    ds_read_b128 a[40:43], v43 offset:8192
    ds_read_b32 a44, v60
    v_mfma_f32_16x16x32_bf16 v[200:203], a[148:151], a[208:211], v[200:203]
    ds_read_b128 a[112:115], v42 offset:10240
    ds_read_b32 a45, v61
    v_mfma_f32_16x16x32_bf16 v[204:207], a[108:111], a[48:51], v[204:207]
    v_perm_b32 v62, v85, v35, s38
    v_perm_b32 v63, v85, v35, s39
    v_mfma_f32_16x16x32_bf16 v[204:207], a[148:151], a[240:243], v[204:207]
    ds_read_b128 a[140:143], v43 offset:10240
    ds_read_b32 a46, v62
    v_mfma_f32_16x16x32_bf16 v[208:211], a[108:111], a[200:203], v[208:211]
    ds_read_b32 a47, v63
    v_perm_b32 v56, v89, v35, s36
    v_mfma_f32_16x16x32_bf16 v[208:211], a[148:151], a[212:215], v[208:211]
    s_waitcnt vmcnt(10)
    ds_read_b32 a172, v56
    v_bitop3_b32 v105, v105, v107, s76 bitop3:0x7e
    v_mfma_f32_16x16x32_bf16 v[212:215], a[108:111], a[228:231], v[212:215]
    ds_read_b128 a[164:167], v42 offset:12288
    v_cmp_ne_u32 vcc, 0, v105
    v_mfma_f32_16x16x32_bf16 v[212:215], a[148:151], a[224:227], v[212:215]
    v_perm_b32 v57, v89, v35, s37
    v_perm_b32 v58, v89, v35, s38
    v_mfma_f32_16x16x32_bf16 v[216:219], a[108:111], a[236:239], v[216:219]
    ds_read_b32 a173, v57
    ds_read_b32 a174, v58
    v_mfma_f32_16x16x32_bf16 v[216:219], a[148:151], a[252:255], v[216:219]
    ds_read_b128 a[132:135], v43 offset:12288
    s_cbranch_vccnz L_slow7_2
L_back7_2:
    v_mfma_f32_16x16x32_bf16 v[220:223], a[108:111], a[60:63], v[220:223]
    v_perm_b32 v59, v89, v35, s39
    v_perm_b32 v60, v101, v35, s36
    v_mfma_f32_16x16x32_bf16 v[220:223], a[148:151], a[16:19], v[220:223]
    ds_read_b32 a175, v59
    ds_read_b32 a220, v60
    v_mfma_f32_16x16x32_bf16 v[224:227], a[156:159], a[180:183], v[224:227]
    ds_read_b128 a[192:195], v42 offset:14336
    v_perm_b32 v61, v101, v35, s37
    v_mfma_f32_16x16x32_bf16 v[224:227], a[160:163], a[184:187], v[224:227]
    ds_read_b32 a221, v61
    v_perm_b32 v62, v101, v35, s38
    v_mfma_f32_16x16x32_bf16 v[228:231], a[156:159], a[196:199], v[228:231]
    ds_read_b32 a222, v62
    v_perm_b32 v63, v101, v35, s39
    v_mfma_f32_16x16x32_bf16 v[228:231], a[160:163], a[204:207], v[228:231]
    ds_read_b128 a[80:83], v43 offset:14336
    ds_read_b32 a223, v63
    v_mfma_f32_16x16x32_bf16 v[232:235], a[156:159], a[76:79], v[232:235]
    s_waitcnt vmcnt(7)
    v_perm_b32 v56, v78, v35, s36
    v_bitop3_b32 v111, v111, v123, s76 bitop3:0x7e
    v_mfma_f32_16x16x32_bf16 v[232:235], a[160:163], a[208:211], v[232:235]
    ds_read_b32 a92, v56
    v_cmp_ne_u32 vcc, 0, v111
    v_mfma_f32_16x16x32_bf16 v[236:239], a[156:159], a[48:51], v[236:239]
    v_perm_b32 v57, v78, v35, s37
    v_perm_b32 v58, v78, v35, s38
    v_mfma_f32_16x16x32_bf16 v[236:239], a[160:163], a[240:243], v[236:239]
    ds_read_b32 a93, v57
    ds_read_b32 a94, v58
    v_mfma_f32_16x16x32_bf16 v[240:243], a[156:159], a[200:203], v[240:243]
    v_perm_b32 v59, v78, v35, s39
    s_cbranch_vccnz L_slow7_0
L_back7_0:
    v_mfma_f32_16x16x32_bf16 v[240:243], a[160:163], a[212:215], v[240:243]
    ds_read_b32 a95, v59
    v_perm_b32 v60, v86, v35, s36
    v_mfma_f32_16x16x32_bf16 v[244:247], a[156:159], a[228:231], v[244:247]
    ds_read_b32 a104, v60
    v_perm_b32 v61, v86, v35, s37
    v_mfma_f32_16x16x32_bf16 v[244:247], a[160:163], a[224:227], v[244:247]
    s_waitcnt lgkmcnt(6)
    ds_read_b32 a105, v61
    v_perm_b32 v62, v86, v35, s38
    v_mfma_f32_16x16x32_bf16 v[248:251], a[156:159], a[236:239], v[248:251]
    s_barrier
    v_mfma_f32_16x16x32_bf16 v[248:251], a[160:163], a[252:255], v[248:251]
    ds_read_b32 a106, v62
    v_perm_b32 v63, v86, v35, s39
    v_mfma_f32_16x16x32_bf16 v[252:255], a[156:159], a[60:63], v[252:255]
    ds_read_b32 a107, v63
    v_perm_b32 v56, v90, v35, s36
    v_mfma_f32_16x16x32_bf16 v[252:255], a[160:163], a[16:19], v[252:255]
    s_waitcnt vmcnt(4)
    ds_read_b32 a116, v56
    v_bitop3_b32 v127, v127, v51, s76 bitop3:0x7e
    v_mfma_f32_16x16x32_bf16 v[128:131], a[176:179], a[52:55], v[128:131]
    v_cmp_ne_u32 vcc, 0, v127
    v_perm_b32 v57, v90, v35, s37
    v_mfma_f32_16x16x32_bf16 v[128:131], a[248:251], a[20:23], v[128:131]
    ds_read_b32 a117, v57
    v_perm_b32 v58, v90, v35, s38
    v_mfma_f32_16x16x32_bf16 v[132:135], a[176:179], a[72:75], v[132:135]
    ds_read_b32 a118, v58
    s_cbranch_vccnz L_slow7_1
L_back7_1:
    v_mfma_f32_16x16x32_bf16 v[132:135], a[248:251], a[32:35], v[132:135]
    v_perm_b32 v59, v90, v35, s39
    v_perm_b32 v60, v102, v35, s36
    v_mfma_f32_16x16x32_bf16 v[136:139], a[176:179], a[12:15], v[136:139]
    ds_read_b32 a119, v59
    ds_read_b32 a100, v60
    v_mfma_f32_16x16x32_bf16 v[136:139], a[248:251], a[28:31], v[136:139]
    v_perm_b32 v61, v102, v35, s37
    v_perm_b32 v62, v102, v35, s38
    v_mfma_f32_16x16x32_bf16 v[140:143], a[176:179], a[64:67], v[140:143]
    ds_read_b32 a101, v61
    ds_read_b32 a102, v62
    v_mfma_f32_16x16x32_bf16 v[140:143], a[248:251], a[8:11], v[140:143]
    v_perm_b32 v63, v102, v35, s39
    v_perm_b32 v56, v104, v35, s36
    v_mfma_f32_16x16x32_bf16 v[144:147], a[176:179], a[36:39], v[144:147]
    ds_read_b32 a103, v63
    ds_read_b32 a68, v56
    v_mfma_f32_16x16x32_bf16 v[144:147], a[248:251], a[40:43], v[144:147]
    v_perm_b32 v57, v104, v35, s37
    v_perm_b32 v58, v104, v35, s38
    v_mfma_f32_16x16x32_bf16 v[148:151], a[176:179], a[112:115], v[148:151]
    ds_read_b32 a69, v57
    ds_read_b32 a70, v58
    v_mfma_f32_16x16x32_bf16 v[148:151], a[248:251], a[140:143], v[148:151]
    v_perm_b32 v59, v104, v35, s39
    v_perm_b32 v60, v106, v35, s36
    v_mfma_f32_16x16x32_bf16 v[152:155], a[176:179], a[164:167], v[152:155]
    ds_read_b32 a71, v59
    ds_read_b32 a120, v60
    v_mfma_f32_16x16x32_bf16 v[152:155], a[248:251], a[132:135], v[152:155]
    v_perm_b32 v61, v106, v35, s37
    v_perm_b32 v62, v106, v35, s38
    v_mfma_f32_16x16x32_bf16 v[156:159], a[176:179], a[192:195], v[156:159]
    ds_read_b32 a121, v61
    ds_read_b32 a122, v62
    v_mfma_f32_16x16x32_bf16 v[156:159], a[248:251], a[80:83], v[156:159]
    ds_read_b128 a[128:131], v40 offset:32768
    v_perm_b32 v63, v106, v35, s39
    v_mfma_f32_16x16x32_bf16 v[160:163], a[136:139], a[52:55], v[160:163]
    ds_read_b32 a123, v63
    v_perm_b32 v56, v108, v35, s36
    v_mfma_f32_16x16x32_bf16 v[160:163], a[188:191], a[20:23], v[160:163]
    ds_read_b32 a124, v56
    v_perm_b32 v57, v108, v35, s37
    v_mfma_f32_16x16x32_bf16 v[164:167], a[136:139], a[72:75], v[164:167]
    ds_read_b32 a125, v57
    v_perm_b32 v58, v108, v35, s38
    v_mfma_f32_16x16x32_bf16 v[164:167], a[188:191], a[32:35], v[164:167]
    ds_read_b32 a126, v58
    ds_read_b128 a[168:171], v41 offset:32768
    v_mfma_f32_16x16x32_bf16 v[168:171], a[136:139], a[12:15], v[168:171]
    v_perm_b32 v59, v108, v35, s39
    v_perm_b32 v60, v120, v35, s36
    v_mfma_f32_16x16x32_bf16 v[168:171], a[188:191], a[28:31], v[168:171]
    ds_read_b32 a127, v59
    ds_read_b32 a144, v60
    v_mfma_f32_16x16x32_bf16 v[172:175], a[136:139], a[64:67], v[172:175]
    ds_read_b128 a[232:235], v40 offset:34816
    v_perm_b32 v61, v120, v35, s37
    v_mfma_f32_16x16x32_bf16 v[172:175], a[188:191], a[8:11], v[172:175]
    ds_read_b32 a145, v61
    v_perm_b32 v62, v120, v35, s38
    v_mfma_f32_16x16x32_bf16 v[176:179], a[136:139], a[36:39], v[176:179]
    ds_read_b32 a146, v62
    v_perm_b32 v63, v120, v35, s39
    v_mfma_f32_16x16x32_bf16 v[176:179], a[188:191], a[40:43], v[176:179]
    ds_read_b32 a147, v63
    v_perm_b32 v56, v124, v35, s36
    v_mfma_f32_16x16x32_bf16 v[180:183], a[136:139], a[112:115], v[180:183]
    ds_read_b32 a108, v56
    ds_read_b128 a[84:87], v41 offset:34816
    v_mfma_f32_16x16x32_bf16 v[180:183], a[188:191], a[140:143], v[180:183]
    v_perm_b32 v57, v124, v35, s37
    v_perm_b32 v58, v124, v35, s38
    v_mfma_f32_16x16x32_bf16 v[184:187], a[136:139], a[164:167], v[184:187]
    s_mov_b32 s64, 0
    ds_read_b32 a109, v57
    ds_read_b32 a110, v58
    v_mfma_f32_16x16x32_bf16 v[184:187], a[188:191], a[132:135], v[184:187]
    v_perm_b32 v59, v124, v35, s39
    v_perm_b32 v60, v48, v35, s36
    v_mfma_f32_16x16x32_bf16 v[188:191], a[136:139], a[192:195], v[188:191]
    ds_read_b32 a111, v59
    ds_read_b32 a148, v60
    v_mfma_f32_16x16x32_bf16 v[188:191], a[188:191], a[80:83], v[188:191]
    s_mov_b32 s65, 14336
    ds_read_b128 a[180:183], v42 offset:32768
    v_perm_b32 v61, v48, v35, s37
    v_mfma_f32_16x16x32_bf16 v[192:195], a[216:219], a[52:55], v[192:195]
    ds_read_b32 a149, v61
    v_perm_b32 v62, v48, v35, s38
    v_mfma_f32_16x16x32_bf16 v[192:195], a[244:247], a[20:23], v[192:195]
    ds_read_b32 a150, v62
    v_perm_b32 v63, v48, v35, s39
    v_mfma_f32_16x16x32_bf16 v[196:199], a[216:219], a[72:75], v[196:199]
    s_mov_b32 s66, 114688
    ds_read_b32 a151, v63
    ds_read_b128 a[184:187], v43 offset:32768
    v_mfma_f32_16x16x32_bf16 v[196:199], a[244:247], a[32:35], v[196:199]
    v_perm_b32 v56, v109, v35, s36
    v_perm_b32 v57, v109, v35, s37
    v_mfma_f32_16x16x32_bf16 v[200:203], a[216:219], a[12:15], v[200:203]
    ds_read_b32 a196, v56
    ds_read_b32 a197, v57
    v_mfma_f32_16x16x32_bf16 v[200:203], a[244:247], a[28:31], v[200:203]
    s_mov_b32 s67, 129024
    ds_read_b128 a[204:207], v42 offset:34816
    v_perm_b32 v58, v109, v35, s38
    v_mfma_f32_16x16x32_bf16 v[204:207], a[216:219], a[64:67], v[204:207]
    ds_read_b32 a198, v58
    v_perm_b32 v59, v109, v35, s39
    v_mfma_f32_16x16x32_bf16 v[204:207], a[244:247], a[8:11], v[204:207]
    ds_read_b32 a199, v59
    v_perm_b32 v60, v121, v35, s36
    v_mfma_f32_16x16x32_bf16 v[208:211], a[216:219], a[36:39], v[208:211]
    s_mov_b32 s68, 229376
    ds_read_b32 a76, v60
    v_perm_b32 v61, v121, v35, s37
    v_mfma_f32_16x16x32_bf16 v[208:211], a[244:247], a[40:43], v[208:211]
    ds_read_b32 a77, v61
    v_perm_b32 v62, v121, v35, s38
    v_mfma_f32_16x16x32_bf16 v[212:215], a[216:219], a[112:115], v[212:215]
    ds_read_b32 a78, v62
    ds_read_b128 a[208:211], v43 offset:34816
    v_mfma_f32_16x16x32_bf16 v[212:215], a[244:247], a[140:143], v[212:215]
    s_mov_b32 s69, 243712
    v_perm_b32 v63, v121, v35, s39
    v_perm_b32 v56, v125, v35, s36
    v_mfma_f32_16x16x32_bf16 v[216:219], a[216:219], a[164:167], v[216:219]
    ds_read_b32 a48, v56
    ds_read_b32 a79, v63
    v_mfma_f32_16x16x32_bf16 v[216:219], a[244:247], a[132:135], v[216:219]
    v_perm_b32 v57, v125, v35, s37
    v_perm_b32 v58, v125, v35, s38
    v_mfma_f32_16x16x32_bf16 v[220:223], a[216:219], a[192:195], v[220:223]
    s_mov_b32 s70, 344064
    ds_read_b32 a49, v57
    ds_read_b32 a50, v58
    v_mfma_f32_16x16x32_bf16 v[220:223], a[244:247], a[80:83], v[220:223]
    s_waitcnt lgkmcnt(9)
    v_perm_b32 v59, v125, v35, s39
    v_perm_b32 v60, v49, v35, s36
    v_mfma_f32_16x16x32_bf16 v[224:227], a[88:91], a[128:131], v[224:227]
    s_waitcnt vmcnt(0)
    ds_read_b32 a240, v60
    ds_read_b32 a51, v59
    v_mfma_f32_16x16x32_bf16 v[224:227], a[24:27], a[168:171], v[224:227]
    s_mov_b32 s71, 358400
    v_perm_b32 v61, v49, v35, s37
    v_perm_b32 v62, v49, v35, s38
    v_mfma_f32_16x16x32_bf16 v[228:231], a[88:91], a[232:235], v[228:231]
    s_barrier
    v_mfma_f32_16x16x32_bf16 v[228:231], a[24:27], a[84:87], v[228:231]
    ds_read_b32 a241, v61
    ds_read_b32 a242, v62
    v_mfma_f32_16x16x32_bf16 v[128:131], a[96:99], a[128:131], v[128:131]
    s_mov_b32 s73, 458752
    v_perm_b32 v63, v49, v35, s39
    v_perm_b32 v56, v110, v35, s36
    v_mfma_f32_16x16x32_bf16 v[128:131], a[0:3], a[168:171], v[128:131]
    ds_read_b32 a200, v56
    ds_read_b32 a243, v63
    v_mfma_f32_16x16x32_bf16 v[128:131], a[152:155], a[180:183], v[128:131]
    ds_read_b128 a[212:215], v44 offset:0
    v_perm_b32 v57, v110, v35, s37
    v_mfma_f32_16x16x32_bf16 v[128:131], a[4:7], a[184:187], v[128:131]
    s_mov_b32 s74, 473088
    ds_read_b128 a[228:231], v45 offset:0
    ds_read_b32 a201, v57
    v_mfma_f32_16x16x32_bf16 v[132:135], a[96:99], a[232:235], v[132:135]
    ds_read_b128 a[224:227], v46 offset:0
    v_perm_b32 v58, v110, v35, s38
    v_mfma_f32_16x16x32_bf16 v[132:135], a[0:3], a[84:87], v[132:135]
    s_waitcnt lgkmcnt(8)
    ds_read_b128 a[236:239], v47 offset:0
    ds_read_b32 a202, v58
    v_mfma_f32_16x16x32_bf16 v[132:135], a[152:155], a[204:207], v[132:135]
    s_mov_b32 s75, 573440
    v_perm_b32 v59, v122, v35, s36
    v_perm_b32 v60, v122, v35, s37
    v_mfma_f32_16x16x32_bf16 v[132:135], a[4:7], a[208:211], v[132:135]
    ds_read_b32 a252, v59
    v_perm_b32 v61, v110, v35, s39
    v_mfma_f32_16x16x32_bf16 v[160:163], a[56:59], a[128:131], v[160:163]
    ds_read_b32 a253, v60
    v_perm_b32 v62, v122, v35, s38
L_pad4:
    s_cbranch_execz L_pad5
    v_mfma_f32_16x16x32_bf16 v[160:163], a[44:47], a[168:171], v[160:163]
    s_mov_b32 s58, 587776
    ds_read_b32 a203, v61
    ds_read_b32 a254, v62
    v_mfma_f32_16x16x32_bf16 v[160:163], a[172:175], a[180:183], v[160:163]
    v_perm_b32 v56, v126, v35, s36
    v_perm_b32 v63, v122, v35, s39
    v_mfma_f32_16x16x32_bf16 v[160:163], a[220:223], a[184:187], v[160:163]
    ds_read_b32 a156, v56
    v_perm_b32 v57, v126, v35, s37
    v_mfma_f32_16x16x32_bf16 v[164:167], a[56:59], a[232:235], v[164:167]
    s_mov_b32 s48, 688128
    ds_read_b32 a255, v63
    v_perm_b32 v58, v126, v35, s38
    v_mfma_f32_16x16x32_bf16 v[164:167], a[44:47], a[84:87], v[164:167]
    ds_read_b32 a157, v57
    ds_read_b128 a[60:63], v44 offset:2048
    v_mfma_f32_16x16x32_bf16 v[164:167], a[172:175], a[204:207], v[164:167]
    ds_read_b32 a158, v58
    v_perm_b32 v59, v126, v35, s39
    v_mfma_f32_16x16x32_bf16 v[164:167], a[220:223], a[208:211], v[164:167]
    s_mov_b32 s49, 702464
    ds_read_b128 a[160:163], v45 offset:2048
    ds_read_b32 a159, v59
    v_mfma_f32_16x16x32_bf16 v[192:195], a[92:95], a[128:131], v[192:195]
    ds_read_b128 a[16:19], v46 offset:2048
    v_perm_b32 v60, v50, v35, s36
    v_mfma_f32_16x16x32_bf16 v[192:195], a[104:107], a[168:171], v[192:195]
    ds_read_b32 a176, v60
    v_perm_b32 v61, v50, v35, s37
    v_mfma_f32_16x16x32_bf16 v[192:195], a[116:119], a[180:183], v[192:195]
    s_mov_b32 s50, 802816
    ds_read_b128 a[248:251], v47 offset:2048
    ds_read_b32 a177, v61
    v_mfma_f32_16x16x32_bf16 v[192:195], a[100:103], a[184:187], v[192:195]
    v_perm_b32 v62, v50, v35, s38
    v_perm_b32 v56, v50, v35, s39
    v_mfma_f32_16x16x32_bf16 v[196:199], a[92:95], a[232:235], v[196:199]
    ds_read_b32 a178, v62
    ds_read_b128 a[136:139], v40 offset:36864
    v_mfma_f32_16x16x32_bf16 v[196:199], a[104:107], a[84:87], v[196:199]
    s_mov_b32 s51, 817152
    ds_read_b32 a179, v56
    v_lshlrev_b32 v52, 16, v98
    v_mfma_f32_16x16x32_bf16 v[196:199], a[116:119], a[204:207], v[196:199]
    ds_read_b128 a[188:191], v41 offset:36864
    v_and_b32 v53, 0xffff0000, v98
    v_mfma_f32_16x16x32_bf16 v[196:199], a[100:103], a[208:211], v[196:199]
    s_waitcnt lgkmcnt(10)
    v_lshlrev_b32 v64, 16, v92
    v_and_b32 v65, 0xffff0000, v93
    v_mfma_f32_16x16x32_bf16 v[224:227], a[68:71], a[212:215], v[224:227]
    v_lshlrev_b32 v66, 16, v95
    v_and_b32 v67, 0xffff0000, v96
    v_mfma_f32_16x16x32_bf16 v[224:227], a[120:123], a[228:231], v[224:227]
    ds_read_b128 a[52:55], v44 offset:4096
    v_and_b32 v112, 0xffff0000, v92
    v_mfma_f32_16x16x32_bf16 v[128:131], a[124:127], a[212:215], v[128:131]
    v_lshlrev_b32 v113, 16, v94
    v_and_b32 v114, 0xffff0000, v95
    v_mfma_f32_16x16x32_bf16 v[128:131], a[144:147], a[228:231], v[128:131]
    v_lshlrev_b32 v115, 16, v97
    v_lshlrev_b32 v116, 16, v93
    v_mfma_f32_16x16x32_bf16 v[128:131], a[108:111], a[224:227], v[128:131]
    ds_read_b128 a[20:23], v45 offset:4096
    v_and_b32 v117, 0xffff0000, v94
    v_mfma_f32_16x16x32_bf16 v[128:131], a[148:151], a[236:239], v[128:131]
    ds_write_b64 v29, v[226:227] offset:0
    v_lshlrev_b32 v118, 16, v96
    v_mfma_f32_16x16x32_bf16 v[160:163], a[196:199], a[212:215], v[160:163]
    v_and_b32 v119, 0xffff0000, v97
    v_mov_b32 v8, 1
    v_mfma_f32_16x16x32_bf16 v[160:163], a[76:79], a[228:231], v[160:163]
    v_min_u32 v9, 1, v0
    v_lshlrev_b32 v9, 30, v9
    v_mfma_f32_16x16x32_bf16 v[160:163], a[48:51], a[224:227], v[160:163]
    ds_read_b128 a[72:75], v42 offset:36864
    v_mfma_f32_16x16x32_bf16 v[160:163], a[240:243], a[236:239], v[160:163]
    buffer_atomic_add v8, v9, s[24:27], s77 offen sc0 sc1
    v_mfma_f32_16x16x32_bf16 v[192:195], a[200:203], a[212:215], v[192:195]
    s_waitcnt lgkmcnt(1)
    s_barrier
    v_mfma_f32_16x16x32_bf16 v[192:195], a[252:255], a[228:231], v[192:195]
    ds_read_b64 v[68:69], v30 offset:0
    ds_read_b128 a[32:35], v43 offset:36864
    v_mfma_f32_16x16x32_bf16 v[192:195], a[156:159], a[224:227], v[192:195]
    v_mul_f32 v128, v128, v64
    v_mul_f32 v129, v129, v65
    v_mfma_f32_16x16x32_bf16 v[192:195], a[176:179], a[236:239], v[192:195]
    v_mul_f32 v130, v130, v66
    v_mul_f32 v131, v131, v67
    v_mfma_f32_16x16x32_bf16 v[228:231], a[68:71], a[60:63], v[228:231]
    v_mul_f32 v160, v160, v112
    v_cvt_pk_bf16_f32 v80, v128, v160
    v_mfma_f32_16x16x32_bf16 v[228:231], a[120:123], a[160:163], v[228:231]
    ds_read_b128 a[12:15], v46 offset:4096
    v_mul_f32 v161, v161, v113
    v_mfma_f32_16x16x32_bf16 v[132:135], a[124:127], a[60:63], v[132:135]
    v_mul_f32 v162, v162, v114
    v_cvt_pk_bf16_f32 v83, v130, v162
    v_mfma_f32_16x16x32_bf16 v[132:135], a[144:147], a[160:163], v[132:135]
    v_mul_f32 v192, v192, v116
    v_mul_f32 v193, v193, v117
    v_mfma_f32_16x16x32_bf16 v[132:135], a[108:111], a[16:19], v[132:135]
    v_mul_f32 v194, v194, v118
    v_mul_f32 v195, v195, v119
    v_mfma_f32_16x16x32_bf16 v[132:135], a[148:151], a[248:251], v[132:135]
    v_cvt_pk_bf16_f32 v81, v192, v129
    v_mul_f32 v163, v163, v115
    v_mfma_f32_16x16x32_bf16 v[164:167], a[196:199], a[60:63], v[164:167]
    ds_write_b64 v26, v[80:81] offset:0
    v_cvt_pk_bf16_f32 v82, v161, v193
    v_mfma_f32_16x16x32_bf16 v[164:167], a[76:79], a[160:163], v[164:167]
    ds_write_b64 v26, v[82:83] offset:8
    v_cvt_pk_bf16_f32 v72, v194, v131
    v_mfma_f32_16x16x32_bf16 v[164:167], a[48:51], a[16:19], v[164:167]
    ds_write_b64 v29, v[230:231] offset:2048
    v_cvt_pk_bf16_f32 v73, v163, v195
    v_mfma_f32_16x16x32_bf16 v[164:167], a[240:243], a[248:251], v[164:167]
    s_waitcnt lgkmcnt(4)
    ds_read_b128 a[28:31], v47 offset:4096
    v_add_f32 v224, v224, v68
    v_mfma_f32_16x16x32_bf16 v[196:199], a[200:203], a[60:63], v[196:199]
    ds_write_b64 v26, v[72:73] offset:16
    v_mul_f32 v224, v224, v52
    v_mfma_f32_16x16x32_bf16 v[196:199], a[252:255], a[160:163], v[196:199]
    v_add_f32 v225, v225, v69
    v_mul_f32 v225, v225, v53
    v_mfma_f32_16x16x32_bf16 v[196:199], a[156:159], a[16:19], v[196:199]
    ds_read_b128 a[64:67], v40 offset:38912
    v_cvt_pk_bf16_f32 v68, v224, v225
    v_mfma_f32_16x16x32_bf16 v[196:199], a[176:179], a[248:251], v[196:199]
    ds_write_b32 v28, v68 offset:0
    v_mul_f32 v132, v132, v64
    v_mfma_f32_16x16x32_bf16 v[232:235], a[88:91], a[136:139], v[232:235]
    ds_read_b128 a[8:11], v41 offset:38912
    v_mul_f32 v133, v133, v65
    v_mfma_f32_16x16x32_bf16 v[232:235], a[24:27], a[188:191], v[232:235]
    v_mul_f32 v134, v134, v66
    v_mul_f32 v135, v135, v67
    v_mfma_f32_16x16x32_bf16 v[232:235], a[68:71], a[52:55], v[232:235]
    ds_read_b128 a[36:39], v44 offset:6144
    v_mul_f32 v164, v164, v112
    v_mfma_f32_16x16x32_bf16 v[232:235], a[120:123], a[20:23], v[232:235]
    v_cvt_pk_bf16_f32 v76, v132, v164
    v_mul_f32 v196, v196, v116
    v_mfma_f32_16x16x32_bf16 v[136:139], a[96:99], a[136:139], v[136:139]
    s_waitcnt lgkmcnt(2)
    s_barrier
    v_mfma_f32_16x16x32_bf16 v[136:139], a[0:3], a[188:191], v[136:139]
    ds_read_b128 v[84:87], v24 offset:0
    ds_read_b64 v[88:89], v30 offset:2048
    v_mfma_f32_16x16x32_bf16 v[136:139], a[152:155], a[72:75], v[136:139]
    ds_read_b128 v[100:103], v24 offset:928
    v_mul_f32 v197, v197, v117
    v_mfma_f32_16x16x32_bf16 v[136:139], a[4:7], a[32:35], v[136:139]
    v_mul_f32 v198, v198, v118
    v_mul_f32 v199, v199, v119
    v_mfma_f32_16x16x32_bf16 v[136:139], a[124:127], a[52:55], v[136:139]
    v_cvt_pk_bf16_f32 v77, v196, v133
    v_mul_f32 v165, v165, v113
    v_mfma_f32_16x16x32_bf16 v[136:139], a[144:147], a[20:23], v[136:139]
    ds_read_b128 a[40:43], v45 offset:6144
    v_mul_f32 v166, v166, v114
    v_mfma_f32_16x16x32_bf16 v[136:139], a[108:111], a[12:15], v[136:139]
    ds_write_b64 v26, v[76:77] offset:7424
    v_cvt_pk_bf16_f32 v79, v134, v166
    v_mfma_f32_16x16x32_bf16 v[136:139], a[148:151], a[28:31], v[136:139]
    s_waitcnt lgkmcnt(4)
    ds_write_b64 v29, v[234:235] offset:4096
    v_mfma_f32_16x16x32_bf16 v[168:171], a[56:59], a[136:139], v[168:171]
    buffer_store_dwordx4 v[84:87], v25, s[16:19], s64 offen sc1
    v_mfma_f32_16x16x32_bf16 v[168:171], a[44:47], a[188:191], v[168:171]
    ds_read_b128 a[112:115], v42 offset:38912
    v_mul_f32 v167, v167, v115
    v_mfma_f32_16x16x32_bf16 v[168:171], a[172:175], a[72:75], v[168:171]
    v_cvt_pk_bf16_f32 v78, v165, v197
    v_cvt_pk_bf16_f32 v104, v198, v135
    v_mfma_f32_16x16x32_bf16 v[168:171], a[220:223], a[32:35], v[168:171]
    s_waitcnt lgkmcnt(4)
    ds_write_b64 v26, v[78:79] offset:7432
    v_mfma_f32_16x16x32_bf16 v[168:171], a[196:199], a[52:55], v[168:171]
    buffer_store_dwordx4 v[100:103], v25, s[16:19], s65 offen sc1
    v_mfma_f32_16x16x32_bf16 v[168:171], a[76:79], a[20:23], v[168:171]
    ds_read_b128 a[140:143], v43 offset:38912
    v_cvt_pk_bf16_f32 v105, v167, v199
    v_mfma_f32_16x16x32_bf16 v[168:171], a[48:51], a[12:15], v[168:171]
    ds_write_b64 v26, v[104:105] offset:7440
    v_add_f32 v228, v228, v88
    v_mfma_f32_16x16x32_bf16 v[168:171], a[240:243], a[28:31], v[168:171]
    v_mul_f32 v228, v228, v52
    v_add_f32 v229, v229, v89
    v_mfma_f32_16x16x32_bf16 v[200:203], a[92:95], a[136:139], v[200:203]
    ds_read_b128 a[164:167], v46 offset:6144
    v_mul_f32 v229, v229, v53
    v_mfma_f32_16x16x32_bf16 v[200:203], a[104:107], a[188:191], v[200:203]
    v_cvt_pk_bf16_f32 v88, v228, v229
    v_mul_f32 v136, v136, v64
    v_mfma_f32_16x16x32_bf16 v[200:203], a[116:119], a[72:75], v[200:203]
    ds_write_b32 v28, v88 offset:7424
    v_mul_f32 v137, v137, v65
    v_mfma_f32_16x16x32_bf16 v[200:203], a[100:103], a[32:35], v[200:203]
    ds_read_b128 a[132:135], v47 offset:6144
    v_mul_f32 v138, v138, v66
    v_mfma_f32_16x16x32_bf16 v[200:203], a[200:203], a[52:55], v[200:203]
    ds_read_b128 a[216:219], v40 offset:40960
    v_mul_f32 v139, v139, v67
    v_mfma_f32_16x16x32_bf16 v[200:203], a[252:255], a[20:23], v[200:203]
    ds_read_b128 a[192:195], v41 offset:40960
    v_mul_f32 v168, v168, v112
    v_mfma_f32_16x16x32_bf16 v[200:203], a[156:159], a[12:15], v[200:203]
    v_cvt_pk_bf16_f32 v108, v136, v168
    v_mul_f32 v169, v169, v113
    v_mfma_f32_16x16x32_bf16 v[200:203], a[176:179], a[28:31], v[200:203]
    s_waitcnt lgkmcnt(3)
    s_barrier
    v_mfma_f32_16x16x32_bf16 v[236:239], a[88:91], a[64:67], v[236:239]
    ds_read_b128 v[120:123], v24 offset:7424
    ds_read_b64 v[124:125], v30 offset:4096
    v_mfma_f32_16x16x32_bf16 v[236:239], a[24:27], a[8:11], v[236:239]
    ds_read_b128 v[48:51], v24 offset:8352
    v_mul_f32 v170, v170, v114
    v_mfma_f32_16x16x32_bf16 v[236:239], a[68:71], a[36:39], v[236:239]
    v_cvt_pk_bf16_f32 v111, v138, v170
    v_mul_f32 v171, v171, v115
    v_mfma_f32_16x16x32_bf16 v[236:239], a[120:123], a[40:43], v[236:239]
    v_mul_f32 v200, v200, v116
    v_mul_f32 v201, v201, v117
    v_mfma_f32_16x16x32_bf16 v[140:143], a[96:99], a[64:67], v[140:143]
    v_mul_f32 v202, v202, v118
    v_mul_f32 v203, v203, v119
    v_mfma_f32_16x16x32_bf16 v[140:143], a[0:3], a[8:11], v[140:143]
    v_cvt_pk_bf16_f32 v109, v200, v137
    v_cvt_pk_bf16_f32 v110, v169, v201
    v_mfma_f32_16x16x32_bf16 v[140:143], a[152:155], a[112:115], v[140:143]
    s_waitcnt lgkmcnt(2)
    ds_read_b128 a[244:247], v44 offset:8192
    v_mfma_f32_16x16x32_bf16 v[140:143], a[4:7], a[140:143], v[140:143]
    buffer_store_dwordx4 v[120:123], v25, s[16:19], s66 offen sc1
    v_mfma_f32_16x16x32_bf16 v[140:143], a[124:127], a[36:39], v[140:143]
    s_waitcnt lgkmcnt(2)
    v_add_f32 v232, v232, v124
    v_mul_f32 v232, v232, v52
    v_mfma_f32_16x16x32_bf16 v[140:143], a[144:147], a[40:43], v[140:143]
    v_add_f32 v233, v233, v125
    v_mul_f32 v233, v233, v53
    v_mfma_f32_16x16x32_bf16 v[140:143], a[108:111], a[164:167], v[140:143]
    s_waitcnt lgkmcnt(1)
    ds_read_b128 a[80:83], v45 offset:8192
    v_mfma_f32_16x16x32_bf16 v[140:143], a[148:151], a[132:135], v[140:143]
    buffer_store_dwordx4 v[48:51], v25, s[16:19], s67 offen sc1
    v_mfma_f32_16x16x32_bf16 v[172:175], a[56:59], a[64:67], v[172:175]
    ds_write_b64 v26, v[108:109] offset:14848
    v_cvt_pk_bf16_f32 v124, v232, v233
    v_mfma_f32_16x16x32_bf16 v[172:175], a[44:47], a[8:11], v[172:175]
    ds_read_b128 a[128:131], v42 offset:40960
    v_cvt_pk_bf16_f32 v92, v202, v139
    v_mfma_f32_16x16x32_bf16 v[172:175], a[172:175], a[112:115], v[172:175]
    ds_write_b32 v28, v124 offset:14848
    v_cvt_pk_bf16_f32 v93, v171, v203
    v_mfma_f32_16x16x32_bf16 v[172:175], a[220:223], a[140:143], v[172:175]
    ds_write_b64 v26, v[110:111] offset:14856
    v_mul_f32 v140, v140, v64
    v_mfma_f32_16x16x32_bf16 v[172:175], a[196:199], a[36:39], v[172:175]
    ds_read_b128 a[168:171], v43 offset:40960
    v_mul_f32 v141, v141, v65
    v_mfma_f32_16x16x32_bf16 v[172:175], a[76:79], a[40:43], v[172:175]
    ds_write_b64 v26, v[92:93] offset:14864
    v_mul_f32 v142, v142, v66
    v_mfma_f32_16x16x32_bf16 v[172:175], a[48:51], a[164:167], v[172:175]
    ds_write_b64 v29, v[238:239] offset:0
    v_mul_f32 v143, v143, v67
    v_mfma_f32_16x16x32_bf16 v[172:175], a[240:243], a[132:135], v[172:175]
    ds_read_b128 a[180:183], v46 offset:8192
    v_mfma_f32_16x16x32_bf16 v[204:207], a[92:95], a[64:67], v[204:207]
    ds_read_b128 a[184:187], v47 offset:8192
    v_mfma_f32_16x16x32_bf16 v[204:207], a[104:107], a[8:11], v[204:207]
    v_mfma_f32_16x16x32_bf16 v[204:207], a[116:119], a[112:115], v[204:207]
    ds_read_b128 a[232:235], v40 offset:43008
    v_mfma_f32_16x16x32_bf16 v[204:207], a[100:103], a[140:143], v[204:207]
    s_waitcnt lgkmcnt(3)
    s_barrier
    v_mfma_f32_16x16x32_bf16 v[204:207], a[200:203], a[36:39], v[204:207]
    ds_read_b128 v[96:99], v24 offset:14848
    ds_read_b64 v[80:81], v30 offset:0
    v_mfma_f32_16x16x32_bf16 v[204:207], a[252:255], a[40:43], v[204:207]
    ds_read_b128 v[72:75], v24 offset:15776
    v_mul_f32 v172, v172, v112
    v_mfma_f32_16x16x32_bf16 v[204:207], a[156:159], a[164:167], v[204:207]
    ds_read_b128 a[84:87], v41 offset:43008
    v_cvt_pk_bf16_f32 v68, v140, v172
    v_mfma_f32_16x16x32_bf16 v[204:207], a[176:179], a[132:135], v[204:207]
    v_mul_f32 v173, v173, v113
    v_mul_f32 v174, v174, v114
    v_mfma_f32_16x16x32_bf16 v[240:243], a[88:91], a[216:219], v[240:243]
    v_cvt_pk_bf16_f32 v71, v142, v174
    v_mul_f32 v175, v175, v115
    v_mfma_f32_16x16x32_bf16 v[240:243], a[24:27], a[192:195], v[240:243]
    ds_read_b128 a[204:207], v44 offset:10240
    v_mfma_f32_16x16x32_bf16 v[240:243], a[68:71], a[244:247], v[240:243]
    s_waitcnt lgkmcnt(4)
    v_mfma_f32_16x16x32_bf16 v[240:243], a[120:123], a[80:83], v[240:243]
    buffer_store_dwordx4 v[96:99], v25, s[16:19], s68 offen sc1
    v_mfma_f32_16x16x32_bf16 v[144:147], a[96:99], a[216:219], v[144:147]
    s_waitcnt lgkmcnt(3)
    v_add_f32 v236, v236, v80
    v_mul_f32 v236, v236, v52
    v_mfma_f32_16x16x32_bf16 v[144:147], a[0:3], a[192:195], v[144:147]
    v_add_f32 v237, v237, v81
    v_mul_f32 v237, v237, v53
    v_mfma_f32_16x16x32_bf16 v[144:147], a[152:155], a[128:131], v[144:147]
    s_waitcnt lgkmcnt(2)
    ds_read_b128 a[208:211], v45 offset:10240
    v_mfma_f32_16x16x32_bf16 v[144:147], a[4:7], a[168:171], v[144:147]
    buffer_store_dwordx4 v[72:75], v25, s[16:19], s69 offen sc1
    v_mfma_f32_16x16x32_bf16 v[144:147], a[124:127], a[244:247], v[144:147]
    v_cvt_pk_bf16_f32 v80, v236, v237
    v_mul_f32 v204, v204, v116
    v_mfma_f32_16x16x32_bf16 v[144:147], a[144:147], a[80:83], v[144:147]
    ds_write_b32 v28, v80 offset:0
    v_mul_f32 v205, v205, v117
    v_mfma_f32_16x16x32_bf16 v[144:147], a[108:111], a[180:183], v[144:147]
    v_mul_f32 v206, v206, v118
    v_mul_f32 v207, v207, v119
    v_mfma_f32_16x16x32_bf16 v[144:147], a[148:151], a[184:187], v[144:147]
    v_cvt_pk_bf16_f32 v69, v204, v141
    v_cvt_pk_bf16_f32 v70, v173, v205
    v_mfma_f32_16x16x32_bf16 v[176:179], a[56:59], a[216:219], v[176:179]
    ds_write_b64 v26, v[68:69] offset:0
    v_cvt_pk_bf16_f32 v84, v206, v143
    v_mfma_f32_16x16x32_bf16 v[176:179], a[44:47], a[192:195], v[176:179]
    ds_read_b128 a[212:215], v42 offset:43008
    v_cvt_pk_bf16_f32 v85, v175, v207
    v_mfma_f32_16x16x32_bf16 v[176:179], a[172:175], a[128:131], v[176:179]
    ds_write_b64 v26, v[70:71] offset:8
    v_mfma_f32_16x16x32_bf16 v[176:179], a[220:223], a[168:171], v[176:179]
    ds_write_b64 v26, v[84:85] offset:16
    v_mul_f32 v144, v144, v64
    v_mfma_f32_16x16x32_bf16 v[176:179], a[196:199], a[244:247], v[176:179]
    ds_read_b128 a[228:231], v43 offset:43008
    v_mul_f32 v145, v145, v65
    v_mfma_f32_16x16x32_bf16 v[176:179], a[76:79], a[80:83], v[176:179]
    ds_write_b64 v29, v[242:243] offset:2048
    v_mul_f32 v146, v146, v66
    v_mfma_f32_16x16x32_bf16 v[176:179], a[48:51], a[180:183], v[176:179]
    ds_read_b128 a[224:227], v46 offset:10240
    v_mul_f32 v147, v147, v67
    v_mfma_f32_16x16x32_bf16 v[176:179], a[240:243], a[184:187], v[176:179]
    ds_read_b128 a[236:239], v47 offset:10240
    v_mfma_f32_16x16x32_bf16 v[208:211], a[92:95], a[216:219], v[208:211]
    v_mfma_f32_16x16x32_bf16 v[208:211], a[104:107], a[192:195], v[208:211]
    v_mfma_f32_16x16x32_bf16 v[208:211], a[116:119], a[128:131], v[208:211]
    s_waitcnt lgkmcnt(2)
    s_barrier
    v_mfma_f32_16x16x32_bf16 v[208:211], a[100:103], a[168:171], v[208:211]
    ds_read_b128 v[76:79], v24 offset:0
    ds_read_b64 v[100:101], v30 offset:2048
    v_mfma_f32_16x16x32_bf16 v[208:211], a[200:203], a[244:247], v[208:211]
    ds_read_b128 v[104:107], v24 offset:928
    v_mul_f32 v176, v176, v112
    v_mfma_f32_16x16x32_bf16 v[208:211], a[252:255], a[80:83], v[208:211]
    ds_read_b128 a[60:63], v40 offset:45056
    v_cvt_pk_bf16_f32 v88, v144, v176
    v_mfma_f32_16x16x32_bf16 v[208:211], a[156:159], a[180:183], v[208:211]
    ds_read_b128 a[160:163], v41 offset:45056
    v_mul_f32 v177, v177, v113
    v_mfma_f32_16x16x32_bf16 v[208:211], a[176:179], a[184:187], v[208:211]
    v_mul_f32 v178, v178, v114
    v_cvt_pk_bf16_f32 v91, v146, v178
    v_mfma_f32_16x16x32_bf16 v[244:247], a[88:91], a[232:235], v[244:247]
    v_mul_f32 v179, v179, v115
    v_mfma_f32_16x16x32_bf16 v[244:247], a[24:27], a[84:87], v[244:247]
    s_waitcnt lgkmcnt(4)
    ds_read_b128 a[16:19], v44 offset:12288
    v_mfma_f32_16x16x32_bf16 v[244:247], a[68:71], a[204:207], v[244:247]
    buffer_store_dwordx4 v[76:79], v25, s[16:19], s70 offen sc1
    v_mfma_f32_16x16x32_bf16 v[244:247], a[120:123], a[208:211], v[244:247]
    s_waitcnt lgkmcnt(4)
    v_add_f32 v240, v240, v100
    v_mul_f32 v240, v240, v52
    v_mfma_f32_16x16x32_bf16 v[148:151], a[96:99], a[232:235], v[148:151]
    v_add_f32 v241, v241, v101
    v_mul_f32 v241, v241, v53
    v_mfma_f32_16x16x32_bf16 v[148:151], a[0:3], a[84:87], v[148:151]
    s_waitcnt lgkmcnt(3)
    ds_read_b128 a[248:251], v45 offset:12288
    v_mfma_f32_16x16x32_bf16 v[148:151], a[152:155], a[212:215], v[148:151]
    buffer_store_dwordx4 v[104:107], v25, s[16:19], s71 offen sc1
    v_mfma_f32_16x16x32_bf16 v[148:151], a[4:7], a[228:231], v[148:151]
    v_cvt_pk_bf16_f32 v100, v240, v241
    v_mul_f32 v208, v208, v116
    v_mfma_f32_16x16x32_bf16 v[148:151], a[124:127], a[204:207], v[148:151]
    ds_write_b32 v28, v100 offset:7424
    v_mul_f32 v209, v209, v117
    v_mfma_f32_16x16x32_bf16 v[148:151], a[144:147], a[208:211], v[148:151]
    v_mul_f32 v210, v210, v118
    v_mul_f32 v211, v211, v119
    v_mfma_f32_16x16x32_bf16 v[148:151], a[108:111], a[224:227], v[148:151]
    v_cvt_pk_bf16_f32 v89, v208, v145
    v_cvt_pk_bf16_f32 v90, v177, v209
    v_mfma_f32_16x16x32_bf16 v[148:151], a[148:151], a[236:239], v[148:151]
    ds_write_b64 v26, v[88:89] offset:7424
    v_cvt_pk_bf16_f32 v120, v210, v147
    v_mfma_f32_16x16x32_bf16 v[180:183], a[56:59], a[232:235], v[180:183]
    ds_write_b64 v26, v[90:91] offset:7432
    v_cvt_pk_bf16_f32 v121, v179, v211
    v_mfma_f32_16x16x32_bf16 v[180:183], a[44:47], a[84:87], v[180:183]
    ds_read_b128 a[136:139], v42 offset:45056
    v_mfma_f32_16x16x32_bf16 v[180:183], a[172:175], a[212:215], v[180:183]
    ds_write_b64 v26, v[120:121] offset:7440
    v_mfma_f32_16x16x32_bf16 v[180:183], a[220:223], a[228:231], v[180:183]
    ds_write_b64 v29, v[246:247] offset:4096
    v_mul_f32 v148, v148, v64
    v_mfma_f32_16x16x32_bf16 v[180:183], a[196:199], a[204:207], v[180:183]
    ds_read_b128 a[188:191], v43 offset:45056
    v_mul_f32 v149, v149, v65
    v_mfma_f32_16x16x32_bf16 v[180:183], a[76:79], a[208:211], v[180:183]
    ds_read_b128 a[72:75], v46 offset:12288
    v_mul_f32 v150, v150, v66
    v_mfma_f32_16x16x32_bf16 v[180:183], a[48:51], a[224:227], v[180:183]
    ds_read_b128 a[32:35], v47 offset:12288
    v_mul_f32 v151, v151, v67
    v_mfma_f32_16x16x32_bf16 v[180:183], a[240:243], a[236:239], v[180:183]
    v_mfma_f32_16x16x32_bf16 v[212:215], a[92:95], a[232:235], v[212:215]
    s_waitcnt lgkmcnt(3)
    s_barrier
    v_mfma_f32_16x16x32_bf16 v[212:215], a[104:107], a[84:87], v[212:215]
    ds_read_b128 v[48:51], v24 offset:7424
    ds_read_b64 v[124:125], v30 offset:4096
    v_mfma_f32_16x16x32_bf16 v[212:215], a[116:119], a[212:215], v[212:215]
    ds_read_b128 v[108:111], v24 offset:8352
    v_mfma_f32_16x16x32_bf16 v[212:215], a[100:103], a[228:231], v[212:215]
    ds_read_b128 a[52:55], v40 offset:47104
    v_mul_f32 v180, v180, v112
    v_mfma_f32_16x16x32_bf16 v[212:215], a[200:203], a[204:207], v[212:215]
    v_cvt_pk_bf16_f32 v92, v148, v180
    v_mul_f32 v181, v181, v113
    v_mfma_f32_16x16x32_bf16 v[212:215], a[252:255], a[208:211], v[212:215]
    ds_read_b128 a[20:23], v41 offset:47104
    v_mul_f32 v182, v182, v114
    v_mfma_f32_16x16x32_bf16 v[212:215], a[156:159], a[224:227], v[212:215]
    v_cvt_pk_bf16_f32 v95, v150, v182
    v_mul_f32 v183, v183, v115
    v_mfma_f32_16x16x32_bf16 v[212:215], a[176:179], a[236:239], v[212:215]
    s_waitcnt lgkmcnt(4)
    v_mfma_f32_16x16x32_bf16 v[248:251], a[88:91], a[60:63], v[248:251]
    buffer_store_dwordx4 v[48:51], v25, s[16:19], s73 offen sc1
    v_mfma_f32_16x16x32_bf16 v[248:251], a[24:27], a[160:163], v[248:251]
    s_waitcnt lgkmcnt(3)
    v_add_f32 v244, v244, v124
    v_mul_f32 v244, v244, v52
    v_mfma_f32_16x16x32_bf16 v[248:251], a[68:71], a[16:19], v[248:251]
    v_add_f32 v245, v245, v125
    v_mul_f32 v245, v245, v53
    v_mfma_f32_16x16x32_bf16 v[248:251], a[120:123], a[248:251], v[248:251]
    s_waitcnt lgkmcnt(2)
    ds_read_b128 a[12:15], v44 offset:14336
    v_mfma_f32_16x16x32_bf16 v[152:155], a[96:99], a[60:63], v[152:155]
    buffer_store_dwordx4 v[108:111], v25, s[16:19], s74 offen sc1
    v_mfma_f32_16x16x32_bf16 v[152:155], a[0:3], a[160:163], v[152:155]
    v_cvt_pk_bf16_f32 v124, v244, v245
    v_mul_f32 v212, v212, v116
    v_mfma_f32_16x16x32_bf16 v[152:155], a[152:155], a[136:139], v[152:155]
    ds_write_b32 v28, v124 offset:14848
    v_mul_f32 v213, v213, v117
    v_mfma_f32_16x16x32_bf16 v[152:155], a[4:7], a[188:191], v[152:155]
    v_mul_f32 v214, v214, v118
    v_mul_f32 v215, v215, v119
    v_mfma_f32_16x16x32_bf16 v[152:155], a[124:127], a[16:19], v[152:155]
    v_cvt_pk_bf16_f32 v93, v212, v149
    v_cvt_pk_bf16_f32 v94, v181, v213
    v_mfma_f32_16x16x32_bf16 v[152:155], a[144:147], a[248:251], v[152:155]
    ds_read_b128 a[28:31], v45 offset:14336
    v_cvt_pk_bf16_f32 v96, v214, v151
    v_mfma_f32_16x16x32_bf16 v[152:155], a[108:111], a[72:75], v[152:155]
    ds_write_b64 v26, v[92:93] offset:14848
    v_cvt_pk_bf16_f32 v97, v183, v215
    v_mfma_f32_16x16x32_bf16 v[152:155], a[148:151], a[32:35], v[152:155]
    ds_write_b64 v26, v[94:95] offset:14856
    v_mfma_f32_16x16x32_bf16 v[184:187], a[56:59], a[60:63], v[184:187]
    ds_write_b64 v26, v[96:97] offset:14864
    v_mfma_f32_16x16x32_bf16 v[184:187], a[44:47], a[160:163], v[184:187]
    ds_read_b128 a[64:67], v42 offset:47104
    v_mfma_f32_16x16x32_bf16 v[184:187], a[172:175], a[136:139], v[184:187]
    ds_write_b64 v29, v[250:251] offset:0
    v_mfma_f32_16x16x32_bf16 v[184:187], a[220:223], a[188:191], v[184:187]
    ds_read_b128 a[8:11], v43 offset:47104
    v_mul_f32 v152, v152, v64
    v_mfma_f32_16x16x32_bf16 v[184:187], a[196:199], a[16:19], v[184:187]
    ds_read_b128 a[112:115], v46 offset:14336
    v_mul_f32 v153, v153, v65
    v_mfma_f32_16x16x32_bf16 v[184:187], a[76:79], a[248:251], v[184:187]
    v_mul_f32 v154, v154, v66
    v_mul_f32 v155, v155, v67
    v_mfma_f32_16x16x32_bf16 v[184:187], a[48:51], a[72:75], v[184:187]
    ds_read_b128 a[140:143], v47 offset:14336
    v_mfma_f32_16x16x32_bf16 v[184:187], a[240:243], a[32:35], v[184:187]
    s_waitcnt lgkmcnt(3)
    s_barrier
    v_mfma_f32_16x16x32_bf16 v[216:219], a[92:95], a[60:63], v[216:219]
    ds_read_b128 v[72:75], v24 offset:14848
    ds_read_b64 v[80:81], v30 offset:0
    v_mfma_f32_16x16x32_bf16 v[216:219], a[104:107], a[160:163], v[216:219]
    ds_read_b128 v[68:71], v24 offset:15776
    v_mfma_f32_16x16x32_bf16 v[216:219], a[116:119], a[136:139], v[216:219]
    v_mfma_f32_16x16x32_bf16 v[216:219], a[100:103], a[188:191], v[216:219]
    v_mul_f32 v184, v184, v112
    v_cvt_pk_bf16_f32 v84, v152, v184
    v_mfma_f32_16x16x32_bf16 v[216:219], a[200:203], a[16:19], v[216:219]
    v_mul_f32 v185, v185, v113
    v_mul_f32 v186, v186, v114
    v_mfma_f32_16x16x32_bf16 v[216:219], a[252:255], a[248:251], v[216:219]
    v_cvt_pk_bf16_f32 v87, v154, v186
    v_mul_f32 v187, v187, v115
    v_mfma_f32_16x16x32_bf16 v[216:219], a[156:159], a[72:75], v[216:219]
    s_waitcnt lgkmcnt(2)
    v_mfma_f32_16x16x32_bf16 v[216:219], a[176:179], a[32:35], v[216:219]
    buffer_store_dwordx4 v[72:75], v25, s[16:19], s75 offen sc1
    v_mfma_f32_16x16x32_bf16 v[252:255], a[88:91], a[52:55], v[252:255]
    s_waitcnt lgkmcnt(1)
    v_add_f32 v248, v248, v80
    v_mul_f32 v248, v248, v52
    v_mfma_f32_16x16x32_bf16 v[252:255], a[24:27], a[20:23], v[252:255]
    v_add_f32 v249, v249, v81
    v_mul_f32 v249, v249, v53
    v_mfma_f32_16x16x32_bf16 v[252:255], a[68:71], a[12:15], v[252:255]
    s_waitcnt lgkmcnt(0)
    v_cvt_pk_bf16_f32 v80, v248, v249
    v_mfma_f32_16x16x32_bf16 v[252:255], a[120:123], a[28:31], v[252:255]
    buffer_store_dwordx4 v[68:71], v25, s[16:19], s58 offen sc1
    v_mfma_f32_16x16x32_bf16 v[156:159], a[96:99], a[52:55], v[156:159]
    ds_write_b32 v28, v80 offset:0
    v_mul_f32 v216, v216, v116
    v_mfma_f32_16x16x32_bf16 v[156:159], a[0:3], a[20:23], v[156:159]
    v_mul_f32 v217, v217, v117
    v_mul_f32 v218, v218, v118
    v_mfma_f32_16x16x32_bf16 v[156:159], a[152:155], a[64:67], v[156:159]
    v_mul_f32 v219, v219, v119
    v_cvt_pk_bf16_f32 v85, v216, v153
    v_mfma_f32_16x16x32_bf16 v[156:159], a[4:7], a[8:11], v[156:159]
    ds_write_b64 v26, v[84:85] offset:0
    v_cvt_pk_bf16_f32 v86, v185, v217
    v_mfma_f32_16x16x32_bf16 v[156:159], a[124:127], a[12:15], v[156:159]
    ds_write_b64 v26, v[86:87] offset:8
    v_cvt_pk_bf16_f32 v76, v218, v155
    v_mfma_f32_16x16x32_bf16 v[156:159], a[144:147], a[28:31], v[156:159]
    ds_write_b64 v29, v[254:255] offset:2048
    v_cvt_pk_bf16_f32 v77, v187, v219
    v_mfma_f32_16x16x32_bf16 v[156:159], a[108:111], a[112:115], v[156:159]
    s_waitcnt vmcnt(12)
    ds_write_b64 v26, v[76:77] offset:16
    v_xor_b32 v8, 15, v8
    v_mfma_f32_16x16x32_bf16 v[156:159], a[148:151], a[140:143], v[156:159]
    v_or_b32 v8, v8, v0
    v_min_u32 v8, 1, v8
    v_mfma_f32_16x16x32_bf16 v[188:191], a[56:59], a[52:55], v[188:191]
    v_lshlrev_b32 v8, 30, v8
    v_mov_b32 v9, s76
    v_mfma_f32_16x16x32_bf16 v[188:191], a[44:47], a[20:23], v[188:191]
    v_mfma_f32_16x16x32_bf16 v[188:191], a[172:175], a[64:67], v[188:191]
    buffer_store_dword v9, v8, s[12:15], s78 offen sc1
    v_mfma_f32_16x16x32_bf16 v[188:191], a[220:223], a[8:11], v[188:191]
    s_waitcnt lgkmcnt(0)
    s_barrier
    v_mfma_f32_16x16x32_bf16 v[188:191], a[196:199], a[12:15], v[188:191]
    ds_read_b128 v[104:107], v24 offset:0
    ds_read_b64 v[100:101], v30 offset:2048
    v_mfma_f32_16x16x32_bf16 v[188:191], a[76:79], a[28:31], v[188:191]
    ds_read_b128 v[88:91], v24 offset:928
    v_mul_f32 v156, v156, v64
    v_mfma_f32_16x16x32_bf16 v[188:191], a[48:51], a[112:115], v[188:191]
    v_mul_f32 v157, v157, v65
    v_mul_f32 v158, v158, v66
    v_mfma_f32_16x16x32_bf16 v[188:191], a[240:243], a[140:143], v[188:191]
    v_mul_f32 v159, v159, v67
    v_mfma_f32_16x16x32_bf16 v[220:223], a[92:95], a[52:55], v[220:223]
    v_mfma_f32_16x16x32_bf16 v[220:223], a[104:107], a[20:23], v[220:223]
    v_mfma_f32_16x16x32_bf16 v[220:223], a[116:119], a[64:67], v[220:223]
    s_waitcnt lgkmcnt(2)
    v_mfma_f32_16x16x32_bf16 v[220:223], a[100:103], a[8:11], v[220:223]
    buffer_store_dwordx4 v[104:107], v25, s[16:19], s48 offen sc1
    v_mfma_f32_16x16x32_bf16 v[220:223], a[200:203], a[12:15], v[220:223]
    s_waitcnt lgkmcnt(1)
    v_add_f32 v252, v252, v100
    v_mul_f32 v252, v252, v52
    v_mfma_f32_16x16x32_bf16 v[220:223], a[252:255], a[28:31], v[220:223]
    v_add_f32 v253, v253, v101
    v_mul_f32 v253, v253, v53
    v_mfma_f32_16x16x32_bf16 v[220:223], a[156:159], a[112:115], v[220:223]
    s_waitcnt lgkmcnt(0)
    v_cvt_pk_bf16_f32 v100, v252, v253
    v_mfma_f32_16x16x32_bf16 v[220:223], a[176:179], a[140:143], v[220:223]
    buffer_store_dwordx4 v[88:91], v25, s[16:19], s49 offen sc1
    ds_write_b32 v28, v100 offset:7424
    v_mul_f32 v188, v188, v112
    v_cvt_pk_bf16_f32 v120, v156, v188
    v_mul_f32 v189, v189, v113
    v_mul_f32 v190, v190, v114
    v_cvt_pk_bf16_f32 v123, v158, v190
    v_mul_f32 v191, v191, v115
    v_mul_f32 v220, v220, v116
L_pad5:
    s_cbranch_execz L_warmed
    v_mul_f32 v221, v221, v117
    v_mul_f32 v222, v222, v118
    v_mul_f32 v223, v223, v119
    v_cvt_pk_bf16_f32 v121, v220, v157
    v_cvt_pk_bf16_f32 v122, v189, v221
    v_cvt_pk_bf16_f32 v48, v222, v159
    v_cvt_pk_bf16_f32 v49, v191, v223
    ds_write_b64 v26, v[120:121] offset:7424
    ds_write_b64 v26, v[122:123] offset:7432
    ds_write_b64 v26, v[48:49] offset:7440
    s_waitcnt lgkmcnt(0)
    s_barrier
    ds_read_b128 v[108:111], v24 offset:7424
    ds_read_b128 v[124:127], v24 offset:8352
    s_waitcnt lgkmcnt(1)
    buffer_store_dwordx4 v[108:111], v25, s[16:19], s50 offen sc1
    s_waitcnt lgkmcnt(0)
    buffer_store_dwordx4 v[124:127], v25, s[16:19], s51 offen sc1
L_end:
    s_endpgm
L_slow1_0:
    s_mov_b32 s22, 1
    s_call_b64 s[20:21], L_tick
    s_mov_b32 s22, 20480
    s_mov_b32 s23, 25600
    buffer_load_dwordx4 v[84:87], v32, s[12:15], s22 offen sc1
    buffer_load_dwordx4 v[88:91], v32, s[12:15], s23 offen sc1
    s_waitcnt vmcnt(0)
    v_bitop3_b32 v87, v87, v91, s76 bitop3:0x7e
    v_cmp_ne_u32 vcc, 0, v87
    s_cbranch_vccnz L_slow1_0
    s_branch L_back1_0
L_slow1_2:
    s_mov_b32 s22, 1
    s_call_b64 s[20:21], L_tick
    s_mov_b32 s22, 20480
    s_mov_b32 s23, 25600
    buffer_load_dwordx2 v[100:101], v34, s[12:15], s22 offen sc1
    buffer_load_dwordx2 v[102:103], v34, s[12:15], s23 offen sc1
    s_waitcnt vmcnt(0)
    v_bitop3_b32 v101, v101, v103, s76 bitop3:0x7e
    v_cmp_ne_u32 vcc, 0, v101
    s_cbranch_vccnz L_slow1_2
    s_branch L_back1_2
L_slow1_1:
    s_mov_b32 s22, 1
    s_call_b64 s[20:21], L_tick
    s_mov_b32 s22, 20480
    s_mov_b32 s23, 25600
    buffer_load_dwordx4 v[112:115], v33, s[12:15], s22 offen sc1
    buffer_load_dwordx4 v[116:119], v33, s[12:15], s23 offen sc1
    s_waitcnt vmcnt(0)
    v_bitop3_b32 v115, v115, v119, s76 bitop3:0x7e
    v_cmp_ne_u32 vcc, 0, v115
    s_cbranch_vccnz L_slow1_1
    s_branch L_back1_1
L_slow2_0:
    s_mov_b32 s22, 2
    s_call_b64 s[20:21], L_tick
    s_mov_b32 s22, 40960
    s_mov_b32 s23, 46080
    buffer_load_dwordx4 v[68:71], v32, s[12:15], s22 offen sc1
    buffer_load_dwordx4 v[80:83], v32, s[12:15], s23 offen sc1
    s_waitcnt vmcnt(0)
    v_bitop3_b32 v71, v71, v83, s76 bitop3:0x7e
    v_cmp_ne_u32 vcc, 0, v71
    s_cbranch_vccnz L_slow2_0
    s_branch L_back2_0
L_slow2_2:
    s_mov_b32 s22, 2
    s_call_b64 s[20:21], L_tick
    s_mov_b32 s22, 40960
    s_mov_b32 s23, 46080
    buffer_load_dwordx2 v[72:73], v34, s[12:15], s22 offen sc1
    buffer_load_dwordx2 v[74:75], v34, s[12:15], s23 offen sc1
    s_waitcnt vmcnt(0)
    v_bitop3_b32 v73, v73, v75, s76 bitop3:0x7e
    v_cmp_ne_u32 vcc, 0, v73
    s_cbranch_vccnz L_slow2_2
    s_branch L_back2_2
L_slow2_1:
    s_mov_b32 s22, 2
    s_call_b64 s[20:21], L_tick
    s_mov_b32 s22, 40960
    s_mov_b32 s23, 46080
    buffer_load_dwordx4 v[76:79], v33, s[12:15], s22 offen sc1
    buffer_load_dwordx4 v[84:87], v33, s[12:15], s23 offen sc1
    s_waitcnt vmcnt(0)
    v_bitop3_b32 v79, v79, v87, s76 bitop3:0x7e
    v_cmp_ne_u32 vcc, 0, v79
    s_cbranch_vccnz L_slow2_1
    s_branch L_back2_1
L_slow3_0:
    s_mov_b32 s22, 3
    s_call_b64 s[20:21], L_tick
    s_mov_b32 s22, 61440
    s_mov_b32 s23, 66560
    buffer_load_dwordx4 v[88:91], v32, s[12:15], s22 offen sc1
    buffer_load_dwordx4 v[100:103], v32, s[12:15], s23 offen sc1
    s_waitcnt vmcnt(0)
    v_bitop3_b32 v91, v91, v103, s76 bitop3:0x7e
    v_cmp_ne_u32 vcc, 0, v91
    s_cbranch_vccnz L_slow3_0
    s_branch L_back3_0
L_slow3_2:
    s_mov_b32 s22, 3
    s_call_b64 s[20:21], L_tick
    s_mov_b32 s22, 61440
    s_mov_b32 s23, 66560
    buffer_load_dwordx2 v[92:93], v34, s[12:15], s22 offen sc1
    buffer_load_dwordx2 v[94:95], v34, s[12:15], s23 offen sc1
    s_waitcnt vmcnt(0)
    v_bitop3_b32 v93, v93, v95, s76 bitop3:0x7e
    v_cmp_ne_u32 vcc, 0, v93
    s_cbranch_vccnz L_slow3_2
    s_branch L_back3_2
L_slow3_1:
    s_mov_b32 s22, 3
    s_call_b64 s[20:21], L_tick
    s_mov_b32 s22, 61440
    s_mov_b32 s23, 66560
    buffer_load_dwordx4 v[96:99], v33, s[12:15], s22 offen sc1
    buffer_load_dwordx4 v[104:107], v33, s[12:15], s23 offen sc1
    s_waitcnt vmcnt(0)
    v_bitop3_b32 v99, v99, v107, s76 bitop3:0x7e
    v_cmp_ne_u32 vcc, 0, v99
    s_cbranch_vccnz L_slow3_1
    s_branch L_back3_1
L_slow4_0:
    s_mov_b32 s22, 4
    s_call_b64 s[20:21], L_tick
    s_mov_b32 s22, 81920
    s_mov_b32 s23, 87040
    buffer_load_dwordx4 v[108:111], v32, s[12:15], s22 offen sc1
    buffer_load_dwordx4 v[120:123], v32, s[12:15], s23 offen sc1
    s_waitcnt vmcnt(0)
    v_bitop3_b32 v111, v111, v123, s76 bitop3:0x7e
    v_cmp_ne_u32 vcc, 0, v111
    s_cbranch_vccnz L_slow4_0
    s_branch L_back4_0
L_slow4_2:
    s_mov_b32 s22, 4
    s_call_b64 s[20:21], L_tick
    s_mov_b32 s22, 81920
    s_mov_b32 s23, 87040
    buffer_load_dwordx2 v[124:125], v34, s[12:15], s22 offen sc1
    buffer_load_dwordx2 v[126:127], v34, s[12:15], s23 offen sc1
    s_waitcnt vmcnt(0)
    v_bitop3_b32 v125, v125, v127, s76 bitop3:0x7e
    v_cmp_ne_u32 vcc, 0, v125
    s_cbranch_vccnz L_slow4_2
    s_branch L_back4_2
L_slow4_1:
    s_mov_b32 s22, 4
    s_call_b64 s[20:21], L_tick
    s_mov_b32 s22, 81920
    s_mov_b32 s23, 87040
    buffer_load_dwordx4 v[48:51], v33, s[12:15], s22 offen sc1
    buffer_load_dwordx4 v[52:55], v33, s[12:15], s23 offen sc1
    s_waitcnt vmcnt(0)
    v_bitop3_b32 v51, v51, v55, s76 bitop3:0x7e
    v_cmp_ne_u32 vcc, 0, v51
    s_cbranch_vccnz L_slow4_1
    s_branch L_back4_1
L_slow5_0:
    s_mov_b32 s22, 5
    s_call_b64 s[20:21], L_tick
    s_mov_b32 s22, 102400
    s_mov_b32 s23, 107520
    buffer_load_dwordx4 v[64:67], v32, s[12:15], s22 offen sc1
    buffer_load_dwordx4 v[112:115], v32, s[12:15], s23 offen sc1
    s_waitcnt vmcnt(0)
    v_bitop3_b32 v67, v67, v115, s76 bitop3:0x7e
    v_cmp_ne_u32 vcc, 0, v67
    s_cbranch_vccnz L_slow5_0
    s_branch L_back5_0
L_slow5_2:
    s_mov_b32 s22, 5
    s_call_b64 s[20:21], L_tick
    s_mov_b32 s22, 102400
    s_mov_b32 s23, 107520
    buffer_load_dwordx2 v[116:117], v34, s[12:15], s22 offen sc1
    buffer_load_dwordx2 v[118:119], v34, s[12:15], s23 offen sc1
    s_waitcnt vmcnt(0)
    v_bitop3_b32 v117, v117, v119, s76 bitop3:0x7e
    v_cmp_ne_u32 vcc, 0, v117
    s_cbranch_vccnz L_slow5_2
    s_branch L_back5_2
L_slow5_1:
    s_mov_b32 s22, 5
    s_call_b64 s[20:21], L_tick
    s_mov_b32 s22, 102400
    s_mov_b32 s23, 107520
    buffer_load_dwordx4 v[68:71], v33, s[12:15], s22 offen sc1
    buffer_load_dwordx4 v[80:83], v33, s[12:15], s23 offen sc1
    s_waitcnt vmcnt(0)
    v_bitop3_b32 v71, v71, v83, s76 bitop3:0x7e
    v_cmp_ne_u32 vcc, 0, v71
    s_cbranch_vccnz L_slow5_1
    s_branch L_back5_1
L_slow6_2:
    s_mov_b32 s22, 6
    s_call_b64 s[20:21], L_tick
    s_mov_b32 s22, 122880
    s_mov_b32 s23, 128000
    buffer_load_dwordx2 v[72:73], v34, s[12:15], s22 offen sc1
    buffer_load_dwordx2 v[74:75], v34, s[12:15], s23 offen sc1
    s_waitcnt vmcnt(0)
    v_bitop3_b32 v73, v73, v75, s76 bitop3:0x7e
    v_cmp_ne_u32 vcc, 0, v73
    s_cbranch_vccnz L_slow6_2
    s_branch L_back6_2
L_slow6_0:
    s_mov_b32 s22, 6
    s_call_b64 s[20:21], L_tick
    s_mov_b32 s22, 122880
    s_mov_b32 s23, 128000
    buffer_load_dwordx4 v[76:79], v32, s[12:15], s22 offen sc1
    buffer_load_dwordx4 v[84:87], v32, s[12:15], s23 offen sc1
    s_waitcnt vmcnt(0)
    v_bitop3_b32 v79, v79, v87, s76 bitop3:0x7e
    v_cmp_ne_u32 vcc, 0, v79
    s_cbranch_vccnz L_slow6_0
    s_branch L_back6_0
L_slow6_1:
    s_mov_b32 s22, 6
    s_call_b64 s[20:21], L_tick
    s_mov_b32 s22, 122880
    s_mov_b32 s23, 128000
    buffer_load_dwordx4 v[88:91], v33, s[12:15], s22 offen sc1
    buffer_load_dwordx4 v[100:103], v33, s[12:15], s23 offen sc1
    s_waitcnt vmcnt(0)
    v_bitop3_b32 v91, v91, v103, s76 bitop3:0x7e
    v_cmp_ne_u32 vcc, 0, v91
    s_cbranch_vccnz L_slow6_1
    s_branch L_back6_1
L_slow7_2:
    s_mov_b32 s22, 7
    s_call_b64 s[20:21], L_tick
    s_mov_b32 s22, 143360
    s_mov_b32 s23, 148480
    buffer_load_dwordx2 v[104:105], v34, s[12:15], s22 offen sc1
    buffer_load_dwordx2 v[106:107], v34, s[12:15], s23 offen sc1
    s_waitcnt vmcnt(0)
    v_bitop3_b32 v105, v105, v107, s76 bitop3:0x7e
    v_cmp_ne_u32 vcc, 0, v105
    s_cbranch_vccnz L_slow7_2
    s_branch L_back7_2
L_slow7_0:
    s_mov_b32 s22, 7
    s_call_b64 s[20:21], L_tick
    s_mov_b32 s22, 143360
    s_mov_b32 s23, 148480
    buffer_load_dwordx4 v[108:111], v32, s[12:15], s22 offen sc1
    buffer_load_dwordx4 v[120:123], v32, s[12:15], s23 offen sc1
    s_waitcnt vmcnt(0)
    v_bitop3_b32 v111, v111, v123, s76 bitop3:0x7e
    v_cmp_ne_u32 vcc, 0, v111
    s_cbranch_vccnz L_slow7_0
    s_branch L_back7_0
L_slow7_1:
    s_mov_b32 s22, 7
    s_call_b64 s[20:21], L_tick
    s_mov_b32 s22, 143360
    s_mov_b32 s23, 148480
    buffer_load_dwordx4 v[124:127], v33, s[12:15], s22 offen sc1
    buffer_load_dwordx4 v[48:51], v33, s[12:15], s23 offen sc1
    s_waitcnt vmcnt(0)
    v_bitop3_b32 v127, v127, v51, s76 bitop3:0x7e
    v_cmp_ne_u32 vcc, 0, v127
    s_cbranch_vccnz L_slow7_1
    s_branch L_back7_1
L_tick:
    s_add_u32 s52, s52, 1
    s_and_b32 s23, s52, 4095
    s_cbranch_scc1 L_tick_ret
L_help:
    s_mov_b32 s53, s61
    s_mov_b32 s54, s62
    s_mov_b32 s72, s6
    s_mov_b32 s6, 14680064
    s_mul_i32 s61, s22, 1835008
    s_add_u32 s61, s61, s79
    s_mul_i32 s62, s22, 20480
    s_mul_i32 s23, s59, 163840
    s_add_u32 s62, s62, s23
    s_mov_b32 s22, 0
L_help_row:
    buffer_load_dwordx4 v[12:15], v19, s[4:7], s61 offen
    buffer_load_dwordx3 v[8:10], v18, s[4:7], s61 offen
    s_waitcnt vmcnt(0)
    v_lshlrev_b32 v12, v5, v12
    v_lshlrev_b32 v13, v5, v13
    v_lshlrev_b32 v14, v5, v14
    v_lshlrev_b32 v15, v5, v15
    v_permlane32_swap_b32 v12, v13
    s_nop 0
    v_permlane32_swap_b32 v14, v15
    v_or_b32 v12, v12, v13
    v_or_b32 v14, v14, v15
    v_mov_b32 v13, s76
    s_nop 0
    v_permlane16_swap_b32 v12, v14
    v_or_b32 v12, v12, v14
    s_nop 1
    v_or_b32_dpp v12, v12, v12 row_ror:8 row_mask:0xf bank_mask:0xf
    buffer_store_dwordx2 v[12:13], v21, s[12:15], s62 offen sc1
    v_mov_b32 v11, s76
    s_mov_b32 s23, 4
L_help_e:
    s_add_u32 s61, s61, 14336
    buffer_load_dwordx3 v[12:14], v18, s[4:7], s61 offen
    s_waitcnt vmcnt(0)
    v_lshl_or_b32 v8, v12, s23, v8
    v_lshl_or_b32 v9, v13, s23, v9
    v_lshl_or_b32 v10, v14, s23, v10
    s_add_u32 s23, s23, 4
    s_cmp_lt_u32 s23, 32
    s_cbranch_scc1 L_help_e
    buffer_store_dwordx4 v[8:11], v20, s[12:15], s62 offen sc1
    s_add_u32 s61, s61, 14336
    s_add_u32 s62, s62, 1280
    s_waitcnt vmcnt(0)
    s_add_u32 s22, s22, 1
    s_cmp_lt_u32 s22, 16
    s_cbranch_scc1 L_help_row
    s_mov_b32 s61, s53
    s_mov_b32 s62, s54
    s_mov_b32 s6, s72
L_tick_ret:
    s_setpc_b64 s[20:21]
L_code_end:

.section .rodata,"a"
.p2align 6
.amdhsa_kernel standalone__normalfloat_lut_af4__prompt_kernel
  .amdhsa_next_free_vgpr 512
  .amdhsa_next_free_sgpr 102
  .amdhsa_accum_offset 256
  .amdhsa_group_segment_fixed_size 0
  .amdhsa_kernarg_size 56
  .amdhsa_user_sgpr_count 2
  .amdhsa_user_sgpr_kernarg_segment_ptr 1
  .amdhsa_system_sgpr_workgroup_id_x 1
.end_amdhsa_kernel
```

```asm
; @launch grid=(256,1,1) block=(256,1,1) lds=163840
.amdgcn_target "amdgcn-amd-amdhsa--gfx950"
.text
.globl standalone__normalfloat_lut_af4__prompt_kernel
.p2align 8
.type standalone__normalfloat_lut_af4__prompt_kernel,@function
standalone__normalfloat_lut_af4__prompt_kernel:
    s_cmp_ge_u32 s2, 256
    s_cbranch_scc1 L_end
    s_load_dwordx2 s[4:5], s[0:1], 8
    s_load_dwordx2 s[12:13], s[0:1], 48
    s_load_dwordx2 s[8:9], s[0:1], 0
    s_load_dwordx2 s[28:29], s[0:1], 16
    s_getpc_b64 s[48:49]
    s_mov_b32 s50, L_code_end-standalone__normalfloat_lut_af4__prompt_kernel-256
    s_mov_b32 s51, 0x20000
    s_lshr_b32 s61, s2, 3
    v_lshl_add_u32 v10, v0, 5, s61
    v_lshlrev_b32 v10, 7, v10
    buffer_load_dword v1, v10, s[48:51], 0 offen offset:256
    v_lshrrev_b32 v5, 6, v0
    v_and_b32 v2, 63, v0
    s_and_b32 s60, s2, 7
    v_readfirstlane_b32 s63, v5
    s_and_b32 s58, s60, 1
    s_lshl_b32 s58, s58, 3
    s_and_b32 s62, s61, 7
    s_add_u32 s58, s58, s62
    s_lshr_b32 s59, s60, 1
    s_lshl_b32 s59, s59, 2
    s_lshr_b32 s62, s61, 3
    s_add_u32 s59, s59, s62
    v_mul_u32_u24 v18, 12, v2
    v_lshrrev_b32 v6, 3, v2
    v_and_b32 v7, 7, v2
    v_mul_u32_u24 v19, 14336, v6
    v_lshl_add_u32 v19, v7, 4, v19
    v_add_u32 v19, 768, v19
    s_lshl_b32 s60, s63, 4
    s_add_u32 s60, s60, s58
    s_mul_i32 s61, s60, 114688
    s_mul_i32 s79, s59, 896
    s_add_u32 s61, s61, s79
    s_mov_b32 s6, 14680064
    s_mov_b32 s7, 0x20000
    s_lshl_b32 s78, s59, 7
    s_add_u32 s78, s78, 2621440
    v_and_b32 v4, 15, v2
    v_lshrrev_b32 v3, 4, v2
    s_mov_b32 s46, 2
    s_cmp_lg_u32 s63, 0
    s_cbranch_scc1 L_role0
    s_mov_b32 s46, 0
L_role0:
    s_cmp_lg_u32 s63, 1
    s_cbranch_scc1 L_role1
    s_mov_b32 s46, 1
L_role1:
    v_lshlrev_b32 v16, 1, v4
    v_lshrrev_b32 v17, 4, v0
    v_lshlrev_b32 v17, 1, v17
    s_mov_b32 s30, 32
    s_mov_b32 s31, 0x20000
    v_xor_b32 v13, v7, v3
    s_lshl_b32 s70, s63, 5
    v_add_lshl_u32 v12, v6, s70, 11
    v_lshl_add_u32 v36, v13, 4, v12
    v_xor_b32 v37, 64, v36
    v_add_u32 v38, 30720, v36
    v_add_u32 v37, 15360, v37
    v_add_u32 v39, 30720, v37
    s_mov_b32 s10, 4194304
    s_mov_b32 s11, 0x20000
    s_lshl_b32 s55, s58, 18
    s_lshl_b32 s57, s63, 12
    s_add_u32 s57, s57, 65536
    s_mov_b32 s14, 2623488
    s_mov_b32 s15, 0x20000
    s_mul_i32 s68, s59, 163840
    s_mul_i32 s62, s60, 1280
    s_add_u32 s62, s62, s68
    v_lshlrev_b32 v5, 2, v6
    v_lshlrev_b32 v20, 4, v2
    v_and_b32 v12, 1, v6
    v_lshlrev_b32 v12, 30, v12
    v_and_b32 v13, 4, v7
    v_mad_u32_u24 v21, v13, 3, v7
    v_lshl_add_u32 v21, v3, 2, v21
    v_lshl_add_u32 v21, v21, 3, v12
    v_add_u32 v21, 1024, v21
    s_waitcnt lgkmcnt(0)
    s_load_dword s76, s[12:13], s78
    s_cmp_eq_u32 s46, 1
    s_cbranch_scc1 L_L
    s_cmp_eq_u32 s46, 2
    s_cbranch_scc1 L_L
L_X:
    buffer_load_dwordx4 v[160:163], v19, s[4:7], s61 offen
    buffer_load_dwordx3 v[128:130], v18, s[4:7], s61 offen
    s_add_u32 s61, s61, 14336
    buffer_load_dwordx3 v[132:134], v18, s[4:7], s61 offen
    s_add_u32 s61, s61, 14336
    buffer_load_dwordx3 v[136:138], v18, s[4:7], s61 offen
    s_add_u32 s61, s61, 14336
    buffer_load_dwordx3 v[140:142], v18, s[4:7], s61 offen
    s_add_u32 s61, s61, 14336
    buffer_load_dwordx3 v[144:146], v18, s[4:7], s61 offen
    s_add_u32 s61, s61, 14336
    buffer_load_dwordx3 v[148:150], v18, s[4:7], s61 offen
    s_add_u32 s61, s61, 14336
    buffer_load_dwordx3 v[152:154], v18, s[4:7], s61 offen
    s_add_u32 s61, s61, 14336
    buffer_load_dwordx3 v[156:158], v18, s[4:7], s61 offen
    s_add_u32 s61, s61, 7239680
    s_cmp_eq_u32 s46, 1
    s_cbranch_scc1 L_D
    s_cmp_eq_u32 s46, 2
    s_cbranch_scc1 L_B
L_L:
    buffer_load_ushort v16, v16, s[28:31], 0 offen
    buffer_load_ushort v17, v17, s[28:31], 0 offen
    s_cmp_eq_u32 s46, 1
    s_cbranch_scc1 L_S
    s_cmp_eq_u32 s46, 2
    s_cbranch_scc1 L_S
L_D:
    s_add_u32 m0, s57, 32768
    s_add_u32 s56, s55, 0
    buffer_load_dwordx4 v36, s[8:11], s56 offen offset:0 lds
    buffer_load_dwordx4 v37, s[8:11], s56 offen offset:1024 lds
    buffer_load_dwordx4 v38, s[8:11], s56 offen offset:2048 lds
    buffer_load_dwordx4 v39, s[8:11], s56 offen offset:3072 lds
    s_add_u32 m0, s57, 49152
    s_add_u32 s3, s55, 128
    buffer_load_dwordx4 v36, s[8:11], s3 offen offset:0 lds
    buffer_load_dwordx4 v37, s[8:11], s3 offen offset:1024 lds
    buffer_load_dwordx4 v38, s[8:11], s3 offen offset:2048 lds
    buffer_load_dwordx4 v39, s[8:11], s3 offen offset:3072 lds
    s_cmp_eq_u32 s46, 1
    s_cbranch_scc1 L_G
    s_cmp_eq_u32 s46, 2
    s_cbranch_scc1 L_G
L_S:
    s_load_dwordx2 s[32:33], s[0:1], 24
    s_load_dwordx2 s[16:17], s[0:1], 32
    s_load_dwordx2 s[24:25], s[0:1], 40
    s_and_b32 s64, s63, 1
    s_lshr_b32 s65, s63, 1
    s_mul_i32 s69, s64, 10240
    v_mul_u32_u24 v12, 1280, v3
    s_lshl_b32 s70, s63, 8
    s_add_u32 s70, s70, s68
    v_lshl_add_u32 v33, v4, 4, v12
    s_add_u32 s71, s70, s69
    v_add_u32 v32, s71, v33
    s_sub_u32 s71, 10240, s69
    s_add_u32 s71, s71, s70
    v_add_u32 v33, s71, v33
    v_and_b32 v13, 1, v4
    v_lshlrev_b32 v13, 6, v13
    s_lshl_b32 s70, s64, 1
    v_xor_b32 v31, s70, v4
    v_and_b32 v31, 2, v31
    v_lshl_add_u32 v13, v31, 4, v13
    v_lshrrev_b32 v31, 2, v4
    v_lshl_add_u32 v13, v31, 3, v13
    s_lshl_b32 s70, s65, 7
    s_add_u32 s70, s70, s68
    s_add_u32 s70, s70, s69
    s_add_u32 s70, s70, 1024
    v_add3_u32 v34, v12, v13, s70
    s_mov_b32 s36, 202114048
    s_mov_b32 s37, 202114304
    s_mov_b32 s38, 202114560
    s_mov_b32 s39, 202114816
    v_and_b32 v35, 31, v2
    v_lshlrev_b32 v35, 2, v35
    v_lshrrev_b32 v12, 1, v4
    v_xor_b32 v12, v12, v3
    v_lshlrev_b32 v12, 4, v12
    v_lshl_add_u32 v12, v4, 7, v12
    s_lshl_b32 s70, s64, 14
    s_add_u32 s72, s70, 65536
    s_sub_u32 s73, 81920, s70
    v_add_u32 v40, s72, v12
    v_add_u32 v42, s73, v12
    v_xor_b32 v41, 64, v40
    v_xor_b32 v43, 64, v42
    v_add_u32 v44, 65536, v40
    v_add_u32 v45, 65536, v41
    v_add_u32 v46, 65536, v42
    v_add_u32 v47, 65536, v43
    s_mov_b32 s52, 0
    s_mov_b32 s40, 0
    s_mov_b32 s41, 5120
    v_lshlrev_b32 v8, 4, v7
    v_lshl_add_u32 v8, v0, 8, v8
    v_xor_b32 v9, 16, v8
    v_xor_b32 v10, 32, v8
    v_xor_b32 v11, 48, v8
    v_xor_b32 v12, 64, v8
    v_xor_b32 v13, 80, v8
    v_xor_b32 v14, 96, v8
    v_xor_b32 v15, 112, v8
    s_cmp_eq_u32 s46, 1
    s_cbranch_scc1 L_X
    s_cmp_eq_u32 s46, 2
    s_cbranch_scc1 L_D
L_G:
    s_waitcnt lgkmcnt(0)
    s_add_u32 s76, s76, 2654435769
    s_cmp_eq_u32 s46, 1
    s_cbranch_scc1 L_T
    s_cmp_eq_u32 s46, 2
    s_cbranch_scc1 L_T
L_K:
    s_waitcnt vmcnt(18)
    v_lshlrev_b32 v160, v5, v160
    v_lshlrev_b32 v161, v5, v161
    v_lshlrev_b32 v162, v5, v162
    v_lshlrev_b32 v163, v5, v163
    v_mov_b32 v131, s76
    v_permlane32_swap_b32 v160, v161
    v_permlane32_swap_b32 v162, v163
    v_or_b32 v160, v160, v161
    v_or_b32 v162, v162, v163
    v_mov_b32 v161, s76
    s_waitcnt vmcnt(16)
    v_lshl_or_b32 v128, v132, 4, v128
    v_permlane16_swap_b32 v160, v162
    v_or_b32 v160, v160, v162
    v_lshl_or_b32 v129, v133, 4, v129
    v_lshl_or_b32 v130, v134, 4, v130
    v_or_b32_dpp v160, v160, v160 row_ror:8 row_mask:0xf bank_mask:0xf
    buffer_store_dwordx2 v[160:161], v21, s[12:15], s62 offen sc1
    s_waitcnt vmcnt(16)
    v_lshl_or_b32 v128, v136, 8, v128
    v_lshl_or_b32 v129, v137, 8, v129
    v_lshl_or_b32 v130, v138, 8, v130
    s_waitcnt vmcnt(15)
    v_lshl_or_b32 v128, v140, 12, v128
    v_lshl_or_b32 v129, v141, 12, v129
    v_lshl_or_b32 v130, v142, 12, v130
    s_waitcnt vmcnt(14)
    v_lshl_or_b32 v128, v144, 16, v128
    v_lshl_or_b32 v129, v145, 16, v129
    v_lshl_or_b32 v130, v146, 16, v130
    s_waitcnt vmcnt(13)
    v_lshl_or_b32 v128, v148, 20, v128
    v_lshl_or_b32 v129, v149, 20, v129
    v_lshl_or_b32 v130, v150, 20, v130
    s_waitcnt vmcnt(12)
    v_lshl_or_b32 v128, v152, 24, v128
    v_lshl_or_b32 v129, v153, 24, v129
    v_lshl_or_b32 v130, v154, 24, v130
    s_waitcnt vmcnt(11)
    v_lshl_or_b32 v128, v156, 28, v128
    v_lshl_or_b32 v129, v157, 28, v129
    v_lshl_or_b32 v130, v158, 28, v130
    buffer_store_dwordx4 v[128:131], v20, s[12:15], s62 offen sc1
    s_add_u32 s62, s62, 81920
    s_cmp_eq_u32 s46, 1
    s_cbranch_scc1 L_B
    s_cmp_eq_u32 s46, 2
    s_cbranch_scc1 L_E
L_T:
    s_waitcnt vmcnt(17)
    s_cmp_eq_u32 s46, 1
    s_cbranch_scc1 L_rw1
    s_waitcnt vmcnt(10)
    s_cmp_eq_u32 s46, 0
    s_cbranch_scc1 L_rw1
    s_waitcnt vmcnt(8)
L_rw1:
    v_lshl_or_b32 v56, v17, 16, v16
    v_lshl_or_b32 v57, v17, 16, v16
    v_lshl_or_b32 v58, v17, 16, v16
    v_lshl_or_b32 v59, v17, 16, v16
    ds_write_b128 v8, v[56:59]
    ds_write_b128 v9, v[56:59]
    ds_write_b128 v10, v[56:59]
    ds_write_b128 v11, v[56:59]
    ds_write_b128 v12, v[56:59]
    ds_write_b128 v13, v[56:59]
    ds_write_b128 v14, v[56:59]
    ds_write_b128 v15, v[56:59]
    s_cmp_lg_u32 s46, 1
    s_cbranch_scc1 L_ed2
    s_waitcnt vmcnt(8)
    s_branch L_K
L_ed2:
    s_cmp_eq_u32 s46, 2
    s_cbranch_scc1 L_X
L_W:
    s_mov_b64 exec, 0
    s_cmp_eq_u32 s63, 0
    s_cbranch_scc1 L_pad0
L_warmed:
    s_mov_b64 exec, -1
L_B:
    s_waitcnt vmcnt(9) lgkmcnt(0)
    s_cmp_eq_u32 s46, 2
    s_cbranch_scc1 L_rw3
    s_waitcnt vmcnt(2)
L_rw3:
    s_barrier
L_Q:
    ds_read_b128 a[0:3], v40 offset:32768
    ds_read_b128 a[4:7], v41 offset:32768
    ds_read_b128 a[8:11], v40 offset:34816
    ds_read_b128 a[12:15], v41 offset:34816
    ds_read_b128 a[16:19], v40 offset:36864
    ds_read_b128 a[20:23], v41 offset:36864
    ds_read_b128 a[24:27], v40 offset:38912
    ds_read_b128 a[28:31], v41 offset:38912
    ds_read_b128 a[36:39], v40 offset:40960
    ds_read_b128 a[40:43], v41 offset:40960
    ds_read_b128 a[44:47], v40 offset:43008
    ds_read_b128 a[52:55], v41 offset:43008
    ds_read_b128 a[56:59], v40 offset:45056
    ds_read_b128 a[64:67], v41 offset:45056
    ds_read_b128 a[68:71], v40 offset:47104
    ds_read_b128 a[72:75], v41 offset:47104
L_P:
    buffer_load_dwordx4 v[64:67], v32, s[12:15], s40 offen sc1
    buffer_load_dwordx4 v[68:71], v32, s[12:15], s41 offen sc1
    buffer_load_dwordx2 v[72:73], v34, s[12:15], s40 offen sc1
    buffer_load_dwordx2 v[74:75], v34, s[12:15], s41 offen sc1
    buffer_load_dwordx4 v[76:79], v33, s[12:15], s40 offen sc1
    buffer_load_dwordx4 v[80:83], v33, s[12:15], s41 offen sc1
    s_cmp_lg_u32 s46, 2
    s_cbranch_scc1 L_ed4
    s_waitcnt vmcnt(6)
    s_branch L_K
L_ed4:
L_E:
    s_add_u32 m0, s57, 65536
    s_add_u32 s56, s55, 256
    buffer_load_dwordx4 v36, s[8:11], s56 offen offset:0 lds
    buffer_load_dwordx4 v37, s[8:11], s56 offen offset:1024 lds
    buffer_load_dwordx4 v38, s[8:11], s56 offen offset:2048 lds
    buffer_load_dwordx4 v39, s[8:11], s56 offen offset:3072 lds
L_chk0:
    s_waitcnt vmcnt(10)
    s_cmp_eq_u32 s46, 2
    s_cbranch_scc1 L_rw5
    s_waitcnt vmcnt(8)
L_rw5:
    v_bitop3_b32 v67, v67, v71, s76 bitop3:0x7e
    v_cmp_ne_u32 vcc, 0, v67
    s_cbranch_vccnz L_retry0
    v_perm_b32 v56, v64, v35, s36
    v_perm_b32 v57, v64, v35, s37
    v_perm_b32 v58, v64, v35, s38
    v_perm_b32 v59, v64, v35, s39
    v_perm_b32 v60, v68, v35, s36
    v_perm_b32 v61, v68, v35, s37
    v_perm_b32 v62, v68, v35, s38
    v_perm_b32 v63, v68, v35, s39
    ds_read_b32 a32, v56
    ds_read_b32 a33, v57
    ds_read_b32 a34, v58
    ds_read_b32 a35, v59
    ds_read_b32 a48, v60
    ds_read_b32 a49, v61
    ds_read_b32 a50, v62
    ds_read_b32 a51, v63
    v_perm_b32 v56, v65, v35, s36
    v_perm_b32 v57, v65, v35, s37
    v_perm_b32 v58, v65, v35, s38
    v_perm_b32 v59, v65, v35, s39
    v_perm_b32 v60, v69, v35, s36
    v_perm_b32 v61, v69, v35, s37
    ds_read_b32 a60, v56
    ds_read_b32 a61, v57
    ds_read_b32 a62, v58
    ds_read_b32 a63, v59
    s_waitcnt vmcnt(6)
    s_cmp_eq_u32 s46, 2
    s_cbranch_scc1 L_rw6
    s_waitcnt vmcnt(4)
L_rw6:
    v_bitop3_b32 v79, v79, v83, s76 bitop3:0x7e
    v_bitop3_b32 v73, v73, v75, s76 bitop3:0x7e
    v_or_b32 v79, v79, v73
    v_cmp_ne_u32 vcc, 0, v79
    s_cbranch_vccz L_main
L_retry0:
    s_add_u32 s52, s52, 1
    s_and_b32 s23, s52, 4095
    s_cbranch_scc1 L_retry0b
    s_mov_b32 s22, 0
    s_call_b64 s[20:21], L_help
L_retry0b:
    buffer_load_dwordx4 v[64:67], v32, s[12:15], s40 offen sc1
    buffer_load_dwordx4 v[68:71], v32, s[12:15], s41 offen sc1
    buffer_load_dwordx2 v[72:73], v34, s[12:15], s40 offen sc1
    buffer_load_dwordx2 v[74:75], v34, s[12:15], s41 offen sc1
    buffer_load_dwordx4 v[76:79], v33, s[12:15], s40 offen sc1
    buffer_load_dwordx4 v[80:83], v33, s[12:15], s41 offen sc1
    s_waitcnt vmcnt(0) lgkmcnt(0)
    s_branch L_chk0
.p2align 12
L_main:
L_pad0:
    s_cbranch_execz L_pad1
    s_waitcnt lgkmcnt(8)
    v_mfma_f32_16x16x32_bf16 v[128:131], a[32:35], a[0:3], 0
    s_waitcnt lgkmcnt(4)
    s_add_u32 m0, s57, 81920
    ds_read_b32 a76, v60
    v_mfma_f32_16x16x32_bf16 v[128:131], a[48:51], a[4:7], v[128:131]
    s_add_u32 s3, s55, 384
    ds_read_b32 a77, v61
    ds_read_b128 a[80:83], v42 offset:32768
    v_mfma_f32_16x16x32_bf16 v[132:135], a[32:35], a[8:11], 0
    buffer_load_dwordx4 v[84:87], v19, s[4:7], s61 offen
    v_mfma_f32_16x16x32_bf16 v[132:135], a[48:51], a[12:15], v[132:135]
    s_mov_b32 s40, 20480
    v_perm_b32 v62, v69, v35, s38
    v_perm_b32 v63, v69, v35, s39
    v_mfma_f32_16x16x32_bf16 v[136:139], a[32:35], a[16:19], 0
    s_mov_b32 s41, 25600
    ds_read_b32 a78, v62
    v_perm_b32 v56, v66, v35, s36
    v_mfma_f32_16x16x32_bf16 v[136:139], a[48:51], a[20:23], v[136:139]
    ds_read_b32 a79, v63
    ds_read_b128 a[84:87], v43 offset:32768
    v_mfma_f32_16x16x32_bf16 v[140:143], a[32:35], a[24:27], 0
    buffer_load_dwordx4 v36, s[8:11], s3 offen offset:0 lds
    v_mfma_f32_16x16x32_bf16 v[140:143], a[48:51], a[28:31], v[140:143]
    ds_read_b32 a88, v56
    v_perm_b32 v57, v66, v35, s37
    v_mfma_f32_16x16x32_bf16 v[144:147], a[32:35], a[36:39], 0
    ds_read_b32 a89, v57
    v_perm_b32 v58, v66, v35, s38
    v_mfma_f32_16x16x32_bf16 v[144:147], a[48:51], a[40:43], v[144:147]
    ds_read_b32 a90, v58
    ds_read_b128 a[92:95], v42 offset:34816
    v_mfma_f32_16x16x32_bf16 v[148:151], a[32:35], a[44:47], 0
    buffer_load_dwordx4 v37, s[8:11], s3 offen offset:1024 lds
    v_mfma_f32_16x16x32_bf16 v[148:151], a[48:51], a[52:55], v[148:151]
    ds_read_b128 a[96:99], v43 offset:34816
    v_perm_b32 v59, v66, v35, s39
    v_mfma_f32_16x16x32_bf16 v[152:155], a[32:35], a[56:59], 0
    ds_read_b32 a91, v59
    v_perm_b32 v60, v70, v35, s36
    v_mfma_f32_16x16x32_bf16 v[152:155], a[48:51], a[64:67], v[152:155]
    s_waitcnt lgkmcnt(8)
    ds_read_b32 a104, v60
    ds_read_b128 a[100:103], v42 offset:36864
    v_mfma_f32_16x16x32_bf16 v[156:159], a[32:35], a[68:71], 0
    buffer_load_dwordx4 v[88:91], v32, s[12:15], s40 offen sc1
    v_mfma_f32_16x16x32_bf16 v[156:159], a[48:51], a[72:75], v[156:159]
    s_mov_b32 s42, 20480
    v_perm_b32 v61, v70, v35, s37
    v_perm_b32 v62, v70, v35, s38
    v_mfma_f32_16x16x32_bf16 v[160:163], a[60:63], a[0:3], 0
    s_waitcnt lgkmcnt(7)
    ds_read_b32 a105, v61
    v_perm_b32 v63, v70, v35, s39
    v_mfma_f32_16x16x32_bf16 v[160:163], a[76:79], a[4:7], v[160:163]
    ds_read_b32 a106, v62
    ds_read_b32 a107, v63
    v_mfma_f32_16x16x32_bf16 v[164:167], a[60:63], a[8:11], 0
    buffer_load_dwordx4 v[92:95], v32, s[12:15], s41 offen sc1
    v_mfma_f32_16x16x32_bf16 v[164:167], a[76:79], a[12:15], v[164:167]
    s_mov_b32 s43, 25600
    ds_read_b128 a[108:111], v43 offset:36864
    v_perm_b32 v56, v72, v35, s36
    v_mfma_f32_16x16x32_bf16 v[168:171], a[60:63], a[16:19], 0
    ds_read_b32 a112, v56
    v_perm_b32 v57, v72, v35, s37
    v_mfma_f32_16x16x32_bf16 v[168:171], a[76:79], a[20:23], v[168:171]
    ds_read_b32 a113, v57
    ds_read_b128 a[116:119], v42 offset:38912
    v_mfma_f32_16x16x32_bf16 v[172:175], a[60:63], a[24:27], 0
    buffer_load_dwordx4 v38, s[8:11], s3 offen offset:2048 lds
    v_mfma_f32_16x16x32_bf16 v[172:175], a[76:79], a[28:31], v[172:175]
    ds_read_b128 a[120:123], v43 offset:38912
    v_perm_b32 v58, v72, v35, s38
    v_mfma_f32_16x16x32_bf16 v[176:179], a[60:63], a[36:39], 0
    ds_read_b32 a114, v58
    v_perm_b32 v59, v72, v35, s39
    v_mfma_f32_16x16x32_bf16 v[176:179], a[76:79], a[40:43], v[176:179]
    ds_read_b32 a115, v59
    ds_read_b128 a[124:127], v42 offset:40960
    v_mfma_f32_16x16x32_bf16 v[180:183], a[60:63], a[44:47], 0
    buffer_load_dwordx4 v39, s[8:11], s3 offen offset:3072 lds
    v_mfma_f32_16x16x32_bf16 v[180:183], a[76:79], a[52:55], v[180:183]
    v_perm_b32 v60, v74, v35, s36
    v_perm_b32 v61, v74, v35, s37
    v_mfma_f32_16x16x32_bf16 v[184:187], a[60:63], a[56:59], 0
    s_mov_b32 s44, 20480
    ds_read_b32 a128, v60
    v_perm_b32 v62, v74, v35, s38
    v_mfma_f32_16x16x32_bf16 v[184:187], a[76:79], a[64:67], v[184:187]
    s_waitcnt lgkmcnt(7)
    ds_read_b32 a129, v61
    ds_read_b32 a130, v62
    v_mfma_f32_16x16x32_bf16 v[188:191], a[60:63], a[68:71], 0
    buffer_load_dwordx2 v[96:97], v34, s[12:15], s42 offen sc1
    v_mfma_f32_16x16x32_bf16 v[188:191], a[76:79], a[72:75], v[188:191]
    s_mov_b32 s45, 25600
    ds_read_b128 a[132:135], v43 offset:40960
    v_perm_b32 v63, v74, v35, s39
    v_mfma_f32_16x16x32_bf16 v[192:195], a[88:91], a[0:3], 0
    ds_read_b32 a131, v63
    v_perm_b32 v56, v76, v35, s36
    v_mfma_f32_16x16x32_bf16 v[192:195], a[104:107], a[4:7], v[192:195]
    ds_read_b32 a140, v56
    ds_read_b128 a[136:139], v42 offset:43008
    v_mfma_f32_16x16x32_bf16 v[196:199], a[88:91], a[8:11], 0
    buffer_load_dwordx2 v[98:99], v34, s[12:15], s43 offen sc1
    v_mfma_f32_16x16x32_bf16 v[196:199], a[104:107], a[12:15], v[196:199]
    ds_read_b128 a[144:147], v43 offset:43008
    v_perm_b32 v57, v76, v35, s37
    v_mfma_f32_16x16x32_bf16 v[200:203], a[88:91], a[16:19], 0
    ds_read_b32 a141, v57
    v_perm_b32 v58, v76, v35, s38
    v_mfma_f32_16x16x32_bf16 v[200:203], a[104:107], a[20:23], v[200:203]
    ds_read_b32 a142, v58
    ds_read_b128 a[148:151], v42 offset:45056
    v_mfma_f32_16x16x32_bf16 v[204:207], a[88:91], a[24:27], 0
    buffer_load_dwordx3 v[100:102], v18, s[4:7], s61 offen
    v_mfma_f32_16x16x32_bf16 v[204:207], a[104:107], a[28:31], v[204:207]
    s_add_u32 s61, s61, 14336
    v_perm_b32 v59, v76, v35, s39
    v_perm_b32 v60, v80, v35, s36
    v_mfma_f32_16x16x32_bf16 v[208:211], a[88:91], a[36:39], 0
    ds_read_b32 a143, v59
    v_perm_b32 v61, v80, v35, s37
    v_mfma_f32_16x16x32_bf16 v[208:211], a[104:107], a[40:43], v[208:211]
    ds_read_b32 a152, v60
    ds_read_b32 a153, v61
    v_mfma_f32_16x16x32_bf16 v[212:215], a[88:91], a[44:47], 0
    buffer_load_dwordx4 v[104:107], v33, s[12:15], s44 offen sc1
    v_mfma_f32_16x16x32_bf16 v[212:215], a[104:107], a[52:55], v[212:215]
    ds_read_b128 a[156:159], v43 offset:45056
    v_perm_b32 v62, v80, v35, s38
    v_mfma_f32_16x16x32_bf16 v[216:219], a[88:91], a[56:59], 0
    ds_read_b32 a154, v62
    v_perm_b32 v63, v80, v35, s39
    v_mfma_f32_16x16x32_bf16 v[216:219], a[104:107], a[64:67], v[216:219]
    s_waitcnt lgkmcnt(7)
    ds_read_b32 a155, v63
    ds_read_b128 a[160:163], v42 offset:47104
    v_mfma_f32_16x16x32_bf16 v[220:223], a[88:91], a[68:71], 0
    buffer_load_dwordx3 v[108:110], v18, s[4:7], s61 offen
    v_mfma_f32_16x16x32_bf16 v[220:223], a[104:107], a[72:75], v[220:223]
    s_add_u32 s61, s61, 14336
    ds_read_b128 a[164:167], v43 offset:47104
    v_perm_b32 v56, v77, v35, s36
    v_mfma_f32_16x16x32_bf16 v[224:227], a[112:115], a[0:3], 0
    s_add_u32 s56, s55, 512
    v_perm_b32 v57, v77, v35, s37
    v_perm_b32 v58, v77, v35, s38
    v_mfma_f32_16x16x32_bf16 v[224:227], a[128:131], a[4:7], v[224:227]
    s_add_u32 m0, s57, 0
    ds_read_b32 a168, v56
    ds_read_b32 a169, v57
    v_mfma_f32_16x16x32_bf16 v[228:231], a[112:115], a[8:11], 0
    buffer_load_dwordx4 v[112:115], v33, s[12:15], s45 offen sc1
    v_mfma_f32_16x16x32_bf16 v[228:231], a[128:131], a[12:15], v[228:231]
    ds_read_b32 a170, v58
    v_perm_b32 v59, v77, v35, s39
    v_mfma_f32_16x16x32_bf16 v[232:235], a[112:115], a[16:19], 0
    v_perm_b32 v60, v81, v35, s36
    v_perm_b32 v61, v81, v35, s37
    v_mfma_f32_16x16x32_bf16 v[232:235], a[128:131], a[20:23], v[232:235]
    ds_read_b32 a171, v59
    ds_read_b32 a172, v60
    v_mfma_f32_16x16x32_bf16 v[236:239], a[112:115], a[24:27], 0
    buffer_load_dwordx3 v[116:118], v18, s[4:7], s61 offen
    v_mfma_f32_16x16x32_bf16 v[236:239], a[128:131], a[28:31], v[236:239]
    s_add_u32 s61, s61, 14336
    ds_read_b32 a173, v61
    v_perm_b32 v62, v81, v35, s38
    v_mfma_f32_16x16x32_bf16 v[240:243], a[112:115], a[36:39], 0
    v_perm_b32 v63, v81, v35, s39
    v_perm_b32 v56, v78, v35, s36
    v_mfma_f32_16x16x32_bf16 v[240:243], a[128:131], a[40:43], v[240:243]
    ds_read_b32 a174, v62
    ds_read_b32 a175, v63
    v_mfma_f32_16x16x32_bf16 v[244:247], a[112:115], a[44:47], 0
    buffer_load_dwordx3 v[120:122], v18, s[4:7], s61 offen
    v_mfma_f32_16x16x32_bf16 v[244:247], a[128:131], a[52:55], v[244:247]
    s_add_u32 s61, s61, 14336
    ds_read_b32 a176, v56
    v_perm_b32 v57, v78, v35, s37
    v_mfma_f32_16x16x32_bf16 v[248:251], a[112:115], a[56:59], 0
    v_perm_b32 v58, v78, v35, s38
    v_perm_b32 v59, v78, v35, s39
    v_mfma_f32_16x16x32_bf16 v[248:251], a[128:131], a[64:67], v[248:251]
    s_waitcnt lgkmcnt(6)
    ds_read_b32 a177, v57
    ds_read_b32 a178, v58
    v_mfma_f32_16x16x32_bf16 v[252:255], a[112:115], a[68:71], 0
    buffer_load_dwordx3 v[124:126], v18, s[4:7], s61 offen
    v_mfma_f32_16x16x32_bf16 v[252:255], a[128:131], a[72:75], v[252:255]
    s_add_u32 s61, s61, 14336
    ds_read_b32 a179, v59
    v_perm_b32 v60, v82, v35, s36
    v_mfma_f32_16x16x32_bf16 v[128:131], a[140:143], a[80:83], v[128:131]
    ds_read_b32 a180, v60
    v_perm_b32 v61, v82, v35, s37
    v_mfma_f32_16x16x32_bf16 v[128:131], a[152:155], a[84:87], v[128:131]
    ds_read_b32 a181, v61
    v_mfma_f32_16x16x32_bf16 v[132:135], a[140:143], a[92:95], v[132:135]
    buffer_load_dwordx3 v[48:50], v18, s[4:7], s61 offen
    v_mfma_f32_16x16x32_bf16 v[132:135], a[152:155], a[96:99], v[132:135]
    s_add_u32 s61, s61, 14336
    v_perm_b32 v62, v82, v35, s38
    v_perm_b32 v63, v82, v35, s39
    v_mfma_f32_16x16x32_bf16 v[136:139], a[140:143], a[100:103], v[136:139]
    ds_read_b32 a182, v62
    ds_read_b32 a183, v63
    v_mfma_f32_16x16x32_bf16 v[136:139], a[152:155], a[108:111], v[136:139]
    v_mfma_f32_16x16x32_bf16 v[140:143], a[140:143], a[116:119], v[140:143]
    buffer_load_dwordx3 v[52:54], v18, s[4:7], s61 offen
    v_mfma_f32_16x16x32_bf16 v[140:143], a[152:155], a[120:123], v[140:143]
    s_add_u32 s61, s61, 14336
    v_mfma_f32_16x16x32_bf16 v[144:147], a[140:143], a[124:127], v[144:147]
    v_mfma_f32_16x16x32_bf16 v[144:147], a[152:155], a[132:135], v[144:147]
    v_mfma_f32_16x16x32_bf16 v[148:151], a[140:143], a[136:139], v[148:151]
    buffer_load_dwordx3 v[64:66], v18, s[4:7], s61 offen
    v_mfma_f32_16x16x32_bf16 v[148:151], a[152:155], a[144:147], v[148:151]
    v_mfma_f32_16x16x32_bf16 v[152:155], a[140:143], a[148:151], v[152:155]
    v_mfma_f32_16x16x32_bf16 v[152:155], a[152:155], a[156:159], v[152:155]
    v_mfma_f32_16x16x32_bf16 v[156:159], a[140:143], a[160:163], v[156:159]
    buffer_load_dwordx4 v36, s[8:11], s56 offen offset:0 lds
    v_mfma_f32_16x16x32_bf16 v[156:159], a[152:155], a[164:167], v[156:159]
    s_waitcnt vmcnt(15) lgkmcnt(0)
    s_add_u32 s3, s55, 640
    v_bitop3_b32 v91, v91, v95, s76 bitop3:0x7e
    v_mfma_f32_16x16x32_bf16 v[160:163], a[168:171], a[80:83], v[160:163]
    v_cmp_ne_u32 vcc, 0, v91
    v_mfma_f32_16x16x32_bf16 v[160:163], a[172:175], a[84:87], v[160:163]
    v_mfma_f32_16x16x32_bf16 v[164:167], a[168:171], a[92:95], v[164:167]
    s_cbranch_vccnz L_slow1_0
L_back1_0:
    v_mfma_f32_16x16x32_bf16 v[164:167], a[172:175], a[96:99], v[164:167]
    v_perm_b32 v56, v88, v35, s36
    v_mfma_f32_16x16x32_bf16 v[168:171], a[168:171], a[100:103], v[168:171]
    buffer_load_dwordx4 v37, s[8:11], s56 offen offset:1024 lds
    v_mfma_f32_16x16x32_bf16 v[168:171], a[172:175], a[108:111], v[168:171]
    s_waitcnt vmcnt(14)
    ds_read_b32 a184, v56
    v_perm_b32 v57, v88, v35, s37
    v_mfma_f32_16x16x32_bf16 v[172:175], a[168:171], a[116:119], v[172:175]
    s_barrier
    v_mfma_f32_16x16x32_bf16 v[172:175], a[172:175], a[120:123], v[172:175]
    ds_read_b32 a185, v57
    ds_read_b128 a[188:191], v44 offset:0
    v_mfma_f32_16x16x32_bf16 v[176:179], a[168:171], a[124:127], v[176:179]
    ds_read_b128 a[192:195], v45 offset:0
    v_perm_b32 v58, v88, v35, s38
    v_mfma_f32_16x16x32_bf16 v[176:179], a[172:175], a[132:135], v[176:179]
    ds_read_b32 a186, v58
    ds_read_b128 a[196:199], v44 offset:2048
    v_mfma_f32_16x16x32_bf16 v[180:183], a[168:171], a[136:139], v[180:183]
    buffer_load_dwordx4 v38, s[8:11], s56 offen offset:2048 lds
    v_mfma_f32_16x16x32_bf16 v[180:183], a[172:175], a[144:147], v[180:183]
    ds_read_b128 a[200:203], v45 offset:2048
    v_perm_b32 v59, v88, v35, s39
    v_mfma_f32_16x16x32_bf16 v[184:187], a[168:171], a[148:151], v[184:187]
    ds_read_b32 a187, v59
    ds_read_b128 a[204:207], v44 offset:4096
    v_mfma_f32_16x16x32_bf16 v[184:187], a[172:175], a[156:159], v[184:187]
    ds_read_b128 a[208:211], v45 offset:4096
    v_perm_b32 v60, v92, v35, s36
    v_mfma_f32_16x16x32_bf16 v[188:191], a[168:171], a[160:163], v[188:191]
    ds_read_b32 a216, v60
    ds_read_b128 a[212:215], v44 offset:6144
    v_mfma_f32_16x16x32_bf16 v[188:191], a[172:175], a[164:167], v[188:191]
    s_waitcnt vmcnt(13)
    ds_read_b128 a[220:223], v45 offset:6144
    v_mfma_f32_16x16x32_bf16 v[192:195], a[176:179], a[80:83], v[192:195]
    buffer_load_dwordx4 v39, s[8:11], s56 offen offset:3072 lds
    v_mfma_f32_16x16x32_bf16 v[192:195], a[180:183], a[84:87], v[192:195]
    s_add_u32 m0, s57, 16384
    ds_read_b128 a[224:227], v44 offset:8192
    v_bitop3_b32 v97, v97, v99, s76 bitop3:0x7e
    v_mfma_f32_16x16x32_bf16 v[196:199], a[176:179], a[92:95], v[196:199]
    ds_read_b128 a[228:231], v45 offset:8192
    v_perm_b32 v61, v92, v35, s37
    v_mfma_f32_16x16x32_bf16 v[196:199], a[180:183], a[96:99], v[196:199]
    ds_read_b32 a217, v61
    v_perm_b32 v62, v92, v35, s38
    v_mfma_f32_16x16x32_bf16 v[200:203], a[176:179], a[100:103], v[200:203]
    ds_read_b32 a218, v62
    v_perm_b32 v63, v92, v35, s39
    v_mfma_f32_16x16x32_bf16 v[200:203], a[180:183], a[108:111], v[200:203]
    ds_read_b32 a219, v63
    ds_read_b128 a[232:235], v44 offset:10240
    v_mfma_f32_16x16x32_bf16 v[204:207], a[176:179], a[116:119], v[204:207]
    buffer_load_dwordx4 v36, s[8:11], s3 offen offset:0 lds
    v_mfma_f32_16x16x32_bf16 v[204:207], a[180:183], a[120:123], v[204:207]
    ds_read_b128 a[236:239], v45 offset:10240
    v_cmp_ne_u32 vcc, 0, v97
    v_mfma_f32_16x16x32_bf16 v[208:211], a[176:179], a[124:127], v[208:211]
    ds_read_b128 a[240:243], v44 offset:12288
    v_perm_b32 v56, v89, v35, s36
    v_mfma_f32_16x16x32_bf16 v[208:211], a[180:183], a[132:135], v[208:211]
    ds_read_b32 a244, v56
    s_cbranch_vccnz L_slow1_2
L_back1_2:
    v_mfma_f32_16x16x32_bf16 v[212:215], a[176:179], a[136:139], v[212:215]
    v_perm_b32 v57, v89, v35, s37
    v_perm_b32 v58, v89, v35, s38
    v_mfma_f32_16x16x32_bf16 v[212:215], a[180:183], a[144:147], v[212:215]
    ds_read_b32 a245, v57
    ds_read_b32 a246, v58
    v_mfma_f32_16x16x32_bf16 v[216:219], a[176:179], a[148:151], v[216:219]
    buffer_load_dwordx4 v37, s[8:11], s3 offen offset:1024 lds
    v_mfma_f32_16x16x32_bf16 v[216:219], a[180:183], a[156:159], v[216:219]
    ds_read_b128 a[248:251], v45 offset:12288
    v_perm_b32 v59, v89, v35, s39
    v_mfma_f32_16x16x32_bf16 v[220:223], a[176:179], a[160:163], v[220:223]
    s_waitcnt vmcnt(12)
    ds_read_b32 a247, v59
    v_bitop3_b32 v107, v107, v115, s76 bitop3:0x7e
    v_mfma_f32_16x16x32_bf16 v[220:223], a[180:183], a[164:167], v[220:223]
    s_waitcnt lgkmcnt(7)
    ds_read_b128 a[252:255], v44 offset:14336
    v_cmp_ne_u32 vcc, 0, v107
    v_mfma_f32_16x16x32_bf16 v[128:131], a[184:187], a[188:191], v[128:131]
    v_perm_b32 v60, v93, v35, s36
    v_perm_b32 v61, v93, v35, s37
    v_mfma_f32_16x16x32_bf16 v[128:131], a[216:219], a[192:195], v[128:131]
    ds_read_b32 a32, v60
    ds_read_b32 a33, v61
    v_mfma_f32_16x16x32_bf16 v[132:135], a[184:187], a[196:199], v[132:135]
    buffer_load_dwordx4 v38, s[8:11], s3 offen offset:2048 lds
    v_mfma_f32_16x16x32_bf16 v[132:135], a[216:219], a[200:203], v[132:135]
    ds_read_b128 a[48:51], v45 offset:14336
    v_perm_b32 v62, v93, v35, s38
    v_mfma_f32_16x16x32_bf16 v[136:139], a[184:187], a[204:207], v[136:139]
    ds_read_b32 a34, v62
    v_perm_b32 v63, v93, v35, s39
    v_mfma_f32_16x16x32_bf16 v[136:139], a[216:219], a[208:211], v[136:139]
    ds_read_b32 a35, v63
    s_cbranch_vccnz L_slow1_1
L_back1_1:
    v_mfma_f32_16x16x32_bf16 v[140:143], a[184:187], a[212:215], v[140:143]
    ds_read_b128 a[60:63], v46 offset:0
    v_perm_b32 v56, v90, v35, s36
    v_mfma_f32_16x16x32_bf16 v[140:143], a[216:219], a[220:223], v[140:143]
    ds_read_b32 a88, v56
    ds_read_b128 a[76:79], v47 offset:0
    v_mfma_f32_16x16x32_bf16 v[144:147], a[184:187], a[224:227], v[144:147]
    buffer_load_dwordx4 v39, s[8:11], s3 offen offset:3072 lds
    v_mfma_f32_16x16x32_bf16 v[144:147], a[216:219], a[228:231], v[144:147]
    s_waitcnt lgkmcnt(8)
    ds_read_b128 a[104:107], v46 offset:2048
    v_perm_b32 v57, v90, v35, s37
    v_mfma_f32_16x16x32_bf16 v[148:151], a[184:187], a[232:235], v[148:151]
    s_mov_b32 s48, 40960
    ds_read_b32 a89, v57
    v_perm_b32 v58, v90, v35, s38
    v_mfma_f32_16x16x32_bf16 v[148:151], a[216:219], a[236:239], v[148:151]
    s_mov_b32 s49, 40960
    ds_read_b32 a90, v58
    v_perm_b32 v59, v90, v35, s39
    v_mfma_f32_16x16x32_bf16 v[152:155], a[184:187], a[240:243], v[152:155]
    s_mov_b32 s50, 40960
    ds_read_b32 a91, v59
    ds_read_b128 a[0:3], v47 offset:2048
    v_mfma_f32_16x16x32_bf16 v[152:155], a[216:219], a[248:251], v[152:155]
    buffer_load_dwordx4 v[68:71], v32, s[12:15], s48 offen sc1
    v_mfma_f32_16x16x32_bf16 v[156:159], a[184:187], a[252:255], v[156:159]
    s_waitcnt lgkmcnt(8)
    s_mov_b32 s69, 46080
    ds_read_b128 a[4:7], v46 offset:4096
    v_perm_b32 v60, v94, v35, s36
    v_mfma_f32_16x16x32_bf16 v[156:159], a[216:219], a[48:51], v[156:159]
    s_mov_b32 s40, 46080
    ds_read_b32 a8, v60
    v_perm_b32 v61, v94, v35, s37
    v_mfma_f32_16x16x32_bf16 v[160:163], a[244:247], a[188:191], v[160:163]
    s_add_u32 s56, s55, 768
    ds_read_b32 a9, v61
    ds_read_b128 a[12:15], v47 offset:4096
    v_mfma_f32_16x16x32_bf16 v[160:163], a[32:35], a[192:195], v[160:163]
    buffer_load_dwordx2 v[72:73], v34, s[12:15], s49 offen sc1
    v_mfma_f32_16x16x32_bf16 v[164:167], a[244:247], a[196:199], v[164:167]
    s_mov_b32 s41, 46080
    v_perm_b32 v62, v94, v35, s38
    v_perm_b32 v63, v94, v35, s39
    v_mfma_f32_16x16x32_bf16 v[164:167], a[32:35], a[200:203], v[164:167]
    s_add_u32 m0, s57, 32768
    ds_read_b32 a10, v62
    v_perm_b32 v56, v96, v35, s36
    v_mfma_f32_16x16x32_bf16 v[168:171], a[244:247], a[204:207], v[168:171]
    ds_read_b32 a11, v63
    ds_read_b32 a16, v56
    v_mfma_f32_16x16x32_bf16 v[168:171], a[32:35], a[208:211], v[168:171]
    buffer_load_dwordx4 v[76:79], v33, s[12:15], s50 offen sc1
    v_mfma_f32_16x16x32_bf16 v[172:175], a[244:247], a[212:215], v[172:175]
    ds_read_b128 a[20:23], v46 offset:6144
    v_perm_b32 v57, v96, v35, s37
    v_mfma_f32_16x16x32_bf16 v[172:175], a[32:35], a[220:223], v[172:175]
    ds_read_b32 a17, v57
    v_perm_b32 v58, v96, v35, s38
    v_mfma_f32_16x16x32_bf16 v[176:179], a[244:247], a[224:227], v[176:179]
    ds_read_b32 a18, v58
    ds_read_b128 a[24:27], v47 offset:6144
    v_mfma_f32_16x16x32_bf16 v[176:179], a[32:35], a[228:231], v[176:179]
    buffer_load_dwordx4 v[80:83], v32, s[12:15], s69 offen sc1
    v_mfma_f32_16x16x32_bf16 v[180:183], a[244:247], a[232:235], v[180:183]
    ds_read_b128 a[28:31], v46 offset:8192
    v_perm_b32 v59, v96, v35, s39
    v_mfma_f32_16x16x32_bf16 v[180:183], a[32:35], a[236:239], v[180:183]
    v_lshlrev_b32 v84, v5, v84
    v_lshlrev_b32 v85, v5, v85
    v_lshlrev_b32 v86, v5, v86
    v_lshlrev_b32 v87, v5, v87
    v_mov_b32 v103, s76
    v_lshl_or_b32 v100, v108, 4, v100
    v_permlane32_swap_b32 v84, v85
    v_permlane32_swap_b32 v86, v87
    v_or_b32 v84, v84, v85
    v_or_b32 v86, v86, v87
    v_mov_b32 v85, s76
    v_lshl_or_b32 v101, v109, 4, v101
    v_lshl_or_b32 v102, v110, 4, v102
    v_permlane16_swap_b32 v84, v86
    v_or_b32 v84, v84, v86
    s_waitcnt vmcnt(17)
    v_lshl_or_b32 v100, v116, 8, v100
    v_lshl_or_b32 v101, v117, 8, v101
    v_or_b32_dpp v84, v84, v84 row_ror:8 row_mask:0xf bank_mask:0xf
    v_lshl_or_b32 v102, v118, 8, v102
    s_waitcnt vmcnt(16)
    v_lshl_or_b32 v100, v120, 12, v100
    v_lshl_or_b32 v101, v121, 12, v101
    v_lshl_or_b32 v102, v122, 12, v102
    s_waitcnt vmcnt(15)
    v_lshl_or_b32 v100, v124, 16, v100
    v_lshl_or_b32 v101, v125, 16, v101
    v_lshl_or_b32 v102, v126, 16, v102
    s_waitcnt vmcnt(14)
    v_lshl_or_b32 v100, v48, 20, v100
    v_lshl_or_b32 v101, v49, 20, v101
    v_lshl_or_b32 v102, v50, 20, v102
    s_waitcnt vmcnt(13)
    v_lshl_or_b32 v100, v52, 24, v100
    v_lshl_or_b32 v101, v53, 24, v101
    v_lshl_or_b32 v102, v54, 24, v102
    s_waitcnt vmcnt(12)
    v_lshl_or_b32 v100, v64, 28, v100
    v_lshl_or_b32 v101, v65, 28, v101
    v_lshl_or_b32 v102, v66, 28, v102
    buffer_store_dwordx4 v[100:103], v20, s[12:15], s62 offen sc1
    buffer_store_dwordx2 v[84:85], v21, s[12:15], s62 offen sc1
    s_mul_i32 s66, s63, 96
    s_lshl_b32 s67, s65, 5
    s_lshl_b32 s70, s64, 2
    s_add_u32 s67, s67, s70
    s_add_u32 s67, s67, 384
    s_mul_i32 s71, s59, 448
    s_add_u32 s70, s66, s71
    v_mad_u32_u24 v22, v3, 24, s70
    s_add_u32 s70, s67, s71
    v_lshl_add_u32 v23, v3, 3, s70
    s_mov_b32 s34, 7168
    s_mov_b32 s35, 0x20000
    s_mov_b32 s26, 256
    s_mov_b32 s27, 0x20000
    s_lshl_b32 s77, s59, 4
    s_mov_b32 s18, 14680064
    s_mov_b32 s19, 0x20000
    s_sub_u32 s70, 65536, s71
    v_mul_u32_u24 v16, 464, v4
    v_add3_u32 v26, v22, v16, s70
    v_add3_u32 v28, v23, v16, s70
    v_lshlrev_b32 v29, 3, v0
    v_xor_b32 v30, 512, v29
    v_add_u32 v29, 87808, v29
    v_add_u32 v30, 87808, v30
    v_mul_u32_u24 v16, 2341, v2
    v_lshrrev_b32 v16, 16, v16
    s_mul_i32 s73, s63, 1856
    s_add_u32 s73, s73, 65536
    v_add_lshl_u32 v24, v2, v16, 4
    v_add_u32 v24, s73, v24
    s_lshl_b32 s74, s58, 7
    s_lshl_b32 s75, s63, 2
    s_add_u32 s74, s74, s75
    s_mul_i32 s74, s74, 7168
    s_add_u32 s74, s74, s71
    v_mul_u32_u24 v17, 6720, v16
    v_lshl_add_u32 v25, v2, 4, v17
    v_lshrrev_b32 v16, 1, v16
    v_lshlrev_b32 v16, 30, v16
    v_add3_u32 v25, v25, v16, s74
    v_mfma_f32_16x16x32_bf16 v[184:187], a[244:247], a[240:243], v[184:187]
    ds_read_b32 a19, v59
    ds_read_b128 a[36:39], v47 offset:8192
    v_mfma_f32_16x16x32_bf16 v[184:187], a[32:35], a[248:251], v[184:187]
    buffer_load_dwordx2 v[74:75], v34, s[12:15], s40 offen sc1
    v_mfma_f32_16x16x32_bf16 v[188:191], a[244:247], a[252:255], v[188:191]
    s_waitcnt lgkmcnt(7)
    v_perm_b32 v60, v98, v35, s36
    v_perm_b32 v61, v98, v35, s37
    v_mfma_f32_16x16x32_bf16 v[188:191], a[32:35], a[48:51], v[188:191]
    ds_read_b32 a40, v60
    ds_read_b32 a41, v61
    v_perm_b32 v62, v98, v35, s38
    v_mfma_f32_16x16x32_bf16 v[192:195], a[88:91], a[188:191], v[192:195]
    ds_read_b32 a42, v62
    ds_read_b128 a[44:47], v46 offset:10240
    v_mfma_f32_16x16x32_bf16 v[192:195], a[8:11], a[192:195], v[192:195]
    buffer_load_dwordx4 v[88:91], v33, s[12:15], s41 offen sc1
    v_mfma_f32_16x16x32_bf16 v[196:199], a[88:91], a[196:199], v[196:199]
    v_perm_b32 v63, v98, v35, s39
    v_perm_b32 v56, v104, v35, s36
    v_mfma_f32_16x16x32_bf16 v[196:199], a[8:11], a[200:203], v[196:199]
    ds_read_b32 a43, v63
    ds_read_b32 a52, v56
    v_perm_b32 v57, v104, v35, s37
    v_mfma_f32_16x16x32_bf16 v[200:203], a[88:91], a[204:207], v[200:203]
    ds_read_b32 a53, v57
    ds_read_b128 a[56:59], v47 offset:10240
    v_mfma_f32_16x16x32_bf16 v[200:203], a[8:11], a[208:211], v[200:203]
    buffer_load_dwordx4 v36, s[8:11], s56 offen offset:0 lds
    v_mfma_f32_16x16x32_bf16 v[204:207], a[88:91], a[212:215], v[204:207]
    v_perm_b32 v58, v104, v35, s38
    v_perm_b32 v59, v104, v35, s39
    v_mfma_f32_16x16x32_bf16 v[204:207], a[8:11], a[220:223], v[204:207]
    ds_read_b32 a54, v58
    ds_read_b32 a55, v59
    v_mfma_f32_16x16x32_bf16 v[208:211], a[88:91], a[224:227], v[208:211]
    ds_read_b128 a[64:67], v46 offset:12288
    v_perm_b32 v60, v112, v35, s36
    v_mfma_f32_16x16x32_bf16 v[208:211], a[8:11], a[228:231], v[208:211]
    ds_read_b32 a68, v60
    v_perm_b32 v61, v112, v35, s37
    v_mfma_f32_16x16x32_bf16 v[212:215], a[88:91], a[232:235], v[212:215]
    ds_read_b32 a69, v61
    ds_read_b128 a[112:115], v47 offset:12288
    v_mfma_f32_16x16x32_bf16 v[212:215], a[8:11], a[236:239], v[212:215]
    buffer_load_dwordx4 v37, s[8:11], s56 offen offset:1024 lds
    v_mfma_f32_16x16x32_bf16 v[216:219], a[88:91], a[240:243], v[216:219]
    s_mov_b32 s42, 61440
    v_perm_b32 v62, v112, v35, s38
    v_perm_b32 v63, v112, v35, s39
    v_mfma_f32_16x16x32_bf16 v[216:219], a[8:11], a[248:251], v[216:219]
    ds_read_b32 a70, v62
    ds_read_b32 a71, v63
    v_mfma_f32_16x16x32_bf16 v[220:223], a[88:91], a[252:255], v[220:223]
    s_waitcnt lgkmcnt(8)
    ds_read_b128 a[72:75], v46 offset:14336
    v_mfma_f32_16x16x32_bf16 v[220:223], a[8:11], a[48:51], v[220:223]
    buffer_load_dwordx4 v[92:95], v32, s[12:15], s42 offen sc1
L_pad1:
    s_cbranch_execz L_pad2
    v_mfma_f32_16x16x32_bf16 v[224:227], a[16:19], a[188:191], v[224:227]
    s_add_u32 s3, s55, 896
    ds_read_b128 a[128:131], v47 offset:14336
    v_perm_b32 v56, v105, v35, s36
    v_mfma_f32_16x16x32_bf16 v[224:227], a[40:43], a[192:195], v[224:227]
    s_mov_b32 s43, 66560
    v_perm_b32 v57, v105, v35, s37
    v_perm_b32 v58, v105, v35, s38
    v_mfma_f32_16x16x32_bf16 v[228:231], a[16:19], a[196:199], v[228:231]
    ds_read_b32 a140, v56
    ds_read_b32 a141, v57
    v_perm_b32 v59, v105, v35, s39
    v_mfma_f32_16x16x32_bf16 v[228:231], a[40:43], a[200:203], v[228:231]
    ds_read_b32 a142, v58
    ds_read_b32 a143, v59
    v_mfma_f32_16x16x32_bf16 v[232:235], a[16:19], a[204:207], v[232:235]
    buffer_load_dwordx4 v[84:87], v32, s[12:15], s43 offen sc1
    v_mfma_f32_16x16x32_bf16 v[232:235], a[40:43], a[208:211], v[232:235]
    v_perm_b32 v60, v113, v35, s36
    v_perm_b32 v61, v113, v35, s37
    v_mfma_f32_16x16x32_bf16 v[236:239], a[16:19], a[212:215], v[236:239]
    ds_read_b32 a152, v60
    ds_read_b32 a153, v61
    v_perm_b32 v62, v113, v35, s38
    v_mfma_f32_16x16x32_bf16 v[236:239], a[40:43], a[220:223], v[236:239]
    ds_read_b32 a154, v62
    v_mfma_f32_16x16x32_bf16 v[240:243], a[16:19], a[224:227], v[240:243]
    buffer_load_dwordx4 v38, s[8:11], s56 offen offset:2048 lds
    v_mfma_f32_16x16x32_bf16 v[240:243], a[40:43], a[228:231], v[240:243]
    v_perm_b32 v63, v113, v35, s39
    v_perm_b32 v56, v106, v35, s36
    v_mfma_f32_16x16x32_bf16 v[244:247], a[16:19], a[232:235], v[244:247]
    ds_read_b32 a155, v63
    ds_read_b32 a168, v56
    v_mfma_f32_16x16x32_bf16 v[244:247], a[40:43], a[236:239], v[244:247]
    v_perm_b32 v57, v106, v35, s37
    v_perm_b32 v58, v106, v35, s38
    v_mfma_f32_16x16x32_bf16 v[248:251], a[16:19], a[240:243], v[248:251]
    ds_read_b32 a169, v57
    ds_read_b32 a170, v58
    v_perm_b32 v59, v106, v35, s39
    v_mfma_f32_16x16x32_bf16 v[248:251], a[40:43], a[248:251], v[248:251]
    s_waitcnt lgkmcnt(7)
    ds_read_b32 a171, v59
    v_mfma_f32_16x16x32_bf16 v[252:255], a[16:19], a[252:255], v[252:255]
    buffer_load_dwordx4 v39, s[8:11], s56 offen offset:3072 lds
    v_mfma_f32_16x16x32_bf16 v[252:255], a[40:43], a[48:51], v[252:255]
    s_add_u32 m0, s57, 49152
    v_perm_b32 v60, v114, v35, s36
    v_perm_b32 v61, v114, v35, s37
    v_mfma_f32_16x16x32_bf16 v[128:131], a[52:55], a[60:63], v[128:131]
    ds_read_b32 a172, v60
    ds_read_b32 a173, v61
    v_mfma_f32_16x16x32_bf16 v[128:131], a[68:71], a[76:79], v[128:131]
    v_perm_b32 v62, v114, v35, s38
    v_perm_b32 v63, v114, v35, s39
    v_mfma_f32_16x16x32_bf16 v[132:135], a[52:55], a[104:107], v[132:135]
    ds_read_b32 a174, v62
    ds_read_b32 a175, v63
    v_mfma_f32_16x16x32_bf16 v[132:135], a[68:71], a[0:3], v[132:135]
    s_waitcnt vmcnt(14)
    v_mfma_f32_16x16x32_bf16 v[136:139], a[52:55], a[4:7], v[136:139]
    buffer_load_dwordx4 v36, s[8:11], s3 offen offset:0 lds
    v_mfma_f32_16x16x32_bf16 v[136:139], a[68:71], a[12:15], v[136:139]
    s_barrier
    v_mfma_f32_16x16x32_bf16 v[140:143], a[52:55], a[20:23], v[140:143]
    ds_read_b128 a[80:83], v40 offset:0
    v_mfma_f32_16x16x32_bf16 v[140:143], a[68:71], a[24:27], v[140:143]
    ds_read_b128 a[84:87], v41 offset:0
    v_mfma_f32_16x16x32_bf16 v[144:147], a[52:55], a[28:31], v[144:147]
    ds_read_b128 a[92:95], v40 offset:2048
    v_mfma_f32_16x16x32_bf16 v[144:147], a[68:71], a[36:39], v[144:147]
    v_mfma_f32_16x16x32_bf16 v[148:151], a[52:55], a[44:47], v[148:151]
    buffer_load_dwordx4 v37, s[8:11], s3 offen offset:1024 lds
    v_mfma_f32_16x16x32_bf16 v[148:151], a[68:71], a[56:59], v[148:151]
    ds_read_b128 a[96:99], v41 offset:2048
    v_mfma_f32_16x16x32_bf16 v[152:155], a[52:55], a[64:67], v[152:155]
    v_mfma_f32_16x16x32_bf16 v[152:155], a[68:71], a[112:115], v[152:155]
    ds_read_b128 a[100:103], v40 offset:4096
    v_mfma_f32_16x16x32_bf16 v[156:159], a[52:55], a[72:75], v[156:159]
    v_mfma_f32_16x16x32_bf16 v[156:159], a[68:71], a[128:131], v[156:159]
    s_waitcnt lgkmcnt(4)
    v_mfma_f32_16x16x32_bf16 v[160:163], a[140:143], a[60:63], v[160:163]
    buffer_load_dwordx4 v38, s[8:11], s3 offen offset:2048 lds
    v_mfma_f32_16x16x32_bf16 v[160:163], a[152:155], a[76:79], v[160:163]
    ds_read_b128 a[108:111], v41 offset:4096
    v_mfma_f32_16x16x32_bf16 v[164:167], a[140:143], a[104:107], v[164:167]
    v_mfma_f32_16x16x32_bf16 v[164:167], a[152:155], a[0:3], v[164:167]
    s_mov_b32 s44, 61440
    ds_read_b128 a[116:119], v40 offset:6144
    v_mfma_f32_16x16x32_bf16 v[168:171], a[140:143], a[4:7], v[168:171]
    v_mfma_f32_16x16x32_bf16 v[168:171], a[152:155], a[12:15], v[168:171]
    s_waitcnt vmcnt(13)
    v_bitop3_b32 v71, v71, v83, s76 bitop3:0x7e
    v_mfma_f32_16x16x32_bf16 v[172:175], a[140:143], a[20:23], v[172:175]
    buffer_load_dwordx2 v[100:101], v34, s[12:15], s44 offen sc1
    v_mfma_f32_16x16x32_bf16 v[172:175], a[152:155], a[24:27], v[172:175]
    s_mov_b32 s45, 66560
    ds_read_b128 a[120:123], v41 offset:6144
    v_cmp_ne_u32 vcc, 0, v71
    v_mfma_f32_16x16x32_bf16 v[176:179], a[140:143], a[28:31], v[176:179]
    v_mfma_f32_16x16x32_bf16 v[176:179], a[152:155], a[36:39], v[176:179]
    ds_read_b128 a[124:127], v40 offset:8192
    s_cbranch_vccnz L_slow2_0
L_back2_0:
    v_mfma_f32_16x16x32_bf16 v[180:183], a[140:143], a[44:47], v[180:183]
    buffer_load_dwordx2 v[102:103], v34, s[12:15], s45 offen sc1
    v_mfma_f32_16x16x32_bf16 v[180:183], a[152:155], a[56:59], v[180:183]
    s_waitcnt vmcnt(12)
    v_bitop3_b32 v73, v73, v75, s76 bitop3:0x7e
    v_perm_b32 v56, v68, v35, s36
    v_mfma_f32_16x16x32_bf16 v[184:187], a[140:143], a[64:67], v[184:187]
    v_cmp_ne_u32 vcc, 0, v73
    v_perm_b32 v57, v68, v35, s37
    v_mfma_f32_16x16x32_bf16 v[184:187], a[152:155], a[112:115], v[184:187]
    ds_read_b32 a132, v56
    ds_read_b32 a133, v57
    v_mfma_f32_16x16x32_bf16 v[188:191], a[140:143], a[72:75], v[188:191]
    buffer_load_dwordx4 v39, s[8:11], s3 offen offset:3072 lds
    v_mfma_f32_16x16x32_bf16 v[188:191], a[152:155], a[128:131], v[188:191]
    v_perm_b32 v58, v68, v35, s38
    s_cbranch_vccnz L_slow2_2
L_back2_2:
    v_mfma_f32_16x16x32_bf16 v[192:195], a[168:171], a[60:63], v[192:195]
    s_mov_b32 s48, 61440
    ds_read_b32 a134, v58
    v_perm_b32 v59, v68, v35, s39
    v_mfma_f32_16x16x32_bf16 v[192:195], a[172:175], a[76:79], v[192:195]
    ds_read_b32 a135, v59
    v_perm_b32 v60, v80, v35, s36
    v_mfma_f32_16x16x32_bf16 v[196:199], a[168:171], a[104:107], v[196:199]
    s_add_u32 s56, s55, 1024
    ds_read_b32 a144, v60
    ds_read_b128 a[136:139], v41 offset:8192
    v_mfma_f32_16x16x32_bf16 v[196:199], a[172:175], a[0:3], v[196:199]
    buffer_load_dwordx4 v[108:111], v33, s[12:15], s48 offen sc1
    v_mfma_f32_16x16x32_bf16 v[200:203], a[168:171], a[4:7], v[200:203]
    s_mov_b32 s49, 66560
    v_perm_b32 v61, v80, v35, s37
    v_perm_b32 v62, v80, v35, s38
    v_mfma_f32_16x16x32_bf16 v[200:203], a[172:175], a[12:15], v[200:203]
    s_add_u32 m0, s57, 65536
    ds_read_b32 a145, v61
    ds_read_b32 a146, v62
    v_mfma_f32_16x16x32_bf16 v[204:207], a[168:171], a[20:23], v[204:207]
    s_waitcnt vmcnt(13)
    ds_read_b128 a[148:151], v40 offset:10240
    v_mfma_f32_16x16x32_bf16 v[204:207], a[172:175], a[24:27], v[204:207]
    buffer_load_dwordx4 v[116:119], v33, s[12:15], s49 offen sc1
    v_mfma_f32_16x16x32_bf16 v[208:211], a[168:171], a[28:31], v[208:211]
    ds_read_b128 a[156:159], v41 offset:10240
    v_perm_b32 v63, v80, v35, s39
    v_bitop3_b32 v79, v79, v91, s76 bitop3:0x7e
    v_mfma_f32_16x16x32_bf16 v[208:211], a[172:175], a[36:39], v[208:211]
    ds_read_b32 a147, v63
    v_cmp_ne_u32 vcc, 0, v79
    v_mfma_f32_16x16x32_bf16 v[212:215], a[168:171], a[44:47], v[212:215]
    ds_read_b128 a[160:163], v40 offset:12288
    v_mfma_f32_16x16x32_bf16 v[212:215], a[172:175], a[56:59], v[212:215]
    buffer_load_dwordx4 v36, s[8:11], s56 offen offset:0 lds
    v_mfma_f32_16x16x32_bf16 v[216:219], a[168:171], a[64:67], v[216:219]
    ds_read_b128 a[176:179], v41 offset:12288
    s_cbranch_vccnz L_slow2_1
L_back2_1:
    v_mfma_f32_16x16x32_bf16 v[216:219], a[172:175], a[112:115], v[216:219]
    v_perm_b32 v56, v69, v35, s36
    v_perm_b32 v57, v69, v35, s37
    v_mfma_f32_16x16x32_bf16 v[220:223], a[168:171], a[72:75], v[220:223]
    ds_read_b32 a164, v56
    ds_read_b32 a165, v57
    v_mfma_f32_16x16x32_bf16 v[220:223], a[172:175], a[128:131], v[220:223]
    s_waitcnt lgkmcnt(6)
    v_perm_b32 v58, v69, v35, s38
    v_perm_b32 v59, v69, v35, s39
    v_mfma_f32_16x16x32_bf16 v[128:131], a[132:135], a[80:83], v[128:131]
    s_waitcnt lgkmcnt(4)
    ds_read_b32 a166, v58
    ds_read_b32 a167, v59
    v_mfma_f32_16x16x32_bf16 v[128:131], a[144:147], a[84:87], v[128:131]
    buffer_load_dwordx4 v37, s[8:11], s56 offen offset:1024 lds
    v_mfma_f32_16x16x32_bf16 v[132:135], a[132:135], a[92:95], v[132:135]
    ds_read_b128 a[180:183], v40 offset:14336
    v_perm_b32 v60, v81, v35, s36
    v_mfma_f32_16x16x32_bf16 v[132:135], a[144:147], a[96:99], v[132:135]
    ds_read_b32 a184, v60
    v_perm_b32 v61, v81, v35, s37
    v_mfma_f32_16x16x32_bf16 v[136:139], a[132:135], a[100:103], v[136:139]
    ds_read_b128 a[216:219], v41 offset:14336
    ds_read_b32 a185, v61
    v_mfma_f32_16x16x32_bf16 v[136:139], a[144:147], a[108:111], v[136:139]
    v_perm_b32 v62, v81, v35, s38
    v_perm_b32 v63, v81, v35, s39
    v_mfma_f32_16x16x32_bf16 v[140:143], a[132:135], a[116:119], v[140:143]
    ds_read_b32 a186, v62
    ds_read_b32 a187, v63
    v_mfma_f32_16x16x32_bf16 v[140:143], a[144:147], a[120:123], v[140:143]
    v_perm_b32 v56, v70, v35, s36
    v_perm_b32 v57, v70, v35, s37
    v_mfma_f32_16x16x32_bf16 v[144:147], a[132:135], a[124:127], v[144:147]
    ds_read_b32 a244, v56
    ds_read_b32 a245, v57
    v_mfma_f32_16x16x32_bf16 v[144:147], a[144:147], a[136:139], v[144:147]
    buffer_load_dwordx4 v38, s[8:11], s56 offen offset:2048 lds
    v_mfma_f32_16x16x32_bf16 v[148:151], a[132:135], a[148:151], v[148:151]
    s_waitcnt lgkmcnt(7)
    v_perm_b32 v58, v70, v35, s38
    v_perm_b32 v59, v70, v35, s39
    v_mfma_f32_16x16x32_bf16 v[148:151], a[144:147], a[156:159], v[148:151]
    ds_read_b32 a246, v58
    ds_read_b32 a247, v59
    v_perm_b32 v60, v82, v35, s36
    v_mfma_f32_16x16x32_bf16 v[152:155], a[132:135], a[160:163], v[152:155]
    ds_read_b32 a32, v60
    v_perm_b32 v61, v82, v35, s37
    v_perm_b32 v62, v82, v35, s38
    v_mfma_f32_16x16x32_bf16 v[152:155], a[144:147], a[176:179], v[152:155]
    ds_read_b32 a33, v61
    ds_read_b32 a34, v62
    v_perm_b32 v63, v82, v35, s39
    v_mfma_f32_16x16x32_bf16 v[156:159], a[132:135], a[180:183], v[156:159]
    s_waitcnt lgkmcnt(9)
    ds_read_b32 a35, v63
    v_perm_b32 v56, v72, v35, s36
    v_mfma_f32_16x16x32_bf16 v[156:159], a[144:147], a[216:219], v[156:159]
    ds_read_b32 a88, v56
    v_perm_b32 v57, v72, v35, s37
    v_mfma_f32_16x16x32_bf16 v[160:163], a[164:167], a[80:83], v[160:163]
    s_waitcnt lgkmcnt(9)
    ds_read_b32 a89, v57
    v_perm_b32 v58, v72, v35, s38
    v_mfma_f32_16x16x32_bf16 v[160:163], a[184:187], a[84:87], v[160:163]
    ds_read_b32 a90, v58
    v_perm_b32 v59, v72, v35, s39
    v_mfma_f32_16x16x32_bf16 v[164:167], a[164:167], a[92:95], v[164:167]
    s_add_u32 s3, s55, 1152
    ds_read_b32 a91, v59
    v_perm_b32 v60, v74, v35, s36
    v_mfma_f32_16x16x32_bf16 v[164:167], a[184:187], a[96:99], v[164:167]
    ds_read_b32 a188, v60
    ds_read_b128 a[8:11], v42 offset:0
    v_perm_b32 v61, v74, v35, s37
    v_mfma_f32_16x16x32_bf16 v[168:171], a[164:167], a[100:103], v[168:171]
    ds_read_b32 a189, v61
    v_perm_b32 v62, v74, v35, s38
    v_mfma_f32_16x16x32_bf16 v[168:171], a[184:187], a[108:111], v[168:171]
    ds_read_b32 a190, v62
    v_perm_b32 v63, v74, v35, s39
    v_mfma_f32_16x16x32_bf16 v[172:175], a[164:167], a[116:119], v[172:175]
    ds_read_b32 a191, v63
    ds_read_b128 a[192:195], v43 offset:0
    v_perm_b32 v56, v76, v35, s36
    v_mfma_f32_16x16x32_bf16 v[172:175], a[184:187], a[120:123], v[172:175]
    ds_read_b32 a196, v56
    v_perm_b32 v57, v76, v35, s37
    v_mfma_f32_16x16x32_bf16 v[176:179], a[164:167], a[124:127], v[176:179]
    ds_read_b32 a197, v57
    v_perm_b32 v58, v76, v35, s38
    v_mfma_f32_16x16x32_bf16 v[176:179], a[184:187], a[136:139], v[176:179]
    ds_read_b32 a198, v58
    ds_read_b128 a[200:203], v42 offset:2048
    v_perm_b32 v59, v76, v35, s39
    v_mfma_f32_16x16x32_bf16 v[180:183], a[164:167], a[148:151], v[180:183]
    ds_read_b32 a199, v59
    v_perm_b32 v60, v88, v35, s36
    v_mfma_f32_16x16x32_bf16 v[180:183], a[184:187], a[156:159], v[180:183]
    ds_read_b32 a204, v60
    v_perm_b32 v61, v88, v35, s37
    v_mfma_f32_16x16x32_bf16 v[184:187], a[164:167], a[160:163], v[184:187]
    ds_read_b32 a205, v61
    ds_read_b128 a[208:211], v43 offset:2048
    v_perm_b32 v62, v88, v35, s38
    v_mfma_f32_16x16x32_bf16 v[184:187], a[184:187], a[176:179], v[184:187]
    s_waitcnt vmcnt(13) lgkmcnt(11)
    ds_read_b32 a206, v62
    ds_read_b128 a[212:215], v42 offset:4096
    v_mfma_f32_16x16x32_bf16 v[188:191], a[164:167], a[180:183], v[188:191]
    buffer_load_dwordx4 v39, s[8:11], s56 offen offset:3072 lds
    v_mfma_f32_16x16x32_bf16 v[188:191], a[184:187], a[216:219], v[188:191]
    s_add_u32 m0, s57, 81920
    v_perm_b32 v63, v88, v35, s39
    v_bitop3_b32 v95, v95, v87, s76 bitop3:0x7e
    v_mfma_f32_16x16x32_bf16 v[192:195], a[244:247], a[80:83], v[192:195]
    ds_read_b32 a207, v63
    ds_read_b128 a[220:223], v43 offset:4096
    v_cmp_ne_u32 vcc, 0, v95
    v_mfma_f32_16x16x32_bf16 v[192:195], a[32:35], a[84:87], v[192:195]
    ds_read_b128 a[224:227], v42 offset:6144
    v_perm_b32 v56, v77, v35, s36
    v_mfma_f32_16x16x32_bf16 v[196:199], a[244:247], a[92:95], v[196:199]
    ds_read_b128 a[228:231], v43 offset:6144
    ds_read_b32 a232, v56
    v_mfma_f32_16x16x32_bf16 v[196:199], a[32:35], a[96:99], v[196:199]
    ds_read_b128 a[236:239], v42 offset:8192
    s_cbranch_vccnz L_slow3_0
L_back3_0:
    v_mfma_f32_16x16x32_bf16 v[200:203], a[244:247], a[100:103], v[200:203]
    buffer_load_dwordx4 v36, s[8:11], s3 offen offset:0 lds
    v_mfma_f32_16x16x32_bf16 v[200:203], a[32:35], a[108:111], v[200:203]
    ds_read_b128 a[240:243], v43 offset:8192
    v_perm_b32 v57, v77, v35, s37
    v_mfma_f32_16x16x32_bf16 v[204:207], a[244:247], a[116:119], v[204:207]
    ds_read_b128 a[248:251], v42 offset:10240
    ds_read_b32 a233, v57
    v_mfma_f32_16x16x32_bf16 v[204:207], a[32:35], a[120:123], v[204:207]
    ds_read_b128 a[252:255], v43 offset:10240
    v_perm_b32 v58, v77, v35, s38
    v_mfma_f32_16x16x32_bf16 v[208:211], a[244:247], a[124:127], v[208:211]
    ds_read_b32 a234, v58
    v_perm_b32 v59, v77, v35, s39
    v_mfma_f32_16x16x32_bf16 v[208:211], a[32:35], a[136:139], v[208:211]
    ds_read_b32 a235, v59
    v_perm_b32 v60, v89, v35, s36
    v_mfma_f32_16x16x32_bf16 v[212:215], a[244:247], a[148:151], v[212:215]
    ds_read_b128 a[16:19], v42 offset:12288
    ds_read_b32 a48, v60
    v_mfma_f32_16x16x32_bf16 v[212:215], a[32:35], a[156:159], v[212:215]
    buffer_load_dwordx4 v37, s[8:11], s3 offen offset:1024 lds
    v_mfma_f32_16x16x32_bf16 v[216:219], a[244:247], a[160:163], v[216:219]
    v_perm_b32 v61, v89, v35, s37
    v_perm_b32 v62, v89, v35, s38
    v_mfma_f32_16x16x32_bf16 v[216:219], a[32:35], a[176:179], v[216:219]
    ds_read_b128 a[40:43], v43 offset:12288
    ds_read_b32 a49, v61
    v_mfma_f32_16x16x32_bf16 v[220:223], a[244:247], a[180:183], v[220:223]
    ds_read_b32 a50, v62
    v_perm_b32 v63, v89, v35, s39
    v_mfma_f32_16x16x32_bf16 v[220:223], a[32:35], a[216:219], v[220:223]
    ds_read_b32 a51, v63
    v_perm_b32 v56, v78, v35, s36
    v_mfma_f32_16x16x32_bf16 v[224:227], a[88:91], a[80:83], v[224:227]
    s_waitcnt lgkmcnt(8)
    ds_read_b128 a[52:55], v42 offset:14336
    ds_read_b32 a68, v56
    v_mfma_f32_16x16x32_bf16 v[224:227], a[188:191], a[84:87], v[224:227]
    buffer_load_dwordx4 v38, s[8:11], s3 offen offset:2048 lds
    v_mfma_f32_16x16x32_bf16 v[228:231], a[88:91], a[92:95], v[228:231]
    v_perm_b32 v57, v78, v35, s37
    v_perm_b32 v58, v78, v35, s38
    v_mfma_f32_16x16x32_bf16 v[228:231], a[188:191], a[96:99], v[228:231]
    ds_read_b128 a[140:143], v43 offset:14336
    ds_read_b32 a69, v57
    v_mfma_f32_16x16x32_bf16 v[232:235], a[88:91], a[100:103], v[232:235]
    ds_read_b32 a70, v58
    v_perm_b32 v59, v78, v35, s39
    v_mfma_f32_16x16x32_bf16 v[232:235], a[188:191], a[108:111], v[232:235]
    ds_read_b32 a71, v59
    v_perm_b32 v60, v90, v35, s36
    v_perm_b32 v61, v90, v35, s37
    v_mfma_f32_16x16x32_bf16 v[236:239], a[88:91], a[116:119], v[236:239]
    ds_read_b32 a152, v60
    ds_read_b32 a153, v61
    v_mfma_f32_16x16x32_bf16 v[236:239], a[188:191], a[120:123], v[236:239]
    buffer_load_dwordx4 v39, s[8:11], s3 offen offset:3072 lds
    v_mfma_f32_16x16x32_bf16 v[240:243], a[88:91], a[124:127], v[240:243]
    v_perm_b32 v62, v90, v35, s38
    v_perm_b32 v63, v90, v35, s39
    v_mfma_f32_16x16x32_bf16 v[240:243], a[188:191], a[136:139], v[240:243]
    ds_read_b32 a154, v62
    ds_read_b32 a155, v63
    v_mfma_f32_16x16x32_bf16 v[244:247], a[88:91], a[148:151], v[244:247]
    s_waitcnt vmcnt(11)
    v_perm_b32 v56, v92, v35, s36
    v_bitop3_b32 v101, v101, v103, s76 bitop3:0x7e
    v_mfma_f32_16x16x32_bf16 v[244:247], a[188:191], a[156:159], v[244:247]
    s_waitcnt vmcnt(10) lgkmcnt(7)
    ds_read_b32 a60, v56
    v_cmp_ne_u32 vcc, 0, v101
    v_mfma_f32_16x16x32_bf16 v[248:251], a[88:91], a[160:163], v[248:251]
    s_barrier
    v_mfma_f32_16x16x32_bf16 v[248:251], a[188:191], a[176:179], v[248:251]
    v_perm_b32 v57, v92, v35, s37
    s_cbranch_vccnz L_slow3_2
L_back3_2:
    v_mfma_f32_16x16x32_bf16 v[252:255], a[88:91], a[180:183], v[252:255]
    s_mov_b32 s50, 81920
    ds_read_b32 a61, v57
    v_perm_b32 v58, v92, v35, s38
    v_mfma_f32_16x16x32_bf16 v[252:255], a[188:191], a[216:219], v[252:255]
    s_mov_b32 s69, 87040
    v_perm_b32 v59, v92, v35, s39
    v_perm_b32 v60, v84, v35, s36
    v_mfma_f32_16x16x32_bf16 v[128:131], a[196:199], a[8:11], v[128:131]
    s_mov_b32 s40, 81920
    ds_read_b32 a62, v58
    ds_read_b32 a63, v59
    v_mfma_f32_16x16x32_bf16 v[128:131], a[204:207], a[192:195], v[128:131]
    buffer_load_dwordx4 v[120:123], v32, s[12:15], s50 offen sc1
    v_mfma_f32_16x16x32_bf16 v[132:135], a[196:199], a[200:203], v[132:135]
    s_mov_b32 s41, 87040
    ds_read_b32 a76, v60
    v_perm_b32 v61, v84, v35, s37
    v_mfma_f32_16x16x32_bf16 v[132:135], a[204:207], a[208:211], v[132:135]
    ds_read_b32 a77, v61
    v_perm_b32 v62, v84, v35, s38
    v_mfma_f32_16x16x32_bf16 v[136:139], a[196:199], a[212:215], v[136:139]
    ds_read_b32 a78, v62
    ds_read_b128 a[104:107], v40 offset:32768
    v_mfma_f32_16x16x32_bf16 v[136:139], a[204:207], a[220:223], v[136:139]
    buffer_load_dwordx4 v[124:127], v32, s[12:15], s69 offen sc1
    v_mfma_f32_16x16x32_bf16 v[140:143], a[196:199], a[224:227], v[140:143]
    v_perm_b32 v63, v84, v35, s39
    v_perm_b32 v56, v93, v35, s36
    v_mfma_f32_16x16x32_bf16 v[140:143], a[204:207], a[228:231], v[140:143]
    ds_read_b32 a79, v63
    ds_read_b32 a0, v56
    v_mfma_f32_16x16x32_bf16 v[144:147], a[196:199], a[236:239], v[144:147]
    s_waitcnt vmcnt(10)
    ds_read_b128 a[4:7], v41 offset:32768
    v_mfma_f32_16x16x32_bf16 v[144:147], a[204:207], a[240:243], v[144:147]
    buffer_load_dwordx2 v[48:49], v34, s[12:15], s40 offen sc1
    v_mfma_f32_16x16x32_bf16 v[148:151], a[196:199], a[248:251], v[148:151]
    s_mov_b32 s42, 81920
    v_bitop3_b32 v111, v111, v119, s76 bitop3:0x7e
    v_perm_b32 v57, v93, v35, s37
    v_mfma_f32_16x16x32_bf16 v[148:151], a[204:207], a[252:255], v[148:151]
    ds_read_b32 a1, v57
    v_cmp_ne_u32 vcc, 0, v111
    v_mfma_f32_16x16x32_bf16 v[152:155], a[196:199], a[16:19], v[152:155]
    s_mov_b32 s43, 87040
    ds_read_b128 a[12:15], v40 offset:34816
    v_mfma_f32_16x16x32_bf16 v[152:155], a[204:207], a[40:43], v[152:155]
    buffer_load_dwordx2 v[50:51], v34, s[12:15], s41 offen sc1
    v_mfma_f32_16x16x32_bf16 v[156:159], a[196:199], a[52:55], v[156:159]
    v_perm_b32 v58, v93, v35, s38
    s_cbranch_vccnz L_slow3_1
L_back3_1:
    v_mfma_f32_16x16x32_bf16 v[156:159], a[204:207], a[140:143], v[156:159]
    s_add_u32 s56, s55, 1280
    ds_read_b128 a[20:23], v41 offset:34816
    ds_read_b32 a2, v58
    v_mfma_f32_16x16x32_bf16 v[160:163], a[232:235], a[8:11], v[160:163]
    ds_read_b128 a[24:27], v40 offset:36864
    v_mfma_f32_16x16x32_bf16 v[160:163], a[48:51], a[192:195], v[160:163]
    buffer_load_dwordx4 v[52:55], v33, s[12:15], s42 offen sc1
    v_mfma_f32_16x16x32_bf16 v[164:167], a[232:235], a[200:203], v[164:167]
    s_add_u32 m0, s57, 0
    v_perm_b32 v59, v93, v35, s39
    v_perm_b32 v60, v85, v35, s36
    v_mfma_f32_16x16x32_bf16 v[164:167], a[48:51], a[208:211], v[164:167]
    ds_read_b32 a3, v59
    ds_read_b32 a28, v60
    v_mfma_f32_16x16x32_bf16 v[168:171], a[232:235], a[212:215], v[168:171]
    ds_read_b128 a[36:39], v41 offset:36864
    v_mfma_f32_16x16x32_bf16 v[168:171], a[48:51], a[220:223], v[168:171]
    buffer_load_dwordx4 v[64:67], v33, s[12:15], s43 offen sc1
    v_mfma_f32_16x16x32_bf16 v[172:175], a[232:235], a[224:227], v[172:175]
    v_perm_b32 v61, v85, v35, s37
    v_perm_b32 v62, v85, v35, s38
    v_mfma_f32_16x16x32_bf16 v[172:175], a[48:51], a[228:231], v[172:175]
    ds_read_b32 a29, v61
    ds_read_b32 a30, v62
    v_mfma_f32_16x16x32_bf16 v[176:179], a[232:235], a[236:239], v[176:179]
    ds_read_b128 a[44:47], v40 offset:38912
    v_mfma_f32_16x16x32_bf16 v[176:179], a[48:51], a[240:243], v[176:179]
    buffer_load_dwordx4 v36, s[8:11], s56 offen offset:0 lds
    v_mfma_f32_16x16x32_bf16 v[180:183], a[232:235], a[248:251], v[180:183]
    v_perm_b32 v63, v85, v35, s39
    v_perm_b32 v56, v94, v35, s36
    v_mfma_f32_16x16x32_bf16 v[180:183], a[48:51], a[252:255], v[180:183]
    ds_read_b128 a[56:59], v41 offset:38912
    ds_read_b32 a31, v63
    v_mfma_f32_16x16x32_bf16 v[184:187], a[232:235], a[16:19], v[184:187]
    ds_read_b32 a64, v56
    v_perm_b32 v57, v94, v35, s37
    v_mfma_f32_16x16x32_bf16 v[184:187], a[48:51], a[40:43], v[184:187]
    ds_read_b32 a65, v57
    v_perm_b32 v58, v94, v35, s38
    v_mfma_f32_16x16x32_bf16 v[188:191], a[232:235], a[52:55], v[188:191]
    s_waitcnt lgkmcnt(7)
    ds_read_b128 a[112:115], v40 offset:40960
    ds_read_b32 a66, v58
    v_mfma_f32_16x16x32_bf16 v[188:191], a[48:51], a[140:143], v[188:191]
    buffer_load_dwordx4 v37, s[8:11], s56 offen offset:1024 lds
    v_mfma_f32_16x16x32_bf16 v[192:195], a[68:71], a[8:11], v[192:195]
    v_perm_b32 v59, v94, v35, s39
    v_perm_b32 v60, v86, v35, s36
    v_mfma_f32_16x16x32_bf16 v[192:195], a[152:155], a[192:195], v[192:195]
    ds_read_b128 a[72:75], v41 offset:40960
    ds_read_b32 a67, v59
    v_mfma_f32_16x16x32_bf16 v[196:199], a[68:71], a[200:203], v[196:199]
    ds_read_b32 a168, v60
    v_perm_b32 v61, v86, v35, s37
    v_mfma_f32_16x16x32_bf16 v[196:199], a[152:155], a[208:211], v[196:199]
    ds_read_b32 a169, v61
    v_perm_b32 v62, v86, v35, s38
    v_mfma_f32_16x16x32_bf16 v[200:203], a[68:71], a[212:215], v[200:203]
    ds_read_b128 a[128:131], v40 offset:43008
    ds_read_b32 a170, v62
    v_mfma_f32_16x16x32_bf16 v[200:203], a[152:155], a[220:223], v[200:203]
    buffer_load_dwordx4 v38, s[8:11], s56 offen offset:2048 lds
    v_mfma_f32_16x16x32_bf16 v[204:207], a[68:71], a[224:227], v[204:207]
    v_perm_b32 v63, v86, v35, s39
    v_perm_b32 v56, v100, v35, s36
    v_mfma_f32_16x16x32_bf16 v[204:207], a[152:155], a[228:231], v[204:207]
    ds_read_b128 a[172:175], v41 offset:43008
    ds_read_b32 a171, v63
    v_mfma_f32_16x16x32_bf16 v[208:211], a[68:71], a[236:239], v[208:211]
    ds_read_b32 a132, v56
    v_perm_b32 v57, v100, v35, s37
    v_mfma_f32_16x16x32_bf16 v[208:211], a[152:155], a[240:243], v[208:211]
    ds_read_b32 a133, v57
    v_perm_b32 v58, v100, v35, s38
    v_mfma_f32_16x16x32_bf16 v[212:215], a[68:71], a[248:251], v[212:215]
    ds_read_b128 a[144:147], v40 offset:45056
    ds_read_b32 a134, v58
    v_mfma_f32_16x16x32_bf16 v[212:215], a[152:155], a[252:255], v[212:215]
    ds_read_b128 a[164:167], v41 offset:45056
    v_mfma_f32_16x16x32_bf16 v[216:219], a[68:71], a[16:19], v[216:219]
    buffer_load_dwordx4 v39, s[8:11], s56 offen offset:3072 lds
    v_mfma_f32_16x16x32_bf16 v[216:219], a[152:155], a[40:43], v[216:219]
    v_perm_b32 v59, v100, v35, s39
    v_perm_b32 v60, v102, v35, s36
    v_mfma_f32_16x16x32_bf16 v[220:223], a[68:71], a[52:55], v[220:223]
    s_add_u32 s3, s55, 1408
    ds_read_b32 a135, v59
    ds_read_b32 a184, v60
    v_mfma_f32_16x16x32_bf16 v[220:223], a[152:155], a[140:143], v[220:223]
    v_perm_b32 v61, v102, v35, s37
    v_perm_b32 v62, v102, v35, s38
    v_mfma_f32_16x16x32_bf16 v[128:131], a[60:63], a[104:107], v[128:131]
    s_mov_b32 s44, 102400
    ds_read_b128 a[244:247], v40 offset:47104
    ds_read_b32 a185, v61
    v_mfma_f32_16x16x32_bf16 v[128:131], a[76:79], a[4:7], v[128:131]
    s_add_u32 m0, s57, 16384
    ds_read_b32 a186, v62
    v_perm_b32 v63, v102, v35, s39
    v_mfma_f32_16x16x32_bf16 v[132:135], a[60:63], a[12:15], v[132:135]
    ds_read_b32 a187, v63
    ds_read_b128 a[32:35], v41 offset:47104
    v_mfma_f32_16x16x32_bf16 v[132:135], a[76:79], a[20:23], v[132:135]
    buffer_load_dwordx4 v[96:99], v32, s[12:15], s44 offen sc1
L_pad2:
    s_cbranch_execz L_pad3
    v_mfma_f32_16x16x32_bf16 v[136:139], a[60:63], a[24:27], v[136:139]
    s_mov_b32 s45, 107520
    v_perm_b32 v56, v108, v35, s36
    v_perm_b32 v57, v108, v35, s37
    v_mfma_f32_16x16x32_bf16 v[136:139], a[76:79], a[36:39], v[136:139]
    s_waitcnt lgkmcnt(7)
    ds_read_b32 a80, v56
    ds_read_b32 a81, v57
    v_mfma_f32_16x16x32_bf16 v[140:143], a[60:63], a[44:47], v[140:143]
    ds_read_b128 a[84:87], v42 offset:32768
    v_mfma_f32_16x16x32_bf16 v[140:143], a[76:79], a[56:59], v[140:143]
    buffer_load_dwordx4 v[104:107], v32, s[12:15], s45 offen sc1
    v_mfma_f32_16x16x32_bf16 v[144:147], a[60:63], a[112:115], v[144:147]
    v_perm_b32 v58, v108, v35, s38
    v_perm_b32 v59, v108, v35, s39
    v_mfma_f32_16x16x32_bf16 v[144:147], a[76:79], a[72:75], v[144:147]
    ds_read_b32 a82, v58
    ds_read_b32 a83, v59
    v_mfma_f32_16x16x32_bf16 v[148:151], a[60:63], a[128:131], v[148:151]
    ds_read_b128 a[92:95], v43 offset:32768
    v_mfma_f32_16x16x32_bf16 v[148:151], a[76:79], a[172:175], v[148:151]
    buffer_load_dwordx4 v36, s[8:11], s3 offen offset:0 lds
    v_mfma_f32_16x16x32_bf16 v[152:155], a[60:63], a[144:147], v[152:155]
    v_perm_b32 v60, v116, v35, s36
    v_perm_b32 v61, v116, v35, s37
    v_mfma_f32_16x16x32_bf16 v[152:155], a[76:79], a[164:167], v[152:155]
    s_waitcnt lgkmcnt(6)
    ds_read_b32 a96, v60
    ds_read_b32 a97, v61
    v_mfma_f32_16x16x32_bf16 v[156:159], a[60:63], a[244:247], v[156:159]
    v_perm_b32 v62, v116, v35, s38
    v_perm_b32 v63, v116, v35, s39
    v_mfma_f32_16x16x32_bf16 v[156:159], a[76:79], a[32:35], v[156:159]
    ds_read_b32 a98, v62
    ds_read_b32 a99, v63
    v_mfma_f32_16x16x32_bf16 v[160:163], a[0:3], a[104:107], v[160:163]
    ds_read_b128 a[100:103], v42 offset:34816
    v_mfma_f32_16x16x32_bf16 v[160:163], a[28:31], a[4:7], v[160:163]
    buffer_load_dwordx4 v37, s[8:11], s3 offen offset:1024 lds
    v_mfma_f32_16x16x32_bf16 v[164:167], a[0:3], a[12:15], v[164:167]
    v_perm_b32 v56, v109, v35, s36
    v_perm_b32 v57, v109, v35, s37
    v_mfma_f32_16x16x32_bf16 v[164:167], a[28:31], a[20:23], v[164:167]
    ds_read_b32 a108, v56
    ds_read_b32 a109, v57
    v_mfma_f32_16x16x32_bf16 v[168:171], a[0:3], a[24:27], v[168:171]
    v_perm_b32 v58, v109, v35, s38
    v_perm_b32 v59, v109, v35, s39
    v_mfma_f32_16x16x32_bf16 v[168:171], a[28:31], a[36:39], v[168:171]
    ds_read_b32 a110, v58
    ds_read_b32 a111, v59
    v_mfma_f32_16x16x32_bf16 v[172:175], a[0:3], a[44:47], v[172:175]
    ds_read_b128 a[116:119], v43 offset:34816
    v_mfma_f32_16x16x32_bf16 v[172:175], a[28:31], a[56:59], v[172:175]
    buffer_load_dwordx4 v38, s[8:11], s3 offen offset:2048 lds
    v_mfma_f32_16x16x32_bf16 v[176:179], a[0:3], a[112:115], v[176:179]
    s_waitcnt vmcnt(13)
    v_perm_b32 v60, v117, v35, s36
    v_bitop3_b32 v123, v123, v127, s76 bitop3:0x7e
    v_mfma_f32_16x16x32_bf16 v[176:179], a[28:31], a[72:75], v[176:179]
    ds_read_b32 a120, v60
    v_cmp_ne_u32 vcc, 0, v123
    v_mfma_f32_16x16x32_bf16 v[180:183], a[0:3], a[128:131], v[180:183]
    v_perm_b32 v61, v117, v35, s37
    v_perm_b32 v62, v117, v35, s38
    v_mfma_f32_16x16x32_bf16 v[180:183], a[28:31], a[172:175], v[180:183]
    ds_read_b32 a121, v61
    ds_read_b32 a122, v62
    v_mfma_f32_16x16x32_bf16 v[184:187], a[0:3], a[144:147], v[184:187]
    ds_read_b128 a[124:127], v42 offset:36864
    s_cbranch_vccnz L_slow4_0
L_back4_0:
    v_mfma_f32_16x16x32_bf16 v[184:187], a[28:31], a[164:167], v[184:187]
    buffer_load_dwordx4 v39, s[8:11], s3 offen offset:3072 lds
    v_mfma_f32_16x16x32_bf16 v[188:191], a[0:3], a[244:247], v[188:191]
    v_perm_b32 v63, v117, v35, s39
    v_perm_b32 v56, v110, v35, s36
    v_mfma_f32_16x16x32_bf16 v[188:191], a[28:31], a[32:35], v[188:191]
    ds_read_b32 a123, v63
    ds_read_b32 a136, v56
    v_mfma_f32_16x16x32_bf16 v[192:195], a[64:67], a[104:107], v[192:195]
    ds_read_b128 a[148:151], v43 offset:36864
    v_perm_b32 v57, v110, v35, s37
    v_mfma_f32_16x16x32_bf16 v[192:195], a[168:171], a[4:7], v[192:195]
    ds_read_b128 a[156:159], v42 offset:38912
    ds_read_b32 a137, v57
    v_mfma_f32_16x16x32_bf16 v[196:199], a[64:67], a[12:15], v[196:199]
    ds_read_b128 a[160:163], v43 offset:38912
    v_perm_b32 v58, v110, v35, s38
    v_mfma_f32_16x16x32_bf16 v[196:199], a[168:171], a[20:23], v[196:199]
    ds_read_b128 a[176:179], v42 offset:40960
    ds_read_b32 a138, v58
    v_perm_b32 v59, v110, v35, s39
    v_mfma_f32_16x16x32_bf16 v[200:203], a[64:67], a[24:27], v[200:203]
    ds_read_b128 a[180:183], v43 offset:40960
    ds_read_b32 a139, v59
    v_mfma_f32_16x16x32_bf16 v[200:203], a[168:171], a[36:39], v[200:203]
    ds_read_b128 a[88:91], v42 offset:43008
    v_perm_b32 v60, v118, v35, s36
    v_mfma_f32_16x16x32_bf16 v[204:207], a[64:67], a[44:47], v[204:207]
    s_mov_b32 s48, 102400
    ds_read_b32 a216, v60
    v_perm_b32 v61, v118, v35, s37
    v_mfma_f32_16x16x32_bf16 v[204:207], a[168:171], a[56:59], v[204:207]
    ds_read_b128 a[188:191], v43 offset:43008
    ds_read_b32 a217, v61
    v_mfma_f32_16x16x32_bf16 v[208:211], a[64:67], a[112:115], v[208:211]
    ds_read_b128 a[196:199], v42 offset:45056
    v_mfma_f32_16x16x32_bf16 v[208:211], a[168:171], a[72:75], v[208:211]
    buffer_load_dwordx2 v[112:113], v34, s[12:15], s48 offen sc1
    v_mfma_f32_16x16x32_bf16 v[212:215], a[64:67], a[128:131], v[212:215]
    s_mov_b32 s49, 107520
    v_perm_b32 v62, v118, v35, s38
    v_perm_b32 v63, v118, v35, s39
    v_mfma_f32_16x16x32_bf16 v[212:215], a[168:171], a[172:175], v[212:215]
    ds_read_b32 a218, v62
    ds_read_b32 a219, v63
    v_mfma_f32_16x16x32_bf16 v[216:219], a[64:67], a[144:147], v[216:219]
    ds_read_b128 a[204:207], v43 offset:45056
    v_mfma_f32_16x16x32_bf16 v[216:219], a[168:171], a[164:167], v[216:219]
    buffer_load_dwordx2 v[114:115], v34, s[12:15], s49 offen sc1
    v_mfma_f32_16x16x32_bf16 v[220:223], a[64:67], a[244:247], v[220:223]
    s_waitcnt vmcnt(14)
    v_bitop3_b32 v49, v49, v51, s76 bitop3:0x7e
    v_perm_b32 v56, v120, v35, s36
    v_mfma_f32_16x16x32_bf16 v[220:223], a[168:171], a[32:35], v[220:223]
    ds_read_b32 a232, v56
    v_cmp_ne_u32 vcc, 0, v49
    v_mfma_f32_16x16x32_bf16 v[224:227], a[132:135], a[104:107], v[224:227]
    ds_read_b128 a[48:51], v42 offset:47104
    v_perm_b32 v57, v120, v35, s37
    v_mfma_f32_16x16x32_bf16 v[224:227], a[184:187], a[4:7], v[224:227]
    ds_read_b32 a233, v57
    s_cbranch_vccnz L_slow4_2
L_back4_2:
    v_mfma_f32_16x16x32_bf16 v[228:231], a[132:135], a[12:15], v[228:231]
    v_perm_b32 v58, v120, v35, s38
    v_perm_b32 v59, v120, v35, s39
    v_mfma_f32_16x16x32_bf16 v[228:231], a[184:187], a[20:23], v[228:231]
    s_mov_b32 s50, 102400
    ds_read_b128 a[8:11], v43 offset:47104
    ds_read_b32 a234, v58
    v_mfma_f32_16x16x32_bf16 v[232:235], a[132:135], a[24:27], v[232:235]
    ds_read_b32 a235, v59
    v_perm_b32 v60, v124, v35, s36
    v_perm_b32 v61, v124, v35, s37
    v_mfma_f32_16x16x32_bf16 v[232:235], a[184:187], a[36:39], v[232:235]
    ds_read_b32 a192, v60
    ds_read_b32 a193, v61
    v_mfma_f32_16x16x32_bf16 v[236:239], a[132:135], a[44:47], v[236:239]
    buffer_load_dwordx4 v[68:71], v33, s[12:15], s50 offen sc1
    v_mfma_f32_16x16x32_bf16 v[236:239], a[184:187], a[56:59], v[236:239]
    s_mov_b32 s69, 107520
    v_perm_b32 v62, v124, v35, s38
    v_perm_b32 v63, v124, v35, s39
    v_mfma_f32_16x16x32_bf16 v[240:243], a[132:135], a[112:115], v[240:243]
    ds_read_b32 a194, v62
    ds_read_b32 a195, v63
    v_perm_b32 v56, v121, v35, s36
    v_mfma_f32_16x16x32_bf16 v[240:243], a[184:187], a[72:75], v[240:243]
    s_waitcnt vmcnt(13) lgkmcnt(6)
    ds_read_b32 a200, v56
    v_mfma_f32_16x16x32_bf16 v[244:247], a[132:135], a[128:131], v[244:247]
    buffer_load_dwordx4 v[80:83], v33, s[12:15], s69 offen sc1
    v_mfma_f32_16x16x32_bf16 v[244:247], a[184:187], a[172:175], v[244:247]
    s_add_u32 s56, s55, 1536
    v_bitop3_b32 v55, v55, v67, s76 bitop3:0x7e
    v_perm_b32 v57, v121, v35, s37
    v_mfma_f32_16x16x32_bf16 v[248:251], a[132:135], a[144:147], v[248:251]
    s_barrier
    v_mfma_f32_16x16x32_bf16 v[248:251], a[184:187], a[164:167], v[248:251]
    s_add_u32 m0, s57, 32768
    ds_read_b32 a201, v57
    v_cmp_ne_u32 vcc, 0, v55
    v_mfma_f32_16x16x32_bf16 v[252:255], a[132:135], a[244:247], v[252:255]
    v_perm_b32 v58, v121, v35, s38
    v_perm_b32 v59, v121, v35, s39
    v_mfma_f32_16x16x32_bf16 v[252:255], a[184:187], a[32:35], v[252:255]
    ds_read_b32 a202, v58
    ds_read_b32 a203, v59
    v_mfma_f32_16x16x32_bf16 v[128:131], a[80:83], a[84:87], v[128:131]
    buffer_load_dwordx4 v36, s[8:11], s56 offen offset:0 lds
    v_mfma_f32_16x16x32_bf16 v[128:131], a[96:99], a[92:95], v[128:131]
    v_perm_b32 v60, v125, v35, s36
    s_cbranch_vccnz L_slow4_1
L_back4_1:
    v_mfma_f32_16x16x32_bf16 v[132:135], a[80:83], a[100:103], v[132:135]
    ds_read_b32 a208, v60
    v_perm_b32 v61, v125, v35, s37
    v_perm_b32 v62, v125, v35, s38
    v_mfma_f32_16x16x32_bf16 v[132:135], a[96:99], a[116:119], v[132:135]
    ds_read_b32 a209, v61
    ds_read_b32 a210, v62
    v_perm_b32 v63, v125, v35, s39
    v_mfma_f32_16x16x32_bf16 v[136:139], a[80:83], a[124:127], v[136:139]
    ds_read_b32 a211, v63
    v_perm_b32 v56, v122, v35, s36
    v_mfma_f32_16x16x32_bf16 v[136:139], a[96:99], a[148:151], v[136:139]
    ds_read_b32 a212, v56
    v_perm_b32 v57, v122, v35, s37
    v_mfma_f32_16x16x32_bf16 v[140:143], a[80:83], a[156:159], v[140:143]
    ds_read_b32 a213, v57
    v_perm_b32 v58, v122, v35, s38
    v_mfma_f32_16x16x32_bf16 v[140:143], a[96:99], a[160:163], v[140:143]
    ds_read_b32 a214, v58
    ds_read_b128 a[220:223], v44 offset:0
    v_mfma_f32_16x16x32_bf16 v[144:147], a[80:83], a[176:179], v[144:147]
    buffer_load_dwordx4 v37, s[8:11], s56 offen offset:1024 lds
    v_mfma_f32_16x16x32_bf16 v[144:147], a[96:99], a[180:183], v[144:147]
    v_perm_b32 v59, v122, v35, s39
    v_perm_b32 v60, v126, v35, s36
    v_mfma_f32_16x16x32_bf16 v[148:151], a[80:83], a[88:91], v[148:151]
    ds_read_b32 a215, v59
    ds_read_b32 a224, v60
    v_mfma_f32_16x16x32_bf16 v[148:151], a[96:99], a[188:191], v[148:151]
    v_perm_b32 v61, v126, v35, s37
    v_perm_b32 v62, v126, v35, s38
    v_mfma_f32_16x16x32_bf16 v[152:155], a[80:83], a[196:199], v[152:155]
    ds_read_b128 a[228:231], v45 offset:0
    ds_read_b32 a225, v61
    v_mfma_f32_16x16x32_bf16 v[152:155], a[96:99], a[204:207], v[152:155]
    ds_read_b128 a[236:239], v44 offset:2048
    ds_read_b32 a226, v62
    v_mfma_f32_16x16x32_bf16 v[156:159], a[80:83], a[48:51], v[156:159]
    v_perm_b32 v63, v126, v35, s39
    v_perm_b32 v56, v48, v35, s36
    v_mfma_f32_16x16x32_bf16 v[156:159], a[96:99], a[8:11], v[156:159]
    ds_read_b128 a[240:243], v45 offset:2048
    ds_read_b32 a227, v63
    v_mfma_f32_16x16x32_bf16 v[160:163], a[108:111], a[84:87], v[160:163]
    buffer_load_dwordx4 v38, s[8:11], s56 offen offset:2048 lds
    v_mfma_f32_16x16x32_bf16 v[160:163], a[120:123], a[92:95], v[160:163]
    ds_read_b32 a248, v56
    v_perm_b32 v57, v48, v35, s37
    v_mfma_f32_16x16x32_bf16 v[164:167], a[108:111], a[100:103], v[164:167]
    ds_read_b128 a[252:255], v44 offset:4096
    ds_read_b32 a249, v57
    v_mfma_f32_16x16x32_bf16 v[164:167], a[120:123], a[116:119], v[164:167]
    v_perm_b32 v58, v48, v35, s38
    v_perm_b32 v59, v48, v35, s39
    v_mfma_f32_16x16x32_bf16 v[168:171], a[108:111], a[124:127], v[168:171]
    ds_read_b32 a250, v58
    ds_read_b32 a251, v59
    v_mfma_f32_16x16x32_bf16 v[168:171], a[120:123], a[148:151], v[168:171]
    ds_read_b128 a[16:19], v45 offset:4096
    v_perm_b32 v60, v50, v35, s36
    v_mfma_f32_16x16x32_bf16 v[172:175], a[108:111], a[156:159], v[172:175]
    ds_read_b32 a40, v60
    v_perm_b32 v61, v50, v35, s37
    v_mfma_f32_16x16x32_bf16 v[172:175], a[120:123], a[160:163], v[172:175]
    ds_read_b32 a41, v61
    ds_read_b128 a[52:55], v44 offset:6144
    v_mfma_f32_16x16x32_bf16 v[176:179], a[108:111], a[176:179], v[176:179]
    buffer_load_dwordx4 v39, s[8:11], s56 offen offset:3072 lds
    v_mfma_f32_16x16x32_bf16 v[176:179], a[120:123], a[180:183], v[176:179]
    v_perm_b32 v62, v50, v35, s38
    v_perm_b32 v63, v50, v35, s39
    v_mfma_f32_16x16x32_bf16 v[180:183], a[108:111], a[88:91], v[180:183]
    s_add_u32 s3, s55, 1664
    ds_read_b32 a42, v62
    ds_read_b32 a43, v63
    v_mfma_f32_16x16x32_bf16 v[180:183], a[120:123], a[188:191], v[180:183]
    s_mov_b32 s40, 122880
    ds_read_b128 a[68:71], v45 offset:6144
    v_perm_b32 v56, v52, v35, s36
    v_mfma_f32_16x16x32_bf16 v[184:187], a[108:111], a[196:199], v[184:187]
    s_waitcnt vmcnt(12)
    ds_read_b32 a152, v56
    ds_read_b128 a[140:143], v44 offset:8192
    v_mfma_f32_16x16x32_bf16 v[184:187], a[120:123], a[204:207], v[184:187]
    buffer_load_dwordx2 v[72:73], v34, s[12:15], s40 offen sc1
    v_mfma_f32_16x16x32_bf16 v[188:191], a[108:111], a[48:51], v[188:191]
    s_add_u32 m0, s57, 49152
    v_bitop3_b32 v99, v99, v107, s76 bitop3:0x7e
    v_perm_b32 v57, v52, v35, s37
    v_mfma_f32_16x16x32_bf16 v[188:191], a[120:123], a[8:11], v[188:191]
    s_mov_b32 s41, 128000
    ds_read_b32 a153, v57
    v_cmp_ne_u32 vcc, 0, v99
    v_mfma_f32_16x16x32_bf16 v[192:195], a[136:139], a[84:87], v[192:195]
    ds_read_b128 a[60:63], v45 offset:8192
    v_mfma_f32_16x16x32_bf16 v[192:195], a[216:219], a[92:95], v[192:195]
    buffer_load_dwordx2 v[74:75], v34, s[12:15], s41 offen sc1
    v_mfma_f32_16x16x32_bf16 v[196:199], a[136:139], a[100:103], v[196:199]
    v_perm_b32 v58, v52, v35, s38
    s_cbranch_vccnz L_slow5_0
L_back5_0:
    v_mfma_f32_16x16x32_bf16 v[196:199], a[216:219], a[116:119], v[196:199]
    ds_read_b32 a154, v58
    v_perm_b32 v59, v52, v35, s39
    v_mfma_f32_16x16x32_bf16 v[200:203], a[136:139], a[124:127], v[200:203]
    ds_read_b128 a[76:79], v44 offset:10240
    ds_read_b32 a155, v59
    v_mfma_f32_16x16x32_bf16 v[200:203], a[216:219], a[148:151], v[200:203]
    buffer_load_dwordx4 v36, s[8:11], s3 offen offset:0 lds
    v_mfma_f32_16x16x32_bf16 v[204:207], a[136:139], a[156:159], v[204:207]
    s_mov_b32 s42, 122880
    v_perm_b32 v60, v64, v35, s36
    v_perm_b32 v61, v64, v35, s37
    v_mfma_f32_16x16x32_bf16 v[204:207], a[216:219], a[160:163], v[204:207]
    ds_read_b128 a[0:3], v45 offset:10240
    ds_read_b32 a28, v60
    v_mfma_f32_16x16x32_bf16 v[208:211], a[136:139], a[176:179], v[208:211]
    ds_read_b32 a29, v61
    ds_read_b128 a[64:67], v44 offset:12288
    v_mfma_f32_16x16x32_bf16 v[208:211], a[216:219], a[180:183], v[208:211]
    buffer_load_dwordx4 v[76:79], v32, s[12:15], s42 offen sc1
    v_mfma_f32_16x16x32_bf16 v[212:215], a[136:139], a[88:91], v[212:215]
    s_mov_b32 s43, 128000
    v_perm_b32 v62, v64, v35, s38
    v_perm_b32 v63, v64, v35, s39
    v_mfma_f32_16x16x32_bf16 v[212:215], a[216:219], a[188:191], v[212:215]
    ds_read_b32 a30, v62
    ds_read_b32 a31, v63
    v_perm_b32 v56, v53, v35, s36
    v_mfma_f32_16x16x32_bf16 v[216:219], a[136:139], a[196:199], v[216:219]
    ds_read_b32 a104, v56
    ds_read_b128 a[168:171], v45 offset:12288
    v_mfma_f32_16x16x32_bf16 v[216:219], a[216:219], a[204:207], v[216:219]
    buffer_load_dwordx4 v[88:91], v32, s[12:15], s43 offen sc1
    v_mfma_f32_16x16x32_bf16 v[220:223], a[136:139], a[48:51], v[220:223]
    v_perm_b32 v57, v53, v35, s37
    v_perm_b32 v58, v53, v35, s38
    v_mfma_f32_16x16x32_bf16 v[220:223], a[216:219], a[8:11], v[220:223]
    s_waitcnt lgkmcnt(8)
    ds_read_b32 a105, v57
    ds_read_b32 a106, v58
    v_mfma_f32_16x16x32_bf16 v[128:131], a[232:235], a[220:223], v[128:131]
    s_add_u32 s56, s55, 1792
    ds_read_b128 a[4:7], v44 offset:14336
    v_mfma_f32_16x16x32_bf16 v[128:131], a[192:195], a[228:231], v[128:131]
    buffer_load_dwordx4 v37, s[8:11], s3 offen offset:1024 lds
    v_mfma_f32_16x16x32_bf16 v[132:135], a[232:235], a[236:239], v[132:135]
    v_perm_b32 v59, v53, v35, s39
    v_perm_b32 v60, v65, v35, s36
    v_mfma_f32_16x16x32_bf16 v[132:135], a[192:195], a[240:243], v[132:135]
    s_mov_b32 s44, 122880
    ds_read_b128 a[12:15], v45 offset:14336
    ds_read_b32 a107, v59
    v_mfma_f32_16x16x32_bf16 v[136:139], a[232:235], a[252:255], v[136:139]
    ds_read_b32 a20, v60
    v_perm_b32 v61, v65, v35, s37
    v_mfma_f32_16x16x32_bf16 v[136:139], a[192:195], a[16:19], v[136:139]
    ds_read_b32 a21, v61
    ds_read_b128 a[24:27], v46 offset:0
    v_mfma_f32_16x16x32_bf16 v[140:143], a[232:235], a[52:55], v[140:143]
    buffer_load_dwordx4 v[92:95], v33, s[12:15], s44 offen sc1
    v_mfma_f32_16x16x32_bf16 v[140:143], a[192:195], a[68:71], v[140:143]
    s_mov_b32 s45, 128000
    v_perm_b32 v62, v65, v35, s38
    v_perm_b32 v63, v65, v35, s39
    v_mfma_f32_16x16x32_bf16 v[144:147], a[232:235], a[140:143], v[144:147]
    ds_read_b32 a22, v62
    ds_read_b32 a23, v63
    v_perm_b32 v56, v54, v35, s36
    v_mfma_f32_16x16x32_bf16 v[144:147], a[192:195], a[60:63], v[144:147]
    s_waitcnt lgkmcnt(7)
    ds_read_b32 a44, v56
    ds_read_b128 a[36:39], v47 offset:0
    v_mfma_f32_16x16x32_bf16 v[148:151], a[232:235], a[76:79], v[148:151]
    buffer_load_dwordx4 v[84:87], v33, s[12:15], s45 offen sc1
    v_mfma_f32_16x16x32_bf16 v[148:151], a[192:195], a[0:3], v[148:151]
    v_perm_b32 v57, v54, v35, s37
    v_perm_b32 v58, v54, v35, s38
    v_mfma_f32_16x16x32_bf16 v[152:155], a[232:235], a[64:67], v[152:155]
    ds_read_b32 a45, v57
    ds_read_b32 a46, v58
    v_mfma_f32_16x16x32_bf16 v[152:155], a[192:195], a[168:171], v[152:155]
    s_waitcnt lgkmcnt(8)
    ds_read_b128 a[56:59], v46 offset:2048
    v_mfma_f32_16x16x32_bf16 v[156:159], a[232:235], a[4:7], v[156:159]
    buffer_load_dwordx4 v38, s[8:11], s3 offen offset:2048 lds
    v_mfma_f32_16x16x32_bf16 v[156:159], a[192:195], a[12:15], v[156:159]
    v_perm_b32 v59, v54, v35, s39
    v_perm_b32 v60, v66, v35, s36
    v_mfma_f32_16x16x32_bf16 v[160:163], a[200:203], a[220:223], v[160:163]
    ds_read_b32 a47, v59
    ds_read_b32 a112, v60
    v_perm_b32 v61, v66, v35, s37
    v_mfma_f32_16x16x32_bf16 v[160:163], a[208:211], a[228:231], v[160:163]
    ds_read_b32 a113, v61
    v_perm_b32 v62, v66, v35, s38
    v_mfma_f32_16x16x32_bf16 v[164:167], a[200:203], a[236:239], v[164:167]
    ds_read_b32 a114, v62
    v_perm_b32 v63, v66, v35, s39
    v_mfma_f32_16x16x32_bf16 v[164:167], a[208:211], a[240:243], v[164:167]
    s_waitcnt vmcnt(15)
    ds_read_b32 a115, v63
    ds_read_b128 a[72:75], v47 offset:2048
    v_mfma_f32_16x16x32_bf16 v[168:171], a[200:203], a[252:255], v[168:171]
    buffer_load_dwordx4 v39, s[8:11], s3 offen offset:3072 lds
    v_mfma_f32_16x16x32_bf16 v[168:171], a[208:211], a[16:19], v[168:171]
    s_add_u32 m0, s57, 65536
    v_perm_b32 v56, v96, v35, s36
    v_bitop3_b32 v113, v113, v115, s76 bitop3:0x7e
    v_mfma_f32_16x16x32_bf16 v[172:175], a[200:203], a[52:55], v[172:175]
    ds_read_b32 a128, v56
    v_cmp_ne_u32 vcc, 0, v113
    v_mfma_f32_16x16x32_bf16 v[172:175], a[208:211], a[68:71], v[172:175]
    ds_read_b128 a[172:175], v46 offset:4096
    v_mfma_f32_16x16x32_bf16 v[176:179], a[200:203], a[140:143], v[176:179]
    buffer_load_dwordx4 v[100:103], v22, s[32:35], 0 offen
    v_mfma_f32_16x16x32_bf16 v[176:179], a[208:211], a[60:63], v[176:179]
    v_perm_b32 v57, v96, v35, s37
    s_cbranch_vccnz L_slow5_2
L_back5_2:
    v_mfma_f32_16x16x32_bf16 v[180:183], a[200:203], a[76:79], v[180:183]
    ds_read_b32 a129, v57
    v_perm_b32 v58, v96, v35, s38
    v_perm_b32 v59, v96, v35, s39
    v_mfma_f32_16x16x32_bf16 v[180:183], a[208:211], a[0:3], v[180:183]
    ds_read_b32 a130, v58
    ds_read_b32 a131, v59
    v_mfma_f32_16x16x32_bf16 v[184:187], a[200:203], a[64:67], v[184:187]
    buffer_load_dwordx2 v[108:109], v22, s[32:35], 0 offen offset:16
    v_mfma_f32_16x16x32_bf16 v[184:187], a[208:211], a[168:171], v[184:187]
    v_perm_b32 v60, v104, v35, s36
    v_perm_b32 v61, v104, v35, s37
    v_mfma_f32_16x16x32_bf16 v[188:191], a[200:203], a[4:7], v[188:191]
    ds_read_b32 a144, v60
    ds_read_b32 a145, v61
    v_mfma_f32_16x16x32_bf16 v[188:191], a[208:211], a[12:15], v[188:191]
    v_perm_b32 v62, v104, v35, s38
    v_perm_b32 v63, v104, v35, s39
    v_mfma_f32_16x16x32_bf16 v[192:195], a[212:215], a[220:223], v[192:195]
    s_add_u32 s3, s55, 1920
    ds_read_b128 a[164:167], v47 offset:4096
    ds_read_b32 a146, v62
    v_mfma_f32_16x16x32_bf16 v[192:195], a[224:227], a[228:231], v[192:195]
    s_waitcnt vmcnt(16)
    ds_read_b128 a[132:135], v46 offset:6144
    ds_read_b32 a147, v63
    v_mfma_f32_16x16x32_bf16 v[196:199], a[212:215], a[236:239], v[196:199]
    buffer_load_dword v110, v23, s[32:35], 0 offen
    v_mfma_f32_16x16x32_bf16 v[196:199], a[224:227], a[240:243], v[196:199]
    ds_read_b128 a[244:247], v47 offset:6144
    v_perm_b32 v56, v97, v35, s36
    v_bitop3_b32 v71, v71, v83, s76 bitop3:0x7e
    v_mfma_f32_16x16x32_bf16 v[200:203], a[212:215], a[252:255], v[200:203]
    ds_read_b128 a[184:187], v46 offset:8192
    ds_read_b32 a32, v56
    v_cmp_ne_u32 vcc, 0, v71
    v_mfma_f32_16x16x32_bf16 v[200:203], a[224:227], a[16:19], v[200:203]
    ds_read_b128 a[80:83], v47 offset:8192
    v_perm_b32 v57, v97, v35, s37
    v_perm_b32 v58, v97, v35, s38
    v_mfma_f32_16x16x32_bf16 v[204:207], a[212:215], a[52:55], v[204:207]
    ds_read_b128 a[96:99], v46 offset:10240
    ds_read_b32 a33, v57
    v_mfma_f32_16x16x32_bf16 v[204:207], a[224:227], a[68:71], v[204:207]
    ds_read_b128 a[108:111], v47 offset:10240
    ds_read_b32 a34, v58
    v_perm_b32 v59, v97, v35, s39
    v_mfma_f32_16x16x32_bf16 v[208:211], a[212:215], a[140:143], v[208:211]
    ds_read_b32 a35, v59
    s_cbranch_vccnz L_slow5_1
L_back5_1:
    v_mfma_f32_16x16x32_bf16 v[208:211], a[224:227], a[60:63], v[208:211]
    v_perm_b32 v60, v105, v35, s36
    v_perm_b32 v61, v105, v35, s37
    v_mfma_f32_16x16x32_bf16 v[212:215], a[212:215], a[76:79], v[212:215]
    ds_read_b128 a[120:123], v46 offset:12288
    ds_read_b32 a84, v60
    v_mfma_f32_16x16x32_bf16 v[212:215], a[224:227], a[0:3], v[212:215]
    ds_read_b32 a85, v61
    v_perm_b32 v62, v105, v35, s38
    v_mfma_f32_16x16x32_bf16 v[216:219], a[212:215], a[64:67], v[216:219]
    ds_read_b32 a86, v62
    v_perm_b32 v63, v105, v35, s39
    v_mfma_f32_16x16x32_bf16 v[216:219], a[224:227], a[168:171], v[216:219]
    ds_read_b128 a[92:95], v47 offset:12288
    ds_read_b32 a87, v63
    v_mfma_f32_16x16x32_bf16 v[220:223], a[212:215], a[4:7], v[220:223]
    v_perm_b32 v56, v98, v35, s36
    v_perm_b32 v57, v98, v35, s37
    v_mfma_f32_16x16x32_bf16 v[220:223], a[224:227], a[12:15], v[220:223]
    ds_read_b32 a100, v56
    ds_read_b32 a101, v57
    v_mfma_f32_16x16x32_bf16 v[224:227], a[248:251], a[220:223], v[224:227]
    ds_read_b128 a[116:119], v46 offset:14336
    v_perm_b32 v58, v98, v35, s38
    v_mfma_f32_16x16x32_bf16 v[224:227], a[40:43], a[228:231], v[224:227]
    ds_read_b32 a102, v58
    v_perm_b32 v59, v98, v35, s39
    v_mfma_f32_16x16x32_bf16 v[228:231], a[248:251], a[236:239], v[228:231]
    ds_read_b32 a103, v59
    v_perm_b32 v60, v106, v35, s36
    v_mfma_f32_16x16x32_bf16 v[228:231], a[40:43], a[240:243], v[228:231]
    ds_read_b128 a[124:127], v47 offset:14336
    ds_read_b32 a148, v60
    v_mfma_f32_16x16x32_bf16 v[232:235], a[248:251], a[252:255], v[232:235]
    v_perm_b32 v61, v106, v35, s37
    v_perm_b32 v62, v106, v35, s38
    v_mfma_f32_16x16x32_bf16 v[232:235], a[40:43], a[16:19], v[232:235]
    ds_read_b32 a149, v61
    ds_read_b32 a150, v62
    v_mfma_f32_16x16x32_bf16 v[236:239], a[248:251], a[52:55], v[236:239]
    v_perm_b32 v63, v106, v35, s39
    v_perm_b32 v56, v112, v35, s36
    v_mfma_f32_16x16x32_bf16 v[236:239], a[40:43], a[68:71], v[236:239]
    ds_read_b32 a151, v63
    ds_read_b32 a156, v56
    v_mfma_f32_16x16x32_bf16 v[240:243], a[248:251], a[140:143], v[240:243]
    v_perm_b32 v57, v112, v35, s37
    v_perm_b32 v58, v112, v35, s38
    v_mfma_f32_16x16x32_bf16 v[240:243], a[40:43], a[60:63], v[240:243]
    ds_read_b32 a157, v57
    ds_read_b32 a158, v58
    v_mfma_f32_16x16x32_bf16 v[244:247], a[248:251], a[76:79], v[244:247]
    v_perm_b32 v59, v112, v35, s39
    v_perm_b32 v60, v114, v35, s36
    v_mfma_f32_16x16x32_bf16 v[244:247], a[40:43], a[0:3], v[244:247]
    s_waitcnt lgkmcnt(7)
    ds_read_b32 a159, v59
    ds_read_b32 a160, v60
    v_mfma_f32_16x16x32_bf16 v[248:251], a[248:251], a[64:67], v[248:251]
    s_barrier
    v_mfma_f32_16x16x32_bf16 v[248:251], a[40:43], a[168:171], v[248:251]
    buffer_load_dwordx4 v36, s[8:11], s56 offen offset:0 lds
    v_mfma_f32_16x16x32_bf16 v[252:255], a[248:251], a[4:7], v[252:255]
    v_perm_b32 v61, v114, v35, s37
    v_perm_b32 v62, v114, v35, s38
    v_mfma_f32_16x16x32_bf16 v[252:255], a[40:43], a[12:15], v[252:255]
    ds_read_b32 a161, v61
    ds_read_b32 a162, v62
    v_mfma_f32_16x16x32_bf16 v[128:131], a[152:155], a[24:27], v[128:131]
    s_waitcnt vmcnt(12)
    v_perm_b32 v63, v114, v35, s39
    v_perm_b32 v56, v68, v35, s36
L_pad3:
    s_cbranch_execz L_pad4
    v_mfma_f32_16x16x32_bf16 v[128:131], a[28:31], a[36:39], v[128:131]
    ds_read_b32 a163, v63
    ds_read_b32 a176, v56
    v_bitop3_b32 v73, v73, v75, s76 bitop3:0x7e
    v_mfma_f32_16x16x32_bf16 v[132:135], a[152:155], a[56:59], v[132:135]
    ds_read_b128 a[180:183], v40 offset:0
    v_mfma_f32_16x16x32_bf16 v[132:135], a[28:31], a[72:75], v[132:135]
    buffer_load_dwordx4 v37, s[8:11], s56 offen offset:1024 lds
    v_mfma_f32_16x16x32_bf16 v[136:139], a[152:155], a[172:175], v[136:139]
    s_mov_b32 s48, 143360
    v_cmp_ne_u32 vcc, 0, v73
    v_perm_b32 v57, v68, v35, s37
    v_mfma_f32_16x16x32_bf16 v[136:139], a[28:31], a[164:167], v[136:139]
    ds_read_b32 a177, v57
    v_perm_b32 v58, v68, v35, s38
    v_mfma_f32_16x16x32_bf16 v[140:143], a[152:155], a[132:135], v[140:143]
    ds_read_b32 a178, v58
    s_cbranch_vccnz L_slow6_2
L_back6_2:
    v_mfma_f32_16x16x32_bf16 v[140:143], a[28:31], a[244:247], v[140:143]
    buffer_load_dwordx2 v[116:117], v34, s[12:15], s48 offen sc1
    v_mfma_f32_16x16x32_bf16 v[144:147], a[152:155], a[184:187], v[144:147]
    s_mov_b32 s49, 148480
    v_perm_b32 v59, v68, v35, s39
    v_perm_b32 v60, v80, v35, s36
    v_mfma_f32_16x16x32_bf16 v[144:147], a[28:31], a[80:83], v[144:147]
    ds_read_b32 a179, v59
    ds_read_b32 a88, v60
    v_mfma_f32_16x16x32_bf16 v[148:151], a[152:155], a[96:99], v[148:151]
    ds_read_b128 a[188:191], v41 offset:0
    v_mfma_f32_16x16x32_bf16 v[148:151], a[28:31], a[108:111], v[148:151]
    buffer_load_dwordx2 v[118:119], v34, s[12:15], s49 offen sc1
    v_mfma_f32_16x16x32_bf16 v[152:155], a[152:155], a[120:123], v[152:155]
    v_perm_b32 v61, v80, v35, s37
    v_perm_b32 v62, v80, v35, s38
    v_mfma_f32_16x16x32_bf16 v[152:155], a[28:31], a[92:95], v[152:155]
    ds_read_b128 a[196:199], v40 offset:2048
    ds_read_b32 a89, v61
    v_mfma_f32_16x16x32_bf16 v[156:159], a[152:155], a[116:119], v[156:159]
    ds_read_b32 a90, v62
    ds_read_b128 a[204:207], v41 offset:2048
    v_mfma_f32_16x16x32_bf16 v[156:159], a[28:31], a[124:127], v[156:159]
    buffer_load_dwordx4 v38, s[8:11], s56 offen offset:2048 lds
    v_mfma_f32_16x16x32_bf16 v[160:163], a[104:107], a[24:27], v[160:163]
    s_mov_b32 s50, 143360
    v_perm_b32 v63, v80, v35, s39
    v_perm_b32 v56, v69, v35, s36
    v_mfma_f32_16x16x32_bf16 v[160:163], a[20:23], a[36:39], v[160:163]
    ds_read_b32 a91, v63
    ds_read_b32 a136, v56
    v_mfma_f32_16x16x32_bf16 v[164:167], a[104:107], a[56:59], v[164:167]
    s_waitcnt vmcnt(13)
    ds_read_b128 a[48:51], v40 offset:4096
    v_mfma_f32_16x16x32_bf16 v[164:167], a[20:23], a[72:75], v[164:167]
    buffer_load_dwordx4 v[120:123], v32, s[12:15], s50 offen sc1
    v_mfma_f32_16x16x32_bf16 v[168:171], a[104:107], a[172:175], v[168:171]
    s_mov_b32 s69, 148480
    v_bitop3_b32 v79, v79, v91, s76 bitop3:0x7e
    v_perm_b32 v57, v69, v35, s37
    v_mfma_f32_16x16x32_bf16 v[168:171], a[20:23], a[164:167], v[168:171]
    ds_read_b128 a[216:219], v41 offset:4096
    ds_read_b32 a137, v57
    v_cmp_ne_u32 vcc, 0, v79
    v_mfma_f32_16x16x32_bf16 v[172:175], a[104:107], a[132:135], v[172:175]
    ds_read_b128 a[8:11], v40 offset:6144
    v_mfma_f32_16x16x32_bf16 v[172:175], a[20:23], a[244:247], v[172:175]
    buffer_load_dwordx4 v[124:127], v32, s[12:15], s69 offen sc1
    v_mfma_f32_16x16x32_bf16 v[176:179], a[104:107], a[184:187], v[176:179]
    v_perm_b32 v58, v69, v35, s38
    s_cbranch_vccnz L_slow6_0
L_back6_0:
    v_mfma_f32_16x16x32_bf16 v[176:179], a[20:23], a[80:83], v[176:179]
    ds_read_b32 a138, v58
    v_perm_b32 v59, v69, v35, s39
    v_mfma_f32_16x16x32_bf16 v[180:183], a[104:107], a[96:99], v[180:183]
    ds_read_b32 a139, v59
    ds_read_b128 a[232:235], v41 offset:6144
    v_mfma_f32_16x16x32_bf16 v[180:183], a[20:23], a[108:111], v[180:183]
    buffer_load_dwordx4 v39, s[8:11], s56 offen offset:3072 lds
    v_mfma_f32_16x16x32_bf16 v[184:187], a[104:107], a[120:123], v[184:187]
    s_add_u32 m0, s57, 81920
    v_perm_b32 v60, v81, v35, s36
    v_perm_b32 v61, v81, v35, s37
    v_mfma_f32_16x16x32_bf16 v[184:187], a[20:23], a[92:95], v[184:187]
    s_mov_b32 s40, 143360
    ds_read_b32 a192, v60
    ds_read_b32 a193, v61
    v_mfma_f32_16x16x32_bf16 v[188:191], a[104:107], a[116:119], v[188:191]
    ds_read_b128 a[200:203], v40 offset:8192
    v_perm_b32 v62, v81, v35, s38
    v_mfma_f32_16x16x32_bf16 v[188:191], a[20:23], a[124:127], v[188:191]
    ds_read_b32 a194, v62
    ds_read_b128 a[208:211], v41 offset:8192
    v_mfma_f32_16x16x32_bf16 v[192:195], a[44:47], a[24:27], v[192:195]
    buffer_load_dwordx4 v[48:51], v33, s[12:15], s40 offen sc1
    v_mfma_f32_16x16x32_bf16 v[192:195], a[112:115], a[36:39], v[192:195]
    s_mov_b32 s41, 148480
    v_perm_b32 v63, v81, v35, s39
    v_perm_b32 v56, v70, v35, s36
    v_mfma_f32_16x16x32_bf16 v[196:199], a[44:47], a[56:59], v[196:199]
    ds_read_b32 a195, v63
    ds_read_b32 a212, v56
    v_mfma_f32_16x16x32_bf16 v[196:199], a[112:115], a[72:75], v[196:199]
    ds_read_b128 a[224:227], v40 offset:10240
    v_mfma_f32_16x16x32_bf16 v[200:203], a[44:47], a[172:175], v[200:203]
    buffer_load_dwordx4 v[52:55], v33, s[12:15], s41 offen sc1
    v_mfma_f32_16x16x32_bf16 v[200:203], a[112:115], a[164:167], v[200:203]
    s_waitcnt vmcnt(15)
    v_bitop3_b32 v95, v95, v87, s76 bitop3:0x7e
    v_perm_b32 v57, v70, v35, s37
    v_mfma_f32_16x16x32_bf16 v[204:207], a[44:47], a[132:135], v[204:207]
    ds_read_b32 a213, v57
    v_cmp_ne_u32 vcc, 0, v95
    v_perm_b32 v58, v70, v35, s38
    v_mfma_f32_16x16x32_bf16 v[204:207], a[112:115], a[244:247], v[204:207]
    ds_read_b128 a[220:223], v41 offset:10240
    ds_read_b32 a214, v58
    v_mfma_f32_16x16x32_bf16 v[208:211], a[44:47], a[184:187], v[208:211]
    buffer_load_dwordx4 v36, s[8:11], s3 offen offset:0 lds
    v_mfma_f32_16x16x32_bf16 v[208:211], a[112:115], a[80:83], v[208:211]
    v_perm_b32 v59, v70, v35, s39
    s_cbranch_vccnz L_slow6_1
L_back6_1:
    v_mfma_f32_16x16x32_bf16 v[212:215], a[44:47], a[96:99], v[212:215]
    ds_read_b128 a[228:231], v40 offset:12288
    ds_read_b32 a215, v59
    v_perm_b32 v60, v82, v35, s36
    v_mfma_f32_16x16x32_bf16 v[212:215], a[112:115], a[108:111], v[212:215]
    ds_read_b32 a236, v60
    v_perm_b32 v61, v82, v35, s37
    v_perm_b32 v62, v82, v35, s38
    v_mfma_f32_16x16x32_bf16 v[216:219], a[44:47], a[120:123], v[216:219]
    ds_read_b32 a237, v61
    ds_read_b32 a238, v62
    v_mfma_f32_16x16x32_bf16 v[216:219], a[112:115], a[92:95], v[216:219]
    ds_read_b128 a[240:243], v41 offset:12288
    v_mfma_f32_16x16x32_bf16 v[220:223], a[44:47], a[116:119], v[220:223]
    buffer_load_dwordx4 v37, s[8:11], s3 offen offset:1024 lds
    v_mfma_f32_16x16x32_bf16 v[220:223], a[112:115], a[124:127], v[220:223]
    s_waitcnt lgkmcnt(8)
    v_perm_b32 v63, v82, v35, s39
    v_perm_b32 v56, v72, v35, s36
    v_mfma_f32_16x16x32_bf16 v[128:131], a[128:131], a[180:183], v[128:131]
    ds_read_b128 a[252:255], v40 offset:14336
    ds_read_b32 a239, v63
    v_perm_b32 v57, v72, v35, s37
    v_mfma_f32_16x16x32_bf16 v[128:131], a[144:147], a[188:191], v[128:131]
    ds_read_b32 a16, v56
    ds_read_b32 a17, v57
    v_mfma_f32_16x16x32_bf16 v[132:135], a[128:131], a[196:199], v[132:135]
    v_perm_b32 v58, v72, v35, s38
    v_perm_b32 v59, v72, v35, s39
    v_mfma_f32_16x16x32_bf16 v[132:135], a[144:147], a[204:207], v[132:135]
    ds_read_b128 a[52:55], v41 offset:14336
    ds_read_b32 a18, v58
    v_mfma_f32_16x16x32_bf16 v[136:139], a[128:131], a[48:51], v[136:139]
    buffer_load_dwordx4 v38, s[8:11], s3 offen offset:2048 lds
    v_mfma_f32_16x16x32_bf16 v[136:139], a[144:147], a[216:219], v[136:139]
    ds_read_b32 a19, v59
    v_perm_b32 v60, v74, v35, s36
    v_mfma_f32_16x16x32_bf16 v[140:143], a[128:131], a[8:11], v[140:143]
    ds_read_b32 a68, v60
    v_perm_b32 v61, v74, v35, s37
    v_mfma_f32_16x16x32_bf16 v[140:143], a[144:147], a[232:235], v[140:143]
    ds_read_b32 a69, v61
    v_perm_b32 v62, v74, v35, s38
    v_mfma_f32_16x16x32_bf16 v[144:147], a[128:131], a[200:203], v[144:147]
    ds_read_b32 a70, v62
    v_perm_b32 v63, v74, v35, s39
    v_mfma_f32_16x16x32_bf16 v[144:147], a[144:147], a[208:211], v[144:147]
    s_waitcnt lgkmcnt(8)
    ds_read_b32 a71, v63
    ds_read_b128 a[140:143], v42 offset:0
    v_mfma_f32_16x16x32_bf16 v[148:151], a[128:131], a[224:227], v[148:151]
    buffer_load_dwordx4 v39, s[8:11], s3 offen offset:3072 lds
    v_mfma_f32_16x16x32_bf16 v[148:151], a[144:147], a[220:223], v[148:151]
    v_perm_b32 v56, v76, v35, s36
    v_perm_b32 v57, v76, v35, s37
    v_mfma_f32_16x16x32_bf16 v[152:155], a[128:131], a[228:231], v[152:155]
    ds_read_b32 a60, v56
    ds_read_b32 a61, v57
    v_mfma_f32_16x16x32_bf16 v[152:155], a[144:147], a[240:243], v[152:155]
    v_perm_b32 v58, v76, v35, s38
    v_perm_b32 v59, v76, v35, s39
    v_mfma_f32_16x16x32_bf16 v[156:159], a[128:131], a[252:255], v[156:159]
    s_waitcnt lgkmcnt(7)
    ds_read_b32 a62, v58
    ds_read_b32 a63, v59
    v_mfma_f32_16x16x32_bf16 v[156:159], a[144:147], a[52:55], v[156:159]
    v_perm_b32 v60, v88, v35, s36
    v_perm_b32 v61, v88, v35, s37
    v_mfma_f32_16x16x32_bf16 v[160:163], a[32:35], a[180:183], v[160:163]
    ds_read_b32 a76, v60
    ds_read_b32 a77, v61
    v_mfma_f32_16x16x32_bf16 v[160:163], a[84:87], a[188:191], v[160:163]
    ds_read_b128 a[0:3], v43 offset:0
    v_perm_b32 v62, v88, v35, s38
    v_mfma_f32_16x16x32_bf16 v[164:167], a[32:35], a[196:199], v[164:167]
    ds_read_b32 a78, v62
    v_perm_b32 v63, v88, v35, s39
    v_mfma_f32_16x16x32_bf16 v[164:167], a[84:87], a[204:207], v[164:167]
    ds_read_b32 a79, v63
    v_perm_b32 v56, v92, v35, s36
    v_mfma_f32_16x16x32_bf16 v[168:171], a[32:35], a[48:51], v[168:171]
    ds_read_b32 a168, v56
    ds_read_b128 a[64:67], v42 offset:2048
    v_mfma_f32_16x16x32_bf16 v[168:171], a[84:87], a[216:219], v[168:171]
    v_perm_b32 v57, v92, v35, s37
    v_perm_b32 v58, v92, v35, s38
    v_mfma_f32_16x16x32_bf16 v[172:175], a[32:35], a[8:11], v[172:175]
    ds_read_b32 a169, v57
    ds_read_b32 a170, v58
    v_mfma_f32_16x16x32_bf16 v[172:175], a[84:87], a[232:235], v[172:175]
    ds_read_b128 a[248:251], v43 offset:2048
    v_perm_b32 v59, v92, v35, s39
    v_mfma_f32_16x16x32_bf16 v[176:179], a[32:35], a[200:203], v[176:179]
    ds_read_b32 a171, v59
    ds_read_b128 a[4:7], v42 offset:4096
    v_mfma_f32_16x16x32_bf16 v[176:179], a[84:87], a[208:211], v[176:179]
    v_perm_b32 v60, v84, v35, s36
    v_perm_b32 v61, v84, v35, s37
    v_mfma_f32_16x16x32_bf16 v[180:183], a[32:35], a[224:227], v[180:183]
    ds_read_b32 a40, v60
    ds_read_b32 a41, v61
    v_mfma_f32_16x16x32_bf16 v[180:183], a[84:87], a[220:223], v[180:183]
    ds_read_b128 a[12:15], v43 offset:4096
    v_perm_b32 v62, v84, v35, s38
    v_mfma_f32_16x16x32_bf16 v[184:187], a[32:35], a[228:231], v[184:187]
    ds_read_b32 a42, v62
    v_perm_b32 v63, v84, v35, s39
    v_mfma_f32_16x16x32_bf16 v[184:187], a[84:87], a[240:243], v[184:187]
    ds_read_b32 a43, v63
    ds_read_b128 a[152:155], v42 offset:6144
    v_mfma_f32_16x16x32_bf16 v[188:191], a[32:35], a[252:255], v[188:191]
    v_perm_b32 v56, v77, v35, s36
    v_perm_b32 v57, v77, v35, s37
    v_mfma_f32_16x16x32_bf16 v[188:191], a[84:87], a[52:55], v[188:191]
    ds_read_b32 a28, v56
    ds_read_b32 a29, v57
    v_mfma_f32_16x16x32_bf16 v[192:195], a[100:103], a[180:183], v[192:195]
    ds_read_b128 a[104:107], v43 offset:6144
    v_perm_b32 v58, v77, v35, s38
    v_mfma_f32_16x16x32_bf16 v[192:195], a[148:151], a[188:191], v[192:195]
    ds_read_b32 a30, v58
    v_perm_b32 v59, v77, v35, s39
    v_mfma_f32_16x16x32_bf16 v[196:199], a[100:103], a[196:199], v[196:199]
    ds_read_b32 a31, v59
    ds_read_b128 a[20:23], v42 offset:8192
    v_mfma_f32_16x16x32_bf16 v[196:199], a[148:151], a[204:207], v[196:199]
    v_perm_b32 v60, v89, v35, s36
    v_perm_b32 v61, v89, v35, s37
    v_mfma_f32_16x16x32_bf16 v[200:203], a[100:103], a[48:51], v[200:203]
    ds_read_b128 a[24:27], v43 offset:8192
    ds_read_b32 a36, v60
    v_mfma_f32_16x16x32_bf16 v[200:203], a[148:151], a[216:219], v[200:203]
    ds_read_b128 a[56:59], v42 offset:10240
    ds_read_b32 a37, v61
    v_mfma_f32_16x16x32_bf16 v[204:207], a[100:103], a[8:11], v[204:207]
    v_perm_b32 v62, v89, v35, s38
    v_perm_b32 v63, v89, v35, s39
    v_mfma_f32_16x16x32_bf16 v[204:207], a[148:151], a[232:235], v[204:207]
    ds_read_b128 a[72:75], v43 offset:10240
    ds_read_b32 a38, v62
    v_mfma_f32_16x16x32_bf16 v[208:211], a[100:103], a[200:203], v[208:211]
    ds_read_b32 a39, v63
    v_perm_b32 v56, v93, v35, s36
    v_mfma_f32_16x16x32_bf16 v[208:211], a[148:151], a[208:211], v[208:211]
    s_waitcnt vmcnt(10)
    ds_read_b32 a172, v56
    v_bitop3_b32 v117, v117, v119, s76 bitop3:0x7e
    v_mfma_f32_16x16x32_bf16 v[212:215], a[100:103], a[224:227], v[212:215]
    ds_read_b128 a[164:167], v42 offset:12288
    v_cmp_ne_u32 vcc, 0, v117
    v_mfma_f32_16x16x32_bf16 v[212:215], a[148:151], a[220:223], v[212:215]
    v_perm_b32 v57, v93, v35, s37
    v_perm_b32 v58, v93, v35, s38
    v_mfma_f32_16x16x32_bf16 v[216:219], a[100:103], a[228:231], v[216:219]
    ds_read_b32 a173, v57
    ds_read_b32 a174, v58
    v_mfma_f32_16x16x32_bf16 v[216:219], a[148:151], a[240:243], v[216:219]
    ds_read_b128 a[132:135], v43 offset:12288
    s_cbranch_vccnz L_slow7_2
L_back7_2:
    v_mfma_f32_16x16x32_bf16 v[220:223], a[100:103], a[252:255], v[220:223]
    v_perm_b32 v59, v93, v35, s39
    v_perm_b32 v60, v85, v35, s36
    v_mfma_f32_16x16x32_bf16 v[220:223], a[148:151], a[52:55], v[220:223]
    ds_read_b32 a175, v59
    ds_read_b32 a244, v60
    v_mfma_f32_16x16x32_bf16 v[224:227], a[156:159], a[180:183], v[224:227]
    ds_read_b128 a[184:187], v42 offset:14336
    v_perm_b32 v61, v85, v35, s37
    v_mfma_f32_16x16x32_bf16 v[224:227], a[160:163], a[188:191], v[224:227]
    ds_read_b32 a245, v61
    v_perm_b32 v62, v85, v35, s38
    v_mfma_f32_16x16x32_bf16 v[228:231], a[156:159], a[196:199], v[228:231]
    ds_read_b32 a246, v62
    v_perm_b32 v63, v85, v35, s39
    v_mfma_f32_16x16x32_bf16 v[228:231], a[160:163], a[204:207], v[228:231]
    ds_read_b128 a[80:83], v43 offset:14336
    ds_read_b32 a247, v63
    v_mfma_f32_16x16x32_bf16 v[232:235], a[156:159], a[48:51], v[232:235]
    s_waitcnt vmcnt(7)
    v_perm_b32 v56, v78, v35, s36
    v_bitop3_b32 v123, v123, v127, s76 bitop3:0x7e
    v_mfma_f32_16x16x32_bf16 v[232:235], a[160:163], a[216:219], v[232:235]
    ds_read_b32 a96, v56
    v_cmp_ne_u32 vcc, 0, v123
    v_mfma_f32_16x16x32_bf16 v[236:239], a[156:159], a[8:11], v[236:239]
    v_perm_b32 v57, v78, v35, s37
    v_perm_b32 v58, v78, v35, s38
    v_mfma_f32_16x16x32_bf16 v[236:239], a[160:163], a[232:235], v[236:239]
    ds_read_b32 a97, v57
    ds_read_b32 a98, v58
    v_mfma_f32_16x16x32_bf16 v[240:243], a[156:159], a[200:203], v[240:243]
    v_perm_b32 v59, v78, v35, s39
    s_cbranch_vccnz L_slow7_0
L_back7_0:
    v_mfma_f32_16x16x32_bf16 v[240:243], a[160:163], a[208:211], v[240:243]
    ds_read_b32 a99, v59
    v_perm_b32 v60, v90, v35, s36
    v_mfma_f32_16x16x32_bf16 v[244:247], a[156:159], a[224:227], v[244:247]
    ds_read_b32 a108, v60
    v_perm_b32 v61, v90, v35, s37
    v_mfma_f32_16x16x32_bf16 v[244:247], a[160:163], a[220:223], v[244:247]
    s_waitcnt lgkmcnt(6)
    ds_read_b32 a109, v61
    v_perm_b32 v62, v90, v35, s38
    v_mfma_f32_16x16x32_bf16 v[248:251], a[156:159], a[228:231], v[248:251]
    s_barrier
    v_mfma_f32_16x16x32_bf16 v[248:251], a[160:163], a[240:243], v[248:251]
    ds_read_b32 a110, v62
    v_perm_b32 v63, v90, v35, s39
    v_mfma_f32_16x16x32_bf16 v[252:255], a[156:159], a[252:255], v[252:255]
    ds_read_b32 a111, v63
    v_perm_b32 v56, v94, v35, s36
    v_mfma_f32_16x16x32_bf16 v[252:255], a[160:163], a[52:55], v[252:255]
    s_waitcnt vmcnt(4)
    ds_read_b32 a120, v56
    v_bitop3_b32 v51, v51, v55, s76 bitop3:0x7e
    v_mfma_f32_16x16x32_bf16 v[128:131], a[176:179], a[140:143], v[128:131]
    v_cmp_ne_u32 vcc, 0, v51
    v_perm_b32 v57, v94, v35, s37
    v_mfma_f32_16x16x32_bf16 v[128:131], a[88:91], a[0:3], v[128:131]
    ds_read_b32 a121, v57
    v_perm_b32 v58, v94, v35, s38
    v_mfma_f32_16x16x32_bf16 v[132:135], a[176:179], a[64:67], v[132:135]
    ds_read_b32 a122, v58
    s_cbranch_vccnz L_slow7_1
L_back7_1:
    v_mfma_f32_16x16x32_bf16 v[132:135], a[88:91], a[248:251], v[132:135]
    v_perm_b32 v59, v94, v35, s39
    v_perm_b32 v60, v86, v35, s36
    v_mfma_f32_16x16x32_bf16 v[136:139], a[176:179], a[4:7], v[136:139]
    ds_read_b32 a123, v59
    ds_read_b32 a92, v60
    v_mfma_f32_16x16x32_bf16 v[136:139], a[88:91], a[12:15], v[136:139]
    v_perm_b32 v61, v86, v35, s37
    v_perm_b32 v62, v86, v35, s38
    v_mfma_f32_16x16x32_bf16 v[140:143], a[176:179], a[152:155], v[140:143]
    ds_read_b32 a93, v61
    ds_read_b32 a94, v62
    v_mfma_f32_16x16x32_bf16 v[140:143], a[88:91], a[104:107], v[140:143]
    v_perm_b32 v63, v86, v35, s39
    v_perm_b32 v56, v116, v35, s36
    v_mfma_f32_16x16x32_bf16 v[144:147], a[176:179], a[20:23], v[144:147]
    ds_read_b32 a95, v63
    ds_read_b32 a44, v56
    v_mfma_f32_16x16x32_bf16 v[144:147], a[88:91], a[24:27], v[144:147]
    v_perm_b32 v57, v116, v35, s37
    v_perm_b32 v58, v116, v35, s38
    v_mfma_f32_16x16x32_bf16 v[148:151], a[176:179], a[56:59], v[148:151]
    ds_read_b32 a45, v57
    ds_read_b32 a46, v58
    v_mfma_f32_16x16x32_bf16 v[148:151], a[88:91], a[72:75], v[148:151]
    v_perm_b32 v59, v116, v35, s39
    v_perm_b32 v60, v118, v35, s36
    v_mfma_f32_16x16x32_bf16 v[152:155], a[176:179], a[164:167], v[152:155]
    ds_read_b32 a47, v59
    ds_read_b32 a116, v60
    v_mfma_f32_16x16x32_bf16 v[152:155], a[88:91], a[132:135], v[152:155]
    v_perm_b32 v61, v118, v35, s37
    v_perm_b32 v62, v118, v35, s38
    v_mfma_f32_16x16x32_bf16 v[156:159], a[176:179], a[184:187], v[156:159]
    ds_read_b32 a117, v61
    ds_read_b32 a118, v62
    v_mfma_f32_16x16x32_bf16 v[156:159], a[88:91], a[80:83], v[156:159]
    ds_read_b128 a[112:115], v40 offset:32768
    v_perm_b32 v63, v118, v35, s39
    v_mfma_f32_16x16x32_bf16 v[160:163], a[136:139], a[140:143], v[160:163]
    ds_read_b32 a119, v63
    v_perm_b32 v56, v120, v35, s36
    v_mfma_f32_16x16x32_bf16 v[160:163], a[192:195], a[0:3], v[160:163]
    ds_read_b32 a124, v56
    v_perm_b32 v57, v120, v35, s37
    v_mfma_f32_16x16x32_bf16 v[164:167], a[136:139], a[64:67], v[164:167]
    ds_read_b32 a125, v57
    v_perm_b32 v58, v120, v35, s38
    v_mfma_f32_16x16x32_bf16 v[164:167], a[192:195], a[248:251], v[164:167]
    ds_read_b32 a126, v58
    ds_read_b128 a[128:131], v41 offset:32768
    v_mfma_f32_16x16x32_bf16 v[168:171], a[136:139], a[4:7], v[168:171]
    v_perm_b32 v59, v120, v35, s39
    v_perm_b32 v60, v124, v35, s36
    v_mfma_f32_16x16x32_bf16 v[168:171], a[192:195], a[12:15], v[168:171]
    ds_read_b32 a127, v59
    ds_read_b32 a144, v60
    v_mfma_f32_16x16x32_bf16 v[172:175], a[136:139], a[152:155], v[172:175]
    ds_read_b128 a[32:35], v40 offset:34816
    v_perm_b32 v61, v124, v35, s37
    v_mfma_f32_16x16x32_bf16 v[172:175], a[192:195], a[104:107], v[172:175]
    ds_read_b32 a145, v61
    v_perm_b32 v62, v124, v35, s38
    v_mfma_f32_16x16x32_bf16 v[176:179], a[136:139], a[20:23], v[176:179]
    ds_read_b32 a146, v62
    v_perm_b32 v63, v124, v35, s39
    v_mfma_f32_16x16x32_bf16 v[176:179], a[192:195], a[24:27], v[176:179]
    ds_read_b32 a147, v63
    v_perm_b32 v56, v48, v35, s36
    v_mfma_f32_16x16x32_bf16 v[180:183], a[136:139], a[56:59], v[180:183]
    ds_read_b32 a100, v56
    ds_read_b128 a[84:87], v41 offset:34816
    v_mfma_f32_16x16x32_bf16 v[180:183], a[192:195], a[72:75], v[180:183]
    v_perm_b32 v57, v48, v35, s37
    v_perm_b32 v58, v48, v35, s38
    v_mfma_f32_16x16x32_bf16 v[184:187], a[136:139], a[164:167], v[184:187]
    s_mov_b32 s64, 0
    ds_read_b32 a101, v57
    ds_read_b32 a102, v58
    v_mfma_f32_16x16x32_bf16 v[184:187], a[192:195], a[132:135], v[184:187]
    v_perm_b32 v59, v48, v35, s39
    v_perm_b32 v60, v52, v35, s36
    v_mfma_f32_16x16x32_bf16 v[188:191], a[136:139], a[184:187], v[188:191]
    ds_read_b32 a103, v59
    ds_read_b32 a148, v60
    v_mfma_f32_16x16x32_bf16 v[188:191], a[192:195], a[80:83], v[188:191]
    s_mov_b32 s65, 14336
    ds_read_b128 a[180:183], v42 offset:32768
    v_perm_b32 v61, v52, v35, s37
    v_mfma_f32_16x16x32_bf16 v[192:195], a[212:215], a[140:143], v[192:195]
    ds_read_b32 a149, v61
    v_perm_b32 v62, v52, v35, s38
    v_mfma_f32_16x16x32_bf16 v[192:195], a[236:239], a[0:3], v[192:195]
    ds_read_b32 a150, v62
    v_perm_b32 v63, v52, v35, s39
    v_mfma_f32_16x16x32_bf16 v[196:199], a[212:215], a[64:67], v[196:199]
    s_mov_b32 s66, 114688
    ds_read_b32 a151, v63
    ds_read_b128 a[188:191], v43 offset:32768
    v_mfma_f32_16x16x32_bf16 v[196:199], a[236:239], a[248:251], v[196:199]
    v_perm_b32 v56, v121, v35, s36
    v_perm_b32 v57, v121, v35, s37
    v_mfma_f32_16x16x32_bf16 v[200:203], a[212:215], a[4:7], v[200:203]
    ds_read_b32 a196, v56
    ds_read_b32 a197, v57
    v_mfma_f32_16x16x32_bf16 v[200:203], a[236:239], a[12:15], v[200:203]
    s_mov_b32 s67, 129024
    ds_read_b128 a[204:207], v42 offset:34816
    v_perm_b32 v58, v121, v35, s38
    v_mfma_f32_16x16x32_bf16 v[204:207], a[212:215], a[152:155], v[204:207]
    ds_read_b32 a198, v58
    v_perm_b32 v59, v121, v35, s39
    v_mfma_f32_16x16x32_bf16 v[204:207], a[236:239], a[104:107], v[204:207]
    ds_read_b32 a199, v59
    v_perm_b32 v60, v125, v35, s36
    v_mfma_f32_16x16x32_bf16 v[208:211], a[212:215], a[20:23], v[208:211]
    s_mov_b32 s68, 229376
    ds_read_b32 a48, v60
    v_perm_b32 v61, v125, v35, s37
    v_mfma_f32_16x16x32_bf16 v[208:211], a[236:239], a[24:27], v[208:211]
    ds_read_b32 a49, v61
    v_perm_b32 v62, v125, v35, s38
    v_mfma_f32_16x16x32_bf16 v[212:215], a[212:215], a[56:59], v[212:215]
    ds_read_b32 a50, v62
    ds_read_b128 a[216:219], v43 offset:34816
    v_mfma_f32_16x16x32_bf16 v[212:215], a[236:239], a[72:75], v[212:215]
    s_mov_b32 s69, 243712
    v_perm_b32 v63, v125, v35, s39
    v_perm_b32 v56, v49, v35, s36
    v_mfma_f32_16x16x32_bf16 v[216:219], a[212:215], a[164:167], v[216:219]
    ds_read_b32 a8, v56
    ds_read_b32 a51, v63
    v_mfma_f32_16x16x32_bf16 v[216:219], a[236:239], a[132:135], v[216:219]
    v_perm_b32 v57, v49, v35, s37
    v_perm_b32 v58, v49, v35, s38
    v_mfma_f32_16x16x32_bf16 v[220:223], a[212:215], a[184:187], v[220:223]
    s_mov_b32 s70, 344064
    ds_read_b32 a9, v57
    ds_read_b32 a10, v58
    v_mfma_f32_16x16x32_bf16 v[220:223], a[236:239], a[80:83], v[220:223]
    s_waitcnt lgkmcnt(9)
    v_perm_b32 v59, v49, v35, s39
    v_perm_b32 v60, v53, v35, s36
    v_mfma_f32_16x16x32_bf16 v[224:227], a[16:19], a[112:115], v[224:227]
    s_waitcnt vmcnt(0)
    ds_read_b32 a232, v60
    ds_read_b32 a11, v59
    v_mfma_f32_16x16x32_bf16 v[224:227], a[68:71], a[128:131], v[224:227]
    s_mov_b32 s71, 358400
    v_perm_b32 v61, v53, v35, s37
    v_perm_b32 v62, v53, v35, s38
    v_mfma_f32_16x16x32_bf16 v[228:231], a[16:19], a[32:35], v[228:231]
    s_barrier
    v_mfma_f32_16x16x32_bf16 v[228:231], a[68:71], a[84:87], v[228:231]
    ds_read_b32 a233, v61
    ds_read_b32 a234, v62
    v_mfma_f32_16x16x32_bf16 v[128:131], a[60:63], a[112:115], v[128:131]
    s_mov_b32 s73, 458752
    v_perm_b32 v63, v53, v35, s39
    v_perm_b32 v56, v122, v35, s36
    v_mfma_f32_16x16x32_bf16 v[128:131], a[76:79], a[128:131], v[128:131]
    ds_read_b32 a200, v56
    ds_read_b32 a235, v63
    v_mfma_f32_16x16x32_bf16 v[128:131], a[168:171], a[180:183], v[128:131]
    ds_read_b128 a[208:211], v44 offset:0
    v_perm_b32 v57, v122, v35, s37
    v_mfma_f32_16x16x32_bf16 v[128:131], a[40:43], a[188:191], v[128:131]
    s_mov_b32 s74, 473088
    ds_read_b128 a[224:227], v45 offset:0
    ds_read_b32 a201, v57
    v_mfma_f32_16x16x32_bf16 v[132:135], a[60:63], a[32:35], v[132:135]
    ds_read_b128 a[220:223], v46 offset:0
    v_perm_b32 v58, v122, v35, s38
    v_mfma_f32_16x16x32_bf16 v[132:135], a[76:79], a[84:87], v[132:135]
    s_waitcnt lgkmcnt(8)
    ds_read_b128 a[228:231], v47 offset:0
    ds_read_b32 a202, v58
    v_mfma_f32_16x16x32_bf16 v[132:135], a[168:171], a[204:207], v[132:135]
    s_mov_b32 s75, 573440
    v_perm_b32 v59, v126, v35, s36
    v_perm_b32 v60, v126, v35, s37
    v_mfma_f32_16x16x32_bf16 v[132:135], a[40:43], a[216:219], v[132:135]
    ds_read_b32 a240, v59
    v_perm_b32 v61, v122, v35, s39
L_pad4:
    s_cbranch_execz L_pad5
    v_mfma_f32_16x16x32_bf16 v[160:163], a[28:31], a[112:115], v[160:163]
    ds_read_b32 a241, v60
    v_perm_b32 v62, v126, v35, s38
    v_mfma_f32_16x16x32_bf16 v[160:163], a[36:39], a[128:131], v[160:163]
    s_mov_b32 s58, 587776
    ds_read_b32 a203, v61
    ds_read_b32 a242, v62
    v_mfma_f32_16x16x32_bf16 v[160:163], a[172:175], a[180:183], v[160:163]
    v_perm_b32 v56, v50, v35, s36
    v_perm_b32 v63, v126, v35, s39
    v_mfma_f32_16x16x32_bf16 v[160:163], a[244:247], a[188:191], v[160:163]
    ds_read_b32 a156, v56
    v_perm_b32 v57, v50, v35, s37
    v_mfma_f32_16x16x32_bf16 v[164:167], a[28:31], a[32:35], v[164:167]
    s_mov_b32 s48, 688128
    ds_read_b32 a243, v63
    v_perm_b32 v58, v50, v35, s38
    v_mfma_f32_16x16x32_bf16 v[164:167], a[36:39], a[84:87], v[164:167]
    ds_read_b32 a157, v57
    ds_read_b128 a[252:255], v44 offset:2048
    v_mfma_f32_16x16x32_bf16 v[164:167], a[172:175], a[204:207], v[164:167]
    ds_read_b32 a158, v58
    v_perm_b32 v59, v50, v35, s39
    v_mfma_f32_16x16x32_bf16 v[164:167], a[244:247], a[216:219], v[164:167]
    s_mov_b32 s49, 702464
    ds_read_b128 a[160:163], v45 offset:2048
    ds_read_b32 a159, v59
    v_mfma_f32_16x16x32_bf16 v[192:195], a[96:99], a[112:115], v[192:195]
    ds_read_b128 a[52:55], v46 offset:2048
    v_perm_b32 v60, v54, v35, s36
    v_mfma_f32_16x16x32_bf16 v[192:195], a[108:111], a[128:131], v[192:195]
    ds_read_b32 a176, v60
    v_perm_b32 v61, v54, v35, s37
    v_mfma_f32_16x16x32_bf16 v[192:195], a[120:123], a[180:183], v[192:195]
    s_mov_b32 s50, 802816
    ds_read_b128 a[88:91], v47 offset:2048
    ds_read_b32 a177, v61
    v_mfma_f32_16x16x32_bf16 v[192:195], a[92:95], a[188:191], v[192:195]
    v_perm_b32 v62, v54, v35, s38
    v_perm_b32 v56, v54, v35, s39
    v_mfma_f32_16x16x32_bf16 v[196:199], a[96:99], a[32:35], v[196:199]
    ds_read_b32 a178, v62
    ds_read_b128 a[136:139], v40 offset:36864
    v_mfma_f32_16x16x32_bf16 v[196:199], a[108:111], a[84:87], v[196:199]
    s_mov_b32 s51, 817152
    ds_read_b32 a179, v56
    v_lshlrev_b32 v64, 16, v110
    v_mfma_f32_16x16x32_bf16 v[196:199], a[120:123], a[204:207], v[196:199]
    ds_read_b128 a[192:195], v41 offset:36864
    v_and_b32 v65, 0xffff0000, v110
    v_mfma_f32_16x16x32_bf16 v[196:199], a[92:95], a[216:219], v[196:199]
    s_waitcnt lgkmcnt(10)
    v_lshlrev_b32 v96, 16, v100
    v_and_b32 v97, 0xffff0000, v101
    v_mfma_f32_16x16x32_bf16 v[224:227], a[44:47], a[208:211], v[224:227]
    v_lshlrev_b32 v98, 16, v103
    v_and_b32 v99, 0xffff0000, v108
    v_mfma_f32_16x16x32_bf16 v[224:227], a[116:119], a[224:227], v[224:227]
    ds_read_b128 a[140:143], v44 offset:4096
    v_and_b32 v104, 0xffff0000, v100
    v_mfma_f32_16x16x32_bf16 v[128:131], a[124:127], a[208:211], v[128:131]
    v_lshlrev_b32 v105, 16, v102
    v_and_b32 v106, 0xffff0000, v103
    v_mfma_f32_16x16x32_bf16 v[128:131], a[144:147], a[224:227], v[128:131]
    v_lshlrev_b32 v107, 16, v109
    v_lshlrev_b32 v112, 16, v101
    v_mfma_f32_16x16x32_bf16 v[128:131], a[100:103], a[220:223], v[128:131]
    ds_read_b128 a[0:3], v45 offset:4096
    v_and_b32 v113, 0xffff0000, v102
    v_mfma_f32_16x16x32_bf16 v[128:131], a[148:151], a[228:231], v[128:131]
    ds_write_b64 v29, v[226:227] offset:0
    v_lshlrev_b32 v114, 16, v108
    v_mfma_f32_16x16x32_bf16 v[160:163], a[196:199], a[208:211], v[160:163]
    v_and_b32 v115, 0xffff0000, v109
    v_mov_b32 v8, 1
    v_mfma_f32_16x16x32_bf16 v[160:163], a[48:51], a[224:227], v[160:163]
    v_min_u32 v9, 1, v0
    v_lshlrev_b32 v9, 30, v9
    v_mfma_f32_16x16x32_bf16 v[160:163], a[8:11], a[220:223], v[160:163]
    ds_read_b128 a[64:67], v42 offset:36864
    v_mfma_f32_16x16x32_bf16 v[160:163], a[232:235], a[228:231], v[160:163]
    buffer_atomic_add v8, v9, s[24:27], s77 offen sc0 sc1
    v_mfma_f32_16x16x32_bf16 v[192:195], a[200:203], a[208:211], v[192:195]
    s_waitcnt lgkmcnt(1)
    s_barrier
    v_mfma_f32_16x16x32_bf16 v[192:195], a[240:243], a[224:227], v[192:195]
    ds_read_b64 v[68:69], v30 offset:0
    ds_read_b128 a[248:251], v43 offset:36864
    v_mfma_f32_16x16x32_bf16 v[192:195], a[156:159], a[220:223], v[192:195]
    v_mul_f32 v128, v128, v96
    v_mul_f32 v129, v129, v97
    v_mfma_f32_16x16x32_bf16 v[192:195], a[176:179], a[228:231], v[192:195]
    v_mul_f32 v130, v130, v98
    v_mul_f32 v131, v131, v99
    v_mfma_f32_16x16x32_bf16 v[228:231], a[44:47], a[252:255], v[228:231]
    v_mul_f32 v160, v160, v104
    v_cvt_pk_bf16_f32 v80, v128, v160
    v_mfma_f32_16x16x32_bf16 v[228:231], a[116:119], a[160:163], v[228:231]
    ds_read_b128 a[4:7], v46 offset:4096
    v_mul_f32 v161, v161, v105
    v_mfma_f32_16x16x32_bf16 v[132:135], a[124:127], a[252:255], v[132:135]
    v_mul_f32 v162, v162, v106
    v_cvt_pk_bf16_f32 v83, v130, v162
    v_mfma_f32_16x16x32_bf16 v[132:135], a[144:147], a[160:163], v[132:135]
    v_mul_f32 v192, v192, v112
    v_mul_f32 v193, v193, v113
    v_mfma_f32_16x16x32_bf16 v[132:135], a[100:103], a[52:55], v[132:135]
    v_mul_f32 v194, v194, v114
    v_mul_f32 v195, v195, v115
    v_mfma_f32_16x16x32_bf16 v[132:135], a[148:151], a[88:91], v[132:135]
    v_cvt_pk_bf16_f32 v81, v192, v129
    v_mul_f32 v163, v163, v107
    v_mfma_f32_16x16x32_bf16 v[164:167], a[196:199], a[252:255], v[164:167]
    ds_write_b64 v26, v[80:81] offset:0
    v_cvt_pk_bf16_f32 v82, v161, v193
    v_mfma_f32_16x16x32_bf16 v[164:167], a[48:51], a[160:163], v[164:167]
    ds_write_b64 v26, v[82:83] offset:8
    v_cvt_pk_bf16_f32 v72, v194, v131
    v_mfma_f32_16x16x32_bf16 v[164:167], a[8:11], a[52:55], v[164:167]
    ds_write_b64 v29, v[230:231] offset:2048
    v_cvt_pk_bf16_f32 v73, v163, v195
    v_mfma_f32_16x16x32_bf16 v[164:167], a[232:235], a[88:91], v[164:167]
    s_waitcnt lgkmcnt(4)
    ds_read_b128 a[12:15], v47 offset:4096
    v_add_f32 v224, v224, v68
    v_mfma_f32_16x16x32_bf16 v[196:199], a[200:203], a[252:255], v[196:199]
    ds_write_b64 v26, v[72:73] offset:16
    v_mul_f32 v224, v224, v64
    v_mfma_f32_16x16x32_bf16 v[196:199], a[240:243], a[160:163], v[196:199]
    v_add_f32 v225, v225, v69
    v_mul_f32 v225, v225, v65
    v_mfma_f32_16x16x32_bf16 v[196:199], a[156:159], a[52:55], v[196:199]
    ds_read_b128 a[152:155], v40 offset:38912
    v_cvt_pk_bf16_f32 v68, v224, v225
    v_mfma_f32_16x16x32_bf16 v[196:199], a[176:179], a[88:91], v[196:199]
    ds_write_b32 v28, v68 offset:0
    v_mul_f32 v132, v132, v96
    v_mfma_f32_16x16x32_bf16 v[232:235], a[16:19], a[136:139], v[232:235]
    ds_read_b128 a[104:107], v41 offset:38912
    v_mul_f32 v133, v133, v97
    v_mfma_f32_16x16x32_bf16 v[232:235], a[68:71], a[192:195], v[232:235]
    v_mul_f32 v134, v134, v98
    v_mul_f32 v135, v135, v99
    v_mfma_f32_16x16x32_bf16 v[232:235], a[44:47], a[140:143], v[232:235]
    ds_read_b128 a[20:23], v44 offset:6144
    v_mul_f32 v164, v164, v104
    v_mfma_f32_16x16x32_bf16 v[232:235], a[116:119], a[0:3], v[232:235]
    v_cvt_pk_bf16_f32 v76, v132, v164
    v_mul_f32 v196, v196, v112
    v_mfma_f32_16x16x32_bf16 v[136:139], a[60:63], a[136:139], v[136:139]
    s_waitcnt lgkmcnt(2)
    s_barrier
    v_mfma_f32_16x16x32_bf16 v[136:139], a[76:79], a[192:195], v[136:139]
    ds_read_b128 v[88:91], v24 offset:0
    ds_read_b64 v[92:93], v30 offset:2048
    v_mfma_f32_16x16x32_bf16 v[136:139], a[168:171], a[64:67], v[136:139]
    ds_read_b128 v[84:87], v24 offset:928
    v_mul_f32 v197, v197, v113
    v_mfma_f32_16x16x32_bf16 v[136:139], a[40:43], a[248:251], v[136:139]
    v_mul_f32 v198, v198, v114
    v_mul_f32 v199, v199, v115
    v_mfma_f32_16x16x32_bf16 v[136:139], a[124:127], a[140:143], v[136:139]
    v_cvt_pk_bf16_f32 v77, v196, v133
    v_mul_f32 v165, v165, v105
    v_mfma_f32_16x16x32_bf16 v[136:139], a[144:147], a[0:3], v[136:139]
    ds_read_b128 a[24:27], v45 offset:6144
    v_mul_f32 v166, v166, v106
    v_mfma_f32_16x16x32_bf16 v[136:139], a[100:103], a[4:7], v[136:139]
    ds_write_b64 v26, v[76:77] offset:7424
    v_cvt_pk_bf16_f32 v79, v134, v166
    v_mfma_f32_16x16x32_bf16 v[136:139], a[148:151], a[12:15], v[136:139]
    s_waitcnt lgkmcnt(4)
    ds_write_b64 v29, v[234:235] offset:4096
    v_mfma_f32_16x16x32_bf16 v[168:171], a[28:31], a[136:139], v[168:171]
    buffer_store_dwordx4 v[88:91], v25, s[16:19], s64 offen sc1
    v_mfma_f32_16x16x32_bf16 v[168:171], a[36:39], a[192:195], v[168:171]
    ds_read_b128 a[56:59], v42 offset:38912
    v_mul_f32 v167, v167, v107
    v_mfma_f32_16x16x32_bf16 v[168:171], a[172:175], a[64:67], v[168:171]
    v_cvt_pk_bf16_f32 v78, v165, v197
    v_cvt_pk_bf16_f32 v116, v198, v135
    v_mfma_f32_16x16x32_bf16 v[168:171], a[244:247], a[248:251], v[168:171]
    s_waitcnt lgkmcnt(4)
    ds_write_b64 v26, v[78:79] offset:7432
    v_mfma_f32_16x16x32_bf16 v[168:171], a[196:199], a[140:143], v[168:171]
    buffer_store_dwordx4 v[84:87], v25, s[16:19], s65 offen sc1
    v_mfma_f32_16x16x32_bf16 v[168:171], a[48:51], a[0:3], v[168:171]
    ds_read_b128 a[72:75], v43 offset:38912
    v_cvt_pk_bf16_f32 v117, v167, v199
    v_mfma_f32_16x16x32_bf16 v[168:171], a[8:11], a[4:7], v[168:171]
    ds_write_b64 v26, v[116:117] offset:7440
    v_add_f32 v228, v228, v92
    v_mfma_f32_16x16x32_bf16 v[168:171], a[232:235], a[12:15], v[168:171]
    v_mul_f32 v228, v228, v64
    v_add_f32 v229, v229, v93
    v_mfma_f32_16x16x32_bf16 v[200:203], a[96:99], a[136:139], v[200:203]
    ds_read_b128 a[164:167], v46 offset:6144
    v_mul_f32 v229, v229, v65
    v_mfma_f32_16x16x32_bf16 v[200:203], a[108:111], a[192:195], v[200:203]
    v_cvt_pk_bf16_f32 v92, v228, v229
    v_mul_f32 v136, v136, v96
    v_mfma_f32_16x16x32_bf16 v[200:203], a[120:123], a[64:67], v[200:203]
    ds_write_b32 v28, v92 offset:7424
    v_mul_f32 v137, v137, v97
    v_mfma_f32_16x16x32_bf16 v[200:203], a[92:95], a[248:251], v[200:203]
    ds_read_b128 a[132:135], v47 offset:6144
    v_mul_f32 v138, v138, v98
    v_mfma_f32_16x16x32_bf16 v[200:203], a[200:203], a[140:143], v[200:203]
    ds_read_b128 a[212:215], v40 offset:40960
    v_mul_f32 v139, v139, v99
    v_mfma_f32_16x16x32_bf16 v[200:203], a[240:243], a[0:3], v[200:203]
    ds_read_b128 a[184:187], v41 offset:40960
    v_mul_f32 v168, v168, v104
    v_mfma_f32_16x16x32_bf16 v[200:203], a[156:159], a[4:7], v[200:203]
    v_cvt_pk_bf16_f32 v120, v136, v168
    v_mul_f32 v169, v169, v105
    v_mfma_f32_16x16x32_bf16 v[200:203], a[176:179], a[12:15], v[200:203]
    s_waitcnt lgkmcnt(3)
    s_barrier
    v_mfma_f32_16x16x32_bf16 v[236:239], a[16:19], a[152:155], v[236:239]
    ds_read_b128 v[124:127], v24 offset:7424
    ds_read_b64 v[48:49], v30 offset:4096
    v_mfma_f32_16x16x32_bf16 v[236:239], a[68:71], a[104:107], v[236:239]
    ds_read_b128 v[52:55], v24 offset:8352
    v_mul_f32 v170, v170, v106
    v_mfma_f32_16x16x32_bf16 v[236:239], a[44:47], a[20:23], v[236:239]
    v_cvt_pk_bf16_f32 v123, v138, v170
    v_mul_f32 v171, v171, v107
    v_mfma_f32_16x16x32_bf16 v[236:239], a[116:119], a[24:27], v[236:239]
    v_mul_f32 v200, v200, v112
    v_mul_f32 v201, v201, v113
    v_mfma_f32_16x16x32_bf16 v[140:143], a[60:63], a[152:155], v[140:143]
    v_mul_f32 v202, v202, v114
    v_mul_f32 v203, v203, v115
    v_mfma_f32_16x16x32_bf16 v[140:143], a[76:79], a[104:107], v[140:143]
    v_cvt_pk_bf16_f32 v121, v200, v137
    v_cvt_pk_bf16_f32 v122, v169, v201
    v_mfma_f32_16x16x32_bf16 v[140:143], a[168:171], a[56:59], v[140:143]
    s_waitcnt lgkmcnt(2)
    ds_read_b128 a[236:239], v44 offset:8192
    v_mfma_f32_16x16x32_bf16 v[140:143], a[40:43], a[72:75], v[140:143]
    buffer_store_dwordx4 v[124:127], v25, s[16:19], s66 offen sc1
    v_mfma_f32_16x16x32_bf16 v[140:143], a[124:127], a[20:23], v[140:143]
    s_waitcnt lgkmcnt(2)
    v_add_f32 v232, v232, v48
    v_mul_f32 v232, v232, v64
    v_mfma_f32_16x16x32_bf16 v[140:143], a[144:147], a[24:27], v[140:143]
    v_add_f32 v233, v233, v49
    v_mul_f32 v233, v233, v65
    v_mfma_f32_16x16x32_bf16 v[140:143], a[100:103], a[164:167], v[140:143]
    s_waitcnt lgkmcnt(1)
    ds_read_b128 a[80:83], v45 offset:8192
    v_mfma_f32_16x16x32_bf16 v[140:143], a[148:151], a[132:135], v[140:143]
    buffer_store_dwordx4 v[52:55], v25, s[16:19], s67 offen sc1
    v_mfma_f32_16x16x32_bf16 v[172:175], a[28:31], a[152:155], v[172:175]
    ds_write_b64 v26, v[120:121] offset:14848
    v_cvt_pk_bf16_f32 v48, v232, v233
    v_mfma_f32_16x16x32_bf16 v[172:175], a[36:39], a[104:107], v[172:175]
    ds_read_b128 a[112:115], v42 offset:40960
    v_cvt_pk_bf16_f32 v100, v202, v139
    v_mfma_f32_16x16x32_bf16 v[172:175], a[172:175], a[56:59], v[172:175]
    ds_write_b32 v28, v48 offset:14848
    v_cvt_pk_bf16_f32 v101, v171, v203
    v_mfma_f32_16x16x32_bf16 v[172:175], a[244:247], a[72:75], v[172:175]
    ds_write_b64 v26, v[122:123] offset:14856
    v_mul_f32 v140, v140, v96
    v_mfma_f32_16x16x32_bf16 v[172:175], a[196:199], a[20:23], v[172:175]
    ds_read_b128 a[128:131], v43 offset:40960
    v_mul_f32 v141, v141, v97
    v_mfma_f32_16x16x32_bf16 v[172:175], a[48:51], a[24:27], v[172:175]
    ds_write_b64 v26, v[100:101] offset:14864
    v_mul_f32 v142, v142, v98
    v_mfma_f32_16x16x32_bf16 v[172:175], a[8:11], a[164:167], v[172:175]
    ds_write_b64 v29, v[238:239] offset:0
    v_mul_f32 v143, v143, v99
    v_mfma_f32_16x16x32_bf16 v[172:175], a[232:235], a[132:135], v[172:175]
    ds_read_b128 a[180:183], v46 offset:8192
    v_mfma_f32_16x16x32_bf16 v[204:207], a[96:99], a[152:155], v[204:207]
    ds_read_b128 a[188:191], v47 offset:8192
    v_mfma_f32_16x16x32_bf16 v[204:207], a[108:111], a[104:107], v[204:207]
    v_mfma_f32_16x16x32_bf16 v[204:207], a[120:123], a[56:59], v[204:207]
    ds_read_b128 a[32:35], v40 offset:43008
    v_mfma_f32_16x16x32_bf16 v[204:207], a[92:95], a[72:75], v[204:207]
    s_waitcnt lgkmcnt(3)
    s_barrier
    v_mfma_f32_16x16x32_bf16 v[204:207], a[200:203], a[20:23], v[204:207]
    ds_read_b128 v[108:111], v24 offset:14848
    ds_read_b64 v[80:81], v30 offset:0
    v_mfma_f32_16x16x32_bf16 v[204:207], a[240:243], a[24:27], v[204:207]
    ds_read_b128 v[72:75], v24 offset:15776
    v_mul_f32 v172, v172, v104
    v_mfma_f32_16x16x32_bf16 v[204:207], a[156:159], a[164:167], v[204:207]
    ds_read_b128 a[84:87], v41 offset:43008
    v_cvt_pk_bf16_f32 v68, v140, v172
    v_mfma_f32_16x16x32_bf16 v[204:207], a[176:179], a[132:135], v[204:207]
    v_mul_f32 v173, v173, v105
    v_mul_f32 v174, v174, v106
    v_mfma_f32_16x16x32_bf16 v[240:243], a[16:19], a[212:215], v[240:243]
    v_cvt_pk_bf16_f32 v71, v142, v174
    v_mul_f32 v175, v175, v107
    v_mfma_f32_16x16x32_bf16 v[240:243], a[68:71], a[184:187], v[240:243]
    ds_read_b128 a[204:207], v44 offset:10240
    v_mfma_f32_16x16x32_bf16 v[240:243], a[44:47], a[236:239], v[240:243]
    s_waitcnt lgkmcnt(4)
    v_mfma_f32_16x16x32_bf16 v[240:243], a[116:119], a[80:83], v[240:243]
    buffer_store_dwordx4 v[108:111], v25, s[16:19], s68 offen sc1
    v_mfma_f32_16x16x32_bf16 v[144:147], a[60:63], a[212:215], v[144:147]
    s_waitcnt lgkmcnt(3)
    v_add_f32 v236, v236, v80
    v_mul_f32 v236, v236, v64
    v_mfma_f32_16x16x32_bf16 v[144:147], a[76:79], a[184:187], v[144:147]
    v_add_f32 v237, v237, v81
    v_mul_f32 v237, v237, v65
    v_mfma_f32_16x16x32_bf16 v[144:147], a[168:171], a[112:115], v[144:147]
    s_waitcnt lgkmcnt(2)
    ds_read_b128 a[216:219], v45 offset:10240
    v_mfma_f32_16x16x32_bf16 v[144:147], a[40:43], a[128:131], v[144:147]
    buffer_store_dwordx4 v[72:75], v25, s[16:19], s69 offen sc1
    v_mfma_f32_16x16x32_bf16 v[144:147], a[124:127], a[236:239], v[144:147]
    v_cvt_pk_bf16_f32 v80, v236, v237
    v_mul_f32 v204, v204, v112
    v_mfma_f32_16x16x32_bf16 v[144:147], a[144:147], a[80:83], v[144:147]
    ds_write_b32 v28, v80 offset:0
    v_mul_f32 v205, v205, v113
    v_mfma_f32_16x16x32_bf16 v[144:147], a[100:103], a[180:183], v[144:147]
    v_mul_f32 v206, v206, v114
    v_mul_f32 v207, v207, v115
    v_mfma_f32_16x16x32_bf16 v[144:147], a[148:151], a[188:191], v[144:147]
    v_cvt_pk_bf16_f32 v69, v204, v141
    v_cvt_pk_bf16_f32 v70, v173, v205
    v_mfma_f32_16x16x32_bf16 v[176:179], a[28:31], a[212:215], v[176:179]
    ds_write_b64 v26, v[68:69] offset:0
    v_cvt_pk_bf16_f32 v88, v206, v143
    v_mfma_f32_16x16x32_bf16 v[176:179], a[36:39], a[184:187], v[176:179]
    ds_read_b128 a[208:211], v42 offset:43008
    v_cvt_pk_bf16_f32 v89, v175, v207
    v_mfma_f32_16x16x32_bf16 v[176:179], a[172:175], a[112:115], v[176:179]
    ds_write_b64 v26, v[70:71] offset:8
    v_mfma_f32_16x16x32_bf16 v[176:179], a[244:247], a[128:131], v[176:179]
    ds_write_b64 v26, v[88:89] offset:16
    v_mul_f32 v144, v144, v96
    v_mfma_f32_16x16x32_bf16 v[176:179], a[196:199], a[236:239], v[176:179]
    ds_read_b128 a[224:227], v43 offset:43008
    v_mul_f32 v145, v145, v97
    v_mfma_f32_16x16x32_bf16 v[176:179], a[48:51], a[80:83], v[176:179]
    ds_write_b64 v29, v[242:243] offset:2048
    v_mul_f32 v146, v146, v98
    v_mfma_f32_16x16x32_bf16 v[176:179], a[8:11], a[180:183], v[176:179]
    ds_read_b128 a[220:223], v46 offset:10240
    v_mul_f32 v147, v147, v99
    v_mfma_f32_16x16x32_bf16 v[176:179], a[232:235], a[188:191], v[176:179]
    ds_read_b128 a[228:231], v47 offset:10240
    v_mfma_f32_16x16x32_bf16 v[208:211], a[96:99], a[212:215], v[208:211]
    v_mfma_f32_16x16x32_bf16 v[208:211], a[108:111], a[184:187], v[208:211]
    v_mfma_f32_16x16x32_bf16 v[208:211], a[120:123], a[112:115], v[208:211]
    s_waitcnt lgkmcnt(2)
    s_barrier
    v_mfma_f32_16x16x32_bf16 v[208:211], a[92:95], a[128:131], v[208:211]
    ds_read_b128 v[76:79], v24 offset:0
    ds_read_b64 v[84:85], v30 offset:2048
    v_mfma_f32_16x16x32_bf16 v[208:211], a[200:203], a[236:239], v[208:211]
    ds_read_b128 v[116:119], v24 offset:928
    v_mul_f32 v176, v176, v104
    v_mfma_f32_16x16x32_bf16 v[208:211], a[240:243], a[80:83], v[208:211]
    ds_read_b128 a[252:255], v40 offset:45056
    v_cvt_pk_bf16_f32 v92, v144, v176
    v_mfma_f32_16x16x32_bf16 v[208:211], a[156:159], a[180:183], v[208:211]
    ds_read_b128 a[160:163], v41 offset:45056
    v_mul_f32 v177, v177, v105
    v_mfma_f32_16x16x32_bf16 v[208:211], a[176:179], a[188:191], v[208:211]
    v_mul_f32 v178, v178, v106
    v_cvt_pk_bf16_f32 v95, v146, v178
    v_mfma_f32_16x16x32_bf16 v[244:247], a[16:19], a[32:35], v[244:247]
    v_mul_f32 v179, v179, v107
    v_mfma_f32_16x16x32_bf16 v[244:247], a[68:71], a[84:87], v[244:247]
    s_waitcnt lgkmcnt(4)
    ds_read_b128 a[52:55], v44 offset:12288
    v_mfma_f32_16x16x32_bf16 v[244:247], a[44:47], a[204:207], v[244:247]
    buffer_store_dwordx4 v[76:79], v25, s[16:19], s70 offen sc1
    v_mfma_f32_16x16x32_bf16 v[244:247], a[116:119], a[216:219], v[244:247]
    s_waitcnt lgkmcnt(4)
    v_add_f32 v240, v240, v84
    v_mul_f32 v240, v240, v64
    v_mfma_f32_16x16x32_bf16 v[148:151], a[60:63], a[32:35], v[148:151]
    v_add_f32 v241, v241, v85
    v_mul_f32 v241, v241, v65
    v_mfma_f32_16x16x32_bf16 v[148:151], a[76:79], a[84:87], v[148:151]
    s_waitcnt lgkmcnt(3)
    ds_read_b128 a[88:91], v45 offset:12288
    v_mfma_f32_16x16x32_bf16 v[148:151], a[168:171], a[208:211], v[148:151]
    buffer_store_dwordx4 v[116:119], v25, s[16:19], s71 offen sc1
    v_mfma_f32_16x16x32_bf16 v[148:151], a[40:43], a[224:227], v[148:151]
    v_cvt_pk_bf16_f32 v84, v240, v241
    v_mul_f32 v208, v208, v112
    v_mfma_f32_16x16x32_bf16 v[148:151], a[124:127], a[204:207], v[148:151]
    ds_write_b32 v28, v84 offset:7424
    v_mul_f32 v209, v209, v113
    v_mfma_f32_16x16x32_bf16 v[148:151], a[144:147], a[216:219], v[148:151]
    v_mul_f32 v210, v210, v114
    v_mul_f32 v211, v211, v115
    v_mfma_f32_16x16x32_bf16 v[148:151], a[100:103], a[220:223], v[148:151]
    v_cvt_pk_bf16_f32 v93, v208, v145
    v_cvt_pk_bf16_f32 v94, v177, v209
    v_mfma_f32_16x16x32_bf16 v[148:151], a[148:151], a[228:231], v[148:151]
    ds_write_b64 v26, v[92:93] offset:7424
    v_cvt_pk_bf16_f32 v124, v210, v147
    v_mfma_f32_16x16x32_bf16 v[180:183], a[28:31], a[32:35], v[180:183]
    ds_write_b64 v26, v[94:95] offset:7432
    v_cvt_pk_bf16_f32 v125, v179, v211
    v_mfma_f32_16x16x32_bf16 v[180:183], a[36:39], a[84:87], v[180:183]
    ds_read_b128 a[136:139], v42 offset:45056
    v_mfma_f32_16x16x32_bf16 v[180:183], a[172:175], a[208:211], v[180:183]
    ds_write_b64 v26, v[124:125] offset:7440
    v_mfma_f32_16x16x32_bf16 v[180:183], a[244:247], a[224:227], v[180:183]
    ds_write_b64 v29, v[246:247] offset:4096
    v_mul_f32 v148, v148, v96
    v_mfma_f32_16x16x32_bf16 v[180:183], a[196:199], a[204:207], v[180:183]
    ds_read_b128 a[192:195], v43 offset:45056
    v_mul_f32 v149, v149, v97
    v_mfma_f32_16x16x32_bf16 v[180:183], a[48:51], a[216:219], v[180:183]
    ds_read_b128 a[64:67], v46 offset:12288
    v_mul_f32 v150, v150, v98
    v_mfma_f32_16x16x32_bf16 v[180:183], a[8:11], a[220:223], v[180:183]
    ds_read_b128 a[248:251], v47 offset:12288
    v_mul_f32 v151, v151, v99
    v_mfma_f32_16x16x32_bf16 v[180:183], a[232:235], a[228:231], v[180:183]
    v_mfma_f32_16x16x32_bf16 v[212:215], a[96:99], a[32:35], v[212:215]
    s_waitcnt lgkmcnt(3)
    s_barrier
    v_mfma_f32_16x16x32_bf16 v[212:215], a[108:111], a[84:87], v[212:215]
    ds_read_b128 v[52:55], v24 offset:7424
    ds_read_b64 v[48:49], v30 offset:4096
    v_mfma_f32_16x16x32_bf16 v[212:215], a[120:123], a[208:211], v[212:215]
    ds_read_b128 v[120:123], v24 offset:8352
    v_mfma_f32_16x16x32_bf16 v[212:215], a[92:95], a[224:227], v[212:215]
    ds_read_b128 a[140:143], v40 offset:47104
    v_mul_f32 v180, v180, v104
    v_mfma_f32_16x16x32_bf16 v[212:215], a[200:203], a[204:207], v[212:215]
    v_cvt_pk_bf16_f32 v100, v148, v180
    v_mul_f32 v181, v181, v105
    v_mfma_f32_16x16x32_bf16 v[212:215], a[240:243], a[216:219], v[212:215]
    ds_read_b128 a[0:3], v41 offset:47104
    v_mul_f32 v182, v182, v106
    v_mfma_f32_16x16x32_bf16 v[212:215], a[156:159], a[220:223], v[212:215]
    v_cvt_pk_bf16_f32 v103, v150, v182
    v_mul_f32 v183, v183, v107
    v_mfma_f32_16x16x32_bf16 v[212:215], a[176:179], a[228:231], v[212:215]
    s_waitcnt lgkmcnt(4)
    v_mfma_f32_16x16x32_bf16 v[248:251], a[16:19], a[252:255], v[248:251]
    buffer_store_dwordx4 v[52:55], v25, s[16:19], s73 offen sc1
    v_mfma_f32_16x16x32_bf16 v[248:251], a[68:71], a[160:163], v[248:251]
    s_waitcnt lgkmcnt(3)
    v_add_f32 v244, v244, v48
    v_mul_f32 v244, v244, v64
    v_mfma_f32_16x16x32_bf16 v[248:251], a[44:47], a[52:55], v[248:251]
    v_add_f32 v245, v245, v49
    v_mul_f32 v245, v245, v65
    v_mfma_f32_16x16x32_bf16 v[248:251], a[116:119], a[88:91], v[248:251]
    s_waitcnt lgkmcnt(2)
    ds_read_b128 a[4:7], v44 offset:14336
    v_mfma_f32_16x16x32_bf16 v[152:155], a[60:63], a[252:255], v[152:155]
    buffer_store_dwordx4 v[120:123], v25, s[16:19], s74 offen sc1
    v_mfma_f32_16x16x32_bf16 v[152:155], a[76:79], a[160:163], v[152:155]
    v_cvt_pk_bf16_f32 v48, v244, v245
    v_mul_f32 v212, v212, v112
    v_mfma_f32_16x16x32_bf16 v[152:155], a[168:171], a[136:139], v[152:155]
    ds_write_b32 v28, v48 offset:14848
    v_mul_f32 v213, v213, v113
    v_mfma_f32_16x16x32_bf16 v[152:155], a[40:43], a[192:195], v[152:155]
    v_mul_f32 v214, v214, v114
    v_mul_f32 v215, v215, v115
    v_mfma_f32_16x16x32_bf16 v[152:155], a[124:127], a[52:55], v[152:155]
    v_cvt_pk_bf16_f32 v101, v212, v149
    v_cvt_pk_bf16_f32 v102, v181, v213
    v_mfma_f32_16x16x32_bf16 v[152:155], a[144:147], a[88:91], v[152:155]
    ds_read_b128 a[12:15], v45 offset:14336
    v_cvt_pk_bf16_f32 v108, v214, v151
    v_mfma_f32_16x16x32_bf16 v[152:155], a[100:103], a[64:67], v[152:155]
    ds_write_b64 v26, v[100:101] offset:14848
    v_cvt_pk_bf16_f32 v109, v183, v215
    v_mfma_f32_16x16x32_bf16 v[152:155], a[148:151], a[248:251], v[152:155]
    ds_write_b64 v26, v[102:103] offset:14856
    v_mfma_f32_16x16x32_bf16 v[184:187], a[28:31], a[252:255], v[184:187]
    ds_write_b64 v26, v[108:109] offset:14864
    v_mfma_f32_16x16x32_bf16 v[184:187], a[36:39], a[160:163], v[184:187]
    ds_read_b128 a[152:155], v42 offset:47104
    v_mfma_f32_16x16x32_bf16 v[184:187], a[172:175], a[136:139], v[184:187]
    ds_write_b64 v29, v[250:251] offset:0
    v_mfma_f32_16x16x32_bf16 v[184:187], a[244:247], a[192:195], v[184:187]
    ds_read_b128 a[104:107], v43 offset:47104
    v_mul_f32 v152, v152, v96
    v_mfma_f32_16x16x32_bf16 v[184:187], a[196:199], a[52:55], v[184:187]
    ds_read_b128 a[56:59], v46 offset:14336
    v_mul_f32 v153, v153, v97
    v_mfma_f32_16x16x32_bf16 v[184:187], a[48:51], a[88:91], v[184:187]
    v_mul_f32 v154, v154, v98
    v_mul_f32 v155, v155, v99
    v_mfma_f32_16x16x32_bf16 v[184:187], a[8:11], a[64:67], v[184:187]
    ds_read_b128 a[72:75], v47 offset:14336
    v_mfma_f32_16x16x32_bf16 v[184:187], a[232:235], a[248:251], v[184:187]
    s_waitcnt lgkmcnt(3)
    s_barrier
    v_mfma_f32_16x16x32_bf16 v[216:219], a[96:99], a[252:255], v[216:219]
    ds_read_b128 v[72:75], v24 offset:14848
    ds_read_b64 v[80:81], v30 offset:0
    v_mfma_f32_16x16x32_bf16 v[216:219], a[108:111], a[160:163], v[216:219]
    ds_read_b128 v[68:71], v24 offset:15776
    v_mfma_f32_16x16x32_bf16 v[216:219], a[120:123], a[136:139], v[216:219]
    v_mfma_f32_16x16x32_bf16 v[216:219], a[92:95], a[192:195], v[216:219]
    v_mul_f32 v184, v184, v104
    v_cvt_pk_bf16_f32 v88, v152, v184
    v_mfma_f32_16x16x32_bf16 v[216:219], a[200:203], a[52:55], v[216:219]
    v_mul_f32 v185, v185, v105
    v_mul_f32 v186, v186, v106
    v_mfma_f32_16x16x32_bf16 v[216:219], a[240:243], a[88:91], v[216:219]
    v_cvt_pk_bf16_f32 v91, v154, v186
    v_mul_f32 v187, v187, v107
    v_mfma_f32_16x16x32_bf16 v[216:219], a[156:159], a[64:67], v[216:219]
    s_waitcnt lgkmcnt(2)
    v_mfma_f32_16x16x32_bf16 v[216:219], a[176:179], a[248:251], v[216:219]
    buffer_store_dwordx4 v[72:75], v25, s[16:19], s75 offen sc1
    v_mfma_f32_16x16x32_bf16 v[252:255], a[16:19], a[140:143], v[252:255]
    s_waitcnt lgkmcnt(1)
    v_add_f32 v248, v248, v80
    v_mul_f32 v248, v248, v64
    v_mfma_f32_16x16x32_bf16 v[252:255], a[68:71], a[0:3], v[252:255]
    v_add_f32 v249, v249, v81
    v_mul_f32 v249, v249, v65
    v_mfma_f32_16x16x32_bf16 v[252:255], a[44:47], a[4:7], v[252:255]
    s_waitcnt lgkmcnt(0)
    v_cvt_pk_bf16_f32 v80, v248, v249
    v_mfma_f32_16x16x32_bf16 v[252:255], a[116:119], a[12:15], v[252:255]
    buffer_store_dwordx4 v[68:71], v25, s[16:19], s58 offen sc1
    v_mfma_f32_16x16x32_bf16 v[156:159], a[60:63], a[140:143], v[156:159]
    ds_write_b32 v28, v80 offset:0
    v_mul_f32 v216, v216, v112
    v_mfma_f32_16x16x32_bf16 v[156:159], a[76:79], a[0:3], v[156:159]
    v_mul_f32 v217, v217, v113
    v_mul_f32 v218, v218, v114
    v_mfma_f32_16x16x32_bf16 v[156:159], a[168:171], a[152:155], v[156:159]
    v_mul_f32 v219, v219, v115
    v_cvt_pk_bf16_f32 v89, v216, v153
    v_mfma_f32_16x16x32_bf16 v[156:159], a[40:43], a[104:107], v[156:159]
    ds_write_b64 v26, v[88:89] offset:0
    v_cvt_pk_bf16_f32 v90, v185, v217
    v_mfma_f32_16x16x32_bf16 v[156:159], a[124:127], a[4:7], v[156:159]
    ds_write_b64 v26, v[90:91] offset:8
    v_cvt_pk_bf16_f32 v76, v218, v155
    v_mfma_f32_16x16x32_bf16 v[156:159], a[144:147], a[12:15], v[156:159]
    ds_write_b64 v29, v[254:255] offset:2048
    v_cvt_pk_bf16_f32 v77, v187, v219
    v_mfma_f32_16x16x32_bf16 v[156:159], a[100:103], a[56:59], v[156:159]
    s_waitcnt vmcnt(12)
    ds_write_b64 v26, v[76:77] offset:16
    v_xor_b32 v8, 15, v8
    v_mfma_f32_16x16x32_bf16 v[156:159], a[148:151], a[72:75], v[156:159]
    v_or_b32 v8, v8, v0
    v_min_u32 v8, 1, v8
    v_mfma_f32_16x16x32_bf16 v[188:191], a[28:31], a[140:143], v[188:191]
    v_lshlrev_b32 v8, 30, v8
    v_mov_b32 v9, s76
    v_mfma_f32_16x16x32_bf16 v[188:191], a[36:39], a[0:3], v[188:191]
    v_mfma_f32_16x16x32_bf16 v[188:191], a[172:175], a[152:155], v[188:191]
    buffer_store_dword v9, v8, s[12:15], s78 offen sc1
    v_mfma_f32_16x16x32_bf16 v[188:191], a[244:247], a[104:107], v[188:191]
    s_waitcnt lgkmcnt(0)
    s_barrier
    v_mfma_f32_16x16x32_bf16 v[188:191], a[196:199], a[4:7], v[188:191]
    ds_read_b128 v[116:119], v24 offset:0
    ds_read_b64 v[84:85], v30 offset:2048
    v_mfma_f32_16x16x32_bf16 v[188:191], a[48:51], a[12:15], v[188:191]
    ds_read_b128 v[92:95], v24 offset:928
    v_mul_f32 v156, v156, v96
    v_mfma_f32_16x16x32_bf16 v[188:191], a[8:11], a[56:59], v[188:191]
    v_mul_f32 v157, v157, v97
    v_mul_f32 v158, v158, v98
    v_mfma_f32_16x16x32_bf16 v[188:191], a[232:235], a[72:75], v[188:191]
    v_mul_f32 v159, v159, v99
    v_mfma_f32_16x16x32_bf16 v[220:223], a[96:99], a[140:143], v[220:223]
    v_mfma_f32_16x16x32_bf16 v[220:223], a[108:111], a[0:3], v[220:223]
    v_mfma_f32_16x16x32_bf16 v[220:223], a[120:123], a[152:155], v[220:223]
    s_waitcnt lgkmcnt(2)
    v_mfma_f32_16x16x32_bf16 v[220:223], a[92:95], a[104:107], v[220:223]
    buffer_store_dwordx4 v[116:119], v25, s[16:19], s48 offen sc1
    v_mfma_f32_16x16x32_bf16 v[220:223], a[200:203], a[4:7], v[220:223]
    s_waitcnt lgkmcnt(1)
    v_add_f32 v252, v252, v84
    v_mul_f32 v252, v252, v64
    v_mfma_f32_16x16x32_bf16 v[220:223], a[240:243], a[12:15], v[220:223]
    v_add_f32 v253, v253, v85
    v_mul_f32 v253, v253, v65
    v_mfma_f32_16x16x32_bf16 v[220:223], a[156:159], a[56:59], v[220:223]
    s_waitcnt lgkmcnt(0)
    v_cvt_pk_bf16_f32 v84, v252, v253
L_pad5:
    s_cbranch_execz L_warmed
    v_mfma_f32_16x16x32_bf16 v[220:223], a[176:179], a[72:75], v[220:223]
    buffer_store_dwordx4 v[92:95], v25, s[16:19], s49 offen sc1
    ds_write_b32 v28, v84 offset:7424
    v_mul_f32 v188, v188, v104
    v_cvt_pk_bf16_f32 v124, v156, v188
    v_mul_f32 v189, v189, v105
    v_mul_f32 v190, v190, v106
    v_cvt_pk_bf16_f32 v127, v158, v190
    v_mul_f32 v191, v191, v107
    v_mul_f32 v220, v220, v112
    v_mul_f32 v221, v221, v113
    v_mul_f32 v222, v222, v114
    v_mul_f32 v223, v223, v115
    v_cvt_pk_bf16_f32 v125, v220, v157
    v_cvt_pk_bf16_f32 v126, v189, v221
    v_cvt_pk_bf16_f32 v52, v222, v159
    v_cvt_pk_bf16_f32 v53, v191, v223
    ds_write_b64 v26, v[124:125] offset:7424
    ds_write_b64 v26, v[126:127] offset:7432
    ds_write_b64 v26, v[52:53] offset:7440
    s_waitcnt lgkmcnt(0)
    s_barrier
    ds_read_b128 v[120:123], v24 offset:7424
    ds_read_b128 v[48:51], v24 offset:8352
    s_waitcnt lgkmcnt(1)
    buffer_store_dwordx4 v[120:123], v25, s[16:19], s50 offen sc1
    s_waitcnt lgkmcnt(0)
    buffer_store_dwordx4 v[48:51], v25, s[16:19], s51 offen sc1
L_end:
    s_endpgm
L_slow1_0:
    s_mov_b32 s22, 1
    s_call_b64 s[20:21], L_tick
    s_mov_b32 s22, 20480
    s_mov_b32 s23, 25600
    buffer_load_dwordx4 v[88:91], v32, s[12:15], s22 offen sc1
    buffer_load_dwordx4 v[92:95], v32, s[12:15], s23 offen sc1
    s_waitcnt vmcnt(0)
    v_bitop3_b32 v91, v91, v95, s76 bitop3:0x7e
    v_cmp_ne_u32 vcc, 0, v91
    s_cbranch_vccnz L_slow1_0
    s_branch L_back1_0
L_slow1_2:
    s_mov_b32 s22, 1
    s_call_b64 s[20:21], L_tick
    s_mov_b32 s22, 20480
    s_mov_b32 s23, 25600
    buffer_load_dwordx2 v[96:97], v34, s[12:15], s22 offen sc1
    buffer_load_dwordx2 v[98:99], v34, s[12:15], s23 offen sc1
    s_waitcnt vmcnt(0)
    v_bitop3_b32 v97, v97, v99, s76 bitop3:0x7e
    v_cmp_ne_u32 vcc, 0, v97
    s_cbranch_vccnz L_slow1_2
    s_branch L_back1_2
L_slow1_1:
    s_mov_b32 s22, 1
    s_call_b64 s[20:21], L_tick
    s_mov_b32 s22, 20480
    s_mov_b32 s23, 25600
    buffer_load_dwordx4 v[104:107], v33, s[12:15], s22 offen sc1
    buffer_load_dwordx4 v[112:115], v33, s[12:15], s23 offen sc1
    s_waitcnt vmcnt(0)
    v_bitop3_b32 v107, v107, v115, s76 bitop3:0x7e
    v_cmp_ne_u32 vcc, 0, v107
    s_cbranch_vccnz L_slow1_1
    s_branch L_back1_1
L_slow2_0:
    s_mov_b32 s22, 2
    s_call_b64 s[20:21], L_tick
    s_mov_b32 s22, 40960
    s_mov_b32 s23, 46080
    buffer_load_dwordx4 v[68:71], v32, s[12:15], s22 offen sc1
    buffer_load_dwordx4 v[80:83], v32, s[12:15], s23 offen sc1
    s_waitcnt vmcnt(0)
    v_bitop3_b32 v71, v71, v83, s76 bitop3:0x7e
    v_cmp_ne_u32 vcc, 0, v71
    s_cbranch_vccnz L_slow2_0
    s_branch L_back2_0
L_slow2_2:
    s_mov_b32 s22, 2
    s_call_b64 s[20:21], L_tick
    s_mov_b32 s22, 40960
    s_mov_b32 s23, 46080
    buffer_load_dwordx2 v[72:73], v34, s[12:15], s22 offen sc1
    buffer_load_dwordx2 v[74:75], v34, s[12:15], s23 offen sc1
    s_waitcnt vmcnt(0)
    v_bitop3_b32 v73, v73, v75, s76 bitop3:0x7e
    v_cmp_ne_u32 vcc, 0, v73
    s_cbranch_vccnz L_slow2_2
    s_branch L_back2_2
L_slow2_1:
    s_mov_b32 s22, 2
    s_call_b64 s[20:21], L_tick
    s_mov_b32 s22, 40960
    s_mov_b32 s23, 46080
    buffer_load_dwordx4 v[76:79], v33, s[12:15], s22 offen sc1
    buffer_load_dwordx4 v[88:91], v33, s[12:15], s23 offen sc1
    s_waitcnt vmcnt(0)
    v_bitop3_b32 v79, v79, v91, s76 bitop3:0x7e
    v_cmp_ne_u32 vcc, 0, v79
    s_cbranch_vccnz L_slow2_1
    s_branch L_back2_1
L_slow3_0:
    s_mov_b32 s22, 3
    s_call_b64 s[20:21], L_tick
    s_mov_b32 s22, 61440
    s_mov_b32 s23, 66560
    buffer_load_dwordx4 v[92:95], v32, s[12:15], s22 offen sc1
    buffer_load_dwordx4 v[84:87], v32, s[12:15], s23 offen sc1
    s_waitcnt vmcnt(0)
    v_bitop3_b32 v95, v95, v87, s76 bitop3:0x7e
    v_cmp_ne_u32 vcc, 0, v95
    s_cbranch_vccnz L_slow3_0
    s_branch L_back3_0
L_slow3_2:
    s_mov_b32 s22, 3
    s_call_b64 s[20:21], L_tick
    s_mov_b32 s22, 61440
    s_mov_b32 s23, 66560
    buffer_load_dwordx2 v[100:101], v34, s[12:15], s22 offen sc1
    buffer_load_dwordx2 v[102:103], v34, s[12:15], s23 offen sc1
    s_waitcnt vmcnt(0)
    v_bitop3_b32 v101, v101, v103, s76 bitop3:0x7e
    v_cmp_ne_u32 vcc, 0, v101
    s_cbranch_vccnz L_slow3_2
    s_branch L_back3_2
L_slow3_1:
    s_mov_b32 s22, 3
    s_call_b64 s[20:21], L_tick
    s_mov_b32 s22, 61440
    s_mov_b32 s23, 66560
    buffer_load_dwordx4 v[108:111], v33, s[12:15], s22 offen sc1
    buffer_load_dwordx4 v[116:119], v33, s[12:15], s23 offen sc1
    s_waitcnt vmcnt(0)
    v_bitop3_b32 v111, v111, v119, s76 bitop3:0x7e
    v_cmp_ne_u32 vcc, 0, v111
    s_cbranch_vccnz L_slow3_1
    s_branch L_back3_1
L_slow4_0:
    s_mov_b32 s22, 4
    s_call_b64 s[20:21], L_tick
    s_mov_b32 s22, 81920
    s_mov_b32 s23, 87040
    buffer_load_dwordx4 v[120:123], v32, s[12:15], s22 offen sc1
    buffer_load_dwordx4 v[124:127], v32, s[12:15], s23 offen sc1
    s_waitcnt vmcnt(0)
    v_bitop3_b32 v123, v123, v127, s76 bitop3:0x7e
    v_cmp_ne_u32 vcc, 0, v123
    s_cbranch_vccnz L_slow4_0
    s_branch L_back4_0
L_slow4_2:
    s_mov_b32 s22, 4
    s_call_b64 s[20:21], L_tick
    s_mov_b32 s22, 81920
    s_mov_b32 s23, 87040
    buffer_load_dwordx2 v[48:49], v34, s[12:15], s22 offen sc1
    buffer_load_dwordx2 v[50:51], v34, s[12:15], s23 offen sc1
    s_waitcnt vmcnt(0)
    v_bitop3_b32 v49, v49, v51, s76 bitop3:0x7e
    v_cmp_ne_u32 vcc, 0, v49
    s_cbranch_vccnz L_slow4_2
    s_branch L_back4_2
L_slow4_1:
    s_mov_b32 s22, 4
    s_call_b64 s[20:21], L_tick
    s_mov_b32 s22, 81920
    s_mov_b32 s23, 87040
    buffer_load_dwordx4 v[52:55], v33, s[12:15], s22 offen sc1
    buffer_load_dwordx4 v[64:67], v33, s[12:15], s23 offen sc1
    s_waitcnt vmcnt(0)
    v_bitop3_b32 v55, v55, v67, s76 bitop3:0x7e
    v_cmp_ne_u32 vcc, 0, v55
    s_cbranch_vccnz L_slow4_1
    s_branch L_back4_1
L_slow5_0:
    s_mov_b32 s22, 5
    s_call_b64 s[20:21], L_tick
    s_mov_b32 s22, 102400
    s_mov_b32 s23, 107520
    buffer_load_dwordx4 v[96:99], v32, s[12:15], s22 offen sc1
    buffer_load_dwordx4 v[104:107], v32, s[12:15], s23 offen sc1
    s_waitcnt vmcnt(0)
    v_bitop3_b32 v99, v99, v107, s76 bitop3:0x7e
    v_cmp_ne_u32 vcc, 0, v99
    s_cbranch_vccnz L_slow5_0
    s_branch L_back5_0
L_slow5_2:
    s_mov_b32 s22, 5
    s_call_b64 s[20:21], L_tick
    s_mov_b32 s22, 102400
    s_mov_b32 s23, 107520
    buffer_load_dwordx2 v[112:113], v34, s[12:15], s22 offen sc1
    buffer_load_dwordx2 v[114:115], v34, s[12:15], s23 offen sc1
    s_waitcnt vmcnt(0)
    v_bitop3_b32 v113, v113, v115, s76 bitop3:0x7e
    v_cmp_ne_u32 vcc, 0, v113
    s_cbranch_vccnz L_slow5_2
    s_branch L_back5_2
L_slow5_1:
    s_mov_b32 s22, 5
    s_call_b64 s[20:21], L_tick
    s_mov_b32 s22, 102400
    s_mov_b32 s23, 107520
    buffer_load_dwordx4 v[68:71], v33, s[12:15], s22 offen sc1
    buffer_load_dwordx4 v[80:83], v33, s[12:15], s23 offen sc1
    s_waitcnt vmcnt(0)
    v_bitop3_b32 v71, v71, v83, s76 bitop3:0x7e
    v_cmp_ne_u32 vcc, 0, v71
    s_cbranch_vccnz L_slow5_1
    s_branch L_back5_1
L_slow6_2:
    s_mov_b32 s22, 6
    s_call_b64 s[20:21], L_tick
    s_mov_b32 s22, 122880
    s_mov_b32 s23, 128000
    buffer_load_dwordx2 v[72:73], v34, s[12:15], s22 offen sc1
    buffer_load_dwordx2 v[74:75], v34, s[12:15], s23 offen sc1
    s_waitcnt vmcnt(0)
    v_bitop3_b32 v73, v73, v75, s76 bitop3:0x7e
    v_cmp_ne_u32 vcc, 0, v73
    s_cbranch_vccnz L_slow6_2
    s_branch L_back6_2
L_slow6_0:
    s_mov_b32 s22, 6
    s_call_b64 s[20:21], L_tick
    s_mov_b32 s22, 122880
    s_mov_b32 s23, 128000
    buffer_load_dwordx4 v[76:79], v32, s[12:15], s22 offen sc1
    buffer_load_dwordx4 v[88:91], v32, s[12:15], s23 offen sc1
    s_waitcnt vmcnt(0)
    v_bitop3_b32 v79, v79, v91, s76 bitop3:0x7e
    v_cmp_ne_u32 vcc, 0, v79
    s_cbranch_vccnz L_slow6_0
    s_branch L_back6_0
L_slow6_1:
    s_mov_b32 s22, 6
    s_call_b64 s[20:21], L_tick
    s_mov_b32 s22, 122880
    s_mov_b32 s23, 128000
    buffer_load_dwordx4 v[92:95], v33, s[12:15], s22 offen sc1
    buffer_load_dwordx4 v[84:87], v33, s[12:15], s23 offen sc1
    s_waitcnt vmcnt(0)
    v_bitop3_b32 v95, v95, v87, s76 bitop3:0x7e
    v_cmp_ne_u32 vcc, 0, v95
    s_cbranch_vccnz L_slow6_1
    s_branch L_back6_1
L_slow7_2:
    s_mov_b32 s22, 7
    s_call_b64 s[20:21], L_tick
    s_mov_b32 s22, 143360
    s_mov_b32 s23, 148480
    buffer_load_dwordx2 v[116:117], v34, s[12:15], s22 offen sc1
    buffer_load_dwordx2 v[118:119], v34, s[12:15], s23 offen sc1
    s_waitcnt vmcnt(0)
    v_bitop3_b32 v117, v117, v119, s76 bitop3:0x7e
    v_cmp_ne_u32 vcc, 0, v117
    s_cbranch_vccnz L_slow7_2
    s_branch L_back7_2
L_slow7_0:
    s_mov_b32 s22, 7
    s_call_b64 s[20:21], L_tick
    s_mov_b32 s22, 143360
    s_mov_b32 s23, 148480
    buffer_load_dwordx4 v[120:123], v32, s[12:15], s22 offen sc1
    buffer_load_dwordx4 v[124:127], v32, s[12:15], s23 offen sc1
    s_waitcnt vmcnt(0)
    v_bitop3_b32 v123, v123, v127, s76 bitop3:0x7e
    v_cmp_ne_u32 vcc, 0, v123
    s_cbranch_vccnz L_slow7_0
    s_branch L_back7_0
L_slow7_1:
    s_mov_b32 s22, 7
    s_call_b64 s[20:21], L_tick
    s_mov_b32 s22, 143360
    s_mov_b32 s23, 148480
    buffer_load_dwordx4 v[48:51], v33, s[12:15], s22 offen sc1
    buffer_load_dwordx4 v[52:55], v33, s[12:15], s23 offen sc1
    s_waitcnt vmcnt(0)
    v_bitop3_b32 v51, v51, v55, s76 bitop3:0x7e
    v_cmp_ne_u32 vcc, 0, v51
    s_cbranch_vccnz L_slow7_1
    s_branch L_back7_1
L_tick:
    s_add_u32 s52, s52, 1
    s_and_b32 s23, s52, 4095
    s_cbranch_scc1 L_tick_ret
L_help:
    s_mov_b32 s53, s61
    s_mov_b32 s54, s62
    s_mov_b32 s72, s6
    s_mov_b32 s6, 14680064
    s_mul_i32 s61, s22, 1835008
    s_add_u32 s61, s61, s79
    s_mul_i32 s62, s22, 20480
    s_mul_i32 s23, s59, 163840
    s_add_u32 s62, s62, s23
    s_mov_b32 s22, 0
L_help_row:
    buffer_load_dwordx4 v[12:15], v19, s[4:7], s61 offen
    buffer_load_dwordx3 v[8:10], v18, s[4:7], s61 offen
    s_waitcnt vmcnt(0)
    v_lshlrev_b32 v12, v5, v12
    v_lshlrev_b32 v13, v5, v13
    v_lshlrev_b32 v14, v5, v14
    v_lshlrev_b32 v15, v5, v15
    v_permlane32_swap_b32 v12, v13
    s_nop 0
    v_permlane32_swap_b32 v14, v15
    v_or_b32 v12, v12, v13
    v_or_b32 v14, v14, v15
    v_mov_b32 v13, s76
    s_nop 0
    v_permlane16_swap_b32 v12, v14
    v_or_b32 v12, v12, v14
    s_nop 1
    v_or_b32_dpp v12, v12, v12 row_ror:8 row_mask:0xf bank_mask:0xf
    buffer_store_dwordx2 v[12:13], v21, s[12:15], s62 offen sc1
    v_mov_b32 v11, s76
    s_mov_b32 s23, 4
L_help_e:
    s_add_u32 s61, s61, 14336
    buffer_load_dwordx3 v[12:14], v18, s[4:7], s61 offen
    s_waitcnt vmcnt(0)
    v_lshl_or_b32 v8, v12, s23, v8
    v_lshl_or_b32 v9, v13, s23, v9
    v_lshl_or_b32 v10, v14, s23, v10
    s_add_u32 s23, s23, 4
    s_cmp_lt_u32 s23, 32
    s_cbranch_scc1 L_help_e
    buffer_store_dwordx4 v[8:11], v20, s[12:15], s62 offen sc1
    s_add_u32 s61, s61, 14336
    s_add_u32 s62, s62, 1280
    s_waitcnt vmcnt(0)
    s_add_u32 s22, s22, 1
    s_cmp_lt_u32 s22, 16
    s_cbranch_scc1 L_help_row
    s_mov_b32 s61, s53
    s_mov_b32 s62, s54
    s_mov_b32 s6, s72
L_tick_ret:
    s_setpc_b64 s[20:21]
L_code_end:

.section .rodata,"a"
.p2align 6
.amdhsa_kernel standalone__normalfloat_lut_af4__prompt_kernel
  .amdhsa_next_free_vgpr 512
  .amdhsa_next_free_sgpr 102
  .amdhsa_accum_offset 256
  .amdhsa_group_segment_fixed_size 0
  .amdhsa_kernarg_size 56
  .amdhsa_user_sgpr_count 2
  .amdhsa_user_sgpr_kernarg_segment_ptr 1
  .amdhsa_system_sgpr_workgroup_id_x 1
.end_amdhsa_kernel
```

```asm
; @launch grid=(256,1,1) block=(256,1,1) lds=163840
.amdgcn_target "amdgcn-amd-amdhsa--gfx950"
.text
.globl standalone__normalfloat_lut_af4__prompt_kernel
.p2align 8
.type standalone__normalfloat_lut_af4__prompt_kernel,@function
standalone__normalfloat_lut_af4__prompt_kernel:
    s_cmp_ge_u32 s2, 256
    s_cbranch_scc1 L_end
    s_load_dwordx2 s[4:5], s[0:1], 8
    s_load_dwordx2 s[12:13], s[0:1], 48
    s_load_dwordx2 s[8:9], s[0:1], 0
    s_load_dwordx2 s[28:29], s[0:1], 16
    s_getpc_b64 s[48:49]
    s_mov_b32 s50, L_code_end-standalone__normalfloat_lut_af4__prompt_kernel-256
    s_mov_b32 s51, 0x20000
    s_lshr_b32 s61, s2, 3
    v_lshl_add_u32 v10, v0, 5, s61
    v_lshlrev_b32 v10, 7, v10
    buffer_load_dword v1, v10, s[48:51], 0 offen offset:256
    v_lshrrev_b32 v5, 6, v0
    v_and_b32 v2, 63, v0
    s_and_b32 s60, s2, 7
    v_readfirstlane_b32 s63, v5
    s_and_b32 s58, s60, 1
    s_lshl_b32 s58, s58, 3
    s_and_b32 s62, s61, 7
    s_add_u32 s58, s58, s62
    s_lshr_b32 s59, s60, 1
    s_lshl_b32 s59, s59, 2
    s_lshr_b32 s62, s61, 3
    s_add_u32 s59, s59, s62
    v_mul_u32_u24 v18, 12, v2
    v_lshrrev_b32 v6, 3, v2
    v_and_b32 v7, 7, v2
    v_mul_u32_u24 v19, 14336, v6
    v_lshl_add_u32 v19, v7, 4, v19
    v_add_u32 v19, 768, v19
    s_lshl_b32 s60, s63, 4
    s_add_u32 s60, s60, s58
    s_mul_i32 s61, s60, 114688
    s_mul_i32 s79, s59, 896
    s_add_u32 s61, s61, s79
    s_mov_b32 s6, 14680064
    s_mov_b32 s7, 0x20000
    s_lshl_b32 s78, s59, 7
    s_add_u32 s78, s78, 2621440
    v_and_b32 v4, 15, v2
    v_lshrrev_b32 v3, 4, v2
    s_mov_b32 s46, 2
    s_cmp_lg_u32 s63, 0
    s_cbranch_scc1 L_role0
    s_mov_b32 s46, 0
L_role0:
    s_cmp_lg_u32 s63, 1
    s_cbranch_scc1 L_role1
    s_mov_b32 s46, 1
L_role1:
    v_lshlrev_b32 v16, 1, v4
    v_lshrrev_b32 v17, 4, v0
    v_lshlrev_b32 v17, 1, v17
    s_mov_b32 s30, 32
    s_mov_b32 s31, 0x20000
    v_xor_b32 v13, v7, v3
    s_lshl_b32 s70, s63, 5
    v_add_lshl_u32 v12, v6, s70, 11
    v_lshl_add_u32 v36, v13, 4, v12
    v_xor_b32 v37, 64, v36
    v_add_u32 v38, 30720, v36
    v_add_u32 v37, 15360, v37
    v_add_u32 v39, 30720, v37
    s_mov_b32 s10, 4194304
    s_mov_b32 s11, 0x20000
    s_lshl_b32 s55, s58, 18
    s_lshl_b32 s57, s63, 12
    s_add_u32 s57, s57, 65536
    s_mov_b32 s14, 2623488
    s_mov_b32 s15, 0x20000
    s_mul_i32 s68, s59, 163840
    s_mul_i32 s62, s60, 1280
    s_add_u32 s62, s62, s68
    v_lshlrev_b32 v5, 2, v6
    v_lshlrev_b32 v20, 4, v2
    v_and_b32 v12, 1, v6
    v_lshlrev_b32 v12, 30, v12
    v_and_b32 v13, 4, v7
    v_mad_u32_u24 v21, v13, 3, v7
    v_lshl_add_u32 v21, v3, 2, v21
    v_lshl_add_u32 v21, v21, 3, v12
    v_add_u32 v21, 1024, v21
    s_waitcnt lgkmcnt(0)
    s_load_dword s76, s[12:13], s78
    s_cmp_eq_u32 s46, 1
    s_cbranch_scc1 L_L
    s_cmp_eq_u32 s46, 2
    s_cbranch_scc1 L_L
L_X:
    buffer_load_dwordx4 v[160:163], v19, s[4:7], s61 offen
    buffer_load_dwordx3 v[128:130], v18, s[4:7], s61 offen
    s_add_u32 s61, s61, 14336
    buffer_load_dwordx3 v[132:134], v18, s[4:7], s61 offen
    s_add_u32 s61, s61, 14336
    buffer_load_dwordx3 v[136:138], v18, s[4:7], s61 offen
    s_add_u32 s61, s61, 14336
    buffer_load_dwordx3 v[140:142], v18, s[4:7], s61 offen
    s_add_u32 s61, s61, 14336
    buffer_load_dwordx3 v[144:146], v18, s[4:7], s61 offen
    s_add_u32 s61, s61, 14336
    buffer_load_dwordx3 v[148:150], v18, s[4:7], s61 offen
    s_add_u32 s61, s61, 14336
    buffer_load_dwordx3 v[152:154], v18, s[4:7], s61 offen
    s_add_u32 s61, s61, 14336
    buffer_load_dwordx3 v[156:158], v18, s[4:7], s61 offen
    s_add_u32 s61, s61, 7239680
    s_cmp_eq_u32 s46, 1
    s_cbranch_scc1 L_D
    s_cmp_eq_u32 s46, 2
    s_cbranch_scc1 L_B
L_L:
    buffer_load_ushort v16, v16, s[28:31], 0 offen
    buffer_load_ushort v17, v17, s[28:31], 0 offen
    s_cmp_eq_u32 s46, 1
    s_cbranch_scc1 L_S
    s_cmp_eq_u32 s46, 2
    s_cbranch_scc1 L_S
L_D:
    s_add_u32 m0, s57, 32768
    s_add_u32 s56, s55, 0
    buffer_load_dwordx4 v36, s[8:11], s56 offen offset:0 lds
    buffer_load_dwordx4 v37, s[8:11], s56 offen offset:1024 lds
    buffer_load_dwordx4 v38, s[8:11], s56 offen offset:2048 lds
    buffer_load_dwordx4 v39, s[8:11], s56 offen offset:3072 lds
    s_add_u32 m0, s57, 49152
    s_add_u32 s3, s55, 128
    buffer_load_dwordx4 v36, s[8:11], s3 offen offset:0 lds
    buffer_load_dwordx4 v37, s[8:11], s3 offen offset:1024 lds
    buffer_load_dwordx4 v38, s[8:11], s3 offen offset:2048 lds
    buffer_load_dwordx4 v39, s[8:11], s3 offen offset:3072 lds
    s_cmp_eq_u32 s46, 1
    s_cbranch_scc1 L_G
    s_cmp_eq_u32 s46, 2
    s_cbranch_scc1 L_G
L_S:
    s_load_dwordx2 s[32:33], s[0:1], 24
    s_load_dwordx2 s[16:17], s[0:1], 32
    s_load_dwordx2 s[24:25], s[0:1], 40
    s_and_b32 s64, s63, 1
    s_lshr_b32 s65, s63, 1
    s_mul_i32 s69, s64, 10240
    v_mul_u32_u24 v12, 1280, v3
    s_lshl_b32 s70, s63, 8
    s_add_u32 s70, s70, s68
    v_lshl_add_u32 v33, v4, 4, v12
    s_add_u32 s71, s70, s69
    v_add_u32 v32, s71, v33
    s_sub_u32 s71, 10240, s69
    s_add_u32 s71, s71, s70
    v_add_u32 v33, s71, v33
    v_and_b32 v13, 1, v4
    v_lshlrev_b32 v13, 6, v13
    s_lshl_b32 s70, s64, 1
    v_xor_b32 v31, s70, v4
    v_and_b32 v31, 2, v31
    v_lshl_add_u32 v13, v31, 4, v13
    v_lshrrev_b32 v31, 2, v4
    v_lshl_add_u32 v13, v31, 3, v13
    s_lshl_b32 s70, s65, 7
    s_add_u32 s70, s70, s68
    s_add_u32 s70, s70, s69
    s_add_u32 s70, s70, 1024
    v_add3_u32 v34, v12, v13, s70
    s_mov_b32 s36, 202114048
    s_mov_b32 s37, 202114304
    s_mov_b32 s38, 202114560
    s_mov_b32 s39, 202114816
    v_and_b32 v35, 31, v2
    v_lshlrev_b32 v35, 2, v35
    v_lshrrev_b32 v12, 1, v4
    v_xor_b32 v12, v12, v3
    v_lshlrev_b32 v12, 4, v12
    v_lshl_add_u32 v12, v4, 7, v12
    s_lshl_b32 s70, s64, 14
    s_add_u32 s72, s70, 65536
    s_sub_u32 s73, 81920, s70
    v_add_u32 v40, s72, v12
    v_add_u32 v42, s73, v12
    v_xor_b32 v41, 64, v40
    v_xor_b32 v43, 64, v42
    v_add_u32 v44, 65536, v40
    v_add_u32 v45, 65536, v41
    v_add_u32 v46, 65536, v42
    v_add_u32 v47, 65536, v43
    s_mov_b32 s52, 0
    s_mov_b32 s40, 0
    s_mov_b32 s41, 5120
    v_lshlrev_b32 v8, 4, v7
    v_lshl_add_u32 v8, v0, 8, v8
    v_xor_b32 v9, 16, v8
    v_xor_b32 v10, 32, v8
    v_xor_b32 v11, 48, v8
    v_xor_b32 v12, 64, v8
    v_xor_b32 v13, 80, v8
    v_xor_b32 v14, 96, v8
    v_xor_b32 v15, 112, v8
    s_cmp_eq_u32 s46, 1
    s_cbranch_scc1 L_X
    s_cmp_eq_u32 s46, 2
    s_cbranch_scc1 L_D
L_G:
    s_waitcnt lgkmcnt(0)
    s_add_u32 s76, s76, 2654435769
    s_cmp_eq_u32 s46, 1
    s_cbranch_scc1 L_T
    s_cmp_eq_u32 s46, 2
    s_cbranch_scc1 L_T
L_K:
    s_waitcnt vmcnt(18)
    v_lshlrev_b32 v160, v5, v160
    v_lshlrev_b32 v161, v5, v161
    v_lshlrev_b32 v162, v5, v162
    v_lshlrev_b32 v163, v5, v163
    v_mov_b32 v131, s76
    v_permlane32_swap_b32 v160, v161
    v_permlane32_swap_b32 v162, v163
    v_or_b32 v160, v160, v161
    v_or_b32 v162, v162, v163
    v_mov_b32 v161, s76
    s_waitcnt vmcnt(16)
    v_lshl_or_b32 v128, v132, 4, v128
    v_permlane16_swap_b32 v160, v162
    v_or_b32 v160, v160, v162
    v_lshl_or_b32 v129, v133, 4, v129
    v_lshl_or_b32 v130, v134, 4, v130
    v_or_b32_dpp v160, v160, v160 row_ror:8 row_mask:0xf bank_mask:0xf
    buffer_store_dwordx2 v[160:161], v21, s[12:15], s62 offen sc1
    s_waitcnt vmcnt(16)
    v_lshl_or_b32 v128, v136, 8, v128
    v_lshl_or_b32 v129, v137, 8, v129
    v_lshl_or_b32 v130, v138, 8, v130
    s_waitcnt vmcnt(15)
    v_lshl_or_b32 v128, v140, 12, v128
    v_lshl_or_b32 v129, v141, 12, v129
    v_lshl_or_b32 v130, v142, 12, v130
    s_waitcnt vmcnt(14)
    v_lshl_or_b32 v128, v144, 16, v128
    v_lshl_or_b32 v129, v145, 16, v129
    v_lshl_or_b32 v130, v146, 16, v130
    s_waitcnt vmcnt(13)
    v_lshl_or_b32 v128, v148, 20, v128
    v_lshl_or_b32 v129, v149, 20, v129
    v_lshl_or_b32 v130, v150, 20, v130
    s_waitcnt vmcnt(12)
    v_lshl_or_b32 v128, v152, 24, v128
    v_lshl_or_b32 v129, v153, 24, v129
    v_lshl_or_b32 v130, v154, 24, v130
    s_waitcnt vmcnt(11)
    v_lshl_or_b32 v128, v156, 28, v128
    v_lshl_or_b32 v129, v157, 28, v129
    v_lshl_or_b32 v130, v158, 28, v130
    buffer_store_dwordx4 v[128:131], v20, s[12:15], s62 offen sc1
    s_add_u32 s62, s62, 81920
    s_cmp_eq_u32 s46, 1
    s_cbranch_scc1 L_B
    s_cmp_eq_u32 s46, 2
    s_cbranch_scc1 L_E
L_T:
    s_waitcnt vmcnt(17)
    s_cmp_eq_u32 s46, 1
    s_cbranch_scc1 L_rw1
    s_waitcnt vmcnt(10)
    s_cmp_eq_u32 s46, 0
    s_cbranch_scc1 L_rw1
    s_waitcnt vmcnt(8)
L_rw1:
    v_lshl_or_b32 v56, v17, 16, v16
    v_lshl_or_b32 v57, v17, 16, v16
    v_lshl_or_b32 v58, v17, 16, v16
    v_lshl_or_b32 v59, v17, 16, v16
    ds_write_b128 v8, v[56:59]
    ds_write_b128 v9, v[56:59]
    ds_write_b128 v10, v[56:59]
    ds_write_b128 v11, v[56:59]
    ds_write_b128 v12, v[56:59]
    ds_write_b128 v13, v[56:59]
    ds_write_b128 v14, v[56:59]
    ds_write_b128 v15, v[56:59]
    s_cmp_lg_u32 s46, 1
    s_cbranch_scc1 L_ed2
    s_waitcnt vmcnt(8)
    s_branch L_K
L_ed2:
    s_cmp_eq_u32 s46, 2
    s_cbranch_scc1 L_X
L_W:
    s_mov_b64 exec, 0
    s_cmp_eq_u32 s63, 0
    s_cbranch_scc1 L_pad0
L_warmed:
    s_mov_b64 exec, -1
L_B:
    s_waitcnt vmcnt(9) lgkmcnt(0)
    s_cmp_eq_u32 s46, 2
    s_cbranch_scc1 L_rw3
    s_waitcnt vmcnt(2)
L_rw3:
    s_barrier
L_Q:
    ds_read_b128 a[0:3], v40 offset:32768
    ds_read_b128 a[4:7], v41 offset:32768
    ds_read_b128 a[8:11], v40 offset:34816
    ds_read_b128 a[12:15], v41 offset:34816
    ds_read_b128 a[16:19], v40 offset:36864
    ds_read_b128 a[20:23], v41 offset:36864
    ds_read_b128 a[24:27], v40 offset:38912
    ds_read_b128 a[28:31], v41 offset:38912
    ds_read_b128 a[36:39], v40 offset:40960
    ds_read_b128 a[40:43], v41 offset:40960
    ds_read_b128 a[44:47], v40 offset:43008
    ds_read_b128 a[52:55], v41 offset:43008
    ds_read_b128 a[56:59], v40 offset:45056
    ds_read_b128 a[64:67], v41 offset:45056
    ds_read_b128 a[68:71], v40 offset:47104
    ds_read_b128 a[72:75], v41 offset:47104
L_P:
    buffer_load_dwordx4 v[64:67], v32, s[12:15], s40 offen sc1
    buffer_load_dwordx4 v[68:71], v32, s[12:15], s41 offen sc1
    buffer_load_dwordx2 v[72:73], v34, s[12:15], s40 offen sc1
    buffer_load_dwordx2 v[74:75], v34, s[12:15], s41 offen sc1
    buffer_load_dwordx4 v[76:79], v33, s[12:15], s40 offen sc1
    buffer_load_dwordx4 v[80:83], v33, s[12:15], s41 offen sc1
    s_cmp_lg_u32 s46, 2
    s_cbranch_scc1 L_ed4
    s_waitcnt vmcnt(6)
    s_branch L_K
L_ed4:
L_E:
    s_add_u32 m0, s57, 65536
    s_add_u32 s56, s55, 256
    buffer_load_dwordx4 v36, s[8:11], s56 offen offset:0 lds
    buffer_load_dwordx4 v37, s[8:11], s56 offen offset:1024 lds
    buffer_load_dwordx4 v38, s[8:11], s56 offen offset:2048 lds
    buffer_load_dwordx4 v39, s[8:11], s56 offen offset:3072 lds
L_chk0:
    s_waitcnt vmcnt(10)
    s_cmp_eq_u32 s46, 2
    s_cbranch_scc1 L_rw5
    s_waitcnt vmcnt(8)
L_rw5:
    v_bitop3_b32 v67, v67, v71, s76 bitop3:0x7e
    v_cmp_ne_u32 vcc, 0, v67
    s_cbranch_vccnz L_retry0
    v_perm_b32 v56, v64, v35, s36
    v_perm_b32 v57, v64, v35, s37
    v_perm_b32 v58, v64, v35, s38
    v_perm_b32 v59, v64, v35, s39
    v_perm_b32 v60, v68, v35, s36
    v_perm_b32 v61, v68, v35, s37
    v_perm_b32 v62, v68, v35, s38
    v_perm_b32 v63, v68, v35, s39
    ds_read_b32 a32, v56
    ds_read_b32 a33, v57
    ds_read_b32 a34, v58
    ds_read_b32 a35, v59
    ds_read_b32 a48, v60
    ds_read_b32 a49, v61
    ds_read_b32 a50, v62
    ds_read_b32 a51, v63
    v_perm_b32 v56, v65, v35, s36
    v_perm_b32 v57, v65, v35, s37
    v_perm_b32 v58, v65, v35, s38
    v_perm_b32 v59, v65, v35, s39
    v_perm_b32 v60, v69, v35, s36
    v_perm_b32 v61, v69, v35, s37
    ds_read_b32 a60, v56
    ds_read_b32 a61, v57
    ds_read_b32 a62, v58
    ds_read_b32 a63, v59
    s_waitcnt vmcnt(6)
    s_cmp_eq_u32 s46, 2
    s_cbranch_scc1 L_rw6
    s_waitcnt vmcnt(4)
L_rw6:
    v_bitop3_b32 v79, v79, v83, s76 bitop3:0x7e
    v_bitop3_b32 v73, v73, v75, s76 bitop3:0x7e
    v_or_b32 v79, v79, v73
    v_cmp_ne_u32 vcc, 0, v79
    s_cbranch_vccz L_main
L_retry0:
    s_add_u32 s52, s52, 1
    s_and_b32 s23, s52, 4095
    s_cbranch_scc1 L_retry0b
    s_mov_b32 s22, 0
    s_call_b64 s[20:21], L_help
L_retry0b:
    buffer_load_dwordx4 v[64:67], v32, s[12:15], s40 offen sc1
    buffer_load_dwordx4 v[68:71], v32, s[12:15], s41 offen sc1
    buffer_load_dwordx2 v[72:73], v34, s[12:15], s40 offen sc1
    buffer_load_dwordx2 v[74:75], v34, s[12:15], s41 offen sc1
    buffer_load_dwordx4 v[76:79], v33, s[12:15], s40 offen sc1
    buffer_load_dwordx4 v[80:83], v33, s[12:15], s41 offen sc1
    s_waitcnt vmcnt(0) lgkmcnt(0)
    s_branch L_chk0
.p2align 12
L_main:
L_pad0:
    s_cbranch_execz L_pad1
    s_waitcnt lgkmcnt(8)
    v_mfma_f32_16x16x32_bf16 v[128:131], a[32:35], a[0:3], 0
    s_waitcnt lgkmcnt(4)
    s_add_u32 m0, s57, 81920
    ds_read_b32 a76, v60
    v_mfma_f32_16x16x32_bf16 v[128:131], a[48:51], a[4:7], v[128:131]
    s_add_u32 s3, s55, 384
    ds_read_b32 a77, v61
    v_perm_b32 v62, v69, v35, s38
    v_mfma_f32_16x16x32_bf16 v[132:135], a[32:35], a[8:11], 0
    s_add_u32 s56, s55, 512
    ds_read_b128 a[80:83], v42 offset:32768
    v_perm_b32 v63, v69, v35, s39
    v_mfma_f32_16x16x32_bf16 v[132:135], a[48:51], a[12:15], v[132:135]
    s_mov_b32 s40, 20480
    ds_read_b32 a78, v62
    v_mfma_f32_16x16x32_bf16 v[136:139], a[32:35], a[16:19], 0
    buffer_load_dwordx4 v[84:87], v32, s[12:15], s40 offen sc1
    v_mfma_f32_16x16x32_bf16 v[136:139], a[48:51], a[20:23], v[136:139]
    s_mov_b32 s41, 25600
    ds_read_b32 a79, v63
    v_perm_b32 v56, v66, v35, s36
    v_mfma_f32_16x16x32_bf16 v[140:143], a[32:35], a[24:27], 0
    s_mov_b32 s42, 20480
    ds_read_b32 a84, v56
    v_perm_b32 v57, v66, v35, s37
    v_mfma_f32_16x16x32_bf16 v[140:143], a[48:51], a[28:31], v[140:143]
    ds_read_b128 a[88:91], v43 offset:32768
    v_mfma_f32_16x16x32_bf16 v[144:147], a[32:35], a[36:39], 0
    buffer_load_dwordx4 v[88:91], v32, s[12:15], s41 offen sc1
    v_mfma_f32_16x16x32_bf16 v[144:147], a[48:51], a[40:43], v[144:147]
    ds_read_b32 a85, v57
    ds_read_b128 a[92:95], v42 offset:34816
    v_mfma_f32_16x16x32_bf16 v[148:151], a[32:35], a[44:47], 0
    s_mov_b32 s43, 25600
    v_perm_b32 v58, v66, v35, s38
    v_perm_b32 v59, v66, v35, s39
    v_mfma_f32_16x16x32_bf16 v[148:151], a[48:51], a[52:55], v[148:151]
    ds_read_b32 a86, v58
    ds_read_b32 a87, v59
    v_mfma_f32_16x16x32_bf16 v[152:155], a[32:35], a[56:59], 0
    buffer_load_dwordx4 v36, s[8:11], s3 offen offset:0 lds
    v_mfma_f32_16x16x32_bf16 v[152:155], a[48:51], a[64:67], v[152:155]
    ds_read_b128 a[96:99], v43 offset:34816
    v_perm_b32 v60, v70, v35, s36
    v_mfma_f32_16x16x32_bf16 v[156:159], a[32:35], a[68:71], 0
    s_mov_b32 s44, 20480
    ds_read_b32 a100, v60
    v_perm_b32 v61, v70, v35, s37
    v_mfma_f32_16x16x32_bf16 v[156:159], a[48:51], a[72:75], v[156:159]
    s_waitcnt lgkmcnt(7)
    ds_read_b32 a101, v61
    ds_read_b128 a[104:107], v42 offset:36864
    v_mfma_f32_16x16x32_bf16 v[160:163], a[60:63], a[0:3], 0
    buffer_load_dwordx4 v37, s[8:11], s3 offen offset:1024 lds
    v_mfma_f32_16x16x32_bf16 v[160:163], a[76:79], a[4:7], v[160:163]
    ds_read_b128 a[108:111], v43 offset:36864
    v_perm_b32 v62, v70, v35, s38
    v_mfma_f32_16x16x32_bf16 v[164:167], a[60:63], a[8:11], 0
    s_mov_b32 s45, 25600
    ds_read_b32 a102, v62
    v_perm_b32 v63, v70, v35, s39
    v_mfma_f32_16x16x32_bf16 v[164:167], a[76:79], a[12:15], v[164:167]
    ds_read_b32 a103, v63
    ds_read_b128 a[112:115], v42 offset:38912
    v_mfma_f32_16x16x32_bf16 v[168:171], a[60:63], a[16:19], 0
    buffer_load_dwordx4 v38, s[8:11], s3 offen offset:2048 lds
    v_mfma_f32_16x16x32_bf16 v[168:171], a[76:79], a[20:23], v[168:171]
    v_perm_b32 v56, v72, v35, s36
    v_perm_b32 v57, v72, v35, s37
    v_mfma_f32_16x16x32_bf16 v[172:175], a[60:63], a[24:27], 0
    ds_read_b32 a116, v56
    v_perm_b32 v58, v72, v35, s38
    v_mfma_f32_16x16x32_bf16 v[172:175], a[76:79], a[28:31], v[172:175]
    ds_read_b32 a117, v57
    ds_read_b32 a118, v58
    v_mfma_f32_16x16x32_bf16 v[176:179], a[60:63], a[36:39], 0
    buffer_load_dwordx4 v39, s[8:11], s3 offen offset:3072 lds
    v_mfma_f32_16x16x32_bf16 v[176:179], a[76:79], a[40:43], v[176:179]
    s_add_u32 m0, s57, 0
    ds_read_b128 a[120:123], v43 offset:38912
    v_perm_b32 v59, v72, v35, s39
    v_mfma_f32_16x16x32_bf16 v[180:183], a[60:63], a[44:47], 0
    s_add_u32 s3, s55, 640
    ds_read_b32 a119, v59
    v_perm_b32 v60, v74, v35, s36
    v_mfma_f32_16x16x32_bf16 v[180:183], a[76:79], a[52:55], v[180:183]
    ds_read_b32 a128, v60
    ds_read_b128 a[124:127], v42 offset:40960
    v_mfma_f32_16x16x32_bf16 v[184:187], a[60:63], a[56:59], 0
    buffer_load_dwordx2 v[92:93], v34, s[12:15], s42 offen sc1
    v_mfma_f32_16x16x32_bf16 v[184:187], a[76:79], a[64:67], v[184:187]
    ds_read_b128 a[132:135], v43 offset:40960
    v_perm_b32 v61, v74, v35, s37
    v_mfma_f32_16x16x32_bf16 v[188:191], a[60:63], a[68:71], 0
    ds_read_b32 a129, v61
    v_perm_b32 v62, v74, v35, s38
    v_mfma_f32_16x16x32_bf16 v[188:191], a[76:79], a[72:75], v[188:191]
    s_waitcnt lgkmcnt(8)
    ds_read_b32 a130, v62
    ds_read_b128 a[136:139], v42 offset:43008
    v_mfma_f32_16x16x32_bf16 v[192:195], a[84:87], a[0:3], 0
    buffer_load_dwordx2 v[94:95], v34, s[12:15], s43 offen sc1
    v_mfma_f32_16x16x32_bf16 v[192:195], a[100:103], a[4:7], v[192:195]
    v_perm_b32 v63, v74, v35, s39
    v_perm_b32 v56, v76, v35, s36
    v_mfma_f32_16x16x32_bf16 v[196:199], a[84:87], a[8:11], 0
    ds_read_b32 a131, v63
    v_perm_b32 v57, v76, v35, s37
    v_mfma_f32_16x16x32_bf16 v[196:199], a[100:103], a[12:15], v[196:199]
    ds_read_b32 a140, v56
    ds_read_b32 a141, v57
    v_mfma_f32_16x16x32_bf16 v[200:203], a[84:87], a[16:19], 0
    buffer_load_dwordx4 v[96:99], v33, s[12:15], s44 offen sc1
    v_mfma_f32_16x16x32_bf16 v[200:203], a[100:103], a[20:23], v[200:203]
    ds_read_b128 a[144:147], v43 offset:43008
    v_perm_b32 v58, v76, v35, s38
    v_mfma_f32_16x16x32_bf16 v[204:207], a[84:87], a[24:27], 0
    ds_read_b32 a142, v58
    v_perm_b32 v59, v76, v35, s39
    v_mfma_f32_16x16x32_bf16 v[204:207], a[100:103], a[28:31], v[204:207]
    ds_read_b32 a143, v59
    ds_read_b128 a[148:151], v42 offset:45056
    v_mfma_f32_16x16x32_bf16 v[208:211], a[84:87], a[36:39], 0
    buffer_load_dwordx4 v[100:103], v33, s[12:15], s45 offen sc1
    v_mfma_f32_16x16x32_bf16 v[208:211], a[100:103], a[40:43], v[208:211]
    ds_read_b128 a[152:155], v43 offset:45056
    v_perm_b32 v60, v80, v35, s36
    v_mfma_f32_16x16x32_bf16 v[212:215], a[84:87], a[44:47], 0
    ds_read_b32 a156, v60
    v_perm_b32 v61, v80, v35, s37
    v_mfma_f32_16x16x32_bf16 v[212:215], a[100:103], a[52:55], v[212:215]
    ds_read_b32 a157, v61
    ds_read_b128 a[160:163], v42 offset:47104
    v_mfma_f32_16x16x32_bf16 v[216:219], a[84:87], a[56:59], 0
    buffer_load_dwordx4 v[104:107], v19, s[4:7], s61 offen
    v_mfma_f32_16x16x32_bf16 v[216:219], a[100:103], a[64:67], v[216:219]
    v_perm_b32 v62, v80, v35, s38
    v_perm_b32 v63, v80, v35, s39
    v_mfma_f32_16x16x32_bf16 v[220:223], a[84:87], a[68:71], 0
    ds_read_b32 a158, v62
    v_perm_b32 v56, v77, v35, s36
    v_mfma_f32_16x16x32_bf16 v[220:223], a[100:103], a[72:75], v[220:223]
    s_waitcnt lgkmcnt(7)
    ds_read_b32 a159, v63
    ds_read_b32 a164, v56
    v_mfma_f32_16x16x32_bf16 v[224:227], a[116:119], a[0:3], 0
    buffer_load_dwordx3 v[108:110], v18, s[4:7], s61 offen
    v_mfma_f32_16x16x32_bf16 v[224:227], a[128:131], a[4:7], v[224:227]
    s_add_u32 s61, s61, 14336
    ds_read_b128 a[168:171], v43 offset:47104
    v_perm_b32 v57, v77, v35, s37
    v_mfma_f32_16x16x32_bf16 v[228:231], a[116:119], a[8:11], 0
    v_perm_b32 v58, v77, v35, s38
    v_perm_b32 v59, v77, v35, s39
    v_mfma_f32_16x16x32_bf16 v[228:231], a[128:131], a[12:15], v[228:231]
    ds_read_b32 a165, v57
    ds_read_b32 a166, v58
    v_mfma_f32_16x16x32_bf16 v[232:235], a[116:119], a[16:19], 0
    buffer_load_dwordx3 v[112:114], v18, s[4:7], s61 offen
    v_mfma_f32_16x16x32_bf16 v[232:235], a[128:131], a[20:23], v[232:235]
    s_add_u32 s61, s61, 14336
    ds_read_b32 a167, v59
    v_perm_b32 v60, v81, v35, s36
    v_mfma_f32_16x16x32_bf16 v[236:239], a[116:119], a[24:27], 0
    v_perm_b32 v61, v81, v35, s37
    v_perm_b32 v62, v81, v35, s38
    v_mfma_f32_16x16x32_bf16 v[236:239], a[128:131], a[28:31], v[236:239]
    s_waitcnt vmcnt(11)
    ds_read_b32 a172, v60
    ds_read_b32 a173, v61
    v_mfma_f32_16x16x32_bf16 v[240:243], a[116:119], a[36:39], 0
    buffer_load_dwordx3 v[116:118], v18, s[4:7], s61 offen
    v_mfma_f32_16x16x32_bf16 v[240:243], a[128:131], a[40:43], v[240:243]
    s_add_u32 s61, s61, 14336
    ds_read_b32 a174, v62
    v_bitop3_b32 v87, v87, v91, s76 bitop3:0x7e
    v_mfma_f32_16x16x32_bf16 v[244:247], a[116:119], a[44:47], 0
    v_cmp_ne_u32 vcc, 0, v87
    v_perm_b32 v63, v81, v35, s39
    v_mfma_f32_16x16x32_bf16 v[244:247], a[128:131], a[52:55], v[244:247]
    ds_read_b32 a175, v63
    v_mfma_f32_16x16x32_bf16 v[248:251], a[116:119], a[56:59], 0
    buffer_load_dwordx3 v[120:122], v18, s[4:7], s61 offen
    v_mfma_f32_16x16x32_bf16 v[248:251], a[128:131], a[64:67], v[248:251]
    s_add_u32 s61, s61, 14336
    v_perm_b32 v56, v78, v35, s36
    v_perm_b32 v57, v78, v35, s37
    v_mfma_f32_16x16x32_bf16 v[252:255], a[116:119], a[68:71], 0
    v_perm_b32 v58, v78, v35, s38
    s_cbranch_vccnz L_slow1_0
L_back1_0:
    v_mfma_f32_16x16x32_bf16 v[252:255], a[128:131], a[72:75], v[252:255]
    s_waitcnt lgkmcnt(4)
    ds_read_b32 a176, v56
    ds_read_b32 a177, v57
    v_mfma_f32_16x16x32_bf16 v[128:131], a[140:143], a[80:83], v[128:131]
    buffer_load_dwordx3 v[124:126], v18, s[4:7], s61 offen
    v_mfma_f32_16x16x32_bf16 v[128:131], a[156:159], a[88:91], v[128:131]
    s_add_u32 s61, s61, 14336
    ds_read_b32 a178, v58
    v_perm_b32 v59, v78, v35, s39
    v_mfma_f32_16x16x32_bf16 v[132:135], a[140:143], a[92:95], v[132:135]
    v_perm_b32 v60, v82, v35, s36
    v_perm_b32 v61, v82, v35, s37
    v_mfma_f32_16x16x32_bf16 v[132:135], a[156:159], a[96:99], v[132:135]
    ds_read_b32 a179, v59
    ds_read_b32 a180, v60
    v_mfma_f32_16x16x32_bf16 v[136:139], a[140:143], a[104:107], v[136:139]
    buffer_load_dwordx3 v[48:50], v18, s[4:7], s61 offen
    v_mfma_f32_16x16x32_bf16 v[136:139], a[156:159], a[108:111], v[136:139]
    s_add_u32 s61, s61, 14336
    ds_read_b32 a181, v61
    v_perm_b32 v62, v82, v35, s38
    v_mfma_f32_16x16x32_bf16 v[140:143], a[140:143], a[112:115], v[140:143]
    v_perm_b32 v63, v82, v35, s39
    v_perm_b32 v56, v84, v35, s36
    v_mfma_f32_16x16x32_bf16 v[140:143], a[156:159], a[120:123], v[140:143]
    ds_read_b32 a182, v62
    ds_read_b32 a183, v63
    v_mfma_f32_16x16x32_bf16 v[144:147], a[140:143], a[124:127], v[144:147]
    buffer_load_dwordx3 v[52:54], v18, s[4:7], s61 offen
    v_mfma_f32_16x16x32_bf16 v[144:147], a[156:159], a[132:135], v[144:147]
    s_add_u32 s61, s61, 14336
    ds_read_b32 a184, v56
    v_perm_b32 v57, v84, v35, s37
    v_mfma_f32_16x16x32_bf16 v[148:151], a[140:143], a[136:139], v[148:151]
    ds_read_b32 a185, v57
    v_perm_b32 v58, v84, v35, s38
    v_mfma_f32_16x16x32_bf16 v[148:151], a[156:159], a[144:147], v[148:151]
    ds_read_b32 a186, v58
    v_perm_b32 v59, v84, v35, s39
    v_mfma_f32_16x16x32_bf16 v[152:155], a[140:143], a[148:151], v[152:155]
    v_perm_b32 v60, v88, v35, s36
    v_perm_b32 v61, v88, v35, s37
    v_mfma_f32_16x16x32_bf16 v[152:155], a[156:159], a[152:155], v[152:155]
    ds_read_b32 a187, v59
    ds_read_b32 a188, v60
    v_mfma_f32_16x16x32_bf16 v[156:159], a[140:143], a[160:163], v[156:159]
    buffer_load_dwordx3 v[64:66], v18, s[4:7], s61 offen
    v_mfma_f32_16x16x32_bf16 v[156:159], a[156:159], a[168:171], v[156:159]
    ds_read_b32 a189, v61
    v_perm_b32 v62, v88, v35, s38
    v_mfma_f32_16x16x32_bf16 v[160:163], a[164:167], a[80:83], v[160:163]
    s_waitcnt lgkmcnt(6)
    ds_read_b32 a190, v62
    v_perm_b32 v63, v88, v35, s39
    v_mfma_f32_16x16x32_bf16 v[160:163], a[172:175], a[88:91], v[160:163]
    ds_read_b32 a191, v63
    v_perm_b32 v56, v85, v35, s36
    v_mfma_f32_16x16x32_bf16 v[164:167], a[164:167], a[92:95], v[164:167]
    v_perm_b32 v57, v85, v35, s37
    v_mfma_f32_16x16x32_bf16 v[164:167], a[172:175], a[96:99], v[164:167]
    ds_read_b32 a192, v56
    v_mfma_f32_16x16x32_bf16 v[168:171], a[164:167], a[104:107], v[168:171]
    ds_read_b32 a193, v57
    v_mfma_f32_16x16x32_bf16 v[168:171], a[172:175], a[108:111], v[168:171]
    buffer_load_dwordx4 v36, s[8:11], s56 offen offset:0 lds
    v_mfma_f32_16x16x32_bf16 v[172:175], a[164:167], a[112:115], v[172:175]
    v_perm_b32 v58, v85, v35, s38
    v_perm_b32 v59, v85, v35, s39
    v_mfma_f32_16x16x32_bf16 v[172:175], a[172:175], a[120:123], v[172:175]
    ds_read_b32 a194, v58
    v_perm_b32 v60, v89, v35, s36
    v_mfma_f32_16x16x32_bf16 v[176:179], a[164:167], a[124:127], v[176:179]
    ds_read_b32 a195, v59
    v_mfma_f32_16x16x32_bf16 v[176:179], a[172:175], a[132:135], v[176:179]
    ds_read_b32 a196, v60
    v_perm_b32 v61, v89, v35, s37
    v_mfma_f32_16x16x32_bf16 v[180:183], a[164:167], a[136:139], v[180:183]
    s_waitcnt vmcnt(14)
    v_perm_b32 v62, v89, v35, s38
    v_mfma_f32_16x16x32_bf16 v[180:183], a[172:175], a[144:147], v[180:183]
    s_barrier
    v_mfma_f32_16x16x32_bf16 v[184:187], a[164:167], a[148:151], v[184:187]
    buffer_load_dwordx4 v37, s[8:11], s56 offen offset:1024 lds
    v_mfma_f32_16x16x32_bf16 v[184:187], a[172:175], a[152:155], v[184:187]
    ds_read_b128 a[200:203], v44 offset:0
    ds_read_b32 a197, v61
    v_mfma_f32_16x16x32_bf16 v[188:191], a[164:167], a[160:163], v[188:191]
    ds_read_b128 a[204:207], v45 offset:0
    ds_read_b32 a198, v62
    v_mfma_f32_16x16x32_bf16 v[188:191], a[172:175], a[168:171], v[188:191]
    s_waitcnt vmcnt(13)
    ds_read_b128 a[208:211], v44 offset:2048
    v_bitop3_b32 v93, v93, v95, s76 bitop3:0x7e
    v_mfma_f32_16x16x32_bf16 v[192:195], a[176:179], a[80:83], v[192:195]
    ds_read_b128 a[212:215], v45 offset:2048
    v_cmp_ne_u32 vcc, 0, v93
    v_mfma_f32_16x16x32_bf16 v[192:195], a[180:183], a[88:91], v[192:195]
    ds_read_b128 a[216:219], v44 offset:4096
    v_perm_b32 v63, v89, v35, s39
    v_mfma_f32_16x16x32_bf16 v[196:199], a[176:179], a[92:95], v[196:199]
    ds_read_b128 a[220:223], v45 offset:4096
    ds_read_b32 a199, v63
    v_mfma_f32_16x16x32_bf16 v[196:199], a[180:183], a[96:99], v[196:199]
    ds_read_b128 a[224:227], v44 offset:6144
    s_cbranch_vccnz L_slow1_2
L_back1_2:
    v_mfma_f32_16x16x32_bf16 v[200:203], a[176:179], a[104:107], v[200:203]
    buffer_load_dwordx4 v38, s[8:11], s56 offen offset:2048 lds
    v_mfma_f32_16x16x32_bf16 v[200:203], a[180:183], a[108:111], v[200:203]
    ds_read_b128 a[228:231], v45 offset:6144
    v_perm_b32 v56, v86, v35, s36
    v_mfma_f32_16x16x32_bf16 v[204:207], a[176:179], a[112:115], v[204:207]
    ds_read_b128 a[232:235], v44 offset:8192
    ds_read_b32 a236, v56
    v_mfma_f32_16x16x32_bf16 v[204:207], a[180:183], a[120:123], v[204:207]
    ds_read_b128 a[240:243], v45 offset:8192
    v_perm_b32 v57, v86, v35, s37
    v_mfma_f32_16x16x32_bf16 v[208:211], a[176:179], a[124:127], v[208:211]
    ds_read_b128 a[244:247], v44 offset:10240
    ds_read_b32 a237, v57
    v_mfma_f32_16x16x32_bf16 v[208:211], a[180:183], a[132:135], v[208:211]
    ds_read_b128 a[248:251], v45 offset:10240
    v_perm_b32 v58, v86, v35, s38
    v_mfma_f32_16x16x32_bf16 v[212:215], a[176:179], a[136:139], v[212:215]
    s_waitcnt vmcnt(12)
    ds_read_b128 a[252:255], v44 offset:12288
    ds_read_b32 a238, v58
    v_mfma_f32_16x16x32_bf16 v[212:215], a[180:183], a[144:147], v[212:215]
    s_mov_b32 s48, 40960
    ds_read_b128 a[32:35], v45 offset:12288
    v_perm_b32 v59, v86, v35, s39
    v_mfma_f32_16x16x32_bf16 v[216:219], a[176:179], a[148:151], v[216:219]
    s_mov_b32 s49, 40960
    v_bitop3_b32 v99, v99, v103, s76 bitop3:0x7e
    v_perm_b32 v60, v90, v35, s36
    v_mfma_f32_16x16x32_bf16 v[216:219], a[180:183], a[152:155], v[216:219]
    s_mov_b32 s50, 40960
    ds_read_b32 a239, v59
    ds_read_b32 a48, v60
    v_mfma_f32_16x16x32_bf16 v[220:223], a[176:179], a[160:163], v[220:223]
    buffer_load_dwordx4 v[68:71], v32, s[12:15], s48 offen sc1
    v_mfma_f32_16x16x32_bf16 v[220:223], a[180:183], a[168:171], v[220:223]
    s_waitcnt lgkmcnt(9)
    s_mov_b32 s69, 46080
    ds_read_b128 a[60:63], v44 offset:14336
    v_cmp_ne_u32 vcc, 0, v99
    v_mfma_f32_16x16x32_bf16 v[128:131], a[184:187], a[200:203], v[128:131]
    s_mov_b32 s40, 46080
    ds_read_b128 a[76:79], v45 offset:14336
    v_perm_b32 v61, v90, v35, s37
    v_mfma_f32_16x16x32_bf16 v[128:131], a[188:191], a[204:207], v[128:131]
    ds_read_b32 a49, v61
    s_cbranch_vccnz L_slow1_1
L_back1_1:
    v_mfma_f32_16x16x32_bf16 v[132:135], a[184:187], a[208:211], v[132:135]
    buffer_load_dwordx4 v[72:75], v32, s[12:15], s69 offen sc1
    v_mfma_f32_16x16x32_bf16 v[132:135], a[188:191], a[212:215], v[132:135]
    s_mov_b32 s41, 46080
    ds_read_b128 a[84:87], v46 offset:0
    v_perm_b32 v62, v90, v35, s38
    v_mfma_f32_16x16x32_bf16 v[136:139], a[184:187], a[216:219], v[136:139]
    ds_read_b32 a50, v62
    v_perm_b32 v63, v90, v35, s39
    v_mfma_f32_16x16x32_bf16 v[136:139], a[188:191], a[220:223], v[136:139]
    s_waitcnt lgkmcnt(7)
    ds_read_b32 a51, v63
    ds_read_b128 a[100:103], v47 offset:0
    v_mfma_f32_16x16x32_bf16 v[140:143], a[184:187], a[224:227], v[140:143]
    buffer_load_dwordx4 v39, s[8:11], s56 offen offset:3072 lds
    v_mfma_f32_16x16x32_bf16 v[140:143], a[188:191], a[228:231], v[140:143]
    s_add_u32 m0, s57, 16384
    ds_read_b128 a[0:3], v46 offset:2048
    v_perm_b32 v56, v92, v35, s36
    v_mfma_f32_16x16x32_bf16 v[144:147], a[184:187], a[232:235], v[144:147]
    s_add_u32 s56, s55, 768
    ds_read_b32 a4, v56
    v_perm_b32 v57, v92, v35, s37
    v_mfma_f32_16x16x32_bf16 v[144:147], a[188:191], a[240:243], v[144:147]
    ds_read_b32 a5, v57
    v_perm_b32 v58, v92, v35, s38
    v_mfma_f32_16x16x32_bf16 v[148:151], a[184:187], a[244:247], v[148:151]
    ds_read_b32 a6, v58
    v_perm_b32 v59, v92, v35, s39
    v_mfma_f32_16x16x32_bf16 v[148:151], a[188:191], a[248:251], v[148:151]
    ds_read_b32 a7, v59
    ds_read_b128 a[8:11], v47 offset:2048
    v_mfma_f32_16x16x32_bf16 v[152:155], a[184:187], a[252:255], v[152:155]
    buffer_load_dwordx4 v36, s[8:11], s3 offen offset:0 lds
    v_mfma_f32_16x16x32_bf16 v[152:155], a[188:191], a[32:35], v[152:155]
    s_waitcnt lgkmcnt(8)
    ds_read_b128 a[12:15], v46 offset:4096
    v_perm_b32 v60, v94, v35, s36
    v_mfma_f32_16x16x32_bf16 v[156:159], a[184:187], a[60:63], v[156:159]
    ds_read_b32 a16, v60
    v_perm_b32 v61, v94, v35, s37
    v_mfma_f32_16x16x32_bf16 v[156:159], a[188:191], a[76:79], v[156:159]
    ds_read_b32 a17, v61
    v_perm_b32 v62, v94, v35, s38
    v_mfma_f32_16x16x32_bf16 v[160:163], a[192:195], a[200:203], v[160:163]
    ds_read_b32 a18, v62
    ds_read_b128 a[20:23], v47 offset:4096
    v_mfma_f32_16x16x32_bf16 v[160:163], a[196:199], a[204:207], v[160:163]
    v_perm_b32 v63, v94, v35, s39
    v_perm_b32 v56, v96, v35, s36
    v_mfma_f32_16x16x32_bf16 v[164:167], a[192:195], a[208:211], v[164:167]
    ds_read_b32 a19, v63
    ds_read_b32 a24, v56
    v_mfma_f32_16x16x32_bf16 v[164:167], a[196:199], a[212:215], v[164:167]
    buffer_load_dwordx4 v37, s[8:11], s3 offen offset:1024 lds
    v_mfma_f32_16x16x32_bf16 v[168:171], a[192:195], a[216:219], v[168:171]
    ds_read_b128 a[28:31], v46 offset:6144
    v_perm_b32 v57, v96, v35, s37
    v_mfma_f32_16x16x32_bf16 v[168:171], a[196:199], a[220:223], v[168:171]
    ds_read_b32 a25, v57
    v_perm_b32 v58, v96, v35, s38
    v_mfma_f32_16x16x32_bf16 v[172:175], a[192:195], a[224:227], v[172:175]
    ds_read_b32 a26, v58
    ds_read_b128 a[36:39], v47 offset:6144
    v_mfma_f32_16x16x32_bf16 v[172:175], a[196:199], a[228:231], v[172:175]
    v_perm_b32 v59, v96, v35, s39
    v_perm_b32 v60, v100, v35, s36
    v_mfma_f32_16x16x32_bf16 v[176:179], a[192:195], a[232:235], v[176:179]
    s_mov_b32 s42, 61440
    ds_read_b32 a27, v59
    ds_read_b32 a40, v60
    v_mfma_f32_16x16x32_bf16 v[176:179], a[196:199], a[240:243], v[176:179]
    v_perm_b32 v61, v100, v35, s37
    v_perm_b32 v62, v100, v35, s38
    v_mfma_f32_16x16x32_bf16 v[180:183], a[192:195], a[244:247], v[180:183]
    ds_read_b32 a41, v61
    ds_read_b32 a42, v62
    v_mfma_f32_16x16x32_bf16 v[180:183], a[196:199], a[248:251], v[180:183]
    buffer_load_dwordx4 v38, s[8:11], s3 offen offset:2048 lds
    v_mfma_f32_16x16x32_bf16 v[184:187], a[192:195], a[252:255], v[184:187]
    s_mov_b32 s43, 66560
    ds_read_b128 a[44:47], v46 offset:8192
    v_perm_b32 v63, v100, v35, s39
    v_mfma_f32_16x16x32_bf16 v[184:187], a[196:199], a[32:35], v[184:187]
    ds_read_b32 a43, v63
    ds_read_b128 a[52:55], v47 offset:8192
    v_mfma_f32_16x16x32_bf16 v[188:191], a[192:195], a[60:63], v[188:191]
    v_perm_b32 v56, v97, v35, s36
    v_perm_b32 v57, v97, v35, s37
    v_mfma_f32_16x16x32_bf16 v[188:191], a[196:199], a[76:79], v[188:191]
    ds_read_b32 a56, v56
    ds_read_b32 a57, v57
    v_mfma_f32_16x16x32_bf16 v[192:195], a[236:239], a[200:203], v[192:195]
    s_waitcnt lgkmcnt(9)
    v_perm_b32 v58, v97, v35, s38
    v_perm_b32 v59, v97, v35, s39
    v_mfma_f32_16x16x32_bf16 v[192:195], a[48:51], a[204:207], v[192:195]
    ds_read_b32 a58, v58
    ds_read_b32 a59, v59
    v_mfma_f32_16x16x32_bf16 v[196:199], a[236:239], a[208:211], v[196:199]
    buffer_load_dwordx4 v39, s[8:11], s3 offen offset:3072 lds
    v_mfma_f32_16x16x32_bf16 v[196:199], a[48:51], a[212:215], v[196:199]
    s_add_u32 m0, s57, 32768
    ds_read_b128 a[64:67], v46 offset:10240
    v_perm_b32 v60, v101, v35, s36
    v_mfma_f32_16x16x32_bf16 v[200:203], a[236:239], a[216:219], v[200:203]
    s_add_u32 s3, s55, 896
    ds_read_b32 a68, v60
    v_perm_b32 v61, v101, v35, s37
    v_mfma_f32_16x16x32_bf16 v[200:203], a[48:51], a[220:223], v[200:203]
    ds_read_b32 a69, v61
    ds_read_b128 a[116:119], v47 offset:10240
    v_mfma_f32_16x16x32_bf16 v[204:207], a[236:239], a[224:227], v[204:207]
    buffer_load_dwordx2 v[76:77], v34, s[12:15], s49 offen sc1
    v_mfma_f32_16x16x32_bf16 v[204:207], a[48:51], a[228:231], v[204:207]
    ds_read_b128 a[72:75], v46 offset:12288
    v_perm_b32 v62, v101, v35, s38
    v_mfma_f32_16x16x32_bf16 v[208:211], a[236:239], a[232:235], v[208:211]
    ds_read_b32 a70, v62
    v_perm_b32 v63, v101, v35, s39
    v_mfma_f32_16x16x32_bf16 v[208:211], a[48:51], a[240:243], v[208:211]
    ds_read_b32 a71, v63
    ds_read_b128 a[128:131], v47 offset:12288
    v_mfma_f32_16x16x32_bf16 v[212:215], a[236:239], a[244:247], v[212:215]
    buffer_load_dwordx2 v[78:79], v34, s[12:15], s40 offen sc1
    v_mfma_f32_16x16x32_bf16 v[212:215], a[48:51], a[248:251], v[212:215]
    ds_read_b128 a[140:143], v46 offset:14336
    v_perm_b32 v56, v98, v35, s36
    v_mfma_f32_16x16x32_bf16 v[216:219], a[236:239], a[252:255], v[216:219]
    s_waitcnt vmcnt(20)
    v_perm_b32 v57, v98, v35, s37
    v_perm_b32 v58, v98, v35, s38
    v_mfma_f32_16x16x32_bf16 v[216:219], a[48:51], a[32:35], v[216:219]
    v_lshlrev_b32 v104, v5, v104
    v_lshlrev_b32 v105, v5, v105
    v_lshlrev_b32 v106, v5, v106
    v_lshlrev_b32 v107, v5, v107
    v_mov_b32 v111, s76
    s_waitcnt vmcnt(18)
    v_lshl_or_b32 v108, v112, 4, v108
    v_permlane32_swap_b32 v104, v105
    v_permlane32_swap_b32 v106, v107
    v_or_b32 v104, v104, v105
    v_or_b32 v106, v106, v107
    v_mov_b32 v105, s76
    v_lshl_or_b32 v109, v113, 4, v109
    v_lshl_or_b32 v110, v114, 4, v110
    v_permlane16_swap_b32 v104, v106
    v_or_b32 v104, v104, v106
    s_waitcnt vmcnt(17)
    v_lshl_or_b32 v108, v116, 8, v108
    v_lshl_or_b32 v109, v117, 8, v109
    v_or_b32_dpp v104, v104, v104 row_ror:8 row_mask:0xf bank_mask:0xf
    v_lshl_or_b32 v110, v118, 8, v110
    s_waitcnt vmcnt(16)
    v_lshl_or_b32 v108, v120, 12, v108
    v_lshl_or_b32 v109, v121, 12, v109
    v_lshl_or_b32 v110, v122, 12, v110
    s_waitcnt vmcnt(15)
    v_lshl_or_b32 v108, v124, 16, v108
    v_lshl_or_b32 v109, v125, 16, v109
    v_lshl_or_b32 v110, v126, 16, v110
    s_waitcnt vmcnt(14)
    v_lshl_or_b32 v108, v48, 20, v108
    v_lshl_or_b32 v109, v49, 20, v109
    v_lshl_or_b32 v110, v50, 20, v110
    s_waitcnt vmcnt(13)
    v_lshl_or_b32 v108, v52, 24, v108
    v_lshl_or_b32 v109, v53, 24, v109
    v_lshl_or_b32 v110, v54, 24, v110
    s_waitcnt vmcnt(12)
    v_lshl_or_b32 v108, v64, 28, v108
    v_lshl_or_b32 v109, v65, 28, v109
    v_lshl_or_b32 v110, v66, 28, v110
    buffer_store_dwordx4 v[108:111], v20, s[12:15], s62 offen sc1
    buffer_store_dwordx2 v[104:105], v21, s[12:15], s62 offen sc1
    s_mul_i32 s66, s63, 96
    s_lshl_b32 s67, s65, 5
    s_lshl_b32 s70, s64, 2
    s_add_u32 s67, s67, s70
    s_add_u32 s67, s67, 384
    s_mul_i32 s71, s59, 448
    s_add_u32 s70, s66, s71
    v_mad_u32_u24 v22, v3, 24, s70
    s_add_u32 s70, s67, s71
    v_lshl_add_u32 v23, v3, 3, s70
    s_mov_b32 s34, 7168
    s_mov_b32 s35, 0x20000
    s_mov_b32 s26, 256
    s_mov_b32 s27, 0x20000
    s_lshl_b32 s77, s59, 4
    s_mov_b32 s18, 14680064
L_pad1:
    s_cbranch_execz L_pad2
    s_mov_b32 s19, 0x20000
    s_sub_u32 s70, 65536, s71
    v_mul_u32_u24 v16, 464, v4
    v_add3_u32 v26, v22, v16, s70
    v_add3_u32 v28, v23, v16, s70
    v_lshlrev_b32 v29, 3, v0
    v_xor_b32 v30, 512, v29
    v_add_u32 v29, 87808, v29
    v_add_u32 v30, 87808, v30
    v_mul_u32_u24 v16, 2341, v2
    v_lshrrev_b32 v16, 16, v16
    s_mul_i32 s73, s63, 1856
    s_add_u32 s73, s73, 65536
    v_add_lshl_u32 v24, v2, v16, 4
    v_add_u32 v24, s73, v24
    s_lshl_b32 s74, s58, 7
    s_lshl_b32 s75, s63, 2
    s_add_u32 s74, s74, s75
    s_mul_i32 s74, s74, 7168
    s_add_u32 s74, s74, s71
    v_mul_u32_u24 v17, 6720, v16
    v_lshl_add_u32 v25, v2, 4, v17
    v_lshrrev_b32 v16, 1, v16
    v_lshlrev_b32 v16, 30, v16
    v_add3_u32 v25, v25, v16, s74
    v_mfma_f32_16x16x32_bf16 v[220:223], a[236:239], a[60:63], v[220:223]
    buffer_load_dwordx4 v[80:83], v33, s[12:15], s50 offen sc1
    v_mfma_f32_16x16x32_bf16 v[220:223], a[48:51], a[76:79], v[220:223]
    ds_read_b32 a156, v56
    ds_read_b32 a157, v57
    v_mfma_f32_16x16x32_bf16 v[224:227], a[4:7], a[200:203], v[224:227]
    ds_read_b32 a158, v58
    v_perm_b32 v59, v98, v35, s39
    v_mfma_f32_16x16x32_bf16 v[224:227], a[16:19], a[204:207], v[224:227]
    ds_read_b32 a159, v59
    ds_read_b128 a[164:167], v47 offset:14336
    v_mfma_f32_16x16x32_bf16 v[228:231], a[4:7], a[208:211], v[228:231]
    buffer_load_dwordx4 v[84:87], v33, s[12:15], s41 offen sc1
    v_mfma_f32_16x16x32_bf16 v[228:231], a[16:19], a[212:215], v[228:231]
    v_perm_b32 v60, v102, v35, s36
    v_perm_b32 v61, v102, v35, s37
    v_mfma_f32_16x16x32_bf16 v[232:235], a[4:7], a[216:219], v[232:235]
    ds_read_b32 a172, v60
    v_perm_b32 v62, v102, v35, s38
    v_mfma_f32_16x16x32_bf16 v[232:235], a[16:19], a[220:223], v[232:235]
    ds_read_b32 a173, v61
    ds_read_b32 a174, v62
    v_mfma_f32_16x16x32_bf16 v[236:239], a[4:7], a[224:227], v[236:239]
    buffer_load_dwordx4 v[88:91], v32, s[12:15], s42 offen sc1
    v_mfma_f32_16x16x32_bf16 v[236:239], a[16:19], a[228:231], v[236:239]
    v_perm_b32 v63, v102, v35, s39
    v_mfma_f32_16x16x32_bf16 v[240:243], a[4:7], a[232:235], v[240:243]
    ds_read_b32 a175, v63
    v_mfma_f32_16x16x32_bf16 v[240:243], a[16:19], a[240:243], v[240:243]
    v_mfma_f32_16x16x32_bf16 v[244:247], a[4:7], a[244:247], v[244:247]
    buffer_load_dwordx4 v[92:95], v32, s[12:15], s43 offen sc1
    v_mfma_f32_16x16x32_bf16 v[244:247], a[16:19], a[248:251], v[244:247]
    v_mfma_f32_16x16x32_bf16 v[248:251], a[4:7], a[252:255], v[248:251]
    v_mfma_f32_16x16x32_bf16 v[248:251], a[16:19], a[32:35], v[248:251]
    v_mfma_f32_16x16x32_bf16 v[252:255], a[4:7], a[60:63], v[252:255]
    v_mfma_f32_16x16x32_bf16 v[252:255], a[16:19], a[76:79], v[252:255]
    s_waitcnt lgkmcnt(1)
    s_mov_b32 s44, 61440
    v_mfma_f32_16x16x32_bf16 v[128:131], a[24:27], a[84:87], v[128:131]
    v_mfma_f32_16x16x32_bf16 v[128:131], a[40:43], a[100:103], v[128:131]
    buffer_load_dwordx4 v36, s[8:11], s56 offen offset:0 lds
    v_mfma_f32_16x16x32_bf16 v[132:135], a[24:27], a[0:3], v[132:135]
    s_mov_b32 s45, 66560
    v_mfma_f32_16x16x32_bf16 v[132:135], a[40:43], a[8:11], v[132:135]
    v_mfma_f32_16x16x32_bf16 v[136:139], a[24:27], a[12:15], v[136:139]
    v_mfma_f32_16x16x32_bf16 v[136:139], a[40:43], a[20:23], v[136:139]
    v_mfma_f32_16x16x32_bf16 v[140:143], a[24:27], a[28:31], v[140:143]
    v_mfma_f32_16x16x32_bf16 v[140:143], a[40:43], a[36:39], v[140:143]
    v_mfma_f32_16x16x32_bf16 v[144:147], a[24:27], a[44:47], v[144:147]
    v_mfma_f32_16x16x32_bf16 v[144:147], a[40:43], a[52:55], v[144:147]
    buffer_load_dwordx4 v37, s[8:11], s56 offen offset:1024 lds
    v_mfma_f32_16x16x32_bf16 v[148:151], a[24:27], a[64:67], v[148:151]
    v_mfma_f32_16x16x32_bf16 v[148:151], a[40:43], a[116:119], v[148:151]
    v_mfma_f32_16x16x32_bf16 v[152:155], a[24:27], a[72:75], v[152:155]
    s_waitcnt vmcnt(15)
    s_mov_b32 s48, 61440
    v_bitop3_b32 v71, v71, v75, s76 bitop3:0x7e
    v_mfma_f32_16x16x32_bf16 v[152:155], a[40:43], a[128:131], v[152:155]
    v_cmp_ne_u32 vcc, 0, v71
    v_mfma_f32_16x16x32_bf16 v[156:159], a[24:27], a[140:143], v[156:159]
    v_mfma_f32_16x16x32_bf16 v[156:159], a[40:43], a[164:167], v[156:159]
    s_cbranch_vccnz L_slow2_0
L_back2_0:
    v_mfma_f32_16x16x32_bf16 v[160:163], a[56:59], a[84:87], v[160:163]
    buffer_load_dwordx4 v38, s[8:11], s56 offen offset:2048 lds
    v_mfma_f32_16x16x32_bf16 v[160:163], a[68:71], a[100:103], v[160:163]
    s_mov_b32 s69, 66560
    v_perm_b32 v56, v68, v35, s36
    v_perm_b32 v57, v68, v35, s37
    v_mfma_f32_16x16x32_bf16 v[164:167], a[56:59], a[0:3], v[164:167]
    ds_read_b32 a80, v56
    ds_read_b32 a81, v57
    v_mfma_f32_16x16x32_bf16 v[164:167], a[68:71], a[8:11], v[164:167]
    v_perm_b32 v58, v68, v35, s38
    v_perm_b32 v59, v68, v35, s39
    v_mfma_f32_16x16x32_bf16 v[168:171], a[56:59], a[12:15], v[168:171]
    ds_read_b32 a82, v58
    ds_read_b32 a83, v59
    v_mfma_f32_16x16x32_bf16 v[168:171], a[68:71], a[20:23], v[168:171]
    v_perm_b32 v60, v72, v35, s36
    v_perm_b32 v61, v72, v35, s37
    v_mfma_f32_16x16x32_bf16 v[172:175], a[56:59], a[28:31], v[172:175]
    ds_read_b32 a88, v60
    ds_read_b32 a89, v61
    v_mfma_f32_16x16x32_bf16 v[172:175], a[68:71], a[36:39], v[172:175]
    buffer_load_dwordx4 v39, s[8:11], s56 offen offset:3072 lds
    v_mfma_f32_16x16x32_bf16 v[176:179], a[56:59], a[44:47], v[176:179]
    s_add_u32 m0, s57, 49152
    v_perm_b32 v62, v72, v35, s38
    v_perm_b32 v63, v72, v35, s39
    v_mfma_f32_16x16x32_bf16 v[176:179], a[68:71], a[52:55], v[176:179]
    s_add_u32 s56, s55, 1024
    ds_read_b32 a90, v62
    ds_read_b32 a91, v63
    v_mfma_f32_16x16x32_bf16 v[180:183], a[56:59], a[64:67], v[180:183]
    v_perm_b32 v56, v69, v35, s36
    v_perm_b32 v57, v69, v35, s37
    v_mfma_f32_16x16x32_bf16 v[180:183], a[68:71], a[116:119], v[180:183]
    ds_read_b32 a92, v56
    ds_read_b32 a93, v57
    v_mfma_f32_16x16x32_bf16 v[184:187], a[56:59], a[72:75], v[184:187]
    v_perm_b32 v58, v69, v35, s38
    v_perm_b32 v59, v69, v35, s39
    v_mfma_f32_16x16x32_bf16 v[184:187], a[68:71], a[128:131], v[184:187]
    ds_read_b32 a94, v58
    ds_read_b32 a95, v59
    v_perm_b32 v60, v73, v35, s36
    v_mfma_f32_16x16x32_bf16 v[188:191], a[56:59], a[140:143], v[188:191]
    ds_read_b32 a96, v60
    v_mfma_f32_16x16x32_bf16 v[188:191], a[68:71], a[164:167], v[188:191]
    buffer_load_dwordx4 v36, s[8:11], s3 offen offset:0 lds
    v_mfma_f32_16x16x32_bf16 v[192:195], a[156:159], a[84:87], v[192:195]
    s_waitcnt lgkmcnt(7)
    v_perm_b32 v61, v73, v35, s37
    v_perm_b32 v62, v73, v35, s38
    v_mfma_f32_16x16x32_bf16 v[192:195], a[172:175], a[100:103], v[192:195]
    ds_read_b32 a97, v61
    ds_read_b32 a98, v62
    v_mfma_f32_16x16x32_bf16 v[196:199], a[156:159], a[0:3], v[196:199]
    v_perm_b32 v63, v73, v35, s39
    v_perm_b32 v56, v70, v35, s36
    v_mfma_f32_16x16x32_bf16 v[196:199], a[172:175], a[8:11], v[196:199]
    ds_read_b32 a99, v63
    ds_read_b32 a104, v56
    v_mfma_f32_16x16x32_bf16 v[200:203], a[156:159], a[12:15], v[200:203]
    v_perm_b32 v57, v70, v35, s37
    v_perm_b32 v58, v70, v35, s38
    v_mfma_f32_16x16x32_bf16 v[200:203], a[172:175], a[20:23], v[200:203]
    s_waitcnt vmcnt(13)
    ds_read_b32 a105, v57
    ds_read_b32 a106, v58
    v_mfma_f32_16x16x32_bf16 v[204:207], a[156:159], a[28:31], v[204:207]
    buffer_load_dwordx4 v37, s[8:11], s3 offen offset:1024 lds
    v_mfma_f32_16x16x32_bf16 v[204:207], a[172:175], a[36:39], v[204:207]
    s_barrier
    v_mfma_f32_16x16x32_bf16 v[208:211], a[156:159], a[44:47], v[208:211]
    ds_read_b128 a[108:111], v40 offset:0
    v_perm_b32 v59, v70, v35, s39
    v_mfma_f32_16x16x32_bf16 v[208:211], a[172:175], a[52:55], v[208:211]
    ds_read_b128 a[112:115], v41 offset:0
    ds_read_b32 a107, v59
    v_mfma_f32_16x16x32_bf16 v[212:215], a[156:159], a[64:67], v[212:215]
    ds_read_b128 a[120:123], v40 offset:2048
    v_perm_b32 v60, v74, v35, s36
    v_mfma_f32_16x16x32_bf16 v[212:215], a[172:175], a[116:119], v[212:215]
    ds_read_b128 a[124:127], v41 offset:2048
    ds_read_b32 a132, v60
    v_mfma_f32_16x16x32_bf16 v[216:219], a[156:159], a[72:75], v[216:219]
    ds_read_b128 a[136:139], v40 offset:4096
    v_perm_b32 v61, v74, v35, s37
    v_mfma_f32_16x16x32_bf16 v[216:219], a[172:175], a[128:131], v[216:219]
    ds_read_b128 a[144:147], v41 offset:4096
    ds_read_b32 a133, v61
    v_mfma_f32_16x16x32_bf16 v[220:223], a[156:159], a[140:143], v[220:223]
    buffer_load_dwordx4 v38, s[8:11], s3 offen offset:2048 lds
    v_mfma_f32_16x16x32_bf16 v[220:223], a[172:175], a[164:167], v[220:223]
    s_waitcnt lgkmcnt(8)
    ds_read_b128 a[148:151], v40 offset:6144
    v_perm_b32 v62, v74, v35, s38
    v_mfma_f32_16x16x32_bf16 v[128:131], a[80:83], a[108:111], v[128:131]
    s_waitcnt lgkmcnt(8)
    ds_read_b128 a[152:155], v41 offset:6144
    ds_read_b32 a134, v62
    v_mfma_f32_16x16x32_bf16 v[128:131], a[88:91], a[112:115], v[128:131]
    s_waitcnt lgkmcnt(8)
    ds_read_b128 a[160:163], v40 offset:8192
    v_perm_b32 v63, v74, v35, s39
    v_mfma_f32_16x16x32_bf16 v[132:135], a[80:83], a[120:123], v[132:135]
    s_waitcnt lgkmcnt(8)
    ds_read_b128 a[176:179], v41 offset:8192
    ds_read_b32 a135, v63
    v_mfma_f32_16x16x32_bf16 v[132:135], a[88:91], a[124:127], v[132:135]
    s_waitcnt lgkmcnt(8)
    ds_read_b128 a[168:171], v40 offset:10240
    v_mfma_f32_16x16x32_bf16 v[136:139], a[80:83], a[136:139], v[136:139]
    s_waitcnt lgkmcnt(8)
    ds_read_b128 a[180:183], v41 offset:10240
    v_mfma_f32_16x16x32_bf16 v[136:139], a[88:91], a[144:147], v[136:139]
    s_waitcnt lgkmcnt(7)
    buffer_load_dwordx4 v39, s[8:11], s3 offen offset:3072 lds
    v_mfma_f32_16x16x32_bf16 v[140:143], a[80:83], a[148:151], v[140:143]
    s_waitcnt vmcnt(14) lgkmcnt(6)
    s_add_u32 m0, s57, 65536
    ds_read_b128 a[184:187], v40 offset:12288
    v_bitop3_b32 v77, v77, v79, s76 bitop3:0x7e
    v_mfma_f32_16x16x32_bf16 v[140:143], a[88:91], a[152:155], v[140:143]
    s_waitcnt lgkmcnt(5)
    s_add_u32 s3, s55, 1152
    ds_read_b128 a[188:191], v41 offset:12288
    v_cmp_ne_u32 vcc, 0, v77
    v_mfma_f32_16x16x32_bf16 v[144:147], a[80:83], a[160:163], v[144:147]
    s_waitcnt lgkmcnt(5)
    ds_read_b128 a[192:195], v40 offset:14336
    v_mfma_f32_16x16x32_bf16 v[144:147], a[88:91], a[176:179], v[144:147]
    s_waitcnt lgkmcnt(4)
    buffer_load_dwordx2 v[104:105], v34, s[12:15], s44 offen sc1
    v_mfma_f32_16x16x32_bf16 v[148:151], a[80:83], a[168:171], v[148:151]
    s_waitcnt lgkmcnt(3)
    ds_read_b128 a[196:199], v41 offset:14336
    s_cbranch_vccnz L_slow2_2
L_back2_2:
    v_mfma_f32_16x16x32_bf16 v[148:151], a[88:91], a[180:183], v[148:151]
    s_waitcnt lgkmcnt(3)
    v_perm_b32 v56, v76, v35, s36
    v_perm_b32 v57, v76, v35, s37
    v_mfma_f32_16x16x32_bf16 v[152:155], a[80:83], a[184:187], v[152:155]
    s_waitcnt lgkmcnt(2)
    ds_read_b32 a236, v56
    ds_read_b32 a237, v57
    v_mfma_f32_16x16x32_bf16 v[152:155], a[88:91], a[188:191], v[152:155]
    s_waitcnt lgkmcnt(3)
    buffer_load_dwordx2 v[106:107], v34, s[12:15], s45 offen sc1
    v_mfma_f32_16x16x32_bf16 v[156:159], a[80:83], a[192:195], v[156:159]
    s_waitcnt vmcnt(12) lgkmcnt(2)
    v_perm_b32 v58, v76, v35, s38
    v_perm_b32 v59, v76, v35, s39
    v_mfma_f32_16x16x32_bf16 v[156:159], a[88:91], a[196:199], v[156:159]
    ds_read_b32 a238, v58
    ds_read_b32 a239, v59
    v_bitop3_b32 v83, v83, v87, s76 bitop3:0x7e
    v_mfma_f32_16x16x32_bf16 v[160:163], a[92:95], a[108:111], v[160:163]
    v_perm_b32 v60, v78, v35, s36
    v_perm_b32 v61, v78, v35, s37
    v_mfma_f32_16x16x32_bf16 v[160:163], a[96:99], a[112:115], v[160:163]
    ds_read_b32 a48, v60
    ds_read_b32 a49, v61
    v_cmp_ne_u32 vcc, 0, v83
    v_mfma_f32_16x16x32_bf16 v[164:167], a[92:95], a[120:123], v[164:167]
    ds_read_b128 a[200:203], v42 offset:0
    v_mfma_f32_16x16x32_bf16 v[164:167], a[96:99], a[124:127], v[164:167]
    buffer_load_dwordx4 v[108:111], v33, s[12:15], s48 offen sc1
    v_mfma_f32_16x16x32_bf16 v[168:171], a[92:95], a[136:139], v[168:171]
    v_perm_b32 v62, v78, v35, s38
    v_perm_b32 v63, v78, v35, s39
    v_mfma_f32_16x16x32_bf16 v[168:171], a[96:99], a[144:147], v[168:171]
    ds_read_b32 a50, v62
    ds_read_b32 a51, v63
    v_mfma_f32_16x16x32_bf16 v[172:175], a[92:95], a[148:151], v[172:175]
    ds_read_b128 a[204:207], v43 offset:0
    s_cbranch_vccnz L_slow2_1
L_back2_1:
    v_mfma_f32_16x16x32_bf16 v[172:175], a[96:99], a[152:155], v[172:175]
    buffer_load_dwordx4 v[112:115], v33, s[12:15], s69 offen sc1
    v_mfma_f32_16x16x32_bf16 v[176:179], a[92:95], a[160:163], v[176:179]
    v_perm_b32 v56, v80, v35, s36
    v_perm_b32 v57, v80, v35, s37
    v_mfma_f32_16x16x32_bf16 v[176:179], a[96:99], a[176:179], v[176:179]
    ds_read_b32 a208, v56
    ds_read_b32 a209, v57
    v_mfma_f32_16x16x32_bf16 v[180:183], a[92:95], a[168:171], v[180:183]
    ds_read_b128 a[212:215], v42 offset:2048
    v_perm_b32 v58, v80, v35, s38
    v_perm_b32 v59, v80, v35, s39
    v_mfma_f32_16x16x32_bf16 v[180:183], a[96:99], a[180:183], v[180:183]
    s_waitcnt vmcnt(12)
    ds_read_b32 a210, v58
    ds_read_b32 a211, v59
    v_mfma_f32_16x16x32_bf16 v[184:187], a[92:95], a[184:187], v[184:187]
    buffer_load_dwordx4 v36, s[8:11], s56 offen offset:0 lds
    v_mfma_f32_16x16x32_bf16 v[184:187], a[96:99], a[188:191], v[184:187]
    ds_read_b128 a[216:219], v43 offset:2048
    v_perm_b32 v60, v84, v35, s36
    v_perm_b32 v61, v84, v35, s37
    v_mfma_f32_16x16x32_bf16 v[188:191], a[92:95], a[192:195], v[188:191]
    ds_read_b32 a220, v60
    ds_read_b32 a221, v61
    v_bitop3_b32 v91, v91, v95, s76 bitop3:0x7e
    v_mfma_f32_16x16x32_bf16 v[188:191], a[96:99], a[196:199], v[188:191]
    ds_read_b128 a[224:227], v42 offset:4096
    v_perm_b32 v62, v84, v35, s38
    v_perm_b32 v63, v84, v35, s39
    v_mfma_f32_16x16x32_bf16 v[192:195], a[104:107], a[108:111], v[192:195]
    ds_read_b32 a222, v62
    ds_read_b32 a223, v63
    v_cmp_ne_u32 vcc, 0, v91
    v_mfma_f32_16x16x32_bf16 v[192:195], a[132:135], a[112:115], v[192:195]
    ds_read_b128 a[228:231], v43 offset:4096
    v_mfma_f32_16x16x32_bf16 v[196:199], a[104:107], a[120:123], v[196:199]
    buffer_load_dwordx4 v37, s[8:11], s56 offen offset:1024 lds
    v_mfma_f32_16x16x32_bf16 v[196:199], a[132:135], a[124:127], v[196:199]
    ds_read_b128 a[232:235], v42 offset:6144
    s_cbranch_vccnz L_slow3_0
L_back3_0:
    v_mfma_f32_16x16x32_bf16 v[200:203], a[104:107], a[136:139], v[200:203]
    ds_read_b128 a[240:243], v43 offset:6144
    v_perm_b32 v56, v81, v35, s36
    v_mfma_f32_16x16x32_bf16 v[200:203], a[132:135], a[144:147], v[200:203]
    ds_read_b128 a[244:247], v42 offset:8192
    ds_read_b32 a248, v56
    v_mfma_f32_16x16x32_bf16 v[204:207], a[104:107], a[148:151], v[204:207]
    ds_read_b128 a[252:255], v43 offset:8192
    v_perm_b32 v57, v81, v35, s37
    v_mfma_f32_16x16x32_bf16 v[204:207], a[132:135], a[152:155], v[204:207]
    ds_read_b128 a[32:35], v42 offset:10240
    ds_read_b32 a249, v57
    v_mfma_f32_16x16x32_bf16 v[208:211], a[104:107], a[160:163], v[208:211]
    ds_read_b128 a[60:63], v43 offset:10240
    v_perm_b32 v58, v81, v35, s38
    v_mfma_f32_16x16x32_bf16 v[208:211], a[132:135], a[176:179], v[208:211]
    ds_read_b32 a250, v58
    v_perm_b32 v59, v81, v35, s39
    v_mfma_f32_16x16x32_bf16 v[212:215], a[104:107], a[168:171], v[212:215]
    ds_read_b128 a[4:7], v42 offset:12288
    ds_read_b32 a251, v59
    v_mfma_f32_16x16x32_bf16 v[212:215], a[132:135], a[180:183], v[212:215]
    buffer_load_dwordx4 v38, s[8:11], s56 offen offset:2048 lds
    v_mfma_f32_16x16x32_bf16 v[216:219], a[104:107], a[184:187], v[216:219]
    v_perm_b32 v60, v85, v35, s36
    v_perm_b32 v61, v85, v35, s37
    v_mfma_f32_16x16x32_bf16 v[216:219], a[132:135], a[188:191], v[216:219]
    ds_read_b128 a[76:79], v43 offset:12288
    ds_read_b32 a16, v60
    v_mfma_f32_16x16x32_bf16 v[220:223], a[104:107], a[192:195], v[220:223]
    ds_read_b32 a17, v61
    v_perm_b32 v62, v85, v35, s38
    v_mfma_f32_16x16x32_bf16 v[220:223], a[132:135], a[196:199], v[220:223]
    s_waitcnt lgkmcnt(9)
    ds_read_b32 a18, v62
    v_perm_b32 v63, v85, v35, s39
    v_mfma_f32_16x16x32_bf16 v[224:227], a[236:239], a[108:111], v[224:227]
    ds_read_b128 a[24:27], v42 offset:14336
    ds_read_b32 a19, v63
    v_mfma_f32_16x16x32_bf16 v[224:227], a[48:51], a[112:115], v[224:227]
    buffer_load_dwordx4 v39, s[8:11], s56 offen offset:3072 lds
    v_mfma_f32_16x16x32_bf16 v[228:231], a[236:239], a[120:123], v[228:231]
    s_add_u32 m0, s57, 81920
    v_perm_b32 v56, v82, v35, s36
    v_perm_b32 v57, v82, v35, s37
    v_mfma_f32_16x16x32_bf16 v[228:231], a[48:51], a[124:127], v[228:231]
    ds_read_b128 a[40:43], v43 offset:14336
    ds_read_b32 a56, v56
    v_mfma_f32_16x16x32_bf16 v[232:235], a[236:239], a[136:139], v[232:235]
    ds_read_b32 a57, v57
    v_perm_b32 v58, v82, v35, s38
    v_mfma_f32_16x16x32_bf16 v[232:235], a[48:51], a[144:147], v[232:235]
    ds_read_b32 a58, v58
    v_perm_b32 v59, v82, v35, s39
    v_mfma_f32_16x16x32_bf16 v[236:239], a[236:239], a[148:151], v[236:239]
    ds_read_b32 a59, v59
    v_perm_b32 v60, v86, v35, s36
    v_perm_b32 v61, v86, v35, s37
    v_mfma_f32_16x16x32_bf16 v[236:239], a[48:51], a[152:155], v[236:239]
    ds_read_b32 a68, v60
    ds_read_b32 a69, v61
    v_mfma_f32_16x16x32_bf16 v[240:243], a[236:239], a[160:163], v[240:243]
    buffer_load_dwordx4 v36, s[8:11], s3 offen offset:0 lds
    v_mfma_f32_16x16x32_bf16 v[240:243], a[48:51], a[176:179], v[240:243]
    v_perm_b32 v62, v86, v35, s38
    v_perm_b32 v63, v86, v35, s39
    v_mfma_f32_16x16x32_bf16 v[244:247], a[236:239], a[168:171], v[244:247]
    s_add_u32 s56, s55, 1280
    ds_read_b32 a70, v62
    ds_read_b32 a71, v63
    v_mfma_f32_16x16x32_bf16 v[244:247], a[48:51], a[180:183], v[244:247]
    v_perm_b32 v56, v88, v35, s36
    v_perm_b32 v57, v88, v35, s37
    v_mfma_f32_16x16x32_bf16 v[248:251], a[236:239], a[184:187], v[248:251]
    ds_read_b32 a84, v56
    ds_read_b32 a85, v57
    v_mfma_f32_16x16x32_bf16 v[248:251], a[48:51], a[188:191], v[248:251]
    v_perm_b32 v58, v88, v35, s38
    v_perm_b32 v59, v88, v35, s39
    v_mfma_f32_16x16x32_bf16 v[252:255], a[236:239], a[192:195], v[252:255]
    ds_read_b32 a86, v58
    ds_read_b32 a87, v59
    v_mfma_f32_16x16x32_bf16 v[252:255], a[48:51], a[196:199], v[252:255]
    buffer_load_dwordx4 v37, s[8:11], s3 offen offset:1024 lds
    v_mfma_f32_16x16x32_bf16 v[128:131], a[208:211], a[200:203], v[128:131]
    v_perm_b32 v60, v92, v35, s36
    v_perm_b32 v61, v92, v35, s37
    v_mfma_f32_16x16x32_bf16 v[128:131], a[220:223], a[204:207], v[128:131]
    ds_read_b32 a100, v60
    ds_read_b32 a101, v61
    v_mfma_f32_16x16x32_bf16 v[132:135], a[208:211], a[212:215], v[132:135]
    v_perm_b32 v62, v92, v35, s38
    v_perm_b32 v63, v92, v35, s39
    v_mfma_f32_16x16x32_bf16 v[132:135], a[220:223], a[216:219], v[132:135]
    ds_read_b32 a102, v62
    ds_read_b32 a103, v63
    v_mfma_f32_16x16x32_bf16 v[136:139], a[208:211], a[224:227], v[136:139]
    v_perm_b32 v56, v89, v35, s36
    v_perm_b32 v57, v89, v35, s37
    v_mfma_f32_16x16x32_bf16 v[136:139], a[220:223], a[228:231], v[136:139]
    ds_read_b32 a0, v56
    ds_read_b32 a1, v57
    v_mfma_f32_16x16x32_bf16 v[140:143], a[208:211], a[232:235], v[140:143]
    s_mov_b32 s49, 81920
    v_perm_b32 v58, v89, v35, s38
    v_perm_b32 v59, v89, v35, s39
    v_mfma_f32_16x16x32_bf16 v[140:143], a[220:223], a[240:243], v[140:143]
    s_mov_b32 s40, 87040
    ds_read_b32 a2, v58
    v_perm_b32 v60, v93, v35, s36
    v_mfma_f32_16x16x32_bf16 v[144:147], a[208:211], a[244:247], v[144:147]
    s_mov_b32 s50, 81920
    ds_read_b32 a3, v59
    ds_read_b32 a8, v60
    v_mfma_f32_16x16x32_bf16 v[144:147], a[220:223], a[252:255], v[144:147]
    s_waitcnt lgkmcnt(9)
    buffer_load_dwordx4 v[116:119], v32, s[12:15], s49 offen sc1
    v_mfma_f32_16x16x32_bf16 v[148:151], a[208:211], a[32:35], v[148:151]
    s_mov_b32 s41, 87040
    v_perm_b32 v61, v93, v35, s37
    v_perm_b32 v62, v93, v35, s38
    v_mfma_f32_16x16x32_bf16 v[148:151], a[220:223], a[60:63], v[148:151]
    s_mov_b32 s42, 81920
    ds_read_b32 a9, v61
    v_perm_b32 v63, v93, v35, s39
    v_mfma_f32_16x16x32_bf16 v[152:155], a[208:211], a[4:7], v[152:155]
    s_mov_b32 s43, 87040
    ds_read_b32 a10, v62
    ds_read_b32 a11, v63
    v_mfma_f32_16x16x32_bf16 v[152:155], a[220:223], a[76:79], v[152:155]
    buffer_load_dwordx4 v[120:123], v32, s[12:15], s40 offen sc1
    v_mfma_f32_16x16x32_bf16 v[156:159], a[208:211], a[24:27], v[156:159]
    v_perm_b32 v56, v90, v35, s36
    v_perm_b32 v57, v90, v35, s37
    v_mfma_f32_16x16x32_bf16 v[156:159], a[220:223], a[40:43], v[156:159]
    ds_read_b32 a12, v56
    ds_read_b32 a13, v57
    v_perm_b32 v58, v90, v35, s38
    v_mfma_f32_16x16x32_bf16 v[160:163], a[248:251], a[200:203], v[160:163]
    ds_read_b32 a14, v58
    v_mfma_f32_16x16x32_bf16 v[160:163], a[16:19], a[204:207], v[160:163]
    buffer_load_dwordx2 v[124:125], v34, s[12:15], s50 offen sc1
    v_mfma_f32_16x16x32_bf16 v[164:167], a[248:251], a[212:215], v[164:167]
    s_waitcnt vmcnt(13)
    v_perm_b32 v59, v90, v35, s39
    v_perm_b32 v60, v94, v35, s36
    v_mfma_f32_16x16x32_bf16 v[164:167], a[16:19], a[216:219], v[164:167]
    ds_read_b32 a15, v59
    ds_read_b32 a20, v60
    v_perm_b32 v61, v94, v35, s37
    v_mfma_f32_16x16x32_bf16 v[168:171], a[248:251], a[224:227], v[168:171]
    s_barrier
    v_mfma_f32_16x16x32_bf16 v[168:171], a[16:19], a[228:231], v[168:171]
    buffer_load_dwordx2 v[126:127], v34, s[12:15], s41 offen sc1
    v_mfma_f32_16x16x32_bf16 v[172:175], a[248:251], a[232:235], v[172:175]
    ds_read_b128 a[28:31], v40 offset:32768
    ds_read_b32 a21, v61
    v_mfma_f32_16x16x32_bf16 v[172:175], a[16:19], a[240:243], v[172:175]
    ds_read_b128 a[36:39], v41 offset:32768
    v_perm_b32 v62, v94, v35, s38
    v_mfma_f32_16x16x32_bf16 v[176:179], a[248:251], a[244:247], v[176:179]
    ds_read_b128 a[44:47], v40 offset:34816
    ds_read_b32 a22, v62
    v_mfma_f32_16x16x32_bf16 v[176:179], a[16:19], a[252:255], v[176:179]
    buffer_load_dwordx4 v[48:51], v33, s[12:15], s42 offen sc1
    v_mfma_f32_16x16x32_bf16 v[180:183], a[248:251], a[32:35], v[180:183]
    s_waitcnt vmcnt(13)
    ds_read_b128 a[52:55], v41 offset:34816
    v_bitop3_b32 v105, v105, v107, s76 bitop3:0x7e
    v_mfma_f32_16x16x32_bf16 v[180:183], a[16:19], a[60:63], v[180:183]
    ds_read_b128 a[64:67], v40 offset:36864
    v_cmp_ne_u32 vcc, 0, v105
    v_mfma_f32_16x16x32_bf16 v[184:187], a[248:251], a[4:7], v[184:187]
    s_mov_b32 s44, 102400
    ds_read_b128 a[116:119], v41 offset:36864
    v_mfma_f32_16x16x32_bf16 v[184:187], a[16:19], a[76:79], v[184:187]
    buffer_load_dwordx4 v[52:55], v33, s[12:15], s43 offen sc1
    v_mfma_f32_16x16x32_bf16 v[188:191], a[248:251], a[24:27], v[188:191]
    ds_read_b128 a[72:75], v40 offset:38912
    s_cbranch_vccnz L_slow3_2
L_back3_2:
    v_mfma_f32_16x16x32_bf16 v[188:191], a[16:19], a[40:43], v[188:191]
    s_mov_b32 s45, 107520
    ds_read_b128 a[128:131], v41 offset:38912
    v_perm_b32 v63, v94, v35, s39
    v_mfma_f32_16x16x32_bf16 v[192:195], a[56:59], a[200:203], v[192:195]
    ds_read_b128 a[140:143], v40 offset:40960
    ds_read_b32 a23, v63
    v_mfma_f32_16x16x32_bf16 v[192:195], a[68:71], a[204:207], v[192:195]
    buffer_load_dwordx4 v38, s[8:11], s3 offen offset:2048 lds
    v_mfma_f32_16x16x32_bf16 v[196:199], a[56:59], a[212:215], v[196:199]
    s_waitcnt vmcnt(13)
    ds_read_b128 a[156:159], v41 offset:40960
    v_bitop3_b32 v111, v111, v115, s76 bitop3:0x7e
    v_mfma_f32_16x16x32_bf16 v[196:199], a[68:71], a[216:219], v[196:199]
    v_cmp_ne_u32 vcc, 0, v111
    v_perm_b32 v56, v104, v35, s36
    v_mfma_f32_16x16x32_bf16 v[200:203], a[56:59], a[224:227], v[200:203]
    ds_read_b128 a[164:167], v40 offset:43008
    ds_read_b32 a172, v56
    v_mfma_f32_16x16x32_bf16 v[200:203], a[68:71], a[228:231], v[200:203]
    ds_read_b128 a[80:83], v41 offset:43008
    s_cbranch_vccnz L_slow3_1
L_back3_1:
    v_mfma_f32_16x16x32_bf16 v[204:207], a[56:59], a[232:235], v[204:207]
    buffer_load_dwordx4 v39, s[8:11], s3 offen offset:3072 lds
    v_mfma_f32_16x16x32_bf16 v[204:207], a[68:71], a[240:243], v[204:207]
    s_add_u32 m0, s57, 0
    v_perm_b32 v57, v104, v35, s37
    v_perm_b32 v58, v104, v35, s38
    v_mfma_f32_16x16x32_bf16 v[208:211], a[56:59], a[244:247], v[208:211]
    s_add_u32 s3, s55, 1408
    ds_read_b32 a173, v57
    ds_read_b32 a174, v58
    v_mfma_f32_16x16x32_bf16 v[208:211], a[68:71], a[252:255], v[208:211]
    v_perm_b32 v59, v104, v35, s39
    v_perm_b32 v60, v106, v35, s36
    v_mfma_f32_16x16x32_bf16 v[212:215], a[56:59], a[32:35], v[212:215]
    ds_read_b128 a[88:91], v40 offset:45056
    ds_read_b32 a175, v59
    v_mfma_f32_16x16x32_bf16 v[212:215], a[68:71], a[60:63], v[212:215]
    buffer_load_dwordx4 v[64:67], v32, s[12:15], s44 offen sc1
    v_mfma_f32_16x16x32_bf16 v[216:219], a[56:59], a[4:7], v[216:219]
    ds_read_b32 a92, v60
    v_perm_b32 v61, v106, v35, s37
    v_mfma_f32_16x16x32_bf16 v[216:219], a[68:71], a[76:79], v[216:219]
    ds_read_b128 a[96:99], v41 offset:45056
    ds_read_b32 a93, v61
    v_mfma_f32_16x16x32_bf16 v[220:223], a[56:59], a[24:27], v[220:223]
    v_perm_b32 v62, v106, v35, s38
    v_perm_b32 v63, v106, v35, s39
    v_mfma_f32_16x16x32_bf16 v[220:223], a[68:71], a[40:43], v[220:223]
    s_waitcnt lgkmcnt(7)
    ds_read_b32 a94, v62
    ds_read_b32 a95, v63
    v_mfma_f32_16x16x32_bf16 v[128:131], a[84:87], a[28:31], v[128:131]
    buffer_load_dwordx4 v[96:99], v32, s[12:15], s45 offen sc1
L_pad2:
    s_cbranch_execz L_pad3
    v_mfma_f32_16x16x32_bf16 v[128:131], a[100:103], a[36:39], v[128:131]
    ds_read_b128 a[104:107], v40 offset:47104
    v_perm_b32 v56, v108, v35, s36
    v_mfma_f32_16x16x32_bf16 v[132:135], a[84:87], a[44:47], v[132:135]
    ds_read_b32 a132, v56
    v_perm_b32 v57, v108, v35, s37
    v_mfma_f32_16x16x32_bf16 v[132:135], a[100:103], a[52:55], v[132:135]
    ds_read_b128 a[108:111], v41 offset:47104
    ds_read_b32 a133, v57
    v_mfma_f32_16x16x32_bf16 v[136:139], a[84:87], a[64:67], v[136:139]
    v_perm_b32 v58, v108, v35, s38
    v_perm_b32 v59, v108, v35, s39
    v_mfma_f32_16x16x32_bf16 v[136:139], a[100:103], a[116:119], v[136:139]
    ds_read_b32 a134, v58
    ds_read_b32 a135, v59
    v_mfma_f32_16x16x32_bf16 v[140:143], a[84:87], a[72:75], v[140:143]
    ds_read_b128 a[112:115], v42 offset:32768
    v_mfma_f32_16x16x32_bf16 v[140:143], a[100:103], a[128:131], v[140:143]
    buffer_load_dwordx4 v36, s[8:11], s56 offen offset:0 lds
    v_mfma_f32_16x16x32_bf16 v[144:147], a[84:87], a[140:143], v[144:147]
    v_perm_b32 v60, v112, v35, s36
    v_perm_b32 v61, v112, v35, s37
    v_mfma_f32_16x16x32_bf16 v[144:147], a[100:103], a[156:159], v[144:147]
    ds_read_b32 a120, v60
    ds_read_b32 a121, v61
    v_mfma_f32_16x16x32_bf16 v[148:151], a[84:87], a[164:167], v[148:151]
    v_perm_b32 v62, v112, v35, s38
    v_perm_b32 v63, v112, v35, s39
    v_mfma_f32_16x16x32_bf16 v[148:151], a[100:103], a[80:83], v[148:151]
    s_waitcnt lgkmcnt(7)
    ds_read_b32 a122, v62
    ds_read_b32 a123, v63
    v_mfma_f32_16x16x32_bf16 v[152:155], a[84:87], a[88:91], v[152:155]
    v_perm_b32 v56, v109, v35, s36
    v_perm_b32 v57, v109, v35, s37
    v_mfma_f32_16x16x32_bf16 v[152:155], a[100:103], a[96:99], v[152:155]
    s_waitcnt lgkmcnt(7)
    ds_read_b32 a124, v56
    ds_read_b32 a125, v57
    v_mfma_f32_16x16x32_bf16 v[156:159], a[84:87], a[104:107], v[156:159]
    buffer_load_dwordx4 v37, s[8:11], s56 offen offset:1024 lds
    v_mfma_f32_16x16x32_bf16 v[156:159], a[100:103], a[108:111], v[156:159]
    ds_read_b128 a[136:139], v43 offset:32768
    v_perm_b32 v58, v109, v35, s38
    v_mfma_f32_16x16x32_bf16 v[160:163], a[0:3], a[28:31], v[160:163]
    ds_read_b32 a126, v58
    v_perm_b32 v59, v109, v35, s39
    v_mfma_f32_16x16x32_bf16 v[160:163], a[8:11], a[36:39], v[160:163]
    ds_read_b32 a127, v59
    v_perm_b32 v60, v113, v35, s36
    v_mfma_f32_16x16x32_bf16 v[164:167], a[0:3], a[44:47], v[164:167]
    s_mov_b32 s48, 102400
    ds_read_b32 a148, v60
    ds_read_b128 a[144:147], v42 offset:34816
    v_mfma_f32_16x16x32_bf16 v[164:167], a[8:11], a[52:55], v[164:167]
    v_perm_b32 v61, v113, v35, s37
    v_perm_b32 v62, v113, v35, s38
    v_mfma_f32_16x16x32_bf16 v[168:171], a[0:3], a[64:67], v[168:171]
    ds_read_b32 a149, v61
    ds_read_b32 a150, v62
    v_mfma_f32_16x16x32_bf16 v[168:171], a[8:11], a[116:119], v[168:171]
    buffer_load_dwordx2 v[100:101], v34, s[12:15], s48 offen sc1
    v_mfma_f32_16x16x32_bf16 v[172:175], a[0:3], a[72:75], v[172:175]
    s_mov_b32 s69, 107520
    ds_read_b128 a[152:155], v43 offset:34816
    v_perm_b32 v63, v113, v35, s39
    v_mfma_f32_16x16x32_bf16 v[172:175], a[8:11], a[128:131], v[172:175]
    ds_read_b32 a151, v63
    v_perm_b32 v56, v110, v35, s36
    v_mfma_f32_16x16x32_bf16 v[176:179], a[0:3], a[140:143], v[176:179]
    ds_read_b32 a176, v56
    ds_read_b128 a[160:163], v42 offset:36864
    v_mfma_f32_16x16x32_bf16 v[176:179], a[8:11], a[156:159], v[176:179]
    buffer_load_dwordx2 v[102:103], v34, s[12:15], s69 offen sc1
    v_mfma_f32_16x16x32_bf16 v[180:183], a[0:3], a[164:167], v[180:183]
    ds_read_b128 a[168:171], v43 offset:36864
    v_perm_b32 v57, v110, v35, s37
    v_mfma_f32_16x16x32_bf16 v[180:183], a[8:11], a[80:83], v[180:183]
    ds_read_b32 a177, v57
    v_perm_b32 v58, v110, v35, s38
    v_mfma_f32_16x16x32_bf16 v[184:187], a[0:3], a[88:91], v[184:187]
    ds_read_b32 a178, v58
    ds_read_b128 a[180:183], v42 offset:38912
    v_mfma_f32_16x16x32_bf16 v[184:187], a[8:11], a[96:99], v[184:187]
    buffer_load_dwordx4 v38, s[8:11], s56 offen offset:2048 lds
    v_mfma_f32_16x16x32_bf16 v[188:191], a[0:3], a[104:107], v[188:191]
    v_perm_b32 v59, v110, v35, s39
    v_perm_b32 v60, v114, v35, s36
    v_mfma_f32_16x16x32_bf16 v[188:191], a[8:11], a[108:111], v[188:191]
    s_mov_b32 s49, 102400
    ds_read_b32 a179, v59
    ds_read_b32 a184, v60
    v_mfma_f32_16x16x32_bf16 v[192:195], a[12:15], a[28:31], v[192:195]
    ds_read_b128 a[188:191], v43 offset:38912
    v_perm_b32 v61, v114, v35, s37
    v_mfma_f32_16x16x32_bf16 v[192:195], a[20:23], a[36:39], v[192:195]
    ds_read_b32 a185, v61
    ds_read_b128 a[192:195], v42 offset:40960
    v_mfma_f32_16x16x32_bf16 v[196:199], a[12:15], a[44:47], v[196:199]
    buffer_load_dwordx4 v[68:71], v33, s[12:15], s49 offen sc1
    v_mfma_f32_16x16x32_bf16 v[196:199], a[20:23], a[52:55], v[196:199]
    s_mov_b32 s40, 107520
    v_perm_b32 v62, v114, v35, s38
    v_perm_b32 v63, v114, v35, s39
    v_mfma_f32_16x16x32_bf16 v[200:203], a[12:15], a[64:67], v[200:203]
    ds_read_b128 a[236:239], v43 offset:40960
    ds_read_b32 a186, v62
    v_mfma_f32_16x16x32_bf16 v[200:203], a[20:23], a[116:119], v[200:203]
    ds_read_b128 a[196:199], v42 offset:43008
    ds_read_b32 a187, v63
    v_mfma_f32_16x16x32_bf16 v[204:207], a[12:15], a[72:75], v[204:207]
    buffer_load_dwordx4 v[72:75], v33, s[12:15], s40 offen sc1
    v_mfma_f32_16x16x32_bf16 v[204:207], a[20:23], a[128:131], v[204:207]
    ds_read_b128 a[48:51], v43 offset:43008
    v_mfma_f32_16x16x32_bf16 v[208:211], a[12:15], a[140:143], v[208:211]
    s_waitcnt vmcnt(15)
    ds_read_b128 a[208:211], v42 offset:45056
    v_bitop3_b32 v119, v119, v123, s76 bitop3:0x7e
    v_mfma_f32_16x16x32_bf16 v[208:211], a[20:23], a[156:159], v[208:211]
    ds_read_b128 a[220:223], v43 offset:45056
    v_cmp_ne_u32 vcc, 0, v119
    v_mfma_f32_16x16x32_bf16 v[212:215], a[12:15], a[164:167], v[212:215]
    v_mfma_f32_16x16x32_bf16 v[212:215], a[20:23], a[80:83], v[212:215]
    s_waitcnt vmcnt(13)
    ds_read_b128 a[248:251], v42 offset:47104
    s_cbranch_vccnz L_slow4_0
L_back4_0:
    v_mfma_f32_16x16x32_bf16 v[216:219], a[12:15], a[88:91], v[216:219]
    buffer_load_dwordx4 v39, s[8:11], s56 offen offset:3072 lds
    v_mfma_f32_16x16x32_bf16 v[216:219], a[20:23], a[96:99], v[216:219]
    s_add_u32 m0, s57, 16384
    v_perm_b32 v56, v116, v35, s36
    v_bitop3_b32 v125, v125, v127, s76 bitop3:0x7e
    v_mfma_f32_16x16x32_bf16 v[220:223], a[12:15], a[104:107], v[220:223]
    ds_read_b32 a16, v56
    v_cmp_ne_u32 vcc, 0, v125
    v_perm_b32 v57, v116, v35, s37
    v_mfma_f32_16x16x32_bf16 v[220:223], a[20:23], a[108:111], v[220:223]
    ds_read_b32 a17, v57
    v_perm_b32 v58, v116, v35, s38
    v_mfma_f32_16x16x32_bf16 v[224:227], a[172:175], a[28:31], v[224:227]
    ds_read_b32 a18, v58
    s_cbranch_vccnz L_slow4_2
L_back4_2:
    v_mfma_f32_16x16x32_bf16 v[224:227], a[92:95], a[36:39], v[224:227]
    v_perm_b32 v59, v116, v35, s39
    v_perm_b32 v60, v120, v35, s36
    v_mfma_f32_16x16x32_bf16 v[228:231], a[172:175], a[44:47], v[228:231]
    ds_read_b32 a19, v59
    ds_read_b32 a200, v60
    v_mfma_f32_16x16x32_bf16 v[228:231], a[92:95], a[52:55], v[228:231]
    buffer_load_dwordx4 v36, s[8:11], s3 offen offset:0 lds
    v_mfma_f32_16x16x32_bf16 v[232:235], a[172:175], a[64:67], v[232:235]
    ds_read_b128 a[204:207], v43 offset:47104
    v_perm_b32 v61, v120, v35, s37
    v_mfma_f32_16x16x32_bf16 v[232:235], a[92:95], a[116:119], v[232:235]
    ds_read_b32 a201, v61
    v_perm_b32 v62, v120, v35, s38
    v_mfma_f32_16x16x32_bf16 v[236:239], a[172:175], a[72:75], v[236:239]
    ds_read_b32 a202, v62
    v_perm_b32 v63, v120, v35, s39
    v_mfma_f32_16x16x32_bf16 v[236:239], a[92:95], a[128:131], v[236:239]
    s_waitcnt vmcnt(13)
    ds_read_b32 a203, v63
    v_perm_b32 v56, v117, v35, s36
    v_mfma_f32_16x16x32_bf16 v[240:243], a[172:175], a[140:143], v[240:243]
    ds_read_b32 a212, v56
    v_bitop3_b32 v51, v51, v55, s76 bitop3:0x7e
    v_perm_b32 v57, v117, v35, s37
    v_mfma_f32_16x16x32_bf16 v[240:243], a[92:95], a[156:159], v[240:243]
    ds_read_b32 a213, v57
    v_mfma_f32_16x16x32_bf16 v[244:247], a[172:175], a[164:167], v[244:247]
    buffer_load_dwordx4 v37, s[8:11], s3 offen offset:1024 lds
    v_mfma_f32_16x16x32_bf16 v[244:247], a[92:95], a[80:83], v[244:247]
    s_add_u32 s56, s55, 1536
    v_cmp_ne_u32 vcc, 0, v51
    v_perm_b32 v58, v117, v35, s38
    v_mfma_f32_16x16x32_bf16 v[248:251], a[172:175], a[88:91], v[248:251]
    ds_read_b32 a214, v58
    v_perm_b32 v59, v117, v35, s39
    v_mfma_f32_16x16x32_bf16 v[248:251], a[92:95], a[96:99], v[248:251]
    ds_read_b32 a215, v59
    s_cbranch_vccnz L_slow4_1
L_back4_1:
    v_mfma_f32_16x16x32_bf16 v[252:255], a[172:175], a[104:107], v[252:255]
    v_perm_b32 v60, v121, v35, s36
    v_perm_b32 v61, v121, v35, s37
    v_mfma_f32_16x16x32_bf16 v[252:255], a[92:95], a[108:111], v[252:255]
    s_waitcnt lgkmcnt(5)
    ds_read_b32 a216, v60
    ds_read_b32 a217, v61
    v_mfma_f32_16x16x32_bf16 v[128:131], a[132:135], a[112:115], v[128:131]
    v_perm_b32 v62, v121, v35, s38
    v_perm_b32 v63, v121, v35, s39
    v_mfma_f32_16x16x32_bf16 v[128:131], a[120:123], a[136:139], v[128:131]
    ds_read_b32 a218, v62
    ds_read_b32 a219, v63
    v_mfma_f32_16x16x32_bf16 v[132:135], a[132:135], a[144:147], v[132:135]
    buffer_load_dwordx4 v38, s[8:11], s3 offen offset:2048 lds
    v_mfma_f32_16x16x32_bf16 v[132:135], a[120:123], a[152:155], v[132:135]
    v_perm_b32 v56, v118, v35, s36
    v_perm_b32 v57, v118, v35, s37
    v_mfma_f32_16x16x32_bf16 v[136:139], a[132:135], a[160:163], v[136:139]
    s_waitcnt vmcnt(13)
    ds_read_b32 a224, v56
    ds_read_b32 a225, v57
    v_mfma_f32_16x16x32_bf16 v[136:139], a[120:123], a[168:171], v[136:139]
    s_barrier
    v_mfma_f32_16x16x32_bf16 v[140:143], a[132:135], a[180:183], v[140:143]
    s_mov_b32 s50, 122880
    v_perm_b32 v58, v118, v35, s38
    v_perm_b32 v59, v118, v35, s39
    v_mfma_f32_16x16x32_bf16 v[140:143], a[120:123], a[188:191], v[140:143]
    ds_read_b32 a226, v58
    ds_read_b32 a227, v59
    v_mfma_f32_16x16x32_bf16 v[144:147], a[132:135], a[192:195], v[144:147]
    ds_read_b128 a[228:231], v44 offset:0
    v_mfma_f32_16x16x32_bf16 v[144:147], a[120:123], a[236:239], v[144:147]
    buffer_load_dwordx4 v39, s[8:11], s3 offen offset:3072 lds
    v_mfma_f32_16x16x32_bf16 v[148:151], a[132:135], a[196:199], v[148:151]
    s_add_u32 m0, s57, 32768
    v_perm_b32 v60, v122, v35, s36
    v_perm_b32 v61, v122, v35, s37
    v_mfma_f32_16x16x32_bf16 v[148:151], a[120:123], a[48:51], v[148:151]
    s_add_u32 s3, s55, 1664
    ds_read_b32 a232, v60
    ds_read_b32 a233, v61
    v_mfma_f32_16x16x32_bf16 v[152:155], a[132:135], a[208:211], v[152:155]
    s_mov_b32 s41, 128000
    ds_read_b128 a[240:243], v45 offset:0
    v_mfma_f32_16x16x32_bf16 v[152:155], a[120:123], a[220:223], v[152:155]
    buffer_load_dwordx2 v[76:77], v34, s[12:15], s50 offen sc1
    v_mfma_f32_16x16x32_bf16 v[156:159], a[132:135], a[248:251], v[156:159]
    ds_read_b128 a[244:247], v44 offset:2048
    v_perm_b32 v62, v122, v35, s38
    v_mfma_f32_16x16x32_bf16 v[156:159], a[120:123], a[204:207], v[156:159]
    ds_read_b128 a[252:255], v45 offset:2048
    ds_read_b32 a234, v62
    v_mfma_f32_16x16x32_bf16 v[160:163], a[124:127], a[112:115], v[160:163]
    ds_read_b128 a[32:35], v44 offset:4096
    v_mfma_f32_16x16x32_bf16 v[160:163], a[148:151], a[136:139], v[160:163]
    buffer_load_dwordx2 v[78:79], v34, s[12:15], s41 offen sc1
    v_mfma_f32_16x16x32_bf16 v[164:167], a[124:127], a[144:147], v[164:167]
    s_mov_b32 s42, 122880
    v_perm_b32 v63, v122, v35, s39
    v_perm_b32 v56, v124, v35, s36
    v_mfma_f32_16x16x32_bf16 v[164:167], a[148:151], a[152:155], v[164:167]
    ds_read_b32 a235, v63
    ds_read_b32 a60, v56
    v_perm_b32 v57, v124, v35, s37
    v_mfma_f32_16x16x32_bf16 v[168:171], a[124:127], a[160:163], v[168:171]
    ds_read_b32 a61, v57
    ds_read_b128 a[4:7], v45 offset:4096
    v_mfma_f32_16x16x32_bf16 v[168:171], a[148:151], a[168:171], v[168:171]
    buffer_load_dwordx4 v[80:83], v32, s[12:15], s42 offen sc1
    v_mfma_f32_16x16x32_bf16 v[172:175], a[124:127], a[180:183], v[172:175]
    s_mov_b32 s43, 128000
    v_perm_b32 v58, v124, v35, s38
    v_perm_b32 v59, v124, v35, s39
    v_mfma_f32_16x16x32_bf16 v[172:175], a[148:151], a[188:191], v[172:175]
    ds_read_b32 a62, v58
    ds_read_b32 a63, v59
    v_mfma_f32_16x16x32_bf16 v[176:179], a[124:127], a[192:195], v[176:179]
    ds_read_b128 a[76:79], v44 offset:6144
    v_mfma_f32_16x16x32_bf16 v[176:179], a[148:151], a[236:239], v[176:179]
    buffer_load_dwordx4 v[84:87], v32, s[12:15], s43 offen sc1
    v_mfma_f32_16x16x32_bf16 v[180:183], a[124:127], a[196:199], v[180:183]
    v_perm_b32 v60, v126, v35, s36
    v_perm_b32 v61, v126, v35, s37
    v_mfma_f32_16x16x32_bf16 v[180:183], a[148:151], a[48:51], v[180:183]
    ds_read_b128 a[24:27], v45 offset:6144
    ds_read_b32 a56, v60
    v_perm_b32 v62, v126, v35, s38
    v_mfma_f32_16x16x32_bf16 v[184:187], a[124:127], a[208:211], v[184:187]
    ds_read_b32 a57, v61
    ds_read_b32 a58, v62
    v_mfma_f32_16x16x32_bf16 v[184:187], a[148:151], a[220:223], v[184:187]
    v_perm_b32 v63, v126, v35, s39
    v_perm_b32 v56, v48, v35, s36
    v_mfma_f32_16x16x32_bf16 v[188:191], a[124:127], a[248:251], v[188:191]
    s_waitcnt vmcnt(16)
    ds_read_b128 a[40:43], v44 offset:8192
    ds_read_b32 a59, v63
    v_mfma_f32_16x16x32_bf16 v[188:191], a[148:151], a[204:207], v[188:191]
    s_mov_b32 s44, 122880
    ds_read_b32 a68, v56
    v_bitop3_b32 v67, v67, v99, s76 bitop3:0x7e
    v_mfma_f32_16x16x32_bf16 v[192:195], a[176:179], a[112:115], v[192:195]
    v_cmp_ne_u32 vcc, 0, v67
    v_perm_b32 v57, v48, v35, s37
    v_mfma_f32_16x16x32_bf16 v[192:195], a[184:187], a[136:139], v[192:195]
    ds_read_b128 a[84:87], v45 offset:8192
    ds_read_b32 a69, v57
    v_mfma_f32_16x16x32_bf16 v[196:199], a[176:179], a[144:147], v[196:199]
    buffer_load_dwordx4 v[88:91], v33, s[12:15], s44 offen sc1
    v_mfma_f32_16x16x32_bf16 v[196:199], a[184:187], a[152:155], v[196:199]
    v_perm_b32 v58, v48, v35, s38
    s_cbranch_vccnz L_slow5_0
L_back5_0:
    v_mfma_f32_16x16x32_bf16 v[200:203], a[176:179], a[160:163], v[200:203]
    s_mov_b32 s45, 128000
    ds_read_b128 a[100:103], v44 offset:10240
    ds_read_b32 a70, v58
    v_mfma_f32_16x16x32_bf16 v[200:203], a[184:187], a[168:171], v[200:203]
    ds_read_b128 a[0:3], v45 offset:10240
    v_mfma_f32_16x16x32_bf16 v[204:207], a[176:179], a[180:183], v[204:207]
    buffer_load_dwordx4 v[92:95], v33, s[12:15], s45 offen sc1
    v_mfma_f32_16x16x32_bf16 v[204:207], a[184:187], a[188:191], v[204:207]
    v_perm_b32 v59, v48, v35, s39
    v_perm_b32 v60, v52, v35, s36
    v_mfma_f32_16x16x32_bf16 v[208:211], a[176:179], a[192:195], v[208:211]
    ds_read_b32 a71, v59
    ds_read_b32 a8, v60
    v_perm_b32 v61, v52, v35, s37
    v_mfma_f32_16x16x32_bf16 v[208:211], a[184:187], a[236:239], v[208:211]
    ds_read_b32 a9, v61
    ds_read_b128 a[12:15], v44 offset:12288
    v_mfma_f32_16x16x32_bf16 v[212:215], a[176:179], a[196:199], v[212:215]
    buffer_load_dwordx4 v36, s[8:11], s56 offen offset:0 lds
    v_mfma_f32_16x16x32_bf16 v[212:215], a[184:187], a[48:51], v[212:215]
    v_perm_b32 v62, v52, v35, s38
    v_perm_b32 v63, v52, v35, s39
    v_mfma_f32_16x16x32_bf16 v[216:219], a[176:179], a[208:211], v[216:219]
    ds_read_b32 a10, v62
    ds_read_b32 a11, v63
    v_perm_b32 v56, v49, v35, s36
    v_mfma_f32_16x16x32_bf16 v[216:219], a[184:187], a[220:223], v[216:219]
    ds_read_b128 a[20:23], v45 offset:12288
    ds_read_b32 a28, v56
    v_perm_b32 v57, v49, v35, s37
    v_mfma_f32_16x16x32_bf16 v[220:223], a[176:179], a[248:251], v[220:223]
    ds_read_b32 a29, v57
    v_perm_b32 v58, v49, v35, s38
    v_mfma_f32_16x16x32_bf16 v[220:223], a[184:187], a[204:207], v[220:223]
    s_waitcnt lgkmcnt(9)
    ds_read_b32 a30, v58
    ds_read_b128 a[36:39], v44 offset:14336
    v_mfma_f32_16x16x32_bf16 v[128:131], a[16:19], a[228:231], v[128:131]
    buffer_load_dwordx4 v37, s[8:11], s56 offen offset:1024 lds
    v_mfma_f32_16x16x32_bf16 v[128:131], a[200:203], a[240:243], v[128:131]
    v_perm_b32 v59, v49, v35, s39
    v_perm_b32 v60, v53, v35, s36
    v_mfma_f32_16x16x32_bf16 v[132:135], a[16:19], a[244:247], v[132:135]
    ds_read_b32 a31, v59
    ds_read_b32 a44, v60
    v_mfma_f32_16x16x32_bf16 v[132:135], a[200:203], a[252:255], v[132:135]
    ds_read_b128 a[52:55], v45 offset:14336
    v_perm_b32 v61, v53, v35, s37
    v_mfma_f32_16x16x32_bf16 v[136:139], a[16:19], a[32:35], v[136:139]
    ds_read_b32 a45, v61
    v_perm_b32 v62, v53, v35, s38
    v_mfma_f32_16x16x32_bf16 v[136:139], a[200:203], a[4:7], v[136:139]
    ds_read_b32 a46, v62
    v_perm_b32 v63, v53, v35, s39
    v_mfma_f32_16x16x32_bf16 v[140:143], a[16:19], a[76:79], v[140:143]
    ds_read_b32 a47, v63
    ds_read_b128 a[64:67], v46 offset:0
    v_mfma_f32_16x16x32_bf16 v[140:143], a[200:203], a[24:27], v[140:143]
    buffer_load_dwordx4 v38, s[8:11], s56 offen offset:2048 lds
    v_mfma_f32_16x16x32_bf16 v[144:147], a[16:19], a[40:43], v[144:147]
    v_perm_b32 v56, v50, v35, s36
    v_perm_b32 v57, v50, v35, s37
    v_mfma_f32_16x16x32_bf16 v[144:147], a[200:203], a[84:87], v[144:147]
    ds_read_b32 a116, v56
    ds_read_b32 a117, v57
    v_mfma_f32_16x16x32_bf16 v[148:151], a[16:19], a[100:103], v[148:151]
    v_perm_b32 v58, v50, v35, s38
    v_perm_b32 v59, v50, v35, s39
    v_mfma_f32_16x16x32_bf16 v[148:151], a[200:203], a[0:3], v[148:151]
    s_waitcnt lgkmcnt(7)
    ds_read_b32 a118, v58
    ds_read_b32 a119, v59
    v_mfma_f32_16x16x32_bf16 v[152:155], a[16:19], a[12:15], v[152:155]
    v_perm_b32 v60, v54, v35, s36
    v_perm_b32 v61, v54, v35, s37
    v_mfma_f32_16x16x32_bf16 v[152:155], a[200:203], a[20:23], v[152:155]
    s_waitcnt lgkmcnt(7)
    ds_read_b32 a72, v60
    ds_read_b32 a73, v61
    v_mfma_f32_16x16x32_bf16 v[156:159], a[16:19], a[36:39], v[156:159]
    buffer_load_dwordx4 v39, s[8:11], s56 offen offset:3072 lds
    v_mfma_f32_16x16x32_bf16 v[156:159], a[200:203], a[52:55], v[156:159]
    s_add_u32 m0, s57, 49152
    v_perm_b32 v62, v54, v35, s38
    v_perm_b32 v63, v54, v35, s39
    v_mfma_f32_16x16x32_bf16 v[160:163], a[212:215], a[228:231], v[160:163]
    s_add_u32 s56, s55, 1792
    ds_read_b32 a74, v62
    ds_read_b32 a75, v63
    v_mfma_f32_16x16x32_bf16 v[160:163], a[216:219], a[240:243], v[160:163]
    ds_read_b128 a[128:131], v47 offset:0
    v_perm_b32 v56, v64, v35, s36
    v_mfma_f32_16x16x32_bf16 v[164:167], a[212:215], a[244:247], v[164:167]
    s_waitcnt vmcnt(18)
    ds_read_b32 a140, v56
    v_bitop3_b32 v101, v101, v103, s76 bitop3:0x7e
    v_mfma_f32_16x16x32_bf16 v[164:167], a[216:219], a[252:255], v[164:167]
    v_cmp_ne_u32 vcc, 0, v101
    v_perm_b32 v57, v64, v35, s37
    v_mfma_f32_16x16x32_bf16 v[168:171], a[212:215], a[32:35], v[168:171]
    ds_read_b32 a141, v57
    v_perm_b32 v58, v64, v35, s38
    v_mfma_f32_16x16x32_bf16 v[168:171], a[216:219], a[4:7], v[168:171]
    ds_read_b32 a142, v58
    s_cbranch_vccnz L_slow5_2
L_back5_2:
    v_mfma_f32_16x16x32_bf16 v[172:175], a[212:215], a[76:79], v[172:175]
    buffer_load_dwordx4 v36, s[8:11], s3 offen offset:0 lds
    v_mfma_f32_16x16x32_bf16 v[172:175], a[216:219], a[24:27], v[172:175]
    ds_read_b128 a[156:159], v46 offset:2048
    v_perm_b32 v59, v64, v35, s39
    v_mfma_f32_16x16x32_bf16 v[176:179], a[212:215], a[40:43], v[176:179]
    ds_read_b32 a143, v59
    v_perm_b32 v60, v96, v35, s36
    v_mfma_f32_16x16x32_bf16 v[176:179], a[216:219], a[84:87], v[176:179]
    ds_read_b32 a80, v60
    ds_read_b128 a[164:167], v47 offset:2048
    v_mfma_f32_16x16x32_bf16 v[180:183], a[212:215], a[100:103], v[180:183]
    buffer_load_dwordx4 v[104:107], v22, s[32:35], 0 offen
    v_mfma_f32_16x16x32_bf16 v[180:183], a[216:219], a[0:3], v[180:183]
    ds_read_b128 a[88:91], v46 offset:4096
    v_perm_b32 v61, v96, v35, s37
    v_mfma_f32_16x16x32_bf16 v[184:187], a[212:215], a[12:15], v[184:187]
    ds_read_b32 a81, v61
    v_perm_b32 v62, v96, v35, s38
    v_mfma_f32_16x16x32_bf16 v[184:187], a[216:219], a[20:23], v[184:187]
    ds_read_b32 a82, v62
    ds_read_b128 a[96:99], v47 offset:4096
    v_mfma_f32_16x16x32_bf16 v[188:191], a[212:215], a[36:39], v[188:191]
    buffer_load_dwordx4 v37, s[8:11], s3 offen offset:1024 lds
    v_mfma_f32_16x16x32_bf16 v[188:191], a[216:219], a[52:55], v[188:191]
    v_perm_b32 v63, v96, v35, s39
    v_perm_b32 v56, v65, v35, s36
    v_mfma_f32_16x16x32_bf16 v[192:195], a[224:227], a[228:231], v[192:195]
    ds_read_b32 a83, v63
    ds_read_b32 a172, v56
    v_mfma_f32_16x16x32_bf16 v[192:195], a[232:235], a[240:243], v[192:195]
    s_waitcnt vmcnt(18)
    ds_read_b128 a[104:107], v46 offset:6144
    v_mfma_f32_16x16x32_bf16 v[196:199], a[224:227], a[244:247], v[196:199]
    buffer_load_dwordx2 v[108:109], v22, s[32:35], 0 offen offset:16
    v_mfma_f32_16x16x32_bf16 v[196:199], a[232:235], a[252:255], v[196:199]
    ds_read_b128 a[92:95], v47 offset:6144
    v_bitop3_b32 v71, v71, v75, s76 bitop3:0x7e
    v_perm_b32 v57, v65, v35, s37
    v_mfma_f32_16x16x32_bf16 v[200:203], a[224:227], a[32:35], v[200:203]
    ds_read_b128 a[108:111], v46 offset:8192
    ds_read_b32 a173, v57
    v_cmp_ne_u32 vcc, 0, v71
    v_mfma_f32_16x16x32_bf16 v[200:203], a[232:235], a[4:7], v[200:203]
    ds_read_b128 a[132:135], v47 offset:8192
    v_mfma_f32_16x16x32_bf16 v[204:207], a[224:227], a[76:79], v[204:207]
    buffer_load_dwordx4 v38, s[8:11], s3 offen offset:2048 lds
    v_mfma_f32_16x16x32_bf16 v[204:207], a[232:235], a[24:27], v[204:207]
    ds_read_b128 a[120:123], v46 offset:10240
    s_cbranch_vccnz L_slow5_1
L_back5_1:
    v_mfma_f32_16x16x32_bf16 v[208:211], a[224:227], a[40:43], v[208:211]
    ds_read_b128 a[124:127], v47 offset:10240
    v_perm_b32 v58, v65, v35, s38
    v_perm_b32 v59, v65, v35, s39
    v_mfma_f32_16x16x32_bf16 v[208:211], a[232:235], a[84:87], v[208:211]
    ds_read_b32 a174, v58
    ds_read_b32 a175, v59
    v_mfma_f32_16x16x32_bf16 v[212:215], a[224:227], a[100:103], v[212:215]
    buffer_load_dword v110, v23, s[32:35], 0 offen
    v_mfma_f32_16x16x32_bf16 v[212:215], a[232:235], a[0:3], v[212:215]
    ds_read_b128 a[148:151], v46 offset:12288
    v_perm_b32 v60, v97, v35, s36
    v_perm_b32 v61, v97, v35, s37
    v_mfma_f32_16x16x32_bf16 v[216:219], a[224:227], a[12:15], v[216:219]
    ds_read_b32 a112, v60
    ds_read_b32 a113, v61
    v_perm_b32 v62, v97, v35, s38
    v_mfma_f32_16x16x32_bf16 v[216:219], a[232:235], a[20:23], v[216:219]
    ds_read_b128 a[136:139], v47 offset:12288
    ds_read_b32 a114, v62
    v_perm_b32 v63, v97, v35, s39
    v_mfma_f32_16x16x32_bf16 v[220:223], a[224:227], a[36:39], v[220:223]
    ds_read_b32 a115, v63
    v_perm_b32 v56, v66, v35, s36
    v_mfma_f32_16x16x32_bf16 v[220:223], a[232:235], a[52:55], v[220:223]
    s_mov_b32 s48, 143360
    ds_read_b32 a144, v56
    v_perm_b32 v57, v66, v35, s37
    v_mfma_f32_16x16x32_bf16 v[224:227], a[60:63], a[228:231], v[224:227]
    ds_read_b128 a[152:155], v46 offset:14336
    ds_read_b32 a145, v57
    v_perm_b32 v58, v66, v35, s38
    v_mfma_f32_16x16x32_bf16 v[224:227], a[56:59], a[240:243], v[224:227]
    ds_read_b32 a146, v58
    ds_read_b128 a[160:163], v47 offset:14336
    v_mfma_f32_16x16x32_bf16 v[228:231], a[60:63], a[244:247], v[228:231]
    buffer_load_dwordx2 v[112:113], v34, s[12:15], s48 offen sc1
    v_mfma_f32_16x16x32_bf16 v[228:231], a[56:59], a[252:255], v[228:231]
    s_mov_b32 s69, 148480
    v_perm_b32 v59, v66, v35, s39
    v_perm_b32 v60, v98, v35, s36
    v_mfma_f32_16x16x32_bf16 v[232:235], a[60:63], a[32:35], v[232:235]
    ds_read_b32 a147, v59
    ds_read_b32 a168, v60
    v_perm_b32 v61, v98, v35, s37
    v_mfma_f32_16x16x32_bf16 v[232:235], a[56:59], a[4:7], v[232:235]
    ds_read_b32 a169, v61
    v_mfma_f32_16x16x32_bf16 v[236:239], a[60:63], a[76:79], v[236:239]
    buffer_load_dwordx2 v[114:115], v34, s[12:15], s69 offen sc1
    v_mfma_f32_16x16x32_bf16 v[236:239], a[56:59], a[24:27], v[236:239]
    v_perm_b32 v62, v98, v35, s38
    v_perm_b32 v63, v98, v35, s39
    v_mfma_f32_16x16x32_bf16 v[240:243], a[60:63], a[40:43], v[240:243]
    ds_read_b32 a170, v62
    ds_read_b32 a171, v63
    v_perm_b32 v56, v100, v35, s36
    v_mfma_f32_16x16x32_bf16 v[240:243], a[56:59], a[84:87], v[240:243]
    s_waitcnt vmcnt(18) lgkmcnt(5)
    ds_read_b32 a180, v56
    v_mfma_f32_16x16x32_bf16 v[244:247], a[60:63], a[100:103], v[244:247]
    buffer_load_dwordx4 v39, s[8:11], s3 offen offset:3072 lds
    v_mfma_f32_16x16x32_bf16 v[244:247], a[56:59], a[0:3], v[244:247]
    s_add_u32 m0, s57, 65536
    v_perm_b32 v57, v100, v35, s37
    v_perm_b32 v58, v100, v35, s38
    v_mfma_f32_16x16x32_bf16 v[248:251], a[60:63], a[12:15], v[248:251]
    s_barrier
    v_mfma_f32_16x16x32_bf16 v[248:251], a[56:59], a[20:23], v[248:251]
    s_add_u32 s3, s55, 1920
    ds_read_b32 a181, v57
    ds_read_b32 a182, v58
    v_mfma_f32_16x16x32_bf16 v[252:255], a[60:63], a[36:39], v[252:255]
    s_mov_b32 s49, 143360
    v_perm_b32 v59, v100, v35, s39
    v_perm_b32 v60, v102, v35, s36
L_pad3:
    s_cbranch_execz L_pad4
    v_mfma_f32_16x16x32_bf16 v[252:255], a[56:59], a[52:55], v[252:255]
    s_mov_b32 s40, 148480
    ds_read_b32 a183, v59
    ds_read_b32 a188, v60
    v_mfma_f32_16x16x32_bf16 v[128:131], a[68:71], a[64:67], v[128:131]
    buffer_load_dwordx4 v[116:119], v32, s[12:15], s49 offen sc1
    v_mfma_f32_16x16x32_bf16 v[128:131], a[8:11], a[128:131], v[128:131]
    v_perm_b32 v61, v102, v35, s37
    v_perm_b32 v62, v102, v35, s38
    v_mfma_f32_16x16x32_bf16 v[132:135], a[68:71], a[156:159], v[132:135]
    ds_read_b32 a189, v61
    ds_read_b32 a190, v62
    v_perm_b32 v63, v102, v35, s39
    v_mfma_f32_16x16x32_bf16 v[132:135], a[8:11], a[164:167], v[132:135]
    ds_read_b32 a191, v63
    ds_read_b128 a[192:195], v40 offset:0
    v_mfma_f32_16x16x32_bf16 v[136:139], a[68:71], a[88:91], v[136:139]
    buffer_load_dwordx4 v[120:123], v32, s[12:15], s40 offen sc1
    v_mfma_f32_16x16x32_bf16 v[136:139], a[8:11], a[96:99], v[136:139]
    s_waitcnt vmcnt(19)
    v_perm_b32 v56, v68, v35, s36
    v_bitop3_b32 v77, v77, v79, s76 bitop3:0x7e
    v_mfma_f32_16x16x32_bf16 v[140:143], a[68:71], a[104:107], v[140:143]
    ds_read_b32 a236, v56
    v_cmp_ne_u32 vcc, 0, v77
    v_mfma_f32_16x16x32_bf16 v[140:143], a[8:11], a[92:95], v[140:143]
    v_perm_b32 v57, v68, v35, s37
    v_perm_b32 v58, v68, v35, s38
    v_mfma_f32_16x16x32_bf16 v[144:147], a[68:71], a[108:111], v[144:147]
    ds_read_b32 a237, v57
    ds_read_b32 a238, v58
    v_mfma_f32_16x16x32_bf16 v[144:147], a[8:11], a[132:135], v[144:147]
    v_perm_b32 v59, v68, v35, s39
    s_cbranch_vccnz L_slow6_2
L_back6_2:
    v_mfma_f32_16x16x32_bf16 v[148:151], a[68:71], a[120:123], v[148:151]
    s_mov_b32 s50, 143360
    ds_read_b32 a239, v59
    v_perm_b32 v60, v72, v35, s36
    v_mfma_f32_16x16x32_bf16 v[148:151], a[8:11], a[124:127], v[148:151]
    ds_read_b32 a48, v60
    ds_read_b128 a[196:199], v41 offset:0
    v_mfma_f32_16x16x32_bf16 v[152:155], a[68:71], a[148:151], v[152:155]
    buffer_load_dwordx4 v[124:127], v33, s[12:15], s50 offen sc1
    v_mfma_f32_16x16x32_bf16 v[152:155], a[8:11], a[136:139], v[152:155]
    s_mov_b32 s41, 148480
    ds_read_b128 a[208:211], v40 offset:2048
    v_perm_b32 v61, v72, v35, s37
    v_mfma_f32_16x16x32_bf16 v[156:159], a[68:71], a[152:155], v[156:159]
    ds_read_b32 a49, v61
    v_perm_b32 v62, v72, v35, s38
    v_mfma_f32_16x16x32_bf16 v[156:159], a[8:11], a[160:163], v[156:159]
    ds_read_b128 a[220:223], v41 offset:2048
    ds_read_b32 a50, v62
    v_mfma_f32_16x16x32_bf16 v[160:163], a[28:31], a[64:67], v[160:163]
    buffer_load_dwordx4 v[48:51], v33, s[12:15], s41 offen sc1
    v_mfma_f32_16x16x32_bf16 v[160:163], a[44:47], a[128:131], v[160:163]
    v_perm_b32 v63, v72, v35, s39
    v_perm_b32 v56, v69, v35, s36
    v_mfma_f32_16x16x32_bf16 v[164:167], a[28:31], a[156:159], v[164:167]
    ds_read_b128 a[176:179], v40 offset:4096
    ds_read_b32 a51, v63
    v_mfma_f32_16x16x32_bf16 v[164:167], a[44:47], a[164:167], v[164:167]
    ds_read_b32 a184, v56
    ds_read_b128 a[248:251], v41 offset:4096
    v_mfma_f32_16x16x32_bf16 v[168:171], a[28:31], a[88:91], v[168:171]
    buffer_load_dwordx4 v36, s[8:11], s56 offen offset:0 lds
    v_mfma_f32_16x16x32_bf16 v[168:171], a[44:47], a[96:99], v[168:171]
    s_waitcnt vmcnt(20)
    v_bitop3_b32 v83, v83, v87, s76 bitop3:0x7e
    v_perm_b32 v57, v69, v35, s37
    v_mfma_f32_16x16x32_bf16 v[172:175], a[28:31], a[104:107], v[172:175]
    ds_read_b32 a185, v57
    v_cmp_ne_u32 vcc, 0, v83
    v_mfma_f32_16x16x32_bf16 v[172:175], a[44:47], a[92:95], v[172:175]
    ds_read_b128 a[204:207], v40 offset:6144
    v_mfma_f32_16x16x32_bf16 v[176:179], a[28:31], a[108:111], v[176:179]
    buffer_load_dwordx4 v37, s[8:11], s56 offen offset:1024 lds
    v_mfma_f32_16x16x32_bf16 v[176:179], a[44:47], a[132:135], v[176:179]
    v_perm_b32 v58, v69, v35, s38
    s_cbranch_vccnz L_slow6_0
L_back6_0:
    v_mfma_f32_16x16x32_bf16 v[180:183], a[28:31], a[120:123], v[180:183]
    ds_read_b32 a186, v58
    v_perm_b32 v59, v69, v35, s39
    v_mfma_f32_16x16x32_bf16 v[180:183], a[44:47], a[124:127], v[180:183]
    ds_read_b128 a[16:19], v41 offset:6144
    ds_read_b32 a187, v59
    v_mfma_f32_16x16x32_bf16 v[184:187], a[28:31], a[148:151], v[184:187]
    buffer_load_dwordx4 v38, s[8:11], s56 offen offset:2048 lds
    v_mfma_f32_16x16x32_bf16 v[184:187], a[44:47], a[136:139], v[184:187]
    v_perm_b32 v60, v73, v35, s36
    v_perm_b32 v61, v73, v35, s37
    v_mfma_f32_16x16x32_bf16 v[188:191], a[28:31], a[152:155], v[188:191]
    ds_read_b128 a[200:203], v40 offset:8192
    ds_read_b32 a212, v60
    v_mfma_f32_16x16x32_bf16 v[188:191], a[44:47], a[160:163], v[188:191]
    ds_read_b32 a213, v61
    v_perm_b32 v62, v73, v35, s38
    v_mfma_f32_16x16x32_bf16 v[192:195], a[116:119], a[64:67], v[192:195]
    s_waitcnt vmcnt(20)
    ds_read_b32 a214, v62
    ds_read_b128 a[216:219], v41 offset:8192
    v_mfma_f32_16x16x32_bf16 v[192:195], a[72:75], a[128:131], v[192:195]
    buffer_load_dwordx4 v39, s[8:11], s56 offen offset:3072 lds
    v_mfma_f32_16x16x32_bf16 v[196:199], a[116:119], a[156:159], v[196:199]
    s_add_u32 m0, s57, 81920
    v_perm_b32 v63, v73, v35, s39
    v_perm_b32 v56, v70, v35, s36
    v_mfma_f32_16x16x32_bf16 v[196:199], a[72:75], a[164:167], v[196:199]
    ds_read_b32 a215, v63
    ds_read_b32 a224, v56
    v_bitop3_b32 v91, v91, v95, s76 bitop3:0x7e
    v_mfma_f32_16x16x32_bf16 v[200:203], a[116:119], a[88:91], v[200:203]
    ds_read_b128 a[232:235], v40 offset:10240
    v_cmp_ne_u32 vcc, 0, v91
    v_perm_b32 v57, v70, v35, s37
    v_mfma_f32_16x16x32_bf16 v[200:203], a[72:75], a[96:99], v[200:203]
    ds_read_b32 a225, v57
    v_perm_b32 v58, v70, v35, s38
    v_mfma_f32_16x16x32_bf16 v[204:207], a[116:119], a[104:107], v[204:207]
    ds_read_b32 a226, v58
    s_cbranch_vccnz L_slow6_1
L_back6_1:
    v_mfma_f32_16x16x32_bf16 v[204:207], a[72:75], a[92:95], v[204:207]
    ds_read_b128 a[228:231], v41 offset:10240
    v_perm_b32 v59, v70, v35, s39
    v_mfma_f32_16x16x32_bf16 v[208:211], a[116:119], a[108:111], v[208:211]
    ds_read_b32 a227, v59
    ds_read_b128 a[240:243], v40 offset:12288
    v_mfma_f32_16x16x32_bf16 v[208:211], a[72:75], a[132:135], v[208:211]
    buffer_load_dwordx4 v36, s[8:11], s3 offen offset:0 lds
    v_mfma_f32_16x16x32_bf16 v[212:215], a[116:119], a[120:123], v[212:215]
    v_perm_b32 v60, v74, v35, s36
    v_perm_b32 v61, v74, v35, s37
    v_mfma_f32_16x16x32_bf16 v[212:215], a[72:75], a[124:127], v[212:215]
    ds_read_b32 a244, v60
    ds_read_b32 a245, v61
    v_perm_b32 v62, v74, v35, s38
    v_mfma_f32_16x16x32_bf16 v[216:219], a[116:119], a[148:151], v[216:219]
    ds_read_b32 a246, v62
    v_perm_b32 v63, v74, v35, s39
    v_mfma_f32_16x16x32_bf16 v[216:219], a[72:75], a[136:139], v[216:219]
    ds_read_b128 a[252:255], v41 offset:12288
    ds_read_b32 a247, v63
    v_mfma_f32_16x16x32_bf16 v[220:223], a[116:119], a[152:155], v[220:223]
    v_perm_b32 v56, v76, v35, s36
    v_perm_b32 v57, v76, v35, s37
    v_mfma_f32_16x16x32_bf16 v[220:223], a[72:75], a[160:163], v[220:223]
    s_waitcnt lgkmcnt(8)
    ds_read_b32 a32, v56
    ds_read_b32 a33, v57
    v_mfma_f32_16x16x32_bf16 v[128:131], a[140:143], a[192:195], v[128:131]
    buffer_load_dwordx4 v37, s[8:11], s3 offen offset:1024 lds
    v_mfma_f32_16x16x32_bf16 v[128:131], a[80:83], a[196:199], v[128:131]
    ds_read_b128 a[4:7], v40 offset:14336
    v_perm_b32 v58, v76, v35, s38
    v_mfma_f32_16x16x32_bf16 v[132:135], a[140:143], a[208:211], v[132:135]
    ds_read_b32 a34, v58
    v_perm_b32 v59, v76, v35, s39
    v_mfma_f32_16x16x32_bf16 v[132:135], a[80:83], a[220:223], v[132:135]
    ds_read_b128 a[76:79], v41 offset:14336
    ds_read_b32 a35, v59
    v_mfma_f32_16x16x32_bf16 v[136:139], a[140:143], a[176:179], v[136:139]
    v_perm_b32 v60, v78, v35, s36
    v_perm_b32 v61, v78, v35, s37
    v_mfma_f32_16x16x32_bf16 v[136:139], a[80:83], a[248:251], v[136:139]
    ds_read_b32 a24, v60
    ds_read_b32 a25, v61
    v_mfma_f32_16x16x32_bf16 v[140:143], a[140:143], a[204:207], v[140:143]
    ds_read_b128 a[40:43], v42 offset:0
    v_mfma_f32_16x16x32_bf16 v[140:143], a[80:83], a[16:19], v[140:143]
    buffer_load_dwordx4 v38, s[8:11], s3 offen offset:2048 lds
    v_mfma_f32_16x16x32_bf16 v[144:147], a[140:143], a[200:203], v[144:147]
    v_perm_b32 v62, v78, v35, s38
    v_perm_b32 v63, v78, v35, s39
    v_mfma_f32_16x16x32_bf16 v[144:147], a[80:83], a[216:219], v[144:147]
    ds_read_b32 a26, v62
    ds_read_b32 a27, v63
    v_mfma_f32_16x16x32_bf16 v[148:151], a[140:143], a[232:235], v[148:151]
    s_waitcnt lgkmcnt(8)
    v_perm_b32 v56, v80, v35, s36
    v_perm_b32 v57, v80, v35, s37
    v_mfma_f32_16x16x32_bf16 v[148:151], a[80:83], a[228:231], v[148:151]
    ds_read_b32 a84, v56
    ds_read_b32 a85, v57
    v_mfma_f32_16x16x32_bf16 v[152:155], a[140:143], a[240:243], v[152:155]
    v_perm_b32 v58, v80, v35, s38
    v_perm_b32 v59, v80, v35, s39
    v_mfma_f32_16x16x32_bf16 v[152:155], a[80:83], a[252:255], v[152:155]
    ds_read_b32 a86, v58
    ds_read_b32 a87, v59
    v_mfma_f32_16x16x32_bf16 v[156:159], a[140:143], a[4:7], v[156:159]
    s_waitcnt lgkmcnt(7)
    ds_read_b128 a[100:103], v43 offset:0
    v_mfma_f32_16x16x32_bf16 v[156:159], a[80:83], a[76:79], v[156:159]
    buffer_load_dwordx4 v39, s[8:11], s3 offen offset:3072 lds
    v_mfma_f32_16x16x32_bf16 v[160:163], a[172:175], a[192:195], v[160:163]
    v_perm_b32 v60, v84, v35, s36
    v_perm_b32 v61, v84, v35, s37
    v_mfma_f32_16x16x32_bf16 v[160:163], a[112:115], a[196:199], v[160:163]
    ds_read_b32 a0, v60
    ds_read_b32 a1, v61
    v_mfma_f32_16x16x32_bf16 v[164:167], a[172:175], a[208:211], v[164:167]
    v_perm_b32 v62, v84, v35, s38
    v_perm_b32 v63, v84, v35, s39
    v_mfma_f32_16x16x32_bf16 v[164:167], a[112:115], a[220:223], v[164:167]
    ds_read_b32 a2, v62
    ds_read_b32 a3, v63
    v_mfma_f32_16x16x32_bf16 v[168:171], a[172:175], a[176:179], v[168:171]
    ds_read_b128 a[12:15], v42 offset:2048
    v_perm_b32 v56, v88, v35, s36
    v_mfma_f32_16x16x32_bf16 v[168:171], a[112:115], a[248:251], v[168:171]
    ds_read_b32 a20, v56
    v_perm_b32 v57, v88, v35, s37
    v_mfma_f32_16x16x32_bf16 v[172:175], a[172:175], a[204:207], v[172:175]
    ds_read_b32 a21, v57
    v_perm_b32 v58, v88, v35, s38
    v_mfma_f32_16x16x32_bf16 v[172:175], a[112:115], a[16:19], v[172:175]
    ds_read_b32 a22, v58
    ds_read_b128 a[60:63], v43 offset:2048
    v_mfma_f32_16x16x32_bf16 v[176:179], a[172:175], a[200:203], v[176:179]
    ds_read_b128 a[36:39], v42 offset:4096
    v_perm_b32 v59, v88, v35, s39
    v_mfma_f32_16x16x32_bf16 v[176:179], a[112:115], a[216:219], v[176:179]
    ds_read_b32 a23, v59
    v_perm_b32 v60, v92, v35, s36
    v_mfma_f32_16x16x32_bf16 v[180:183], a[172:175], a[232:235], v[180:183]
    ds_read_b32 a56, v60
    v_perm_b32 v61, v92, v35, s37
    v_mfma_f32_16x16x32_bf16 v[180:183], a[112:115], a[228:231], v[180:183]
    ds_read_b32 a57, v61
    ds_read_b128 a[52:55], v43 offset:4096
    v_mfma_f32_16x16x32_bf16 v[184:187], a[172:175], a[240:243], v[184:187]
    v_perm_b32 v62, v92, v35, s38
    v_perm_b32 v63, v92, v35, s39
    v_mfma_f32_16x16x32_bf16 v[184:187], a[112:115], a[252:255], v[184:187]
    ds_read_b32 a58, v62
    ds_read_b32 a59, v63
    v_mfma_f32_16x16x32_bf16 v[188:191], a[172:175], a[4:7], v[188:191]
    ds_read_b128 a[68:71], v42 offset:6144
    v_perm_b32 v56, v81, v35, s36
    v_mfma_f32_16x16x32_bf16 v[188:191], a[112:115], a[76:79], v[188:191]
    ds_read_b32 a8, v56
    v_perm_b32 v57, v81, v35, s37
    v_mfma_f32_16x16x32_bf16 v[192:195], a[144:147], a[192:195], v[192:195]
    ds_read_b32 a9, v57
    ds_read_b128 a[28:31], v43 offset:6144
    v_mfma_f32_16x16x32_bf16 v[192:195], a[168:171], a[196:199], v[192:195]
    v_perm_b32 v58, v81, v35, s38
    v_perm_b32 v59, v81, v35, s39
    v_mfma_f32_16x16x32_bf16 v[196:199], a[144:147], a[208:211], v[196:199]
    ds_read_b32 a10, v58
    ds_read_b32 a11, v59
    v_mfma_f32_16x16x32_bf16 v[196:199], a[168:171], a[220:223], v[196:199]
    ds_read_b128 a[44:47], v42 offset:8192
    v_perm_b32 v60, v85, v35, s36
    v_mfma_f32_16x16x32_bf16 v[200:203], a[144:147], a[176:179], v[200:203]
    ds_read_b128 a[64:67], v43 offset:8192
    ds_read_b32 a128, v60
    v_mfma_f32_16x16x32_bf16 v[200:203], a[168:171], a[248:251], v[200:203]
    ds_read_b128 a[156:159], v42 offset:10240
    v_perm_b32 v61, v85, v35, s37
    v_mfma_f32_16x16x32_bf16 v[204:207], a[144:147], a[204:207], v[204:207]
    ds_read_b32 a129, v61
    v_perm_b32 v62, v85, v35, s38
    v_mfma_f32_16x16x32_bf16 v[204:207], a[168:171], a[16:19], v[204:207]
    ds_read_b128 a[164:167], v43 offset:10240
    ds_read_b32 a130, v62
    v_mfma_f32_16x16x32_bf16 v[208:211], a[144:147], a[200:203], v[208:211]
    v_perm_b32 v63, v85, v35, s39
    v_perm_b32 v56, v89, v35, s36
    v_mfma_f32_16x16x32_bf16 v[208:211], a[168:171], a[216:219], v[208:211]
    ds_read_b32 a131, v63
    ds_read_b32 a88, v56
    v_mfma_f32_16x16x32_bf16 v[212:215], a[144:147], a[232:235], v[212:215]
    s_waitcnt vmcnt(13)
    ds_read_b128 a[96:99], v42 offset:12288
    v_bitop3_b32 v113, v113, v115, s76 bitop3:0x7e
    v_mfma_f32_16x16x32_bf16 v[212:215], a[168:171], a[228:231], v[212:215]
    v_cmp_ne_u32 vcc, 0, v113
    v_perm_b32 v57, v89, v35, s37
    v_mfma_f32_16x16x32_bf16 v[216:219], a[144:147], a[240:243], v[216:219]
    ds_read_b32 a89, v57
    v_perm_b32 v58, v89, v35, s38
    v_mfma_f32_16x16x32_bf16 v[216:219], a[168:171], a[252:255], v[216:219]
    ds_read_b128 a[104:107], v43 offset:12288
    ds_read_b32 a90, v58
    v_mfma_f32_16x16x32_bf16 v[220:223], a[144:147], a[4:7], v[220:223]
    v_perm_b32 v59, v89, v35, s39
    s_cbranch_vccnz L_slow7_2
L_back7_2:
    v_mfma_f32_16x16x32_bf16 v[220:223], a[168:171], a[76:79], v[220:223]
    ds_read_b32 a91, v59
    v_perm_b32 v60, v93, v35, s36
    v_mfma_f32_16x16x32_bf16 v[224:227], a[180:183], a[192:195], v[224:227]
    ds_read_b128 a[92:95], v42 offset:14336
    ds_read_b32 a108, v60
    v_mfma_f32_16x16x32_bf16 v[224:227], a[188:191], a[196:199], v[224:227]
    v_perm_b32 v61, v93, v35, s37
    v_perm_b32 v62, v93, v35, s38
    v_mfma_f32_16x16x32_bf16 v[228:231], a[180:183], a[208:211], v[228:231]
    ds_read_b32 a109, v61
    ds_read_b32 a110, v62
    v_mfma_f32_16x16x32_bf16 v[228:231], a[188:191], a[220:223], v[228:231]
    ds_read_b128 a[132:135], v43 offset:14336
    v_perm_b32 v63, v93, v35, s39
    v_mfma_f32_16x16x32_bf16 v[232:235], a[180:183], a[176:179], v[232:235]
    ds_read_b32 a111, v63
    v_perm_b32 v56, v82, v35, s36
    v_mfma_f32_16x16x32_bf16 v[232:235], a[188:191], a[248:251], v[232:235]
    s_waitcnt vmcnt(10)
    ds_read_b32 a120, v56
    v_bitop3_b32 v119, v119, v123, s76 bitop3:0x7e
    v_mfma_f32_16x16x32_bf16 v[236:239], a[180:183], a[204:207], v[236:239]
    v_cmp_ne_u32 vcc, 0, v119
    v_perm_b32 v57, v82, v35, s37
    v_mfma_f32_16x16x32_bf16 v[236:239], a[188:191], a[16:19], v[236:239]
    ds_read_b32 a121, v57
    v_perm_b32 v58, v82, v35, s38
    v_mfma_f32_16x16x32_bf16 v[240:243], a[180:183], a[200:203], v[240:243]
    ds_read_b32 a122, v58
    s_cbranch_vccnz L_slow7_0
L_back7_0:
    v_mfma_f32_16x16x32_bf16 v[240:243], a[188:191], a[216:219], v[240:243]
    v_perm_b32 v59, v82, v35, s39
    v_perm_b32 v60, v86, v35, s36
    v_mfma_f32_16x16x32_bf16 v[244:247], a[180:183], a[232:235], v[244:247]
    ds_read_b32 a123, v59
    ds_read_b32 a124, v60
    v_mfma_f32_16x16x32_bf16 v[244:247], a[188:191], a[228:231], v[244:247]
    s_waitcnt lgkmcnt(6)
    v_perm_b32 v61, v86, v35, s37
    v_perm_b32 v62, v86, v35, s38
    v_mfma_f32_16x16x32_bf16 v[248:251], a[180:183], a[240:243], v[248:251]
    s_barrier
    v_mfma_f32_16x16x32_bf16 v[248:251], a[188:191], a[252:255], v[248:251]
    ds_read_b32 a125, v61
    ds_read_b32 a126, v62
    v_mfma_f32_16x16x32_bf16 v[252:255], a[180:183], a[4:7], v[252:255]
    v_perm_b32 v63, v86, v35, s39
    v_perm_b32 v56, v90, v35, s36
    v_mfma_f32_16x16x32_bf16 v[252:255], a[188:191], a[76:79], v[252:255]
    ds_read_b32 a127, v63
    ds_read_b32 a148, v56
    v_mfma_f32_16x16x32_bf16 v[128:131], a[236:239], a[40:43], v[128:131]
    s_waitcnt vmcnt(8)
    v_bitop3_b32 v127, v127, v51, s76 bitop3:0x7e
    v_perm_b32 v57, v90, v35, s37
    v_mfma_f32_16x16x32_bf16 v[128:131], a[48:51], a[100:103], v[128:131]
    ds_read_b32 a149, v57
    v_cmp_ne_u32 vcc, 0, v127
    v_mfma_f32_16x16x32_bf16 v[132:135], a[236:239], a[12:15], v[132:135]
    v_perm_b32 v58, v90, v35, s38
    v_perm_b32 v59, v90, v35, s39
    v_mfma_f32_16x16x32_bf16 v[132:135], a[48:51], a[60:63], v[132:135]
    ds_read_b32 a150, v58
    ds_read_b32 a151, v59
    v_mfma_f32_16x16x32_bf16 v[136:139], a[236:239], a[36:39], v[136:139]
    v_perm_b32 v60, v94, v35, s36
    s_cbranch_vccnz L_slow7_1
L_back7_1:
    v_mfma_f32_16x16x32_bf16 v[136:139], a[48:51], a[52:55], v[136:139]
    ds_read_b32 a136, v60
    v_perm_b32 v61, v94, v35, s37
    v_mfma_f32_16x16x32_bf16 v[140:143], a[236:239], a[68:71], v[140:143]
    ds_read_b32 a137, v61
    v_perm_b32 v62, v94, v35, s38
    v_mfma_f32_16x16x32_bf16 v[140:143], a[48:51], a[28:31], v[140:143]
    ds_read_b32 a138, v62
    v_perm_b32 v63, v94, v35, s39
    v_mfma_f32_16x16x32_bf16 v[144:147], a[236:239], a[44:47], v[144:147]
    ds_read_b32 a139, v63
    v_perm_b32 v56, v112, v35, s36
    v_mfma_f32_16x16x32_bf16 v[144:147], a[48:51], a[64:67], v[144:147]
    ds_read_b32 a116, v56
    v_perm_b32 v57, v112, v35, s37
    v_mfma_f32_16x16x32_bf16 v[148:151], a[236:239], a[156:159], v[148:151]
    ds_read_b32 a117, v57
    v_perm_b32 v58, v112, v35, s38
    v_mfma_f32_16x16x32_bf16 v[148:151], a[48:51], a[164:167], v[148:151]
    ds_read_b32 a118, v58
    v_perm_b32 v59, v112, v35, s39
    v_mfma_f32_16x16x32_bf16 v[152:155], a[236:239], a[96:99], v[152:155]
    ds_read_b32 a119, v59
    v_perm_b32 v60, v114, v35, s36
    v_mfma_f32_16x16x32_bf16 v[152:155], a[48:51], a[104:107], v[152:155]
    ds_read_b32 a152, v60
    v_perm_b32 v61, v114, v35, s37
    v_mfma_f32_16x16x32_bf16 v[156:159], a[236:239], a[92:95], v[156:159]
    ds_read_b32 a153, v61
    v_perm_b32 v62, v114, v35, s38
    v_mfma_f32_16x16x32_bf16 v[156:159], a[48:51], a[132:135], v[156:159]
    ds_read_b32 a154, v62
    v_perm_b32 v63, v114, v35, s39
    v_mfma_f32_16x16x32_bf16 v[160:163], a[184:187], a[40:43], v[160:163]
    ds_read_b32 a155, v63
    ds_read_b128 a[72:75], v40 offset:32768
    v_mfma_f32_16x16x32_bf16 v[160:163], a[212:215], a[100:103], v[160:163]
    v_perm_b32 v56, v116, v35, s36
    v_perm_b32 v57, v116, v35, s37
    v_mfma_f32_16x16x32_bf16 v[164:167], a[184:187], a[12:15], v[164:167]
    ds_read_b32 a160, v56
    ds_read_b32 a161, v57
    v_mfma_f32_16x16x32_bf16 v[164:167], a[212:215], a[60:63], v[164:167]
    ds_read_b128 a[140:143], v41 offset:32768
    v_perm_b32 v58, v116, v35, s38
    v_mfma_f32_16x16x32_bf16 v[168:171], a[184:187], a[36:39], v[168:171]
    ds_read_b32 a162, v58
    v_perm_b32 v59, v116, v35, s39
    v_mfma_f32_16x16x32_bf16 v[168:171], a[212:215], a[52:55], v[168:171]
    ds_read_b32 a163, v59
    v_perm_b32 v60, v120, v35, s36
    v_mfma_f32_16x16x32_bf16 v[172:175], a[184:187], a[68:71], v[172:175]
    ds_read_b32 a80, v60
    v_perm_b32 v61, v120, v35, s37
    v_mfma_f32_16x16x32_bf16 v[172:175], a[212:215], a[28:31], v[172:175]
    ds_read_b32 a81, v61
    ds_read_b128 a[172:175], v40 offset:34816
    v_mfma_f32_16x16x32_bf16 v[176:179], a[184:187], a[44:47], v[176:179]
    v_perm_b32 v62, v120, v35, s38
    v_perm_b32 v63, v120, v35, s39
    v_mfma_f32_16x16x32_bf16 v[176:179], a[212:215], a[64:67], v[176:179]
    ds_read_b32 a82, v62
    ds_read_b32 a83, v63
    v_mfma_f32_16x16x32_bf16 v[180:183], a[184:187], a[156:159], v[180:183]
    ds_read_b128 a[112:115], v41 offset:34816
    v_perm_b32 v56, v124, v35, s36
    v_mfma_f32_16x16x32_bf16 v[180:183], a[212:215], a[164:167], v[180:183]
    ds_read_b32 a144, v56
    v_perm_b32 v57, v124, v35, s37
    v_mfma_f32_16x16x32_bf16 v[184:187], a[184:187], a[96:99], v[184:187]
    s_mov_b32 s64, 0
    ds_read_b32 a145, v57
    v_perm_b32 v58, v124, v35, s38
    v_mfma_f32_16x16x32_bf16 v[184:187], a[212:215], a[104:107], v[184:187]
    ds_read_b32 a146, v58
    v_perm_b32 v59, v124, v35, s39
    v_mfma_f32_16x16x32_bf16 v[188:191], a[184:187], a[92:95], v[188:191]
    ds_read_b32 a147, v59
    v_perm_b32 v60, v48, v35, s36
    v_mfma_f32_16x16x32_bf16 v[188:191], a[212:215], a[132:135], v[188:191]
    s_mov_b32 s65, 14336
    ds_read_b32 a192, v60
    ds_read_b128 a[168:171], v42 offset:32768
    v_mfma_f32_16x16x32_bf16 v[192:195], a[224:227], a[40:43], v[192:195]
    v_perm_b32 v61, v48, v35, s37
    v_perm_b32 v62, v48, v35, s38
    v_mfma_f32_16x16x32_bf16 v[192:195], a[244:247], a[100:103], v[192:195]
    ds_read_b32 a193, v61
    ds_read_b32 a194, v62
    v_mfma_f32_16x16x32_bf16 v[196:199], a[224:227], a[12:15], v[196:199]
    s_mov_b32 s66, 114688
    ds_read_b128 a[196:199], v43 offset:32768
    v_perm_b32 v63, v48, v35, s39
    v_mfma_f32_16x16x32_bf16 v[196:199], a[244:247], a[60:63], v[196:199]
    ds_read_b32 a195, v63
    v_perm_b32 v56, v117, v35, s36
    v_mfma_f32_16x16x32_bf16 v[200:203], a[224:227], a[36:39], v[200:203]
    ds_read_b32 a208, v56
    v_perm_b32 v57, v117, v35, s37
    v_mfma_f32_16x16x32_bf16 v[200:203], a[244:247], a[52:55], v[200:203]
    s_mov_b32 s67, 129024
    ds_read_b32 a209, v57
    v_perm_b32 v58, v117, v35, s38
    v_mfma_f32_16x16x32_bf16 v[204:207], a[224:227], a[68:71], v[204:207]
    ds_read_b32 a210, v58
    ds_read_b128 a[220:223], v42 offset:34816
    v_mfma_f32_16x16x32_bf16 v[204:207], a[244:247], a[28:31], v[204:207]
    v_perm_b32 v59, v117, v35, s39
    v_perm_b32 v60, v121, v35, s36
    v_mfma_f32_16x16x32_bf16 v[208:211], a[224:227], a[44:47], v[208:211]
    s_mov_b32 s68, 229376
    ds_read_b32 a211, v59
    ds_read_b32 a176, v60
    v_mfma_f32_16x16x32_bf16 v[208:211], a[244:247], a[64:67], v[208:211]
    v_perm_b32 v61, v121, v35, s37
    v_perm_b32 v62, v121, v35, s38
    v_mfma_f32_16x16x32_bf16 v[212:215], a[224:227], a[156:159], v[212:215]
    ds_read_b32 a177, v61
    ds_read_b32 a178, v62
    v_mfma_f32_16x16x32_bf16 v[212:215], a[244:247], a[164:167], v[212:215]
    s_mov_b32 s69, 243712
    ds_read_b128 a[248:251], v43 offset:34816
    v_perm_b32 v63, v121, v35, s39
    v_mfma_f32_16x16x32_bf16 v[216:219], a[224:227], a[96:99], v[216:219]
    ds_read_b32 a179, v63
    v_perm_b32 v56, v125, v35, s36
    v_mfma_f32_16x16x32_bf16 v[216:219], a[244:247], a[104:107], v[216:219]
    ds_read_b32 a204, v56
    v_perm_b32 v57, v125, v35, s37
    v_mfma_f32_16x16x32_bf16 v[220:223], a[224:227], a[92:95], v[220:223]
    s_mov_b32 s70, 344064
    ds_read_b32 a205, v57
    v_perm_b32 v58, v125, v35, s38
    v_mfma_f32_16x16x32_bf16 v[220:223], a[244:247], a[132:135], v[220:223]
    s_waitcnt lgkmcnt(8)
    ds_read_b32 a206, v58
    v_perm_b32 v59, v125, v35, s39
    v_mfma_f32_16x16x32_bf16 v[224:227], a[32:35], a[72:75], v[224:227]
    s_waitcnt vmcnt(0)
    ds_read_b32 a207, v59
    v_perm_b32 v60, v49, v35, s36
    v_mfma_f32_16x16x32_bf16 v[224:227], a[24:27], a[140:143], v[224:227]
    s_mov_b32 s71, 358400
    ds_read_b32 a16, v60
    v_perm_b32 v61, v49, v35, s37
    v_mfma_f32_16x16x32_bf16 v[228:231], a[32:35], a[172:175], v[228:231]
    s_barrier
    v_mfma_f32_16x16x32_bf16 v[228:231], a[24:27], a[112:115], v[228:231]
    ds_read_b32 a17, v61
    v_perm_b32 v62, v49, v35, s38
    v_mfma_f32_16x16x32_bf16 v[128:131], a[84:87], a[72:75], v[128:131]
    s_mov_b32 s73, 458752
    ds_read_b32 a18, v62
    v_perm_b32 v63, v49, v35, s39
    v_mfma_f32_16x16x32_bf16 v[128:131], a[0:3], a[140:143], v[128:131]
    ds_read_b32 a19, v63
    v_perm_b32 v56, v118, v35, s36
    v_mfma_f32_16x16x32_bf16 v[128:131], a[20:23], a[168:171], v[128:131]
    ds_read_b32 a200, v56
    v_perm_b32 v57, v118, v35, s37
    v_mfma_f32_16x16x32_bf16 v[128:131], a[56:59], a[196:199], v[128:131]
    s_mov_b32 s74, 473088
    ds_read_b128 a[216:219], v44 offset:0
    ds_read_b32 a201, v57
    v_mfma_f32_16x16x32_bf16 v[132:135], a[84:87], a[172:175], v[132:135]
    ds_read_b128 a[232:235], v45 offset:0
    v_perm_b32 v58, v118, v35, s38
L_pad4:
    s_cbranch_execz L_pad5
    v_mfma_f32_16x16x32_bf16 v[132:135], a[0:3], a[112:115], v[132:135]
    s_waitcnt lgkmcnt(8)
    ds_read_b128 a[228:231], v46 offset:0
    ds_read_b32 a202, v58
    v_mfma_f32_16x16x32_bf16 v[132:135], a[20:23], a[220:223], v[132:135]
    s_mov_b32 s75, 573440
    ds_read_b128 a[240:243], v47 offset:0
    v_perm_b32 v59, v122, v35, s36
    v_mfma_f32_16x16x32_bf16 v[132:135], a[56:59], a[248:251], v[132:135]
    ds_read_b32 a252, v59
    v_perm_b32 v60, v122, v35, s37
    v_mfma_f32_16x16x32_bf16 v[160:163], a[8:11], a[72:75], v[160:163]
    ds_read_b32 a253, v60
    v_perm_b32 v61, v118, v35, s39
    v_mfma_f32_16x16x32_bf16 v[160:163], a[128:131], a[140:143], v[160:163]
    s_mov_b32 s58, 587776
    ds_read_b32 a203, v61
    v_perm_b32 v62, v122, v35, s38
    v_mfma_f32_16x16x32_bf16 v[160:163], a[88:91], a[168:171], v[160:163]
    ds_read_b32 a254, v62
    v_perm_b32 v63, v126, v35, s36
    v_mfma_f32_16x16x32_bf16 v[160:163], a[108:111], a[196:199], v[160:163]
    ds_read_b32 a180, v63
    v_perm_b32 v56, v126, v35, s37
    v_mfma_f32_16x16x32_bf16 v[164:167], a[8:11], a[172:175], v[164:167]
    s_mov_b32 s48, 688128
    v_perm_b32 v57, v122, v35, s39
    v_perm_b32 v58, v126, v35, s38
    v_mfma_f32_16x16x32_bf16 v[164:167], a[128:131], a[112:115], v[164:167]
    ds_read_b32 a181, v56
    ds_read_b32 a255, v57
    v_mfma_f32_16x16x32_bf16 v[164:167], a[88:91], a[220:223], v[164:167]
    ds_read_b32 a182, v58
    v_perm_b32 v59, v126, v35, s39
    v_mfma_f32_16x16x32_bf16 v[164:167], a[108:111], a[248:251], v[164:167]
    s_mov_b32 s49, 702464
    ds_read_b128 a[4:7], v44 offset:2048
    ds_read_b32 a183, v59
    v_mfma_f32_16x16x32_bf16 v[192:195], a[120:123], a[72:75], v[192:195]
    ds_read_b128 a[188:191], v45 offset:2048
    v_perm_b32 v60, v50, v35, s36
    v_mfma_f32_16x16x32_bf16 v[192:195], a[124:127], a[140:143], v[192:195]
    ds_read_b128 a[76:79], v46 offset:2048
    v_perm_b32 v61, v50, v35, s37
    v_mfma_f32_16x16x32_bf16 v[192:195], a[148:151], a[168:171], v[192:195]
    s_mov_b32 s50, 802816
    ds_read_b32 a48, v60
    ds_read_b128 a[236:239], v47 offset:2048
    v_mfma_f32_16x16x32_bf16 v[192:195], a[136:139], a[196:199], v[192:195]
    ds_read_b32 a49, v61
    v_perm_b32 v62, v50, v35, s38
    v_mfma_f32_16x16x32_bf16 v[196:199], a[120:123], a[172:175], v[196:199]
    ds_read_b32 a50, v62
    v_perm_b32 v63, v50, v35, s39
    v_mfma_f32_16x16x32_bf16 v[196:199], a[124:127], a[112:115], v[196:199]
    s_mov_b32 s51, 817152
    ds_read_b128 a[184:187], v40 offset:36864
    ds_read_b32 a51, v63
    v_mfma_f32_16x16x32_bf16 v[196:199], a[148:151], a[220:223], v[196:199]
    v_lshlrev_b32 v52, 16, v110
    v_and_b32 v53, 0xffff0000, v110
    v_mfma_f32_16x16x32_bf16 v[196:199], a[136:139], a[248:251], v[196:199]
    s_waitcnt lgkmcnt(10)
    ds_read_b128 a[212:215], v41 offset:36864
    v_lshlrev_b32 v64, 16, v104
    v_mfma_f32_16x16x32_bf16 v[224:227], a[116:119], a[216:219], v[224:227]
    v_and_b32 v65, 0xffff0000, v105
    v_lshlrev_b32 v66, 16, v107
    v_mfma_f32_16x16x32_bf16 v[224:227], a[152:155], a[232:235], v[224:227]
    ds_read_b128 a[40:43], v44 offset:4096
    v_and_b32 v67, 0xffff0000, v108
    v_mfma_f32_16x16x32_bf16 v[128:131], a[160:163], a[216:219], v[128:131]
    v_and_b32 v96, 0xffff0000, v104
    v_lshlrev_b32 v97, 16, v106
    v_mfma_f32_16x16x32_bf16 v[128:131], a[80:83], a[232:235], v[128:131]
    v_and_b32 v98, 0xffff0000, v107
    v_lshlrev_b32 v99, 16, v109
    v_mfma_f32_16x16x32_bf16 v[128:131], a[144:147], a[228:231], v[128:131]
    ds_read_b128 a[100:103], v45 offset:4096
    v_lshlrev_b32 v100, 16, v105
    v_mfma_f32_16x16x32_bf16 v[128:131], a[192:195], a[240:243], v[128:131]
    ds_write_b64 v29, v[226:227] offset:0
    v_and_b32 v101, 0xffff0000, v106
    v_mfma_f32_16x16x32_bf16 v[160:163], a[208:211], a[216:219], v[160:163]
    v_lshlrev_b32 v102, 16, v108
    v_and_b32 v103, 0xffff0000, v109
    v_mfma_f32_16x16x32_bf16 v[160:163], a[176:179], a[232:235], v[160:163]
    v_mov_b32 v8, 1
    v_min_u32 v9, 1, v0
    v_mfma_f32_16x16x32_bf16 v[160:163], a[204:207], a[228:231], v[160:163]
    ds_read_b128 a[12:15], v42 offset:36864
    v_lshlrev_b32 v9, 30, v9
    v_mfma_f32_16x16x32_bf16 v[160:163], a[16:19], a[240:243], v[160:163]
    v_mul_f32 v128, v128, v64
    v_mfma_f32_16x16x32_bf16 v[192:195], a[200:203], a[216:219], v[192:195]
    buffer_atomic_add v8, v9, s[24:27], s77 offen sc0 sc1
    v_mfma_f32_16x16x32_bf16 v[192:195], a[252:255], a[232:235], v[192:195]
    s_waitcnt lgkmcnt(1)
    s_barrier
    v_mfma_f32_16x16x32_bf16 v[192:195], a[180:183], a[228:231], v[192:195]
    ds_read_b64 v[68:69], v30 offset:0
    ds_read_b128 a[60:63], v43 offset:36864
    v_mfma_f32_16x16x32_bf16 v[192:195], a[48:51], a[240:243], v[192:195]
    v_mul_f32 v129, v129, v65
    v_mul_f32 v130, v130, v66
    v_mfma_f32_16x16x32_bf16 v[228:231], a[116:119], a[4:7], v[228:231]
    v_mul_f32 v131, v131, v67
    v_mul_f32 v160, v160, v96
    v_mfma_f32_16x16x32_bf16 v[228:231], a[152:155], a[188:191], v[228:231]
    ds_read_b128 a[36:39], v46 offset:4096
    v_cvt_pk_bf16_f32 v72, v128, v160
    v_mfma_f32_16x16x32_bf16 v[132:135], a[160:163], a[4:7], v[132:135]
    v_mul_f32 v161, v161, v97
    v_mul_f32 v162, v162, v98
    v_mfma_f32_16x16x32_bf16 v[132:135], a[80:83], a[188:191], v[132:135]
    v_cvt_pk_bf16_f32 v75, v130, v162
    v_mul_f32 v192, v192, v100
    v_mfma_f32_16x16x32_bf16 v[132:135], a[144:147], a[76:79], v[132:135]
    v_mul_f32 v193, v193, v101
    v_mul_f32 v194, v194, v102
    v_mfma_f32_16x16x32_bf16 v[132:135], a[192:195], a[236:239], v[132:135]
    v_mul_f32 v195, v195, v103
    v_cvt_pk_bf16_f32 v73, v192, v129
    v_mfma_f32_16x16x32_bf16 v[164:167], a[208:211], a[4:7], v[164:167]
    ds_write_b64 v26, v[72:73] offset:0
    v_mul_f32 v163, v163, v99
    v_mfma_f32_16x16x32_bf16 v[164:167], a[176:179], a[188:191], v[164:167]
    v_cvt_pk_bf16_f32 v74, v161, v193
    v_cvt_pk_bf16_f32 v76, v194, v131
    v_mfma_f32_16x16x32_bf16 v[164:167], a[204:207], a[76:79], v[164:167]
    ds_write_b64 v26, v[74:75] offset:8
    v_cvt_pk_bf16_f32 v77, v163, v195
    v_mfma_f32_16x16x32_bf16 v[164:167], a[16:19], a[236:239], v[164:167]
    s_waitcnt lgkmcnt(3)
    ds_read_b128 a[52:55], v47 offset:4096
    v_add_f32 v224, v224, v68
    v_mfma_f32_16x16x32_bf16 v[196:199], a[200:203], a[4:7], v[196:199]
    ds_write_b64 v26, v[76:77] offset:16
    v_mul_f32 v224, v224, v52
    v_mfma_f32_16x16x32_bf16 v[196:199], a[252:255], a[188:191], v[196:199]
    ds_write_b64 v29, v[230:231] offset:2048
    v_add_f32 v225, v225, v69
    v_mfma_f32_16x16x32_bf16 v[196:199], a[180:183], a[76:79], v[196:199]
    v_mul_f32 v225, v225, v53
    v_cvt_pk_bf16_f32 v68, v224, v225
    v_mfma_f32_16x16x32_bf16 v[196:199], a[48:51], a[236:239], v[196:199]
    ds_read_b128 a[68:71], v40 offset:38912
    v_mul_f32 v132, v132, v64
    v_mfma_f32_16x16x32_bf16 v[232:235], a[32:35], a[184:187], v[232:235]
    ds_write_b32 v28, v68 offset:0
    v_mul_f32 v133, v133, v65
    v_mfma_f32_16x16x32_bf16 v[232:235], a[24:27], a[212:215], v[232:235]
    ds_read_b128 a[28:31], v41 offset:38912
    v_mul_f32 v134, v134, v66
    v_mfma_f32_16x16x32_bf16 v[232:235], a[116:119], a[40:43], v[232:235]
    ds_read_b128 a[44:47], v44 offset:6144
    v_mul_f32 v135, v135, v67
    v_mfma_f32_16x16x32_bf16 v[232:235], a[152:155], a[100:103], v[232:235]
    v_mul_f32 v196, v196, v100
    v_mul_f32 v197, v197, v101
    v_mfma_f32_16x16x32_bf16 v[136:139], a[84:87], a[184:187], v[136:139]
    v_mul_f32 v198, v198, v102
    v_mul_f32 v199, v199, v103
    v_mfma_f32_16x16x32_bf16 v[136:139], a[0:3], a[212:215], v[136:139]
    s_waitcnt lgkmcnt(2)
    s_barrier
    v_mfma_f32_16x16x32_bf16 v[136:139], a[20:23], a[12:15], v[136:139]
    ds_read_b128 v[80:83], v24 offset:0
    ds_read_b64 v[84:85], v30 offset:2048
    v_mfma_f32_16x16x32_bf16 v[136:139], a[56:59], a[60:63], v[136:139]
    ds_read_b128 v[88:91], v24 offset:928
    v_cvt_pk_bf16_f32 v93, v196, v133
    v_mfma_f32_16x16x32_bf16 v[136:139], a[160:163], a[40:43], v[136:139]
    v_mul_f32 v164, v164, v96
    v_cvt_pk_bf16_f32 v92, v132, v164
    v_mfma_f32_16x16x32_bf16 v[136:139], a[80:83], a[100:103], v[136:139]
    ds_read_b128 a[64:67], v45 offset:6144
    v_mul_f32 v165, v165, v97
    v_mfma_f32_16x16x32_bf16 v[136:139], a[144:147], a[36:39], v[136:139]
    ds_write_b64 v26, v[92:93] offset:7424
    v_mul_f32 v166, v166, v98
    v_mfma_f32_16x16x32_bf16 v[136:139], a[192:195], a[52:55], v[136:139]
    v_cvt_pk_bf16_f32 v95, v134, v166
    v_mul_f32 v167, v167, v99
    v_mfma_f32_16x16x32_bf16 v[168:171], a[8:11], a[184:187], v[168:171]
    s_waitcnt lgkmcnt(4)
    ds_write_b64 v29, v[234:235] offset:4096
    v_mfma_f32_16x16x32_bf16 v[168:171], a[128:131], a[212:215], v[168:171]
    buffer_store_dwordx4 v[80:83], v25, s[16:19], s64 offen sc1
    v_mfma_f32_16x16x32_bf16 v[168:171], a[88:91], a[12:15], v[168:171]
    ds_read_b128 a[156:159], v42 offset:38912
    v_cvt_pk_bf16_f32 v94, v165, v197
    v_mfma_f32_16x16x32_bf16 v[168:171], a[108:111], a[60:63], v[168:171]
    ds_write_b64 v26, v[94:95] offset:7432
    v_cvt_pk_bf16_f32 v112, v198, v135
    v_mfma_f32_16x16x32_bf16 v[168:171], a[208:211], a[40:43], v[168:171]
    s_waitcnt lgkmcnt(5)
    ds_read_b128 a[164:167], v43 offset:38912
    v_mfma_f32_16x16x32_bf16 v[168:171], a[176:179], a[100:103], v[168:171]
    buffer_store_dwordx4 v[88:91], v25, s[16:19], s65 offen sc1
    v_mfma_f32_16x16x32_bf16 v[168:171], a[204:207], a[36:39], v[168:171]
    v_cvt_pk_bf16_f32 v113, v167, v199
    v_add_f32 v228, v228, v84
    v_mfma_f32_16x16x32_bf16 v[168:171], a[16:19], a[52:55], v[168:171]
    ds_write_b64 v26, v[112:113] offset:7440
    v_mul_f32 v228, v228, v52
    v_mfma_f32_16x16x32_bf16 v[200:203], a[120:123], a[184:187], v[200:203]
    ds_read_b128 a[96:99], v46 offset:6144
    v_add_f32 v229, v229, v85
    v_mul_f32 v229, v229, v53
    v_mfma_f32_16x16x32_bf16 v[200:203], a[124:127], a[212:215], v[200:203]
    v_cvt_pk_bf16_f32 v84, v228, v229
    v_mul_f32 v136, v136, v64
    v_mfma_f32_16x16x32_bf16 v[200:203], a[148:151], a[12:15], v[200:203]
    ds_write_b32 v28, v84 offset:7424
    v_mul_f32 v137, v137, v65
    v_mfma_f32_16x16x32_bf16 v[200:203], a[136:139], a[60:63], v[200:203]
    ds_read_b128 a[104:107], v47 offset:6144
    v_mul_f32 v138, v138, v66
    v_mfma_f32_16x16x32_bf16 v[200:203], a[200:203], a[40:43], v[200:203]
    ds_read_b128 a[224:227], v40 offset:40960
    v_mul_f32 v139, v139, v67
    v_mfma_f32_16x16x32_bf16 v[200:203], a[252:255], a[100:103], v[200:203]
    ds_read_b128 a[92:95], v41 offset:40960
    v_mul_f32 v168, v168, v96
    v_mfma_f32_16x16x32_bf16 v[200:203], a[180:183], a[36:39], v[200:203]
    v_cvt_pk_bf16_f32 v116, v136, v168
    v_mul_f32 v169, v169, v97
    v_mfma_f32_16x16x32_bf16 v[200:203], a[48:51], a[52:55], v[200:203]
    s_waitcnt lgkmcnt(3)
    s_barrier
    v_mfma_f32_16x16x32_bf16 v[236:239], a[32:35], a[68:71], v[236:239]
    ds_read_b128 v[120:123], v24 offset:7424
    ds_read_b64 v[124:125], v30 offset:4096
    v_mfma_f32_16x16x32_bf16 v[236:239], a[24:27], a[28:31], v[236:239]
    ds_read_b128 v[48:51], v24 offset:8352
    v_mul_f32 v170, v170, v98
    v_mfma_f32_16x16x32_bf16 v[236:239], a[116:119], a[44:47], v[236:239]
    v_cvt_pk_bf16_f32 v119, v138, v170
    v_mul_f32 v171, v171, v99
    v_mfma_f32_16x16x32_bf16 v[236:239], a[152:155], a[64:67], v[236:239]
    v_mul_f32 v200, v200, v100
    v_mul_f32 v201, v201, v101
    v_mfma_f32_16x16x32_bf16 v[140:143], a[84:87], a[68:71], v[140:143]
    v_mul_f32 v202, v202, v102
    v_mul_f32 v203, v203, v103
    v_mfma_f32_16x16x32_bf16 v[140:143], a[0:3], a[28:31], v[140:143]
    v_cvt_pk_bf16_f32 v117, v200, v137
    v_cvt_pk_bf16_f32 v118, v169, v201
    v_mfma_f32_16x16x32_bf16 v[140:143], a[20:23], a[156:159], v[140:143]
    s_waitcnt lgkmcnt(2)
    ds_read_b128 a[244:247], v44 offset:8192
    v_mfma_f32_16x16x32_bf16 v[140:143], a[56:59], a[164:167], v[140:143]
    buffer_store_dwordx4 v[120:123], v25, s[16:19], s66 offen sc1
    v_mfma_f32_16x16x32_bf16 v[140:143], a[160:163], a[44:47], v[140:143]
    s_waitcnt lgkmcnt(2)
    v_add_f32 v232, v232, v124
    v_mul_f32 v232, v232, v52
    v_mfma_f32_16x16x32_bf16 v[140:143], a[80:83], a[64:67], v[140:143]
    v_add_f32 v233, v233, v125
    v_mul_f32 v233, v233, v53
    v_mfma_f32_16x16x32_bf16 v[140:143], a[144:147], a[96:99], v[140:143]
    s_waitcnt lgkmcnt(1)
    ds_read_b128 a[132:135], v45 offset:8192
    v_mfma_f32_16x16x32_bf16 v[140:143], a[192:195], a[104:107], v[140:143]
    buffer_store_dwordx4 v[48:51], v25, s[16:19], s67 offen sc1
    v_mfma_f32_16x16x32_bf16 v[172:175], a[8:11], a[68:71], v[172:175]
    ds_write_b64 v26, v[116:117] offset:14848
    v_cvt_pk_bf16_f32 v124, v232, v233
    v_mfma_f32_16x16x32_bf16 v[172:175], a[128:131], a[28:31], v[172:175]
    ds_read_b128 a[72:75], v42 offset:40960
    v_cvt_pk_bf16_f32 v104, v202, v139
    v_mfma_f32_16x16x32_bf16 v[172:175], a[88:91], a[156:159], v[172:175]
    ds_write_b32 v28, v124 offset:14848
    v_cvt_pk_bf16_f32 v105, v171, v203
    v_mfma_f32_16x16x32_bf16 v[172:175], a[108:111], a[164:167], v[172:175]
    ds_write_b64 v26, v[118:119] offset:14856
    v_mul_f32 v140, v140, v64
    v_mfma_f32_16x16x32_bf16 v[172:175], a[208:211], a[44:47], v[172:175]
    ds_read_b128 a[140:143], v43 offset:40960
    v_mul_f32 v141, v141, v65
    v_mfma_f32_16x16x32_bf16 v[172:175], a[176:179], a[64:67], v[172:175]
    ds_write_b64 v26, v[104:105] offset:14864
    v_mul_f32 v142, v142, v66
    v_mfma_f32_16x16x32_bf16 v[172:175], a[204:207], a[96:99], v[172:175]
    ds_write_b64 v29, v[238:239] offset:0
    v_mul_f32 v143, v143, v67
    v_mfma_f32_16x16x32_bf16 v[172:175], a[16:19], a[104:107], v[172:175]
    ds_read_b128 a[168:171], v46 offset:8192
    v_mfma_f32_16x16x32_bf16 v[204:207], a[120:123], a[68:71], v[204:207]
    ds_read_b128 a[196:199], v47 offset:8192
    v_mfma_f32_16x16x32_bf16 v[204:207], a[124:127], a[28:31], v[204:207]
    v_mfma_f32_16x16x32_bf16 v[204:207], a[148:151], a[156:159], v[204:207]
    ds_read_b128 a[172:175], v40 offset:43008
    v_mfma_f32_16x16x32_bf16 v[204:207], a[136:139], a[164:167], v[204:207]
    s_waitcnt lgkmcnt(3)
    s_barrier
    v_mfma_f32_16x16x32_bf16 v[204:207], a[200:203], a[44:47], v[204:207]
    ds_read_b128 v[108:111], v24 offset:14848
    ds_read_b64 v[72:73], v30 offset:0
    v_mfma_f32_16x16x32_bf16 v[204:207], a[252:255], a[64:67], v[204:207]
    ds_read_b128 v[76:79], v24 offset:15776
    v_mul_f32 v172, v172, v96
    v_mfma_f32_16x16x32_bf16 v[204:207], a[180:183], a[96:99], v[204:207]
    ds_read_b128 a[112:115], v41 offset:43008
    v_cvt_pk_bf16_f32 v68, v140, v172
    v_mfma_f32_16x16x32_bf16 v[204:207], a[48:51], a[104:107], v[204:207]
    v_mul_f32 v173, v173, v97
    v_mul_f32 v174, v174, v98
    v_mfma_f32_16x16x32_bf16 v[240:243], a[32:35], a[224:227], v[240:243]
    v_cvt_pk_bf16_f32 v71, v142, v174
    v_mul_f32 v175, v175, v99
    v_mfma_f32_16x16x32_bf16 v[240:243], a[24:27], a[92:95], v[240:243]
    ds_read_b128 a[220:223], v44 offset:10240
    v_mfma_f32_16x16x32_bf16 v[240:243], a[116:119], a[244:247], v[240:243]
    s_waitcnt lgkmcnt(4)
    v_mfma_f32_16x16x32_bf16 v[240:243], a[152:155], a[132:135], v[240:243]
    buffer_store_dwordx4 v[108:111], v25, s[16:19], s68 offen sc1
    v_mfma_f32_16x16x32_bf16 v[144:147], a[84:87], a[224:227], v[144:147]
    s_waitcnt lgkmcnt(3)
    v_add_f32 v236, v236, v72
    v_mul_f32 v236, v236, v52
    v_mfma_f32_16x16x32_bf16 v[144:147], a[0:3], a[92:95], v[144:147]
    v_add_f32 v237, v237, v73
    v_mul_f32 v237, v237, v53
    v_mfma_f32_16x16x32_bf16 v[144:147], a[20:23], a[72:75], v[144:147]
    s_waitcnt lgkmcnt(2)
    ds_read_b128 a[248:251], v45 offset:10240
    v_mfma_f32_16x16x32_bf16 v[144:147], a[56:59], a[140:143], v[144:147]
    buffer_store_dwordx4 v[76:79], v25, s[16:19], s69 offen sc1
    v_mfma_f32_16x16x32_bf16 v[144:147], a[160:163], a[244:247], v[144:147]
    v_cvt_pk_bf16_f32 v72, v236, v237
    v_mul_f32 v204, v204, v100
    v_mfma_f32_16x16x32_bf16 v[144:147], a[80:83], a[132:135], v[144:147]
    ds_write_b32 v28, v72 offset:0
    v_mul_f32 v205, v205, v101
    v_mfma_f32_16x16x32_bf16 v[144:147], a[144:147], a[168:171], v[144:147]
    v_mul_f32 v206, v206, v102
    v_mul_f32 v207, v207, v103
    v_mfma_f32_16x16x32_bf16 v[144:147], a[192:195], a[196:199], v[144:147]
    v_cvt_pk_bf16_f32 v69, v204, v141
    v_cvt_pk_bf16_f32 v70, v173, v205
    v_mfma_f32_16x16x32_bf16 v[176:179], a[8:11], a[224:227], v[176:179]
    ds_write_b64 v26, v[68:69] offset:0
    v_cvt_pk_bf16_f32 v80, v206, v143
    v_mfma_f32_16x16x32_bf16 v[176:179], a[128:131], a[92:95], v[176:179]
    ds_read_b128 a[216:219], v42 offset:43008
    v_cvt_pk_bf16_f32 v81, v175, v207
    v_mfma_f32_16x16x32_bf16 v[176:179], a[88:91], a[72:75], v[176:179]
    ds_write_b64 v26, v[70:71] offset:8
    v_mfma_f32_16x16x32_bf16 v[176:179], a[108:111], a[140:143], v[176:179]
    ds_write_b64 v26, v[80:81] offset:16
    v_mul_f32 v144, v144, v64
    v_mfma_f32_16x16x32_bf16 v[176:179], a[208:211], a[244:247], v[176:179]
    ds_read_b128 a[232:235], v43 offset:43008
    v_mul_f32 v145, v145, v65
    v_mfma_f32_16x16x32_bf16 v[176:179], a[176:179], a[132:135], v[176:179]
    ds_write_b64 v29, v[242:243] offset:2048
    v_mul_f32 v146, v146, v66
    v_mfma_f32_16x16x32_bf16 v[176:179], a[204:207], a[168:171], v[176:179]
    ds_read_b128 a[228:231], v46 offset:10240
    v_mul_f32 v147, v147, v67
    v_mfma_f32_16x16x32_bf16 v[176:179], a[16:19], a[196:199], v[176:179]
    ds_read_b128 a[240:243], v47 offset:10240
    v_mfma_f32_16x16x32_bf16 v[208:211], a[120:123], a[224:227], v[208:211]
    v_mfma_f32_16x16x32_bf16 v[208:211], a[124:127], a[92:95], v[208:211]
    v_mfma_f32_16x16x32_bf16 v[208:211], a[148:151], a[72:75], v[208:211]
    s_waitcnt lgkmcnt(2)
    s_barrier
    v_mfma_f32_16x16x32_bf16 v[208:211], a[136:139], a[140:143], v[208:211]
    ds_read_b128 v[92:95], v24 offset:0
    ds_read_b64 v[88:89], v30 offset:2048
    v_mfma_f32_16x16x32_bf16 v[208:211], a[200:203], a[244:247], v[208:211]
    ds_read_b128 v[112:115], v24 offset:928
    v_mul_f32 v176, v176, v96
    v_mfma_f32_16x16x32_bf16 v[208:211], a[252:255], a[132:135], v[208:211]
    ds_read_b128 a[4:7], v40 offset:45056
    v_cvt_pk_bf16_f32 v84, v144, v176
    v_mfma_f32_16x16x32_bf16 v[208:211], a[180:183], a[168:171], v[208:211]
    ds_read_b128 a[188:191], v41 offset:45056
    v_mul_f32 v177, v177, v97
    v_mfma_f32_16x16x32_bf16 v[208:211], a[48:51], a[196:199], v[208:211]
    v_mul_f32 v178, v178, v98
    v_cvt_pk_bf16_f32 v87, v146, v178
    v_mfma_f32_16x16x32_bf16 v[244:247], a[32:35], a[172:175], v[244:247]
    v_mul_f32 v179, v179, v99
    v_mfma_f32_16x16x32_bf16 v[244:247], a[24:27], a[112:115], v[244:247]
    s_waitcnt lgkmcnt(4)
    ds_read_b128 a[76:79], v44 offset:12288
    v_mfma_f32_16x16x32_bf16 v[244:247], a[116:119], a[220:223], v[244:247]
    buffer_store_dwordx4 v[92:95], v25, s[16:19], s70 offen sc1
    v_mfma_f32_16x16x32_bf16 v[244:247], a[152:155], a[248:251], v[244:247]
    s_waitcnt lgkmcnt(4)
    v_add_f32 v240, v240, v88
    v_mul_f32 v240, v240, v52
    v_mfma_f32_16x16x32_bf16 v[148:151], a[84:87], a[172:175], v[148:151]
    v_add_f32 v241, v241, v89
    v_mul_f32 v241, v241, v53
    v_mfma_f32_16x16x32_bf16 v[148:151], a[0:3], a[112:115], v[148:151]
    s_waitcnt lgkmcnt(3)
    ds_read_b128 a[236:239], v45 offset:12288
    v_mfma_f32_16x16x32_bf16 v[148:151], a[20:23], a[216:219], v[148:151]
    buffer_store_dwordx4 v[112:115], v25, s[16:19], s71 offen sc1
    v_mfma_f32_16x16x32_bf16 v[148:151], a[56:59], a[232:235], v[148:151]
    v_cvt_pk_bf16_f32 v88, v240, v241
    v_mul_f32 v208, v208, v100
    v_mfma_f32_16x16x32_bf16 v[148:151], a[160:163], a[220:223], v[148:151]
    ds_write_b32 v28, v88 offset:7424
    v_mul_f32 v209, v209, v101
    v_mfma_f32_16x16x32_bf16 v[148:151], a[80:83], a[248:251], v[148:151]
    v_mul_f32 v210, v210, v102
    v_mul_f32 v211, v211, v103
    v_mfma_f32_16x16x32_bf16 v[148:151], a[144:147], a[228:231], v[148:151]
    v_cvt_pk_bf16_f32 v85, v208, v145
    v_cvt_pk_bf16_f32 v86, v177, v209
    v_mfma_f32_16x16x32_bf16 v[148:151], a[192:195], a[240:243], v[148:151]
    ds_write_b64 v26, v[84:85] offset:7424
    v_cvt_pk_bf16_f32 v120, v210, v147
    v_mfma_f32_16x16x32_bf16 v[180:183], a[8:11], a[172:175], v[180:183]
    ds_write_b64 v26, v[86:87] offset:7432
    v_cvt_pk_bf16_f32 v121, v179, v211
    v_mfma_f32_16x16x32_bf16 v[180:183], a[128:131], a[112:115], v[180:183]
    ds_read_b128 a[184:187], v42 offset:45056
    v_mfma_f32_16x16x32_bf16 v[180:183], a[88:91], a[216:219], v[180:183]
    ds_write_b64 v26, v[120:121] offset:7440
    v_mfma_f32_16x16x32_bf16 v[180:183], a[108:111], a[232:235], v[180:183]
    ds_write_b64 v29, v[246:247] offset:4096
    v_mul_f32 v148, v148, v64
    v_mfma_f32_16x16x32_bf16 v[180:183], a[208:211], a[220:223], v[180:183]
    ds_read_b128 a[212:215], v43 offset:45056
    v_mul_f32 v149, v149, v65
    v_mfma_f32_16x16x32_bf16 v[180:183], a[176:179], a[248:251], v[180:183]
    ds_read_b128 a[12:15], v46 offset:12288
    v_mul_f32 v150, v150, v66
    v_mfma_f32_16x16x32_bf16 v[180:183], a[204:207], a[228:231], v[180:183]
    ds_read_b128 a[60:63], v47 offset:12288
    v_mul_f32 v151, v151, v67
    v_mfma_f32_16x16x32_bf16 v[180:183], a[16:19], a[240:243], v[180:183]
    v_mfma_f32_16x16x32_bf16 v[212:215], a[120:123], a[172:175], v[212:215]
    s_waitcnt lgkmcnt(3)
    s_barrier
    v_mfma_f32_16x16x32_bf16 v[212:215], a[124:127], a[112:115], v[212:215]
    ds_read_b128 v[48:51], v24 offset:7424
    ds_read_b64 v[124:125], v30 offset:4096
    v_mfma_f32_16x16x32_bf16 v[212:215], a[148:151], a[216:219], v[212:215]
    ds_read_b128 v[116:119], v24 offset:8352
    v_mfma_f32_16x16x32_bf16 v[212:215], a[136:139], a[232:235], v[212:215]
    ds_read_b128 a[40:43], v40 offset:47104
    v_mul_f32 v180, v180, v96
    v_mfma_f32_16x16x32_bf16 v[212:215], a[200:203], a[220:223], v[212:215]
    v_cvt_pk_bf16_f32 v104, v148, v180
    v_mul_f32 v181, v181, v97
    v_mfma_f32_16x16x32_bf16 v[212:215], a[252:255], a[248:251], v[212:215]
    ds_read_b128 a[100:103], v41 offset:47104
    v_mul_f32 v182, v182, v98
    v_mfma_f32_16x16x32_bf16 v[212:215], a[180:183], a[228:231], v[212:215]
    v_cvt_pk_bf16_f32 v107, v150, v182
    v_mul_f32 v183, v183, v99
    v_mfma_f32_16x16x32_bf16 v[212:215], a[48:51], a[240:243], v[212:215]
    s_waitcnt lgkmcnt(4)
    v_mfma_f32_16x16x32_bf16 v[248:251], a[32:35], a[4:7], v[248:251]
    buffer_store_dwordx4 v[48:51], v25, s[16:19], s73 offen sc1
    v_mfma_f32_16x16x32_bf16 v[248:251], a[24:27], a[188:191], v[248:251]
    s_waitcnt lgkmcnt(3)
    v_add_f32 v244, v244, v124
    v_mul_f32 v244, v244, v52
    v_mfma_f32_16x16x32_bf16 v[248:251], a[116:119], a[76:79], v[248:251]
    v_add_f32 v245, v245, v125
    v_mul_f32 v245, v245, v53
    v_mfma_f32_16x16x32_bf16 v[248:251], a[152:155], a[236:239], v[248:251]
    s_waitcnt lgkmcnt(2)
    ds_read_b128 a[36:39], v44 offset:14336
    v_mfma_f32_16x16x32_bf16 v[152:155], a[84:87], a[4:7], v[152:155]
    buffer_store_dwordx4 v[116:119], v25, s[16:19], s74 offen sc1
    v_mfma_f32_16x16x32_bf16 v[152:155], a[0:3], a[188:191], v[152:155]
    v_cvt_pk_bf16_f32 v124, v244, v245
    v_mul_f32 v212, v212, v100
    v_mfma_f32_16x16x32_bf16 v[152:155], a[20:23], a[184:187], v[152:155]
    ds_write_b32 v28, v124 offset:14848
    v_mul_f32 v213, v213, v101
    v_mfma_f32_16x16x32_bf16 v[152:155], a[56:59], a[212:215], v[152:155]
    v_mul_f32 v214, v214, v102
    v_mul_f32 v215, v215, v103
    v_mfma_f32_16x16x32_bf16 v[152:155], a[160:163], a[76:79], v[152:155]
    v_cvt_pk_bf16_f32 v105, v212, v149
    v_cvt_pk_bf16_f32 v106, v181, v213
    v_mfma_f32_16x16x32_bf16 v[152:155], a[80:83], a[236:239], v[152:155]
    ds_read_b128 a[52:55], v45 offset:14336
    v_cvt_pk_bf16_f32 v108, v214, v151
    v_mfma_f32_16x16x32_bf16 v[152:155], a[144:147], a[12:15], v[152:155]
    ds_write_b64 v26, v[104:105] offset:14848
    v_cvt_pk_bf16_f32 v109, v183, v215
    v_mfma_f32_16x16x32_bf16 v[152:155], a[192:195], a[60:63], v[152:155]
    ds_write_b64 v26, v[106:107] offset:14856
    v_mfma_f32_16x16x32_bf16 v[184:187], a[8:11], a[4:7], v[184:187]
    ds_write_b64 v26, v[108:109] offset:14864
    v_mfma_f32_16x16x32_bf16 v[184:187], a[128:131], a[188:191], v[184:187]
    ds_read_b128 a[68:71], v42 offset:47104
    v_mfma_f32_16x16x32_bf16 v[184:187], a[88:91], a[184:187], v[184:187]
    ds_write_b64 v29, v[250:251] offset:0
    v_mfma_f32_16x16x32_bf16 v[184:187], a[108:111], a[212:215], v[184:187]
    ds_read_b128 a[28:31], v43 offset:47104
    v_mul_f32 v152, v152, v64
    v_mfma_f32_16x16x32_bf16 v[184:187], a[208:211], a[76:79], v[184:187]
    ds_read_b128 a[156:159], v46 offset:14336
    v_mul_f32 v153, v153, v65
    v_mfma_f32_16x16x32_bf16 v[184:187], a[176:179], a[236:239], v[184:187]
    v_mul_f32 v154, v154, v66
    v_mul_f32 v155, v155, v67
    v_mfma_f32_16x16x32_bf16 v[184:187], a[204:207], a[12:15], v[184:187]
    ds_read_b128 a[164:167], v47 offset:14336
    v_mfma_f32_16x16x32_bf16 v[184:187], a[16:19], a[60:63], v[184:187]
    s_waitcnt lgkmcnt(3)
    s_barrier
    v_mfma_f32_16x16x32_bf16 v[216:219], a[120:123], a[4:7], v[216:219]
    ds_read_b128 v[76:79], v24 offset:14848
    ds_read_b64 v[72:73], v30 offset:0
    v_mfma_f32_16x16x32_bf16 v[216:219], a[124:127], a[188:191], v[216:219]
    ds_read_b128 v[68:71], v24 offset:15776
    v_mfma_f32_16x16x32_bf16 v[216:219], a[148:151], a[184:187], v[216:219]
    v_mfma_f32_16x16x32_bf16 v[216:219], a[136:139], a[212:215], v[216:219]
    v_mul_f32 v184, v184, v96
    v_cvt_pk_bf16_f32 v80, v152, v184
    v_mfma_f32_16x16x32_bf16 v[216:219], a[200:203], a[76:79], v[216:219]
    v_mul_f32 v185, v185, v97
    v_mul_f32 v186, v186, v98
    v_mfma_f32_16x16x32_bf16 v[216:219], a[252:255], a[236:239], v[216:219]
    v_cvt_pk_bf16_f32 v83, v154, v186
    v_mul_f32 v187, v187, v99
    v_mfma_f32_16x16x32_bf16 v[216:219], a[180:183], a[12:15], v[216:219]
    s_waitcnt lgkmcnt(2)
    v_mfma_f32_16x16x32_bf16 v[216:219], a[48:51], a[60:63], v[216:219]
    buffer_store_dwordx4 v[76:79], v25, s[16:19], s75 offen sc1
    v_mfma_f32_16x16x32_bf16 v[252:255], a[32:35], a[40:43], v[252:255]
    s_waitcnt lgkmcnt(1)
    v_add_f32 v248, v248, v72
    v_mul_f32 v248, v248, v52
    v_mfma_f32_16x16x32_bf16 v[252:255], a[24:27], a[100:103], v[252:255]
    v_add_f32 v249, v249, v73
    v_mul_f32 v249, v249, v53
    v_mfma_f32_16x16x32_bf16 v[252:255], a[116:119], a[36:39], v[252:255]
    s_waitcnt lgkmcnt(0)
    v_cvt_pk_bf16_f32 v72, v248, v249
    v_mfma_f32_16x16x32_bf16 v[252:255], a[152:155], a[52:55], v[252:255]
    buffer_store_dwordx4 v[68:71], v25, s[16:19], s58 offen sc1
    v_mfma_f32_16x16x32_bf16 v[156:159], a[84:87], a[40:43], v[156:159]
    ds_write_b32 v28, v72 offset:0
    v_mul_f32 v216, v216, v100
    v_mfma_f32_16x16x32_bf16 v[156:159], a[0:3], a[100:103], v[156:159]
    v_mul_f32 v217, v217, v101
    v_mul_f32 v218, v218, v102
    v_mfma_f32_16x16x32_bf16 v[156:159], a[20:23], a[68:71], v[156:159]
    v_mul_f32 v219, v219, v103
    v_cvt_pk_bf16_f32 v81, v216, v153
    v_mfma_f32_16x16x32_bf16 v[156:159], a[56:59], a[28:31], v[156:159]
    ds_write_b64 v26, v[80:81] offset:0
    v_cvt_pk_bf16_f32 v82, v185, v217
    v_mfma_f32_16x16x32_bf16 v[156:159], a[160:163], a[36:39], v[156:159]
    ds_write_b64 v26, v[82:83] offset:8
    v_cvt_pk_bf16_f32 v92, v218, v155
    v_mfma_f32_16x16x32_bf16 v[156:159], a[80:83], a[52:55], v[156:159]
    ds_write_b64 v29, v[254:255] offset:2048
    v_cvt_pk_bf16_f32 v93, v187, v219
    v_mfma_f32_16x16x32_bf16 v[156:159], a[144:147], a[156:159], v[156:159]
    s_waitcnt vmcnt(12)
    ds_write_b64 v26, v[92:93] offset:16
    v_xor_b32 v8, 15, v8
    v_mfma_f32_16x16x32_bf16 v[156:159], a[192:195], a[164:167], v[156:159]
    v_or_b32 v8, v8, v0
    v_min_u32 v8, 1, v8
    v_mfma_f32_16x16x32_bf16 v[188:191], a[8:11], a[40:43], v[188:191]
    v_lshlrev_b32 v8, 30, v8
    v_mov_b32 v9, s76
    v_mfma_f32_16x16x32_bf16 v[188:191], a[128:131], a[100:103], v[188:191]
    v_mfma_f32_16x16x32_bf16 v[188:191], a[88:91], a[68:71], v[188:191]
    buffer_store_dword v9, v8, s[12:15], s78 offen sc1
    v_mfma_f32_16x16x32_bf16 v[188:191], a[108:111], a[28:31], v[188:191]
    s_waitcnt lgkmcnt(0)
    s_barrier
    v_mfma_f32_16x16x32_bf16 v[188:191], a[208:211], a[36:39], v[188:191]
    ds_read_b128 v[112:115], v24 offset:0
    ds_read_b64 v[88:89], v30 offset:2048
    v_mfma_f32_16x16x32_bf16 v[188:191], a[176:179], a[52:55], v[188:191]
    ds_read_b128 v[84:87], v24 offset:928
    v_mul_f32 v156, v156, v64
    v_mfma_f32_16x16x32_bf16 v[188:191], a[204:207], a[156:159], v[188:191]
    v_mul_f32 v157, v157, v65
    v_mul_f32 v158, v158, v66
    v_mfma_f32_16x16x32_bf16 v[188:191], a[16:19], a[164:167], v[188:191]
    v_mul_f32 v159, v159, v67
    v_mfma_f32_16x16x32_bf16 v[220:223], a[120:123], a[40:43], v[220:223]
    v_mfma_f32_16x16x32_bf16 v[220:223], a[124:127], a[100:103], v[220:223]
    v_mfma_f32_16x16x32_bf16 v[220:223], a[148:151], a[68:71], v[220:223]
    s_waitcnt lgkmcnt(2)
    v_mfma_f32_16x16x32_bf16 v[220:223], a[136:139], a[28:31], v[220:223]
    buffer_store_dwordx4 v[112:115], v25, s[16:19], s48 offen sc1
L_pad5:
    s_cbranch_execz L_warmed
    v_mfma_f32_16x16x32_bf16 v[220:223], a[200:203], a[36:39], v[220:223]
    s_waitcnt lgkmcnt(1)
    v_add_f32 v252, v252, v88
    v_mul_f32 v252, v252, v52
    v_mfma_f32_16x16x32_bf16 v[220:223], a[252:255], a[52:55], v[220:223]
    v_add_f32 v253, v253, v89
    v_mul_f32 v253, v253, v53
    v_mfma_f32_16x16x32_bf16 v[220:223], a[180:183], a[156:159], v[220:223]
    s_waitcnt lgkmcnt(0)
    v_cvt_pk_bf16_f32 v88, v252, v253
    v_mfma_f32_16x16x32_bf16 v[220:223], a[48:51], a[164:167], v[220:223]
    buffer_store_dwordx4 v[84:87], v25, s[16:19], s49 offen sc1
    ds_write_b32 v28, v88 offset:7424
    v_mul_f32 v188, v188, v96
    v_cvt_pk_bf16_f32 v120, v156, v188
    v_mul_f32 v189, v189, v97
    v_mul_f32 v190, v190, v98
    v_cvt_pk_bf16_f32 v123, v158, v190
    v_mul_f32 v191, v191, v99
    v_mul_f32 v220, v220, v100
    v_mul_f32 v221, v221, v101
    v_mul_f32 v222, v222, v102
    v_mul_f32 v223, v223, v103
    v_cvt_pk_bf16_f32 v121, v220, v157
    v_cvt_pk_bf16_f32 v122, v189, v221
    v_cvt_pk_bf16_f32 v48, v222, v159
    v_cvt_pk_bf16_f32 v49, v191, v223
    ds_write_b64 v26, v[120:121] offset:7424
    ds_write_b64 v26, v[122:123] offset:7432
    ds_write_b64 v26, v[48:49] offset:7440
    s_waitcnt lgkmcnt(0)
    s_barrier
    ds_read_b128 v[116:119], v24 offset:7424
    ds_read_b128 v[124:127], v24 offset:8352
    s_waitcnt lgkmcnt(1)
    buffer_store_dwordx4 v[116:119], v25, s[16:19], s50 offen sc1
    s_waitcnt lgkmcnt(0)
    buffer_store_dwordx4 v[124:127], v25, s[16:19], s51 offen sc1
L_end:
    s_endpgm
L_slow1_0:
    s_mov_b32 s22, 1
    s_call_b64 s[20:21], L_tick
    s_mov_b32 s22, 20480
    s_mov_b32 s23, 25600
    buffer_load_dwordx4 v[84:87], v32, s[12:15], s22 offen sc1
    buffer_load_dwordx4 v[88:91], v32, s[12:15], s23 offen sc1
    s_waitcnt vmcnt(0)
    v_bitop3_b32 v87, v87, v91, s76 bitop3:0x7e
    v_cmp_ne_u32 vcc, 0, v87
    s_cbranch_vccnz L_slow1_0
    s_branch L_back1_0
L_slow1_2:
    s_mov_b32 s22, 1
    s_call_b64 s[20:21], L_tick
    s_mov_b32 s22, 20480
    s_mov_b32 s23, 25600
    buffer_load_dwordx2 v[92:93], v34, s[12:15], s22 offen sc1
    buffer_load_dwordx2 v[94:95], v34, s[12:15], s23 offen sc1
    s_waitcnt vmcnt(0)
    v_bitop3_b32 v93, v93, v95, s76 bitop3:0x7e
    v_cmp_ne_u32 vcc, 0, v93
    s_cbranch_vccnz L_slow1_2
    s_branch L_back1_2
L_slow1_1:
    s_mov_b32 s22, 1
    s_call_b64 s[20:21], L_tick
    s_mov_b32 s22, 20480
    s_mov_b32 s23, 25600
    buffer_load_dwordx4 v[96:99], v33, s[12:15], s22 offen sc1
    buffer_load_dwordx4 v[100:103], v33, s[12:15], s23 offen sc1
    s_waitcnt vmcnt(0)
    v_bitop3_b32 v99, v99, v103, s76 bitop3:0x7e
    v_cmp_ne_u32 vcc, 0, v99
    s_cbranch_vccnz L_slow1_1
    s_branch L_back1_1
L_slow2_0:
    s_mov_b32 s22, 2
    s_call_b64 s[20:21], L_tick
    s_mov_b32 s22, 40960
    s_mov_b32 s23, 46080
    buffer_load_dwordx4 v[68:71], v32, s[12:15], s22 offen sc1
    buffer_load_dwordx4 v[72:75], v32, s[12:15], s23 offen sc1
    s_waitcnt vmcnt(0)
    v_bitop3_b32 v71, v71, v75, s76 bitop3:0x7e
    v_cmp_ne_u32 vcc, 0, v71
    s_cbranch_vccnz L_slow2_0
    s_branch L_back2_0
L_slow2_2:
    s_mov_b32 s22, 2
    s_call_b64 s[20:21], L_tick
    s_mov_b32 s22, 40960
    s_mov_b32 s23, 46080
    buffer_load_dwordx2 v[76:77], v34, s[12:15], s22 offen sc1
    buffer_load_dwordx2 v[78:79], v34, s[12:15], s23 offen sc1
    s_waitcnt vmcnt(0)
    v_bitop3_b32 v77, v77, v79, s76 bitop3:0x7e
    v_cmp_ne_u32 vcc, 0, v77
    s_cbranch_vccnz L_slow2_2
    s_branch L_back2_2
L_slow2_1:
    s_mov_b32 s22, 2
    s_call_b64 s[20:21], L_tick
    s_mov_b32 s22, 40960
    s_mov_b32 s23, 46080
    buffer_load_dwordx4 v[80:83], v33, s[12:15], s22 offen sc1
    buffer_load_dwordx4 v[84:87], v33, s[12:15], s23 offen sc1
    s_waitcnt vmcnt(0)
    v_bitop3_b32 v83, v83, v87, s76 bitop3:0x7e
    v_cmp_ne_u32 vcc, 0, v83
    s_cbranch_vccnz L_slow2_1
    s_branch L_back2_1
L_slow3_0:
    s_mov_b32 s22, 3
    s_call_b64 s[20:21], L_tick
    s_mov_b32 s22, 61440
    s_mov_b32 s23, 66560
    buffer_load_dwordx4 v[88:91], v32, s[12:15], s22 offen sc1
    buffer_load_dwordx4 v[92:95], v32, s[12:15], s23 offen sc1
    s_waitcnt vmcnt(0)
    v_bitop3_b32 v91, v91, v95, s76 bitop3:0x7e
    v_cmp_ne_u32 vcc, 0, v91
    s_cbranch_vccnz L_slow3_0
    s_branch L_back3_0
L_slow3_2:
    s_mov_b32 s22, 3
    s_call_b64 s[20:21], L_tick
    s_mov_b32 s22, 61440
    s_mov_b32 s23, 66560
    buffer_load_dwordx2 v[104:105], v34, s[12:15], s22 offen sc1
    buffer_load_dwordx2 v[106:107], v34, s[12:15], s23 offen sc1
    s_waitcnt vmcnt(0)
    v_bitop3_b32 v105, v105, v107, s76 bitop3:0x7e
    v_cmp_ne_u32 vcc, 0, v105
    s_cbranch_vccnz L_slow3_2
    s_branch L_back3_2
L_slow3_1:
    s_mov_b32 s22, 3
    s_call_b64 s[20:21], L_tick
    s_mov_b32 s22, 61440
    s_mov_b32 s23, 66560
    buffer_load_dwordx4 v[108:111], v33, s[12:15], s22 offen sc1
    buffer_load_dwordx4 v[112:115], v33, s[12:15], s23 offen sc1
    s_waitcnt vmcnt(0)
    v_bitop3_b32 v111, v111, v115, s76 bitop3:0x7e
    v_cmp_ne_u32 vcc, 0, v111
    s_cbranch_vccnz L_slow3_1
    s_branch L_back3_1
L_slow4_0:
    s_mov_b32 s22, 4
    s_call_b64 s[20:21], L_tick
    s_mov_b32 s22, 81920
    s_mov_b32 s23, 87040
    buffer_load_dwordx4 v[116:119], v32, s[12:15], s22 offen sc1
    buffer_load_dwordx4 v[120:123], v32, s[12:15], s23 offen sc1
    s_waitcnt vmcnt(0)
    v_bitop3_b32 v119, v119, v123, s76 bitop3:0x7e
    v_cmp_ne_u32 vcc, 0, v119
    s_cbranch_vccnz L_slow4_0
    s_branch L_back4_0
L_slow4_2:
    s_mov_b32 s22, 4
    s_call_b64 s[20:21], L_tick
    s_mov_b32 s22, 81920
    s_mov_b32 s23, 87040
    buffer_load_dwordx2 v[124:125], v34, s[12:15], s22 offen sc1
    buffer_load_dwordx2 v[126:127], v34, s[12:15], s23 offen sc1
    s_waitcnt vmcnt(0)
    v_bitop3_b32 v125, v125, v127, s76 bitop3:0x7e
    v_cmp_ne_u32 vcc, 0, v125
    s_cbranch_vccnz L_slow4_2
    s_branch L_back4_2
L_slow4_1:
    s_mov_b32 s22, 4
    s_call_b64 s[20:21], L_tick
    s_mov_b32 s22, 81920
    s_mov_b32 s23, 87040
    buffer_load_dwordx4 v[48:51], v33, s[12:15], s22 offen sc1
    buffer_load_dwordx4 v[52:55], v33, s[12:15], s23 offen sc1
    s_waitcnt vmcnt(0)
    v_bitop3_b32 v51, v51, v55, s76 bitop3:0x7e
    v_cmp_ne_u32 vcc, 0, v51
    s_cbranch_vccnz L_slow4_1
    s_branch L_back4_1
L_slow5_0:
    s_mov_b32 s22, 5
    s_call_b64 s[20:21], L_tick
    s_mov_b32 s22, 102400
    s_mov_b32 s23, 107520
    buffer_load_dwordx4 v[64:67], v32, s[12:15], s22 offen sc1
    buffer_load_dwordx4 v[96:99], v32, s[12:15], s23 offen sc1
    s_waitcnt vmcnt(0)
    v_bitop3_b32 v67, v67, v99, s76 bitop3:0x7e
    v_cmp_ne_u32 vcc, 0, v67
    s_cbranch_vccnz L_slow5_0
    s_branch L_back5_0
L_slow5_2:
    s_mov_b32 s22, 5
    s_call_b64 s[20:21], L_tick
    s_mov_b32 s22, 102400
    s_mov_b32 s23, 107520
    buffer_load_dwordx2 v[100:101], v34, s[12:15], s22 offen sc1
    buffer_load_dwordx2 v[102:103], v34, s[12:15], s23 offen sc1
    s_waitcnt vmcnt(0)
    v_bitop3_b32 v101, v101, v103, s76 bitop3:0x7e
    v_cmp_ne_u32 vcc, 0, v101
    s_cbranch_vccnz L_slow5_2
    s_branch L_back5_2
L_slow5_1:
    s_mov_b32 s22, 5
    s_call_b64 s[20:21], L_tick
    s_mov_b32 s22, 102400
    s_mov_b32 s23, 107520
    buffer_load_dwordx4 v[68:71], v33, s[12:15], s22 offen sc1
    buffer_load_dwordx4 v[72:75], v33, s[12:15], s23 offen sc1
    s_waitcnt vmcnt(0)
    v_bitop3_b32 v71, v71, v75, s76 bitop3:0x7e
    v_cmp_ne_u32 vcc, 0, v71
    s_cbranch_vccnz L_slow5_1
    s_branch L_back5_1
L_slow6_2:
    s_mov_b32 s22, 6
    s_call_b64 s[20:21], L_tick
    s_mov_b32 s22, 122880
    s_mov_b32 s23, 128000
    buffer_load_dwordx2 v[76:77], v34, s[12:15], s22 offen sc1
    buffer_load_dwordx2 v[78:79], v34, s[12:15], s23 offen sc1
    s_waitcnt vmcnt(0)
    v_bitop3_b32 v77, v77, v79, s76 bitop3:0x7e
    v_cmp_ne_u32 vcc, 0, v77
    s_cbranch_vccnz L_slow6_2
    s_branch L_back6_2
L_slow6_0:
    s_mov_b32 s22, 6
    s_call_b64 s[20:21], L_tick
    s_mov_b32 s22, 122880
    s_mov_b32 s23, 128000
    buffer_load_dwordx4 v[80:83], v32, s[12:15], s22 offen sc1
    buffer_load_dwordx4 v[84:87], v32, s[12:15], s23 offen sc1
    s_waitcnt vmcnt(0)
    v_bitop3_b32 v83, v83, v87, s76 bitop3:0x7e
    v_cmp_ne_u32 vcc, 0, v83
    s_cbranch_vccnz L_slow6_0
    s_branch L_back6_0
L_slow6_1:
    s_mov_b32 s22, 6
    s_call_b64 s[20:21], L_tick
    s_mov_b32 s22, 122880
    s_mov_b32 s23, 128000
    buffer_load_dwordx4 v[88:91], v33, s[12:15], s22 offen sc1
    buffer_load_dwordx4 v[92:95], v33, s[12:15], s23 offen sc1
    s_waitcnt vmcnt(0)
    v_bitop3_b32 v91, v91, v95, s76 bitop3:0x7e
    v_cmp_ne_u32 vcc, 0, v91
    s_cbranch_vccnz L_slow6_1
    s_branch L_back6_1
L_slow7_2:
    s_mov_b32 s22, 7
    s_call_b64 s[20:21], L_tick
    s_mov_b32 s22, 143360
    s_mov_b32 s23, 148480
    buffer_load_dwordx2 v[112:113], v34, s[12:15], s22 offen sc1
    buffer_load_dwordx2 v[114:115], v34, s[12:15], s23 offen sc1
    s_waitcnt vmcnt(0)
    v_bitop3_b32 v113, v113, v115, s76 bitop3:0x7e
    v_cmp_ne_u32 vcc, 0, v113
    s_cbranch_vccnz L_slow7_2
    s_branch L_back7_2
L_slow7_0:
    s_mov_b32 s22, 7
    s_call_b64 s[20:21], L_tick
    s_mov_b32 s22, 143360
    s_mov_b32 s23, 148480
    buffer_load_dwordx4 v[116:119], v32, s[12:15], s22 offen sc1
    buffer_load_dwordx4 v[120:123], v32, s[12:15], s23 offen sc1
    s_waitcnt vmcnt(0)
    v_bitop3_b32 v119, v119, v123, s76 bitop3:0x7e
    v_cmp_ne_u32 vcc, 0, v119
    s_cbranch_vccnz L_slow7_0
    s_branch L_back7_0
L_slow7_1:
    s_mov_b32 s22, 7
    s_call_b64 s[20:21], L_tick
    s_mov_b32 s22, 143360
    s_mov_b32 s23, 148480
    buffer_load_dwordx4 v[124:127], v33, s[12:15], s22 offen sc1
    buffer_load_dwordx4 v[48:51], v33, s[12:15], s23 offen sc1
    s_waitcnt vmcnt(0)
    v_bitop3_b32 v127, v127, v51, s76 bitop3:0x7e
    v_cmp_ne_u32 vcc, 0, v127
    s_cbranch_vccnz L_slow7_1
    s_branch L_back7_1
L_tick:
    s_add_u32 s52, s52, 1
    s_and_b32 s23, s52, 4095
    s_cbranch_scc1 L_tick_ret
L_help:
    s_mov_b32 s53, s61
    s_mov_b32 s54, s62
    s_mov_b32 s72, s6
    s_mov_b32 s6, 14680064
    s_mul_i32 s61, s22, 1835008
    s_add_u32 s61, s61, s79
    s_mul_i32 s62, s22, 20480
    s_mul_i32 s23, s59, 163840
    s_add_u32 s62, s62, s23
    s_mov_b32 s22, 0
L_help_row:
    buffer_load_dwordx4 v[12:15], v19, s[4:7], s61 offen
    buffer_load_dwordx3 v[8:10], v18, s[4:7], s61 offen
    s_waitcnt vmcnt(0)
    v_lshlrev_b32 v12, v5, v12
    v_lshlrev_b32 v13, v5, v13
    v_lshlrev_b32 v14, v5, v14
    v_lshlrev_b32 v15, v5, v15
    v_permlane32_swap_b32 v12, v13
    s_nop 0
    v_permlane32_swap_b32 v14, v15
    v_or_b32 v12, v12, v13
    v_or_b32 v14, v14, v15
    v_mov_b32 v13, s76
    s_nop 0
    v_permlane16_swap_b32 v12, v14
    v_or_b32 v12, v12, v14
    s_nop 1
    v_or_b32_dpp v12, v12, v12 row_ror:8 row_mask:0xf bank_mask:0xf
    buffer_store_dwordx2 v[12:13], v21, s[12:15], s62 offen sc1
    v_mov_b32 v11, s76
    s_mov_b32 s23, 4
L_help_e:
    s_add_u32 s61, s61, 14336
    buffer_load_dwordx3 v[12:14], v18, s[4:7], s61 offen
    s_waitcnt vmcnt(0)
    v_lshl_or_b32 v8, v12, s23, v8
    v_lshl_or_b32 v9, v13, s23, v9
    v_lshl_or_b32 v10, v14, s23, v10
    s_add_u32 s23, s23, 4
    s_cmp_lt_u32 s23, 32
    s_cbranch_scc1 L_help_e
    buffer_store_dwordx4 v[8:11], v20, s[12:15], s62 offen sc1
    s_add_u32 s61, s61, 14336
    s_add_u32 s62, s62, 1280
    s_waitcnt vmcnt(0)
    s_add_u32 s22, s22, 1
    s_cmp_lt_u32 s22, 16
    s_cbranch_scc1 L_help_row
    s_mov_b32 s61, s53
    s_mov_b32 s62, s54
    s_mov_b32 s6, s72
L_tick_ret:
    s_setpc_b64 s[20:21]
L_code_end:

.section .rodata,"a"
.p2align 6
.amdhsa_kernel standalone__normalfloat_lut_af4__prompt_kernel
  .amdhsa_next_free_vgpr 512
  .amdhsa_next_free_sgpr 102
  .amdhsa_accum_offset 256
  .amdhsa_group_segment_fixed_size 0
  .amdhsa_kernarg_size 56
  .amdhsa_user_sgpr_count 2
  .amdhsa_user_sgpr_kernarg_segment_ptr 1
  .amdhsa_system_sgpr_workgroup_id_x 1
.end_amdhsa_kernel
```

```asm
; @launch grid=(256,1,1) block=(256,1,1) lds=163840
.amdgcn_target "amdgcn-amd-amdhsa--gfx950"
.text
.globl standalone__normalfloat_lut_af4__prompt_kernel
.p2align 8
.type standalone__normalfloat_lut_af4__prompt_kernel,@function
standalone__normalfloat_lut_af4__prompt_kernel:
    s_cmp_ge_u32 s2, 256
    s_cbranch_scc1 L_end
    s_load_dwordx2 s[4:5], s[0:1], 8
    s_load_dwordx2 s[12:13], s[0:1], 48
    s_load_dwordx2 s[8:9], s[0:1], 0
    s_load_dwordx2 s[28:29], s[0:1], 16
    s_getpc_b64 s[48:49]
    s_mov_b32 s50, L_code_end-standalone__normalfloat_lut_af4__prompt_kernel-256
    s_mov_b32 s51, 0x20000
    s_lshr_b32 s61, s2, 3
    v_lshl_add_u32 v10, v0, 5, s61
    v_lshlrev_b32 v10, 7, v10
    buffer_load_dword v1, v10, s[48:51], 0 offen offset:256
    v_lshrrev_b32 v5, 6, v0
    v_and_b32 v2, 63, v0
    s_and_b32 s60, s2, 7
    v_readfirstlane_b32 s63, v5
    s_and_b32 s58, s60, 1
    s_lshl_b32 s58, s58, 3
    s_and_b32 s62, s61, 7
    s_add_u32 s58, s58, s62
    s_lshr_b32 s59, s60, 1
    s_lshl_b32 s59, s59, 2
    s_lshr_b32 s62, s61, 3
    s_add_u32 s59, s59, s62
    v_mul_u32_u24 v18, 12, v2
    s_lshl_b32 s60, s63, 4
    s_add_u32 s60, s60, s58
    s_mul_i32 s61, s60, 114688
    s_mul_i32 s79, s59, 896
    s_add_u32 s61, s61, s79
    s_mov_b32 s6, 14680064
    s_mov_b32 s7, 0x20000
    s_lshl_b32 s78, s59, 7
    s_add_u32 s78, s78, 2097152
    v_and_b32 v4, 15, v2
    v_lshrrev_b32 v3, 4, v2
    v_and_b32 v12, 1, v3
    v_lshlrev_b32 v13, 1, v12
    v_xor_b32 v13, v13, v4
    v_lshrrev_b32 v19, 1, v3
    v_lshl_add_u32 v19, v19, 4, v13
    s_bfe_u32 s70, s58, 0x10002
    s_xor_b32 s70, s70, 1
    v_xor_b32 v12, s70, v12
    v_mul_u32_u24 v12, 14336, v12
    v_add_lshl_u32 v19, v19, v12, 2
    v_add_u32 v19, 768, v19
    s_mov_b32 s46, 2
    s_cmp_lg_u32 s63, 0
    s_cbranch_scc1 L_role0
    s_mov_b32 s46, 0
L_role0:
    s_cmp_lg_u32 s63, 1
    s_cbranch_scc1 L_role1
    s_mov_b32 s46, 1
L_role1:
    v_lshlrev_b32 v16, 1, v4
    v_lshrrev_b32 v17, 4, v0
    v_lshlrev_b32 v17, 1, v17
    s_mov_b32 s30, 32
    s_mov_b32 s31, 0x20000
    v_lshrrev_b32 v6, 3, v2
    v_and_b32 v7, 7, v2
    v_xor_b32 v13, v7, v3
    s_lshl_b32 s70, s63, 5
    v_add_lshl_u32 v12, v6, s70, 11
    v_lshl_add_u32 v36, v13, 4, v12
    v_xor_b32 v37, 64, v36
    v_add_u32 v38, 30720, v36
    v_add_u32 v37, 15360, v37
    v_add_u32 v39, 30720, v37
    s_mov_b32 s10, 4194304
    s_mov_b32 s11, 0x20000
    s_lshl_b32 s55, s58, 18
    s_and_b32 s71, s58, 8
    s_lshl_b32 s70, s71, 4
    s_add_u32 s55, s55, s70
    s_xor_b32 s69, s55, 128
    s_lshl_b32 s57, s63, 12
    s_add_u32 s57, s57, 65536
    s_mov_b32 s14, 2099200
    s_mov_b32 s15, 0x20000
    s_lshl_b32 s68, s59, 17
    s_lshl_b32 s62, s60, 10
    s_add_u32 s62, s62, s68
    v_lshlrev_b32 v20, 4, v2
    s_waitcnt lgkmcnt(0)
    s_load_dword s76, s[12:13], s78
    s_cmp_eq_u32 s46, 1
    s_cbranch_scc1 L_L
    s_cmp_eq_u32 s46, 2
    s_cbranch_scc1 L_L
L_X:
    buffer_load_dwordx3 v[128:130], v18, s[4:7], s61 offen
    buffer_load_dword v131, v19, s[4:7], s61 offen
    s_add_u32 s61, s61, 14336
    buffer_load_dwordx3 v[132:134], v18, s[4:7], s61 offen
    buffer_load_dword v135, v19, s[4:7], s61 offen
    s_add_u32 s61, s61, 14336
    buffer_load_dwordx3 v[136:138], v18, s[4:7], s61 offen
    buffer_load_dword v139, v19, s[4:7], s61 offen
    s_add_u32 s61, s61, 14336
    buffer_load_dwordx3 v[140:142], v18, s[4:7], s61 offen
    buffer_load_dword v143, v19, s[4:7], s61 offen
    s_add_u32 s61, s61, 14336
    buffer_load_dwordx3 v[144:146], v18, s[4:7], s61 offen
    s_add_u32 s61, s61, 14336
    buffer_load_dwordx3 v[148:150], v18, s[4:7], s61 offen
    s_add_u32 s61, s61, 14336
    buffer_load_dwordx3 v[152:154], v18, s[4:7], s61 offen
    s_add_u32 s61, s61, 14336
    buffer_load_dwordx3 v[156:158], v18, s[4:7], s61 offen
    s_add_u32 s61, s61, 7239680
    s_cmp_eq_u32 s46, 1
    s_cbranch_scc1 L_D
    s_cmp_eq_u32 s46, 2
    s_cbranch_scc1 L_B
L_L:
    buffer_load_ushort v16, v16, s[28:31], 0 offen
    buffer_load_ushort v17, v17, s[28:31], 0 offen
    s_cmp_eq_u32 s46, 1
    s_cbranch_scc1 L_S
    s_cmp_eq_u32 s46, 2
    s_cbranch_scc1 L_S
L_D:
    s_add_u32 m0, s57, 32768
    s_add_u32 s56, s55, 0
    buffer_load_dwordx4 v36, s[8:11], s56 offen offset:0 lds
    buffer_load_dwordx4 v37, s[8:11], s56 offen offset:1024 lds
    buffer_load_dwordx4 v38, s[8:11], s56 offen offset:2048 lds
    buffer_load_dwordx4 v39, s[8:11], s56 offen offset:3072 lds
L_d:
    s_add_u32 m0, s57, 49152
    s_add_u32 s3, s69, 0
    buffer_load_dwordx4 v36, s[8:11], s3 offen offset:0 lds
    buffer_load_dwordx4 v37, s[8:11], s3 offen offset:1024 lds
    buffer_load_dwordx4 v38, s[8:11], s3 offen offset:2048 lds
    buffer_load_dwordx4 v39, s[8:11], s3 offen offset:3072 lds
    s_cmp_eq_u32 s46, 1
    s_cbranch_scc1 L_G
    s_cmp_eq_u32 s46, 2
    s_cbranch_scc1 L_G
L_S:
    s_load_dwordx2 s[32:33], s[0:1], 24
    s_load_dwordx2 s[16:17], s[0:1], 32
    s_load_dwordx2 s[24:25], s[0:1], 40
    s_and_b32 s64, s63, 1
    s_lshr_b32 s65, s63, 1
    s_and_b32 s70, s58, 8
    s_lshl_b32 s70, s70, 10
    s_lshl_b32 s71, s64, 12
    s_add_u32 s70, s70, s71
    s_lshl_b32 s71, s63, 8
    s_add_u32 s70, s70, s71
    s_add_u32 s70, s70, s68
    v_lshl_add_u32 v32, v4, 4, s70
    v_lshl_add_u32 v32, v3, 10, v32
    v_xor_b32 v33, 4096, v32
    v_xor_b32 v34, 8192, v32
    v_xor_b32 v44, 12288, v32
    s_mov_b32 s36, 202114048
    s_mov_b32 s37, 202114304
    s_mov_b32 s38, 202114560
    s_mov_b32 s39, 202114816
    v_and_b32 v35, 31, v2
    v_lshlrev_b32 v35, 2, v35
    s_lshl_b32 s70, s64, 6
    s_add_u32 s70, s70, 65536
    v_lshrrev_b32 v12, 1, v4
    v_xor_b32 v12, v12, v3
    v_lshlrev_b32 v12, 4, v12
    v_lshl_add_u32 v12, v4, 7, v12
    v_xor_b32 v40, s70, v12
    v_xor_b32 v41, 64, v40
    v_add_u32 v42, 65536, v40
    v_add_u32 v43, 65536, v41
    s_mov_b32 s52, 0
    v_lshlrev_b32 v8, 4, v7
    v_lshl_add_u32 v8, v0, 8, v8
    v_xor_b32 v9, 16, v8
    v_xor_b32 v10, 32, v8
    v_xor_b32 v11, 48, v8
    v_xor_b32 v12, 64, v8
    v_xor_b32 v13, 80, v8
    v_xor_b32 v14, 96, v8
    v_xor_b32 v15, 112, v8
    s_cmp_eq_u32 s46, 1
    s_cbranch_scc1 L_X
    s_cmp_eq_u32 s46, 2
    s_cbranch_scc1 L_D
L_G:
    s_waitcnt lgkmcnt(0)
    s_add_u32 s76, s76, 2654435769
    s_and_b32 s47, s76, 0xffff0000
    s_cmp_eq_u32 s46, 1
    s_cbranch_scc1 L_T
    s_cmp_eq_u32 s46, 2
    s_cbranch_scc1 L_T
L_K:
    s_waitcnt vmcnt(20)
    v_or_b32 v131, s47, v131
    s_waitcnt vmcnt(19)
    v_lshl_or_b32 v128, v132, 4, v128
    v_lshl_or_b32 v129, v133, 4, v129
    v_lshl_or_b32 v130, v134, 4, v130
    s_waitcnt vmcnt(18)
    v_lshl_or_b32 v131, v135, 4, v131
    s_waitcnt vmcnt(17)
    v_lshl_or_b32 v128, v136, 8, v128
    v_lshl_or_b32 v129, v137, 8, v129
    v_lshl_or_b32 v130, v138, 8, v130
    s_waitcnt vmcnt(16)
    v_lshl_or_b32 v131, v139, 8, v131
    s_waitcnt vmcnt(15)
    v_lshl_or_b32 v128, v140, 12, v128
    v_lshl_or_b32 v129, v141, 12, v129
    v_lshl_or_b32 v130, v142, 12, v130
    s_waitcnt vmcnt(14)
    v_lshl_or_b32 v131, v143, 12, v131
    s_waitcnt vmcnt(13)
    v_lshl_or_b32 v128, v144, 16, v128
    v_lshl_or_b32 v129, v145, 16, v129
    v_lshl_or_b32 v130, v146, 16, v130
    s_waitcnt vmcnt(12)
    v_lshl_or_b32 v128, v148, 20, v128
    v_lshl_or_b32 v129, v149, 20, v129
    v_lshl_or_b32 v130, v150, 20, v130
    s_waitcnt vmcnt(11)
    v_lshl_or_b32 v128, v152, 24, v128
    v_lshl_or_b32 v129, v153, 24, v129
    v_lshl_or_b32 v130, v154, 24, v130
    s_waitcnt vmcnt(10)
    v_lshl_or_b32 v128, v156, 28, v128
    v_lshl_or_b32 v129, v157, 28, v129
    v_lshl_or_b32 v130, v158, 28, v130
    buffer_store_dwordx4 v[128:131], v20, s[12:15], s62 offen sc1
    s_add_u32 s62, s62, 65536
    s_cmp_eq_u32 s46, 1
    s_cbranch_scc1 L_B
    s_cmp_eq_u32 s46, 2
    s_cbranch_scc1 L_E
L_T:
    s_waitcnt vmcnt(20)
    s_cmp_eq_u32 s46, 1
    s_cbranch_scc1 L_rw1
    s_waitcnt vmcnt(9)
    s_cmp_eq_u32 s46, 0
    s_cbranch_scc1 L_rw1
    s_waitcnt vmcnt(8)
L_rw1:
    v_lshl_or_b32 v56, v17, 16, v16
    v_lshl_or_b32 v57, v17, 16, v16
    v_lshl_or_b32 v58, v17, 16, v16
    v_lshl_or_b32 v59, v17, 16, v16
    ds_write_b128 v8, v[56:59]
    ds_write_b128 v9, v[56:59]
    ds_write_b128 v10, v[56:59]
    ds_write_b128 v11, v[56:59]
    ds_write_b128 v12, v[56:59]
    ds_write_b128 v13, v[56:59]
    ds_write_b128 v14, v[56:59]
    ds_write_b128 v15, v[56:59]
    s_cmp_lg_u32 s46, 1
    s_cbranch_scc1 L_ed2
    s_waitcnt vmcnt(8)
    s_branch L_K
L_ed2:
    s_cmp_eq_u32 s46, 2
    s_cbranch_scc1 L_X
L_W:
    s_mov_b64 exec, 0
    s_cmp_eq_u32 s63, 0
    s_cbranch_scc1 L_pad0
L_warmed:
    s_mov_b64 exec, -1
L_B:
    s_waitcnt vmcnt(12) lgkmcnt(0)
    s_cmp_eq_u32 s46, 2
    s_cbranch_scc1 L_rw3
    s_waitcnt vmcnt(1)
L_rw3:
    s_barrier
L_Q:
    ds_read_b128 a[0:3], v40 offset:32768
    ds_read_b128 a[4:7], v41 offset:32768
    ds_read_b128 a[8:11], v40 offset:34816
    ds_read_b128 a[12:15], v41 offset:34816
    ds_read_b128 a[16:19], v40 offset:36864
    ds_read_b128 a[20:23], v41 offset:36864
    ds_read_b128 a[24:27], v40 offset:38912
    ds_read_b128 a[28:31], v41 offset:38912
    ds_read_b128 a[32:35], v40 offset:40960
    ds_read_b128 a[36:39], v41 offset:40960
    ds_read_b128 a[40:43], v40 offset:43008
    ds_read_b128 a[44:47], v41 offset:43008
    ds_read_b128 a[48:51], v40 offset:45056
    ds_read_b128 a[52:55], v41 offset:45056
    ds_read_b128 a[56:59], v40 offset:47104
    ds_read_b128 a[60:63], v41 offset:47104
L_P:
    buffer_load_dwordx4 v[64:67], v32, s[12:15], 0 offen sc1
    buffer_load_dwordx4 v[68:71], v33, s[12:15], 0 offen sc1
L_p:
    buffer_load_dwordx4 v[72:75], v34, s[12:15], 0 offen sc1
    buffer_load_dwordx4 v[76:79], v44, s[12:15], 0 offen sc1
    s_cmp_lg_u32 s46, 2
    s_cbranch_scc1 L_ed4
    s_waitcnt vmcnt(4)
    s_branch L_K
L_ed4:
L_E:
    s_add_u32 m0, s57, 65536
    s_add_u32 s56, s55, 256
    buffer_load_dwordx4 v36, s[8:11], s56 offen offset:0 lds
    buffer_load_dwordx4 v37, s[8:11], s56 offen offset:1024 lds
    buffer_load_dwordx4 v38, s[8:11], s56 offen offset:2048 lds
    buffer_load_dwordx4 v39, s[8:11], s56 offen offset:3072 lds
L_chk0:
    s_waitcnt vmcnt(7)
    s_cmp_eq_u32 s46, 2
    s_cbranch_scc1 L_rw5
    s_waitcnt vmcnt(6)
L_rw5:
    v_bitop3_b32 v12, v67, v71, s76 bitop3:0x7e
    v_cmp_lt_u32 vcc, 0xffff, v12
    s_cbranch_vccnz L_retry0
    v_perm_b32 v56, v64, v35, s36
    v_perm_b32 v57, v64, v35, s37
    v_perm_b32 v58, v64, v35, s38
    v_perm_b32 v59, v64, v35, s39
    v_perm_b32 v60, v68, v35, s36
    v_perm_b32 v61, v68, v35, s37
    v_perm_b32 v62, v68, v35, s38
    v_perm_b32 v63, v68, v35, s39
    ds_read_b32 a136, v56
    ds_read_b32 a137, v57
    ds_read_b32 a138, v58
    ds_read_b32 a139, v59
    ds_read_b32 a140, v60
    ds_read_b32 a141, v61
    ds_read_b32 a142, v62
    ds_read_b32 a143, v63
    v_perm_b32 v56, v65, v35, s36
    v_perm_b32 v57, v65, v35, s37
    v_perm_b32 v58, v65, v35, s38
    v_perm_b32 v59, v65, v35, s39
    v_perm_b32 v60, v69, v35, s36
    v_perm_b32 v61, v69, v35, s37
    ds_read_b32 a144, v56
    ds_read_b32 a145, v57
    ds_read_b32 a146, v58
    ds_read_b32 a147, v59
    s_waitcnt vmcnt(5)
    s_cmp_eq_u32 s46, 2
    s_cbranch_scc1 L_rw6
    s_waitcnt vmcnt(4)
L_rw6:
    v_bitop3_b32 v12, v75, v79, s76 bitop3:0x7e
    v_cmp_lt_u32 vcc, 0xffff, v12
    s_cbranch_vccz L_main
L_retry0:
    s_add_u32 s52, s52, 1
    s_and_b32 s23, s52, 4095
    s_cbranch_scc1 L_retry0b
    s_mov_b32 s22, 0
    s_call_b64 s[20:21], L_help
L_retry0b:
    buffer_load_dwordx4 v[64:67], v32, s[12:15], 0 offen sc1
    buffer_load_dwordx4 v[68:71], v33, s[12:15], 0 offen sc1
    buffer_load_dwordx4 v[72:75], v34, s[12:15], 0 offen sc1
    buffer_load_dwordx4 v[76:79], v44, s[12:15], 0 offen sc1
    s_waitcnt vmcnt(0) lgkmcnt(0)
    s_branch L_chk0
.p2align 12
L_main:
L_pad0:
    s_cbranch_execz L_pad1
    s_waitcnt lgkmcnt(8)
    v_mfma_f32_16x16x32_bf16 v[128:131], a[136:139], a[0:3], 0
    s_waitcnt lgkmcnt(4)
    s_mov_b32 s40, 16384
    ds_read_b32 a148, v60
    v_mfma_f32_16x16x32_bf16 v[128:131], a[140:143], a[4:7], v[128:131]
    buffer_load_dwordx4 v[80:83], v32, s[12:15], s40 offen sc1
    v_mfma_f32_16x16x32_bf16 v[132:135], a[136:139], a[8:11], 0
    s_add_u32 m0, s57, 81920
    ds_read_b32 a149, v61
    v_perm_b32 v62, v69, v35, s38
    v_mfma_f32_16x16x32_bf16 v[132:135], a[140:143], a[12:15], v[132:135]
    s_add_u32 s3, s69, 256
    ds_read_b32 a150, v62
    v_perm_b32 v63, v69, v35, s39
    v_mfma_f32_16x16x32_bf16 v[136:139], a[136:139], a[16:19], 0
    s_add_u32 s56, s55, 512
    ds_read_b128 a[64:67], v40 offset:49152
    ds_read_b32 a151, v63
    v_mfma_f32_16x16x32_bf16 v[136:139], a[140:143], a[20:23], v[136:139]
    buffer_load_dwordx4 v[84:87], v33, s[12:15], s40 offen sc1
    v_mfma_f32_16x16x32_bf16 v[140:143], a[136:139], a[24:27], 0
    ds_read_b128 a[68:71], v41 offset:49152
    v_perm_b32 v56, v66, v35, s36
    v_mfma_f32_16x16x32_bf16 v[140:143], a[140:143], a[28:31], v[140:143]
    ds_read_b32 a152, v56
    v_perm_b32 v57, v66, v35, s37
    v_mfma_f32_16x16x32_bf16 v[144:147], a[136:139], a[32:35], 0
    ds_read_b32 a153, v57
    ds_read_b128 a[72:75], v40 offset:51200
    v_mfma_f32_16x16x32_bf16 v[144:147], a[140:143], a[36:39], v[144:147]
    buffer_load_dwordx4 v[88:91], v34, s[12:15], s40 offen sc1
    v_mfma_f32_16x16x32_bf16 v[148:151], a[136:139], a[40:43], 0
    v_perm_b32 v58, v66, v35, s38
    v_perm_b32 v59, v66, v35, s39
    v_mfma_f32_16x16x32_bf16 v[148:151], a[140:143], a[44:47], v[148:151]
    ds_read_b32 a154, v58
    v_perm_b32 v60, v70, v35, s36
    v_mfma_f32_16x16x32_bf16 v[152:155], a[136:139], a[48:51], 0
    s_mov_b32 s41, 32768
    ds_read_b32 a155, v59
    ds_read_b32 a156, v60
    v_mfma_f32_16x16x32_bf16 v[152:155], a[140:143], a[52:55], v[152:155]
    buffer_load_dwordx4 v[92:95], v44, s[12:15], s40 offen sc1
    v_mfma_f32_16x16x32_bf16 v[156:159], a[136:139], a[56:59], 0
    ds_read_b128 a[76:79], v41 offset:51200
    v_perm_b32 v61, v70, v35, s37
    v_mfma_f32_16x16x32_bf16 v[156:159], a[140:143], a[60:63], v[156:159]
    s_waitcnt lgkmcnt(7)
    ds_read_b32 a157, v61
    v_perm_b32 v62, v70, v35, s38
    v_mfma_f32_16x16x32_bf16 v[160:163], a[144:147], a[0:3], 0
    ds_read_b128 a[80:83], v40 offset:53248
    ds_read_b32 a158, v62
    v_mfma_f32_16x16x32_bf16 v[160:163], a[148:151], a[4:7], v[160:163]
    buffer_load_dwordx4 v36, s[8:11], s3 offen offset:0 lds
    v_mfma_f32_16x16x32_bf16 v[164:167], a[144:147], a[8:11], 0
    ds_read_b128 a[84:87], v41 offset:53248
    v_perm_b32 v63, v70, v35, s39
    v_mfma_f32_16x16x32_bf16 v[164:167], a[148:151], a[12:15], v[164:167]
    ds_read_b32 a159, v63
    v_perm_b32 v56, v67, v35, s36
    v_mfma_f32_16x16x32_bf16 v[168:171], a[144:147], a[16:19], 0
    ds_read_b32 a160, v56
    ds_read_b128 a[88:91], v40 offset:55296
    v_mfma_f32_16x16x32_bf16 v[168:171], a[148:151], a[20:23], v[168:171]
    buffer_load_dwordx4 v37, s[8:11], s3 offen offset:1024 lds
    v_mfma_f32_16x16x32_bf16 v[172:175], a[144:147], a[24:27], 0
    ds_read_b128 a[92:95], v41 offset:55296
    v_perm_b32 v57, v67, v35, s37
    v_mfma_f32_16x16x32_bf16 v[172:175], a[148:151], a[28:31], v[172:175]
    v_perm_b32 v58, v71, v35, s36
    v_perm_b32 v59, v71, v35, s37
    v_mfma_f32_16x16x32_bf16 v[176:179], a[144:147], a[32:35], 0
    s_mov_b32 s42, 49152
    ds_read_b32 a161, v57
    ds_read_b32 a162, v58
    v_mfma_f32_16x16x32_bf16 v[176:179], a[148:151], a[36:39], v[176:179]
    buffer_load_dwordx4 v38, s[8:11], s3 offen offset:2048 lds
    v_mfma_f32_16x16x32_bf16 v[180:183], a[144:147], a[40:43], 0
    ds_read_b32 a163, v59
    ds_read_b128 a[96:99], v40 offset:57344
    v_mfma_f32_16x16x32_bf16 v[180:183], a[148:151], a[44:47], v[180:183]
    v_perm_b32 v60, v75, v35, s36
    v_perm_b32 v61, v75, v35, s37
    v_mfma_f32_16x16x32_bf16 v[184:187], a[144:147], a[48:51], 0
    s_waitcnt lgkmcnt(7)
    ds_read_b32 a164, v60
    ds_read_b32 a165, v61
    v_mfma_f32_16x16x32_bf16 v[184:187], a[148:151], a[52:55], v[184:187]
    buffer_load_dwordx4 v39, s[8:11], s3 offen offset:3072 lds
    v_mfma_f32_16x16x32_bf16 v[188:191], a[144:147], a[56:59], 0
    s_add_u32 m0, s57, 0
    ds_read_b128 a[100:103], v41 offset:57344
    v_perm_b32 v62, v79, v35, s36
    v_mfma_f32_16x16x32_bf16 v[188:191], a[148:151], a[60:63], v[188:191]
    s_add_u32 s3, s69, 512
    ds_read_b32 a166, v62
    v_perm_b32 v63, v79, v35, s37
    v_mfma_f32_16x16x32_bf16 v[192:195], a[152:155], a[0:3], 0
    ds_read_b32 a167, v63
    ds_read_b128 a[104:107], v40 offset:59392
    v_mfma_f32_16x16x32_bf16 v[192:195], a[156:159], a[4:7], v[192:195]
    buffer_load_dwordx3 v[96:98], v18, s[4:7], s61 offen
    v_mfma_f32_16x16x32_bf16 v[196:199], a[152:155], a[8:11], 0
    ds_read_b128 a[108:111], v41 offset:59392
    v_perm_b32 v56, v72, v35, s36
    v_mfma_f32_16x16x32_bf16 v[196:199], a[156:159], a[12:15], v[196:199]
    v_perm_b32 v57, v72, v35, s37
    v_perm_b32 v58, v72, v35, s38
    v_mfma_f32_16x16x32_bf16 v[200:203], a[152:155], a[16:19], 0
    s_mov_b32 s43, 65536
    ds_read_b32 a168, v56
    ds_read_b32 a169, v57
    v_mfma_f32_16x16x32_bf16 v[200:203], a[156:159], a[20:23], v[200:203]
    buffer_load_dword v99, v19, s[4:7], s61 offen
    v_mfma_f32_16x16x32_bf16 v[204:207], a[152:155], a[24:27], 0
    s_add_u32 s61, s61, 14336
    ds_read_b32 a170, v58
    ds_read_b128 a[112:115], v40 offset:61440
    v_mfma_f32_16x16x32_bf16 v[204:207], a[156:159], a[28:31], v[204:207]
    v_perm_b32 v59, v72, v35, s39
    v_perm_b32 v60, v76, v35, s36
    v_mfma_f32_16x16x32_bf16 v[208:211], a[152:155], a[32:35], 0
    ds_read_b32 a171, v59
    ds_read_b32 a172, v60
    v_mfma_f32_16x16x32_bf16 v[208:211], a[156:159], a[36:39], v[208:211]
    buffer_load_dwordx3 v[100:102], v18, s[4:7], s61 offen
    v_mfma_f32_16x16x32_bf16 v[212:215], a[152:155], a[40:43], 0
    ds_read_b128 a[116:119], v41 offset:61440
    v_perm_b32 v61, v76, v35, s37
    v_mfma_f32_16x16x32_bf16 v[212:215], a[156:159], a[44:47], v[212:215]
    ds_read_b32 a173, v61
    v_perm_b32 v62, v76, v35, s38
    v_mfma_f32_16x16x32_bf16 v[216:219], a[152:155], a[48:51], 0
    ds_read_b32 a174, v62
    ds_read_b128 a[120:123], v40 offset:63488
    v_mfma_f32_16x16x32_bf16 v[216:219], a[156:159], a[52:55], v[216:219]
    buffer_load_dword v103, v19, s[4:7], s61 offen
    v_mfma_f32_16x16x32_bf16 v[220:223], a[152:155], a[56:59], 0
    s_add_u32 s61, s61, 14336
    ds_read_b128 a[124:127], v41 offset:63488
    v_perm_b32 v63, v76, v35, s39
    v_mfma_f32_16x16x32_bf16 v[220:223], a[156:159], a[60:63], v[220:223]
    s_waitcnt lgkmcnt(7)
    v_perm_b32 v56, v73, v35, s36
    v_perm_b32 v57, v73, v35, s37
    v_mfma_f32_16x16x32_bf16 v[224:227], a[160:163], a[2:5], 0
    s_mov_b32 s44, 81920
    ds_read_b32 a175, v63
    ds_read_b32 a176, v56
    v_mfma_f32_16x16x32_bf16 v[224:227], a[164:167], a[66:69], v[224:227]
    buffer_load_dwordx3 v[104:106], v18, s[4:7], s61 offen
    v_mfma_f32_16x16x32_bf16 v[228:231], a[160:163], a[10:13], 0
    ds_read_b32 a177, v57
    v_perm_b32 v58, v73, v35, s38
    v_mfma_f32_16x16x32_bf16 v[228:231], a[164:167], a[74:77], v[228:231]
    v_perm_b32 v59, v73, v35, s39
    v_perm_b32 v60, v77, v35, s36
    v_mfma_f32_16x16x32_bf16 v[232:235], a[160:163], a[18:21], 0
    ds_read_b32 a178, v58
    ds_read_b32 a179, v59
    v_mfma_f32_16x16x32_bf16 v[232:235], a[164:167], a[82:85], v[232:235]
    buffer_load_dword v107, v19, s[4:7], s61 offen
    v_mfma_f32_16x16x32_bf16 v[236:239], a[160:163], a[26:29], 0
    s_add_u32 s61, s61, 14336
    ds_read_b32 a180, v60
    v_perm_b32 v61, v77, v35, s37
    v_mfma_f32_16x16x32_bf16 v[236:239], a[164:167], a[90:93], v[236:239]
    v_perm_b32 v62, v77, v35, s38
    v_perm_b32 v63, v77, v35, s39
    v_mfma_f32_16x16x32_bf16 v[240:243], a[160:163], a[34:37], 0
    ds_read_b32 a181, v61
    ds_read_b32 a182, v62
    v_mfma_f32_16x16x32_bf16 v[240:243], a[164:167], a[98:101], v[240:243]
    buffer_load_dwordx3 v[108:110], v18, s[4:7], s61 offen
    v_mfma_f32_16x16x32_bf16 v[244:247], a[160:163], a[42:45], 0
    s_waitcnt vmcnt(13)
    ds_read_b32 a183, v63
    v_bitop3_b32 v56, v83, v87, s76 bitop3:0x7e
    v_mfma_f32_16x16x32_bf16 v[244:247], a[164:167], a[106:109], v[244:247]
    v_cmp_lt_u32 vcc, 0xffff, v56
    v_perm_b32 v57, v74, v35, s36
    v_mfma_f32_16x16x32_bf16 v[248:251], a[160:163], a[50:53], 0
    s_waitcnt lgkmcnt(6)
    s_mov_b32 s45, 98304
    ds_read_b32 a184, v57
    v_mfma_f32_16x16x32_bf16 v[248:251], a[164:167], a[114:117], v[248:251]
    buffer_load_dword v111, v19, s[4:7], s61 offen
    v_mfma_f32_16x16x32_bf16 v[252:255], a[160:163], a[58:61], 0
    s_add_u32 s61, s61, 14336
    v_perm_b32 v58, v74, v35, s37
    v_perm_b32 v59, v74, v35, s38
    v_mfma_f32_16x16x32_bf16 v[252:255], a[164:167], a[122:125], v[252:255]
    v_perm_b32 v60, v74, v35, s39
    s_cbranch_vccnz L_slow1_0
L_back1_0:
    v_mfma_f32_16x16x32_bf16 v[128:131], a[168:171], a[64:67], v[128:131]
    ds_read_b32 a185, v58
    ds_read_b32 a186, v59
    v_mfma_f32_16x16x32_bf16 v[128:131], a[172:175], a[68:71], v[128:131]
    buffer_load_dwordx3 v[112:114], v18, s[4:7], s61 offen
    v_mfma_f32_16x16x32_bf16 v[132:135], a[168:171], a[72:75], v[132:135]
    s_barrier
    v_mfma_f32_16x16x32_bf16 v[132:135], a[172:175], a[76:79], v[132:135]
    s_add_u32 s61, s61, 14336
    ds_read_b32 a187, v60
    ds_read_b128 a[128:131], v42 offset:0
    v_mfma_f32_16x16x32_bf16 v[136:139], a[168:171], a[80:83], v[136:139]
    ds_read_b128 a[132:135], v43 offset:0
    v_mfma_f32_16x16x32_bf16 v[136:139], a[172:175], a[84:87], v[136:139]
    buffer_load_dwordx3 v[116:118], v18, s[4:7], s61 offen
    v_mfma_f32_16x16x32_bf16 v[140:143], a[168:171], a[88:91], v[140:143]
    s_add_u32 s61, s61, 14336
    v_perm_b32 v61, v78, v35, s36
    v_perm_b32 v62, v78, v35, s37
    v_mfma_f32_16x16x32_bf16 v[140:143], a[172:175], a[92:95], v[140:143]
    ds_read_b32 a188, v61
    v_perm_b32 v63, v78, v35, s38
    v_mfma_f32_16x16x32_bf16 v[144:147], a[168:171], a[96:99], v[144:147]
    s_mov_b32 s72, 114688
    ds_read_b32 a189, v62
    ds_read_b32 a190, v63
    v_mfma_f32_16x16x32_bf16 v[144:147], a[172:175], a[100:103], v[144:147]
    buffer_load_dwordx3 v[120:122], v18, s[4:7], s61 offen
    v_mfma_f32_16x16x32_bf16 v[148:151], a[168:171], a[104:107], v[148:151]
    s_add_u32 s61, s61, 14336
    ds_read_b128 a[0:3], v42 offset:2048
    v_perm_b32 v56, v78, v35, s39
    v_mfma_f32_16x16x32_bf16 v[148:151], a[172:175], a[108:111], v[148:151]
    ds_read_b32 a191, v56
    v_perm_b32 v57, v80, v35, s36
    v_mfma_f32_16x16x32_bf16 v[152:155], a[168:171], a[112:115], v[152:155]
    ds_read_b32 a192, v57
    ds_read_b128 a[4:7], v43 offset:2048
    v_mfma_f32_16x16x32_bf16 v[152:155], a[172:175], a[116:119], v[152:155]
    buffer_load_dwordx3 v[124:126], v18, s[4:7], s61 offen
    v_mfma_f32_16x16x32_bf16 v[156:159], a[168:171], a[120:123], v[156:159]
    ds_read_b128 a[8:11], v42 offset:4096
    v_perm_b32 v58, v80, v35, s37
    v_mfma_f32_16x16x32_bf16 v[156:159], a[172:175], a[124:127], v[156:159]
    s_waitcnt lgkmcnt(8)
    ds_read_b32 a193, v58
    v_perm_b32 v59, v80, v35, s38
    v_mfma_f32_16x16x32_bf16 v[160:163], a[176:179], a[64:67], v[160:163]
    ds_read_b32 a194, v59
    ds_read_b128 a[12:15], v43 offset:4096
    v_mfma_f32_16x16x32_bf16 v[160:163], a[180:183], a[68:71], v[160:163]
    buffer_load_dwordx4 v[48:51], v32, s[12:15], s41 offen sc1
    v_mfma_f32_16x16x32_bf16 v[164:167], a[176:179], a[72:75], v[164:167]
    v_perm_b32 v60, v80, v35, s39
    v_perm_b32 v61, v84, v35, s36
    v_mfma_f32_16x16x32_bf16 v[164:167], a[180:183], a[76:79], v[164:167]
    ds_read_b32 a195, v60
    v_perm_b32 v62, v84, v35, s37
    v_mfma_f32_16x16x32_bf16 v[168:171], a[176:179], a[80:83], v[168:171]
    ds_read_b32 a196, v61
    ds_read_b32 a197, v62
    v_mfma_f32_16x16x32_bf16 v[168:171], a[180:183], a[84:87], v[168:171]
    buffer_load_dwordx4 v[52:55], v33, s[12:15], s41 offen sc1
    v_mfma_f32_16x16x32_bf16 v[172:175], a[176:179], a[88:91], v[172:175]
    ds_read_b128 a[16:19], v42 offset:6144
    v_perm_b32 v63, v84, v35, s38
    v_mfma_f32_16x16x32_bf16 v[172:175], a[180:183], a[92:95], v[172:175]
    ds_read_b32 a198, v63
    v_perm_b32 v56, v84, v35, s39
    v_mfma_f32_16x16x32_bf16 v[176:179], a[176:179], a[96:99], v[176:179]
    ds_read_b32 a199, v56
    ds_read_b128 a[20:23], v43 offset:6144
    v_mfma_f32_16x16x32_bf16 v[176:179], a[180:183], a[100:103], v[176:179]
    buffer_load_dwordx4 v36, s[8:11], s56 offen offset:0 lds
    v_mfma_f32_16x16x32_bf16 v[180:183], a[176:179], a[104:107], v[180:183]
    ds_read_b128 a[24:27], v42 offset:8192
    v_perm_b32 v57, v81, v35, s36
    v_mfma_f32_16x16x32_bf16 v[180:183], a[180:183], a[108:111], v[180:183]
    ds_read_b32 a200, v57
    v_perm_b32 v58, v81, v35, s37
    v_mfma_f32_16x16x32_bf16 v[184:187], a[176:179], a[112:115], v[184:187]
    ds_read_b32 a201, v58
    ds_read_b128 a[28:31], v43 offset:8192
    v_mfma_f32_16x16x32_bf16 v[184:187], a[180:183], a[116:119], v[184:187]
    buffer_load_dwordx4 v37, s[8:11], s56 offen offset:1024 lds
    v_mfma_f32_16x16x32_bf16 v[188:191], a[176:179], a[120:123], v[188:191]
    v_perm_b32 v59, v81, v35, s38
    v_perm_b32 v60, v81, v35, s39
    v_mfma_f32_16x16x32_bf16 v[188:191], a[180:183], a[124:127], v[188:191]
    ds_read_b32 a202, v59
    ds_read_b32 a203, v60
    v_mfma_f32_16x16x32_bf16 v[192:195], a[184:187], a[64:67], v[192:195]
    s_waitcnt lgkmcnt(8)
    ds_read_b128 a[32:35], v42 offset:10240
    v_perm_b32 v61, v85, v35, s36
    v_mfma_f32_16x16x32_bf16 v[192:195], a[188:191], a[68:71], v[192:195]
    ds_read_b32 a204, v61
    v_perm_b32 v62, v85, v35, s37
    v_mfma_f32_16x16x32_bf16 v[196:199], a[184:187], a[72:75], v[196:199]
    ds_read_b32 a205, v62
    v_perm_b32 v63, v85, v35, s38
    v_mfma_f32_16x16x32_bf16 v[196:199], a[188:191], a[76:79], v[196:199]
    ds_read_b32 a206, v63
    ds_read_b128 a[36:39], v43 offset:10240
    v_mfma_f32_16x16x32_bf16 v[200:203], a[184:187], a[80:83], v[200:203]
    buffer_load_dwordx4 v38, s[8:11], s56 offen offset:2048 lds
    v_mfma_f32_16x16x32_bf16 v[200:203], a[188:191], a[84:87], v[200:203]
    ds_read_b128 a[40:43], v42 offset:12288
    v_perm_b32 v56, v85, v35, s39
    v_mfma_f32_16x16x32_bf16 v[204:207], a[184:187], a[88:91], v[204:207]
    s_waitcnt vmcnt(21)
    ds_read_b32 a207, v56
    v_bitop3_b32 v57, v91, v95, s76 bitop3:0x7e
    v_mfma_f32_16x16x32_bf16 v[204:207], a[188:191], a[92:95], v[204:207]
    v_cmp_lt_u32 vcc, 0xffff, v57
    v_perm_b32 v58, v82, v35, s36
    v_mfma_f32_16x16x32_bf16 v[208:211], a[184:187], a[96:99], v[208:211]
    ds_read_b32 a208, v58
    ds_read_b128 a[44:47], v43 offset:12288
    v_mfma_f32_16x16x32_bf16 v[208:211], a[188:191], a[100:103], v[208:211]
    v_perm_b32 v59, v82, v35, s37
    s_cbranch_vccnz L_slow1_1
L_back1_1:
    v_mfma_f32_16x16x32_bf16 v[212:215], a[184:187], a[104:107], v[212:215]
    ds_read_b32 a209, v59
    v_mfma_f32_16x16x32_bf16 v[212:215], a[188:191], a[108:111], v[212:215]
    buffer_load_dwordx4 v39, s[8:11], s56 offen offset:3072 lds
    v_mfma_f32_16x16x32_bf16 v[216:219], a[184:187], a[112:115], v[216:219]
    s_add_u32 m0, s57, 16384
    ds_read_b128 a[48:51], v42 offset:14336
    v_perm_b32 v60, v82, v35, s38
    v_mfma_f32_16x16x32_bf16 v[216:219], a[188:191], a[116:119], v[216:219]
    s_add_u32 s56, s55, 768
    ds_read_b32 a210, v60
    v_perm_b32 v61, v82, v35, s39
    v_mfma_f32_16x16x32_bf16 v[220:223], a[184:187], a[120:123], v[220:223]
    ds_read_b32 a211, v61
    v_perm_b32 v62, v86, v35, s36
    v_mfma_f32_16x16x32_bf16 v[220:223], a[188:191], a[124:127], v[220:223]
    s_waitcnt lgkmcnt(6)
    ds_read_b32 a212, v62
    ds_read_b128 a[52:55], v43 offset:14336
    v_mfma_f32_16x16x32_bf16 v[128:131], a[192:195], a[128:131], v[128:131]
    buffer_load_dwordx4 v[64:67], v34, s[12:15], s41 offen sc1
    v_mfma_f32_16x16x32_bf16 v[128:131], a[196:199], a[132:135], v[128:131]
    v_perm_b32 v63, v86, v35, s37
    v_perm_b32 v56, v86, v35, s38
    v_mfma_f32_16x16x32_bf16 v[132:135], a[192:195], a[0:3], v[132:135]
    ds_read_b32 a213, v63
    ds_read_b32 a214, v56
    v_mfma_f32_16x16x32_bf16 v[132:135], a[196:199], a[4:7], v[132:135]
    v_perm_b32 v57, v86, v35, s39
    v_perm_b32 v58, v83, v35, s36
    v_mfma_f32_16x16x32_bf16 v[136:139], a[192:195], a[8:11], v[136:139]
    ds_read_b32 a215, v57
    ds_read_b32 a216, v58
    v_mfma_f32_16x16x32_bf16 v[136:139], a[196:199], a[12:15], v[136:139]
    buffer_load_dwordx4 v[68:71], v44, s[12:15], s41 offen sc1
    v_mfma_f32_16x16x32_bf16 v[140:143], a[192:195], a[16:19], v[140:143]
    v_perm_b32 v59, v83, v35, s37
    v_perm_b32 v60, v87, v35, s36
    v_mfma_f32_16x16x32_bf16 v[140:143], a[196:199], a[20:23], v[140:143]
    ds_read_b32 a217, v59
    ds_read_b32 a218, v60
    v_mfma_f32_16x16x32_bf16 v[144:147], a[192:195], a[24:27], v[144:147]
    v_perm_b32 v61, v87, v35, s37
    v_perm_b32 v62, v88, v35, s36
    v_mfma_f32_16x16x32_bf16 v[144:147], a[196:199], a[28:31], v[144:147]
    ds_read_b32 a219, v61
    ds_read_b32 a220, v62
    v_mfma_f32_16x16x32_bf16 v[148:151], a[192:195], a[32:35], v[148:151]
    v_perm_b32 v63, v88, v35, s37
    v_perm_b32 v56, v88, v35, s38
    v_mfma_f32_16x16x32_bf16 v[148:151], a[196:199], a[36:39], v[148:151]
    s_waitcnt lgkmcnt(6)
    ds_read_b32 a221, v63
    ds_read_b32 a222, v56
    v_mfma_f32_16x16x32_bf16 v[152:155], a[192:195], a[40:43], v[152:155]
    buffer_load_dwordx4 v36, s[8:11], s3 offen offset:0 lds
    v_mfma_f32_16x16x32_bf16 v[152:155], a[196:199], a[44:47], v[152:155]
    v_perm_b32 v57, v88, v35, s39
    v_perm_b32 v58, v92, v35, s36
    v_mfma_f32_16x16x32_bf16 v[156:159], a[192:195], a[48:51], v[156:159]
    ds_read_b32 a223, v57
    ds_read_b32 a224, v58
    v_mfma_f32_16x16x32_bf16 v[156:159], a[196:199], a[52:55], v[156:159]
    v_perm_b32 v59, v92, v35, s37
    v_perm_b32 v60, v92, v35, s38
    v_mfma_f32_16x16x32_bf16 v[160:163], a[200:203], a[128:131], v[160:163]
    ds_read_b32 a225, v59
    ds_read_b32 a226, v60
    v_mfma_f32_16x16x32_bf16 v[160:163], a[204:207], a[132:135], v[160:163]
    v_perm_b32 v61, v92, v35, s39
    v_perm_b32 v62, v89, v35, s36
    v_mfma_f32_16x16x32_bf16 v[164:167], a[200:203], a[0:3], v[164:167]
    s_waitcnt vmcnt(21)
    ds_read_b32 a227, v61
    ds_read_b32 a228, v62
    v_mfma_f32_16x16x32_bf16 v[164:167], a[204:207], a[4:7], v[164:167]
    buffer_load_dwordx4 v37, s[8:11], s3 offen offset:1024 lds
    v_mfma_f32_16x16x32_bf16 v[168:171], a[200:203], a[8:11], v[168:171]
    s_barrier
    v_mfma_f32_16x16x32_bf16 v[168:171], a[204:207], a[12:15], v[168:171]
    ds_read_b128 a[56:59], v42 offset:16384
    v_perm_b32 v63, v89, v35, s37
    v_mfma_f32_16x16x32_bf16 v[172:175], a[200:203], a[16:19], v[172:175]
    ds_read_b32 a229, v63
    v_perm_b32 v56, v89, v35, s38
    v_mfma_f32_16x16x32_bf16 v[172:175], a[204:207], a[20:23], v[172:175]
    ds_read_b32 a230, v56
    ds_read_b128 a[60:63], v43 offset:16384
    v_mfma_f32_16x16x32_bf16 v[176:179], a[200:203], a[24:27], v[176:179]
    v_perm_b32 v57, v89, v35, s39
    v_perm_b32 v58, v93, v35, s36
    v_mfma_f32_16x16x32_bf16 v[176:179], a[204:207], a[28:31], v[176:179]
    ds_read_b32 a231, v57
    v_perm_b32 v59, v93, v35, s37
    v_mfma_f32_16x16x32_bf16 v[180:183], a[200:203], a[32:35], v[180:183]
    ds_read_b32 a232, v58
    ds_read_b32 a233, v59
    v_mfma_f32_16x16x32_bf16 v[180:183], a[204:207], a[36:39], v[180:183]
    buffer_load_dwordx4 v38, s[8:11], s3 offen offset:2048 lds
    v_mfma_f32_16x16x32_bf16 v[184:187], a[200:203], a[40:43], v[184:187]
    ds_read_b128 a[64:67], v42 offset:18432
    v_perm_b32 v60, v93, v35, s38
    v_mfma_f32_16x16x32_bf16 v[184:187], a[204:207], a[44:47], v[184:187]
    ds_read_b32 a234, v60
    ds_read_b128 a[68:71], v43 offset:18432
    v_mfma_f32_16x16x32_bf16 v[188:191], a[200:203], a[48:51], v[188:191]
    ds_read_b128 a[72:75], v42 offset:20480
    v_perm_b32 v61, v93, v35, s39
    v_mfma_f32_16x16x32_bf16 v[188:191], a[204:207], a[52:55], v[188:191]
    ds_read_b32 a235, v61
    ds_read_b128 a[76:79], v43 offset:20480
    v_mfma_f32_16x16x32_bf16 v[192:195], a[208:211], a[128:131], v[192:195]
    s_waitcnt lgkmcnt(9)
    v_perm_b32 v62, v90, v35, s36
    v_perm_b32 v63, v90, v35, s37
    v_mfma_f32_16x16x32_bf16 v[192:195], a[212:215], a[132:135], v[192:195]
    s_waitcnt vmcnt(19)
    ds_read_b32 a236, v62
    ds_read_b32 a237, v63
    v_mfma_f32_16x16x32_bf16 v[196:199], a[208:211], a[0:3], v[196:199]
    buffer_load_dwordx4 v39, s[8:11], s3 offen offset:3072 lds
    v_mfma_f32_16x16x32_bf16 v[196:199], a[212:215], a[4:7], v[196:199]
    v_or_b32 v99, s47, v99
    v_lshl_or_b32 v96, v100, 4, v96
    v_lshl_or_b32 v97, v101, 4, v97
    v_lshl_or_b32 v98, v102, 4, v98
    v_lshl_or_b32 v99, v103, 4, v99
    s_waitcnt vmcnt(19)
    v_lshl_or_b32 v96, v104, 8, v96
    v_lshl_or_b32 v97, v105, 8, v97
    v_lshl_or_b32 v98, v106, 8, v98
    s_waitcnt vmcnt(18)
    v_lshl_or_b32 v99, v107, 8, v99
    s_waitcnt vmcnt(17)
    v_lshl_or_b32 v96, v108, 12, v96
    v_lshl_or_b32 v97, v109, 12, v97
    v_lshl_or_b32 v98, v110, 12, v98
    s_waitcnt vmcnt(16)
    v_lshl_or_b32 v99, v111, 12, v99
    s_waitcnt vmcnt(15)
    v_lshl_or_b32 v96, v112, 16, v96
    v_lshl_or_b32 v97, v113, 16, v97
    v_lshl_or_b32 v98, v114, 16, v98
    s_waitcnt vmcnt(14)
    v_lshl_or_b32 v96, v116, 20, v96
    v_lshl_or_b32 v97, v117, 20, v97
    v_lshl_or_b32 v98, v118, 20, v98
    s_waitcnt vmcnt(13)
    v_lshl_or_b32 v96, v120, 24, v96
    v_lshl_or_b32 v97, v121, 24, v97
    v_lshl_or_b32 v98, v122, 24, v98
    s_waitcnt vmcnt(12)
    v_lshl_or_b32 v96, v124, 28, v96
    v_lshl_or_b32 v97, v125, 28, v97
    v_lshl_or_b32 v98, v126, 28, v98
    buffer_store_dwordx4 v[96:99], v20, s[12:15], s62 offen sc1
    s_mul_i32 s66, s63, 96
    s_lshl_b32 s67, s65, 5
    s_lshl_b32 s70, s64, 2
    s_add_u32 s67, s67, s70
    s_add_u32 s67, s67, 384
    s_mul_i32 s71, s59, 448
    s_add_u32 s70, s66, s71
    v_mad_u32_u24 v22, v3, 24, s70
    s_add_u32 s70, s67, s71
    v_lshl_add_u32 v23, v3, 3, s70
    s_mov_b32 s34, 7168
    s_mov_b32 s35, 0x20000
    s_mov_b32 s26, 256
    s_mov_b32 s27, 0x20000
    s_lshl_b32 s77, s59, 4
    s_mov_b32 s18, 14680064
    s_mov_b32 s19, 0x20000
    s_sub_u32 s70, 65536, s71
    v_mul_u32_u24 v16, 464, v4
    v_add3_u32 v26, v22, v16, s70
    v_add3_u32 v28, v23, v16, s70
    v_lshlrev_b32 v29, 3, v0
    v_xor_b32 v30, 512, v29
    v_add_u32 v29, 87808, v29
    v_add_u32 v30, 87808, v30
    v_mul_u32_u24 v16, 2341, v2
    v_lshrrev_b32 v16, 16, v16
    s_mul_i32 s73, s63, 1856
    s_add_u32 s73, s73, 65536
    v_add_lshl_u32 v24, v2, v16, 4
    v_add_u32 v24, s73, v24
    s_lshl_b32 s74, s58, 7
    s_lshl_b32 s75, s63, 2
    s_add_u32 s74, s74, s75
    s_mul_i32 s74, s74, 7168
    s_add_u32 s74, s74, s71
    v_mul_u32_u24 v17, 6720, v16
    v_lshl_add_u32 v25, v2, 4, v17
    v_lshrrev_b32 v16, 1, v16
    v_lshlrev_b32 v16, 30, v16
    v_add3_u32 v25, v25, v16, s74
    v_mfma_f32_16x16x32_bf16 v[200:203], a[208:211], a[8:11], v[200:203]
    s_add_u32 m0, s57, 32768
    ds_read_b128 a[80:83], v42 offset:22528
    v_perm_b32 v56, v90, v35, s38
    v_mfma_f32_16x16x32_bf16 v[200:203], a[212:215], a[12:15], v[200:203]
    s_add_u32 s3, s69, 768
    ds_read_b32 a238, v56
    v_perm_b32 v57, v90, v35, s39
    v_mfma_f32_16x16x32_bf16 v[204:207], a[208:211], a[16:19], v[204:207]
    ds_read_b32 a239, v57
    ds_read_b128 a[84:87], v43 offset:22528
    v_mfma_f32_16x16x32_bf16 v[204:207], a[212:215], a[20:23], v[204:207]
    buffer_load_dwordx4 v[72:75], v32, s[12:15], s42 offen sc1
    v_mfma_f32_16x16x32_bf16 v[208:211], a[208:211], a[24:27], v[208:211]
    ds_read_b128 a[88:91], v42 offset:24576
    v_perm_b32 v58, v94, v35, s36
    v_mfma_f32_16x16x32_bf16 v[208:211], a[212:215], a[28:31], v[208:211]
    ds_read_b32 a240, v58
    ds_read_b128 a[92:95], v43 offset:24576
L_pad1:
    s_cbranch_execz L_pad2
    v_mfma_f32_16x16x32_bf16 v[212:215], a[208:211], a[32:35], v[212:215]
    ds_read_b128 a[96:99], v42 offset:26624
    v_perm_b32 v59, v94, v35, s37
    v_mfma_f32_16x16x32_bf16 v[212:215], a[212:215], a[36:39], v[212:215]
    ds_read_b32 a241, v59
    ds_read_b128 a[100:103], v43 offset:26624
    v_mfma_f32_16x16x32_bf16 v[216:219], a[208:211], a[40:43], v[216:219]
    buffer_load_dwordx4 v[76:79], v33, s[12:15], s42 offen sc1
    v_mfma_f32_16x16x32_bf16 v[216:219], a[212:215], a[44:47], v[216:219]
    s_waitcnt vmcnt(13)
    ds_read_b128 a[104:107], v42 offset:28672
    v_bitop3_b32 v60, v51, v55, s76 bitop3:0x7e
    v_mfma_f32_16x16x32_bf16 v[220:223], a[208:211], a[48:51], v[220:223]
    v_cmp_lt_u32 vcc, 0xffff, v60
    v_perm_b32 v61, v94, v35, s38
    v_mfma_f32_16x16x32_bf16 v[220:223], a[212:215], a[52:55], v[220:223]
    ds_read_b32 a242, v61
    ds_read_b128 a[108:111], v43 offset:28672
    v_mfma_f32_16x16x32_bf16 v[224:227], a[216:219], a[130:133], v[224:227]
    v_perm_b32 v62, v94, v35, s39
    s_cbranch_vccnz L_slow2_0
L_back2_0:
    v_mfma_f32_16x16x32_bf16 v[228:231], a[216:219], a[2:5], v[228:231]
    ds_read_b32 a243, v62
    v_perm_b32 v63, v91, v35, s36
    v_mfma_f32_16x16x32_bf16 v[232:235], a[216:219], a[10:13], v[232:235]
    ds_read_b32 a244, v63
    ds_read_b128 a[112:115], v42 offset:30720
    v_mfma_f32_16x16x32_bf16 v[236:239], a[216:219], a[18:21], v[236:239]
    buffer_load_dwordx4 v36, s[8:11], s56 offen offset:0 lds
    v_mfma_f32_16x16x32_bf16 v[240:243], a[216:219], a[26:29], v[240:243]
    ds_read_b128 a[116:119], v43 offset:30720
    v_perm_b32 v56, v91, v35, s37
    v_mfma_f32_16x16x32_bf16 v[244:247], a[216:219], a[34:37], v[244:247]
    ds_read_b32 a245, v56
    v_perm_b32 v57, v95, v35, s36
    v_mfma_f32_16x16x32_bf16 v[248:251], a[216:219], a[42:45], v[248:251]
    ds_read_b32 a246, v57
    v_perm_b32 v58, v95, v35, s37
    v_mfma_f32_16x16x32_bf16 v[252:255], a[216:219], a[50:53], v[252:255]
    ds_read_b32 a247, v58
    v_perm_b32 v59, v48, v35, s36
    v_mfma_f32_16x16x32_bf16 v[128:131], a[220:223], a[56:59], v[128:131]
    ds_read_b32 a248, v59
    v_perm_b32 v60, v48, v35, s37
    v_mfma_f32_16x16x32_bf16 v[128:131], a[224:227], a[60:63], v[128:131]
    s_waitcnt lgkmcnt(8)
    v_perm_b32 v61, v48, v35, s38
    v_perm_b32 v62, v48, v35, s39
    v_mfma_f32_16x16x32_bf16 v[132:135], a[220:223], a[64:67], v[132:135]
    ds_read_b32 a249, v60
    ds_read_b32 a250, v61
    v_mfma_f32_16x16x32_bf16 v[132:135], a[224:227], a[68:71], v[132:135]
    buffer_load_dwordx4 v37, s[8:11], s56 offen offset:1024 lds
    v_mfma_f32_16x16x32_bf16 v[136:139], a[220:223], a[72:75], v[136:139]
    ds_read_b32 a251, v62
    v_perm_b32 v63, v52, v35, s36
    v_mfma_f32_16x16x32_bf16 v[136:139], a[224:227], a[76:79], v[136:139]
    ds_read_b32 a252, v63
    v_perm_b32 v56, v52, v35, s37
    v_mfma_f32_16x16x32_bf16 v[140:143], a[220:223], a[80:83], v[140:143]
    ds_read_b32 a253, v56
    v_perm_b32 v57, v52, v35, s38
    v_mfma_f32_16x16x32_bf16 v[140:143], a[224:227], a[84:87], v[140:143]
    ds_read_b32 a254, v57
    v_perm_b32 v58, v52, v35, s39
    v_mfma_f32_16x16x32_bf16 v[144:147], a[220:223], a[88:91], v[144:147]
    v_perm_b32 v59, v49, v35, s36
    v_perm_b32 v60, v49, v35, s37
    v_mfma_f32_16x16x32_bf16 v[144:147], a[224:227], a[92:95], v[144:147]
    ds_read_b32 a255, v58
    ds_read_b32 a136, v59
    v_mfma_f32_16x16x32_bf16 v[148:151], a[220:223], a[96:99], v[148:151]
    buffer_load_dwordx4 v38, s[8:11], s56 offen offset:2048 lds
    v_mfma_f32_16x16x32_bf16 v[148:151], a[224:227], a[100:103], v[148:151]
    ds_read_b32 a137, v60
    v_perm_b32 v61, v49, v35, s38
    v_mfma_f32_16x16x32_bf16 v[152:155], a[220:223], a[104:107], v[152:155]
    ds_read_b32 a138, v61
    v_perm_b32 v62, v49, v35, s39
    v_mfma_f32_16x16x32_bf16 v[152:155], a[224:227], a[108:111], v[152:155]
    s_waitcnt lgkmcnt(7)
    ds_read_b32 a139, v62
    v_perm_b32 v63, v53, v35, s36
    v_mfma_f32_16x16x32_bf16 v[156:159], a[220:223], a[112:115], v[156:159]
    ds_read_b32 a140, v63
    v_perm_b32 v56, v53, v35, s37
    v_mfma_f32_16x16x32_bf16 v[156:159], a[224:227], a[116:119], v[156:159]
    v_perm_b32 v57, v53, v35, s38
    v_perm_b32 v58, v53, v35, s39
    v_mfma_f32_16x16x32_bf16 v[160:163], a[228:231], a[56:59], v[160:163]
    s_waitcnt vmcnt(12)
    ds_read_b32 a141, v56
    ds_read_b32 a142, v57
    v_mfma_f32_16x16x32_bf16 v[160:163], a[232:235], a[60:63], v[160:163]
    buffer_load_dwordx4 v39, s[8:11], s56 offen offset:3072 lds
    v_mfma_f32_16x16x32_bf16 v[164:167], a[228:231], a[64:67], v[164:167]
    s_barrier
    v_mfma_f32_16x16x32_bf16 v[164:167], a[232:235], a[68:71], v[164:167]
    s_add_u32 m0, s57, 49152
    ds_read_b128 a[120:123], v40 offset:0
    ds_read_b32 a143, v58
    v_mfma_f32_16x16x32_bf16 v[168:171], a[228:231], a[72:75], v[168:171]
    s_add_u32 s56, s55, 1024
    ds_read_b128 a[124:127], v41 offset:0
    v_perm_b32 v59, v50, v35, s36
    v_mfma_f32_16x16x32_bf16 v[168:171], a[232:235], a[76:79], v[168:171]
    ds_read_b128 a[128:131], v40 offset:2048
    ds_read_b32 a144, v59
    v_mfma_f32_16x16x32_bf16 v[172:175], a[228:231], a[80:83], v[172:175]
    ds_read_b128 a[132:135], v41 offset:2048
    v_perm_b32 v60, v50, v35, s37
    v_mfma_f32_16x16x32_bf16 v[172:175], a[232:235], a[84:87], v[172:175]
    ds_read_b32 a145, v60
    v_perm_b32 v61, v50, v35, s38
    v_mfma_f32_16x16x32_bf16 v[176:179], a[228:231], a[88:91], v[176:179]
    ds_read_b32 a146, v61
    ds_read_b128 a[0:3], v40 offset:4096
    v_mfma_f32_16x16x32_bf16 v[176:179], a[232:235], a[92:95], v[176:179]
    buffer_load_dwordx4 v36, s[8:11], s3 offen offset:0 lds
    v_mfma_f32_16x16x32_bf16 v[180:183], a[228:231], a[96:99], v[180:183]
    ds_read_b128 a[4:7], v41 offset:4096
    v_perm_b32 v62, v50, v35, s39
    v_mfma_f32_16x16x32_bf16 v[180:183], a[232:235], a[100:103], v[180:183]
    ds_read_b32 a147, v62
    ds_read_b128 a[8:11], v40 offset:6144
    v_mfma_f32_16x16x32_bf16 v[184:187], a[228:231], a[104:107], v[184:187]
    s_waitcnt vmcnt(12)
    v_bitop3_b32 v63, v67, v71, s76 bitop3:0x7e
    v_perm_b32 v56, v54, v35, s36
    v_mfma_f32_16x16x32_bf16 v[184:187], a[232:235], a[108:111], v[184:187]
    ds_read_b32 a148, v56
    v_cmp_lt_u32 vcc, 0xffff, v63
    v_mfma_f32_16x16x32_bf16 v[188:191], a[228:231], a[112:115], v[188:191]
    v_perm_b32 v57, v54, v35, s37
    v_perm_b32 v58, v54, v35, s38
    v_mfma_f32_16x16x32_bf16 v[188:191], a[232:235], a[116:119], v[188:191]
    ds_read_b32 a149, v57
    s_cbranch_vccnz L_slow2_1
L_back2_1:
    v_mfma_f32_16x16x32_bf16 v[192:195], a[236:239], a[56:59], v[192:195]
    buffer_load_dwordx4 v37, s[8:11], s3 offen offset:1024 lds
    v_mfma_f32_16x16x32_bf16 v[192:195], a[240:243], a[60:63], v[192:195]
    ds_read_b32 a150, v58
    ds_read_b128 a[12:15], v41 offset:6144
    v_mfma_f32_16x16x32_bf16 v[196:199], a[236:239], a[64:67], v[196:199]
    ds_read_b128 a[16:19], v40 offset:8192
    v_perm_b32 v59, v54, v35, s39
    v_mfma_f32_16x16x32_bf16 v[196:199], a[240:243], a[68:71], v[196:199]
    ds_read_b32 a151, v59
    v_perm_b32 v60, v51, v35, s36
    v_mfma_f32_16x16x32_bf16 v[200:203], a[236:239], a[72:75], v[200:203]
    ds_read_b32 a152, v60
    ds_read_b128 a[20:23], v41 offset:8192
    v_mfma_f32_16x16x32_bf16 v[200:203], a[240:243], a[76:79], v[200:203]
    v_perm_b32 v61, v51, v35, s37
    v_perm_b32 v62, v55, v35, s36
    v_mfma_f32_16x16x32_bf16 v[204:207], a[236:239], a[80:83], v[204:207]
    ds_read_b32 a153, v61
    ds_read_b32 a154, v62
    v_mfma_f32_16x16x32_bf16 v[204:207], a[240:243], a[84:87], v[204:207]
    buffer_load_dwordx4 v38, s[8:11], s3 offen offset:2048 lds
    v_mfma_f32_16x16x32_bf16 v[208:211], a[236:239], a[88:91], v[208:211]
    ds_read_b128 a[24:27], v40 offset:10240
    v_perm_b32 v63, v55, v35, s37
    v_mfma_f32_16x16x32_bf16 v[208:211], a[240:243], a[92:95], v[208:211]
    ds_read_b32 a155, v63
    v_perm_b32 v56, v64, v35, s36
    v_mfma_f32_16x16x32_bf16 v[212:215], a[236:239], a[96:99], v[212:215]
    ds_read_b32 a156, v56
    ds_read_b128 a[28:31], v41 offset:10240
    v_mfma_f32_16x16x32_bf16 v[212:215], a[240:243], a[100:103], v[212:215]
    v_perm_b32 v57, v64, v35, s37
    v_perm_b32 v58, v64, v35, s38
    v_mfma_f32_16x16x32_bf16 v[216:219], a[236:239], a[104:107], v[216:219]
    ds_read_b32 a157, v57
    ds_read_b32 a158, v58
    v_mfma_f32_16x16x32_bf16 v[216:219], a[240:243], a[108:111], v[216:219]
    v_perm_b32 v59, v64, v35, s39
    v_perm_b32 v60, v68, v35, s36
    v_mfma_f32_16x16x32_bf16 v[220:223], a[236:239], a[112:115], v[220:223]
    ds_read_b32 a159, v59
    ds_read_b32 a160, v60
    v_mfma_f32_16x16x32_bf16 v[220:223], a[240:243], a[116:119], v[220:223]
    buffer_load_dwordx4 v39, s[8:11], s3 offen offset:3072 lds
    v_mfma_f32_16x16x32_bf16 v[224:227], a[244:247], a[58:61], v[224:227]
    s_add_u32 m0, s57, 65536
    ds_read_b128 a[32:35], v40 offset:12288
    v_perm_b32 v61, v68, v35, s37
    v_mfma_f32_16x16x32_bf16 v[228:231], a[244:247], a[66:69], v[228:231]
    s_add_u32 s3, s69, 1024
    ds_read_b32 a161, v61
    v_perm_b32 v62, v68, v35, s38
    v_mfma_f32_16x16x32_bf16 v[232:235], a[244:247], a[74:77], v[232:235]
    ds_read_b32 a162, v62
    ds_read_b128 a[36:39], v41 offset:12288
    v_mfma_f32_16x16x32_bf16 v[236:239], a[244:247], a[82:85], v[236:239]
    buffer_load_dwordx4 v[80:83], v34, s[12:15], s42 offen sc1
    v_mfma_f32_16x16x32_bf16 v[240:243], a[244:247], a[90:93], v[240:243]
    ds_read_b128 a[40:43], v40 offset:14336
    v_perm_b32 v63, v68, v35, s39
    v_mfma_f32_16x16x32_bf16 v[244:247], a[244:247], a[98:101], v[244:247]
    ds_read_b32 a163, v63
    v_perm_b32 v56, v65, v35, s36
    v_mfma_f32_16x16x32_bf16 v[248:251], a[244:247], a[106:109], v[248:251]
    ds_read_b32 a164, v56
    v_perm_b32 v57, v65, v35, s37
    v_mfma_f32_16x16x32_bf16 v[252:255], a[244:247], a[114:117], v[252:255]
    s_waitcnt lgkmcnt(7)
    ds_read_b32 a165, v57
    ds_read_b128 a[44:47], v41 offset:14336
    v_mfma_f32_16x16x32_bf16 v[128:131], a[248:251], a[120:123], v[128:131]
    buffer_load_dwordx4 v[84:87], v44, s[12:15], s42 offen sc1
    v_mfma_f32_16x16x32_bf16 v[128:131], a[252:255], a[124:127], v[128:131]
    v_perm_b32 v58, v65, v35, s38
    v_perm_b32 v59, v65, v35, s39
    v_mfma_f32_16x16x32_bf16 v[132:135], a[248:251], a[128:131], v[132:135]
    ds_read_b32 a166, v58
    ds_read_b32 a167, v59
    v_mfma_f32_16x16x32_bf16 v[132:135], a[252:255], a[132:135], v[132:135]
    v_perm_b32 v60, v69, v35, s36
    v_perm_b32 v61, v69, v35, s37
    v_mfma_f32_16x16x32_bf16 v[136:139], a[248:251], a[0:3], v[136:139]
    ds_read_b32 a168, v60
    ds_read_b32 a169, v61
    v_mfma_f32_16x16x32_bf16 v[136:139], a[252:255], a[4:7], v[136:139]
    v_perm_b32 v62, v69, v35, s38
    v_perm_b32 v63, v69, v35, s39
    v_mfma_f32_16x16x32_bf16 v[140:143], a[248:251], a[8:11], v[140:143]
    ds_read_b32 a170, v62
    v_perm_b32 v56, v66, v35, s36
    v_mfma_f32_16x16x32_bf16 v[140:143], a[252:255], a[12:15], v[140:143]
    ds_read_b32 a171, v63
    ds_read_b32 a172, v56
    v_mfma_f32_16x16x32_bf16 v[144:147], a[248:251], a[16:19], v[144:147]
    buffer_load_dwordx4 v[96:99], v32, s[12:15], s43 offen sc1
    v_mfma_f32_16x16x32_bf16 v[144:147], a[252:255], a[20:23], v[144:147]
    v_perm_b32 v57, v66, v35, s37
    v_perm_b32 v58, v66, v35, s38
    v_mfma_f32_16x16x32_bf16 v[148:151], a[248:251], a[24:27], v[148:151]
    ds_read_b32 a173, v57
    v_perm_b32 v59, v66, v35, s39
    v_mfma_f32_16x16x32_bf16 v[148:151], a[252:255], a[28:31], v[148:151]
    s_waitcnt lgkmcnt(6)
    ds_read_b32 a174, v58
    ds_read_b32 a175, v59
    v_mfma_f32_16x16x32_bf16 v[152:155], a[248:251], a[32:35], v[152:155]
    buffer_load_dwordx4 v[100:103], v33, s[12:15], s43 offen sc1
    v_mfma_f32_16x16x32_bf16 v[152:155], a[252:255], a[36:39], v[152:155]
    s_waitcnt vmcnt(12)
    v_bitop3_b32 v60, v75, v79, s76 bitop3:0x7e
    v_perm_b32 v61, v70, v35, s36
    v_mfma_f32_16x16x32_bf16 v[156:159], a[248:251], a[40:43], v[156:159]
    ds_read_b32 a176, v61
    v_cmp_lt_u32 vcc, 0xffff, v60
    v_mfma_f32_16x16x32_bf16 v[156:159], a[252:255], a[44:47], v[156:159]
    v_perm_b32 v62, v70, v35, s37
    v_perm_b32 v63, v70, v35, s38
    v_mfma_f32_16x16x32_bf16 v[160:163], a[136:139], a[120:123], v[160:163]
    ds_read_b32 a177, v62
    s_cbranch_vccnz L_slow3_0
L_back3_0:
    v_mfma_f32_16x16x32_bf16 v[160:163], a[140:143], a[124:127], v[160:163]
    buffer_load_dwordx4 v36, s[8:11], s56 offen offset:0 lds
    v_mfma_f32_16x16x32_bf16 v[164:167], a[136:139], a[128:131], v[164:167]
    ds_read_b32 a178, v63
    v_perm_b32 v56, v70, v35, s39
    v_mfma_f32_16x16x32_bf16 v[164:167], a[140:143], a[132:135], v[164:167]
    ds_read_b32 a179, v56
    v_perm_b32 v57, v67, v35, s36
    v_mfma_f32_16x16x32_bf16 v[168:171], a[136:139], a[0:3], v[168:171]
    s_barrier
    v_mfma_f32_16x16x32_bf16 v[168:171], a[140:143], a[4:7], v[168:171]
    ds_read_b32 a180, v57
    ds_read_b128 a[48:51], v40 offset:16384
    v_mfma_f32_16x16x32_bf16 v[172:175], a[136:139], a[8:11], v[172:175]
    v_perm_b32 v58, v67, v35, s37
    v_perm_b32 v59, v71, v35, s36
    v_mfma_f32_16x16x32_bf16 v[172:175], a[140:143], a[12:15], v[172:175]
    ds_read_b32 a181, v58
    v_perm_b32 v60, v71, v35, s37
    v_mfma_f32_16x16x32_bf16 v[176:179], a[136:139], a[16:19], v[176:179]
    ds_read_b32 a182, v59
    ds_read_b32 a183, v60
    v_mfma_f32_16x16x32_bf16 v[176:179], a[140:143], a[20:23], v[176:179]
    buffer_load_dwordx4 v37, s[8:11], s56 offen offset:1024 lds
    v_mfma_f32_16x16x32_bf16 v[180:183], a[136:139], a[24:27], v[180:183]
    ds_read_b128 a[52:55], v41 offset:16384
    v_perm_b32 v61, v72, v35, s36
    v_mfma_f32_16x16x32_bf16 v[180:183], a[140:143], a[28:31], v[180:183]
    ds_read_b32 a184, v61
    ds_read_b128 a[56:59], v40 offset:18432
    v_mfma_f32_16x16x32_bf16 v[184:187], a[136:139], a[32:35], v[184:187]
    ds_read_b128 a[60:63], v41 offset:18432
    v_perm_b32 v62, v72, v35, s37
    v_mfma_f32_16x16x32_bf16 v[184:187], a[140:143], a[36:39], v[184:187]
    ds_read_b32 a185, v62
    ds_read_b128 a[64:67], v40 offset:20480
    v_mfma_f32_16x16x32_bf16 v[188:191], a[136:139], a[40:43], v[188:191]
    v_perm_b32 v63, v72, v35, s38
    v_perm_b32 v56, v72, v35, s39
    v_mfma_f32_16x16x32_bf16 v[188:191], a[140:143], a[44:47], v[188:191]
    ds_read_b32 a186, v63
    ds_read_b32 a187, v56
    v_mfma_f32_16x16x32_bf16 v[192:195], a[144:147], a[120:123], v[192:195]
    buffer_load_dwordx4 v38, s[8:11], s56 offen offset:2048 lds
    v_mfma_f32_16x16x32_bf16 v[192:195], a[148:151], a[124:127], v[192:195]
    ds_read_b128 a[68:71], v41 offset:20480
    v_perm_b32 v57, v76, v35, s36
    v_mfma_f32_16x16x32_bf16 v[196:199], a[144:147], a[128:131], v[196:199]
    ds_read_b32 a188, v57
    ds_read_b128 a[72:75], v40 offset:22528
    v_mfma_f32_16x16x32_bf16 v[196:199], a[148:151], a[132:135], v[196:199]
    ds_read_b128 a[76:79], v41 offset:22528
    v_perm_b32 v58, v76, v35, s37
    v_mfma_f32_16x16x32_bf16 v[200:203], a[144:147], a[0:3], v[200:203]
    ds_read_b32 a189, v58
    v_perm_b32 v59, v76, v35, s38
    v_mfma_f32_16x16x32_bf16 v[200:203], a[148:151], a[4:7], v[200:203]
    ds_read_b32 a190, v59
    v_perm_b32 v60, v76, v35, s39
    v_mfma_f32_16x16x32_bf16 v[204:207], a[144:147], a[8:11], v[204:207]
    ds_read_b32 a191, v60
    ds_read_b128 a[80:83], v40 offset:24576
    v_mfma_f32_16x16x32_bf16 v[204:207], a[148:151], a[12:15], v[204:207]
    buffer_load_dwordx4 v39, s[8:11], s56 offen offset:3072 lds
    v_mfma_f32_16x16x32_bf16 v[208:211], a[144:147], a[16:19], v[208:211]
    s_add_u32 m0, s57, 81920
    ds_read_b128 a[84:87], v41 offset:24576
    v_perm_b32 v61, v73, v35, s36
    v_mfma_f32_16x16x32_bf16 v[208:211], a[148:151], a[20:23], v[208:211]
    ds_read_b32 a192, v61
    ds_read_b128 a[88:91], v40 offset:26624
    v_mfma_f32_16x16x32_bf16 v[212:215], a[144:147], a[24:27], v[212:215]
    v_perm_b32 v62, v73, v35, s37
    v_perm_b32 v63, v73, v35, s38
    v_mfma_f32_16x16x32_bf16 v[212:215], a[148:151], a[28:31], v[212:215]
    ds_read_b32 a193, v62
    ds_read_b32 a194, v63
    v_mfma_f32_16x16x32_bf16 v[216:219], a[144:147], a[32:35], v[216:219]
    ds_read_b128 a[92:95], v41 offset:26624
    v_perm_b32 v56, v73, v35, s39
    v_mfma_f32_16x16x32_bf16 v[216:219], a[148:151], a[36:39], v[216:219]
    ds_read_b32 a195, v56
    v_perm_b32 v57, v77, v35, s36
    v_mfma_f32_16x16x32_bf16 v[220:223], a[144:147], a[40:43], v[220:223]
    ds_read_b32 a196, v57
    ds_read_b128 a[96:99], v40 offset:28672
    v_mfma_f32_16x16x32_bf16 v[220:223], a[148:151], a[44:47], v[220:223]
    buffer_load_dwordx4 v36, s[8:11], s3 offen offset:0 lds
    v_mfma_f32_16x16x32_bf16 v[224:227], a[152:155], a[122:125], v[224:227]
    ds_read_b128 a[100:103], v41 offset:28672
    v_perm_b32 v58, v77, v35, s37
    v_mfma_f32_16x16x32_bf16 v[228:231], a[152:155], a[130:133], v[228:231]
    ds_read_b32 a197, v58
    ds_read_b128 a[104:107], v40 offset:30720
    v_mfma_f32_16x16x32_bf16 v[232:235], a[152:155], a[2:5], v[232:235]
    v_perm_b32 v59, v77, v35, s38
    v_perm_b32 v60, v77, v35, s39
    v_mfma_f32_16x16x32_bf16 v[236:239], a[152:155], a[10:13], v[236:239]
    ds_read_b32 a198, v59
    ds_read_b32 a199, v60
    v_mfma_f32_16x16x32_bf16 v[240:243], a[152:155], a[18:21], v[240:243]
    v_perm_b32 v61, v74, v35, s36
    v_perm_b32 v62, v74, v35, s37
    v_mfma_f32_16x16x32_bf16 v[244:247], a[152:155], a[26:29], v[244:247]
    ds_read_b32 a200, v61
    ds_read_b32 a201, v62
    v_mfma_f32_16x16x32_bf16 v[248:251], a[152:155], a[34:37], v[248:251]
    buffer_load_dwordx4 v37, s[8:11], s3 offen offset:1024 lds
    v_mfma_f32_16x16x32_bf16 v[252:255], a[152:155], a[42:45], v[252:255]
    s_waitcnt lgkmcnt(7)
    ds_read_b128 a[108:111], v41 offset:30720
    v_perm_b32 v63, v74, v35, s38
    v_mfma_f32_16x16x32_bf16 v[128:131], a[156:159], a[48:51], v[128:131]
    ds_read_b32 a202, v63
    v_perm_b32 v56, v74, v35, s39
    v_mfma_f32_16x16x32_bf16 v[128:131], a[160:163], a[52:55], v[128:131]
    ds_read_b32 a203, v56
    v_perm_b32 v57, v78, v35, s36
    v_mfma_f32_16x16x32_bf16 v[132:135], a[156:159], a[56:59], v[132:135]
    s_add_u32 s56, s55, 1280
    ds_read_b32 a204, v57
    v_perm_b32 v58, v78, v35, s37
    v_mfma_f32_16x16x32_bf16 v[132:135], a[160:163], a[60:63], v[132:135]
    ds_read_b32 a205, v58
    v_perm_b32 v59, v78, v35, s38
    v_mfma_f32_16x16x32_bf16 v[136:139], a[156:159], a[64:67], v[136:139]
    v_perm_b32 v60, v78, v35, s39
    v_mfma_f32_16x16x32_bf16 v[136:139], a[160:163], a[68:71], v[136:139]
    ds_read_b32 a206, v59
    v_mfma_f32_16x16x32_bf16 v[140:143], a[156:159], a[72:75], v[140:143]
    ds_read_b32 a207, v60
    v_mfma_f32_16x16x32_bf16 v[140:143], a[160:163], a[76:79], v[140:143]
    buffer_load_dwordx4 v[104:107], v34, s[12:15], s43 offen sc1
    v_mfma_f32_16x16x32_bf16 v[144:147], a[156:159], a[80:83], v[144:147]
    v_perm_b32 v61, v75, v35, s36
    v_perm_b32 v62, v75, v35, s37
    v_mfma_f32_16x16x32_bf16 v[144:147], a[160:163], a[84:87], v[144:147]
    ds_read_b32 a208, v61
    v_perm_b32 v63, v79, v35, s36
    v_mfma_f32_16x16x32_bf16 v[148:151], a[156:159], a[88:91], v[148:151]
    ds_read_b32 a209, v62
    v_mfma_f32_16x16x32_bf16 v[148:151], a[160:163], a[92:95], v[148:151]
    buffer_load_dwordx4 v[108:111], v44, s[12:15], s43 offen sc1
    v_mfma_f32_16x16x32_bf16 v[152:155], a[156:159], a[96:99], v[152:155]
    s_waitcnt lgkmcnt(4)
    ds_read_b32 a210, v63
    v_perm_b32 v56, v79, v35, s37
    v_mfma_f32_16x16x32_bf16 v[152:155], a[160:163], a[100:103], v[152:155]
    s_waitcnt vmcnt(12)
    ds_read_b32 a211, v56
    v_mfma_f32_16x16x32_bf16 v[156:159], a[156:159], a[104:107], v[156:159]
    s_barrier
    v_mfma_f32_16x16x32_bf16 v[156:159], a[160:163], a[108:111], v[156:159]
    buffer_load_dwordx4 v38, s[8:11], s3 offen offset:2048 lds
    v_mfma_f32_16x16x32_bf16 v[160:163], a[164:167], a[48:51], v[160:163]
    ds_read_b128 a[112:115], v40 offset:32768
    v_mfma_f32_16x16x32_bf16 v[160:163], a[168:171], a[52:55], v[160:163]
    ds_read_b128 a[116:119], v41 offset:32768
    v_mfma_f32_16x16x32_bf16 v[164:167], a[164:167], a[56:59], v[164:167]
    ds_read_b128 a[120:123], v40 offset:34816
    v_mfma_f32_16x16x32_bf16 v[164:167], a[168:171], a[60:63], v[164:167]
    ds_read_b128 a[124:127], v41 offset:34816
    v_mfma_f32_16x16x32_bf16 v[168:171], a[164:167], a[64:67], v[168:171]
    v_mfma_f32_16x16x32_bf16 v[168:171], a[168:171], a[68:71], v[168:171]
    ds_read_b128 a[128:131], v40 offset:36864
    v_mfma_f32_16x16x32_bf16 v[172:175], a[164:167], a[72:75], v[172:175]
    buffer_load_dwordx4 v39, s[8:11], s3 offen offset:3072 lds
    v_mfma_f32_16x16x32_bf16 v[172:175], a[168:171], a[76:79], v[172:175]
    s_waitcnt vmcnt(12)
    s_add_u32 m0, s57, 0
    v_bitop3_b32 v57, v83, v87, s76 bitop3:0x7e
    v_mfma_f32_16x16x32_bf16 v[176:179], a[164:167], a[80:83], v[176:179]
    s_add_u32 s3, s69, 1280
    ds_read_b128 a[132:135], v41 offset:36864
    v_cmp_lt_u32 vcc, 0xffff, v57
    v_mfma_f32_16x16x32_bf16 v[176:179], a[168:171], a[84:87], v[176:179]
    v_mfma_f32_16x16x32_bf16 v[180:183], a[164:167], a[88:91], v[180:183]
    s_cbranch_vccnz L_slow3_1
L_back3_1:
    v_mfma_f32_16x16x32_bf16 v[180:183], a[168:171], a[92:95], v[180:183]
    ds_read_b128 a[0:3], v40 offset:38912
    v_perm_b32 v58, v83, v35, s36
    v_mfma_f32_16x16x32_bf16 v[184:187], a[164:167], a[96:99], v[184:187]
    v_perm_b32 v59, v83, v35, s37
    v_perm_b32 v60, v87, v35, s36
    v_mfma_f32_16x16x32_bf16 v[184:187], a[168:171], a[100:103], v[184:187]
    ds_read_b32 a212, v58
    ds_read_b32 a213, v59
    v_mfma_f32_16x16x32_bf16 v[188:191], a[164:167], a[104:107], v[188:191]
    buffer_load_dwordx4 v36, s[8:11], s56 offen offset:0 lds
    v_mfma_f32_16x16x32_bf16 v[188:191], a[168:171], a[108:111], v[188:191]
    ds_read_b32 a214, v60
    ds_read_b128 a[4:7], v41 offset:38912
    v_mfma_f32_16x16x32_bf16 v[192:195], a[172:175], a[48:51], v[192:195]
    v_perm_b32 v61, v87, v35, s37
    v_perm_b32 v62, v80, v35, s36
    v_mfma_f32_16x16x32_bf16 v[192:195], a[176:179], a[52:55], v[192:195]
    ds_read_b32 a215, v61
    ds_read_b32 a216, v62
    v_mfma_f32_16x16x32_bf16 v[196:199], a[172:175], a[56:59], v[196:199]
    ds_read_b128 a[8:11], v40 offset:40960
    v_perm_b32 v63, v80, v35, s37
    v_mfma_f32_16x16x32_bf16 v[196:199], a[176:179], a[60:63], v[196:199]
    ds_read_b32 a217, v63
    v_perm_b32 v56, v80, v35, s38
    v_mfma_f32_16x16x32_bf16 v[200:203], a[172:175], a[64:67], v[200:203]
    ds_read_b32 a218, v56
    ds_read_b128 a[12:15], v41 offset:40960
    v_mfma_f32_16x16x32_bf16 v[200:203], a[176:179], a[68:71], v[200:203]
    v_perm_b32 v57, v80, v35, s39
    v_perm_b32 v58, v84, v35, s36
    v_mfma_f32_16x16x32_bf16 v[204:207], a[172:175], a[72:75], v[204:207]
    ds_read_b32 a219, v57
    ds_read_b32 a220, v58
    v_mfma_f32_16x16x32_bf16 v[204:207], a[176:179], a[76:79], v[204:207]
    buffer_load_dwordx4 v[112:115], v32, s[12:15], s44 offen sc1
    v_mfma_f32_16x16x32_bf16 v[208:211], a[172:175], a[80:83], v[208:211]
    ds_read_b128 a[16:19], v40 offset:43008
    v_perm_b32 v59, v84, v35, s37
    v_mfma_f32_16x16x32_bf16 v[208:211], a[176:179], a[84:87], v[208:211]
    ds_read_b32 a221, v59
    v_perm_b32 v60, v84, v35, s38
    v_mfma_f32_16x16x32_bf16 v[212:215], a[172:175], a[88:91], v[212:215]
    ds_read_b32 a222, v60
    ds_read_b128 a[20:23], v41 offset:43008
    v_mfma_f32_16x16x32_bf16 v[212:215], a[176:179], a[92:95], v[212:215]
    buffer_load_dwordx4 v[116:119], v33, s[12:15], s44 offen sc1
    v_mfma_f32_16x16x32_bf16 v[216:219], a[172:175], a[96:99], v[216:219]
    v_perm_b32 v61, v84, v35, s39
    v_perm_b32 v62, v81, v35, s36
    v_mfma_f32_16x16x32_bf16 v[216:219], a[176:179], a[100:103], v[216:219]
    ds_read_b32 a223, v61
    v_perm_b32 v63, v81, v35, s37
    v_mfma_f32_16x16x32_bf16 v[220:223], a[172:175], a[104:107], v[220:223]
    ds_read_b32 a224, v62
    ds_read_b32 a225, v63
    v_mfma_f32_16x16x32_bf16 v[220:223], a[176:179], a[108:111], v[220:223]
    buffer_load_dwordx4 v37, s[8:11], s56 offen offset:1024 lds
    v_mfma_f32_16x16x32_bf16 v[224:227], a[180:183], a[50:53], v[224:227]
    s_waitcnt vmcnt(14)
    ds_read_b128 a[24:27], v40 offset:45056
    v_bitop3_b32 v56, v99, v103, s76 bitop3:0x7e
    v_mfma_f32_16x16x32_bf16 v[228:231], a[180:183], a[58:61], v[228:231]
    ds_read_b128 a[28:31], v41 offset:45056
    v_cmp_lt_u32 vcc, 0xffff, v56
    v_mfma_f32_16x16x32_bf16 v[232:235], a[180:183], a[66:69], v[232:235]
    v_perm_b32 v57, v81, v35, s38
    v_perm_b32 v58, v81, v35, s39
    v_mfma_f32_16x16x32_bf16 v[236:239], a[180:183], a[74:77], v[236:239]
    ds_read_b32 a226, v57
    ds_read_b32 a227, v58
    v_mfma_f32_16x16x32_bf16 v[240:243], a[180:183], a[82:85], v[240:243]
    v_perm_b32 v59, v85, v35, s36
    s_cbranch_vccnz L_slow4_0
L_back4_0:
    v_mfma_f32_16x16x32_bf16 v[244:247], a[180:183], a[90:93], v[244:247]
    ds_read_b32 a228, v59
    ds_read_b128 a[32:35], v40 offset:47104
    v_mfma_f32_16x16x32_bf16 v[248:251], a[180:183], a[98:101], v[248:251]
    buffer_load_dwordx4 v38, s[8:11], s56 offen offset:2048 lds
    v_mfma_f32_16x16x32_bf16 v[252:255], a[180:183], a[106:109], v[252:255]
    s_waitcnt lgkmcnt(6)
    ds_read_b128 a[36:39], v41 offset:47104
    v_perm_b32 v60, v85, v35, s37
    v_mfma_f32_16x16x32_bf16 v[128:131], a[184:187], a[112:115], v[128:131]
    ds_read_b32 a229, v60
    v_perm_b32 v61, v85, v35, s38
L_pad2:
    s_cbranch_execz L_pad3
    v_mfma_f32_16x16x32_bf16 v[128:131], a[188:191], a[116:119], v[128:131]
    ds_read_b32 a230, v61
    ds_read_b128 a[40:43], v40 offset:49152
    v_mfma_f32_16x16x32_bf16 v[132:135], a[184:187], a[120:123], v[132:135]
    v_perm_b32 v62, v85, v35, s39
    v_perm_b32 v63, v82, v35, s36
    v_mfma_f32_16x16x32_bf16 v[132:135], a[188:191], a[124:127], v[132:135]
    ds_read_b32 a231, v62
    v_perm_b32 v56, v82, v35, s37
    v_mfma_f32_16x16x32_bf16 v[136:139], a[184:187], a[128:131], v[136:139]
    ds_read_b32 a232, v63
    ds_read_b32 a233, v56
    v_mfma_f32_16x16x32_bf16 v[136:139], a[188:191], a[132:135], v[136:139]
    buffer_load_dwordx4 v39, s[8:11], s56 offen offset:3072 lds
    v_mfma_f32_16x16x32_bf16 v[140:143], a[184:187], a[0:3], v[140:143]
    s_add_u32 m0, s57, 16384
    ds_read_b128 a[44:47], v41 offset:49152
    v_perm_b32 v57, v82, v35, s38
    v_mfma_f32_16x16x32_bf16 v[140:143], a[188:191], a[4:7], v[140:143]
    ds_read_b32 a234, v57
    ds_read_b128 a[48:51], v40 offset:51200
    v_mfma_f32_16x16x32_bf16 v[144:147], a[184:187], a[8:11], v[144:147]
    v_perm_b32 v58, v82, v35, s39
    v_perm_b32 v59, v86, v35, s36
    v_mfma_f32_16x16x32_bf16 v[144:147], a[188:191], a[12:15], v[144:147]
    ds_read_b32 a235, v58
    ds_read_b32 a236, v59
    v_mfma_f32_16x16x32_bf16 v[148:151], a[184:187], a[16:19], v[148:151]
    ds_read_b128 a[52:55], v41 offset:51200
    v_perm_b32 v60, v86, v35, s37
    v_mfma_f32_16x16x32_bf16 v[148:151], a[188:191], a[20:23], v[148:151]
    s_waitcnt lgkmcnt(9)
    v_perm_b32 v61, v86, v35, s38
    v_perm_b32 v62, v86, v35, s39
    v_mfma_f32_16x16x32_bf16 v[152:155], a[184:187], a[24:27], v[152:155]
    ds_read_b32 a237, v60
    ds_read_b32 a238, v61
    v_mfma_f32_16x16x32_bf16 v[152:155], a[188:191], a[28:31], v[152:155]
    buffer_load_dwordx4 v36, s[8:11], s3 offen offset:0 lds
    v_mfma_f32_16x16x32_bf16 v[156:159], a[184:187], a[32:35], v[156:159]
    ds_read_b32 a239, v62
    ds_read_b128 a[56:59], v40 offset:53248
    v_mfma_f32_16x16x32_bf16 v[156:159], a[188:191], a[36:39], v[156:159]
    v_perm_b32 v63, v96, v35, s36
    v_perm_b32 v56, v96, v35, s37
    v_mfma_f32_16x16x32_bf16 v[160:163], a[192:195], a[112:115], v[160:163]
    ds_read_b32 a240, v63
    ds_read_b32 a241, v56
    v_mfma_f32_16x16x32_bf16 v[160:163], a[196:199], a[116:119], v[160:163]
    ds_read_b128 a[60:63], v41 offset:53248
    v_perm_b32 v57, v96, v35, s38
    v_mfma_f32_16x16x32_bf16 v[164:167], a[192:195], a[120:123], v[164:167]
    ds_read_b32 a242, v57
    v_perm_b32 v58, v96, v35, s39
    v_mfma_f32_16x16x32_bf16 v[164:167], a[196:199], a[124:127], v[164:167]
    ds_read_b32 a243, v58
    ds_read_b128 a[64:67], v40 offset:55296
    v_mfma_f32_16x16x32_bf16 v[168:171], a[192:195], a[128:131], v[168:171]
    buffer_load_dwordx4 v37, s[8:11], s3 offen offset:1024 lds
    v_mfma_f32_16x16x32_bf16 v[168:171], a[196:199], a[132:135], v[168:171]
    v_perm_b32 v59, v100, v35, s36
    v_perm_b32 v60, v100, v35, s37
    v_mfma_f32_16x16x32_bf16 v[172:175], a[192:195], a[0:3], v[172:175]
    ds_read_b32 a244, v59
    ds_read_b32 a245, v60
    v_mfma_f32_16x16x32_bf16 v[172:175], a[196:199], a[4:7], v[172:175]
    ds_read_b128 a[68:71], v41 offset:55296
    v_perm_b32 v61, v100, v35, s38
    v_mfma_f32_16x16x32_bf16 v[176:179], a[192:195], a[8:11], v[176:179]
    ds_read_b32 a246, v61
    v_perm_b32 v62, v100, v35, s39
    v_mfma_f32_16x16x32_bf16 v[176:179], a[196:199], a[12:15], v[176:179]
    ds_read_b32 a247, v62
    ds_read_b128 a[72:75], v40 offset:57344
    v_mfma_f32_16x16x32_bf16 v[180:183], a[192:195], a[16:19], v[180:183]
    v_perm_b32 v63, v97, v35, s36
    v_perm_b32 v56, v97, v35, s37
    v_mfma_f32_16x16x32_bf16 v[180:183], a[196:199], a[20:23], v[180:183]
    ds_read_b32 a248, v63
    ds_read_b32 a249, v56
    v_mfma_f32_16x16x32_bf16 v[184:187], a[192:195], a[24:27], v[184:187]
    buffer_load_dwordx4 v[120:123], v34, s[12:15], s44 offen sc1
    v_mfma_f32_16x16x32_bf16 v[184:187], a[196:199], a[28:31], v[184:187]
    ds_read_b128 a[76:79], v41 offset:57344
    v_perm_b32 v57, v97, v35, s38
    v_mfma_f32_16x16x32_bf16 v[188:191], a[192:195], a[32:35], v[188:191]
    ds_read_b32 a250, v57
    v_perm_b32 v58, v97, v35, s39
    v_mfma_f32_16x16x32_bf16 v[188:191], a[196:199], a[36:39], v[188:191]
    ds_read_b32 a251, v58
    ds_read_b128 a[80:83], v40 offset:59392
    v_mfma_f32_16x16x32_bf16 v[192:195], a[200:203], a[112:115], v[192:195]
    buffer_load_dwordx4 v[124:127], v44, s[12:15], s44 offen sc1
    v_mfma_f32_16x16x32_bf16 v[192:195], a[204:207], a[116:119], v[192:195]
    v_perm_b32 v59, v101, v35, s36
    v_perm_b32 v60, v101, v35, s37
    v_mfma_f32_16x16x32_bf16 v[196:199], a[200:203], a[120:123], v[196:199]
    ds_read_b32 a252, v59
    ds_read_b32 a253, v60
    v_mfma_f32_16x16x32_bf16 v[196:199], a[204:207], a[124:127], v[196:199]
    s_waitcnt vmcnt(12)
    v_bitop3_b32 v61, v107, v111, s76 bitop3:0x7e
    v_perm_b32 v62, v101, v35, s38
    v_mfma_f32_16x16x32_bf16 v[200:203], a[200:203], a[128:131], v[200:203]
    ds_read_b32 a254, v62
    ds_read_b128 a[84:87], v41 offset:59392
    v_mfma_f32_16x16x32_bf16 v[200:203], a[204:207], a[132:135], v[200:203]
    buffer_load_dwordx4 v38, s[8:11], s3 offen offset:2048 lds
    v_mfma_f32_16x16x32_bf16 v[204:207], a[200:203], a[0:3], v[204:207]
    ds_read_b128 a[88:91], v40 offset:61440
    v_cmp_lt_u32 vcc, 0xffff, v61
    v_mfma_f32_16x16x32_bf16 v[204:207], a[204:207], a[4:7], v[204:207]
    v_perm_b32 v63, v101, v35, s39
    v_perm_b32 v56, v98, v35, s36
    v_mfma_f32_16x16x32_bf16 v[208:211], a[200:203], a[8:11], v[208:211]
    ds_read_b32 a255, v63
    ds_read_b32 a136, v56
    v_mfma_f32_16x16x32_bf16 v[208:211], a[204:207], a[12:15], v[208:211]
    ds_read_b128 a[92:95], v41 offset:61440
    s_cbranch_vccnz L_slow4_1
L_back4_1:
    v_mfma_f32_16x16x32_bf16 v[212:215], a[200:203], a[16:19], v[212:215]
    v_perm_b32 v57, v98, v35, s37
    v_perm_b32 v58, v98, v35, s38
    v_mfma_f32_16x16x32_bf16 v[212:215], a[204:207], a[20:23], v[212:215]
    ds_read_b32 a137, v57
    ds_read_b32 a138, v58
    v_mfma_f32_16x16x32_bf16 v[216:219], a[200:203], a[24:27], v[216:219]
    buffer_load_dwordx4 v39, s[8:11], s3 offen offset:3072 lds
    v_mfma_f32_16x16x32_bf16 v[216:219], a[204:207], a[28:31], v[216:219]
    ds_read_b128 a[96:99], v40 offset:63488
    v_perm_b32 v59, v98, v35, s39
    v_mfma_f32_16x16x32_bf16 v[220:223], a[200:203], a[32:35], v[220:223]
    ds_read_b32 a139, v59
    ds_read_b128 a[100:103], v41 offset:63488
    v_mfma_f32_16x16x32_bf16 v[220:223], a[204:207], a[36:39], v[220:223]
    v_perm_b32 v60, v102, v35, s36
    v_perm_b32 v62, v102, v35, s37
    v_mfma_f32_16x16x32_bf16 v[224:227], a[208:211], a[114:117], v[224:227]
    s_waitcnt lgkmcnt(8)
    ds_read_b32 a140, v60
    ds_read_b32 a141, v62
    v_mfma_f32_16x16x32_bf16 v[224:227], a[212:215], a[42:45], v[224:227]
    v_perm_b32 v61, v102, v35, s38
    v_perm_b32 v63, v102, v35, s39
    v_mfma_f32_16x16x32_bf16 v[228:231], a[208:211], a[122:125], v[228:231]
    ds_read_b32 a142, v61
    ds_read_b32 a143, v63
    v_mfma_f32_16x16x32_bf16 v[228:231], a[212:215], a[50:53], v[228:231]
    v_perm_b32 v56, v99, v35, s36
    v_perm_b32 v57, v99, v35, s37
    v_mfma_f32_16x16x32_bf16 v[232:235], a[208:211], a[130:133], v[232:235]
    ds_read_b32 a144, v56
    ds_read_b32 a145, v57
    v_mfma_f32_16x16x32_bf16 v[232:235], a[212:215], a[58:61], v[232:235]
    v_perm_b32 v58, v103, v35, s36
    v_perm_b32 v59, v103, v35, s37
    v_mfma_f32_16x16x32_bf16 v[236:239], a[208:211], a[2:5], v[236:239]
    ds_read_b32 a146, v58
    ds_read_b32 a147, v59
    v_mfma_f32_16x16x32_bf16 v[236:239], a[212:215], a[66:69], v[236:239]
    v_perm_b32 v60, v107, v35, s36
    v_perm_b32 v62, v107, v35, s37
    v_mfma_f32_16x16x32_bf16 v[240:243], a[208:211], a[10:13], v[240:243]
    ds_read_b32 a148, v60
    ds_read_b32 a149, v62
    v_mfma_f32_16x16x32_bf16 v[240:243], a[212:215], a[74:77], v[240:243]
    v_perm_b32 v61, v111, v35, s36
    v_perm_b32 v63, v111, v35, s37
    v_mfma_f32_16x16x32_bf16 v[244:247], a[208:211], a[18:21], v[244:247]
    s_add_u32 s56, s55, 1536
    ds_read_b32 a150, v61
    ds_read_b32 a151, v63
    v_mfma_f32_16x16x32_bf16 v[244:247], a[212:215], a[82:85], v[244:247]
    s_waitcnt vmcnt(12) lgkmcnt(8)
    v_perm_b32 v56, v104, v35, s36
    v_perm_b32 v57, v104, v35, s37
    v_mfma_f32_16x16x32_bf16 v[248:251], a[208:211], a[26:29], v[248:251]
    s_barrier
    v_mfma_f32_16x16x32_bf16 v[248:251], a[212:215], a[90:93], v[248:251]
    s_add_u32 m0, s57, 32768
    ds_read_b32 a152, v56
    ds_read_b32 a153, v57
    v_mfma_f32_16x16x32_bf16 v[252:255], a[208:211], a[34:37], v[252:255]
    v_perm_b32 v58, v104, v35, s38
    v_perm_b32 v59, v104, v35, s39
    v_mfma_f32_16x16x32_bf16 v[252:255], a[212:215], a[98:101], v[252:255]
    ds_read_b32 a154, v58
    ds_read_b32 a155, v59
    v_mfma_f32_16x16x32_bf16 v[128:131], a[216:219], a[40:43], v[128:131]
    buffer_load_dwordx4 v36, s[8:11], s56 offen offset:0 lds
    v_mfma_f32_16x16x32_bf16 v[128:131], a[220:223], a[44:47], v[128:131]
    ds_read_b128 a[104:107], v42 offset:0
    v_perm_b32 v60, v108, v35, s36
    v_mfma_f32_16x16x32_bf16 v[132:135], a[216:219], a[48:51], v[132:135]
    v_perm_b32 v62, v108, v35, s37
    v_perm_b32 v61, v108, v35, s38
    v_mfma_f32_16x16x32_bf16 v[132:135], a[220:223], a[52:55], v[132:135]
    ds_read_b32 a156, v60
    ds_read_b32 a157, v62
    v_mfma_f32_16x16x32_bf16 v[136:139], a[216:219], a[56:59], v[136:139]
    buffer_load_dwordx4 v37, s[8:11], s56 offen offset:1024 lds
    v_mfma_f32_16x16x32_bf16 v[136:139], a[220:223], a[60:63], v[136:139]
    ds_read_b32 a158, v61
    ds_read_b128 a[108:111], v43 offset:0
    v_mfma_f32_16x16x32_bf16 v[140:143], a[216:219], a[64:67], v[140:143]
    v_perm_b32 v63, v108, v35, s39
    v_perm_b32 v56, v105, v35, s36
    v_mfma_f32_16x16x32_bf16 v[140:143], a[220:223], a[68:71], v[140:143]
    ds_read_b32 a159, v63
    v_perm_b32 v57, v105, v35, s37
    v_mfma_f32_16x16x32_bf16 v[144:147], a[216:219], a[72:75], v[144:147]
    ds_read_b32 a160, v56
    ds_read_b32 a161, v57
    v_mfma_f32_16x16x32_bf16 v[144:147], a[220:223], a[76:79], v[144:147]
    buffer_load_dwordx4 v[88:91], v32, s[12:15], s45 offen sc1
    v_mfma_f32_16x16x32_bf16 v[148:151], a[216:219], a[80:83], v[148:151]
    s_add_u32 s3, s69, 1536
    ds_read_b128 a[112:115], v42 offset:2048
    v_perm_b32 v58, v105, v35, s38
    v_mfma_f32_16x16x32_bf16 v[148:151], a[220:223], a[84:87], v[148:151]
    ds_read_b32 a162, v58
    v_perm_b32 v59, v105, v35, s39
    v_mfma_f32_16x16x32_bf16 v[152:155], a[216:219], a[88:91], v[152:155]
    ds_read_b32 a163, v59
    ds_read_b128 a[116:119], v43 offset:2048
    v_mfma_f32_16x16x32_bf16 v[152:155], a[220:223], a[92:95], v[152:155]
    buffer_load_dwordx4 v[92:95], v33, s[12:15], s45 offen sc1
    v_mfma_f32_16x16x32_bf16 v[156:159], a[216:219], a[96:99], v[156:159]
    ds_read_b128 a[120:123], v42 offset:4096
    v_perm_b32 v60, v109, v35, s36
    v_mfma_f32_16x16x32_bf16 v[156:159], a[220:223], a[100:103], v[156:159]
    ds_read_b32 a164, v60
    v_perm_b32 v62, v109, v35, s37
    v_mfma_f32_16x16x32_bf16 v[160:163], a[224:227], a[40:43], v[160:163]
    ds_read_b32 a165, v62
    ds_read_b128 a[124:127], v43 offset:4096
    v_mfma_f32_16x16x32_bf16 v[160:163], a[228:231], a[44:47], v[160:163]
    buffer_load_dwordx4 v[48:51], v34, s[12:15], s45 offen sc1
    v_mfma_f32_16x16x32_bf16 v[164:167], a[224:227], a[48:51], v[164:167]
    s_waitcnt vmcnt(14)
    v_bitop3_b32 v61, v115, v119, s76 bitop3:0x7e
    v_perm_b32 v63, v109, v35, s38
    v_mfma_f32_16x16x32_bf16 v[164:167], a[228:231], a[52:55], v[164:167]
    v_cmp_lt_u32 vcc, 0xffff, v61
    v_perm_b32 v56, v109, v35, s39
    v_mfma_f32_16x16x32_bf16 v[168:171], a[224:227], a[56:59], v[168:171]
    ds_read_b32 a166, v63
    ds_read_b32 a167, v56
    v_mfma_f32_16x16x32_bf16 v[168:171], a[228:231], a[60:63], v[168:171]
    buffer_load_dwordx4 v[52:55], v44, s[12:15], s45 offen sc1
    v_mfma_f32_16x16x32_bf16 v[172:175], a[224:227], a[64:67], v[172:175]
    ds_read_b128 a[128:131], v42 offset:6144
    s_cbranch_vccnz L_slow5_0
L_back5_0:
    v_mfma_f32_16x16x32_bf16 v[172:175], a[228:231], a[68:71], v[172:175]
    v_perm_b32 v57, v106, v35, s36
    v_perm_b32 v58, v106, v35, s37
    v_mfma_f32_16x16x32_bf16 v[176:179], a[224:227], a[72:75], v[176:179]
    ds_read_b32 a168, v57
    ds_read_b32 a169, v58
    v_mfma_f32_16x16x32_bf16 v[176:179], a[228:231], a[76:79], v[176:179]
    buffer_load_dwordx4 v38, s[8:11], s56 offen offset:2048 lds
    v_mfma_f32_16x16x32_bf16 v[180:183], a[224:227], a[80:83], v[180:183]
    ds_read_b128 a[132:135], v43 offset:6144
    v_perm_b32 v59, v106, v35, s38
    v_mfma_f32_16x16x32_bf16 v[180:183], a[228:231], a[84:87], v[180:183]
    ds_read_b32 a170, v59
    v_perm_b32 v60, v106, v35, s39
    v_mfma_f32_16x16x32_bf16 v[184:187], a[224:227], a[88:91], v[184:187]
    ds_read_b32 a171, v60
    ds_read_b128 a[0:3], v42 offset:8192
    v_mfma_f32_16x16x32_bf16 v[184:187], a[228:231], a[92:95], v[184:187]
    buffer_load_dwordx4 v39, s[8:11], s56 offen offset:3072 lds
    v_mfma_f32_16x16x32_bf16 v[188:191], a[224:227], a[96:99], v[188:191]
    s_add_u32 m0, s57, 49152
    ds_read_b128 a[4:7], v43 offset:8192
    v_perm_b32 v62, v110, v35, s36
    v_mfma_f32_16x16x32_bf16 v[188:191], a[228:231], a[100:103], v[188:191]
    ds_read_b32 a172, v62
    ds_read_b128 a[8:11], v42 offset:10240
    v_mfma_f32_16x16x32_bf16 v[192:195], a[232:235], a[40:43], v[192:195]
    v_perm_b32 v61, v110, v35, s37
    v_perm_b32 v63, v110, v35, s38
    v_mfma_f32_16x16x32_bf16 v[192:195], a[236:239], a[44:47], v[192:195]
    ds_read_b32 a173, v61
    ds_read_b32 a174, v63
    v_mfma_f32_16x16x32_bf16 v[196:199], a[232:235], a[48:51], v[196:199]
    v_perm_b32 v56, v110, v35, s39
    v_perm_b32 v57, v112, v35, s36
    v_mfma_f32_16x16x32_bf16 v[196:199], a[236:239], a[52:55], v[196:199]
    ds_read_b32 a175, v56
    ds_read_b32 a176, v57
    v_mfma_f32_16x16x32_bf16 v[200:203], a[232:235], a[56:59], v[200:203]
    buffer_load_dwordx4 v36, s[8:11], s3 offen offset:0 lds
    v_mfma_f32_16x16x32_bf16 v[200:203], a[236:239], a[60:63], v[200:203]
    ds_read_b128 a[12:15], v43 offset:10240
    v_perm_b32 v58, v112, v35, s37
    v_mfma_f32_16x16x32_bf16 v[204:207], a[232:235], a[64:67], v[204:207]
    ds_read_b32 a177, v58
    ds_read_b128 a[16:19], v42 offset:12288
    v_mfma_f32_16x16x32_bf16 v[204:207], a[236:239], a[68:71], v[204:207]
    v_perm_b32 v59, v112, v35, s38
    v_perm_b32 v60, v112, v35, s39
    v_mfma_f32_16x16x32_bf16 v[208:211], a[232:235], a[72:75], v[208:211]
    ds_read_b32 a178, v59
    ds_read_b32 a179, v60
    v_mfma_f32_16x16x32_bf16 v[208:211], a[236:239], a[76:79], v[208:211]
    ds_read_b128 a[20:23], v43 offset:12288
    v_perm_b32 v62, v116, v35, s36
    v_mfma_f32_16x16x32_bf16 v[212:215], a[232:235], a[80:83], v[212:215]
    ds_read_b32 a180, v62
    v_perm_b32 v61, v116, v35, s37
    v_mfma_f32_16x16x32_bf16 v[212:215], a[236:239], a[84:87], v[212:215]
    ds_read_b32 a181, v61
    ds_read_b128 a[24:27], v42 offset:14336
    v_mfma_f32_16x16x32_bf16 v[216:219], a[232:235], a[88:91], v[216:219]
    buffer_load_dwordx4 v37, s[8:11], s3 offen offset:1024 lds
    v_mfma_f32_16x16x32_bf16 v[216:219], a[236:239], a[92:95], v[216:219]
    v_perm_b32 v63, v116, v35, s38
    v_perm_b32 v56, v116, v35, s39
    v_mfma_f32_16x16x32_bf16 v[220:223], a[232:235], a[96:99], v[220:223]
    ds_read_b32 a182, v63
    ds_read_b32 a183, v56
    v_mfma_f32_16x16x32_bf16 v[220:223], a[236:239], a[100:103], v[220:223]
    s_waitcnt lgkmcnt(8)
    ds_read_b128 a[28:31], v43 offset:14336
    v_perm_b32 v57, v113, v35, s36
    v_mfma_f32_16x16x32_bf16 v[128:131], a[240:243], a[104:107], v[128:131]
    s_add_u32 s56, s55, 1792
    ds_read_b32 a184, v57
    v_perm_b32 v58, v113, v35, s37
    v_mfma_f32_16x16x32_bf16 v[128:131], a[244:247], a[108:111], v[128:131]
    ds_read_b32 a185, v58
    v_perm_b32 v59, v113, v35, s38
    v_mfma_f32_16x16x32_bf16 v[132:135], a[240:243], a[112:115], v[132:135]
    ds_read_b32 a186, v59
    ds_read_b128 a[32:35], v42 offset:16384
    v_mfma_f32_16x16x32_bf16 v[132:135], a[244:247], a[116:119], v[132:135]
    buffer_load_dwordx4 v38, s[8:11], s3 offen offset:2048 lds
    v_mfma_f32_16x16x32_bf16 v[136:139], a[240:243], a[120:123], v[136:139]
    ds_read_b128 a[36:39], v43 offset:16384
    v_perm_b32 v60, v113, v35, s39
    v_mfma_f32_16x16x32_bf16 v[136:139], a[244:247], a[124:127], v[136:139]
    ds_read_b32 a187, v60
    v_perm_b32 v62, v117, v35, s36
    v_mfma_f32_16x16x32_bf16 v[140:143], a[240:243], a[128:131], v[140:143]
    ds_read_b32 a188, v62
    v_perm_b32 v61, v117, v35, s37
    v_mfma_f32_16x16x32_bf16 v[140:143], a[244:247], a[132:135], v[140:143]
    ds_read_b32 a189, v61
    ds_read_b128 a[40:43], v42 offset:18432
    v_mfma_f32_16x16x32_bf16 v[144:147], a[240:243], a[0:3], v[144:147]
    v_perm_b32 v63, v117, v35, s38
    v_perm_b32 v56, v117, v35, s39
    v_mfma_f32_16x16x32_bf16 v[144:147], a[244:247], a[4:7], v[144:147]
    ds_read_b32 a190, v63
    v_perm_b32 v57, v114, v35, s36
    v_mfma_f32_16x16x32_bf16 v[148:151], a[240:243], a[8:11], v[148:151]
    s_waitcnt lgkmcnt(8)
    ds_read_b32 a191, v56
    ds_read_b32 a192, v57
    v_mfma_f32_16x16x32_bf16 v[148:151], a[244:247], a[12:15], v[148:151]
    buffer_load_dwordx4 v39, s[8:11], s3 offen offset:3072 lds
    v_mfma_f32_16x16x32_bf16 v[152:155], a[240:243], a[16:19], v[152:155]
    s_add_u32 m0, s57, 65536
    ds_read_b128 a[44:47], v43 offset:18432
    v_perm_b32 v58, v114, v35, s37
    v_mfma_f32_16x16x32_bf16 v[152:155], a[244:247], a[20:23], v[152:155]
    s_waitcnt vmcnt(14)
    ds_read_b32 a193, v58
    v_bitop3_b32 v59, v123, v127, s76 bitop3:0x7e
    v_mfma_f32_16x16x32_bf16 v[156:159], a[240:243], a[24:27], v[156:159]
    ds_read_b128 a[48:51], v42 offset:20480
    v_cmp_lt_u32 vcc, 0xffff, v59
    v_mfma_f32_16x16x32_bf16 v[156:159], a[244:247], a[28:31], v[156:159]
    v_perm_b32 v60, v114, v35, s38
    v_perm_b32 v62, v114, v35, s39
    v_mfma_f32_16x16x32_bf16 v[160:163], a[248:251], a[104:107], v[160:163]
    s_add_u32 s3, s69, 1792
    ds_read_b32 a194, v60
    ds_read_b32 a195, v62
    v_mfma_f32_16x16x32_bf16 v[160:163], a[252:255], a[108:111], v[160:163]
    ds_read_b128 a[52:55], v43 offset:20480
    s_cbranch_vccnz L_slow5_1
L_back5_1:
    v_mfma_f32_16x16x32_bf16 v[164:167], a[248:251], a[112:115], v[164:167]
    v_perm_b32 v61, v118, v35, s36
    v_perm_b32 v63, v118, v35, s37
    v_mfma_f32_16x16x32_bf16 v[164:167], a[252:255], a[116:119], v[164:167]
    ds_read_b32 a196, v61
    ds_read_b32 a197, v63
    v_mfma_f32_16x16x32_bf16 v[168:171], a[248:251], a[120:123], v[168:171]
    v_perm_b32 v56, v118, v35, s38
    v_perm_b32 v57, v118, v35, s39
    v_mfma_f32_16x16x32_bf16 v[168:171], a[252:255], a[124:127], v[168:171]
    ds_read_b32 a198, v56
    ds_read_b32 a199, v57
    v_mfma_f32_16x16x32_bf16 v[172:175], a[248:251], a[128:131], v[172:175]
    buffer_load_dwordx4 v[64:67], v22, s[32:35], 0 offen
    v_mfma_f32_16x16x32_bf16 v[172:175], a[252:255], a[132:135], v[172:175]
    ds_read_b128 a[56:59], v42 offset:22528
    v_perm_b32 v58, v115, v35, s36
    v_mfma_f32_16x16x32_bf16 v[176:179], a[248:251], a[0:3], v[176:179]
    ds_read_b32 a200, v58
    ds_read_b128 a[60:63], v43 offset:22528
    v_mfma_f32_16x16x32_bf16 v[176:179], a[252:255], a[4:7], v[176:179]
    ds_read_b128 a[64:67], v42 offset:24576
    v_perm_b32 v59, v115, v35, s37
    v_mfma_f32_16x16x32_bf16 v[180:183], a[248:251], a[8:11], v[180:183]
    v_perm_b32 v60, v119, v35, s36
    v_perm_b32 v62, v119, v35, s37
    v_mfma_f32_16x16x32_bf16 v[180:183], a[252:255], a[12:15], v[180:183]
    ds_read_b32 a201, v59
    ds_read_b32 a202, v60
    v_mfma_f32_16x16x32_bf16 v[184:187], a[248:251], a[16:19], v[184:187]
    buffer_load_dwordx2 v[68:69], v22, s[32:35], 0 offen offset:16
    v_mfma_f32_16x16x32_bf16 v[184:187], a[252:255], a[20:23], v[184:187]
    ds_read_b32 a203, v62
    ds_read_b128 a[68:71], v43 offset:24576
    v_mfma_f32_16x16x32_bf16 v[188:191], a[248:251], a[24:27], v[188:191]
    v_perm_b32 v61, v123, v35, s36
    v_perm_b32 v63, v123, v35, s37
    v_mfma_f32_16x16x32_bf16 v[188:191], a[252:255], a[28:31], v[188:191]
    ds_read_b32 a204, v61
    ds_read_b32 a205, v63
    v_mfma_f32_16x16x32_bf16 v[192:195], a[136:139], a[104:107], v[192:195]
    v_perm_b32 v56, v127, v35, s36
    v_perm_b32 v57, v127, v35, s37
    v_mfma_f32_16x16x32_bf16 v[192:195], a[140:143], a[108:111], v[192:195]
    ds_read_b32 a206, v56
    ds_read_b32 a207, v57
    v_mfma_f32_16x16x32_bf16 v[196:199], a[136:139], a[112:115], v[196:199]
    buffer_load_dword v70, v23, s[32:35], 0 offen
    v_mfma_f32_16x16x32_bf16 v[196:199], a[140:143], a[116:119], v[196:199]
    ds_read_b128 a[72:75], v42 offset:26624
    v_perm_b32 v58, v120, v35, s36
    v_mfma_f32_16x16x32_bf16 v[200:203], a[136:139], a[120:123], v[200:203]
    ds_read_b32 a208, v58
    ds_read_b128 a[76:79], v43 offset:26624
    v_mfma_f32_16x16x32_bf16 v[200:203], a[140:143], a[124:127], v[200:203]
    ds_read_b128 a[80:83], v42 offset:28672
    v_perm_b32 v59, v120, v35, s37
    v_mfma_f32_16x16x32_bf16 v[204:207], a[136:139], a[128:131], v[204:207]
    ds_read_b32 a209, v59
    v_perm_b32 v60, v120, v35, s38
    v_mfma_f32_16x16x32_bf16 v[204:207], a[140:143], a[132:135], v[204:207]
    ds_read_b32 a210, v60
    v_perm_b32 v62, v120, v35, s39
    v_mfma_f32_16x16x32_bf16 v[208:211], a[136:139], a[0:3], v[208:211]
    ds_read_b32 a211, v62
    ds_read_b128 a[84:87], v43 offset:28672
    v_mfma_f32_16x16x32_bf16 v[208:211], a[140:143], a[4:7], v[208:211]
    v_perm_b32 v61, v124, v35, s36
    v_perm_b32 v63, v124, v35, s37
    v_mfma_f32_16x16x32_bf16 v[212:215], a[136:139], a[8:11], v[212:215]
    ds_read_b32 a212, v61
    ds_read_b32 a213, v63
    v_mfma_f32_16x16x32_bf16 v[212:215], a[140:143], a[12:15], v[212:215]
    ds_read_b128 a[88:91], v42 offset:30720
    v_perm_b32 v56, v124, v35, s38
    v_mfma_f32_16x16x32_bf16 v[216:219], a[136:139], a[16:19], v[216:219]
    ds_read_b32 a214, v56
    v_perm_b32 v57, v124, v35, s39
    v_mfma_f32_16x16x32_bf16 v[216:219], a[140:143], a[20:23], v[216:219]
    ds_read_b32 a215, v57
    v_perm_b32 v58, v121, v35, s36
    v_mfma_f32_16x16x32_bf16 v[220:223], a[136:139], a[24:27], v[220:223]
    ds_read_b32 a216, v58
    ds_read_b128 a[92:95], v43 offset:30720
    v_mfma_f32_16x16x32_bf16 v[220:223], a[140:143], a[28:31], v[220:223]
    v_perm_b32 v59, v121, v35, s37
    v_perm_b32 v60, v121, v35, s38
    v_mfma_f32_16x16x32_bf16 v[224:227], a[144:147], a[106:109], v[224:227]
    s_waitcnt lgkmcnt(9)
    ds_read_b32 a217, v59
    v_perm_b32 v62, v121, v35, s39
    v_mfma_f32_16x16x32_bf16 v[224:227], a[148:151], a[34:37], v[224:227]
    ds_read_b32 a218, v60
    v_mfma_f32_16x16x32_bf16 v[228:231], a[144:147], a[114:117], v[228:231]
    buffer_load_dwordx4 v[72:75], v32, s[12:15], s72 offen sc1
    v_mfma_f32_16x16x32_bf16 v[228:231], a[148:151], a[42:45], v[228:231]
    ds_read_b32 a219, v62
    v_perm_b32 v61, v125, v35, s36
    v_mfma_f32_16x16x32_bf16 v[232:235], a[144:147], a[122:125], v[232:235]
    ds_read_b32 a220, v61
    v_perm_b32 v63, v125, v35, s37
    v_mfma_f32_16x16x32_bf16 v[232:235], a[148:151], a[50:53], v[232:235]
    ds_read_b32 a221, v63
    v_mfma_f32_16x16x32_bf16 v[236:239], a[144:147], a[130:133], v[236:239]
    buffer_load_dwordx4 v[76:79], v33, s[12:15], s72 offen sc1
    v_mfma_f32_16x16x32_bf16 v[236:239], a[148:151], a[58:61], v[236:239]
    v_perm_b32 v56, v125, v35, s38
    v_perm_b32 v57, v125, v35, s39
    v_mfma_f32_16x16x32_bf16 v[240:243], a[144:147], a[2:5], v[240:243]
    ds_read_b32 a222, v56
    v_perm_b32 v58, v122, v35, s36
    v_mfma_f32_16x16x32_bf16 v[240:243], a[148:151], a[66:69], v[240:243]
    ds_read_b32 a223, v57
    v_mfma_f32_16x16x32_bf16 v[244:247], a[144:147], a[10:13], v[244:247]
    buffer_load_dwordx4 v[80:83], v34, s[12:15], s72 offen sc1
    v_mfma_f32_16x16x32_bf16 v[244:247], a[148:151], a[74:77], v[244:247]
    s_waitcnt vmcnt(14) lgkmcnt(5)
    ds_read_b32 a224, v58
    v_bitop3_b32 v59, v91, v95, s76 bitop3:0x7e
    v_mfma_f32_16x16x32_bf16 v[248:251], a[144:147], a[18:21], v[248:251]
    s_barrier
    v_mfma_f32_16x16x32_bf16 v[248:251], a[148:151], a[82:85], v[248:251]
    v_cmp_lt_u32 vcc, 0xffff, v59
    v_mfma_f32_16x16x32_bf16 v[252:255], a[144:147], a[26:29], v[252:255]
    buffer_load_dwordx4 v[84:87], v44, s[12:15], s72 offen sc1
    v_mfma_f32_16x16x32_bf16 v[252:255], a[148:151], a[90:93], v[252:255]
    v_perm_b32 v60, v122, v35, s37
    s_cbranch_vccnz L_slow6_0
L_back6_0:
    v_mfma_f32_16x16x32_bf16 v[128:131], a[152:155], a[32:35], v[128:131]
    s_waitcnt vmcnt(13)
    v_bitop3_b32 v62, v51, v55, s76 bitop3:0x7e
    v_perm_b32 v61, v122, v35, s38
    v_mfma_f32_16x16x32_bf16 v[128:131], a[156:159], a[36:39], v[128:131]
    ds_read_b32 a225, v60
    ds_read_b32 a226, v61
    v_mfma_f32_16x16x32_bf16 v[132:135], a[152:155], a[40:43], v[132:135]
    buffer_load_dwordx4 v36, s[8:11], s56 offen offset:0 lds
L_pad3:
    s_cbranch_execz L_pad4
    v_mfma_f32_16x16x32_bf16 v[132:135], a[156:159], a[44:47], v[132:135]
    ds_read_b128 a[96:99], v40 offset:0
    v_cmp_lt_u32 vcc, 0xffff, v62
    v_mfma_f32_16x16x32_bf16 v[136:139], a[152:155], a[48:51], v[136:139]
    v_perm_b32 v63, v122, v35, s39
    v_perm_b32 v56, v126, v35, s36
    v_mfma_f32_16x16x32_bf16 v[136:139], a[156:159], a[52:55], v[136:139]
    ds_read_b32 a227, v63
    ds_read_b32 a228, v56
    v_mfma_f32_16x16x32_bf16 v[140:143], a[152:155], a[56:59], v[140:143]
    buffer_load_dwordx4 v37, s[8:11], s56 offen offset:1024 lds
    v_mfma_f32_16x16x32_bf16 v[140:143], a[156:159], a[60:63], v[140:143]
    ds_read_b128 a[100:103], v41 offset:0
    s_cbranch_vccnz L_slow6_1
L_back6_1:
    v_mfma_f32_16x16x32_bf16 v[144:147], a[152:155], a[64:67], v[144:147]
    v_perm_b32 v57, v126, v35, s37
    v_perm_b32 v58, v126, v35, s38
    v_mfma_f32_16x16x32_bf16 v[144:147], a[156:159], a[68:71], v[144:147]
    ds_read_b32 a229, v57
    ds_read_b32 a230, v58
    v_mfma_f32_16x16x32_bf16 v[148:151], a[152:155], a[72:75], v[148:151]
    buffer_load_dwordx4 v38, s[8:11], s56 offen offset:2048 lds
    v_mfma_f32_16x16x32_bf16 v[148:151], a[156:159], a[76:79], v[148:151]
    ds_read_b128 a[104:107], v40 offset:2048
    v_perm_b32 v59, v126, v35, s39
    v_mfma_f32_16x16x32_bf16 v[152:155], a[152:155], a[80:83], v[152:155]
    ds_read_b32 a231, v59
    v_perm_b32 v60, v91, v35, s36
    v_mfma_f32_16x16x32_bf16 v[152:155], a[156:159], a[84:87], v[152:155]
    ds_read_b32 a232, v60
    ds_read_b128 a[108:111], v41 offset:2048
    v_mfma_f32_16x16x32_bf16 v[156:159], a[152:155], a[88:91], v[156:159]
    buffer_load_dwordx4 v39, s[8:11], s56 offen offset:3072 lds
    v_mfma_f32_16x16x32_bf16 v[156:159], a[156:159], a[92:95], v[156:159]
    s_add_u32 m0, s57, 81920
    ds_read_b128 a[112:115], v40 offset:4096
    v_perm_b32 v61, v91, v35, s37
    v_mfma_f32_16x16x32_bf16 v[160:163], a[160:163], a[32:35], v[160:163]
    ds_read_b32 a233, v61
    v_perm_b32 v62, v95, v35, s36
    v_mfma_f32_16x16x32_bf16 v[160:163], a[164:167], a[36:39], v[160:163]
    ds_read_b32 a234, v62
    ds_read_b128 a[116:119], v41 offset:4096
    v_mfma_f32_16x16x32_bf16 v[164:167], a[160:163], a[40:43], v[164:167]
    buffer_load_dwordx4 v36, s[8:11], s3 offen offset:0 lds
    v_mfma_f32_16x16x32_bf16 v[164:167], a[164:167], a[44:47], v[164:167]
    ds_read_b128 a[120:123], v40 offset:6144
    v_perm_b32 v63, v95, v35, s37
    v_mfma_f32_16x16x32_bf16 v[168:171], a[160:163], a[48:51], v[168:171]
    v_perm_b32 v56, v51, v35, s36
    v_perm_b32 v57, v51, v35, s37
    v_mfma_f32_16x16x32_bf16 v[168:171], a[164:167], a[52:55], v[168:171]
    ds_read_b32 a235, v63
    ds_read_b32 a236, v56
    v_mfma_f32_16x16x32_bf16 v[172:175], a[160:163], a[56:59], v[172:175]
    buffer_load_dwordx4 v37, s[8:11], s3 offen offset:1024 lds
    v_mfma_f32_16x16x32_bf16 v[172:175], a[164:167], a[60:63], v[172:175]
    ds_read_b32 a237, v57
    ds_read_b128 a[124:127], v41 offset:6144
    v_mfma_f32_16x16x32_bf16 v[176:179], a[160:163], a[64:67], v[176:179]
    v_perm_b32 v58, v55, v35, s36
    v_perm_b32 v59, v55, v35, s37
    v_mfma_f32_16x16x32_bf16 v[176:179], a[164:167], a[68:71], v[176:179]
    ds_read_b32 a238, v58
    ds_read_b32 a239, v59
    v_mfma_f32_16x16x32_bf16 v[180:183], a[160:163], a[72:75], v[180:183]
    buffer_load_dwordx4 v38, s[8:11], s3 offen offset:2048 lds
    v_mfma_f32_16x16x32_bf16 v[180:183], a[164:167], a[76:79], v[180:183]
    ds_read_b128 a[128:131], v40 offset:8192
    v_perm_b32 v60, v88, v35, s36
    v_mfma_f32_16x16x32_bf16 v[184:187], a[160:163], a[80:83], v[184:187]
    ds_read_b32 a240, v60
    ds_read_b128 a[132:135], v41 offset:8192
    v_mfma_f32_16x16x32_bf16 v[184:187], a[164:167], a[84:87], v[184:187]
    v_perm_b32 v61, v88, v35, s37
    v_perm_b32 v62, v88, v35, s38
    v_mfma_f32_16x16x32_bf16 v[188:191], a[160:163], a[88:91], v[188:191]
    ds_read_b32 a241, v61
    ds_read_b32 a242, v62
    v_mfma_f32_16x16x32_bf16 v[188:191], a[164:167], a[92:95], v[188:191]
    buffer_load_dwordx4 v39, s[8:11], s3 offen offset:3072 lds
    v_mfma_f32_16x16x32_bf16 v[192:195], a[168:171], a[32:35], v[192:195]
    ds_read_b128 a[0:3], v40 offset:10240
    v_perm_b32 v63, v88, v35, s39
    v_mfma_f32_16x16x32_bf16 v[192:195], a[172:175], a[36:39], v[192:195]
    ds_read_b32 a243, v63
    v_perm_b32 v56, v92, v35, s36
    v_mfma_f32_16x16x32_bf16 v[196:199], a[168:171], a[40:43], v[196:199]
    ds_read_b32 a244, v56
    ds_read_b128 a[4:7], v41 offset:10240
    v_mfma_f32_16x16x32_bf16 v[196:199], a[172:175], a[44:47], v[196:199]
    v_perm_b32 v57, v92, v35, s37
    v_perm_b32 v58, v92, v35, s38
    v_mfma_f32_16x16x32_bf16 v[200:203], a[168:171], a[48:51], v[200:203]
    ds_read_b32 a245, v57
    ds_read_b32 a246, v58
    v_mfma_f32_16x16x32_bf16 v[200:203], a[172:175], a[52:55], v[200:203]
    ds_read_b128 a[8:11], v40 offset:12288
    v_perm_b32 v59, v92, v35, s39
    v_mfma_f32_16x16x32_bf16 v[204:207], a[168:171], a[56:59], v[204:207]
    ds_read_b32 a247, v59
    v_perm_b32 v60, v48, v35, s36
    v_mfma_f32_16x16x32_bf16 v[204:207], a[172:175], a[60:63], v[204:207]
    ds_read_b32 a248, v60
    v_perm_b32 v61, v48, v35, s37
    v_mfma_f32_16x16x32_bf16 v[208:211], a[168:171], a[64:67], v[208:211]
    ds_read_b32 a249, v61
    ds_read_b128 a[12:15], v41 offset:12288
    v_mfma_f32_16x16x32_bf16 v[208:211], a[172:175], a[68:71], v[208:211]
    v_perm_b32 v62, v48, v35, s38
    v_perm_b32 v63, v48, v35, s39
    v_mfma_f32_16x16x32_bf16 v[212:215], a[168:171], a[72:75], v[212:215]
    ds_read_b32 a250, v62
    ds_read_b32 a251, v63
    v_mfma_f32_16x16x32_bf16 v[212:215], a[172:175], a[76:79], v[212:215]
    ds_read_b128 a[16:19], v40 offset:14336
    v_perm_b32 v56, v52, v35, s36
    v_mfma_f32_16x16x32_bf16 v[216:219], a[168:171], a[80:83], v[216:219]
    ds_read_b32 a252, v56
    v_perm_b32 v57, v52, v35, s37
    v_mfma_f32_16x16x32_bf16 v[216:219], a[172:175], a[84:87], v[216:219]
    ds_read_b32 a253, v57
    v_perm_b32 v58, v52, v35, s38
    v_mfma_f32_16x16x32_bf16 v[220:223], a[168:171], a[88:91], v[220:223]
    ds_read_b32 a254, v58
    ds_read_b128 a[20:23], v41 offset:14336
    v_mfma_f32_16x16x32_bf16 v[220:223], a[172:175], a[92:95], v[220:223]
    s_waitcnt lgkmcnt(10)
    v_perm_b32 v59, v52, v35, s39
    v_perm_b32 v60, v89, v35, s36
    v_mfma_f32_16x16x32_bf16 v[128:131], a[176:179], a[96:99], v[128:131]
    ds_read_b32 a255, v59
    ds_read_b32 a136, v60
    v_mfma_f32_16x16x32_bf16 v[128:131], a[180:183], a[100:103], v[128:131]
    ds_read_b128 a[24:27], v40 offset:16384
    v_perm_b32 v61, v89, v35, s37
    v_mfma_f32_16x16x32_bf16 v[132:135], a[176:179], a[104:107], v[132:135]
    ds_read_b32 a137, v61
    v_perm_b32 v62, v89, v35, s38
    v_mfma_f32_16x16x32_bf16 v[132:135], a[180:183], a[108:111], v[132:135]
    ds_read_b32 a138, v62
    v_perm_b32 v63, v89, v35, s39
    v_mfma_f32_16x16x32_bf16 v[136:139], a[176:179], a[112:115], v[136:139]
    ds_read_b32 a139, v63
    ds_read_b128 a[28:31], v41 offset:16384
    v_mfma_f32_16x16x32_bf16 v[136:139], a[180:183], a[116:119], v[136:139]
    v_perm_b32 v56, v93, v35, s36
    v_perm_b32 v57, v93, v35, s37
    v_mfma_f32_16x16x32_bf16 v[140:143], a[176:179], a[120:123], v[140:143]
    ds_read_b32 a140, v56
    ds_read_b32 a141, v57
    v_mfma_f32_16x16x32_bf16 v[140:143], a[180:183], a[124:127], v[140:143]
    ds_read_b128 a[32:35], v40 offset:18432
    v_perm_b32 v58, v93, v35, s38
    v_mfma_f32_16x16x32_bf16 v[144:147], a[176:179], a[128:131], v[144:147]
    ds_read_b32 a142, v58
    v_perm_b32 v59, v93, v35, s39
    v_mfma_f32_16x16x32_bf16 v[144:147], a[180:183], a[132:135], v[144:147]
    ds_read_b32 a143, v59
    v_perm_b32 v60, v49, v35, s36
    v_mfma_f32_16x16x32_bf16 v[148:151], a[176:179], a[0:3], v[148:151]
    ds_read_b32 a144, v60
    ds_read_b128 a[36:39], v41 offset:18432
    v_mfma_f32_16x16x32_bf16 v[148:151], a[180:183], a[4:7], v[148:151]
    v_perm_b32 v61, v49, v35, s37
    v_perm_b32 v62, v49, v35, s38
    v_mfma_f32_16x16x32_bf16 v[152:155], a[176:179], a[8:11], v[152:155]
    s_waitcnt lgkmcnt(9)
    ds_read_b32 a145, v61
    v_mfma_f32_16x16x32_bf16 v[152:155], a[180:183], a[12:15], v[152:155]
    ds_read_b32 a146, v62
    ds_read_b128 a[40:43], v40 offset:20480
    v_mfma_f32_16x16x32_bf16 v[156:159], a[176:179], a[16:19], v[156:159]
    v_perm_b32 v63, v49, v35, s39
    v_perm_b32 v56, v53, v35, s36
    v_mfma_f32_16x16x32_bf16 v[156:159], a[180:183], a[20:23], v[156:159]
    ds_read_b32 a147, v63
    v_mfma_f32_16x16x32_bf16 v[160:163], a[184:187], a[96:99], v[160:163]
    ds_read_b32 a148, v56
    ds_read_b128 a[44:47], v41 offset:20480
    v_mfma_f32_16x16x32_bf16 v[160:163], a[188:191], a[100:103], v[160:163]
    v_perm_b32 v57, v53, v35, s37
    v_mfma_f32_16x16x32_bf16 v[164:167], a[184:187], a[104:107], v[164:167]
    ds_read_b32 a149, v57
    v_perm_b32 v58, v53, v35, s38
    v_mfma_f32_16x16x32_bf16 v[164:167], a[188:191], a[108:111], v[164:167]
    ds_read_b128 a[48:51], v40 offset:22528
    v_perm_b32 v59, v53, v35, s39
    v_mfma_f32_16x16x32_bf16 v[168:171], a[184:187], a[112:115], v[168:171]
    ds_read_b32 a150, v58
    v_mfma_f32_16x16x32_bf16 v[168:171], a[188:191], a[116:119], v[168:171]
    ds_read_b32 a151, v59
    v_perm_b32 v60, v90, v35, s36
    v_mfma_f32_16x16x32_bf16 v[172:175], a[184:187], a[120:123], v[172:175]
    ds_read_b128 a[52:55], v41 offset:22528
    v_perm_b32 v61, v90, v35, s37
    v_mfma_f32_16x16x32_bf16 v[172:175], a[188:191], a[124:127], v[172:175]
    ds_read_b32 a152, v60
    v_mfma_f32_16x16x32_bf16 v[176:179], a[184:187], a[128:131], v[176:179]
    ds_read_b32 a153, v61
    v_perm_b32 v62, v90, v35, s38
    v_mfma_f32_16x16x32_bf16 v[176:179], a[188:191], a[132:135], v[176:179]
    ds_read_b128 a[56:59], v40 offset:24576
    v_mfma_f32_16x16x32_bf16 v[180:183], a[184:187], a[0:3], v[180:183]
    ds_read_b32 a154, v62
    v_perm_b32 v63, v90, v35, s39
    v_mfma_f32_16x16x32_bf16 v[180:183], a[188:191], a[4:7], v[180:183]
    v_perm_b32 v56, v94, v35, s36
    v_mfma_f32_16x16x32_bf16 v[184:187], a[184:187], a[8:11], v[184:187]
    ds_read_b32 a155, v63
    ds_read_b128 a[60:63], v41 offset:24576
    v_mfma_f32_16x16x32_bf16 v[184:187], a[188:191], a[12:15], v[184:187]
    ds_read_b32 a156, v56
    v_perm_b32 v57, v94, v35, s37
    v_mfma_f32_16x16x32_bf16 v[188:191], a[184:187], a[16:19], v[188:191]
    v_perm_b32 v58, v94, v35, s38
    v_mfma_f32_16x16x32_bf16 v[188:191], a[188:191], a[20:23], v[188:191]
    ds_read_b32 a157, v57
    ds_read_b128 a[64:67], v40 offset:26624
    v_mfma_f32_16x16x32_bf16 v[192:195], a[192:195], a[96:99], v[192:195]
    ds_read_b32 a158, v58
    v_perm_b32 v59, v94, v35, s39
    v_mfma_f32_16x16x32_bf16 v[192:195], a[196:199], a[100:103], v[192:195]
    v_mfma_f32_16x16x32_bf16 v[196:199], a[192:195], a[104:107], v[196:199]
    ds_read_b32 a159, v59
    ds_read_b128 a[68:71], v41 offset:26624
    v_mfma_f32_16x16x32_bf16 v[196:199], a[196:199], a[108:111], v[196:199]
    s_waitcnt vmcnt(10)
    v_bitop3_b32 v60, v75, v79, s76 bitop3:0x7e
    v_perm_b32 v61, v50, v35, s36
    v_mfma_f32_16x16x32_bf16 v[200:203], a[192:195], a[112:115], v[200:203]
    ds_read_b32 a160, v61
    v_cmp_lt_u32 vcc, 0xffff, v60
    v_mfma_f32_16x16x32_bf16 v[200:203], a[196:199], a[116:119], v[200:203]
    ds_read_b128 a[72:75], v40 offset:28672
    v_perm_b32 v62, v50, v35, s37
    v_mfma_f32_16x16x32_bf16 v[204:207], a[192:195], a[120:123], v[204:207]
    ds_read_b32 a161, v62
    s_cbranch_vccnz L_slow7_0
L_back7_0:
    v_mfma_f32_16x16x32_bf16 v[204:207], a[196:199], a[124:127], v[204:207]
    v_perm_b32 v63, v50, v35, s38
    v_perm_b32 v56, v50, v35, s39
    v_mfma_f32_16x16x32_bf16 v[208:211], a[192:195], a[128:131], v[208:211]
    ds_read_b32 a162, v63
    ds_read_b32 a163, v56
    v_mfma_f32_16x16x32_bf16 v[208:211], a[196:199], a[132:135], v[208:211]
    ds_read_b128 a[76:79], v41 offset:28672
    v_perm_b32 v57, v54, v35, s36
    v_mfma_f32_16x16x32_bf16 v[212:215], a[192:195], a[0:3], v[212:215]
    s_waitcnt vmcnt(8)
    ds_read_b32 a164, v57
    v_bitop3_b32 v58, v83, v87, s76 bitop3:0x7e
    v_mfma_f32_16x16x32_bf16 v[212:215], a[196:199], a[4:7], v[212:215]
    ds_read_b128 a[80:83], v40 offset:30720
    v_cmp_lt_u32 vcc, 0xffff, v58
    v_mfma_f32_16x16x32_bf16 v[216:219], a[192:195], a[8:11], v[216:219]
    v_perm_b32 v59, v54, v35, s37
    v_perm_b32 v60, v54, v35, s38
    v_mfma_f32_16x16x32_bf16 v[216:219], a[196:199], a[12:15], v[216:219]
    ds_read_b32 a165, v59
    s_cbranch_vccnz L_slow7_1
L_back7_1:
    v_mfma_f32_16x16x32_bf16 v[220:223], a[192:195], a[16:19], v[220:223]
    ds_read_b32 a166, v60
    ds_read_b128 a[84:87], v41 offset:30720
    v_mfma_f32_16x16x32_bf16 v[220:223], a[196:199], a[20:23], v[220:223]
    v_perm_b32 v61, v54, v35, s39
    v_perm_b32 v62, v75, v35, s36
    v_mfma_f32_16x16x32_bf16 v[224:227], a[200:203], a[98:101], v[224:227]
    s_waitcnt lgkmcnt(8)
    ds_read_b32 a167, v61
    ds_read_b32 a168, v62
    v_mfma_f32_16x16x32_bf16 v[224:227], a[204:207], a[26:29], v[224:227]
    v_perm_b32 v63, v75, v35, s37
    v_mfma_f32_16x16x32_bf16 v[228:231], a[200:203], a[106:109], v[228:231]
    ds_read_b32 a169, v63
    v_perm_b32 v56, v79, v35, s36
    v_mfma_f32_16x16x32_bf16 v[228:231], a[204:207], a[34:37], v[228:231]
    v_perm_b32 v57, v79, v35, s37
    v_mfma_f32_16x16x32_bf16 v[232:235], a[200:203], a[114:117], v[232:235]
    ds_read_b32 a170, v56
    v_mfma_f32_16x16x32_bf16 v[232:235], a[204:207], a[42:45], v[232:235]
    ds_read_b32 a171, v57
    v_perm_b32 v58, v83, v35, s36
    v_mfma_f32_16x16x32_bf16 v[236:239], a[200:203], a[122:125], v[236:239]
    v_perm_b32 v59, v83, v35, s37
    v_mfma_f32_16x16x32_bf16 v[236:239], a[204:207], a[50:53], v[236:239]
    ds_read_b32 a172, v58
    v_mfma_f32_16x16x32_bf16 v[240:243], a[200:203], a[130:133], v[240:243]
    ds_read_b32 a173, v59
    v_perm_b32 v60, v87, v35, s36
    v_mfma_f32_16x16x32_bf16 v[240:243], a[204:207], a[58:61], v[240:243]
    v_mfma_f32_16x16x32_bf16 v[244:247], a[200:203], a[2:5], v[244:247]
    ds_read_b32 a174, v60
    v_perm_b32 v61, v87, v35, s37
    v_mfma_f32_16x16x32_bf16 v[244:247], a[204:207], a[66:69], v[244:247]
    s_waitcnt lgkmcnt(5)
    v_perm_b32 v62, v72, v35, s36
    v_mfma_f32_16x16x32_bf16 v[248:251], a[200:203], a[10:13], v[248:251]
    s_barrier
    v_mfma_f32_16x16x32_bf16 v[248:251], a[204:207], a[74:77], v[248:251]
    ds_read_b32 a175, v61
    ds_read_b32 a176, v62
    v_mfma_f32_16x16x32_bf16 v[252:255], a[200:203], a[18:21], v[252:255]
    v_perm_b32 v63, v72, v35, s37
    v_perm_b32 v56, v72, v35, s38
    v_mfma_f32_16x16x32_bf16 v[252:255], a[204:207], a[82:85], v[252:255]
    ds_read_b32 a177, v63
    v_mfma_f32_16x16x32_bf16 v[128:131], a[208:211], a[24:27], v[128:131]
    ds_read_b32 a178, v56
    v_perm_b32 v57, v72, v35, s39
    v_mfma_f32_16x16x32_bf16 v[128:131], a[212:215], a[28:31], v[128:131]
    v_mfma_f32_16x16x32_bf16 v[132:135], a[208:211], a[32:35], v[132:135]
    ds_read_b32 a179, v57
    v_perm_b32 v58, v76, v35, s36
    v_mfma_f32_16x16x32_bf16 v[132:135], a[212:215], a[36:39], v[132:135]
    v_perm_b32 v59, v76, v35, s37
    v_mfma_f32_16x16x32_bf16 v[136:139], a[208:211], a[40:43], v[136:139]
    ds_read_b32 a180, v58
    v_mfma_f32_16x16x32_bf16 v[136:139], a[212:215], a[44:47], v[136:139]
    ds_read_b32 a181, v59
    v_perm_b32 v60, v76, v35, s38
    v_mfma_f32_16x16x32_bf16 v[140:143], a[208:211], a[48:51], v[140:143]
    v_perm_b32 v61, v76, v35, s39
    v_mfma_f32_16x16x32_bf16 v[140:143], a[212:215], a[52:55], v[140:143]
    ds_read_b32 a182, v60
    v_mfma_f32_16x16x32_bf16 v[144:147], a[208:211], a[56:59], v[144:147]
    ds_read_b32 a183, v61
    v_perm_b32 v62, v80, v35, s36
    v_mfma_f32_16x16x32_bf16 v[144:147], a[212:215], a[60:63], v[144:147]
    v_mfma_f32_16x16x32_bf16 v[148:151], a[208:211], a[64:67], v[148:151]
    ds_read_b32 a184, v62
    v_perm_b32 v63, v80, v35, s37
    v_mfma_f32_16x16x32_bf16 v[148:151], a[212:215], a[68:71], v[148:151]
    v_perm_b32 v56, v80, v35, s38
    v_mfma_f32_16x16x32_bf16 v[152:155], a[208:211], a[72:75], v[152:155]
    ds_read_b32 a185, v63
    v_mfma_f32_16x16x32_bf16 v[152:155], a[212:215], a[76:79], v[152:155]
    ds_read_b32 a186, v56
    v_perm_b32 v57, v80, v35, s39
    v_mfma_f32_16x16x32_bf16 v[156:159], a[208:211], a[80:83], v[156:159]
    ds_read_b128 a[88:91], v40 offset:32768
    v_perm_b32 v58, v84, v35, s36
    v_mfma_f32_16x16x32_bf16 v[156:159], a[212:215], a[84:87], v[156:159]
    ds_read_b32 a187, v57
    v_mfma_f32_16x16x32_bf16 v[160:163], a[216:219], a[24:27], v[160:163]
    ds_read_b32 a188, v58
    v_perm_b32 v59, v84, v35, s37
    v_mfma_f32_16x16x32_bf16 v[160:163], a[220:223], a[28:31], v[160:163]
    ds_read_b128 a[92:95], v41 offset:32768
    v_mfma_f32_16x16x32_bf16 v[164:167], a[216:219], a[32:35], v[164:167]
    ds_read_b32 a189, v59
    v_perm_b32 v60, v84, v35, s38
    v_mfma_f32_16x16x32_bf16 v[164:167], a[220:223], a[36:39], v[164:167]
    v_perm_b32 v61, v84, v35, s39
    v_mfma_f32_16x16x32_bf16 v[168:171], a[216:219], a[40:43], v[168:171]
    ds_read_b32 a190, v60
    v_mfma_f32_16x16x32_bf16 v[168:171], a[220:223], a[44:47], v[168:171]
    ds_read_b32 a191, v61
    ds_read_b128 a[96:99], v40 offset:49152
    v_mfma_f32_16x16x32_bf16 v[172:175], a[216:219], a[48:51], v[172:175]
    v_perm_b32 v62, v73, v35, s36
    v_perm_b32 v63, v73, v35, s37
    v_mfma_f32_16x16x32_bf16 v[172:175], a[220:223], a[52:55], v[172:175]
    ds_read_b32 a192, v62
    v_mfma_f32_16x16x32_bf16 v[176:179], a[216:219], a[56:59], v[176:179]
    ds_read_b32 a193, v63
    ds_read_b128 a[100:103], v41 offset:49152
    v_mfma_f32_16x16x32_bf16 v[176:179], a[220:223], a[60:63], v[176:179]
    v_perm_b32 v56, v73, v35, s38
    v_mfma_f32_16x16x32_bf16 v[180:183], a[216:219], a[64:67], v[180:183]
    ds_read_b32 a194, v56
    v_perm_b32 v57, v73, v35, s39
    v_mfma_f32_16x16x32_bf16 v[180:183], a[220:223], a[68:71], v[180:183]
    v_perm_b32 v58, v77, v35, s36
    v_mfma_f32_16x16x32_bf16 v[184:187], a[216:219], a[72:75], v[184:187]
    ds_read_b32 a195, v57
    ds_read_b128 a[104:107], v40 offset:34816
    v_mfma_f32_16x16x32_bf16 v[184:187], a[220:223], a[76:79], v[184:187]
    ds_read_b32 a196, v58
    v_perm_b32 v59, v77, v35, s37
    v_mfma_f32_16x16x32_bf16 v[188:191], a[216:219], a[80:83], v[188:191]
    v_perm_b32 v60, v77, v35, s38
    v_mfma_f32_16x16x32_bf16 v[188:191], a[220:223], a[84:87], v[188:191]
    ds_read_b32 a197, v59
    ds_read_b128 a[108:111], v41 offset:34816
    v_mfma_f32_16x16x32_bf16 v[192:195], a[224:227], a[24:27], v[192:195]
    ds_read_b32 a198, v60
    v_perm_b32 v61, v77, v35, s39
    v_mfma_f32_16x16x32_bf16 v[192:195], a[228:231], a[28:31], v[192:195]
    v_mfma_f32_16x16x32_bf16 v[196:199], a[224:227], a[32:35], v[196:199]
    ds_read_b32 a199, v61
    v_perm_b32 v62, v81, v35, s36
    v_mfma_f32_16x16x32_bf16 v[196:199], a[228:231], a[36:39], v[196:199]
    ds_read_b128 a[112:115], v40 offset:51200
    v_perm_b32 v63, v81, v35, s37
    v_mfma_f32_16x16x32_bf16 v[200:203], a[224:227], a[40:43], v[200:203]
    ds_read_b32 a200, v62
    v_mfma_f32_16x16x32_bf16 v[200:203], a[228:231], a[44:47], v[200:203]
    ds_read_b32 a201, v63
    v_perm_b32 v56, v81, v35, s38
    v_mfma_f32_16x16x32_bf16 v[204:207], a[224:227], a[48:51], v[204:207]
    ds_read_b128 a[116:119], v41 offset:51200
    v_perm_b32 v57, v81, v35, s39
    v_mfma_f32_16x16x32_bf16 v[204:207], a[228:231], a[52:55], v[204:207]
    ds_read_b32 a202, v56
    v_lshlrev_b32 v96, 16, v70
    v_mfma_f32_16x16x32_bf16 v[208:211], a[224:227], a[56:59], v[208:211]
    ds_read_b32 a203, v57
    v_perm_b32 v58, v85, v35, s36
    v_mfma_f32_16x16x32_bf16 v[208:211], a[228:231], a[60:63], v[208:211]
    v_and_b32 v97, 0xffff0000, v70
    v_lshlrev_b32 v100, 16, v64
    v_mfma_f32_16x16x32_bf16 v[212:215], a[224:227], a[64:67], v[212:215]
    ds_read_b32 a204, v58
    v_perm_b32 v59, v85, v35, s37
    v_mfma_f32_16x16x32_bf16 v[212:215], a[228:231], a[68:71], v[212:215]
    v_perm_b32 v60, v85, v35, s38
    v_and_b32 v101, 0xffff0000, v65
    v_mfma_f32_16x16x32_bf16 v[216:219], a[224:227], a[72:75], v[216:219]
    ds_read_b32 a205, v59
    v_lshlrev_b32 v102, 16, v67
    v_mfma_f32_16x16x32_bf16 v[216:219], a[228:231], a[76:79], v[216:219]
    ds_read_b32 a206, v60
    v_perm_b32 v61, v85, v35, s39
    v_mfma_f32_16x16x32_bf16 v[220:223], a[224:227], a[80:83], v[220:223]
    v_perm_b32 v62, v74, v35, s36
    v_and_b32 v103, 0xffff0000, v68
    v_mfma_f32_16x16x32_bf16 v[220:223], a[228:231], a[84:87], v[220:223]
    s_waitcnt vmcnt(0) lgkmcnt(5)
    ds_read_b32 a207, v61
    v_and_b32 v104, 0xffff0000, v64
    v_mfma_f32_16x16x32_bf16 v[224:227], a[232:235], a[90:93], v[224:227]
    s_mov_b32 s66, 0
    ds_read_b32 a208, v62
    v_perm_b32 v63, v74, v35, s37
    v_mfma_f32_16x16x32_bf16 v[224:227], a[236:239], a[98:101], v[224:227]
    s_mov_b32 s67, 14336
    v_lshlrev_b32 v105, 16, v66
    v_and_b32 v106, 0xffff0000, v67
    v_mfma_f32_16x16x32_bf16 v[228:231], a[232:235], a[106:109], v[228:231]
    s_barrier
    v_mfma_f32_16x16x32_bf16 v[228:231], a[236:239], a[114:117], v[228:231]
    ds_read_b32 a209, v63
    ds_read_b128 a[120:123], v42 offset:0
    v_mfma_f32_16x16x32_bf16 v[128:131], a[240:243], a[88:91], v[128:131]
    ds_read_b128 a[124:127], v43 offset:0
    v_perm_b32 v56, v74, v35, s38
    v_mfma_f32_16x16x32_bf16 v[128:131], a[244:247], a[92:95], v[128:131]
    ds_read_b32 a210, v56
    ds_read_b128 a[128:131], v42 offset:16384
    v_mfma_f32_16x16x32_bf16 v[128:131], a[248:251], a[96:99], v[128:131]
    ds_read_b128 a[132:135], v43 offset:16384
    v_perm_b32 v57, v74, v35, s39
    v_mfma_f32_16x16x32_bf16 v[128:131], a[252:255], a[100:103], v[128:131]
    ds_read_b32 a211, v57
    v_perm_b32 v58, v78, v35, s36
    v_mfma_f32_16x16x32_bf16 v[132:135], a[240:243], a[104:107], v[132:135]
    ds_read_b32 a212, v58
    v_perm_b32 v59, v78, v35, s37
    v_mfma_f32_16x16x32_bf16 v[132:135], a[244:247], a[108:111], v[132:135]
    ds_read_b32 a213, v59
    v_perm_b32 v60, v78, v35, s38
    v_mfma_f32_16x16x32_bf16 v[132:135], a[248:251], a[112:115], v[132:135]
    ds_read_b32 a214, v60
    ds_read_b128 a[0:3], v42 offset:2048
    v_mfma_f32_16x16x32_bf16 v[132:135], a[252:255], a[116:119], v[132:135]
    v_perm_b32 v61, v78, v35, s39
    v_perm_b32 v62, v82, v35, s36
    v_mfma_f32_16x16x32_bf16 v[160:163], a[136:139], a[88:91], v[160:163]
    ds_read_b32 a215, v61
    ds_read_b128 a[4:7], v43 offset:2048
    v_mfma_f32_16x16x32_bf16 v[160:163], a[140:143], a[92:95], v[160:163]
    ds_read_b32 a216, v62
    v_perm_b32 v63, v82, v35, s37
    v_mfma_f32_16x16x32_bf16 v[160:163], a[144:147], a[96:99], v[160:163]
    v_perm_b32 v56, v82, v35, s38
    v_lshlrev_b32 v107, 16, v69
    v_mfma_f32_16x16x32_bf16 v[160:163], a[148:151], a[100:103], v[160:163]
    ds_read_b32 a217, v63
    ds_read_b128 a[8:11], v42 offset:18432
    v_mfma_f32_16x16x32_bf16 v[164:167], a[136:139], a[104:107], v[164:167]
    ds_read_b32 a218, v56
    v_perm_b32 v57, v82, v35, s39
    v_mfma_f32_16x16x32_bf16 v[164:167], a[140:143], a[108:111], v[164:167]
    v_lshlrev_b32 v108, 16, v65
    v_and_b32 v109, 0xffff0000, v66
    v_mfma_f32_16x16x32_bf16 v[164:167], a[144:147], a[112:115], v[164:167]
    ds_read_b32 a219, v57
    v_perm_b32 v58, v86, v35, s36
    v_mfma_f32_16x16x32_bf16 v[164:167], a[148:151], a[116:119], v[164:167]
    ds_read_b128 a[12:15], v43 offset:18432
    v_perm_b32 v59, v86, v35, s37
    v_mfma_f32_16x16x32_bf16 v[192:195], a[152:155], a[88:91], v[192:195]
    ds_read_b32 a220, v58
    v_lshlrev_b32 v110, 16, v68
    v_mfma_f32_16x16x32_bf16 v[192:195], a[156:159], a[92:95], v[192:195]
    ds_read_b32 a221, v59
    v_perm_b32 v60, v86, v35, s38
    v_mfma_f32_16x16x32_bf16 v[192:195], a[160:163], a[96:99], v[192:195]
    ds_read_b128 a[16:19], v40 offset:36864
    v_and_b32 v111, 0xffff0000, v69
    v_mfma_f32_16x16x32_bf16 v[192:195], a[164:167], a[100:103], v[192:195]
    ds_read_b32 a222, v60
    v_perm_b32 v61, v86, v35, s39
    v_mfma_f32_16x16x32_bf16 v[196:199], a[152:155], a[104:107], v[196:199]
    v_mfma_f32_16x16x32_bf16 v[196:199], a[156:159], a[108:111], v[196:199]
    ds_read_b32 a223, v61
    ds_read_b128 a[20:23], v41 offset:36864
    v_mfma_f32_16x16x32_bf16 v[196:199], a[160:163], a[112:115], v[196:199]
    v_mfma_f32_16x16x32_bf16 v[196:199], a[164:167], a[116:119], v[196:199]
    s_waitcnt lgkmcnt(7)
    v_mfma_f32_16x16x32_bf16 v[224:227], a[168:171], a[122:125], v[224:227]
    v_mfma_f32_16x16x32_bf16 v[224:227], a[172:175], a[130:133], v[224:227]
    ds_read_b128 a[24:27], v40 offset:53248
    v_mfma_f32_16x16x32_bf16 v[128:131], a[176:179], a[120:123], v[128:131]
    v_mfma_f32_16x16x32_bf16 v[128:131], a[180:183], a[124:127], v[128:131]
    v_mov_b32 v8, 1
    v_min_u32 v9, 1, v0
    v_mfma_f32_16x16x32_bf16 v[128:131], a[184:187], a[128:131], v[128:131]
    ds_read_b128 a[28:31], v41 offset:53248
    v_lshlrev_b32 v9, 30, v9
    v_mfma_f32_16x16x32_bf16 v[128:131], a[188:191], a[132:135], v[128:131]
    ds_write_b64 v29, v[226:227] offset:0
    v_mfma_f32_16x16x32_bf16 v[160:163], a[192:195], a[120:123], v[160:163]
    buffer_atomic_add v8, v9, s[24:27], s77 offen sc0 sc1
    v_mfma_f32_16x16x32_bf16 v[160:163], a[196:199], a[124:127], v[160:163]
L_pad4:
    s_cbranch_execz L_warmed
    v_mfma_f32_16x16x32_bf16 v[160:163], a[200:203], a[128:131], v[160:163]
    ds_read_b128 a[32:35], v42 offset:4096
    v_mfma_f32_16x16x32_bf16 v[160:163], a[204:207], a[132:135], v[160:163]
    v_mul_f32 v128, v128, v100
    v_mul_f32 v129, v129, v101
    v_mfma_f32_16x16x32_bf16 v[192:195], a[208:211], a[120:123], v[192:195]
    s_waitcnt lgkmcnt(1)
    s_barrier
    v_mfma_f32_16x16x32_bf16 v[192:195], a[212:215], a[124:127], v[192:195]
    ds_read_b64 v[112:113], v30 offset:0
    ds_read_b128 a[36:39], v43 offset:4096
    v_mfma_f32_16x16x32_bf16 v[192:195], a[216:219], a[128:131], v[192:195]
    v_mul_f32 v130, v130, v102
    v_mul_f32 v131, v131, v103
    v_mfma_f32_16x16x32_bf16 v[192:195], a[220:223], a[132:135], v[192:195]
    v_mul_f32 v160, v160, v104
    v_cvt_pk_bf16_f32 v116, v128, v160
    v_mfma_f32_16x16x32_bf16 v[228:231], a[168:171], a[2:5], v[228:231]
    v_mul_f32 v161, v161, v105
    v_mul_f32 v162, v162, v106
    v_mfma_f32_16x16x32_bf16 v[228:231], a[172:175], a[10:13], v[228:231]
    ds_read_b128 a[40:43], v42 offset:20480
    v_cvt_pk_bf16_f32 v119, v130, v162
    v_mfma_f32_16x16x32_bf16 v[132:135], a[176:179], a[0:3], v[132:135]
    v_mul_f32 v163, v163, v107
    v_mfma_f32_16x16x32_bf16 v[132:135], a[180:183], a[4:7], v[132:135]
    v_mul_f32 v192, v192, v108
    v_mul_f32 v193, v193, v109
    v_mfma_f32_16x16x32_bf16 v[132:135], a[184:187], a[8:11], v[132:135]
    v_mul_f32 v194, v194, v110
    v_mul_f32 v195, v195, v111
    v_mfma_f32_16x16x32_bf16 v[132:135], a[188:191], a[12:15], v[132:135]
    ds_read_b128 a[44:47], v43 offset:20480
    v_cvt_pk_bf16_f32 v117, v192, v129
    v_mfma_f32_16x16x32_bf16 v[164:167], a[192:195], a[0:3], v[164:167]
    ds_write_b64 v26, v[116:117] offset:0
    v_cvt_pk_bf16_f32 v118, v161, v193
    v_mfma_f32_16x16x32_bf16 v[164:167], a[196:199], a[4:7], v[164:167]
    ds_write_b64 v26, v[118:119] offset:8
    v_cvt_pk_bf16_f32 v120, v194, v131
    v_mfma_f32_16x16x32_bf16 v[164:167], a[200:203], a[8:11], v[164:167]
    ds_write_b64 v29, v[230:231] offset:2048
    v_cvt_pk_bf16_f32 v121, v163, v195
    v_mfma_f32_16x16x32_bf16 v[164:167], a[204:207], a[12:15], v[164:167]
    s_waitcnt lgkmcnt(5)
    ds_write_b64 v26, v[120:121] offset:16
    v_add_f32 v224, v224, v112
    v_mfma_f32_16x16x32_bf16 v[196:199], a[208:211], a[0:3], v[196:199]
    v_mul_f32 v224, v224, v96
    v_add_f32 v225, v225, v113
    v_mfma_f32_16x16x32_bf16 v[196:199], a[212:215], a[4:7], v[196:199]
    v_mul_f32 v225, v225, v97
    v_cvt_pk_bf16_f32 v112, v224, v225
    v_mfma_f32_16x16x32_bf16 v[196:199], a[216:219], a[8:11], v[196:199]
    ds_write_b32 v28, v112 offset:0
    v_mul_f32 v132, v132, v100
    v_mfma_f32_16x16x32_bf16 v[196:199], a[220:223], a[12:15], v[196:199]
    ds_read_b128 a[48:51], v40 offset:38912
    v_mul_f32 v133, v133, v101
    v_mfma_f32_16x16x32_bf16 v[232:235], a[232:235], a[18:21], v[232:235]
    ds_read_b128 a[52:55], v41 offset:38912
    v_mul_f32 v134, v134, v102
    v_mfma_f32_16x16x32_bf16 v[232:235], a[236:239], a[26:29], v[232:235]
    ds_read_b128 a[56:59], v40 offset:55296
    v_mul_f32 v135, v135, v103
    v_mfma_f32_16x16x32_bf16 v[232:235], a[168:171], a[34:37], v[232:235]
    s_waitcnt lgkmcnt(6)
    v_mul_f32 v164, v164, v104
    v_cvt_pk_bf16_f32 v124, v132, v164
    v_mfma_f32_16x16x32_bf16 v[232:235], a[172:175], a[42:45], v[232:235]
    s_waitcnt lgkmcnt(3)
    s_barrier
    v_mfma_f32_16x16x32_bf16 v[136:139], a[240:243], a[16:19], v[136:139]
    ds_read_b128 v[88:91], v24 offset:0
    ds_read_b64 v[92:93], v30 offset:2048
    v_mfma_f32_16x16x32_bf16 v[136:139], a[244:247], a[20:23], v[136:139]
    ds_read_b128 v[48:51], v24 offset:928
    v_mul_f32 v196, v196, v108
    v_mfma_f32_16x16x32_bf16 v[136:139], a[248:251], a[24:27], v[136:139]
    v_mul_f32 v197, v197, v109
    v_mul_f32 v198, v198, v110
    v_mfma_f32_16x16x32_bf16 v[136:139], a[252:255], a[28:31], v[136:139]
    v_mul_f32 v199, v199, v111
    v_cvt_pk_bf16_f32 v125, v196, v133
    v_mfma_f32_16x16x32_bf16 v[136:139], a[176:179], a[32:35], v[136:139]
    ds_write_b64 v26, v[124:125] offset:7424
    v_mul_f32 v165, v165, v105
    v_mfma_f32_16x16x32_bf16 v[136:139], a[180:183], a[36:39], v[136:139]
    v_mul_f32 v166, v166, v106
    v_cvt_pk_bf16_f32 v127, v134, v166
    v_mfma_f32_16x16x32_bf16 v[136:139], a[184:187], a[40:43], v[136:139]
    s_waitcnt lgkmcnt(3)
    ds_read_b128 a[60:63], v41 offset:55296
    v_mfma_f32_16x16x32_bf16 v[136:139], a[188:191], a[44:47], v[136:139]
    buffer_store_dwordx4 v[88:91], v25, s[16:19], s66 offen sc1
    v_mfma_f32_16x16x32_bf16 v[168:171], a[136:139], a[16:19], v[168:171]
    s_mov_b32 s66, 114688
    v_mul_f32 v167, v167, v107
    v_cvt_pk_bf16_f32 v126, v165, v197
    v_mfma_f32_16x16x32_bf16 v[168:171], a[140:143], a[20:23], v[168:171]
    ds_write_b64 v26, v[126:127] offset:7432
    v_cvt_pk_bf16_f32 v52, v198, v135
    v_mfma_f32_16x16x32_bf16 v[168:171], a[144:147], a[24:27], v[168:171]
    s_waitcnt lgkmcnt(3)
    ds_read_b128 a[64:67], v42 offset:6144
    v_mfma_f32_16x16x32_bf16 v[168:171], a[148:151], a[28:31], v[168:171]
    buffer_store_dwordx4 v[48:51], v25, s[16:19], s67 offen sc1
    v_mfma_f32_16x16x32_bf16 v[168:171], a[192:195], a[32:35], v[168:171]
    s_mov_b32 s67, 129024
    ds_read_b128 a[68:71], v43 offset:6144
    v_cvt_pk_bf16_f32 v53, v167, v199
    v_mfma_f32_16x16x32_bf16 v[168:171], a[196:199], a[36:39], v[168:171]
    ds_write_b64 v26, v[52:53] offset:7440
    v_add_f32 v228, v228, v92
    v_mfma_f32_16x16x32_bf16 v[168:171], a[200:203], a[40:43], v[168:171]
    v_mul_f32 v228, v228, v96
    v_add_f32 v229, v229, v93
    v_mfma_f32_16x16x32_bf16 v[168:171], a[204:207], a[44:47], v[168:171]
    ds_read_b128 a[72:75], v42 offset:22528
    v_mul_f32 v229, v229, v97
    v_mfma_f32_16x16x32_bf16 v[200:203], a[152:155], a[16:19], v[200:203]
    ds_read_b128 a[76:79], v43 offset:22528
    v_cvt_pk_bf16_f32 v92, v228, v229
    v_mfma_f32_16x16x32_bf16 v[200:203], a[156:159], a[20:23], v[200:203]
    ds_write_b32 v28, v92 offset:7424
    v_mul_f32 v136, v136, v100
    v_mfma_f32_16x16x32_bf16 v[200:203], a[160:163], a[24:27], v[200:203]
    ds_write_b64 v29, v[234:235] offset:4096
    v_mul_f32 v137, v137, v101
    v_mfma_f32_16x16x32_bf16 v[200:203], a[164:167], a[28:31], v[200:203]
    v_mul_f32 v138, v138, v102
    v_mul_f32 v139, v139, v103
    v_mfma_f32_16x16x32_bf16 v[200:203], a[208:211], a[32:35], v[200:203]
    ds_read_b128 a[80:83], v40 offset:40960
    v_mul_f32 v168, v168, v104
    v_mfma_f32_16x16x32_bf16 v[200:203], a[212:215], a[36:39], v[200:203]
    ds_read_b128 a[84:87], v41 offset:40960
    v_cvt_pk_bf16_f32 v72, v136, v168
    v_mfma_f32_16x16x32_bf16 v[200:203], a[216:219], a[40:43], v[200:203]
    v_mul_f32 v169, v169, v105
    v_mul_f32 v170, v170, v106
    v_mfma_f32_16x16x32_bf16 v[200:203], a[220:223], a[44:47], v[200:203]
    s_waitcnt lgkmcnt(2)
    s_barrier
    v_mfma_f32_16x16x32_bf16 v[236:239], a[232:235], a[50:53], v[236:239]
    ds_read_b128 v[76:79], v24 offset:7424
    ds_read_b64 v[80:81], v30 offset:4096
    v_mfma_f32_16x16x32_bf16 v[236:239], a[236:239], a[58:61], v[236:239]
    ds_read_b128 v[64:67], v24 offset:8352
    v_cvt_pk_bf16_f32 v75, v138, v170
    v_mfma_f32_16x16x32_bf16 v[236:239], a[168:171], a[66:69], v[236:239]
    ds_read_b128 a[88:91], v40 offset:57344
    v_mul_f32 v171, v171, v107
    v_mfma_f32_16x16x32_bf16 v[236:239], a[172:175], a[74:77], v[236:239]
    v_mul_f32 v200, v200, v108
    v_mul_f32 v201, v201, v109
    v_mfma_f32_16x16x32_bf16 v[140:143], a[240:243], a[48:51], v[140:143]
    v_mul_f32 v202, v202, v110
    v_mul_f32 v203, v203, v111
    v_mfma_f32_16x16x32_bf16 v[140:143], a[244:247], a[52:55], v[140:143]
    v_cvt_pk_bf16_f32 v73, v200, v137
    v_cvt_pk_bf16_f32 v74, v169, v201
    v_mfma_f32_16x16x32_bf16 v[140:143], a[248:251], a[56:59], v[140:143]
    s_waitcnt lgkmcnt(2)
    ds_write_b64 v26, v[72:73] offset:14848
    v_mfma_f32_16x16x32_bf16 v[140:143], a[252:255], a[60:63], v[140:143]
    buffer_store_dwordx4 v[76:79], v25, s[16:19], s66 offen sc1
    v_mfma_f32_16x16x32_bf16 v[140:143], a[176:179], a[64:67], v[140:143]
    s_mov_b32 s66, 229376
    v_add_f32 v232, v232, v80
    v_mul_f32 v232, v232, v96
    v_mfma_f32_16x16x32_bf16 v[140:143], a[180:183], a[68:71], v[140:143]
    v_add_f32 v233, v233, v81
    v_mul_f32 v233, v233, v97
    v_mfma_f32_16x16x32_bf16 v[140:143], a[184:187], a[72:75], v[140:143]
    s_waitcnt lgkmcnt(2)
    ds_read_b128 a[92:95], v41 offset:57344
    v_mfma_f32_16x16x32_bf16 v[140:143], a[188:191], a[76:79], v[140:143]
    buffer_store_dwordx4 v[64:67], v25, s[16:19], s67 offen sc1
    v_mfma_f32_16x16x32_bf16 v[172:175], a[136:139], a[48:51], v[172:175]
    s_mov_b32 s67, 243712
    ds_write_b64 v26, v[74:75] offset:14856
    v_cvt_pk_bf16_f32 v80, v232, v233
    v_mfma_f32_16x16x32_bf16 v[172:175], a[140:143], a[52:55], v[172:175]
    ds_read_b128 a[96:99], v42 offset:8192
    v_cvt_pk_bf16_f32 v68, v202, v139
    v_mfma_f32_16x16x32_bf16 v[172:175], a[144:147], a[56:59], v[172:175]
    ds_write_b32 v28, v80 offset:14848
    v_cvt_pk_bf16_f32 v69, v171, v203
    v_mfma_f32_16x16x32_bf16 v[172:175], a[148:151], a[60:63], v[172:175]
    ds_write_b64 v26, v[68:69] offset:14864
    v_mul_f32 v140, v140, v100
    v_mfma_f32_16x16x32_bf16 v[172:175], a[192:195], a[64:67], v[172:175]
    ds_read_b128 a[100:103], v43 offset:8192
    v_mul_f32 v141, v141, v101
    v_mfma_f32_16x16x32_bf16 v[172:175], a[196:199], a[68:71], v[172:175]
    ds_write_b64 v29, v[238:239] offset:0
    v_mul_f32 v142, v142, v102
    v_mfma_f32_16x16x32_bf16 v[172:175], a[200:203], a[72:75], v[172:175]
    ds_read_b128 a[104:107], v42 offset:24576
    v_mul_f32 v143, v143, v103
    v_mfma_f32_16x16x32_bf16 v[172:175], a[204:207], a[76:79], v[172:175]
    ds_read_b128 a[108:111], v43 offset:24576
    v_mfma_f32_16x16x32_bf16 v[204:207], a[152:155], a[48:51], v[204:207]
    v_mfma_f32_16x16x32_bf16 v[204:207], a[156:159], a[52:55], v[204:207]
    v_mfma_f32_16x16x32_bf16 v[204:207], a[160:163], a[56:59], v[204:207]
    s_waitcnt lgkmcnt(2)
    s_barrier
    v_mfma_f32_16x16x32_bf16 v[204:207], a[164:167], a[60:63], v[204:207]
    ds_read_b128 v[84:87], v24 offset:14848
    ds_read_b64 v[116:117], v30 offset:0
    v_mfma_f32_16x16x32_bf16 v[204:207], a[208:211], a[64:67], v[204:207]
    ds_read_b128 v[120:123], v24 offset:15776
    v_mul_f32 v172, v172, v104
    v_mfma_f32_16x16x32_bf16 v[204:207], a[212:215], a[68:71], v[204:207]
    ds_read_b128 a[112:115], v40 offset:43008
    v_cvt_pk_bf16_f32 v112, v140, v172
    v_mfma_f32_16x16x32_bf16 v[204:207], a[216:219], a[72:75], v[204:207]
    ds_read_b128 a[116:119], v41 offset:43008
    v_mul_f32 v173, v173, v105
    v_mfma_f32_16x16x32_bf16 v[204:207], a[220:223], a[76:79], v[204:207]
    v_mul_f32 v174, v174, v106
    v_cvt_pk_bf16_f32 v115, v142, v174
    v_mfma_f32_16x16x32_bf16 v[240:243], a[232:235], a[82:85], v[240:243]
    v_mul_f32 v175, v175, v107
    v_mfma_f32_16x16x32_bf16 v[240:243], a[236:239], a[90:93], v[240:243]
    s_waitcnt lgkmcnt(3)
    ds_read_b128 a[120:123], v40 offset:59392
    v_mfma_f32_16x16x32_bf16 v[240:243], a[168:171], a[98:101], v[240:243]
    buffer_store_dwordx4 v[84:87], v25, s[16:19], s66 offen sc1
    v_mfma_f32_16x16x32_bf16 v[240:243], a[172:175], a[106:109], v[240:243]
    s_mov_b32 s66, 344064
    v_add_f32 v236, v236, v116
    v_mul_f32 v236, v236, v96
    v_mfma_f32_16x16x32_bf16 v[144:147], a[240:243], a[80:83], v[144:147]
    v_add_f32 v237, v237, v117
    v_mul_f32 v237, v237, v97
    v_mfma_f32_16x16x32_bf16 v[144:147], a[244:247], a[84:87], v[144:147]
    s_waitcnt lgkmcnt(3)
    ds_read_b128 a[124:127], v41 offset:59392
    v_mfma_f32_16x16x32_bf16 v[144:147], a[248:251], a[88:91], v[144:147]
    buffer_store_dwordx4 v[120:123], v25, s[16:19], s67 offen sc1
    v_mfma_f32_16x16x32_bf16 v[144:147], a[252:255], a[92:95], v[144:147]
    s_mov_b32 s67, 358400
    v_cvt_pk_bf16_f32 v116, v236, v237
    v_mul_f32 v204, v204, v108
    v_mfma_f32_16x16x32_bf16 v[144:147], a[176:179], a[96:99], v[144:147]
    ds_write_b32 v28, v116 offset:0
    v_mul_f32 v205, v205, v109
    v_mfma_f32_16x16x32_bf16 v[144:147], a[180:183], a[100:103], v[144:147]
    v_mul_f32 v206, v206, v110
    v_mul_f32 v207, v207, v111
    v_mfma_f32_16x16x32_bf16 v[144:147], a[184:187], a[104:107], v[144:147]
    v_cvt_pk_bf16_f32 v113, v204, v141
    v_cvt_pk_bf16_f32 v114, v173, v205
    v_mfma_f32_16x16x32_bf16 v[144:147], a[188:191], a[108:111], v[144:147]
    ds_write_b64 v26, v[112:113] offset:0
    v_cvt_pk_bf16_f32 v88, v206, v143
    v_mfma_f32_16x16x32_bf16 v[176:179], a[136:139], a[80:83], v[176:179]
    ds_write_b64 v26, v[114:115] offset:8
    v_cvt_pk_bf16_f32 v89, v175, v207
    v_mfma_f32_16x16x32_bf16 v[176:179], a[140:143], a[84:87], v[176:179]
    ds_read_b128 a[128:131], v42 offset:10240
    v_mfma_f32_16x16x32_bf16 v[176:179], a[144:147], a[88:91], v[176:179]
    ds_write_b64 v26, v[88:89] offset:16
    v_mfma_f32_16x16x32_bf16 v[176:179], a[148:151], a[92:95], v[176:179]
    ds_write_b64 v29, v[242:243] offset:2048
    v_mul_f32 v144, v144, v100
    v_mfma_f32_16x16x32_bf16 v[176:179], a[192:195], a[96:99], v[176:179]
    ds_read_b128 a[132:135], v43 offset:10240
    v_mul_f32 v145, v145, v101
    v_mfma_f32_16x16x32_bf16 v[176:179], a[196:199], a[100:103], v[176:179]
    ds_read_b128 a[0:3], v42 offset:26624
    v_mul_f32 v146, v146, v102
    v_mfma_f32_16x16x32_bf16 v[176:179], a[200:203], a[104:107], v[176:179]
    ds_read_b128 a[4:7], v43 offset:26624
    v_mul_f32 v147, v147, v103
    v_mfma_f32_16x16x32_bf16 v[176:179], a[204:207], a[108:111], v[176:179]
    v_mfma_f32_16x16x32_bf16 v[208:211], a[152:155], a[80:83], v[208:211]
    s_waitcnt lgkmcnt(3)
    s_barrier
    v_mfma_f32_16x16x32_bf16 v[208:211], a[156:159], a[84:87], v[208:211]
    ds_read_b128 v[124:127], v24 offset:0
    ds_read_b64 v[48:49], v30 offset:2048
    v_mfma_f32_16x16x32_bf16 v[208:211], a[160:163], a[88:91], v[208:211]
    ds_read_b128 v[52:55], v24 offset:928
    v_mfma_f32_16x16x32_bf16 v[208:211], a[164:167], a[92:95], v[208:211]
    ds_read_b128 a[8:11], v40 offset:45056
    v_mul_f32 v176, v176, v104
    v_mfma_f32_16x16x32_bf16 v[208:211], a[208:211], a[96:99], v[208:211]
    v_cvt_pk_bf16_f32 v92, v144, v176
    v_mul_f32 v177, v177, v105
    v_mfma_f32_16x16x32_bf16 v[208:211], a[212:215], a[100:103], v[208:211]
    ds_read_b128 a[12:15], v41 offset:45056
    v_mul_f32 v178, v178, v106
    v_mfma_f32_16x16x32_bf16 v[208:211], a[216:219], a[104:107], v[208:211]
    v_cvt_pk_bf16_f32 v95, v146, v178
    v_mul_f32 v179, v179, v107
    v_mfma_f32_16x16x32_bf16 v[208:211], a[220:223], a[108:111], v[208:211]
    s_waitcnt lgkmcnt(3)
    v_mfma_f32_16x16x32_bf16 v[244:247], a[232:235], a[114:117], v[244:247]
    buffer_store_dwordx4 v[124:127], v25, s[16:19], s66 offen sc1
    v_mfma_f32_16x16x32_bf16 v[244:247], a[236:239], a[122:125], v[244:247]
    s_mov_b32 s66, 458752
    v_add_f32 v240, v240, v48
    v_mul_f32 v240, v240, v96
    v_mfma_f32_16x16x32_bf16 v[244:247], a[168:171], a[130:133], v[244:247]
    v_add_f32 v241, v241, v49
    v_mul_f32 v241, v241, v97
    v_mfma_f32_16x16x32_bf16 v[244:247], a[172:175], a[2:5], v[244:247]
    s_waitcnt lgkmcnt(2)
    ds_read_b128 a[16:19], v40 offset:61440
    v_mfma_f32_16x16x32_bf16 v[148:151], a[240:243], a[112:115], v[148:151]
    buffer_store_dwordx4 v[52:55], v25, s[16:19], s67 offen sc1
    v_mfma_f32_16x16x32_bf16 v[148:151], a[244:247], a[116:119], v[148:151]
    s_mov_b32 s67, 473088
    v_cvt_pk_bf16_f32 v48, v240, v241
    v_mul_f32 v208, v208, v108
    v_mfma_f32_16x16x32_bf16 v[148:151], a[248:251], a[120:123], v[148:151]
    ds_write_b32 v28, v48 offset:7424
    v_mul_f32 v209, v209, v109
    v_mfma_f32_16x16x32_bf16 v[148:151], a[252:255], a[124:127], v[148:151]
    v_mul_f32 v210, v210, v110
    v_mul_f32 v211, v211, v111
    v_mfma_f32_16x16x32_bf16 v[148:151], a[176:179], a[128:131], v[148:151]
    v_cvt_pk_bf16_f32 v93, v208, v145
    v_cvt_pk_bf16_f32 v94, v177, v209
    v_mfma_f32_16x16x32_bf16 v[148:151], a[180:183], a[132:135], v[148:151]
    ds_read_b128 a[20:23], v41 offset:61440
    v_cvt_pk_bf16_f32 v76, v210, v147
    v_mfma_f32_16x16x32_bf16 v[148:151], a[184:187], a[0:3], v[148:151]
    ds_write_b64 v26, v[92:93] offset:7424
    v_cvt_pk_bf16_f32 v77, v179, v211
    v_mfma_f32_16x16x32_bf16 v[148:151], a[188:191], a[4:7], v[148:151]
    ds_write_b64 v26, v[94:95] offset:7432
    v_mfma_f32_16x16x32_bf16 v[180:183], a[136:139], a[112:115], v[180:183]
    ds_write_b64 v26, v[76:77] offset:7440
    v_mfma_f32_16x16x32_bf16 v[180:183], a[140:143], a[116:119], v[180:183]
    ds_read_b128 a[24:27], v42 offset:12288
    v_mfma_f32_16x16x32_bf16 v[180:183], a[144:147], a[120:123], v[180:183]
    ds_write_b64 v29, v[246:247] offset:4096
    v_mfma_f32_16x16x32_bf16 v[180:183], a[148:151], a[124:127], v[180:183]
    ds_read_b128 a[28:31], v43 offset:12288
    v_mul_f32 v148, v148, v100
    v_mfma_f32_16x16x32_bf16 v[180:183], a[192:195], a[128:131], v[180:183]
    ds_read_b128 a[32:35], v42 offset:28672
    v_mul_f32 v149, v149, v101
    v_mfma_f32_16x16x32_bf16 v[180:183], a[196:199], a[132:135], v[180:183]
    v_mul_f32 v150, v150, v102
    v_mul_f32 v151, v151, v103
    v_mfma_f32_16x16x32_bf16 v[180:183], a[200:203], a[0:3], v[180:183]
    ds_read_b128 a[36:39], v43 offset:28672
    v_mfma_f32_16x16x32_bf16 v[180:183], a[204:207], a[4:7], v[180:183]
    s_waitcnt lgkmcnt(3)
    s_barrier
    v_mfma_f32_16x16x32_bf16 v[212:215], a[152:155], a[112:115], v[212:215]
    ds_read_b128 v[64:67], v24 offset:7424
    ds_read_b64 v[72:73], v30 offset:4096
    v_mfma_f32_16x16x32_bf16 v[212:215], a[156:159], a[116:119], v[212:215]
    ds_read_b128 v[80:83], v24 offset:8352
    v_mfma_f32_16x16x32_bf16 v[212:215], a[160:163], a[120:123], v[212:215]
    ds_read_b128 a[40:43], v40 offset:47104
    v_mfma_f32_16x16x32_bf16 v[212:215], a[164:167], a[124:127], v[212:215]
    v_mul_f32 v180, v180, v104
    v_cvt_pk_bf16_f32 v68, v148, v180
    v_mfma_f32_16x16x32_bf16 v[212:215], a[208:211], a[128:131], v[212:215]
    v_mul_f32 v181, v181, v105
    v_mul_f32 v182, v182, v106
    v_mfma_f32_16x16x32_bf16 v[212:215], a[212:215], a[132:135], v[212:215]
    v_cvt_pk_bf16_f32 v71, v150, v182
    v_mul_f32 v183, v183, v107
    v_mfma_f32_16x16x32_bf16 v[212:215], a[216:219], a[0:3], v[212:215]
    s_waitcnt lgkmcnt(2)
    ds_read_b128 a[44:47], v41 offset:47104
    v_mfma_f32_16x16x32_bf16 v[212:215], a[220:223], a[4:7], v[212:215]
    buffer_store_dwordx4 v[64:67], v25, s[16:19], s66 offen sc1
    v_mfma_f32_16x16x32_bf16 v[248:251], a[232:235], a[10:13], v[248:251]
    s_mov_b32 s66, 573440
    v_add_f32 v244, v244, v72
    v_mul_f32 v244, v244, v96
    v_mfma_f32_16x16x32_bf16 v[248:251], a[236:239], a[18:21], v[248:251]
    v_add_f32 v245, v245, v73
    v_mul_f32 v245, v245, v97
    v_mfma_f32_16x16x32_bf16 v[248:251], a[168:171], a[26:29], v[248:251]
    s_waitcnt lgkmcnt(2)
    ds_read_b128 a[48:51], v40 offset:63488
    v_mfma_f32_16x16x32_bf16 v[248:251], a[172:175], a[34:37], v[248:251]
    buffer_store_dwordx4 v[80:83], v25, s[16:19], s67 offen sc1
    v_mfma_f32_16x16x32_bf16 v[152:155], a[240:243], a[8:11], v[152:155]
    s_mov_b32 s67, 587776
    v_cvt_pk_bf16_f32 v72, v244, v245
    v_mul_f32 v212, v212, v108
    v_mfma_f32_16x16x32_bf16 v[152:155], a[244:247], a[12:15], v[152:155]
    ds_write_b32 v28, v72 offset:14848
    v_mul_f32 v213, v213, v109
    v_mfma_f32_16x16x32_bf16 v[152:155], a[248:251], a[16:19], v[152:155]
    v_mul_f32 v214, v214, v110
    v_mul_f32 v215, v215, v111
    v_mfma_f32_16x16x32_bf16 v[152:155], a[252:255], a[20:23], v[152:155]
    v_cvt_pk_bf16_f32 v69, v212, v149
    v_cvt_pk_bf16_f32 v70, v181, v213
    v_mfma_f32_16x16x32_bf16 v[152:155], a[176:179], a[24:27], v[152:155]
    ds_write_b64 v26, v[68:69] offset:14848
    v_cvt_pk_bf16_f32 v84, v214, v151
    v_mfma_f32_16x16x32_bf16 v[152:155], a[180:183], a[28:31], v[152:155]
    ds_read_b128 a[52:55], v41 offset:63488
    v_cvt_pk_bf16_f32 v85, v183, v215
    v_mfma_f32_16x16x32_bf16 v[152:155], a[184:187], a[32:35], v[152:155]
    ds_write_b64 v26, v[70:71] offset:14856
    v_mfma_f32_16x16x32_bf16 v[152:155], a[188:191], a[36:39], v[152:155]
    ds_write_b64 v26, v[84:85] offset:14864
    v_mfma_f32_16x16x32_bf16 v[184:187], a[136:139], a[8:11], v[184:187]
    ds_write_b64 v29, v[250:251] offset:0
    v_mfma_f32_16x16x32_bf16 v[184:187], a[140:143], a[12:15], v[184:187]
    ds_read_b128 a[56:59], v42 offset:14336
    v_mfma_f32_16x16x32_bf16 v[184:187], a[144:147], a[16:19], v[184:187]
    ds_read_b128 a[60:63], v43 offset:14336
    v_mfma_f32_16x16x32_bf16 v[184:187], a[148:151], a[20:23], v[184:187]
    ds_read_b128 a[64:67], v42 offset:30720
    v_mul_f32 v152, v152, v100
    v_mfma_f32_16x16x32_bf16 v[184:187], a[192:195], a[24:27], v[184:187]
    v_mul_f32 v153, v153, v101
    v_mul_f32 v154, v154, v102
    v_mfma_f32_16x16x32_bf16 v[184:187], a[196:199], a[28:31], v[184:187]
    s_waitcnt lgkmcnt(3)
    s_barrier
    v_mfma_f32_16x16x32_bf16 v[184:187], a[200:203], a[32:35], v[184:187]
    ds_read_b128 v[120:123], v24 offset:14848
    ds_read_b64 v[116:117], v30 offset:0
    v_mfma_f32_16x16x32_bf16 v[184:187], a[204:207], a[36:39], v[184:187]
    ds_read_b128 a[68:71], v43 offset:30720
    v_mul_f32 v155, v155, v103
    v_mfma_f32_16x16x32_bf16 v[216:219], a[152:155], a[8:11], v[216:219]
    ds_read_b128 v[112:115], v24 offset:15776
    v_mfma_f32_16x16x32_bf16 v[216:219], a[156:159], a[12:15], v[216:219]
    v_mfma_f32_16x16x32_bf16 v[216:219], a[160:163], a[16:19], v[216:219]
    v_mfma_f32_16x16x32_bf16 v[216:219], a[164:167], a[20:23], v[216:219]
    v_mul_f32 v184, v184, v104
    v_cvt_pk_bf16_f32 v88, v152, v184
    v_mfma_f32_16x16x32_bf16 v[216:219], a[208:211], a[24:27], v[216:219]
    s_waitcnt lgkmcnt(2)
    v_mul_f32 v185, v185, v105
    v_mfma_f32_16x16x32_bf16 v[216:219], a[212:215], a[28:31], v[216:219]
    buffer_store_dwordx4 v[120:123], v25, s[16:19], s66 offen sc1
    v_mfma_f32_16x16x32_bf16 v[216:219], a[216:219], a[32:35], v[216:219]
    s_mov_b32 s66, 688128
    v_add_f32 v248, v248, v116
    v_mul_f32 v248, v248, v96
    v_mfma_f32_16x16x32_bf16 v[216:219], a[220:223], a[36:39], v[216:219]
    v_add_f32 v249, v249, v117
    v_mul_f32 v249, v249, v97
    v_mfma_f32_16x16x32_bf16 v[252:255], a[232:235], a[42:45], v[252:255]
    s_waitcnt lgkmcnt(0)
    v_cvt_pk_bf16_f32 v116, v248, v249
    v_mfma_f32_16x16x32_bf16 v[252:255], a[236:239], a[50:53], v[252:255]
    buffer_store_dwordx4 v[112:115], v25, s[16:19], s67 offen sc1
    v_mfma_f32_16x16x32_bf16 v[252:255], a[168:171], a[58:61], v[252:255]
    s_mov_b32 s67, 702464
    ds_write_b32 v28, v116 offset:0
    v_mul_f32 v186, v186, v106
    v_mfma_f32_16x16x32_bf16 v[252:255], a[172:175], a[66:69], v[252:255]
    v_cvt_pk_bf16_f32 v91, v154, v186
    v_mul_f32 v187, v187, v107
    v_mfma_f32_16x16x32_bf16 v[156:159], a[240:243], a[40:43], v[156:159]
    v_mul_f32 v216, v216, v108
    v_mul_f32 v217, v217, v109
    v_mfma_f32_16x16x32_bf16 v[156:159], a[244:247], a[44:47], v[156:159]
    v_mul_f32 v218, v218, v110
    v_mul_f32 v219, v219, v111
    v_mfma_f32_16x16x32_bf16 v[156:159], a[248:251], a[48:51], v[156:159]
    v_cvt_pk_bf16_f32 v89, v216, v153
    v_cvt_pk_bf16_f32 v90, v185, v217
    v_mfma_f32_16x16x32_bf16 v[156:159], a[252:255], a[52:55], v[156:159]
    ds_write_b64 v26, v[88:89] offset:0
    v_cvt_pk_bf16_f32 v124, v218, v155
    v_mfma_f32_16x16x32_bf16 v[156:159], a[176:179], a[56:59], v[156:159]
    ds_write_b64 v26, v[90:91] offset:8
    v_cvt_pk_bf16_f32 v125, v187, v219
    v_mfma_f32_16x16x32_bf16 v[156:159], a[180:183], a[60:63], v[156:159]
    s_waitcnt vmcnt(12)
    ds_write_b64 v26, v[124:125] offset:16
    v_xor_b32 v8, 15, v8
    v_mfma_f32_16x16x32_bf16 v[156:159], a[184:187], a[64:67], v[156:159]
    ds_write_b64 v29, v[254:255] offset:2048
    v_or_b32 v8, v8, v0
    v_mfma_f32_16x16x32_bf16 v[156:159], a[188:191], a[68:71], v[156:159]
    v_min_u32 v8, 1, v8
    v_lshlrev_b32 v8, 30, v8
    v_mfma_f32_16x16x32_bf16 v[188:191], a[136:139], a[40:43], v[188:191]
    v_mov_b32 v9, s76
    v_mfma_f32_16x16x32_bf16 v[188:191], a[140:143], a[44:47], v[188:191]
    buffer_store_dword v9, v8, s[12:15], s78 offen sc1
    v_mfma_f32_16x16x32_bf16 v[188:191], a[144:147], a[48:51], v[188:191]
    v_mfma_f32_16x16x32_bf16 v[188:191], a[148:151], a[52:55], v[188:191]
    s_waitcnt lgkmcnt(0)
    s_barrier
    v_mfma_f32_16x16x32_bf16 v[188:191], a[192:195], a[56:59], v[188:191]
    ds_read_b128 v[52:55], v24 offset:0
    ds_read_b64 v[48:49], v30 offset:2048
    v_mfma_f32_16x16x32_bf16 v[188:191], a[196:199], a[60:63], v[188:191]
    ds_read_b128 v[92:95], v24 offset:928
    v_mul_f32 v156, v156, v100
    v_mfma_f32_16x16x32_bf16 v[188:191], a[200:203], a[64:67], v[188:191]
    v_mul_f32 v157, v157, v101
    v_mul_f32 v158, v158, v102
    v_mfma_f32_16x16x32_bf16 v[188:191], a[204:207], a[68:71], v[188:191]
    v_mul_f32 v159, v159, v103
    v_mfma_f32_16x16x32_bf16 v[220:223], a[152:155], a[40:43], v[220:223]
    v_mfma_f32_16x16x32_bf16 v[220:223], a[156:159], a[44:47], v[220:223]
    v_mfma_f32_16x16x32_bf16 v[220:223], a[160:163], a[48:51], v[220:223]
    s_waitcnt lgkmcnt(1)
    v_mfma_f32_16x16x32_bf16 v[220:223], a[164:167], a[52:55], v[220:223]
    buffer_store_dwordx4 v[52:55], v25, s[16:19], s66 offen sc1
    v_mfma_f32_16x16x32_bf16 v[220:223], a[208:211], a[56:59], v[220:223]
    s_mov_b32 s66, 802816
    v_add_f32 v252, v252, v48
    v_mul_f32 v252, v252, v96
    v_mfma_f32_16x16x32_bf16 v[220:223], a[212:215], a[60:63], v[220:223]
    v_add_f32 v253, v253, v49
    v_mul_f32 v253, v253, v97
    v_mfma_f32_16x16x32_bf16 v[220:223], a[216:219], a[64:67], v[220:223]
    s_waitcnt lgkmcnt(0)
    v_cvt_pk_bf16_f32 v48, v252, v253
    v_mfma_f32_16x16x32_bf16 v[220:223], a[220:223], a[68:71], v[220:223]
    buffer_store_dwordx4 v[92:95], v25, s[16:19], s67 offen sc1
    s_mov_b32 s67, 817152
    ds_write_b32 v28, v48 offset:7424
    v_mul_f32 v188, v188, v104
    v_cvt_pk_bf16_f32 v76, v156, v188
    v_mul_f32 v189, v189, v105
    v_mul_f32 v190, v190, v106
    v_cvt_pk_bf16_f32 v79, v158, v190
    v_mul_f32 v191, v191, v107
    v_mul_f32 v220, v220, v108
    v_mul_f32 v221, v221, v109
    v_mul_f32 v222, v222, v110
    v_mul_f32 v223, v223, v111
    v_cvt_pk_bf16_f32 v77, v220, v157
    v_cvt_pk_bf16_f32 v78, v189, v221
    v_cvt_pk_bf16_f32 v64, v222, v159
    v_cvt_pk_bf16_f32 v65, v191, v223
    ds_write_b64 v26, v[76:77] offset:7424
    ds_write_b64 v26, v[78:79] offset:7432
    ds_write_b64 v26, v[64:65] offset:7440
    s_waitcnt lgkmcnt(0)
    s_barrier
    ds_read_b128 v[80:83], v24 offset:7424
    ds_read_b128 v[72:75], v24 offset:8352
    s_waitcnt lgkmcnt(1)
    buffer_store_dwordx4 v[80:83], v25, s[16:19], s66 offen sc1
    s_waitcnt lgkmcnt(0)
    buffer_store_dwordx4 v[72:75], v25, s[16:19], s67 offen sc1
L_end:
    s_endpgm
L_slow1_0:
    s_mov_b32 s22, 1
    s_call_b64 s[20:21], L_tick
    buffer_load_dwordx4 v[80:83], v32, s[12:15], s40 offen sc1
    buffer_load_dwordx4 v[84:87], v33, s[12:15], s40 offen sc1
    s_waitcnt vmcnt(0)
    v_bitop3_b32 v12, v83, v87, s76 bitop3:0x7e
    v_cmp_lt_u32 vcc, 0xffff, v12
    s_cbranch_vccnz L_slow1_0
    s_branch L_back1_0
L_slow1_1:
    s_mov_b32 s22, 1
    s_call_b64 s[20:21], L_tick
    buffer_load_dwordx4 v[88:91], v34, s[12:15], s40 offen sc1
    buffer_load_dwordx4 v[92:95], v44, s[12:15], s40 offen sc1
    s_waitcnt vmcnt(0)
    v_bitop3_b32 v12, v91, v95, s76 bitop3:0x7e
    v_cmp_lt_u32 vcc, 0xffff, v12
    s_cbranch_vccnz L_slow1_1
    s_branch L_back1_1
L_slow2_0:
    s_mov_b32 s22, 2
    s_call_b64 s[20:21], L_tick
    buffer_load_dwordx4 v[48:51], v32, s[12:15], s41 offen sc1
    buffer_load_dwordx4 v[52:55], v33, s[12:15], s41 offen sc1
    s_waitcnt vmcnt(0)
    v_bitop3_b32 v12, v51, v55, s76 bitop3:0x7e
    v_cmp_lt_u32 vcc, 0xffff, v12
    s_cbranch_vccnz L_slow2_0
    s_branch L_back2_0
L_slow2_1:
    s_mov_b32 s22, 2
    s_call_b64 s[20:21], L_tick
    buffer_load_dwordx4 v[64:67], v34, s[12:15], s41 offen sc1
    buffer_load_dwordx4 v[68:71], v44, s[12:15], s41 offen sc1
    s_waitcnt vmcnt(0)
    v_bitop3_b32 v12, v67, v71, s76 bitop3:0x7e
    v_cmp_lt_u32 vcc, 0xffff, v12
    s_cbranch_vccnz L_slow2_1
    s_branch L_back2_1
L_slow3_0:
    s_mov_b32 s22, 3
    s_call_b64 s[20:21], L_tick
    buffer_load_dwordx4 v[72:75], v32, s[12:15], s42 offen sc1
    buffer_load_dwordx4 v[76:79], v33, s[12:15], s42 offen sc1
    s_waitcnt vmcnt(0)
    v_bitop3_b32 v12, v75, v79, s76 bitop3:0x7e
    v_cmp_lt_u32 vcc, 0xffff, v12
    s_cbranch_vccnz L_slow3_0
    s_branch L_back3_0
L_slow3_1:
    s_mov_b32 s22, 3
    s_call_b64 s[20:21], L_tick
    buffer_load_dwordx4 v[80:83], v34, s[12:15], s42 offen sc1
    buffer_load_dwordx4 v[84:87], v44, s[12:15], s42 offen sc1
    s_waitcnt vmcnt(0)
    v_bitop3_b32 v12, v83, v87, s76 bitop3:0x7e
    v_cmp_lt_u32 vcc, 0xffff, v12
    s_cbranch_vccnz L_slow3_1
    s_branch L_back3_1
L_slow4_0:
    s_mov_b32 s22, 4
    s_call_b64 s[20:21], L_tick
    buffer_load_dwordx4 v[96:99], v32, s[12:15], s43 offen sc1
    buffer_load_dwordx4 v[100:103], v33, s[12:15], s43 offen sc1
    s_waitcnt vmcnt(0)
    v_bitop3_b32 v12, v99, v103, s76 bitop3:0x7e
    v_cmp_lt_u32 vcc, 0xffff, v12
    s_cbranch_vccnz L_slow4_0
    s_branch L_back4_0
L_slow4_1:
    s_mov_b32 s22, 4
    s_call_b64 s[20:21], L_tick
    buffer_load_dwordx4 v[104:107], v34, s[12:15], s43 offen sc1
    buffer_load_dwordx4 v[108:111], v44, s[12:15], s43 offen sc1
    s_waitcnt vmcnt(0)
    v_bitop3_b32 v12, v107, v111, s76 bitop3:0x7e
    v_cmp_lt_u32 vcc, 0xffff, v12
    s_cbranch_vccnz L_slow4_1
    s_branch L_back4_1
L_slow5_0:
    s_mov_b32 s22, 5
    s_call_b64 s[20:21], L_tick
    buffer_load_dwordx4 v[112:115], v32, s[12:15], s44 offen sc1
    buffer_load_dwordx4 v[116:119], v33, s[12:15], s44 offen sc1
    s_waitcnt vmcnt(0)
    v_bitop3_b32 v12, v115, v119, s76 bitop3:0x7e
    v_cmp_lt_u32 vcc, 0xffff, v12
    s_cbranch_vccnz L_slow5_0
    s_branch L_back5_0
L_slow5_1:
    s_mov_b32 s22, 5
    s_call_b64 s[20:21], L_tick
    buffer_load_dwordx4 v[120:123], v34, s[12:15], s44 offen sc1
    buffer_load_dwordx4 v[124:127], v44, s[12:15], s44 offen sc1
    s_waitcnt vmcnt(0)
    v_bitop3_b32 v12, v123, v127, s76 bitop3:0x7e
    v_cmp_lt_u32 vcc, 0xffff, v12
    s_cbranch_vccnz L_slow5_1
    s_branch L_back5_1
L_slow6_0:
    s_mov_b32 s22, 6
    s_call_b64 s[20:21], L_tick
    buffer_load_dwordx4 v[88:91], v32, s[12:15], s45 offen sc1
    buffer_load_dwordx4 v[92:95], v33, s[12:15], s45 offen sc1
    s_waitcnt vmcnt(0)
    v_bitop3_b32 v12, v91, v95, s76 bitop3:0x7e
    v_cmp_lt_u32 vcc, 0xffff, v12
    s_cbranch_vccnz L_slow6_0
    s_branch L_back6_0
L_slow6_1:
    s_mov_b32 s22, 6
    s_call_b64 s[20:21], L_tick
    buffer_load_dwordx4 v[48:51], v34, s[12:15], s45 offen sc1
    buffer_load_dwordx4 v[52:55], v44, s[12:15], s45 offen sc1
    s_waitcnt vmcnt(0)
    v_bitop3_b32 v12, v51, v55, s76 bitop3:0x7e
    v_cmp_lt_u32 vcc, 0xffff, v12
    s_cbranch_vccnz L_slow6_1
    s_branch L_back6_1
L_slow7_0:
    s_mov_b32 s22, 7
    s_call_b64 s[20:21], L_tick
    buffer_load_dwordx4 v[72:75], v32, s[12:15], s72 offen sc1
    buffer_load_dwordx4 v[76:79], v33, s[12:15], s72 offen sc1
    s_waitcnt vmcnt(0)
    v_bitop3_b32 v12, v75, v79, s76 bitop3:0x7e
    v_cmp_lt_u32 vcc, 0xffff, v12
    s_cbranch_vccnz L_slow7_0
    s_branch L_back7_0
L_slow7_1:
    s_mov_b32 s22, 7
    s_call_b64 s[20:21], L_tick
    buffer_load_dwordx4 v[80:83], v34, s[12:15], s72 offen sc1
    buffer_load_dwordx4 v[84:87], v44, s[12:15], s72 offen sc1
    s_waitcnt vmcnt(0)
    v_bitop3_b32 v12, v83, v87, s76 bitop3:0x7e
    v_cmp_lt_u32 vcc, 0xffff, v12
    s_cbranch_vccnz L_slow7_1
    s_branch L_back7_1
L_tick:
    s_add_u32 s52, s52, 1
    s_and_b32 s23, s52, 4095
    s_cbranch_scc1 L_tick_ret
L_help:
    s_mov_b32 s53, s61
    s_mov_b32 s54, s62
    s_mul_i32 s61, s22, 1835008
    s_add_u32 s61, s61, s79
    s_lshl_b32 s62, s22, 14
    s_add_u32 s62, s62, s68
    s_mov_b32 s22, 0
L_help_row:
    v_mov_b32 v21, v19
    s_xor_b32 s23, s22, s58
    s_bitcmp0_b32 s23, 2
    s_cbranch_scc1 L_help_same
    v_add_u32 v12, 57344, v19
    v_subrev_u32 v13, 57344, v19
    v_min_u32 v21, v12, v13
L_help_same:
    v_mov_b32 v8, 0
    v_mov_b32 v9, 0
    v_mov_b32 v10, 0
    v_mov_b32 v11, s47
    s_mov_b32 s23, 0
L_help_e:
    v_mov_b32 v15, 0
    buffer_load_dwordx3 v[12:14], v18, s[4:7], s61 offen
    s_cmp_ge_u32 s23, 16
    s_cbranch_scc1 L_help_own
    buffer_load_dword v15, v21, s[4:7], s61 offen
L_help_own:
    s_waitcnt vmcnt(0)
    v_lshl_or_b32 v8, v12, s23, v8
    v_lshl_or_b32 v9, v13, s23, v9
    v_lshl_or_b32 v10, v14, s23, v10
    v_lshl_or_b32 v11, v15, s23, v11
    s_add_u32 s61, s61, 14336
    s_add_u32 s23, s23, 4
    s_cmp_lt_u32 s23, 32
    s_cbranch_scc1 L_help_e
    buffer_store_dwordx4 v[8:11], v20, s[12:15], s62 offen sc1
    s_add_u32 s62, s62, 1024
    s_waitcnt vmcnt(0)
    s_add_u32 s22, s22, 1
    s_cmp_lt_u32 s22, 16
    s_cbranch_scc1 L_help_row
    s_mov_b32 s61, s53
    s_mov_b32 s62, s54
L_tick_ret:
    s_setpc_b64 s[20:21]
L_code_end:

.section .rodata,"a"
.p2align 6
.amdhsa_kernel standalone__normalfloat_lut_af4__prompt_kernel
  .amdhsa_next_free_vgpr 512
  .amdhsa_next_free_sgpr 102
  .amdhsa_accum_offset 256
  .amdhsa_group_segment_fixed_size 0
  .amdhsa_kernarg_size 56
  .amdhsa_user_sgpr_count 2
  .amdhsa_user_sgpr_kernarg_segment_ptr 1
  .amdhsa_system_sgpr_workgroup_id_x 1
.end_amdhsa_kernel
```

```asm
; @launch grid=(256,1,1) block=(256,1,1) lds=163840
.amdgcn_target "amdgcn-amd-amdhsa--gfx950"
.text
.globl standalone__normalfloat_lut_af4__prompt_kernel
.p2align 8
.type standalone__normalfloat_lut_af4__prompt_kernel,@function
standalone__normalfloat_lut_af4__prompt_kernel:
    s_cmp_ge_u32 s2, 256
    s_cbranch_scc1 L_end
    s_load_dwordx2 s[4:5], s[0:1], 8
    s_load_dwordx2 s[12:13], s[0:1], 48
    s_load_dwordx2 s[8:9], s[0:1], 0
    s_load_dwordx2 s[28:29], s[0:1], 16
    s_getpc_b64 s[48:49]
    s_mov_b32 s50, L_code_end-standalone__normalfloat_lut_af4__prompt_kernel-256
    s_mov_b32 s51, 0x20000
    s_lshr_b32 s61, s2, 3
    v_lshl_add_u32 v10, v0, 5, s61
    v_lshlrev_b32 v10, 7, v10
    buffer_load_dword v1, v10, s[48:51], 0 offen offset:256
    v_lshrrev_b32 v5, 6, v0
    v_and_b32 v2, 63, v0
    s_and_b32 s60, s2, 7
    v_readfirstlane_b32 s63, v5
    s_and_b32 s58, s60, 1
    s_lshl_b32 s58, s58, 3
    s_and_b32 s62, s61, 7
    s_add_u32 s58, s58, s62
    s_lshr_b32 s59, s60, 1
    s_lshl_b32 s59, s59, 2
    s_lshr_b32 s62, s61, 3
    s_add_u32 s59, s59, s62
    v_mul_u32_u24 v18, 12, v2
    s_lshl_b32 s60, s63, 4
    s_add_u32 s60, s60, s58
    s_mul_i32 s61, s60, 114688
    s_mul_i32 s79, s59, 896
    s_add_u32 s61, s61, s79
    s_mov_b32 s6, 14680064
    s_mov_b32 s7, 0x20000
    s_lshl_b32 s78, s59, 7
    s_add_u32 s78, s78, 2097152
    v_and_b32 v4, 15, v2
    v_lshrrev_b32 v3, 4, v2
    v_and_b32 v12, 1, v3
    v_lshlrev_b32 v13, 1, v12
    v_xor_b32 v13, v13, v4
    v_lshrrev_b32 v19, 1, v3
    v_lshl_add_u32 v19, v19, 4, v13
    s_bfe_u32 s70, s58, 0x10002
    s_xor_b32 s70, s70, 1
    v_xor_b32 v12, s70, v12
    v_mul_u32_u24 v12, 14336, v12
    v_add_lshl_u32 v19, v19, v12, 2
    v_add_u32 v19, 768, v19
    s_mov_b32 s46, 2
    s_cmp_lg_u32 s63, 0
    s_cbranch_scc1 L_role0
    s_mov_b32 s46, 0
L_role0:
    s_cmp_lg_u32 s63, 1
    s_cbranch_scc1 L_role1
    s_mov_b32 s46, 1
L_role1:
    v_lshlrev_b32 v16, 1, v4
    v_lshrrev_b32 v17, 4, v0
    v_lshlrev_b32 v17, 1, v17
    s_mov_b32 s30, 32
    s_mov_b32 s31, 0x20000
    v_lshrrev_b32 v6, 3, v2
    v_and_b32 v7, 7, v2
    v_xor_b32 v13, v7, v3
    s_lshl_b32 s70, s63, 5
    v_add_lshl_u32 v12, v6, s70, 11
    v_lshl_add_u32 v36, v13, 4, v12
    v_xor_b32 v37, 64, v36
    v_add_u32 v38, 30720, v36
    v_add_u32 v37, 15360, v37
    v_add_u32 v39, 30720, v37
    s_mov_b32 s10, 4194304
    s_mov_b32 s11, 0x20000
    s_lshl_b32 s55, s58, 18
    s_and_b32 s71, s58, 8
    s_lshl_b32 s70, s71, 4
    s_add_u32 s55, s55, s70
    s_xor_b32 s69, s55, 128
    s_lshl_b32 s57, s63, 12
    s_add_u32 s57, s57, 65536
    s_mov_b32 s14, 2099200
    s_mov_b32 s15, 0x20000
    s_lshl_b32 s68, s59, 17
    s_lshl_b32 s62, s60, 10
    s_add_u32 s62, s62, s68
    v_lshlrev_b32 v20, 4, v2
    s_waitcnt lgkmcnt(0)
    s_load_dword s76, s[12:13], s78
    s_cmp_eq_u32 s46, 1
    s_cbranch_scc1 L_L
    s_cmp_eq_u32 s46, 2
    s_cbranch_scc1 L_L
L_X:
    buffer_load_dwordx3 v[128:130], v18, s[4:7], s61 offen
    buffer_load_dword v131, v19, s[4:7], s61 offen
    s_add_u32 s61, s61, 14336
    buffer_load_dwordx3 v[132:134], v18, s[4:7], s61 offen
    buffer_load_dword v135, v19, s[4:7], s61 offen
    s_add_u32 s61, s61, 14336
    buffer_load_dwordx3 v[136:138], v18, s[4:7], s61 offen
    buffer_load_dword v139, v19, s[4:7], s61 offen
    s_add_u32 s61, s61, 14336
    buffer_load_dwordx3 v[140:142], v18, s[4:7], s61 offen
    buffer_load_dword v143, v19, s[4:7], s61 offen
    s_add_u32 s61, s61, 14336
    buffer_load_dwordx3 v[144:146], v18, s[4:7], s61 offen
    s_add_u32 s61, s61, 14336
    buffer_load_dwordx3 v[148:150], v18, s[4:7], s61 offen
    s_add_u32 s61, s61, 14336
    buffer_load_dwordx3 v[152:154], v18, s[4:7], s61 offen
    s_add_u32 s61, s61, 14336
    buffer_load_dwordx3 v[156:158], v18, s[4:7], s61 offen
    s_add_u32 s61, s61, 7239680
    s_cmp_eq_u32 s46, 1
    s_cbranch_scc1 L_D
    s_cmp_eq_u32 s46, 2
    s_cbranch_scc1 L_B
L_L:
    buffer_load_ushort v16, v16, s[28:31], 0 offen
    buffer_load_ushort v17, v17, s[28:31], 0 offen
    s_cmp_eq_u32 s46, 1
    s_cbranch_scc1 L_S
    s_cmp_eq_u32 s46, 2
    s_cbranch_scc1 L_S
L_D:
    s_add_u32 m0, s57, 32768
    s_add_u32 s56, s55, 0
    buffer_load_dwordx4 v36, s[8:11], s56 offen offset:0 lds
    buffer_load_dwordx4 v37, s[8:11], s56 offen offset:1024 lds
    buffer_load_dwordx4 v38, s[8:11], s56 offen offset:2048 lds
    buffer_load_dwordx4 v39, s[8:11], s56 offen offset:3072 lds
    s_cmp_eq_u32 s46, 1
    s_cbranch_scc1 L_G
    s_cmp_eq_u32 s46, 2
    s_cbranch_scc1 L_G
L_S:
    s_load_dwordx2 s[32:33], s[0:1], 24
    s_load_dwordx2 s[16:17], s[0:1], 32
    s_load_dwordx2 s[24:25], s[0:1], 40
    s_and_b32 s64, s63, 1
    s_lshr_b32 s65, s63, 1
    s_and_b32 s70, s58, 8
    s_lshl_b32 s70, s70, 10
    s_lshl_b32 s71, s64, 12
    s_add_u32 s70, s70, s71
    s_lshl_b32 s71, s63, 8
    s_add_u32 s70, s70, s71
    s_add_u32 s70, s70, s68
    v_lshl_add_u32 v32, v4, 4, s70
    v_lshl_add_u32 v32, v3, 10, v32
    v_xor_b32 v33, 4096, v32
    v_xor_b32 v34, 8192, v32
    v_xor_b32 v44, 12288, v32
    s_mov_b32 s36, 202114048
    s_mov_b32 s37, 202114304
    s_mov_b32 s38, 202114560
    s_mov_b32 s39, 202114816
    v_and_b32 v35, 31, v2
    v_lshlrev_b32 v35, 2, v35
    s_lshl_b32 s70, s64, 6
    s_add_u32 s70, s70, 65536
    v_lshrrev_b32 v12, 1, v4
    v_xor_b32 v12, v12, v3
    v_lshlrev_b32 v12, 4, v12
    v_lshl_add_u32 v12, v4, 7, v12
    v_xor_b32 v40, s70, v12
    v_xor_b32 v41, 64, v40
    v_add_u32 v42, 65536, v40
    v_add_u32 v43, 65536, v41
    s_mov_b32 s52, 0
    v_lshlrev_b32 v8, 4, v7
    v_lshl_add_u32 v8, v0, 8, v8
    v_xor_b32 v9, 16, v8
    v_xor_b32 v10, 32, v8
    v_xor_b32 v11, 48, v8
    v_xor_b32 v12, 64, v8
    v_xor_b32 v13, 80, v8
    v_xor_b32 v14, 96, v8
    v_xor_b32 v15, 112, v8
    s_cmp_eq_u32 s46, 1
    s_cbranch_scc1 L_X
    s_cmp_eq_u32 s46, 2
    s_cbranch_scc1 L_D
L_G:
    s_waitcnt lgkmcnt(0)
    s_add_u32 s76, s76, 2654435769
    s_and_b32 s47, s76, 0xffff0000
    s_cmp_eq_u32 s46, 1
    s_cbranch_scc1 L_T
    s_cmp_eq_u32 s46, 2
    s_cbranch_scc1 L_T
L_K:
    s_waitcnt vmcnt(16)
    v_or_b32 v131, s47, v131
    s_waitcnt vmcnt(15)
    v_lshl_or_b32 v128, v132, 4, v128
    v_lshl_or_b32 v129, v133, 4, v129
    v_lshl_or_b32 v130, v134, 4, v130
    s_waitcnt vmcnt(14)
    v_lshl_or_b32 v131, v135, 4, v131
    s_waitcnt vmcnt(13)
    v_lshl_or_b32 v128, v136, 8, v128
    v_lshl_or_b32 v129, v137, 8, v129
    v_lshl_or_b32 v130, v138, 8, v130
    s_waitcnt vmcnt(12)
    v_lshl_or_b32 v131, v139, 8, v131
    s_waitcnt vmcnt(11)
    v_lshl_or_b32 v128, v140, 12, v128
    v_lshl_or_b32 v129, v141, 12, v129
    v_lshl_or_b32 v130, v142, 12, v130
    s_waitcnt vmcnt(10)
    v_lshl_or_b32 v131, v143, 12, v131
    s_waitcnt vmcnt(9)
    v_lshl_or_b32 v128, v144, 16, v128
    v_lshl_or_b32 v129, v145, 16, v129
    v_lshl_or_b32 v130, v146, 16, v130
    s_waitcnt vmcnt(8)
    v_lshl_or_b32 v128, v148, 20, v128
    v_lshl_or_b32 v129, v149, 20, v129
    v_lshl_or_b32 v130, v150, 20, v130
    s_waitcnt vmcnt(7)
    v_lshl_or_b32 v128, v152, 24, v128
    v_lshl_or_b32 v129, v153, 24, v129
    v_lshl_or_b32 v130, v154, 24, v130
    s_waitcnt vmcnt(6)
    v_lshl_or_b32 v128, v156, 28, v128
    v_lshl_or_b32 v129, v157, 28, v129
    v_lshl_or_b32 v130, v158, 28, v130
    buffer_store_dwordx4 v[128:131], v20, s[12:15], s62 offen sc1
    s_add_u32 s62, s62, 65536
    s_cmp_eq_u32 s46, 1
    s_cbranch_scc1 L_B
    s_cmp_eq_u32 s46, 2
    s_cbranch_scc1 L_E
L_T:
    s_waitcnt vmcnt(16)
    s_cmp_eq_u32 s46, 1
    s_cbranch_scc1 L_rw1
    s_waitcnt vmcnt(5)
    s_cmp_eq_u32 s46, 0
    s_cbranch_scc1 L_rw1
    s_waitcnt vmcnt(4)
L_rw1:
    v_lshl_or_b32 v56, v17, 16, v16
    v_lshl_or_b32 v57, v17, 16, v16
    v_lshl_or_b32 v58, v17, 16, v16
    v_lshl_or_b32 v59, v17, 16, v16
    ds_write_b128 v8, v[56:59]
    ds_write_b128 v9, v[56:59]
    ds_write_b128 v10, v[56:59]
    ds_write_b128 v11, v[56:59]
    ds_write_b128 v12, v[56:59]
    ds_write_b128 v13, v[56:59]
    ds_write_b128 v14, v[56:59]
    ds_write_b128 v15, v[56:59]
    s_cmp_lg_u32 s46, 1
    s_cbranch_scc1 L_ed2
    s_waitcnt vmcnt(4)
    s_branch L_K
L_ed2:
    s_cmp_eq_u32 s46, 2
    s_cbranch_scc1 L_X
L_W:
    s_mov_b64 exec, 0
    s_cmp_eq_u32 s63, 0
    s_cbranch_scc1 L_pad0
L_warmed:
    s_mov_b64 exec, -1
L_B:
    s_waitcnt vmcnt(12) lgkmcnt(0)
    s_cmp_eq_u32 s46, 2
    s_cbranch_scc1 L_rw3
    s_waitcnt vmcnt(1)
L_rw3:
    s_barrier
L_Q:
    ds_read_b128 a[0:3], v40 offset:32768
    ds_read_b128 a[4:7], v41 offset:32768
    ds_read_b128 a[8:11], v40 offset:34816
    ds_read_b128 a[12:15], v41 offset:34816
    ds_read_b128 a[16:19], v40 offset:36864
    ds_read_b128 a[20:23], v41 offset:36864
    ds_read_b128 a[24:27], v40 offset:38912
    ds_read_b128 a[28:31], v41 offset:38912
    ds_read_b128 a[32:35], v40 offset:40960
    ds_read_b128 a[36:39], v41 offset:40960
    ds_read_b128 a[40:43], v40 offset:43008
    ds_read_b128 a[44:47], v41 offset:43008
    ds_read_b128 a[48:51], v40 offset:45056
    ds_read_b128 a[52:55], v41 offset:45056
    ds_read_b128 a[56:59], v40 offset:47104
    ds_read_b128 a[60:63], v41 offset:47104
L_P:
    buffer_load_dwordx4 v[64:67], v32, s[12:15], 0 offen sc1
    buffer_load_dwordx4 v[68:71], v33, s[12:15], 0 offen sc1
L_d:
    s_add_u32 m0, s57, 49152
    s_add_u32 s3, s69, 0
    buffer_load_dwordx4 v36, s[8:11], s3 offen offset:0 lds
    buffer_load_dwordx4 v37, s[8:11], s3 offen offset:1024 lds
    buffer_load_dwordx4 v38, s[8:11], s3 offen offset:2048 lds
    buffer_load_dwordx4 v39, s[8:11], s3 offen offset:3072 lds
L_p:
    buffer_load_dwordx4 v[72:75], v34, s[12:15], 0 offen sc1
    buffer_load_dwordx4 v[76:79], v44, s[12:15], 0 offen sc1
    s_cmp_lg_u32 s46, 2
    s_cbranch_scc1 L_ed4
    s_waitcnt vmcnt(8)
    s_branch L_K
L_ed4:
L_E:
L_chk0:
    s_waitcnt vmcnt(7)
    s_cmp_eq_u32 s46, 2
    s_cbranch_scc1 L_rw5
    s_waitcnt vmcnt(6)
L_rw5:
    v_bitop3_b32 v12, v67, v71, s76 bitop3:0x7e
    v_cmp_lt_u32 vcc, 0xffff, v12
    s_cbranch_vccnz L_retry0
    v_perm_b32 v56, v64, v35, s36
    v_perm_b32 v57, v64, v35, s37
    v_perm_b32 v58, v64, v35, s38
    v_perm_b32 v59, v64, v35, s39
    v_perm_b32 v60, v68, v35, s36
    v_perm_b32 v61, v68, v35, s37
    v_perm_b32 v62, v68, v35, s38
    v_perm_b32 v63, v68, v35, s39
    ds_read_b32 a136, v56
    ds_read_b32 a137, v57
    ds_read_b32 a138, v58
    ds_read_b32 a139, v59
    ds_read_b32 a140, v60
    ds_read_b32 a141, v61
    ds_read_b32 a142, v62
    ds_read_b32 a143, v63
    v_perm_b32 v56, v65, v35, s36
    v_perm_b32 v57, v65, v35, s37
    v_perm_b32 v58, v65, v35, s38
    v_perm_b32 v59, v65, v35, s39
    v_perm_b32 v60, v69, v35, s36
    v_perm_b32 v61, v69, v35, s37
    ds_read_b32 a144, v56
    ds_read_b32 a145, v57
    ds_read_b32 a146, v58
    ds_read_b32 a147, v59
    s_cbranch_vccz L_main
L_retry0:
    s_add_u32 s52, s52, 1
    s_and_b32 s23, s52, 4095
    s_cbranch_scc1 L_retry0b
    s_mov_b32 s22, 0
    s_call_b64 s[20:21], L_help
L_retry0b:
    buffer_load_dwordx4 v[64:67], v32, s[12:15], 0 offen sc1
    buffer_load_dwordx4 v[68:71], v33, s[12:15], 0 offen sc1
    buffer_load_dwordx4 v[72:75], v34, s[12:15], 0 offen sc1
    buffer_load_dwordx4 v[76:79], v44, s[12:15], 0 offen sc1
    s_waitcnt vmcnt(0) lgkmcnt(0)
    s_branch L_chk0
.p2align 12
L_main:
L_pad0:
    s_cbranch_execz L_pad1
    s_waitcnt lgkmcnt(8)
    v_mfma_f32_16x16x32_bf16 v[128:131], a[136:139], a[0:3], 0
    s_waitcnt lgkmcnt(4)
    s_mov_b32 s40, 16384
    ds_read_b32 a148, v60
    v_mfma_f32_16x16x32_bf16 v[128:131], a[140:143], a[4:7], v[128:131]
    buffer_load_dwordx4 v[80:83], v32, s[12:15], s40 offen sc1
    v_mfma_f32_16x16x32_bf16 v[132:135], a[136:139], a[8:11], 0
    s_add_u32 m0, s57, 65536
    ds_read_b32 a149, v61
    v_perm_b32 v62, v69, v35, s38
    v_mfma_f32_16x16x32_bf16 v[132:135], a[140:143], a[12:15], v[132:135]
    s_add_u32 s56, s55, 256
    ds_read_b32 a150, v62
    v_perm_b32 v63, v69, v35, s39
    v_mfma_f32_16x16x32_bf16 v[136:139], a[136:139], a[16:19], 0
    s_add_u32 s3, s69, 256
    ds_read_b32 a151, v63
    v_mfma_f32_16x16x32_bf16 v[136:139], a[140:143], a[20:23], v[136:139]
    buffer_load_dwordx4 v[84:87], v33, s[12:15], s40 offen sc1
    v_mfma_f32_16x16x32_bf16 v[140:143], a[136:139], a[24:27], 0
    v_perm_b32 v56, v66, v35, s36
    v_perm_b32 v57, v66, v35, s37
    v_mfma_f32_16x16x32_bf16 v[140:143], a[140:143], a[28:31], v[140:143]
    ds_read_b32 a152, v56
    v_perm_b32 v58, v66, v35, s38
    v_mfma_f32_16x16x32_bf16 v[144:147], a[136:139], a[32:35], 0
    ds_read_b32 a153, v57
    v_mfma_f32_16x16x32_bf16 v[144:147], a[140:143], a[36:39], v[144:147]
    buffer_load_dwordx4 v36, s[8:11], s56 offen offset:0 lds
    v_mfma_f32_16x16x32_bf16 v[148:151], a[136:139], a[40:43], 0
    ds_read_b32 a154, v58
    v_perm_b32 v59, v66, v35, s39
    v_mfma_f32_16x16x32_bf16 v[148:151], a[140:143], a[44:47], v[148:151]
    ds_read_b32 a155, v59
    v_perm_b32 v60, v70, v35, s36
    v_mfma_f32_16x16x32_bf16 v[152:155], a[136:139], a[48:51], 0
    s_mov_b32 s41, 32768
    ds_read_b32 a156, v60
    v_mfma_f32_16x16x32_bf16 v[152:155], a[140:143], a[52:55], v[152:155]
    buffer_load_dwordx4 v37, s[8:11], s56 offen offset:1024 lds
    v_mfma_f32_16x16x32_bf16 v[156:159], a[136:139], a[56:59], 0
    s_waitcnt vmcnt(4)
    v_bitop3_b32 v61, v75, v79, s76 bitop3:0x7e
    v_perm_b32 v62, v70, v35, s37
    v_mfma_f32_16x16x32_bf16 v[156:159], a[140:143], a[60:63], v[156:159]
    s_waitcnt lgkmcnt(5)
    v_cmp_lt_u32 vcc, 0xffff, v61
    v_perm_b32 v63, v70, v35, s38
    v_mfma_f32_16x16x32_bf16 v[160:163], a[144:147], a[0:3], 0
    ds_read_b32 a157, v62
    ds_read_b32 a158, v63
    v_mfma_f32_16x16x32_bf16 v[160:163], a[148:151], a[4:7], v[160:163]
    buffer_load_dwordx4 v38, s[8:11], s56 offen offset:2048 lds
    v_mfma_f32_16x16x32_bf16 v[164:167], a[144:147], a[8:11], 0
    v_perm_b32 v56, v70, v35, s39
    s_cbranch_vccnz L_slow0_1
L_back0_1:
    v_mfma_f32_16x16x32_bf16 v[164:167], a[148:151], a[12:15], v[164:167]
    v_perm_b32 v57, v67, v35, s36
    v_perm_b32 v58, v67, v35, s37
    v_mfma_f32_16x16x32_bf16 v[168:171], a[144:147], a[16:19], 0
    ds_read_b32 a159, v56
    ds_read_b32 a160, v57
    v_mfma_f32_16x16x32_bf16 v[168:171], a[148:151], a[20:23], v[168:171]
    buffer_load_dwordx4 v39, s[8:11], s56 offen offset:3072 lds
    v_mfma_f32_16x16x32_bf16 v[172:175], a[144:147], a[24:27], 0
    s_add_u32 m0, s57, 81920
    ds_read_b32 a161, v58
    v_perm_b32 v59, v71, v35, s36
    v_mfma_f32_16x16x32_bf16 v[172:175], a[148:151], a[28:31], v[172:175]
    s_add_u32 s56, s55, 512
    v_perm_b32 v60, v71, v35, s37
    v_perm_b32 v61, v72, v35, s36
    v_mfma_f32_16x16x32_bf16 v[176:179], a[144:147], a[32:35], 0
    s_mov_b32 s42, 49152
    ds_read_b32 a162, v59
    ds_read_b32 a163, v60
    v_mfma_f32_16x16x32_bf16 v[176:179], a[148:151], a[36:39], v[176:179]
    buffer_load_dwordx4 v[88:91], v34, s[12:15], s40 offen sc1
    v_mfma_f32_16x16x32_bf16 v[180:183], a[144:147], a[40:43], 0
    ds_read_b32 a164, v61
    v_perm_b32 v62, v72, v35, s37
    v_mfma_f32_16x16x32_bf16 v[180:183], a[148:151], a[44:47], v[180:183]
    v_perm_b32 v63, v72, v35, s38
    v_perm_b32 v56, v72, v35, s39
    v_mfma_f32_16x16x32_bf16 v[184:187], a[144:147], a[48:51], 0
    s_barrier
    v_mfma_f32_16x16x32_bf16 v[184:187], a[148:151], a[52:55], v[184:187]
    buffer_load_dwordx4 v[92:95], v44, s[12:15], s40 offen sc1
    v_mfma_f32_16x16x32_bf16 v[188:191], a[144:147], a[56:59], 0
    ds_read_b32 a165, v62
    ds_read_b32 a166, v63
    v_mfma_f32_16x16x32_bf16 v[188:191], a[148:151], a[60:63], v[188:191]
    s_waitcnt lgkmcnt(5)
    ds_read_b32 a167, v56
    v_perm_b32 v57, v76, v35, s36
    v_mfma_f32_16x16x32_bf16 v[192:195], a[152:155], a[0:3], 0
    ds_read_b32 a168, v57
    ds_read_b128 a[64:67], v40 offset:49152
    v_mfma_f32_16x16x32_bf16 v[192:195], a[156:159], a[4:7], v[192:195]
    buffer_load_dwordx4 v36, s[8:11], s3 offen offset:0 lds
    v_mfma_f32_16x16x32_bf16 v[196:199], a[152:155], a[8:11], 0
    ds_read_b128 a[68:71], v41 offset:49152
    v_perm_b32 v58, v76, v35, s37
    v_mfma_f32_16x16x32_bf16 v[196:199], a[156:159], a[12:15], v[196:199]
    ds_read_b32 a169, v58
    v_perm_b32 v59, v76, v35, s38
    v_mfma_f32_16x16x32_bf16 v[200:203], a[152:155], a[16:19], 0
    s_mov_b32 s43, 65536
    ds_read_b32 a170, v59
    ds_read_b128 a[72:75], v40 offset:51200
    v_mfma_f32_16x16x32_bf16 v[200:203], a[156:159], a[20:23], v[200:203]
    buffer_load_dwordx4 v37, s[8:11], s3 offen offset:1024 lds
    v_mfma_f32_16x16x32_bf16 v[204:207], a[152:155], a[24:27], 0
    ds_read_b128 a[76:79], v41 offset:51200
    v_perm_b32 v60, v76, v35, s39
    v_mfma_f32_16x16x32_bf16 v[204:207], a[156:159], a[28:31], v[204:207]
    ds_read_b32 a171, v60
    v_perm_b32 v61, v73, v35, s36
    v_mfma_f32_16x16x32_bf16 v[208:211], a[152:155], a[32:35], 0
    ds_read_b32 a172, v61
    ds_read_b128 a[80:83], v40 offset:53248
    v_mfma_f32_16x16x32_bf16 v[208:211], a[156:159], a[36:39], v[208:211]
    buffer_load_dwordx4 v38, s[8:11], s3 offen offset:2048 lds
    v_mfma_f32_16x16x32_bf16 v[212:215], a[152:155], a[40:43], 0
    ds_read_b128 a[84:87], v41 offset:53248
    v_perm_b32 v62, v73, v35, s37
    v_mfma_f32_16x16x32_bf16 v[212:215], a[156:159], a[44:47], v[212:215]
    ds_read_b32 a173, v62
    ds_read_b128 a[88:91], v40 offset:55296
    v_mfma_f32_16x16x32_bf16 v[216:219], a[152:155], a[48:51], 0
    ds_read_b128 a[92:95], v41 offset:55296
    v_perm_b32 v63, v73, v35, s38
    v_mfma_f32_16x16x32_bf16 v[216:219], a[156:159], a[52:55], v[216:219]
    ds_read_b32 a174, v63
    ds_read_b128 a[96:99], v40 offset:57344
    v_mfma_f32_16x16x32_bf16 v[220:223], a[152:155], a[56:59], 0
    v_perm_b32 v56, v73, v35, s39
    v_perm_b32 v57, v77, v35, s36
    v_mfma_f32_16x16x32_bf16 v[220:223], a[156:159], a[60:63], v[220:223]
    s_waitcnt lgkmcnt(9)
    ds_read_b32 a175, v56
    ds_read_b32 a176, v57
    v_mfma_f32_16x16x32_bf16 v[224:227], a[160:163], a[2:5], 0
    buffer_load_dwordx4 v39, s[8:11], s3 offen offset:3072 lds
    v_mfma_f32_16x16x32_bf16 v[228:231], a[160:163], a[10:13], 0
    s_add_u32 m0, s57, 0
    ds_read_b128 a[100:103], v41 offset:57344
    v_perm_b32 v58, v77, v35, s37
    v_mfma_f32_16x16x32_bf16 v[232:235], a[160:163], a[18:21], 0
    s_add_u32 s3, s69, 512
    ds_read_b32 a177, v58
    ds_read_b128 a[104:107], v40 offset:59392
    v_mfma_f32_16x16x32_bf16 v[236:239], a[160:163], a[26:29], 0
    s_mov_b32 s44, 81920
    v_perm_b32 v59, v77, v35, s38
    v_perm_b32 v60, v77, v35, s39
    v_mfma_f32_16x16x32_bf16 v[240:243], a[160:163], a[34:37], 0
    ds_read_b32 a178, v59
    ds_read_b32 a179, v60
    v_mfma_f32_16x16x32_bf16 v[244:247], a[160:163], a[42:45], 0
    buffer_load_dwordx3 v[96:98], v18, s[4:7], s61 offen
    v_mfma_f32_16x16x32_bf16 v[248:251], a[160:163], a[50:53], 0
    ds_read_b128 a[108:111], v41 offset:59392
    v_perm_b32 v61, v74, v35, s36
    v_mfma_f32_16x16x32_bf16 v[252:255], a[160:163], a[58:61], 0
    ds_read_b32 a180, v61
    v_perm_b32 v62, v74, v35, s37
    v_mfma_f32_16x16x32_bf16 v[128:131], a[164:167], a[64:67], v[128:131]
    s_waitcnt vmcnt(11) lgkmcnt(7)
    ds_read_b128 a[112:115], v40 offset:61440
    ds_read_b32 a181, v62
    v_mfma_f32_16x16x32_bf16 v[128:131], a[168:171], a[68:71], v[128:131]
    buffer_load_dword v99, v19, s[4:7], s61 offen
    v_mfma_f32_16x16x32_bf16 v[132:135], a[164:167], a[72:75], v[132:135]
    s_add_u32 s61, s61, 14336
    ds_read_b128 a[116:119], v41 offset:61440
    v_bitop3_b32 v63, v83, v87, s76 bitop3:0x7e
    v_mfma_f32_16x16x32_bf16 v[132:135], a[168:171], a[76:79], v[132:135]
    v_cmp_lt_u32 vcc, 0xffff, v63
    v_perm_b32 v56, v74, v35, s38
    v_mfma_f32_16x16x32_bf16 v[136:139], a[164:167], a[80:83], v[136:139]
    s_mov_b32 s45, 98304
    ds_read_b128 a[120:123], v40 offset:63488
    ds_read_b32 a182, v56
    v_mfma_f32_16x16x32_bf16 v[136:139], a[168:171], a[84:87], v[136:139]
    buffer_load_dwordx3 v[100:102], v18, s[4:7], s61 offen
    v_mfma_f32_16x16x32_bf16 v[140:143], a[164:167], a[88:91], v[140:143]
    ds_read_b128 a[124:127], v41 offset:63488
    s_cbranch_vccnz L_slow1_0
L_back1_0:
    v_mfma_f32_16x16x32_bf16 v[140:143], a[168:171], a[92:95], v[140:143]
    v_perm_b32 v57, v74, v35, s39
    v_perm_b32 v58, v78, v35, s36
    v_mfma_f32_16x16x32_bf16 v[144:147], a[164:167], a[96:99], v[144:147]
    s_waitcnt lgkmcnt(6)
    ds_read_b32 a183, v57
    ds_read_b32 a184, v58
    v_mfma_f32_16x16x32_bf16 v[144:147], a[168:171], a[100:103], v[144:147]
    buffer_load_dword v103, v19, s[4:7], s61 offen
    v_mfma_f32_16x16x32_bf16 v[148:151], a[164:167], a[104:107], v[148:151]
    s_add_u32 s61, s61, 14336
    v_perm_b32 v59, v78, v35, s37
    v_perm_b32 v60, v78, v35, s38
    v_mfma_f32_16x16x32_bf16 v[148:151], a[168:171], a[108:111], v[148:151]
    s_waitcnt lgkmcnt(5)
    ds_read_b32 a185, v59
    v_perm_b32 v61, v78, v35, s39
    v_mfma_f32_16x16x32_bf16 v[152:155], a[164:167], a[112:115], v[152:155]
    s_waitcnt lgkmcnt(5)
    ds_read_b32 a186, v60
    ds_read_b32 a187, v61
    v_mfma_f32_16x16x32_bf16 v[152:155], a[168:171], a[116:119], v[152:155]
    buffer_load_dwordx3 v[104:106], v18, s[4:7], s61 offen
    v_mfma_f32_16x16x32_bf16 v[156:159], a[164:167], a[120:123], v[156:159]
    s_waitcnt lgkmcnt(5)
    v_perm_b32 v62, v75, v35, s36
    v_perm_b32 v63, v75, v35, s37
    v_mfma_f32_16x16x32_bf16 v[156:159], a[168:171], a[124:127], v[156:159]
    ds_read_b32 a188, v62
    v_perm_b32 v56, v79, v35, s36
    v_mfma_f32_16x16x32_bf16 v[160:163], a[172:175], a[64:67], v[160:163]
    s_mov_b32 s72, 114688
    ds_read_b32 a189, v63
    ds_read_b32 a190, v56
    v_mfma_f32_16x16x32_bf16 v[160:163], a[176:179], a[68:71], v[160:163]
    buffer_load_dword v107, v19, s[4:7], s61 offen
    v_mfma_f32_16x16x32_bf16 v[164:167], a[172:175], a[72:75], v[164:167]
    s_add_u32 s61, s61, 14336
    v_perm_b32 v57, v79, v35, s37
    v_perm_b32 v58, v80, v35, s36
    v_mfma_f32_16x16x32_bf16 v[164:167], a[176:179], a[76:79], v[164:167]
    ds_read_b32 a191, v57
    v_perm_b32 v59, v80, v35, s37
    v_mfma_f32_16x16x32_bf16 v[168:171], a[172:175], a[80:83], v[168:171]
    ds_read_b32 a192, v58
    ds_read_b32 a193, v59
    v_mfma_f32_16x16x32_bf16 v[168:171], a[176:179], a[84:87], v[168:171]
    buffer_load_dwordx3 v[108:110], v18, s[4:7], s61 offen
    v_mfma_f32_16x16x32_bf16 v[172:175], a[172:175], a[88:91], v[172:175]
    v_perm_b32 v60, v80, v35, s38
    v_perm_b32 v61, v80, v35, s39
    v_mfma_f32_16x16x32_bf16 v[172:175], a[176:179], a[92:95], v[172:175]
    ds_read_b32 a194, v60
    v_perm_b32 v62, v84, v35, s36
    v_mfma_f32_16x16x32_bf16 v[176:179], a[172:175], a[96:99], v[176:179]
    ds_read_b32 a195, v61
    ds_read_b32 a196, v62
    v_mfma_f32_16x16x32_bf16 v[176:179], a[176:179], a[100:103], v[176:179]
    buffer_load_dword v111, v19, s[4:7], s61 offen
    v_mfma_f32_16x16x32_bf16 v[180:183], a[172:175], a[104:107], v[180:183]
    s_add_u32 s61, s61, 14336
    v_perm_b32 v63, v84, v35, s37
    v_perm_b32 v56, v84, v35, s38
    v_mfma_f32_16x16x32_bf16 v[180:183], a[176:179], a[108:111], v[180:183]
    ds_read_b32 a197, v63
    v_perm_b32 v57, v84, v35, s39
    v_mfma_f32_16x16x32_bf16 v[184:187], a[172:175], a[112:115], v[184:187]
    ds_read_b32 a198, v56
    ds_read_b32 a199, v57
    v_mfma_f32_16x16x32_bf16 v[184:187], a[176:179], a[116:119], v[184:187]
    buffer_load_dwordx3 v[112:114], v18, s[4:7], s61 offen
    v_mfma_f32_16x16x32_bf16 v[188:191], a[172:175], a[120:123], v[188:191]
    s_add_u32 s61, s61, 14336
    v_perm_b32 v58, v81, v35, s36
    v_perm_b32 v59, v81, v35, s37
    v_mfma_f32_16x16x32_bf16 v[188:191], a[176:179], a[124:127], v[188:191]
    s_waitcnt vmcnt(15) lgkmcnt(6)
    ds_read_b32 a200, v58
    v_perm_b32 v60, v81, v35, s38
    v_mfma_f32_16x16x32_bf16 v[192:195], a[180:183], a[64:67], v[192:195]
    s_barrier
    v_mfma_f32_16x16x32_bf16 v[192:195], a[184:187], a[68:71], v[192:195]
    buffer_load_dwordx3 v[116:118], v18, s[4:7], s61 offen
    v_mfma_f32_16x16x32_bf16 v[196:199], a[180:183], a[72:75], v[196:199]
    s_add_u32 s61, s61, 14336
    ds_read_b128 a[128:131], v42 offset:0
    ds_read_b32 a201, v59
    v_mfma_f32_16x16x32_bf16 v[196:199], a[184:187], a[76:79], v[196:199]
    ds_read_b128 a[132:135], v43 offset:0
    ds_read_b32 a202, v60
    v_mfma_f32_16x16x32_bf16 v[200:203], a[180:183], a[80:83], v[200:203]
    ds_read_b128 a[0:3], v42 offset:2048
    v_perm_b32 v61, v81, v35, s39
    v_mfma_f32_16x16x32_bf16 v[200:203], a[184:187], a[84:87], v[200:203]
    ds_read_b128 a[4:7], v43 offset:2048
    ds_read_b32 a203, v61
    v_mfma_f32_16x16x32_bf16 v[204:207], a[180:183], a[88:91], v[204:207]
    buffer_load_dwordx3 v[120:122], v18, s[4:7], s61 offen
    v_mfma_f32_16x16x32_bf16 v[204:207], a[184:187], a[92:95], v[204:207]
    s_add_u32 s61, s61, 14336
    ds_read_b128 a[8:11], v42 offset:4096
    v_perm_b32 v62, v85, v35, s36
    v_mfma_f32_16x16x32_bf16 v[208:211], a[180:183], a[96:99], v[208:211]
    ds_read_b128 a[12:15], v43 offset:4096
    ds_read_b32 a204, v62
    v_mfma_f32_16x16x32_bf16 v[208:211], a[184:187], a[100:103], v[208:211]
    ds_read_b128 a[16:19], v42 offset:6144
    v_perm_b32 v63, v85, v35, s37
    v_mfma_f32_16x16x32_bf16 v[212:215], a[180:183], a[104:107], v[212:215]
    ds_read_b128 a[20:23], v43 offset:6144
    ds_read_b32 a205, v63
    v_mfma_f32_16x16x32_bf16 v[212:215], a[184:187], a[108:111], v[212:215]
    buffer_load_dwordx3 v[124:126], v18, s[4:7], s61 offen
    v_mfma_f32_16x16x32_bf16 v[216:219], a[180:183], a[112:115], v[216:219]
    s_waitcnt vmcnt(16)
    ds_read_b128 a[24:27], v42 offset:8192
    v_bitop3_b32 v56, v91, v95, s76 bitop3:0x7e
    v_mfma_f32_16x16x32_bf16 v[216:219], a[184:187], a[116:119], v[216:219]
    ds_read_b128 a[28:31], v43 offset:8192
    v_cmp_lt_u32 vcc, 0xffff, v56
    v_mfma_f32_16x16x32_bf16 v[220:223], a[180:183], a[120:123], v[220:223]
    ds_read_b128 a[32:35], v42 offset:10240
    v_perm_b32 v57, v85, v35, s38
    v_mfma_f32_16x16x32_bf16 v[220:223], a[184:187], a[124:127], v[220:223]
    ds_read_b128 a[36:39], v43 offset:10240
    ds_read_b32 a206, v57
    v_mfma_f32_16x16x32_bf16 v[224:227], a[188:191], a[66:69], v[224:227]
    buffer_load_dwordx4 v[48:51], v32, s[12:15], s41 offen sc1
    v_mfma_f32_16x16x32_bf16 v[228:231], a[188:191], a[74:77], v[228:231]
    ds_read_b128 a[40:43], v42 offset:12288
    s_cbranch_vccnz L_slow1_1
L_back1_1:
    v_mfma_f32_16x16x32_bf16 v[232:235], a[188:191], a[82:85], v[232:235]
    ds_read_b128 a[44:47], v43 offset:12288
    v_perm_b32 v58, v85, v35, s39
    v_mfma_f32_16x16x32_bf16 v[236:239], a[188:191], a[90:93], v[236:239]
    ds_read_b32 a207, v58
    v_perm_b32 v59, v82, v35, s36
    v_mfma_f32_16x16x32_bf16 v[240:243], a[188:191], a[98:101], v[240:243]
    ds_read_b32 a208, v59
    ds_read_b128 a[48:51], v42 offset:14336
    v_mfma_f32_16x16x32_bf16 v[244:247], a[188:191], a[106:109], v[244:247]
    buffer_load_dwordx4 v[52:55], v33, s[12:15], s41 offen sc1
    v_mfma_f32_16x16x32_bf16 v[248:251], a[188:191], a[114:117], v[248:251]
    ds_read_b128 a[52:55], v43 offset:14336
    v_perm_b32 v60, v82, v35, s37
    v_mfma_f32_16x16x32_bf16 v[252:255], a[188:191], a[122:125], v[252:255]
    s_waitcnt lgkmcnt(8)
    ds_read_b32 a209, v60
    v_perm_b32 v61, v82, v35, s38
    v_mfma_f32_16x16x32_bf16 v[128:131], a[192:195], a[128:131], v[128:131]
    ds_read_b32 a210, v61
    v_perm_b32 v62, v82, v35, s39
    v_mfma_f32_16x16x32_bf16 v[128:131], a[196:199], a[132:135], v[128:131]
    ds_read_b32 a211, v62
    v_perm_b32 v63, v86, v35, s36
    v_mfma_f32_16x16x32_bf16 v[132:135], a[192:195], a[0:3], v[132:135]
    v_perm_b32 v56, v86, v35, s37
    v_perm_b32 v57, v86, v35, s38
    v_mfma_f32_16x16x32_bf16 v[132:135], a[196:199], a[4:7], v[132:135]
    ds_read_b32 a212, v63
    v_perm_b32 v58, v86, v35, s39
    v_mfma_f32_16x16x32_bf16 v[136:139], a[192:195], a[8:11], v[136:139]
    ds_read_b32 a213, v56
    v_perm_b32 v59, v83, v35, s36
    v_mfma_f32_16x16x32_bf16 v[136:139], a[196:199], a[12:15], v[136:139]
    ds_read_b32 a214, v57
    ds_read_b32 a215, v58
    v_mfma_f32_16x16x32_bf16 v[140:143], a[192:195], a[16:19], v[140:143]
    buffer_load_dwordx4 v36, s[8:11], s56 offen offset:0 lds
    v_mfma_f32_16x16x32_bf16 v[140:143], a[196:199], a[20:23], v[140:143]
    ds_read_b32 a216, v59
    v_perm_b32 v60, v83, v35, s37
    v_mfma_f32_16x16x32_bf16 v[144:147], a[192:195], a[24:27], v[144:147]
    ds_read_b32 a217, v60
    v_perm_b32 v61, v87, v35, s36
    v_mfma_f32_16x16x32_bf16 v[144:147], a[196:199], a[28:31], v[144:147]
    v_perm_b32 v62, v87, v35, s37
    v_perm_b32 v63, v88, v35, s36
    v_mfma_f32_16x16x32_bf16 v[148:151], a[192:195], a[32:35], v[148:151]
    s_waitcnt lgkmcnt(6)
    ds_read_b32 a218, v61
    ds_read_b32 a219, v62
    v_mfma_f32_16x16x32_bf16 v[148:151], a[196:199], a[36:39], v[148:151]
    buffer_load_dwordx4 v37, s[8:11], s56 offen offset:1024 lds
    v_mfma_f32_16x16x32_bf16 v[152:155], a[192:195], a[40:43], v[152:155]
    ds_read_b32 a220, v63
    v_perm_b32 v56, v88, v35, s37
    v_mfma_f32_16x16x32_bf16 v[152:155], a[196:199], a[44:47], v[152:155]
    ds_read_b32 a221, v56
    v_perm_b32 v57, v88, v35, s38
    v_mfma_f32_16x16x32_bf16 v[156:159], a[192:195], a[48:51], v[156:159]
    ds_read_b32 a222, v57
    v_perm_b32 v58, v88, v35, s39
    v_mfma_f32_16x16x32_bf16 v[156:159], a[196:199], a[52:55], v[156:159]
    ds_read_b32 a223, v58
    v_perm_b32 v59, v92, v35, s36
    v_mfma_f32_16x16x32_bf16 v[160:163], a[200:203], a[128:131], v[160:163]
    ds_read_b32 a224, v59
    v_perm_b32 v60, v92, v35, s37
    v_mfma_f32_16x16x32_bf16 v[160:163], a[204:207], a[132:135], v[160:163]
    v_perm_b32 v61, v92, v35, s38
    v_perm_b32 v62, v92, v35, s39
    v_mfma_f32_16x16x32_bf16 v[164:167], a[200:203], a[0:3], v[164:167]
    ds_read_b32 a225, v60
    ds_read_b32 a226, v61
    v_mfma_f32_16x16x32_bf16 v[164:167], a[204:207], a[4:7], v[164:167]
    buffer_load_dwordx4 v38, s[8:11], s56 offen offset:2048 lds
    v_mfma_f32_16x16x32_bf16 v[168:171], a[200:203], a[8:11], v[168:171]
    ds_read_b32 a227, v62
    v_perm_b32 v63, v89, v35, s36
    v_mfma_f32_16x16x32_bf16 v[168:171], a[204:207], a[12:15], v[168:171]
    ds_read_b32 a228, v63
    v_perm_b32 v56, v89, v35, s37
    v_mfma_f32_16x16x32_bf16 v[172:175], a[200:203], a[16:19], v[172:175]
    ds_read_b32 a229, v56
    v_perm_b32 v57, v89, v35, s38
    v_mfma_f32_16x16x32_bf16 v[172:175], a[204:207], a[20:23], v[172:175]
    ds_read_b32 a230, v57
    v_perm_b32 v58, v89, v35, s39
    v_mfma_f32_16x16x32_bf16 v[176:179], a[200:203], a[24:27], v[176:179]
    v_perm_b32 v59, v93, v35, s36
    v_perm_b32 v60, v93, v35, s37
    v_mfma_f32_16x16x32_bf16 v[176:179], a[204:207], a[28:31], v[176:179]
    s_waitcnt vmcnt(17)
    ds_read_b32 a231, v58
    ds_read_b32 a232, v59
    v_mfma_f32_16x16x32_bf16 v[180:183], a[200:203], a[32:35], v[180:183]
    buffer_load_dwordx4 v39, s[8:11], s56 offen offset:3072 lds
    v_mfma_f32_16x16x32_bf16 v[180:183], a[204:207], a[36:39], v[180:183]
    s_add_u32 m0, s57, 16384
    ds_read_b32 a233, v60
    v_perm_b32 v61, v93, v35, s38
    v_mfma_f32_16x16x32_bf16 v[184:187], a[200:203], a[40:43], v[184:187]
    s_barrier
    v_mfma_f32_16x16x32_bf16 v[184:187], a[204:207], a[44:47], v[184:187]
    s_add_u32 s56, s55, 768
    ds_read_b32 a234, v61
    v_perm_b32 v62, v93, v35, s39
    v_mfma_f32_16x16x32_bf16 v[188:191], a[200:203], a[48:51], v[188:191]
    ds_read_b32 a235, v62
    ds_read_b128 a[56:59], v42 offset:16384
    v_mfma_f32_16x16x32_bf16 v[188:191], a[204:207], a[52:55], v[188:191]
    buffer_load_dwordx4 v[64:67], v34, s[12:15], s41 offen sc1
    v_mfma_f32_16x16x32_bf16 v[192:195], a[208:211], a[128:131], v[192:195]
    s_waitcnt lgkmcnt(6)
    ds_read_b128 a[60:63], v43 offset:16384
    v_perm_b32 v63, v90, v35, s36
    v_mfma_f32_16x16x32_bf16 v[192:195], a[212:215], a[132:135], v[192:195]
    ds_read_b32 a236, v63
    ds_read_b128 a[64:67], v42 offset:18432
    v_mfma_f32_16x16x32_bf16 v[196:199], a[208:211], a[0:3], v[196:199]
    v_perm_b32 v56, v90, v35, s37
    v_perm_b32 v57, v90, v35, s38
    v_mfma_f32_16x16x32_bf16 v[196:199], a[212:215], a[4:7], v[196:199]
    ds_read_b32 a237, v56
    ds_read_b32 a238, v57
    v_mfma_f32_16x16x32_bf16 v[200:203], a[208:211], a[8:11], v[200:203]
    buffer_load_dwordx4 v[68:71], v44, s[12:15], s41 offen sc1
    v_mfma_f32_16x16x32_bf16 v[200:203], a[212:215], a[12:15], v[200:203]
    ds_read_b128 a[68:71], v43 offset:18432
    v_perm_b32 v58, v90, v35, s39
    v_mfma_f32_16x16x32_bf16 v[204:207], a[208:211], a[16:19], v[204:207]
    ds_read_b32 a239, v58
    ds_read_b128 a[72:75], v42 offset:20480
    v_mfma_f32_16x16x32_bf16 v[204:207], a[212:215], a[20:23], v[204:207]
    v_perm_b32 v59, v94, v35, s36
    v_perm_b32 v60, v94, v35, s37
    v_mfma_f32_16x16x32_bf16 v[208:211], a[208:211], a[24:27], v[208:211]
    ds_read_b32 a240, v59
    ds_read_b32 a241, v60
    v_mfma_f32_16x16x32_bf16 v[208:211], a[212:215], a[28:31], v[208:211]
    buffer_load_dwordx4 v[72:75], v32, s[12:15], s42 offen sc1
    v_mfma_f32_16x16x32_bf16 v[212:215], a[208:211], a[32:35], v[212:215]
    ds_read_b128 a[76:79], v43 offset:20480
    v_perm_b32 v61, v94, v35, s38
    v_mfma_f32_16x16x32_bf16 v[212:215], a[212:215], a[36:39], v[212:215]
    ds_read_b32 a242, v61
    v_perm_b32 v62, v94, v35, s39
    v_mfma_f32_16x16x32_bf16 v[216:219], a[208:211], a[40:43], v[216:219]
    ds_read_b32 a243, v62
    ds_read_b128 a[80:83], v42 offset:22528
    v_mfma_f32_16x16x32_bf16 v[216:219], a[212:215], a[44:47], v[216:219]
    buffer_load_dwordx4 v[76:79], v33, s[12:15], s42 offen sc1
    v_mfma_f32_16x16x32_bf16 v[220:223], a[208:211], a[48:51], v[220:223]
    s_waitcnt vmcnt(18)
    ds_read_b128 a[84:87], v43 offset:22528
    v_perm_b32 v63, v91, v35, s36
    v_mfma_f32_16x16x32_bf16 v[220:223], a[212:215], a[52:55], v[220:223]
    v_or_b32 v99, s47, v99
    v_lshl_or_b32 v96, v100, 4, v96
    v_lshl_or_b32 v97, v101, 4, v97
    v_lshl_or_b32 v98, v102, 4, v98
    v_lshl_or_b32 v99, v103, 4, v99
    s_waitcnt vmcnt(17)
    v_lshl_or_b32 v96, v104, 8, v96
    v_lshl_or_b32 v97, v105, 8, v97
    v_lshl_or_b32 v98, v106, 8, v98
    s_waitcnt vmcnt(16)
    v_lshl_or_b32 v99, v107, 8, v99
    s_waitcnt vmcnt(15)
    v_lshl_or_b32 v96, v108, 12, v96
    v_lshl_or_b32 v97, v109, 12, v97
    v_lshl_or_b32 v98, v110, 12, v98
    s_waitcnt vmcnt(14)
    v_lshl_or_b32 v99, v111, 12, v99
    s_waitcnt vmcnt(13)
    v_lshl_or_b32 v96, v112, 16, v96
    v_lshl_or_b32 v97, v113, 16, v97
    v_lshl_or_b32 v98, v114, 16, v98
    s_waitcnt vmcnt(12)
    v_lshl_or_b32 v96, v116, 20, v96
    v_lshl_or_b32 v97, v117, 20, v97
    v_lshl_or_b32 v98, v118, 20, v98
    s_waitcnt vmcnt(11)
    v_lshl_or_b32 v96, v120, 24, v96
    v_lshl_or_b32 v97, v121, 24, v97
    v_lshl_or_b32 v98, v122, 24, v98
    s_waitcnt vmcnt(10)
    v_lshl_or_b32 v96, v124, 28, v96
    v_lshl_or_b32 v97, v125, 28, v97
    v_lshl_or_b32 v98, v126, 28, v98
    buffer_store_dwordx4 v[96:99], v20, s[12:15], s62 offen sc1
    s_mul_i32 s66, s63, 96
    s_lshl_b32 s67, s65, 5
    s_lshl_b32 s70, s64, 2
    s_add_u32 s67, s67, s70
    s_add_u32 s67, s67, 384
    s_mul_i32 s71, s59, 448
    s_add_u32 s70, s66, s71
    v_mad_u32_u24 v22, v3, 24, s70
    s_add_u32 s70, s67, s71
    v_lshl_add_u32 v23, v3, 3, s70
    s_mov_b32 s34, 7168
    s_mov_b32 s35, 0x20000
    s_mov_b32 s26, 256
    s_mov_b32 s27, 0x20000
    s_lshl_b32 s77, s59, 4
    s_mov_b32 s18, 14680064
    s_mov_b32 s19, 0x20000
    s_sub_u32 s70, 65536, s71
    v_mul_u32_u24 v16, 464, v4
    v_add3_u32 v26, v22, v16, s70
L_pad1:
    s_cbranch_execz L_pad2
    v_add3_u32 v28, v23, v16, s70
    v_lshlrev_b32 v29, 3, v0
    v_xor_b32 v30, 512, v29
    v_add_u32 v29, 87808, v29
    v_add_u32 v30, 87808, v30
    v_mul_u32_u24 v16, 2341, v2
    v_lshrrev_b32 v16, 16, v16
    s_mul_i32 s73, s63, 1856
    s_add_u32 s73, s73, 65536
    v_add_lshl_u32 v24, v2, v16, 4
    v_add_u32 v24, s73, v24
    s_lshl_b32 s74, s58, 7
    s_lshl_b32 s75, s63, 2
    s_add_u32 s74, s74, s75
    s_mul_i32 s74, s74, 7168
    s_add_u32 s74, s74, s71
    v_mul_u32_u24 v17, 6720, v16
    v_lshl_add_u32 v25, v2, 4, v17
    v_lshrrev_b32 v16, 1, v16
    v_lshlrev_b32 v16, 30, v16
    v_add3_u32 v25, v25, v16, s74
    v_mfma_f32_16x16x32_bf16 v[224:227], a[216:219], a[130:133], v[224:227]
    ds_read_b32 a244, v63
    ds_read_b128 a[88:91], v42 offset:24576
    v_mfma_f32_16x16x32_bf16 v[228:231], a[216:219], a[2:5], v[228:231]
    ds_read_b128 a[92:95], v43 offset:24576
    v_perm_b32 v56, v91, v35, s37
    v_mfma_f32_16x16x32_bf16 v[232:235], a[216:219], a[10:13], v[232:235]
    ds_read_b32 a245, v56
    ds_read_b128 a[96:99], v42 offset:26624
    v_mfma_f32_16x16x32_bf16 v[236:239], a[216:219], a[18:21], v[236:239]
    v_perm_b32 v57, v95, v35, s36
    v_perm_b32 v58, v95, v35, s37
    v_mfma_f32_16x16x32_bf16 v[240:243], a[216:219], a[26:29], v[240:243]
    ds_read_b32 a246, v57
    ds_read_b32 a247, v58
    v_mfma_f32_16x16x32_bf16 v[244:247], a[216:219], a[34:37], v[244:247]
    buffer_load_dwordx4 v36, s[8:11], s3 offen offset:0 lds
    v_mfma_f32_16x16x32_bf16 v[248:251], a[216:219], a[42:45], v[248:251]
    ds_read_b128 a[100:103], v43 offset:26624
    v_mfma_f32_16x16x32_bf16 v[252:255], a[216:219], a[50:53], v[252:255]
    s_waitcnt lgkmcnt(8)
    ds_read_b128 a[104:107], v42 offset:28672
    v_mfma_f32_16x16x32_bf16 v[128:131], a[220:223], a[56:59], v[128:131]
    ds_read_b128 a[108:111], v43 offset:28672
    v_mfma_f32_16x16x32_bf16 v[128:131], a[224:227], a[60:63], v[128:131]
    ds_read_b128 a[112:115], v42 offset:30720
    v_mfma_f32_16x16x32_bf16 v[132:135], a[220:223], a[64:67], v[132:135]
    v_mfma_f32_16x16x32_bf16 v[132:135], a[224:227], a[68:71], v[132:135]
    ds_read_b128 a[116:119], v43 offset:30720
    v_mfma_f32_16x16x32_bf16 v[136:139], a[220:223], a[72:75], v[136:139]
    buffer_load_dwordx4 v37, s[8:11], s3 offen offset:1024 lds
    v_mfma_f32_16x16x32_bf16 v[136:139], a[224:227], a[76:79], v[136:139]
    v_mfma_f32_16x16x32_bf16 v[140:143], a[220:223], a[80:83], v[140:143]
    v_mfma_f32_16x16x32_bf16 v[140:143], a[224:227], a[84:87], v[140:143]
    s_waitcnt lgkmcnt(4)
    v_mfma_f32_16x16x32_bf16 v[144:147], a[220:223], a[88:91], v[144:147]
    v_mfma_f32_16x16x32_bf16 v[144:147], a[224:227], a[92:95], v[144:147]
    v_mfma_f32_16x16x32_bf16 v[148:151], a[220:223], a[96:99], v[148:151]
    s_waitcnt lgkmcnt(1)
    v_mfma_f32_16x16x32_bf16 v[148:151], a[224:227], a[100:103], v[148:151]
    buffer_load_dwordx4 v38, s[8:11], s3 offen offset:2048 lds
    v_mfma_f32_16x16x32_bf16 v[152:155], a[220:223], a[104:107], v[152:155]
    v_mfma_f32_16x16x32_bf16 v[152:155], a[224:227], a[108:111], v[152:155]
    v_mfma_f32_16x16x32_bf16 v[156:159], a[220:223], a[112:115], v[156:159]
    s_waitcnt lgkmcnt(0)
    v_mfma_f32_16x16x32_bf16 v[156:159], a[224:227], a[116:119], v[156:159]
    v_mfma_f32_16x16x32_bf16 v[160:163], a[228:231], a[56:59], v[160:163]
    v_mfma_f32_16x16x32_bf16 v[160:163], a[232:235], a[60:63], v[160:163]
    v_mfma_f32_16x16x32_bf16 v[164:167], a[228:231], a[64:67], v[164:167]
    v_mfma_f32_16x16x32_bf16 v[164:167], a[232:235], a[68:71], v[164:167]
    buffer_load_dwordx4 v39, s[8:11], s3 offen offset:3072 lds
    v_mfma_f32_16x16x32_bf16 v[168:171], a[228:231], a[72:75], v[168:171]
    s_waitcnt vmcnt(13)
    s_add_u32 m0, s57, 32768
    v_bitop3_b32 v59, v51, v55, s76 bitop3:0x7e
    v_mfma_f32_16x16x32_bf16 v[168:171], a[232:235], a[76:79], v[168:171]
    s_add_u32 s3, s69, 768
    v_cmp_lt_u32 vcc, 0xffff, v59
    v_mfma_f32_16x16x32_bf16 v[172:175], a[228:231], a[80:83], v[172:175]
    v_mfma_f32_16x16x32_bf16 v[172:175], a[232:235], a[84:87], v[172:175]
    s_cbranch_vccnz L_slow2_0
L_back2_0:
    v_mfma_f32_16x16x32_bf16 v[176:179], a[228:231], a[88:91], v[176:179]
    v_perm_b32 v60, v48, v35, s36
    v_perm_b32 v61, v48, v35, s37
    v_mfma_f32_16x16x32_bf16 v[176:179], a[232:235], a[92:95], v[176:179]
    ds_read_b32 a248, v60
    ds_read_b32 a249, v61
    v_perm_b32 v62, v48, v35, s38
    v_mfma_f32_16x16x32_bf16 v[180:183], a[228:231], a[96:99], v[180:183]
    ds_read_b32 a250, v62
    v_perm_b32 v63, v48, v35, s39
    v_perm_b32 v56, v52, v35, s36
    v_mfma_f32_16x16x32_bf16 v[180:183], a[232:235], a[100:103], v[180:183]
    ds_read_b32 a251, v63
    ds_read_b32 a252, v56
    v_perm_b32 v57, v52, v35, s37
    v_mfma_f32_16x16x32_bf16 v[184:187], a[228:231], a[104:107], v[184:187]
    ds_read_b32 a253, v57
    v_mfma_f32_16x16x32_bf16 v[184:187], a[232:235], a[108:111], v[184:187]
    buffer_load_dwordx4 v36, s[8:11], s56 offen offset:0 lds
    v_mfma_f32_16x16x32_bf16 v[188:191], a[228:231], a[112:115], v[188:191]
    v_perm_b32 v58, v52, v35, s38
    v_perm_b32 v59, v52, v35, s39
    v_mfma_f32_16x16x32_bf16 v[188:191], a[232:235], a[116:119], v[188:191]
    ds_read_b32 a254, v58
    ds_read_b32 a255, v59
    v_mfma_f32_16x16x32_bf16 v[192:195], a[236:239], a[56:59], v[192:195]
    v_perm_b32 v60, v49, v35, s36
    v_perm_b32 v61, v49, v35, s37
    v_mfma_f32_16x16x32_bf16 v[192:195], a[240:243], a[60:63], v[192:195]
    ds_read_b32 a136, v60
    ds_read_b32 a137, v61
    v_perm_b32 v62, v49, v35, s38
    v_mfma_f32_16x16x32_bf16 v[196:199], a[236:239], a[64:67], v[196:199]
    ds_read_b32 a138, v62
    v_mfma_f32_16x16x32_bf16 v[196:199], a[240:243], a[68:71], v[196:199]
    buffer_load_dwordx4 v37, s[8:11], s56 offen offset:1024 lds
    v_mfma_f32_16x16x32_bf16 v[200:203], a[236:239], a[72:75], v[200:203]
    v_perm_b32 v63, v49, v35, s39
    v_perm_b32 v56, v53, v35, s36
    v_mfma_f32_16x16x32_bf16 v[200:203], a[240:243], a[76:79], v[200:203]
    ds_read_b32 a139, v63
    ds_read_b32 a140, v56
    v_mfma_f32_16x16x32_bf16 v[204:207], a[236:239], a[80:83], v[204:207]
    v_perm_b32 v57, v53, v35, s37
    v_perm_b32 v58, v53, v35, s38
    v_mfma_f32_16x16x32_bf16 v[204:207], a[240:243], a[84:87], v[204:207]
    ds_read_b32 a141, v57
    ds_read_b32 a142, v58
    v_perm_b32 v59, v53, v35, s39
    v_mfma_f32_16x16x32_bf16 v[208:211], a[236:239], a[88:91], v[208:211]
    ds_read_b32 a143, v59
    v_mfma_f32_16x16x32_bf16 v[208:211], a[240:243], a[92:95], v[208:211]
    buffer_load_dwordx4 v38, s[8:11], s56 offen offset:2048 lds
    v_mfma_f32_16x16x32_bf16 v[212:215], a[236:239], a[96:99], v[212:215]
    v_perm_b32 v60, v50, v35, s36
    v_perm_b32 v61, v50, v35, s37
    v_mfma_f32_16x16x32_bf16 v[212:215], a[240:243], a[100:103], v[212:215]
    ds_read_b32 a144, v60
    ds_read_b32 a145, v61
    v_mfma_f32_16x16x32_bf16 v[216:219], a[236:239], a[104:107], v[216:219]
    v_perm_b32 v62, v50, v35, s38
    v_perm_b32 v63, v50, v35, s39
    v_mfma_f32_16x16x32_bf16 v[216:219], a[240:243], a[108:111], v[216:219]
    ds_read_b32 a146, v62
    ds_read_b32 a147, v63
    v_mfma_f32_16x16x32_bf16 v[220:223], a[236:239], a[112:115], v[220:223]
    s_waitcnt vmcnt(12)
    v_perm_b32 v56, v54, v35, s36
    v_perm_b32 v57, v54, v35, s37
    v_mfma_f32_16x16x32_bf16 v[220:223], a[240:243], a[116:119], v[220:223]
    s_barrier
    v_mfma_f32_16x16x32_bf16 v[224:227], a[244:247], a[58:61], v[224:227]
    buffer_load_dwordx4 v39, s[8:11], s56 offen offset:3072 lds
    v_mfma_f32_16x16x32_bf16 v[228:231], a[244:247], a[66:69], v[228:231]
    s_add_u32 m0, s57, 49152
    ds_read_b128 a[120:123], v40 offset:0
    ds_read_b32 a148, v56
    v_mfma_f32_16x16x32_bf16 v[232:235], a[244:247], a[74:77], v[232:235]
    s_add_u32 s56, s55, 1024
    ds_read_b128 a[124:127], v41 offset:0
    ds_read_b32 a149, v57
    v_mfma_f32_16x16x32_bf16 v[236:239], a[244:247], a[82:85], v[236:239]
    ds_read_b128 a[128:131], v40 offset:2048
    v_perm_b32 v58, v54, v35, s38
    v_mfma_f32_16x16x32_bf16 v[240:243], a[244:247], a[90:93], v[240:243]
    ds_read_b128 a[132:135], v41 offset:2048
    ds_read_b32 a150, v58
    v_mfma_f32_16x16x32_bf16 v[244:247], a[244:247], a[98:101], v[244:247]
    ds_read_b128 a[0:3], v40 offset:4096
    v_perm_b32 v59, v54, v35, s39
    v_mfma_f32_16x16x32_bf16 v[248:251], a[244:247], a[106:109], v[248:251]
    ds_read_b128 a[4:7], v41 offset:4096
    ds_read_b32 a151, v59
    v_mfma_f32_16x16x32_bf16 v[252:255], a[244:247], a[114:117], v[252:255]
    s_waitcnt lgkmcnt(9)
    ds_read_b128 a[8:11], v40 offset:6144
    v_perm_b32 v60, v51, v35, s36
    v_mfma_f32_16x16x32_bf16 v[128:131], a[248:251], a[120:123], v[128:131]
    s_waitcnt lgkmcnt(8)
    ds_read_b128 a[12:15], v41 offset:6144
    ds_read_b32 a152, v60
    v_mfma_f32_16x16x32_bf16 v[128:131], a[252:255], a[124:127], v[128:131]
    s_waitcnt lgkmcnt(8)
    buffer_load_dwordx4 v36, s[8:11], s3 offen offset:0 lds
    v_mfma_f32_16x16x32_bf16 v[132:135], a[248:251], a[128:131], v[132:135]
    s_waitcnt lgkmcnt(7)
    ds_read_b128 a[16:19], v40 offset:8192
    v_perm_b32 v61, v51, v35, s37
    v_mfma_f32_16x16x32_bf16 v[132:135], a[252:255], a[132:135], v[132:135]
    s_waitcnt vmcnt(12) lgkmcnt(6)
    ds_read_b128 a[20:23], v41 offset:8192
    ds_read_b32 a153, v61
    v_bitop3_b32 v62, v67, v71, s76 bitop3:0x7e
    v_mfma_f32_16x16x32_bf16 v[136:139], a[248:251], a[0:3], v[136:139]
    s_waitcnt lgkmcnt(7)
    ds_read_b128 a[24:27], v40 offset:10240
    v_cmp_lt_u32 vcc, 0xffff, v62
    v_mfma_f32_16x16x32_bf16 v[136:139], a[252:255], a[4:7], v[136:139]
    s_waitcnt lgkmcnt(6)
    ds_read_b128 a[28:31], v41 offset:10240
    v_perm_b32 v63, v55, v35, s36
    v_mfma_f32_16x16x32_bf16 v[140:143], a[248:251], a[8:11], v[140:143]
    s_waitcnt lgkmcnt(6)
    ds_read_b128 a[32:35], v40 offset:12288
    s_cbranch_vccnz L_slow2_1
L_back2_1:
    v_mfma_f32_16x16x32_bf16 v[140:143], a[252:255], a[12:15], v[140:143]
    s_waitcnt lgkmcnt(5)
    buffer_load_dwordx4 v37, s[8:11], s3 offen offset:1024 lds
    v_mfma_f32_16x16x32_bf16 v[144:147], a[248:251], a[16:19], v[144:147]
    s_waitcnt lgkmcnt(4)
    ds_read_b128 a[36:39], v41 offset:12288
    ds_read_b32 a154, v63
    v_mfma_f32_16x16x32_bf16 v[144:147], a[252:255], a[20:23], v[144:147]
    s_waitcnt lgkmcnt(4)
    ds_read_b128 a[40:43], v40 offset:14336
    v_perm_b32 v56, v55, v35, s37
    v_mfma_f32_16x16x32_bf16 v[148:151], a[248:251], a[24:27], v[148:151]
    s_waitcnt lgkmcnt(4)
    ds_read_b128 a[44:47], v41 offset:14336
    ds_read_b32 a155, v56
    v_mfma_f32_16x16x32_bf16 v[148:151], a[252:255], a[28:31], v[148:151]
    s_waitcnt lgkmcnt(5)
    v_perm_b32 v57, v64, v35, s36
    v_perm_b32 v58, v64, v35, s37
    v_mfma_f32_16x16x32_bf16 v[152:155], a[248:251], a[32:35], v[152:155]
    s_waitcnt lgkmcnt(4)
    ds_read_b32 a156, v57
    ds_read_b32 a157, v58
    v_perm_b32 v59, v64, v35, s38
    v_mfma_f32_16x16x32_bf16 v[152:155], a[252:255], a[36:39], v[152:155]
    s_waitcnt lgkmcnt(4)
    ds_read_b32 a158, v59
    v_mfma_f32_16x16x32_bf16 v[156:159], a[248:251], a[40:43], v[156:159]
    s_waitcnt lgkmcnt(4)
    buffer_load_dwordx4 v38, s[8:11], s3 offen offset:2048 lds
    v_mfma_f32_16x16x32_bf16 v[156:159], a[252:255], a[44:47], v[156:159]
    s_waitcnt vmcnt(12)
    v_perm_b32 v61, v64, v35, s39
    v_bitop3_b32 v60, v75, v79, s76 bitop3:0x7e
    v_mfma_f32_16x16x32_bf16 v[160:163], a[136:139], a[120:123], v[160:163]
    ds_read_b32 a159, v61
    v_perm_b32 v62, v68, v35, s36
    v_mfma_f32_16x16x32_bf16 v[160:163], a[140:143], a[124:127], v[160:163]
    ds_read_b32 a160, v62
    v_perm_b32 v63, v68, v35, s37
    v_mfma_f32_16x16x32_bf16 v[164:167], a[136:139], a[128:131], v[164:167]
    ds_read_b32 a161, v63
    v_perm_b32 v56, v68, v35, s38
    v_mfma_f32_16x16x32_bf16 v[164:167], a[140:143], a[132:135], v[164:167]
    ds_read_b32 a162, v56
    v_perm_b32 v57, v68, v35, s39
    v_mfma_f32_16x16x32_bf16 v[168:171], a[136:139], a[0:3], v[168:171]
    ds_read_b32 a163, v57
    v_cmp_lt_u32 vcc, 0xffff, v60
    v_perm_b32 v58, v65, v35, s36
    v_mfma_f32_16x16x32_bf16 v[168:171], a[140:143], a[4:7], v[168:171]
    ds_read_b32 a164, v58
    v_mfma_f32_16x16x32_bf16 v[172:175], a[136:139], a[8:11], v[172:175]
    buffer_load_dwordx4 v39, s[8:11], s3 offen offset:3072 lds
    v_mfma_f32_16x16x32_bf16 v[172:175], a[140:143], a[12:15], v[172:175]
    s_add_u32 m0, s57, 65536
    v_perm_b32 v59, v65, v35, s37
    v_perm_b32 v61, v65, v35, s38
    v_mfma_f32_16x16x32_bf16 v[176:179], a[136:139], a[16:19], v[176:179]
    s_add_u32 s3, s69, 1024
    ds_read_b32 a165, v59
    ds_read_b32 a166, v61
    v_mfma_f32_16x16x32_bf16 v[176:179], a[140:143], a[20:23], v[176:179]
    v_perm_b32 v62, v65, v35, s39
    s_cbranch_vccnz L_slow3_0
L_back3_0:
    v_mfma_f32_16x16x32_bf16 v[180:183], a[136:139], a[24:27], v[180:183]
    ds_read_b32 a167, v62
    v_mfma_f32_16x16x32_bf16 v[180:183], a[140:143], a[28:31], v[180:183]
    buffer_load_dwordx4 v[80:83], v34, s[12:15], s42 offen sc1
    v_mfma_f32_16x16x32_bf16 v[184:187], a[136:139], a[32:35], v[184:187]
    v_perm_b32 v63, v69, v35, s36
    v_perm_b32 v56, v69, v35, s37
    v_mfma_f32_16x16x32_bf16 v[184:187], a[140:143], a[36:39], v[184:187]
    ds_read_b32 a168, v63
    ds_read_b32 a169, v56
    v_perm_b32 v60, v69, v35, s38
    v_mfma_f32_16x16x32_bf16 v[188:191], a[136:139], a[40:43], v[188:191]
    ds_read_b32 a170, v60
    v_mfma_f32_16x16x32_bf16 v[188:191], a[140:143], a[44:47], v[188:191]
    buffer_load_dwordx4 v[84:87], v44, s[12:15], s42 offen sc1
    v_mfma_f32_16x16x32_bf16 v[192:195], a[144:147], a[120:123], v[192:195]
    v_perm_b32 v57, v69, v35, s39
    v_perm_b32 v58, v66, v35, s36
    v_mfma_f32_16x16x32_bf16 v[192:195], a[148:151], a[124:127], v[192:195]
    ds_read_b32 a171, v57
    ds_read_b32 a172, v58
    v_mfma_f32_16x16x32_bf16 v[196:199], a[144:147], a[128:131], v[196:199]
    v_perm_b32 v59, v66, v35, s37
    v_perm_b32 v61, v66, v35, s38
    v_mfma_f32_16x16x32_bf16 v[196:199], a[148:151], a[132:135], v[196:199]
    ds_read_b32 a173, v59
    ds_read_b32 a174, v61
    v_mfma_f32_16x16x32_bf16 v[200:203], a[144:147], a[0:3], v[200:203]
    buffer_load_dwordx4 v[96:99], v32, s[12:15], s43 offen sc1
    v_mfma_f32_16x16x32_bf16 v[200:203], a[148:151], a[4:7], v[200:203]
    v_perm_b32 v62, v66, v35, s39
    v_perm_b32 v63, v70, v35, s36
    v_mfma_f32_16x16x32_bf16 v[204:207], a[144:147], a[8:11], v[204:207]
    ds_read_b32 a175, v62
    ds_read_b32 a176, v63
    v_mfma_f32_16x16x32_bf16 v[204:207], a[148:151], a[12:15], v[204:207]
    v_perm_b32 v56, v70, v35, s37
    v_perm_b32 v60, v70, v35, s38
    v_mfma_f32_16x16x32_bf16 v[208:211], a[144:147], a[16:19], v[208:211]
    s_waitcnt vmcnt(11)
    ds_read_b32 a177, v56
    ds_read_b32 a178, v60
    v_mfma_f32_16x16x32_bf16 v[208:211], a[148:151], a[20:23], v[208:211]
    buffer_load_dwordx4 v[100:103], v33, s[12:15], s43 offen sc1
    v_mfma_f32_16x16x32_bf16 v[212:215], a[144:147], a[24:27], v[212:215]
    s_barrier
    v_mfma_f32_16x16x32_bf16 v[212:215], a[148:151], a[28:31], v[212:215]
    ds_read_b128 a[48:51], v40 offset:16384
    v_perm_b32 v57, v70, v35, s39
    v_mfma_f32_16x16x32_bf16 v[216:219], a[144:147], a[32:35], v[216:219]
    ds_read_b128 a[52:55], v41 offset:16384
    ds_read_b32 a179, v57
    v_mfma_f32_16x16x32_bf16 v[216:219], a[148:151], a[36:39], v[216:219]
    ds_read_b128 a[56:59], v40 offset:18432
    v_perm_b32 v58, v67, v35, s36
    v_mfma_f32_16x16x32_bf16 v[220:223], a[144:147], a[40:43], v[220:223]
    ds_read_b128 a[60:63], v41 offset:18432
    ds_read_b32 a180, v58
    v_mfma_f32_16x16x32_bf16 v[220:223], a[148:151], a[44:47], v[220:223]
    s_waitcnt lgkmcnt(8)
    ds_read_b128 a[64:67], v40 offset:20480
    v_mfma_f32_16x16x32_bf16 v[224:227], a[152:155], a[122:125], v[224:227]
    buffer_load_dwordx4 v36, s[8:11], s56 offen offset:0 lds
    v_mfma_f32_16x16x32_bf16 v[228:231], a[152:155], a[130:133], v[228:231]
    ds_read_b128 a[68:71], v41 offset:20480
    v_perm_b32 v59, v67, v35, s37
    v_mfma_f32_16x16x32_bf16 v[232:235], a[152:155], a[2:5], v[232:235]
    ds_read_b128 a[72:75], v40 offset:22528
    ds_read_b32 a181, v59
    v_mfma_f32_16x16x32_bf16 v[236:239], a[152:155], a[10:13], v[236:239]
    ds_read_b128 a[76:79], v41 offset:22528
    v_perm_b32 v61, v71, v35, s36
    v_mfma_f32_16x16x32_bf16 v[240:243], a[152:155], a[18:21], v[240:243]
    ds_read_b128 a[80:83], v40 offset:24576
    ds_read_b32 a182, v61
    v_mfma_f32_16x16x32_bf16 v[244:247], a[152:155], a[26:29], v[244:247]
    ds_read_b128 a[84:87], v41 offset:24576
    v_perm_b32 v62, v71, v35, s37
    v_mfma_f32_16x16x32_bf16 v[248:251], a[152:155], a[34:37], v[248:251]
    ds_read_b128 a[88:91], v40 offset:26624
    ds_read_b32 a183, v62
    v_mfma_f32_16x16x32_bf16 v[252:255], a[152:155], a[42:45], v[252:255]
    s_waitcnt lgkmcnt(10)
    ds_read_b128 a[92:95], v41 offset:26624
    v_mfma_f32_16x16x32_bf16 v[128:131], a[156:159], a[48:51], v[128:131]
    buffer_load_dwordx4 v37, s[8:11], s56 offen offset:1024 lds
    v_mfma_f32_16x16x32_bf16 v[128:131], a[160:163], a[52:55], v[128:131]
    ds_read_b128 a[96:99], v40 offset:28672
    v_perm_b32 v63, v72, v35, s36
    v_mfma_f32_16x16x32_bf16 v[132:135], a[156:159], a[56:59], v[132:135]
    ds_read_b128 a[100:103], v41 offset:28672
    ds_read_b32 a184, v63
    v_mfma_f32_16x16x32_bf16 v[132:135], a[160:163], a[60:63], v[132:135]
    s_waitcnt lgkmcnt(10)
    ds_read_b128 a[104:107], v40 offset:30720
    v_perm_b32 v56, v72, v35, s37
    v_mfma_f32_16x16x32_bf16 v[136:139], a[156:159], a[64:67], v[136:139]
    ds_read_b128 a[108:111], v41 offset:30720
    ds_read_b32 a185, v56
    v_mfma_f32_16x16x32_bf16 v[136:139], a[160:163], a[68:71], v[136:139]
    v_perm_b32 v60, v72, v35, s38
    v_perm_b32 v57, v72, v35, s39
    v_mfma_f32_16x16x32_bf16 v[140:143], a[156:159], a[72:75], v[140:143]
    s_waitcnt lgkmcnt(9)
    ds_read_b32 a186, v60
    ds_read_b32 a187, v57
    v_mfma_f32_16x16x32_bf16 v[140:143], a[160:163], a[76:79], v[140:143]
    buffer_load_dwordx4 v38, s[8:11], s56 offen offset:2048 lds
    v_mfma_f32_16x16x32_bf16 v[144:147], a[156:159], a[80:83], v[144:147]
    v_perm_b32 v58, v76, v35, s36
    v_perm_b32 v59, v76, v35, s37
    v_mfma_f32_16x16x32_bf16 v[144:147], a[160:163], a[84:87], v[144:147]
    s_waitcnt lgkmcnt(8)
    ds_read_b32 a188, v58
    ds_read_b32 a189, v59
    v_mfma_f32_16x16x32_bf16 v[148:151], a[156:159], a[88:91], v[148:151]
    v_perm_b32 v61, v76, v35, s38
    v_perm_b32 v62, v76, v35, s39
    v_mfma_f32_16x16x32_bf16 v[148:151], a[160:163], a[92:95], v[148:151]
    s_waitcnt lgkmcnt(7)
    ds_read_b32 a190, v61
    ds_read_b32 a191, v62
    v_mfma_f32_16x16x32_bf16 v[152:155], a[156:159], a[96:99], v[152:155]
    v_perm_b32 v63, v73, v35, s36
    v_perm_b32 v56, v73, v35, s37
    v_mfma_f32_16x16x32_bf16 v[152:155], a[160:163], a[100:103], v[152:155]
    s_waitcnt lgkmcnt(6)
    ds_read_b32 a192, v63
    ds_read_b32 a193, v56
    v_mfma_f32_16x16x32_bf16 v[156:159], a[156:159], a[104:107], v[156:159]
    buffer_load_dwordx4 v39, s[8:11], s56 offen offset:3072 lds
    v_mfma_f32_16x16x32_bf16 v[156:159], a[160:163], a[108:111], v[156:159]
    s_add_u32 m0, s57, 81920
    v_perm_b32 v60, v73, v35, s38
    v_perm_b32 v57, v73, v35, s39
    v_mfma_f32_16x16x32_bf16 v[160:163], a[164:167], a[48:51], v[160:163]
    s_add_u32 s56, s55, 1280
    ds_read_b32 a194, v60
    ds_read_b32 a195, v57
    v_mfma_f32_16x16x32_bf16 v[160:163], a[168:171], a[52:55], v[160:163]
    v_perm_b32 v58, v77, v35, s36
    v_perm_b32 v59, v77, v35, s37
    v_mfma_f32_16x16x32_bf16 v[164:167], a[164:167], a[56:59], v[164:167]
    ds_read_b32 a196, v58
    ds_read_b32 a197, v59
    v_mfma_f32_16x16x32_bf16 v[164:167], a[168:171], a[60:63], v[164:167]
    buffer_load_dwordx4 v[104:107], v34, s[12:15], s43 offen sc1
    v_mfma_f32_16x16x32_bf16 v[168:171], a[164:167], a[64:67], v[168:171]
    v_perm_b32 v61, v77, v35, s38
    v_perm_b32 v62, v77, v35, s39
    v_mfma_f32_16x16x32_bf16 v[168:171], a[168:171], a[68:71], v[168:171]
    ds_read_b32 a198, v61
    ds_read_b32 a199, v62
    v_mfma_f32_16x16x32_bf16 v[172:175], a[164:167], a[72:75], v[172:175]
    v_perm_b32 v63, v74, v35, s36
    v_perm_b32 v56, v74, v35, s37
    v_mfma_f32_16x16x32_bf16 v[172:175], a[168:171], a[76:79], v[172:175]
    ds_read_b32 a200, v63
    ds_read_b32 a201, v56
    v_mfma_f32_16x16x32_bf16 v[176:179], a[164:167], a[80:83], v[176:179]
    buffer_load_dwordx4 v[108:111], v44, s[12:15], s43 offen sc1
    v_mfma_f32_16x16x32_bf16 v[176:179], a[168:171], a[84:87], v[176:179]
    v_perm_b32 v60, v74, v35, s38
    v_perm_b32 v57, v74, v35, s39
    v_mfma_f32_16x16x32_bf16 v[180:183], a[164:167], a[88:91], v[180:183]
    ds_read_b32 a202, v60
    ds_read_b32 a203, v57
    v_mfma_f32_16x16x32_bf16 v[180:183], a[168:171], a[92:95], v[180:183]
    v_perm_b32 v58, v78, v35, s36
    v_perm_b32 v59, v78, v35, s37
    v_mfma_f32_16x16x32_bf16 v[184:187], a[164:167], a[96:99], v[184:187]
    ds_read_b32 a204, v58
    ds_read_b32 a205, v59
    v_mfma_f32_16x16x32_bf16 v[184:187], a[168:171], a[100:103], v[184:187]
    v_perm_b32 v61, v78, v35, s38
    v_perm_b32 v62, v78, v35, s39
    v_mfma_f32_16x16x32_bf16 v[188:191], a[164:167], a[104:107], v[188:191]
    ds_read_b32 a206, v61
    ds_read_b32 a207, v62
    v_mfma_f32_16x16x32_bf16 v[188:191], a[168:171], a[108:111], v[188:191]
    buffer_load_dwordx4 v36, s[8:11], s3 offen offset:0 lds
    v_mfma_f32_16x16x32_bf16 v[192:195], a[172:175], a[48:51], v[192:195]
    v_perm_b32 v63, v75, v35, s36
    v_perm_b32 v56, v75, v35, s37
    v_mfma_f32_16x16x32_bf16 v[192:195], a[176:179], a[52:55], v[192:195]
    ds_read_b32 a208, v63
    ds_read_b32 a209, v56
    v_mfma_f32_16x16x32_bf16 v[196:199], a[172:175], a[56:59], v[196:199]
    v_perm_b32 v60, v79, v35, s36
    v_perm_b32 v57, v79, v35, s37
    v_mfma_f32_16x16x32_bf16 v[196:199], a[176:179], a[60:63], v[196:199]
    ds_read_b32 a210, v60
    ds_read_b32 a211, v57
    v_mfma_f32_16x16x32_bf16 v[200:203], a[172:175], a[64:67], v[200:203]
    v_mfma_f32_16x16x32_bf16 v[200:203], a[176:179], a[68:71], v[200:203]
    v_mfma_f32_16x16x32_bf16 v[204:207], a[172:175], a[72:75], v[204:207]
    v_mfma_f32_16x16x32_bf16 v[204:207], a[176:179], a[76:79], v[204:207]
    buffer_load_dwordx4 v37, s[8:11], s3 offen offset:1024 lds
    v_mfma_f32_16x16x32_bf16 v[208:211], a[172:175], a[80:83], v[208:211]
    v_mfma_f32_16x16x32_bf16 v[208:211], a[176:179], a[84:87], v[208:211]
    v_mfma_f32_16x16x32_bf16 v[212:215], a[172:175], a[88:91], v[212:215]
    v_mfma_f32_16x16x32_bf16 v[212:215], a[176:179], a[92:95], v[212:215]
    v_mfma_f32_16x16x32_bf16 v[216:219], a[172:175], a[96:99], v[216:219]
    s_waitcnt vmcnt(12)
    v_mfma_f32_16x16x32_bf16 v[216:219], a[176:179], a[100:103], v[216:219]
    s_barrier
    v_mfma_f32_16x16x32_bf16 v[220:223], a[172:175], a[104:107], v[220:223]
    buffer_load_dwordx4 v38, s[8:11], s3 offen offset:2048 lds
    v_mfma_f32_16x16x32_bf16 v[220:223], a[176:179], a[108:111], v[220:223]
    ds_read_b128 a[112:115], v40 offset:32768
    v_mfma_f32_16x16x32_bf16 v[224:227], a[180:183], a[50:53], v[224:227]
    ds_read_b128 a[116:119], v41 offset:32768
    v_mfma_f32_16x16x32_bf16 v[228:231], a[180:183], a[58:61], v[228:231]
    ds_read_b128 a[120:123], v40 offset:34816
    v_mfma_f32_16x16x32_bf16 v[232:235], a[180:183], a[66:69], v[232:235]
    ds_read_b128 a[124:127], v41 offset:34816
    v_mfma_f32_16x16x32_bf16 v[236:239], a[180:183], a[74:77], v[236:239]
    ds_read_b128 a[128:131], v40 offset:36864
    v_mfma_f32_16x16x32_bf16 v[240:243], a[180:183], a[82:85], v[240:243]
    s_waitcnt vmcnt(11)
    ds_read_b128 a[132:135], v41 offset:36864
    v_mfma_f32_16x16x32_bf16 v[244:247], a[180:183], a[90:93], v[244:247]
    buffer_load_dwordx4 v39, s[8:11], s3 offen offset:3072 lds
    v_mfma_f32_16x16x32_bf16 v[248:251], a[180:183], a[98:101], v[248:251]
    s_add_u32 m0, s57, 0
    ds_read_b128 a[0:3], v40 offset:38912
    v_bitop3_b32 v58, v83, v87, s76 bitop3:0x7e
    v_mfma_f32_16x16x32_bf16 v[252:255], a[180:183], a[106:109], v[252:255]
    s_waitcnt lgkmcnt(6)
    s_add_u32 s3, s69, 1280
    ds_read_b128 a[4:7], v41 offset:38912
    v_cmp_lt_u32 vcc, 0xffff, v58
    v_mfma_f32_16x16x32_bf16 v[128:131], a[184:187], a[112:115], v[128:131]
    s_waitcnt lgkmcnt(6)
    ds_read_b128 a[8:11], v40 offset:40960
    v_mfma_f32_16x16x32_bf16 v[128:131], a[188:191], a[116:119], v[128:131]
    s_waitcnt lgkmcnt(4)
    ds_read_b128 a[12:15], v41 offset:40960
    s_cbranch_vccnz L_slow3_1
L_back3_1:
    v_mfma_f32_16x16x32_bf16 v[132:135], a[184:187], a[120:123], v[132:135]
    buffer_load_dwordx4 v[112:115], v32, s[12:15], s44 offen sc1
    v_mfma_f32_16x16x32_bf16 v[132:135], a[188:191], a[124:127], v[132:135]
    ds_read_b128 a[16:19], v40 offset:43008
    v_perm_b32 v59, v83, v35, s36
    v_perm_b32 v61, v83, v35, s37
    v_mfma_f32_16x16x32_bf16 v[136:139], a[184:187], a[128:131], v[136:139]
    s_waitcnt lgkmcnt(4)
    ds_read_b128 a[20:23], v41 offset:43008
    ds_read_b32 a212, v59
    v_perm_b32 v62, v87, v35, s36
    v_mfma_f32_16x16x32_bf16 v[136:139], a[188:191], a[132:135], v[136:139]
    ds_read_b128 a[24:27], v40 offset:45056
    ds_read_b32 a213, v61
    v_perm_b32 v63, v87, v35, s37
    v_mfma_f32_16x16x32_bf16 v[140:143], a[184:187], a[0:3], v[140:143]
    s_waitcnt lgkmcnt(6)
    ds_read_b128 a[28:31], v41 offset:45056
    ds_read_b32 a214, v62
    v_perm_b32 v56, v80, v35, s36
    v_mfma_f32_16x16x32_bf16 v[140:143], a[188:191], a[4:7], v[140:143]
    ds_read_b128 a[32:35], v40 offset:47104
    ds_read_b32 a215, v63
    v_perm_b32 v60, v80, v35, s37
    v_mfma_f32_16x16x32_bf16 v[144:147], a[184:187], a[8:11], v[144:147]
    s_waitcnt lgkmcnt(9)
    ds_read_b128 a[36:39], v41 offset:47104
    ds_read_b32 a216, v56
    v_mfma_f32_16x16x32_bf16 v[144:147], a[188:191], a[12:15], v[144:147]
    s_waitcnt lgkmcnt(10)
    buffer_load_dwordx4 v[116:119], v33, s[12:15], s44 offen sc1
L_pad2:
    s_cbranch_execz L_pad3
    v_mfma_f32_16x16x32_bf16 v[148:151], a[184:187], a[16:19], v[148:151]
    s_waitcnt vmcnt(12) lgkmcnt(9)
    ds_read_b32 a217, v60
    v_bitop3_b32 v57, v99, v103, s76 bitop3:0x7e
    v_perm_b32 v58, v80, v35, s38
    v_mfma_f32_16x16x32_bf16 v[148:151], a[188:191], a[20:23], v[148:151]
    s_waitcnt lgkmcnt(8)
    ds_read_b32 a218, v58
    v_cmp_lt_u32 vcc, 0xffff, v57
    v_perm_b32 v59, v80, v35, s39
    v_mfma_f32_16x16x32_bf16 v[152:155], a[184:187], a[24:27], v[152:155]
    s_waitcnt lgkmcnt(7)
    ds_read_b128 a[40:43], v40 offset:49152
    ds_read_b32 a219, v59
    v_perm_b32 v61, v84, v35, s36
    v_mfma_f32_16x16x32_bf16 v[152:155], a[188:191], a[28:31], v[152:155]
    s_waitcnt lgkmcnt(7)
    ds_read_b128 a[44:47], v41 offset:49152
    ds_read_b32 a220, v61
    v_perm_b32 v62, v84, v35, s37
    v_mfma_f32_16x16x32_bf16 v[156:159], a[184:187], a[32:35], v[156:159]
    s_waitcnt lgkmcnt(7)
    ds_read_b128 a[48:51], v40 offset:51200
    ds_read_b32 a221, v62
    v_perm_b32 v63, v84, v35, s38
    v_mfma_f32_16x16x32_bf16 v[156:159], a[188:191], a[36:39], v[156:159]
    ds_read_b128 a[52:55], v41 offset:51200
    ds_read_b32 a222, v63
    v_perm_b32 v56, v84, v35, s39
    v_mfma_f32_16x16x32_bf16 v[160:163], a[192:195], a[112:115], v[160:163]
    ds_read_b32 a223, v56
    s_cbranch_vccnz L_slow4_0
L_back4_0:
    v_mfma_f32_16x16x32_bf16 v[160:163], a[196:199], a[116:119], v[160:163]
    ds_read_b128 a[56:59], v40 offset:53248
    v_mfma_f32_16x16x32_bf16 v[164:167], a[192:195], a[120:123], v[164:167]
    buffer_load_dwordx4 v[120:123], v34, s[12:15], s44 offen sc1
    v_mfma_f32_16x16x32_bf16 v[164:167], a[196:199], a[124:127], v[164:167]
    v_perm_b32 v60, v81, v35, s36
    v_perm_b32 v57, v81, v35, s37
    v_mfma_f32_16x16x32_bf16 v[168:171], a[192:195], a[128:131], v[168:171]
    ds_read_b32 a224, v60
    ds_read_b32 a225, v57
    v_perm_b32 v58, v81, v35, s38
    v_mfma_f32_16x16x32_bf16 v[168:171], a[196:199], a[132:135], v[168:171]
    ds_read_b128 a[60:63], v41 offset:53248
    ds_read_b32 a226, v58
    v_mfma_f32_16x16x32_bf16 v[172:175], a[192:195], a[0:3], v[172:175]
    buffer_load_dwordx4 v[124:127], v44, s[12:15], s44 offen sc1
    v_mfma_f32_16x16x32_bf16 v[172:175], a[196:199], a[4:7], v[172:175]
    v_perm_b32 v59, v81, v35, s39
    v_perm_b32 v61, v85, v35, s36
    v_mfma_f32_16x16x32_bf16 v[176:179], a[192:195], a[8:11], v[176:179]
    ds_read_b128 a[64:67], v40 offset:55296
    ds_read_b32 a227, v59
    v_perm_b32 v62, v85, v35, s37
    v_mfma_f32_16x16x32_bf16 v[176:179], a[196:199], a[12:15], v[176:179]
    ds_read_b32 a228, v61
    ds_read_b32 a229, v62
    v_mfma_f32_16x16x32_bf16 v[180:183], a[192:195], a[16:19], v[180:183]
    buffer_load_dwordx4 v36, s[8:11], s56 offen offset:0 lds
    v_mfma_f32_16x16x32_bf16 v[180:183], a[196:199], a[20:23], v[180:183]
    ds_read_b128 a[68:71], v41 offset:55296
    v_perm_b32 v63, v85, v35, s38
    v_perm_b32 v56, v85, v35, s39
    v_mfma_f32_16x16x32_bf16 v[184:187], a[192:195], a[24:27], v[184:187]
    ds_read_b32 a230, v63
    ds_read_b32 a231, v56
    v_perm_b32 v60, v82, v35, s36
    v_mfma_f32_16x16x32_bf16 v[184:187], a[196:199], a[28:31], v[184:187]
    ds_read_b32 a232, v60
    v_perm_b32 v57, v82, v35, s37
    v_perm_b32 v58, v82, v35, s38
    v_mfma_f32_16x16x32_bf16 v[188:191], a[192:195], a[32:35], v[188:191]
    ds_read_b128 a[72:75], v40 offset:57344
    ds_read_b32 a233, v57
    v_mfma_f32_16x16x32_bf16 v[188:191], a[196:199], a[36:39], v[188:191]
    buffer_load_dwordx4 v37, s[8:11], s56 offen offset:1024 lds
    v_mfma_f32_16x16x32_bf16 v[192:195], a[200:203], a[112:115], v[192:195]
    ds_read_b32 a234, v58
    v_perm_b32 v59, v82, v35, s39
    v_perm_b32 v61, v86, v35, s36
    v_mfma_f32_16x16x32_bf16 v[192:195], a[204:207], a[116:119], v[192:195]
    ds_read_b128 a[76:79], v41 offset:57344
    ds_read_b32 a235, v59
    v_perm_b32 v62, v86, v35, s37
    v_mfma_f32_16x16x32_bf16 v[196:199], a[200:203], a[120:123], v[196:199]
    ds_read_b32 a236, v61
    ds_read_b32 a237, v62
    v_perm_b32 v63, v86, v35, s38
    v_mfma_f32_16x16x32_bf16 v[196:199], a[204:207], a[124:127], v[196:199]
    ds_read_b32 a238, v63
    v_perm_b32 v56, v86, v35, s39
    v_mfma_f32_16x16x32_bf16 v[200:203], a[200:203], a[128:131], v[200:203]
    ds_read_b128 a[80:83], v40 offset:59392
    ds_read_b32 a239, v56
    v_perm_b32 v60, v96, v35, s36
    v_mfma_f32_16x16x32_bf16 v[200:203], a[204:207], a[132:135], v[200:203]
    ds_read_b32 a240, v60
    v_perm_b32 v57, v96, v35, s37
    v_mfma_f32_16x16x32_bf16 v[204:207], a[200:203], a[0:3], v[204:207]
    ds_read_b32 a241, v57
    ds_read_b128 a[84:87], v41 offset:59392
    v_mfma_f32_16x16x32_bf16 v[204:207], a[204:207], a[4:7], v[204:207]
    buffer_load_dwordx4 v38, s[8:11], s56 offen offset:2048 lds
    v_mfma_f32_16x16x32_bf16 v[208:211], a[200:203], a[8:11], v[208:211]
    v_perm_b32 v58, v96, v35, s38
    v_perm_b32 v59, v96, v35, s39
    v_mfma_f32_16x16x32_bf16 v[208:211], a[204:207], a[12:15], v[208:211]
    ds_read_b32 a242, v58
    ds_read_b32 a243, v59
    v_mfma_f32_16x16x32_bf16 v[212:215], a[200:203], a[16:19], v[212:215]
    ds_read_b128 a[88:91], v40 offset:61440
    v_perm_b32 v61, v100, v35, s36
    v_mfma_f32_16x16x32_bf16 v[212:215], a[204:207], a[20:23], v[212:215]
    ds_read_b32 a244, v61
    v_perm_b32 v62, v100, v35, s37
    v_mfma_f32_16x16x32_bf16 v[216:219], a[200:203], a[24:27], v[216:219]
    ds_read_b32 a245, v62
    v_perm_b32 v63, v100, v35, s38
    v_mfma_f32_16x16x32_bf16 v[216:219], a[204:207], a[28:31], v[216:219]
    s_waitcnt vmcnt(11) lgkmcnt(8)
    ds_read_b128 a[92:95], v41 offset:61440
    ds_read_b32 a246, v63
    v_mfma_f32_16x16x32_bf16 v[220:223], a[200:203], a[32:35], v[220:223]
    buffer_load_dwordx4 v39, s[8:11], s56 offen offset:3072 lds
    v_mfma_f32_16x16x32_bf16 v[220:223], a[204:207], a[36:39], v[220:223]
    s_add_u32 m0, s57, 16384
    v_bitop3_b32 v56, v107, v111, s76 bitop3:0x7e
    v_perm_b32 v60, v100, v35, s39
    v_mfma_f32_16x16x32_bf16 v[224:227], a[208:211], a[114:117], v[224:227]
    ds_read_b128 a[96:99], v40 offset:63488
    ds_read_b32 a247, v60
    v_cmp_lt_u32 vcc, 0xffff, v56
    v_mfma_f32_16x16x32_bf16 v[224:227], a[212:215], a[42:45], v[224:227]
    v_perm_b32 v57, v97, v35, s36
    v_perm_b32 v58, v97, v35, s37
    v_mfma_f32_16x16x32_bf16 v[228:231], a[208:211], a[122:125], v[228:231]
    ds_read_b32 a248, v57
    ds_read_b32 a249, v58
    v_mfma_f32_16x16x32_bf16 v[228:231], a[212:215], a[50:53], v[228:231]
    v_perm_b32 v59, v97, v35, s38
    s_cbranch_vccnz L_slow4_1
L_back4_1:
    v_mfma_f32_16x16x32_bf16 v[232:235], a[208:211], a[130:133], v[232:235]
    ds_read_b128 a[100:103], v41 offset:63488
    ds_read_b32 a250, v59
    v_mfma_f32_16x16x32_bf16 v[232:235], a[212:215], a[58:61], v[232:235]
    buffer_load_dwordx4 v36, s[8:11], s3 offen offset:0 lds
    v_mfma_f32_16x16x32_bf16 v[236:239], a[208:211], a[2:5], v[236:239]
    v_perm_b32 v61, v97, v35, s39
    v_perm_b32 v62, v101, v35, s36
    v_mfma_f32_16x16x32_bf16 v[236:239], a[212:215], a[66:69], v[236:239]
    ds_read_b32 a251, v61
    ds_read_b32 a252, v62
    v_mfma_f32_16x16x32_bf16 v[240:243], a[208:211], a[10:13], v[240:243]
    v_perm_b32 v63, v101, v35, s37
    v_perm_b32 v56, v101, v35, s38
    v_mfma_f32_16x16x32_bf16 v[240:243], a[212:215], a[74:77], v[240:243]
    s_waitcnt lgkmcnt(6)
    ds_read_b32 a253, v63
    ds_read_b32 a254, v56
    v_mfma_f32_16x16x32_bf16 v[244:247], a[208:211], a[18:21], v[244:247]
    s_add_u32 s56, s55, 1536
    v_perm_b32 v60, v101, v35, s39
    v_perm_b32 v57, v98, v35, s36
    v_mfma_f32_16x16x32_bf16 v[244:247], a[212:215], a[82:85], v[244:247]
    ds_read_b32 a255, v60
    ds_read_b32 a136, v57
    v_perm_b32 v58, v98, v35, s37
    v_mfma_f32_16x16x32_bf16 v[248:251], a[208:211], a[26:29], v[248:251]
    ds_read_b32 a137, v58
    v_mfma_f32_16x16x32_bf16 v[248:251], a[212:215], a[90:93], v[248:251]
    buffer_load_dwordx4 v37, s[8:11], s3 offen offset:1024 lds
    v_mfma_f32_16x16x32_bf16 v[252:255], a[208:211], a[34:37], v[252:255]
    s_waitcnt lgkmcnt(7)
    v_perm_b32 v59, v98, v35, s38
    v_perm_b32 v61, v98, v35, s39
    v_mfma_f32_16x16x32_bf16 v[252:255], a[212:215], a[98:101], v[252:255]
    ds_read_b32 a138, v59
    ds_read_b32 a139, v61
    v_mfma_f32_16x16x32_bf16 v[128:131], a[216:219], a[40:43], v[128:131]
    v_perm_b32 v62, v102, v35, s36
    v_perm_b32 v63, v102, v35, s37
    v_mfma_f32_16x16x32_bf16 v[128:131], a[220:223], a[44:47], v[128:131]
    ds_read_b32 a140, v62
    ds_read_b32 a141, v63
    v_mfma_f32_16x16x32_bf16 v[132:135], a[216:219], a[48:51], v[132:135]
    v_perm_b32 v56, v102, v35, s38
    v_perm_b32 v60, v102, v35, s39
    v_mfma_f32_16x16x32_bf16 v[132:135], a[220:223], a[52:55], v[132:135]
    ds_read_b32 a142, v56
    ds_read_b32 a143, v60
    v_mfma_f32_16x16x32_bf16 v[136:139], a[216:219], a[56:59], v[136:139]
    buffer_load_dwordx4 v38, s[8:11], s3 offen offset:2048 lds
    v_mfma_f32_16x16x32_bf16 v[136:139], a[220:223], a[60:63], v[136:139]
    v_perm_b32 v57, v99, v35, s36
    v_perm_b32 v58, v99, v35, s37
    v_mfma_f32_16x16x32_bf16 v[140:143], a[216:219], a[64:67], v[140:143]
    ds_read_b32 a144, v57
    ds_read_b32 a145, v58
    v_mfma_f32_16x16x32_bf16 v[140:143], a[220:223], a[68:71], v[140:143]
    v_perm_b32 v59, v103, v35, s36
    v_perm_b32 v61, v103, v35, s37
    v_mfma_f32_16x16x32_bf16 v[144:147], a[216:219], a[72:75], v[144:147]
    ds_read_b32 a146, v59
    ds_read_b32 a147, v61
    v_mfma_f32_16x16x32_bf16 v[144:147], a[220:223], a[76:79], v[144:147]
    v_perm_b32 v62, v107, v35, s36
    v_perm_b32 v63, v107, v35, s37
    v_mfma_f32_16x16x32_bf16 v[148:151], a[216:219], a[80:83], v[148:151]
    s_waitcnt vmcnt(11)
    ds_read_b32 a148, v62
    ds_read_b32 a149, v63
    v_mfma_f32_16x16x32_bf16 v[148:151], a[220:223], a[84:87], v[148:151]
    buffer_load_dwordx4 v39, s[8:11], s3 offen offset:3072 lds
    v_mfma_f32_16x16x32_bf16 v[152:155], a[216:219], a[88:91], v[152:155]
    s_barrier
    v_mfma_f32_16x16x32_bf16 v[152:155], a[220:223], a[92:95], v[152:155]
    s_add_u32 m0, s57, 32768
    ds_read_b128 a[104:107], v42 offset:0
    v_perm_b32 v56, v111, v35, s36
    v_mfma_f32_16x16x32_bf16 v[156:159], a[216:219], a[96:99], v[156:159]
    s_add_u32 s3, s69, 1536
    ds_read_b128 a[108:111], v43 offset:0
    ds_read_b32 a150, v56
    v_mfma_f32_16x16x32_bf16 v[156:159], a[220:223], a[100:103], v[156:159]
    ds_read_b128 a[112:115], v42 offset:2048
    v_mfma_f32_16x16x32_bf16 v[160:163], a[224:227], a[40:43], v[160:163]
    buffer_load_dwordx4 v[88:91], v32, s[12:15], s45 offen sc1
    v_mfma_f32_16x16x32_bf16 v[160:163], a[228:231], a[44:47], v[160:163]
    ds_read_b128 a[116:119], v43 offset:2048
    v_perm_b32 v60, v111, v35, s37
    v_mfma_f32_16x16x32_bf16 v[164:167], a[224:227], a[48:51], v[164:167]
    ds_read_b128 a[120:123], v42 offset:4096
    ds_read_b32 a151, v60
    v_mfma_f32_16x16x32_bf16 v[164:167], a[228:231], a[52:55], v[164:167]
    v_perm_b32 v57, v104, v35, s36
    v_perm_b32 v58, v104, v35, s37
    v_mfma_f32_16x16x32_bf16 v[168:171], a[224:227], a[56:59], v[168:171]
    ds_read_b32 a152, v57
    ds_read_b32 a153, v58
    v_mfma_f32_16x16x32_bf16 v[168:171], a[228:231], a[60:63], v[168:171]
    buffer_load_dwordx4 v[92:95], v33, s[12:15], s45 offen sc1
    v_mfma_f32_16x16x32_bf16 v[172:175], a[224:227], a[64:67], v[172:175]
    s_waitcnt vmcnt(12)
    ds_read_b128 a[124:127], v43 offset:4096
    v_bitop3_b32 v59, v115, v119, s76 bitop3:0x7e
    v_mfma_f32_16x16x32_bf16 v[172:175], a[228:231], a[68:71], v[172:175]
    v_cmp_lt_u32 vcc, 0xffff, v59
    v_perm_b32 v61, v104, v35, s38
    v_mfma_f32_16x16x32_bf16 v[176:179], a[224:227], a[72:75], v[176:179]
    ds_read_b128 a[128:131], v42 offset:6144
    ds_read_b32 a154, v61
    v_mfma_f32_16x16x32_bf16 v[176:179], a[228:231], a[76:79], v[176:179]
    ds_read_b128 a[132:135], v43 offset:6144
    s_cbranch_vccnz L_slow5_0
L_back5_0:
    v_mfma_f32_16x16x32_bf16 v[180:183], a[224:227], a[80:83], v[180:183]
    buffer_load_dwordx4 v[48:51], v34, s[12:15], s45 offen sc1
    v_mfma_f32_16x16x32_bf16 v[180:183], a[228:231], a[84:87], v[180:183]
    v_perm_b32 v62, v104, v35, s39
    v_perm_b32 v63, v108, v35, s36
    v_mfma_f32_16x16x32_bf16 v[184:187], a[224:227], a[88:91], v[184:187]
    ds_read_b32 a155, v62
    ds_read_b32 a156, v63
    v_mfma_f32_16x16x32_bf16 v[184:187], a[228:231], a[92:95], v[184:187]
    v_perm_b32 v56, v108, v35, s37
    v_perm_b32 v60, v108, v35, s38
    v_mfma_f32_16x16x32_bf16 v[188:191], a[224:227], a[96:99], v[188:191]
    ds_read_b128 a[0:3], v42 offset:8192
    ds_read_b32 a157, v56
    v_mfma_f32_16x16x32_bf16 v[188:191], a[228:231], a[100:103], v[188:191]
    buffer_load_dwordx4 v[52:55], v44, s[12:15], s45 offen sc1
    v_mfma_f32_16x16x32_bf16 v[192:195], a[232:235], a[40:43], v[192:195]
    ds_read_b32 a158, v60
    v_perm_b32 v57, v108, v35, s39
    v_mfma_f32_16x16x32_bf16 v[192:195], a[236:239], a[44:47], v[192:195]
    ds_read_b128 a[4:7], v43 offset:8192
    ds_read_b32 a159, v57
    v_mfma_f32_16x16x32_bf16 v[196:199], a[232:235], a[48:51], v[196:199]
    v_perm_b32 v58, v105, v35, s36
    v_perm_b32 v59, v105, v35, s37
    v_mfma_f32_16x16x32_bf16 v[196:199], a[236:239], a[52:55], v[196:199]
    ds_read_b32 a160, v58
    ds_read_b32 a161, v59
    v_mfma_f32_16x16x32_bf16 v[200:203], a[232:235], a[56:59], v[200:203]
    ds_read_b128 a[8:11], v42 offset:10240
    v_perm_b32 v61, v105, v35, s38
    v_mfma_f32_16x16x32_bf16 v[200:203], a[236:239], a[60:63], v[200:203]
    ds_read_b32 a162, v61
    ds_read_b128 a[12:15], v43 offset:10240
    v_mfma_f32_16x16x32_bf16 v[204:207], a[232:235], a[64:67], v[204:207]
    buffer_load_dwordx4 v36, s[8:11], s56 offen offset:0 lds
    v_mfma_f32_16x16x32_bf16 v[204:207], a[236:239], a[68:71], v[204:207]
    v_perm_b32 v62, v105, v35, s39
    v_perm_b32 v63, v109, v35, s36
    v_mfma_f32_16x16x32_bf16 v[208:211], a[232:235], a[72:75], v[208:211]
    ds_read_b32 a163, v62
    ds_read_b32 a164, v63
    v_mfma_f32_16x16x32_bf16 v[208:211], a[236:239], a[76:79], v[208:211]
    v_perm_b32 v56, v109, v35, s37
    v_perm_b32 v60, v109, v35, s38
    v_mfma_f32_16x16x32_bf16 v[212:215], a[232:235], a[80:83], v[212:215]
    ds_read_b128 a[16:19], v42 offset:12288
    ds_read_b32 a165, v56
    v_mfma_f32_16x16x32_bf16 v[212:215], a[236:239], a[84:87], v[212:215]
    ds_read_b32 a166, v60
    v_perm_b32 v57, v109, v35, s39
    v_mfma_f32_16x16x32_bf16 v[216:219], a[232:235], a[88:91], v[216:219]
    ds_read_b32 a167, v57
    ds_read_b128 a[20:23], v43 offset:12288
    v_mfma_f32_16x16x32_bf16 v[216:219], a[236:239], a[92:95], v[216:219]
    buffer_load_dwordx4 v37, s[8:11], s56 offen offset:1024 lds
    v_mfma_f32_16x16x32_bf16 v[220:223], a[232:235], a[96:99], v[220:223]
    v_perm_b32 v58, v106, v35, s36
    v_perm_b32 v59, v106, v35, s37
    v_mfma_f32_16x16x32_bf16 v[220:223], a[236:239], a[100:103], v[220:223]
    s_waitcnt lgkmcnt(7)
    ds_read_b32 a168, v58
    ds_read_b32 a169, v59
    v_mfma_f32_16x16x32_bf16 v[128:131], a[240:243], a[104:107], v[128:131]
    ds_read_b128 a[24:27], v42 offset:14336
    v_perm_b32 v61, v106, v35, s38
    v_mfma_f32_16x16x32_bf16 v[128:131], a[244:247], a[108:111], v[128:131]
    ds_read_b32 a170, v61
    v_perm_b32 v62, v106, v35, s39
    v_mfma_f32_16x16x32_bf16 v[132:135], a[240:243], a[112:115], v[132:135]
    ds_read_b32 a171, v62
    v_perm_b32 v63, v110, v35, s36
    v_mfma_f32_16x16x32_bf16 v[132:135], a[244:247], a[116:119], v[132:135]
    ds_read_b128 a[28:31], v43 offset:14336
    ds_read_b32 a172, v63
    v_mfma_f32_16x16x32_bf16 v[136:139], a[240:243], a[120:123], v[136:139]
    ds_read_b128 a[32:35], v42 offset:16384
    v_mfma_f32_16x16x32_bf16 v[136:139], a[244:247], a[124:127], v[136:139]
    buffer_load_dwordx4 v38, s[8:11], s56 offen offset:2048 lds
    v_mfma_f32_16x16x32_bf16 v[140:143], a[240:243], a[128:131], v[140:143]
    v_perm_b32 v56, v110, v35, s37
    v_perm_b32 v60, v110, v35, s38
    v_mfma_f32_16x16x32_bf16 v[140:143], a[244:247], a[132:135], v[140:143]
    ds_read_b32 a173, v56
    ds_read_b32 a174, v60
    v_mfma_f32_16x16x32_bf16 v[144:147], a[240:243], a[0:3], v[144:147]
    v_perm_b32 v57, v110, v35, s39
    v_perm_b32 v58, v112, v35, s36
    v_mfma_f32_16x16x32_bf16 v[144:147], a[244:247], a[4:7], v[144:147]
    ds_read_b32 a175, v57
    ds_read_b32 a176, v58
    v_mfma_f32_16x16x32_bf16 v[148:151], a[240:243], a[8:11], v[148:151]
    v_perm_b32 v59, v112, v35, s37
    v_perm_b32 v61, v112, v35, s38
    v_mfma_f32_16x16x32_bf16 v[148:151], a[244:247], a[12:15], v[148:151]
    s_waitcnt lgkmcnt(6)
    ds_read_b32 a177, v59
    ds_read_b32 a178, v61
    v_mfma_f32_16x16x32_bf16 v[152:155], a[240:243], a[16:19], v[152:155]
    buffer_load_dwordx4 v39, s[8:11], s56 offen offset:3072 lds
    v_mfma_f32_16x16x32_bf16 v[152:155], a[244:247], a[20:23], v[152:155]
    s_add_u32 m0, s57, 49152
    ds_read_b128 a[36:39], v43 offset:16384
    v_perm_b32 v62, v112, v35, s39
    v_mfma_f32_16x16x32_bf16 v[156:159], a[240:243], a[24:27], v[156:159]
    s_add_u32 s56, s55, 1792
    ds_read_b128 a[40:43], v42 offset:18432
    ds_read_b32 a179, v62
    v_mfma_f32_16x16x32_bf16 v[156:159], a[244:247], a[28:31], v[156:159]
    s_waitcnt vmcnt(16)
    ds_read_b128 a[44:47], v43 offset:18432
    v_bitop3_b32 v63, v123, v127, s76 bitop3:0x7e
    v_mfma_f32_16x16x32_bf16 v[160:163], a[248:251], a[104:107], v[160:163]
    v_cmp_lt_u32 vcc, 0xffff, v63
    v_perm_b32 v56, v116, v35, s36
    v_mfma_f32_16x16x32_bf16 v[160:163], a[252:255], a[108:111], v[160:163]
    ds_read_b32 a180, v56
    v_perm_b32 v60, v116, v35, s37
    v_mfma_f32_16x16x32_bf16 v[164:167], a[248:251], a[112:115], v[164:167]
    ds_read_b128 a[48:51], v42 offset:20480
    ds_read_b32 a181, v60
    v_mfma_f32_16x16x32_bf16 v[164:167], a[252:255], a[116:119], v[164:167]
    buffer_load_dwordx4 v36, s[8:11], s3 offen offset:0 lds
    v_mfma_f32_16x16x32_bf16 v[168:171], a[248:251], a[120:123], v[168:171]
    v_perm_b32 v57, v116, v35, s38
    s_cbranch_vccnz L_slow5_1
L_back5_1:
    v_mfma_f32_16x16x32_bf16 v[168:171], a[252:255], a[124:127], v[168:171]
    ds_read_b128 a[52:55], v43 offset:20480
    ds_read_b32 a182, v57
    v_mfma_f32_16x16x32_bf16 v[172:175], a[248:251], a[128:131], v[172:175]
    ds_read_b128 a[56:59], v42 offset:22528
    v_mfma_f32_16x16x32_bf16 v[172:175], a[252:255], a[132:135], v[172:175]
    buffer_load_dwordx4 v[64:67], v22, s[32:35], 0 offen
    v_mfma_f32_16x16x32_bf16 v[176:179], a[248:251], a[0:3], v[176:179]
    v_perm_b32 v58, v116, v35, s39
    v_perm_b32 v59, v113, v35, s36
    v_mfma_f32_16x16x32_bf16 v[176:179], a[252:255], a[4:7], v[176:179]
    ds_read_b32 a183, v58
    ds_read_b32 a184, v59
    v_mfma_f32_16x16x32_bf16 v[180:183], a[248:251], a[8:11], v[180:183]
    ds_read_b128 a[60:63], v43 offset:22528
    v_mfma_f32_16x16x32_bf16 v[180:183], a[252:255], a[12:15], v[180:183]
    buffer_load_dwordx4 v37, s[8:11], s3 offen offset:1024 lds
    v_mfma_f32_16x16x32_bf16 v[184:187], a[248:251], a[16:19], v[184:187]
    v_perm_b32 v61, v113, v35, s37
    v_perm_b32 v62, v113, v35, s38
    v_mfma_f32_16x16x32_bf16 v[184:187], a[252:255], a[20:23], v[184:187]
    ds_read_b32 a185, v61
    ds_read_b32 a186, v62
    v_mfma_f32_16x16x32_bf16 v[188:191], a[248:251], a[24:27], v[188:191]
    ds_read_b128 a[64:67], v42 offset:24576
    v_mfma_f32_16x16x32_bf16 v[188:191], a[252:255], a[28:31], v[188:191]
    buffer_load_dwordx2 v[68:69], v22, s[32:35], 0 offen offset:16
    v_mfma_f32_16x16x32_bf16 v[192:195], a[136:139], a[104:107], v[192:195]
    v_perm_b32 v63, v113, v35, s39
    v_perm_b32 v56, v117, v35, s36
    v_mfma_f32_16x16x32_bf16 v[192:195], a[140:143], a[108:111], v[192:195]
    ds_read_b128 a[68:71], v43 offset:24576
    ds_read_b32 a187, v63
    v_perm_b32 v60, v117, v35, s37
    v_mfma_f32_16x16x32_bf16 v[196:199], a[136:139], a[112:115], v[196:199]
    ds_read_b32 a188, v56
    ds_read_b32 a189, v60
    v_mfma_f32_16x16x32_bf16 v[196:199], a[140:143], a[116:119], v[196:199]
    buffer_load_dword v70, v23, s[32:35], 0 offen
    v_mfma_f32_16x16x32_bf16 v[200:203], a[136:139], a[120:123], v[200:203]
    ds_read_b128 a[72:75], v42 offset:26624
    v_perm_b32 v57, v117, v35, s38
    v_perm_b32 v58, v117, v35, s39
    v_mfma_f32_16x16x32_bf16 v[200:203], a[140:143], a[124:127], v[200:203]
    ds_read_b32 a190, v57
    ds_read_b32 a191, v58
    v_perm_b32 v59, v114, v35, s36
    v_mfma_f32_16x16x32_bf16 v[204:207], a[136:139], a[128:131], v[204:207]
    ds_read_b32 a192, v59
    ds_read_b128 a[76:79], v43 offset:26624
    v_mfma_f32_16x16x32_bf16 v[204:207], a[140:143], a[132:135], v[204:207]
    buffer_load_dwordx4 v[72:75], v32, s[12:15], s72 offen sc1
    v_mfma_f32_16x16x32_bf16 v[208:211], a[136:139], a[0:3], v[208:211]
    v_perm_b32 v61, v114, v35, s37
    v_perm_b32 v62, v114, v35, s38
    v_mfma_f32_16x16x32_bf16 v[208:211], a[140:143], a[4:7], v[208:211]
    ds_read_b32 a193, v61
    ds_read_b32 a194, v62
    v_mfma_f32_16x16x32_bf16 v[212:215], a[136:139], a[8:11], v[212:215]
    ds_read_b128 a[80:83], v42 offset:28672
    v_mfma_f32_16x16x32_bf16 v[212:215], a[140:143], a[12:15], v[212:215]
    buffer_load_dwordx4 v[76:79], v33, s[12:15], s72 offen sc1
    v_mfma_f32_16x16x32_bf16 v[216:219], a[136:139], a[16:19], v[216:219]
    v_perm_b32 v63, v114, v35, s39
    v_perm_b32 v56, v118, v35, s36
    v_mfma_f32_16x16x32_bf16 v[216:219], a[140:143], a[20:23], v[216:219]
    ds_read_b128 a[84:87], v43 offset:28672
    ds_read_b32 a195, v63
    v_perm_b32 v60, v118, v35, s37
    v_mfma_f32_16x16x32_bf16 v[220:223], a[136:139], a[24:27], v[220:223]
    s_waitcnt lgkmcnt(7)
    ds_read_b32 a196, v56
    ds_read_b32 a197, v60
    v_mfma_f32_16x16x32_bf16 v[220:223], a[140:143], a[28:31], v[220:223]
    buffer_load_dwordx4 v[80:83], v34, s[12:15], s72 offen sc1
    v_mfma_f32_16x16x32_bf16 v[224:227], a[144:147], a[106:109], v[224:227]
    ds_read_b128 a[88:91], v42 offset:30720
    v_perm_b32 v57, v118, v35, s38
    v_perm_b32 v58, v118, v35, s39
    v_mfma_f32_16x16x32_bf16 v[224:227], a[148:151], a[34:37], v[224:227]
    ds_read_b32 a198, v57
    ds_read_b32 a199, v58
    v_perm_b32 v59, v115, v35, s36
    v_mfma_f32_16x16x32_bf16 v[228:231], a[144:147], a[114:117], v[228:231]
    ds_read_b32 a200, v59
    ds_read_b128 a[92:95], v43 offset:30720
    v_mfma_f32_16x16x32_bf16 v[228:231], a[148:151], a[42:45], v[228:231]
    buffer_load_dwordx4 v[84:87], v44, s[12:15], s72 offen sc1
    v_mfma_f32_16x16x32_bf16 v[232:235], a[144:147], a[122:125], v[232:235]
    v_perm_b32 v61, v115, v35, s37
    v_perm_b32 v62, v119, v35, s36
    v_mfma_f32_16x16x32_bf16 v[232:235], a[148:151], a[50:53], v[232:235]
    ds_read_b32 a201, v61
    ds_read_b32 a202, v62
    v_perm_b32 v63, v119, v35, s37
    v_mfma_f32_16x16x32_bf16 v[236:239], a[144:147], a[130:133], v[236:239]
    ds_read_b32 a203, v63
    v_mfma_f32_16x16x32_bf16 v[236:239], a[148:151], a[58:61], v[236:239]
    buffer_load_dwordx4 v38, s[8:11], s3 offen offset:2048 lds
    v_mfma_f32_16x16x32_bf16 v[240:243], a[144:147], a[2:5], v[240:243]
    v_perm_b32 v56, v123, v35, s36
    v_perm_b32 v60, v123, v35, s37
    v_mfma_f32_16x16x32_bf16 v[240:243], a[148:151], a[66:69], v[240:243]
    ds_read_b32 a204, v56
    ds_read_b32 a205, v60
    v_mfma_f32_16x16x32_bf16 v[244:247], a[144:147], a[10:13], v[244:247]
    s_waitcnt vmcnt(16) lgkmcnt(5)
    v_perm_b32 v57, v127, v35, s36
    v_perm_b32 v58, v127, v35, s37
    v_mfma_f32_16x16x32_bf16 v[244:247], a[148:151], a[74:77], v[244:247]
    ds_read_b32 a206, v57
    v_bitop3_b32 v59, v91, v95, s76 bitop3:0x7e
    v_perm_b32 v61, v120, v35, s36
    v_mfma_f32_16x16x32_bf16 v[248:251], a[144:147], a[18:21], v[248:251]
    s_barrier
    v_mfma_f32_16x16x32_bf16 v[248:251], a[148:151], a[82:85], v[248:251]
    buffer_load_dwordx4 v39, s[8:11], s3 offen offset:3072 lds
    v_mfma_f32_16x16x32_bf16 v[252:255], a[144:147], a[26:29], v[252:255]
    s_add_u32 m0, s57, 65536
    ds_read_b32 a207, v58
    ds_read_b32 a208, v61
    v_mfma_f32_16x16x32_bf16 v[252:255], a[148:151], a[90:93], v[252:255]
    s_add_u32 s3, s69, 1792
    v_cmp_lt_u32 vcc, 0xffff, v59
    v_perm_b32 v62, v120, v35, s37
    v_mfma_f32_16x16x32_bf16 v[128:131], a[152:155], a[32:35], v[128:131]
    ds_read_b32 a209, v62
    v_perm_b32 v63, v120, v35, s38
    v_mfma_f32_16x16x32_bf16 v[128:131], a[156:159], a[36:39], v[128:131]
    ds_read_b32 a210, v63
    s_cbranch_vccnz L_slow6_0
L_back6_0:
    v_mfma_f32_16x16x32_bf16 v[132:135], a[152:155], a[40:43], v[132:135]
    s_waitcnt vmcnt(15)
    v_perm_b32 v60, v120, v35, s39
    v_bitop3_b32 v56, v51, v55, s76 bitop3:0x7e
    v_mfma_f32_16x16x32_bf16 v[132:135], a[156:159], a[44:47], v[132:135]
    ds_read_b32 a211, v60
    ds_read_b128 a[96:99], v40 offset:0
    v_mfma_f32_16x16x32_bf16 v[136:139], a[152:155], a[48:51], v[136:139]
    buffer_load_dwordx4 v36, s[8:11], s56 offen offset:0 lds
L_pad3:
    s_cbranch_execz L_pad4
    v_mfma_f32_16x16x32_bf16 v[136:139], a[156:159], a[52:55], v[136:139]
    v_cmp_lt_u32 vcc, 0xffff, v56
    v_perm_b32 v57, v124, v35, s36
    v_mfma_f32_16x16x32_bf16 v[140:143], a[152:155], a[56:59], v[140:143]
    ds_read_b32 a212, v57
    v_perm_b32 v58, v124, v35, s37
    v_mfma_f32_16x16x32_bf16 v[140:143], a[156:159], a[60:63], v[140:143]
    ds_read_b32 a213, v58
    s_cbranch_vccnz L_slow6_1
L_back6_1:
    v_mfma_f32_16x16x32_bf16 v[144:147], a[152:155], a[64:67], v[144:147]
    v_perm_b32 v61, v124, v35, s38
    v_perm_b32 v59, v124, v35, s39
    v_mfma_f32_16x16x32_bf16 v[144:147], a[156:159], a[68:71], v[144:147]
    ds_read_b32 a214, v61
    ds_read_b32 a215, v59
    v_mfma_f32_16x16x32_bf16 v[148:151], a[152:155], a[72:75], v[148:151]
    ds_read_b128 a[100:103], v41 offset:0
    v_mfma_f32_16x16x32_bf16 v[148:151], a[156:159], a[76:79], v[148:151]
    buffer_load_dwordx4 v37, s[8:11], s56 offen offset:1024 lds
    v_mfma_f32_16x16x32_bf16 v[152:155], a[152:155], a[80:83], v[152:155]
    v_perm_b32 v62, v121, v35, s36
    v_perm_b32 v63, v121, v35, s37
    v_mfma_f32_16x16x32_bf16 v[152:155], a[156:159], a[84:87], v[152:155]
    ds_read_b128 a[104:107], v40 offset:2048
    ds_read_b32 a216, v62
    v_mfma_f32_16x16x32_bf16 v[156:159], a[152:155], a[88:91], v[156:159]
    ds_read_b32 a217, v63
    v_perm_b32 v60, v121, v35, s38
    v_mfma_f32_16x16x32_bf16 v[156:159], a[156:159], a[92:95], v[156:159]
    ds_read_b128 a[108:111], v41 offset:2048
    ds_read_b32 a218, v60
    v_mfma_f32_16x16x32_bf16 v[160:163], a[160:163], a[32:35], v[160:163]
    v_perm_b32 v56, v121, v35, s39
    v_perm_b32 v57, v125, v35, s36
    v_mfma_f32_16x16x32_bf16 v[160:163], a[164:167], a[36:39], v[160:163]
    ds_read_b32 a219, v56
    ds_read_b32 a220, v57
    v_mfma_f32_16x16x32_bf16 v[164:167], a[160:163], a[40:43], v[164:167]
    ds_read_b128 a[112:115], v40 offset:4096
    v_mfma_f32_16x16x32_bf16 v[164:167], a[164:167], a[44:47], v[164:167]
    buffer_load_dwordx4 v38, s[8:11], s56 offen offset:2048 lds
    v_mfma_f32_16x16x32_bf16 v[168:171], a[160:163], a[48:51], v[168:171]
    v_perm_b32 v58, v125, v35, s37
    v_perm_b32 v61, v125, v35, s38
    v_mfma_f32_16x16x32_bf16 v[168:171], a[164:167], a[52:55], v[168:171]
    ds_read_b128 a[116:119], v41 offset:4096
    ds_read_b32 a221, v58
    v_mfma_f32_16x16x32_bf16 v[172:175], a[160:163], a[56:59], v[172:175]
    ds_read_b32 a222, v61
    v_perm_b32 v59, v125, v35, s39
    v_mfma_f32_16x16x32_bf16 v[172:175], a[164:167], a[60:63], v[172:175]
    ds_read_b32 a223, v59
    v_perm_b32 v62, v122, v35, s36
    v_mfma_f32_16x16x32_bf16 v[176:179], a[160:163], a[64:67], v[176:179]
    ds_read_b128 a[120:123], v40 offset:6144
    ds_read_b32 a224, v62
    v_mfma_f32_16x16x32_bf16 v[176:179], a[164:167], a[68:71], v[176:179]
    ds_read_b128 a[124:127], v41 offset:6144
    v_mfma_f32_16x16x32_bf16 v[180:183], a[160:163], a[72:75], v[180:183]
    buffer_load_dwordx4 v39, s[8:11], s56 offen offset:3072 lds
    v_mfma_f32_16x16x32_bf16 v[180:183], a[164:167], a[76:79], v[180:183]
    s_add_u32 m0, s57, 81920
    v_perm_b32 v63, v122, v35, s37
    v_perm_b32 v60, v122, v35, s38
    v_mfma_f32_16x16x32_bf16 v[184:187], a[160:163], a[80:83], v[184:187]
    ds_read_b32 a225, v63
    ds_read_b32 a226, v60
    v_perm_b32 v56, v122, v35, s39
    v_mfma_f32_16x16x32_bf16 v[184:187], a[164:167], a[84:87], v[184:187]
    ds_read_b32 a227, v56
    v_perm_b32 v57, v126, v35, s36
    v_mfma_f32_16x16x32_bf16 v[188:191], a[160:163], a[88:91], v[188:191]
    ds_read_b128 a[128:131], v40 offset:8192
    ds_read_b32 a228, v57
    v_mfma_f32_16x16x32_bf16 v[188:191], a[164:167], a[92:95], v[188:191]
    v_perm_b32 v58, v126, v35, s37
    v_perm_b32 v61, v126, v35, s38
    v_mfma_f32_16x16x32_bf16 v[192:195], a[168:171], a[32:35], v[192:195]
    ds_read_b32 a229, v58
    ds_read_b32 a230, v61
    v_mfma_f32_16x16x32_bf16 v[192:195], a[172:175], a[36:39], v[192:195]
    ds_read_b128 a[132:135], v41 offset:8192
    v_mfma_f32_16x16x32_bf16 v[196:199], a[168:171], a[40:43], v[196:199]
    buffer_load_dwordx4 v36, s[8:11], s3 offen offset:0 lds
    v_mfma_f32_16x16x32_bf16 v[196:199], a[172:175], a[44:47], v[196:199]
    v_perm_b32 v59, v126, v35, s39
    v_perm_b32 v62, v91, v35, s36
    v_mfma_f32_16x16x32_bf16 v[200:203], a[168:171], a[48:51], v[200:203]
    ds_read_b128 a[0:3], v40 offset:10240
    ds_read_b32 a231, v59
    v_mfma_f32_16x16x32_bf16 v[200:203], a[172:175], a[52:55], v[200:203]
    ds_read_b32 a232, v62
    v_perm_b32 v63, v91, v35, s37
    v_mfma_f32_16x16x32_bf16 v[204:207], a[168:171], a[56:59], v[204:207]
    ds_read_b32 a233, v63
    v_perm_b32 v60, v95, v35, s36
    v_mfma_f32_16x16x32_bf16 v[204:207], a[172:175], a[60:63], v[204:207]
    ds_read_b128 a[4:7], v41 offset:10240
    ds_read_b32 a234, v60
    v_mfma_f32_16x16x32_bf16 v[208:211], a[168:171], a[64:67], v[208:211]
    ds_read_b128 a[8:11], v40 offset:12288
    v_mfma_f32_16x16x32_bf16 v[208:211], a[172:175], a[68:71], v[208:211]
    buffer_load_dwordx4 v37, s[8:11], s3 offen offset:1024 lds
    v_mfma_f32_16x16x32_bf16 v[212:215], a[168:171], a[72:75], v[212:215]
    v_perm_b32 v56, v95, v35, s37
    v_perm_b32 v57, v51, v35, s36
    v_mfma_f32_16x16x32_bf16 v[212:215], a[172:175], a[76:79], v[212:215]
    ds_read_b32 a235, v56
    ds_read_b32 a236, v57
    v_mfma_f32_16x16x32_bf16 v[216:219], a[168:171], a[80:83], v[216:219]
    v_perm_b32 v58, v51, v35, s37
    v_perm_b32 v61, v55, v35, s36
    v_mfma_f32_16x16x32_bf16 v[216:219], a[172:175], a[84:87], v[216:219]
    ds_read_b128 a[12:15], v41 offset:12288
    ds_read_b32 a237, v58
    v_mfma_f32_16x16x32_bf16 v[220:223], a[168:171], a[88:91], v[220:223]
    ds_read_b32 a238, v61
    v_perm_b32 v59, v55, v35, s37
    v_mfma_f32_16x16x32_bf16 v[220:223], a[172:175], a[92:95], v[220:223]
    s_waitcnt lgkmcnt(8)
    ds_read_b32 a239, v59
    ds_read_b128 a[16:19], v40 offset:14336
    v_mfma_f32_16x16x32_bf16 v[128:131], a[176:179], a[96:99], v[128:131]
    buffer_load_dwordx4 v38, s[8:11], s3 offen offset:2048 lds
    v_mfma_f32_16x16x32_bf16 v[128:131], a[180:183], a[100:103], v[128:131]
    v_perm_b32 v62, v88, v35, s36
    v_perm_b32 v63, v88, v35, s37
    v_mfma_f32_16x16x32_bf16 v[132:135], a[176:179], a[104:107], v[132:135]
    ds_read_b32 a240, v62
    ds_read_b32 a241, v63
    v_mfma_f32_16x16x32_bf16 v[132:135], a[180:183], a[108:111], v[132:135]
    ds_read_b128 a[20:23], v41 offset:14336
    v_perm_b32 v60, v88, v35, s38
    v_mfma_f32_16x16x32_bf16 v[136:139], a[176:179], a[112:115], v[136:139]
    ds_read_b32 a242, v60
    v_perm_b32 v56, v88, v35, s39
    v_mfma_f32_16x16x32_bf16 v[136:139], a[180:183], a[116:119], v[136:139]
    ds_read_b32 a243, v56
    v_perm_b32 v57, v92, v35, s36
    v_mfma_f32_16x16x32_bf16 v[140:143], a[176:179], a[120:123], v[140:143]
    ds_read_b32 a244, v57
    v_perm_b32 v58, v92, v35, s37
    v_mfma_f32_16x16x32_bf16 v[140:143], a[180:183], a[124:127], v[140:143]
    ds_read_b32 a245, v58
    ds_read_b128 a[24:27], v40 offset:16384
    v_mfma_f32_16x16x32_bf16 v[144:147], a[176:179], a[128:131], v[144:147]
    buffer_load_dwordx4 v39, s[8:11], s3 offen offset:3072 lds
    v_mfma_f32_16x16x32_bf16 v[144:147], a[180:183], a[132:135], v[144:147]
    v_perm_b32 v61, v92, v35, s38
    v_perm_b32 v59, v92, v35, s39
    v_mfma_f32_16x16x32_bf16 v[148:151], a[176:179], a[0:3], v[148:151]
    s_waitcnt lgkmcnt(8)
    ds_read_b32 a246, v61
    ds_read_b32 a247, v59
    v_mfma_f32_16x16x32_bf16 v[148:151], a[180:183], a[4:7], v[148:151]
    v_perm_b32 v62, v48, v35, s36
    v_perm_b32 v63, v48, v35, s37
    v_mfma_f32_16x16x32_bf16 v[152:155], a[176:179], a[8:11], v[152:155]
    ds_read_b128 a[28:31], v41 offset:16384
    ds_read_b32 a248, v62
    v_mfma_f32_16x16x32_bf16 v[152:155], a[180:183], a[12:15], v[152:155]
    ds_read_b32 a249, v63
    v_perm_b32 v60, v48, v35, s38
    v_mfma_f32_16x16x32_bf16 v[156:159], a[176:179], a[16:19], v[156:159]
    s_waitcnt lgkmcnt(8)
    ds_read_b128 a[32:35], v40 offset:18432
    ds_read_b32 a250, v60
    v_mfma_f32_16x16x32_bf16 v[156:159], a[180:183], a[20:23], v[156:159]
    ds_read_b128 a[36:39], v41 offset:18432
    v_perm_b32 v56, v48, v35, s39
    v_mfma_f32_16x16x32_bf16 v[160:163], a[184:187], a[96:99], v[160:163]
    ds_read_b32 a251, v56
    v_perm_b32 v57, v52, v35, s36
    v_mfma_f32_16x16x32_bf16 v[160:163], a[188:191], a[100:103], v[160:163]
    ds_read_b32 a252, v57
    v_perm_b32 v58, v52, v35, s37
    v_mfma_f32_16x16x32_bf16 v[164:167], a[184:187], a[104:107], v[164:167]
    ds_read_b128 a[40:43], v40 offset:20480
    ds_read_b32 a253, v58
    v_mfma_f32_16x16x32_bf16 v[164:167], a[188:191], a[108:111], v[164:167]
    v_perm_b32 v61, v52, v35, s38
    v_perm_b32 v59, v52, v35, s39
    v_mfma_f32_16x16x32_bf16 v[168:171], a[184:187], a[112:115], v[168:171]
    ds_read_b32 a254, v61
    ds_read_b32 a255, v59
    v_mfma_f32_16x16x32_bf16 v[168:171], a[188:191], a[116:119], v[168:171]
    ds_read_b128 a[44:47], v41 offset:20480
    v_perm_b32 v62, v89, v35, s36
    v_mfma_f32_16x16x32_bf16 v[172:175], a[184:187], a[120:123], v[172:175]
    ds_read_b32 a136, v62
    v_perm_b32 v63, v89, v35, s37
    v_mfma_f32_16x16x32_bf16 v[172:175], a[188:191], a[124:127], v[172:175]
    ds_read_b32 a137, v63
    v_perm_b32 v60, v89, v35, s38
    v_mfma_f32_16x16x32_bf16 v[176:179], a[184:187], a[128:131], v[176:179]
    ds_read_b128 a[48:51], v40 offset:22528
    ds_read_b32 a138, v60
    v_mfma_f32_16x16x32_bf16 v[176:179], a[188:191], a[132:135], v[176:179]
    v_perm_b32 v56, v89, v35, s39
    v_perm_b32 v57, v93, v35, s36
    v_mfma_f32_16x16x32_bf16 v[180:183], a[184:187], a[0:3], v[180:183]
    ds_read_b32 a139, v56
    ds_read_b32 a140, v57
    v_mfma_f32_16x16x32_bf16 v[180:183], a[188:191], a[4:7], v[180:183]
    ds_read_b128 a[52:55], v41 offset:22528
    v_perm_b32 v58, v93, v35, s37
    v_mfma_f32_16x16x32_bf16 v[184:187], a[184:187], a[8:11], v[184:187]
    ds_read_b32 a141, v58
    v_perm_b32 v61, v93, v35, s38
    v_mfma_f32_16x16x32_bf16 v[184:187], a[188:191], a[12:15], v[184:187]
    ds_read_b32 a142, v61
    v_perm_b32 v59, v93, v35, s39
    v_mfma_f32_16x16x32_bf16 v[188:191], a[184:187], a[16:19], v[188:191]
    ds_read_b128 a[56:59], v40 offset:24576
    ds_read_b32 a143, v59
    v_mfma_f32_16x16x32_bf16 v[188:191], a[188:191], a[20:23], v[188:191]
    s_waitcnt vmcnt(12)
    v_perm_b32 v63, v49, v35, s36
    v_bitop3_b32 v62, v75, v79, s76 bitop3:0x7e
    v_mfma_f32_16x16x32_bf16 v[192:195], a[192:195], a[96:99], v[192:195]
    ds_read_b32 a144, v63
    v_cmp_lt_u32 vcc, 0xffff, v62
    v_mfma_f32_16x16x32_bf16 v[192:195], a[196:199], a[100:103], v[192:195]
    ds_read_b128 a[60:63], v41 offset:24576
    v_perm_b32 v60, v49, v35, s37
    v_mfma_f32_16x16x32_bf16 v[196:199], a[192:195], a[104:107], v[196:199]
    ds_read_b32 a145, v60
    s_cbranch_vccnz L_slow7_0
L_back7_0:
    v_mfma_f32_16x16x32_bf16 v[196:199], a[196:199], a[108:111], v[196:199]
    v_perm_b32 v56, v49, v35, s38
    v_perm_b32 v57, v49, v35, s39
    v_mfma_f32_16x16x32_bf16 v[200:203], a[192:195], a[112:115], v[200:203]
    ds_read_b128 a[64:67], v40 offset:26624
    ds_read_b32 a146, v56
    v_mfma_f32_16x16x32_bf16 v[200:203], a[196:199], a[116:119], v[200:203]
    s_waitcnt vmcnt(10)
    ds_read_b32 a147, v57
    v_bitop3_b32 v58, v83, v87, s76 bitop3:0x7e
    v_mfma_f32_16x16x32_bf16 v[204:207], a[192:195], a[120:123], v[204:207]
    v_cmp_lt_u32 vcc, 0xffff, v58
    v_perm_b32 v61, v53, v35, s36
    v_mfma_f32_16x16x32_bf16 v[204:207], a[196:199], a[124:127], v[204:207]
    ds_read_b128 a[68:71], v41 offset:26624
    ds_read_b32 a148, v61
    v_mfma_f32_16x16x32_bf16 v[208:211], a[192:195], a[128:131], v[208:211]
    v_perm_b32 v59, v53, v35, s37
    s_cbranch_vccnz L_slow7_1
L_back7_1:
    v_mfma_f32_16x16x32_bf16 v[208:211], a[196:199], a[132:135], v[208:211]
    ds_read_b32 a149, v59
    v_perm_b32 v62, v53, v35, s38
    v_mfma_f32_16x16x32_bf16 v[212:215], a[192:195], a[0:3], v[212:215]
    ds_read_b128 a[72:75], v40 offset:28672
    ds_read_b32 a150, v62
    v_mfma_f32_16x16x32_bf16 v[212:215], a[196:199], a[4:7], v[212:215]
    v_perm_b32 v63, v53, v35, s39
    v_perm_b32 v60, v90, v35, s36
    v_mfma_f32_16x16x32_bf16 v[216:219], a[192:195], a[8:11], v[216:219]
    ds_read_b32 a151, v63
    ds_read_b32 a152, v60
    v_mfma_f32_16x16x32_bf16 v[216:219], a[196:199], a[12:15], v[216:219]
    ds_read_b128 a[76:79], v41 offset:28672
    v_perm_b32 v56, v90, v35, s37
    v_mfma_f32_16x16x32_bf16 v[220:223], a[192:195], a[16:19], v[220:223]
    ds_read_b32 a153, v56
    v_perm_b32 v57, v90, v35, s38
    v_mfma_f32_16x16x32_bf16 v[220:223], a[196:199], a[20:23], v[220:223]
    ds_read_b32 a154, v57
    v_perm_b32 v58, v90, v35, s39
    v_mfma_f32_16x16x32_bf16 v[224:227], a[200:203], a[98:101], v[224:227]
    s_waitcnt lgkmcnt(8)
    ds_read_b128 a[80:83], v40 offset:30720
    ds_read_b32 a155, v58
    v_mfma_f32_16x16x32_bf16 v[224:227], a[204:207], a[26:29], v[224:227]
    v_perm_b32 v61, v94, v35, s36
    v_perm_b32 v59, v94, v35, s37
    v_mfma_f32_16x16x32_bf16 v[228:231], a[200:203], a[106:109], v[228:231]
    ds_read_b32 a156, v61
    ds_read_b32 a157, v59
    v_mfma_f32_16x16x32_bf16 v[228:231], a[204:207], a[34:37], v[228:231]
    ds_read_b128 a[84:87], v41 offset:30720
    v_perm_b32 v62, v94, v35, s38
    v_mfma_f32_16x16x32_bf16 v[232:235], a[200:203], a[114:117], v[232:235]
    ds_read_b32 a158, v62
    v_perm_b32 v63, v94, v35, s39
    v_mfma_f32_16x16x32_bf16 v[232:235], a[204:207], a[42:45], v[232:235]
    ds_read_b32 a159, v63
    v_perm_b32 v60, v50, v35, s36
    v_mfma_f32_16x16x32_bf16 v[236:239], a[200:203], a[122:125], v[236:239]
    ds_read_b32 a160, v60
    v_perm_b32 v56, v50, v35, s37
    v_mfma_f32_16x16x32_bf16 v[236:239], a[204:207], a[50:53], v[236:239]
    ds_read_b32 a161, v56
    v_perm_b32 v57, v50, v35, s38
    v_mfma_f32_16x16x32_bf16 v[240:243], a[200:203], a[130:133], v[240:243]
    ds_read_b32 a162, v57
    v_perm_b32 v58, v50, v35, s39
    v_mfma_f32_16x16x32_bf16 v[240:243], a[204:207], a[58:61], v[240:243]
    ds_read_b32 a163, v58
    v_perm_b32 v61, v54, v35, s36
    v_mfma_f32_16x16x32_bf16 v[244:247], a[200:203], a[2:5], v[244:247]
    ds_read_b32 a164, v61
    v_perm_b32 v59, v54, v35, s37
    v_mfma_f32_16x16x32_bf16 v[244:247], a[204:207], a[66:69], v[244:247]
    s_waitcnt vmcnt(8) lgkmcnt(7)
    ds_read_b32 a165, v59
    v_perm_b32 v62, v54, v35, s38
    v_mfma_f32_16x16x32_bf16 v[248:251], a[200:203], a[10:13], v[248:251]
    s_barrier
    v_mfma_f32_16x16x32_bf16 v[248:251], a[204:207], a[74:77], v[248:251]
    ds_read_b32 a166, v62
    v_perm_b32 v63, v54, v35, s39
    v_mfma_f32_16x16x32_bf16 v[252:255], a[200:203], a[18:21], v[252:255]
    ds_read_b32 a167, v63
    v_perm_b32 v60, v75, v35, s36
    v_mfma_f32_16x16x32_bf16 v[252:255], a[204:207], a[82:85], v[252:255]
    ds_read_b32 a168, v60
    v_perm_b32 v56, v75, v35, s37
    v_mfma_f32_16x16x32_bf16 v[128:131], a[208:211], a[24:27], v[128:131]
    ds_read_b32 a169, v56
    v_perm_b32 v57, v79, v35, s36
    v_mfma_f32_16x16x32_bf16 v[128:131], a[212:215], a[28:31], v[128:131]
    ds_read_b32 a170, v57
    v_perm_b32 v58, v79, v35, s37
    v_mfma_f32_16x16x32_bf16 v[132:135], a[208:211], a[32:35], v[132:135]
    ds_read_b32 a171, v58
    v_perm_b32 v61, v83, v35, s36
    v_mfma_f32_16x16x32_bf16 v[132:135], a[212:215], a[36:39], v[132:135]
    ds_read_b32 a172, v61
    v_perm_b32 v59, v83, v35, s37
    v_mfma_f32_16x16x32_bf16 v[136:139], a[208:211], a[40:43], v[136:139]
    ds_read_b32 a173, v59
    v_perm_b32 v62, v87, v35, s36
    v_mfma_f32_16x16x32_bf16 v[136:139], a[212:215], a[44:47], v[136:139]
    ds_read_b32 a174, v62
    v_perm_b32 v63, v87, v35, s37
    v_mfma_f32_16x16x32_bf16 v[140:143], a[208:211], a[48:51], v[140:143]
    ds_read_b32 a175, v63
    v_perm_b32 v60, v72, v35, s36
    v_mfma_f32_16x16x32_bf16 v[140:143], a[212:215], a[52:55], v[140:143]
    ds_read_b32 a176, v60
    v_perm_b32 v56, v72, v35, s37
    v_mfma_f32_16x16x32_bf16 v[144:147], a[208:211], a[56:59], v[144:147]
    ds_read_b32 a177, v56
    v_perm_b32 v57, v72, v35, s38
    v_mfma_f32_16x16x32_bf16 v[144:147], a[212:215], a[60:63], v[144:147]
    ds_read_b32 a178, v57
    v_perm_b32 v58, v72, v35, s39
    v_mfma_f32_16x16x32_bf16 v[148:151], a[208:211], a[64:67], v[148:151]
    ds_read_b32 a179, v58
    v_perm_b32 v61, v76, v35, s36
    v_mfma_f32_16x16x32_bf16 v[148:151], a[212:215], a[68:71], v[148:151]
    ds_read_b32 a180, v61
    v_perm_b32 v59, v76, v35, s37
    v_mfma_f32_16x16x32_bf16 v[152:155], a[208:211], a[72:75], v[152:155]
    ds_read_b32 a181, v59
    v_perm_b32 v62, v76, v35, s38
    v_mfma_f32_16x16x32_bf16 v[152:155], a[212:215], a[76:79], v[152:155]
    ds_read_b32 a182, v62
    v_perm_b32 v63, v76, v35, s39
    v_mfma_f32_16x16x32_bf16 v[156:159], a[208:211], a[80:83], v[156:159]
    ds_read_b32 a183, v63
    v_perm_b32 v60, v80, v35, s36
    v_mfma_f32_16x16x32_bf16 v[156:159], a[212:215], a[84:87], v[156:159]
    ds_read_b32 a184, v60
    v_perm_b32 v56, v80, v35, s37
    v_mfma_f32_16x16x32_bf16 v[160:163], a[216:219], a[24:27], v[160:163]
    ds_read_b32 a185, v56
    v_perm_b32 v57, v80, v35, s38
    v_mfma_f32_16x16x32_bf16 v[160:163], a[220:223], a[28:31], v[160:163]
    ds_read_b32 a186, v57
    v_perm_b32 v58, v80, v35, s39
    v_mfma_f32_16x16x32_bf16 v[164:167], a[216:219], a[32:35], v[164:167]
    ds_read_b32 a187, v58
    ds_read_b128 a[88:91], v40 offset:32768
    v_mfma_f32_16x16x32_bf16 v[164:167], a[220:223], a[36:39], v[164:167]
    v_perm_b32 v61, v84, v35, s36
    v_perm_b32 v59, v84, v35, s37
    v_mfma_f32_16x16x32_bf16 v[168:171], a[216:219], a[40:43], v[168:171]
    ds_read_b32 a188, v61
    ds_read_b32 a189, v59
    v_mfma_f32_16x16x32_bf16 v[168:171], a[220:223], a[44:47], v[168:171]
    ds_read_b128 a[92:95], v41 offset:32768
    v_perm_b32 v62, v84, v35, s38
    v_mfma_f32_16x16x32_bf16 v[172:175], a[216:219], a[48:51], v[172:175]
    ds_read_b32 a190, v62
    v_perm_b32 v63, v84, v35, s39
    v_mfma_f32_16x16x32_bf16 v[172:175], a[220:223], a[52:55], v[172:175]
    ds_read_b32 a191, v63
    v_perm_b32 v60, v73, v35, s36
    v_mfma_f32_16x16x32_bf16 v[176:179], a[216:219], a[56:59], v[176:179]
    ds_read_b32 a192, v60
    v_perm_b32 v56, v73, v35, s37
    v_mfma_f32_16x16x32_bf16 v[176:179], a[220:223], a[60:63], v[176:179]
    ds_read_b32 a193, v56
    v_perm_b32 v57, v73, v35, s38
    v_mfma_f32_16x16x32_bf16 v[180:183], a[216:219], a[64:67], v[180:183]
    ds_read_b128 a[96:99], v40 offset:49152
    ds_read_b32 a194, v57
    v_mfma_f32_16x16x32_bf16 v[180:183], a[220:223], a[68:71], v[180:183]
    v_perm_b32 v58, v73, v35, s39
    v_perm_b32 v61, v77, v35, s36
    v_mfma_f32_16x16x32_bf16 v[184:187], a[216:219], a[72:75], v[184:187]
    ds_read_b32 a195, v58
    ds_read_b32 a196, v61
    v_mfma_f32_16x16x32_bf16 v[184:187], a[220:223], a[76:79], v[184:187]
    ds_read_b128 a[100:103], v41 offset:49152
    v_perm_b32 v59, v77, v35, s37
    v_mfma_f32_16x16x32_bf16 v[188:191], a[216:219], a[80:83], v[188:191]
    ds_read_b32 a197, v59
    v_perm_b32 v62, v77, v35, s38
    v_mfma_f32_16x16x32_bf16 v[188:191], a[220:223], a[84:87], v[188:191]
    ds_read_b32 a198, v62
    v_perm_b32 v63, v81, v35, s36
    v_mfma_f32_16x16x32_bf16 v[192:195], a[224:227], a[24:27], v[192:195]
    ds_read_b32 a200, v63
    v_perm_b32 v60, v81, v35, s37
    v_mfma_f32_16x16x32_bf16 v[192:195], a[228:231], a[28:31], v[192:195]
    ds_read_b32 a201, v60
    v_perm_b32 v56, v77, v35, s39
    v_mfma_f32_16x16x32_bf16 v[196:199], a[224:227], a[32:35], v[196:199]
    ds_read_b32 a199, v56
    v_perm_b32 v57, v81, v35, s38
    v_mfma_f32_16x16x32_bf16 v[196:199], a[228:231], a[36:39], v[196:199]
    s_waitcnt vmcnt(0)
    ds_read_b32 a202, v57
    v_perm_b32 v58, v81, v35, s39
    v_mfma_f32_16x16x32_bf16 v[200:203], a[224:227], a[40:43], v[200:203]
    s_barrier
    v_mfma_f32_16x16x32_bf16 v[200:203], a[228:231], a[44:47], v[200:203]
    v_perm_b32 v61, v85, v35, s36
    v_perm_b32 v59, v85, v35, s37
    v_mfma_f32_16x16x32_bf16 v[204:207], a[224:227], a[48:51], v[204:207]
    ds_read_b32 a204, v61
    ds_read_b32 a205, v59
    v_mfma_f32_16x16x32_bf16 v[204:207], a[228:231], a[52:55], v[204:207]
    ds_read_b32 a203, v58
    v_perm_b32 v62, v85, v35, s38
    v_mfma_f32_16x16x32_bf16 v[208:211], a[224:227], a[56:59], v[208:211]
    ds_read_b32 a206, v62
    v_perm_b32 v63, v74, v35, s36
    v_mfma_f32_16x16x32_bf16 v[208:211], a[228:231], a[60:63], v[208:211]
    ds_read_b128 a[104:107], v42 offset:0
    ds_read_b32 a208, v63
    v_mfma_f32_16x16x32_bf16 v[212:215], a[224:227], a[64:67], v[212:215]
    ds_read_b128 a[108:111], v43 offset:0
    v_perm_b32 v60, v74, v35, s37
    v_mfma_f32_16x16x32_bf16 v[212:215], a[228:231], a[68:71], v[212:215]
    ds_read_b128 a[112:115], v42 offset:16384
    v_perm_b32 v56, v85, v35, s39
    v_mfma_f32_16x16x32_bf16 v[216:219], a[224:227], a[72:75], v[216:219]
    ds_read_b128 a[116:119], v43 offset:16384
    v_perm_b32 v57, v78, v35, s36
    v_mfma_f32_16x16x32_bf16 v[216:219], a[228:231], a[76:79], v[216:219]
    ds_read_b32 a209, v60
    v_perm_b32 v61, v74, v35, s38
    v_mfma_f32_16x16x32_bf16 v[220:223], a[224:227], a[80:83], v[220:223]
    ds_read_b32 a212, v57
    v_perm_b32 v59, v78, v35, s37
    v_mfma_f32_16x16x32_bf16 v[220:223], a[228:231], a[84:87], v[220:223]
    s_waitcnt lgkmcnt(9)
    ds_read_b32 a207, v56
    ds_read_b32 a210, v61
    v_mfma_f32_16x16x32_bf16 v[224:227], a[232:235], a[90:93], v[224:227]
    s_mov_b32 s66, 0
    v_perm_b32 v62, v82, v35, s36
    v_perm_b32 v58, v74, v35, s39
    v_mfma_f32_16x16x32_bf16 v[224:227], a[236:239], a[98:101], v[224:227]
    s_mov_b32 s67, 14336
    ds_read_b32 a213, v59
    v_perm_b32 v63, v78, v35, s38
    v_mfma_f32_16x16x32_bf16 v[128:131], a[240:243], a[88:91], v[128:131]
    ds_read_b32 a216, v62
    v_perm_b32 v60, v82, v35, s37
    v_mfma_f32_16x16x32_bf16 v[128:131], a[244:247], a[92:95], v[128:131]
    ds_read_b32 a211, v58
    ds_read_b32 a214, v63
    v_mfma_f32_16x16x32_bf16 v[128:131], a[248:251], a[96:99], v[128:131]
    ds_read_b32 a217, v60
    v_perm_b32 v57, v78, v35, s39
    v_mfma_f32_16x16x32_bf16 v[128:131], a[252:255], a[100:103], v[128:131]
    ds_read_b32 a215, v57
    v_perm_b32 v56, v82, v35, s38
    v_mfma_f32_16x16x32_bf16 v[160:163], a[136:139], a[88:91], v[160:163]
    ds_read_b32 a218, v56
    v_perm_b32 v61, v86, v35, s36
    v_mfma_f32_16x16x32_bf16 v[160:163], a[140:143], a[92:95], v[160:163]
    v_perm_b32 v62, v86, v35, s37
    v_perm_b32 v59, v82, v35, s39
    v_mfma_f32_16x16x32_bf16 v[160:163], a[144:147], a[96:99], v[160:163]
    ds_read_b32 a220, v61
    ds_read_b32 a219, v59
    v_mfma_f32_16x16x32_bf16 v[160:163], a[148:151], a[100:103], v[160:163]
    ds_read_b32 a221, v62
    v_perm_b32 v58, v86, v35, s38
    v_mfma_f32_16x16x32_bf16 v[192:195], a[152:155], a[88:91], v[192:195]
    ds_read_b128 a[120:123], v40 offset:34816
    ds_read_b32 a222, v58
    v_mfma_f32_16x16x32_bf16 v[192:195], a[156:159], a[92:95], v[192:195]
    ds_read_b128 a[124:127], v41 offset:34816
    v_perm_b32 v63, v86, v35, s39
    v_mfma_f32_16x16x32_bf16 v[192:195], a[160:163], a[96:99], v[192:195]
    ds_read_b128 a[128:131], v40 offset:51200
    ds_read_b32 a223, v63
    v_mfma_f32_16x16x32_bf16 v[192:195], a[164:167], a[100:103], v[192:195]
    s_waitcnt lgkmcnt(10)
    v_lshlrev_b32 v96, 16, v70
    v_and_b32 v97, 0xffff0000, v70
    v_mfma_f32_16x16x32_bf16 v[224:227], a[168:171], a[106:109], v[224:227]
    ds_read_b128 a[132:135], v41 offset:51200
    v_lshlrev_b32 v100, 16, v64
    v_mfma_f32_16x16x32_bf16 v[224:227], a[172:175], a[114:117], v[224:227]
    ds_read_b128 a[0:3], v42 offset:2048
    v_and_b32 v101, 0xffff0000, v65
    v_mfma_f32_16x16x32_bf16 v[128:131], a[176:179], a[104:107], v[128:131]
    ds_read_b128 a[4:7], v43 offset:2048
    v_lshlrev_b32 v102, 16, v67
    v_mfma_f32_16x16x32_bf16 v[128:131], a[180:183], a[108:111], v[128:131]
    ds_read_b128 a[8:11], v42 offset:18432
    v_and_b32 v103, 0xffff0000, v68
    v_mfma_f32_16x16x32_bf16 v[128:131], a[184:187], a[112:115], v[128:131]
    v_and_b32 v104, 0xffff0000, v64
    v_lshlrev_b32 v105, 16, v66
L_pad4:
    s_cbranch_execz L_warmed
    v_mfma_f32_16x16x32_bf16 v[128:131], a[188:191], a[116:119], v[128:131]
    ds_read_b128 a[12:15], v43 offset:18432
    v_and_b32 v106, 0xffff0000, v67
    v_mfma_f32_16x16x32_bf16 v[160:163], a[192:195], a[104:107], v[160:163]
    ds_write_b64 v29, v[226:227] offset:0
    v_lshlrev_b32 v107, 16, v69
    v_mfma_f32_16x16x32_bf16 v[160:163], a[196:199], a[108:111], v[160:163]
    v_lshlrev_b32 v108, 16, v65
    v_and_b32 v109, 0xffff0000, v66
    v_mfma_f32_16x16x32_bf16 v[160:163], a[200:203], a[112:115], v[160:163]
    v_lshlrev_b32 v110, 16, v68
    v_and_b32 v111, 0xffff0000, v69
    v_mfma_f32_16x16x32_bf16 v[160:163], a[204:207], a[116:119], v[160:163]
    ds_read_b128 a[16:19], v40 offset:36864
    v_mul_f32 v128, v128, v100
    v_mfma_f32_16x16x32_bf16 v[192:195], a[208:211], a[104:107], v[192:195]
    s_waitcnt lgkmcnt(5)
    v_mul_f32 v129, v129, v101
    v_mul_f32 v130, v130, v102
    v_mfma_f32_16x16x32_bf16 v[192:195], a[212:215], a[108:111], v[192:195]
    s_waitcnt lgkmcnt(1)
    s_barrier
    v_mfma_f32_16x16x32_bf16 v[192:195], a[216:219], a[112:115], v[192:195]
    ds_read_b64 v[112:113], v30 offset:0
    ds_read_b128 a[20:23], v41 offset:36864
    v_mfma_f32_16x16x32_bf16 v[192:195], a[220:223], a[116:119], v[192:195]
    v_mul_f32 v131, v131, v103
    v_mul_f32 v160, v160, v104
    v_mfma_f32_16x16x32_bf16 v[228:231], a[232:235], a[122:125], v[228:231]
    v_cvt_pk_bf16_f32 v116, v128, v160
    v_mul_f32 v161, v161, v105
    v_mfma_f32_16x16x32_bf16 v[228:231], a[236:239], a[130:133], v[228:231]
    ds_read_b128 a[24:27], v40 offset:53248
    v_mul_f32 v162, v162, v106
    v_mfma_f32_16x16x32_bf16 v[228:231], a[168:171], a[2:5], v[228:231]
    v_cvt_pk_bf16_f32 v119, v130, v162
    v_mul_f32 v163, v163, v107
    v_mfma_f32_16x16x32_bf16 v[228:231], a[172:175], a[10:13], v[228:231]
    v_mul_f32 v192, v192, v108
    v_mul_f32 v193, v193, v109
    v_mfma_f32_16x16x32_bf16 v[132:135], a[240:243], a[120:123], v[132:135]
    v_mul_f32 v194, v194, v110
    v_mul_f32 v195, v195, v111
    v_mfma_f32_16x16x32_bf16 v[132:135], a[244:247], a[124:127], v[132:135]
    v_cvt_pk_bf16_f32 v117, v192, v129
    v_cvt_pk_bf16_f32 v118, v161, v193
    v_mfma_f32_16x16x32_bf16 v[132:135], a[248:251], a[128:131], v[132:135]
    ds_write_b64 v26, v[116:117] offset:0
    v_cvt_pk_bf16_f32 v120, v194, v131
    v_mfma_f32_16x16x32_bf16 v[132:135], a[252:255], a[132:135], v[132:135]
    ds_write_b64 v26, v[118:119] offset:8
    v_cvt_pk_bf16_f32 v121, v163, v195
    v_mfma_f32_16x16x32_bf16 v[132:135], a[176:179], a[0:3], v[132:135]
    s_waitcnt lgkmcnt(3)
    ds_write_b64 v26, v[120:121] offset:16
    v_add_f32 v224, v224, v112
    v_mfma_f32_16x16x32_bf16 v[132:135], a[180:183], a[4:7], v[132:135]
    ds_read_b128 a[28:31], v41 offset:53248
    v_mul_f32 v224, v224, v96
    v_mfma_f32_16x16x32_bf16 v[132:135], a[184:187], a[8:11], v[132:135]
    v_add_f32 v225, v225, v113
    v_mul_f32 v225, v225, v97
    v_mfma_f32_16x16x32_bf16 v[132:135], a[188:191], a[12:15], v[132:135]
    ds_write_b64 v29, v[230:231] offset:2048
    v_cvt_pk_bf16_f32 v112, v224, v225
    v_mfma_f32_16x16x32_bf16 v[164:167], a[136:139], a[120:123], v[164:167]
    ds_write_b32 v28, v112 offset:0
    v_mov_b32 v8, 1
    v_mfma_f32_16x16x32_bf16 v[164:167], a[140:143], a[124:127], v[164:167]
    ds_read_b128 a[32:35], v42 offset:4096
    v_min_u32 v9, 1, v0
    v_mfma_f32_16x16x32_bf16 v[164:167], a[144:147], a[128:131], v[164:167]
    ds_read_b128 a[36:39], v43 offset:4096
    v_lshlrev_b32 v9, 30, v9
    v_mfma_f32_16x16x32_bf16 v[164:167], a[148:151], a[132:135], v[164:167]
    ds_read_b128 a[40:43], v42 offset:20480
    v_mfma_f32_16x16x32_bf16 v[164:167], a[192:195], a[0:3], v[164:167]
    buffer_atomic_add v8, v9, s[24:27], s77 offen sc0 sc1
    v_mfma_f32_16x16x32_bf16 v[164:167], a[196:199], a[4:7], v[164:167]
    s_waitcnt lgkmcnt(3)
    s_barrier
    v_mfma_f32_16x16x32_bf16 v[164:167], a[200:203], a[8:11], v[164:167]
    ds_read_b128 v[124:127], v24 offset:0
    ds_read_b64 v[88:89], v30 offset:2048
    v_mfma_f32_16x16x32_bf16 v[164:167], a[204:207], a[12:15], v[164:167]
    ds_read_b128 a[44:47], v43 offset:20480
    v_mul_f32 v132, v132, v100
    v_mfma_f32_16x16x32_bf16 v[196:199], a[152:155], a[120:123], v[196:199]
    ds_read_b128 v[92:95], v24 offset:928
    v_mul_f32 v133, v133, v101
    v_mfma_f32_16x16x32_bf16 v[196:199], a[156:159], a[124:127], v[196:199]
    v_mul_f32 v134, v134, v102
    v_mul_f32 v135, v135, v103
    v_mfma_f32_16x16x32_bf16 v[196:199], a[160:163], a[128:131], v[196:199]
    ds_read_b128 a[48:51], v40 offset:38912
    v_mfma_f32_16x16x32_bf16 v[196:199], a[164:167], a[132:135], v[196:199]
    v_mul_f32 v164, v164, v104
    v_cvt_pk_bf16_f32 v48, v132, v164
    v_mfma_f32_16x16x32_bf16 v[196:199], a[208:211], a[0:3], v[196:199]
    s_waitcnt lgkmcnt(3)
    v_mul_f32 v165, v165, v105
    v_mfma_f32_16x16x32_bf16 v[196:199], a[212:215], a[4:7], v[196:199]
    buffer_store_dwordx4 v[124:127], v25, s[16:19], s66 offen sc1
    v_mfma_f32_16x16x32_bf16 v[196:199], a[216:219], a[8:11], v[196:199]
    s_mov_b32 s66, 114688
    v_add_f32 v228, v228, v88
    v_mul_f32 v228, v228, v96
    v_mfma_f32_16x16x32_bf16 v[196:199], a[220:223], a[12:15], v[196:199]
    v_add_f32 v229, v229, v89
    v_mul_f32 v229, v229, v97
    v_mfma_f32_16x16x32_bf16 v[232:235], a[232:235], a[18:21], v[232:235]
    s_waitcnt lgkmcnt(1)
    ds_read_b128 a[52:55], v41 offset:38912
    v_mfma_f32_16x16x32_bf16 v[232:235], a[236:239], a[26:29], v[232:235]
    buffer_store_dwordx4 v[92:95], v25, s[16:19], s67 offen sc1
    v_mfma_f32_16x16x32_bf16 v[232:235], a[168:171], a[34:37], v[232:235]
    s_mov_b32 s67, 129024
    v_cvt_pk_bf16_f32 v88, v228, v229
    v_mul_f32 v166, v166, v106
    v_mfma_f32_16x16x32_bf16 v[232:235], a[172:175], a[42:45], v[232:235]
    ds_write_b32 v28, v88 offset:7424
    v_cvt_pk_bf16_f32 v51, v134, v166
    v_mfma_f32_16x16x32_bf16 v[136:139], a[240:243], a[16:19], v[136:139]
    v_mul_f32 v167, v167, v107
    v_mul_f32 v196, v196, v108
    v_mfma_f32_16x16x32_bf16 v[136:139], a[244:247], a[20:23], v[136:139]
    v_mul_f32 v197, v197, v109
    v_mul_f32 v198, v198, v110
    v_mfma_f32_16x16x32_bf16 v[136:139], a[248:251], a[24:27], v[136:139]
    ds_read_b128 a[56:59], v40 offset:55296
    v_mul_f32 v199, v199, v111
    v_mfma_f32_16x16x32_bf16 v[136:139], a[252:255], a[28:31], v[136:139]
    v_cvt_pk_bf16_f32 v49, v196, v133
    v_cvt_pk_bf16_f32 v50, v165, v197
    v_mfma_f32_16x16x32_bf16 v[136:139], a[176:179], a[32:35], v[136:139]
    ds_write_b64 v26, v[48:49] offset:7424
    v_cvt_pk_bf16_f32 v52, v198, v135
    v_mfma_f32_16x16x32_bf16 v[136:139], a[180:183], a[36:39], v[136:139]
    ds_read_b128 a[60:63], v41 offset:55296
    v_cvt_pk_bf16_f32 v53, v167, v199
    v_mfma_f32_16x16x32_bf16 v[136:139], a[184:187], a[40:43], v[136:139]
    ds_write_b64 v26, v[50:51] offset:7432
    v_mfma_f32_16x16x32_bf16 v[136:139], a[188:191], a[44:47], v[136:139]
    ds_write_b64 v26, v[52:53] offset:7440
    v_mfma_f32_16x16x32_bf16 v[168:171], a[136:139], a[16:19], v[168:171]
    ds_write_b64 v29, v[234:235] offset:4096
    v_mfma_f32_16x16x32_bf16 v[168:171], a[140:143], a[20:23], v[168:171]
    ds_read_b128 a[64:67], v42 offset:6144
    v_mfma_f32_16x16x32_bf16 v[168:171], a[144:147], a[24:27], v[168:171]
    ds_read_b128 a[68:71], v43 offset:6144
    v_mfma_f32_16x16x32_bf16 v[168:171], a[148:151], a[28:31], v[168:171]
    ds_read_b128 a[72:75], v42 offset:22528
    v_mul_f32 v136, v136, v100
    v_mfma_f32_16x16x32_bf16 v[168:171], a[192:195], a[32:35], v[168:171]
    v_mul_f32 v137, v137, v101
    v_mul_f32 v138, v138, v102
    v_mfma_f32_16x16x32_bf16 v[168:171], a[196:199], a[36:39], v[168:171]
    s_waitcnt lgkmcnt(3)
    s_barrier
    v_mfma_f32_16x16x32_bf16 v[168:171], a[200:203], a[40:43], v[168:171]
    ds_read_b128 v[72:75], v24 offset:7424
    ds_read_b64 v[76:77], v30 offset:4096
    v_mfma_f32_16x16x32_bf16 v[168:171], a[204:207], a[44:47], v[168:171]
    ds_read_b128 a[76:79], v43 offset:22528
    v_mul_f32 v139, v139, v103
    v_mfma_f32_16x16x32_bf16 v[200:203], a[152:155], a[16:19], v[200:203]
    ds_read_b128 v[80:83], v24 offset:8352
    v_mfma_f32_16x16x32_bf16 v[200:203], a[156:159], a[20:23], v[200:203]
    v_mfma_f32_16x16x32_bf16 v[200:203], a[160:163], a[24:27], v[200:203]
    ds_read_b128 a[80:83], v40 offset:40960
    v_mfma_f32_16x16x32_bf16 v[200:203], a[164:167], a[28:31], v[200:203]
    v_mul_f32 v168, v168, v104
    v_cvt_pk_bf16_f32 v84, v136, v168
    v_mfma_f32_16x16x32_bf16 v[200:203], a[208:211], a[32:35], v[200:203]
    s_waitcnt lgkmcnt(3)
    v_mul_f32 v169, v169, v105
    v_mfma_f32_16x16x32_bf16 v[200:203], a[212:215], a[36:39], v[200:203]
    buffer_store_dwordx4 v[72:75], v25, s[16:19], s66 offen sc1
    v_mfma_f32_16x16x32_bf16 v[200:203], a[216:219], a[40:43], v[200:203]
    s_mov_b32 s66, 229376
    v_add_f32 v232, v232, v76
    v_mul_f32 v232, v232, v96
    v_mfma_f32_16x16x32_bf16 v[200:203], a[220:223], a[44:47], v[200:203]
    v_add_f32 v233, v233, v77
    v_mul_f32 v233, v233, v97
    v_mfma_f32_16x16x32_bf16 v[236:239], a[232:235], a[50:53], v[236:239]
    s_waitcnt lgkmcnt(1)
    ds_read_b128 a[84:87], v41 offset:40960
    v_mfma_f32_16x16x32_bf16 v[236:239], a[236:239], a[58:61], v[236:239]
    buffer_store_dwordx4 v[80:83], v25, s[16:19], s67 offen sc1
    v_mfma_f32_16x16x32_bf16 v[236:239], a[168:171], a[66:69], v[236:239]
    s_mov_b32 s67, 243712
    v_cvt_pk_bf16_f32 v76, v232, v233
    v_mul_f32 v170, v170, v106
    v_mfma_f32_16x16x32_bf16 v[236:239], a[172:175], a[74:77], v[236:239]
    ds_write_b32 v28, v76 offset:14848
    v_cvt_pk_bf16_f32 v87, v138, v170
    v_mfma_f32_16x16x32_bf16 v[140:143], a[240:243], a[48:51], v[140:143]
    v_mul_f32 v171, v171, v107
    v_mul_f32 v200, v200, v108
    v_mfma_f32_16x16x32_bf16 v[140:143], a[244:247], a[52:55], v[140:143]
    v_mul_f32 v201, v201, v109
    v_mul_f32 v202, v202, v110
    v_mfma_f32_16x16x32_bf16 v[140:143], a[248:251], a[56:59], v[140:143]
    ds_read_b128 a[88:91], v40 offset:57344
    v_mul_f32 v203, v203, v111
    v_mfma_f32_16x16x32_bf16 v[140:143], a[252:255], a[60:63], v[140:143]
    v_cvt_pk_bf16_f32 v85, v200, v137
    v_cvt_pk_bf16_f32 v86, v169, v201
    v_mfma_f32_16x16x32_bf16 v[140:143], a[176:179], a[64:67], v[140:143]
    ds_write_b64 v26, v[84:85] offset:14848
    v_cvt_pk_bf16_f32 v64, v202, v139
    v_mfma_f32_16x16x32_bf16 v[140:143], a[180:183], a[68:71], v[140:143]
    ds_read_b128 a[92:95], v41 offset:57344
    v_cvt_pk_bf16_f32 v65, v171, v203
    v_mfma_f32_16x16x32_bf16 v[140:143], a[184:187], a[72:75], v[140:143]
    ds_write_b64 v26, v[86:87] offset:14856
    v_mfma_f32_16x16x32_bf16 v[140:143], a[188:191], a[76:79], v[140:143]
    ds_write_b64 v26, v[64:65] offset:14864
    v_mfma_f32_16x16x32_bf16 v[172:175], a[136:139], a[48:51], v[172:175]
    ds_write_b64 v29, v[238:239] offset:0
    v_mfma_f32_16x16x32_bf16 v[172:175], a[140:143], a[52:55], v[172:175]
    ds_read_b128 a[96:99], v42 offset:8192
    v_mfma_f32_16x16x32_bf16 v[172:175], a[144:147], a[56:59], v[172:175]
    ds_read_b128 a[100:103], v43 offset:8192
    v_mfma_f32_16x16x32_bf16 v[172:175], a[148:151], a[60:63], v[172:175]
    ds_read_b128 a[104:107], v42 offset:24576
    v_mul_f32 v140, v140, v100
    v_mfma_f32_16x16x32_bf16 v[172:175], a[192:195], a[64:67], v[172:175]
    v_mul_f32 v141, v141, v101
    v_mul_f32 v142, v142, v102
    v_mfma_f32_16x16x32_bf16 v[172:175], a[196:199], a[68:71], v[172:175]
    s_waitcnt lgkmcnt(3)
    s_barrier
    v_mfma_f32_16x16x32_bf16 v[172:175], a[200:203], a[72:75], v[172:175]
    ds_read_b128 v[68:71], v24 offset:14848
    ds_read_b64 v[116:117], v30 offset:0
    v_mfma_f32_16x16x32_bf16 v[172:175], a[204:207], a[76:79], v[172:175]
    ds_read_b128 a[108:111], v43 offset:24576
    v_mul_f32 v143, v143, v103
    v_mfma_f32_16x16x32_bf16 v[204:207], a[152:155], a[48:51], v[204:207]
    ds_read_b128 v[120:123], v24 offset:15776
    v_mfma_f32_16x16x32_bf16 v[204:207], a[156:159], a[52:55], v[204:207]
    v_mfma_f32_16x16x32_bf16 v[204:207], a[160:163], a[56:59], v[204:207]
    ds_read_b128 a[112:115], v40 offset:43008
    v_mfma_f32_16x16x32_bf16 v[204:207], a[164:167], a[60:63], v[204:207]
    v_mul_f32 v172, v172, v104
    v_cvt_pk_bf16_f32 v112, v140, v172
    v_mfma_f32_16x16x32_bf16 v[204:207], a[208:211], a[64:67], v[204:207]
    s_waitcnt lgkmcnt(3)
    v_mul_f32 v173, v173, v105
    v_mfma_f32_16x16x32_bf16 v[204:207], a[212:215], a[68:71], v[204:207]
    buffer_store_dwordx4 v[68:71], v25, s[16:19], s66 offen sc1
    v_mfma_f32_16x16x32_bf16 v[204:207], a[216:219], a[72:75], v[204:207]
    s_mov_b32 s66, 344064
    v_add_f32 v236, v236, v116
    v_mul_f32 v236, v236, v96
    v_mfma_f32_16x16x32_bf16 v[204:207], a[220:223], a[76:79], v[204:207]
    v_add_f32 v237, v237, v117
    v_mul_f32 v237, v237, v97
    v_mfma_f32_16x16x32_bf16 v[240:243], a[232:235], a[82:85], v[240:243]
    s_waitcnt lgkmcnt(1)
    ds_read_b128 a[116:119], v41 offset:43008
    v_mfma_f32_16x16x32_bf16 v[240:243], a[236:239], a[90:93], v[240:243]
    buffer_store_dwordx4 v[120:123], v25, s[16:19], s67 offen sc1
    v_mfma_f32_16x16x32_bf16 v[240:243], a[168:171], a[98:101], v[240:243]
    s_mov_b32 s67, 358400
    v_cvt_pk_bf16_f32 v116, v236, v237
    v_mul_f32 v174, v174, v106
    v_mfma_f32_16x16x32_bf16 v[240:243], a[172:175], a[106:109], v[240:243]
    ds_write_b32 v28, v116 offset:0
    v_cvt_pk_bf16_f32 v115, v142, v174
    v_mfma_f32_16x16x32_bf16 v[144:147], a[240:243], a[80:83], v[144:147]
    v_mul_f32 v175, v175, v107
    v_mul_f32 v204, v204, v108
    v_mfma_f32_16x16x32_bf16 v[144:147], a[244:247], a[84:87], v[144:147]
    v_mul_f32 v205, v205, v109
    v_mul_f32 v206, v206, v110
    v_mfma_f32_16x16x32_bf16 v[144:147], a[248:251], a[88:91], v[144:147]
    ds_read_b128 a[120:123], v40 offset:59392
    v_mul_f32 v207, v207, v111
    v_mfma_f32_16x16x32_bf16 v[144:147], a[252:255], a[92:95], v[144:147]
    v_cvt_pk_bf16_f32 v113, v204, v141
    v_cvt_pk_bf16_f32 v114, v173, v205
    v_mfma_f32_16x16x32_bf16 v[144:147], a[176:179], a[96:99], v[144:147]
    ds_write_b64 v26, v[112:113] offset:0
    v_cvt_pk_bf16_f32 v124, v206, v143
    v_mfma_f32_16x16x32_bf16 v[144:147], a[180:183], a[100:103], v[144:147]
    ds_read_b128 a[124:127], v41 offset:59392
    v_cvt_pk_bf16_f32 v125, v175, v207
    v_mfma_f32_16x16x32_bf16 v[144:147], a[184:187], a[104:107], v[144:147]
    ds_write_b64 v26, v[114:115] offset:8
    v_mfma_f32_16x16x32_bf16 v[144:147], a[188:191], a[108:111], v[144:147]
    ds_write_b64 v26, v[124:125] offset:16
    v_mfma_f32_16x16x32_bf16 v[176:179], a[136:139], a[80:83], v[176:179]
    ds_write_b64 v29, v[242:243] offset:2048
    v_mfma_f32_16x16x32_bf16 v[176:179], a[140:143], a[84:87], v[176:179]
    ds_read_b128 a[128:131], v42 offset:10240
    v_mfma_f32_16x16x32_bf16 v[176:179], a[144:147], a[88:91], v[176:179]
    ds_read_b128 a[132:135], v43 offset:10240
    v_mfma_f32_16x16x32_bf16 v[176:179], a[148:151], a[92:95], v[176:179]
    ds_read_b128 a[0:3], v42 offset:26624
    v_mul_f32 v144, v144, v100
    v_mfma_f32_16x16x32_bf16 v[176:179], a[192:195], a[96:99], v[176:179]
    v_mul_f32 v145, v145, v101
    v_mul_f32 v146, v146, v102
    v_mfma_f32_16x16x32_bf16 v[176:179], a[196:199], a[100:103], v[176:179]
    s_waitcnt lgkmcnt(3)
    s_barrier
    v_mfma_f32_16x16x32_bf16 v[176:179], a[200:203], a[104:107], v[176:179]
    ds_read_b128 v[92:95], v24 offset:0
    ds_read_b64 v[88:89], v30 offset:2048
    v_mfma_f32_16x16x32_bf16 v[176:179], a[204:207], a[108:111], v[176:179]
    ds_read_b128 a[4:7], v43 offset:26624
    v_mul_f32 v147, v147, v103
    v_mfma_f32_16x16x32_bf16 v[208:211], a[152:155], a[80:83], v[208:211]
    ds_read_b128 v[48:51], v24 offset:928
    v_mfma_f32_16x16x32_bf16 v[208:211], a[156:159], a[84:87], v[208:211]
    v_mfma_f32_16x16x32_bf16 v[208:211], a[160:163], a[88:91], v[208:211]
    ds_read_b128 a[8:11], v40 offset:45056
    v_mfma_f32_16x16x32_bf16 v[208:211], a[164:167], a[92:95], v[208:211]
    v_mul_f32 v176, v176, v104
    v_cvt_pk_bf16_f32 v52, v144, v176
    v_mfma_f32_16x16x32_bf16 v[208:211], a[208:211], a[96:99], v[208:211]
    s_waitcnt lgkmcnt(3)
    v_mul_f32 v177, v177, v105
    v_mfma_f32_16x16x32_bf16 v[208:211], a[212:215], a[100:103], v[208:211]
    buffer_store_dwordx4 v[92:95], v25, s[16:19], s66 offen sc1
    v_mfma_f32_16x16x32_bf16 v[208:211], a[216:219], a[104:107], v[208:211]
    s_mov_b32 s66, 458752
    v_add_f32 v240, v240, v88
    v_mul_f32 v240, v240, v96
    v_mfma_f32_16x16x32_bf16 v[208:211], a[220:223], a[108:111], v[208:211]
    v_add_f32 v241, v241, v89
    v_mul_f32 v241, v241, v97
    v_mfma_f32_16x16x32_bf16 v[244:247], a[232:235], a[114:117], v[244:247]
    s_waitcnt lgkmcnt(1)
    ds_read_b128 a[12:15], v41 offset:45056
    v_mfma_f32_16x16x32_bf16 v[244:247], a[236:239], a[122:125], v[244:247]
    buffer_store_dwordx4 v[48:51], v25, s[16:19], s67 offen sc1
    v_mfma_f32_16x16x32_bf16 v[244:247], a[168:171], a[130:133], v[244:247]
    s_mov_b32 s67, 473088
    v_cvt_pk_bf16_f32 v88, v240, v241
    v_mul_f32 v178, v178, v106
    v_mfma_f32_16x16x32_bf16 v[244:247], a[172:175], a[2:5], v[244:247]
    ds_write_b32 v28, v88 offset:7424
    v_cvt_pk_bf16_f32 v55, v146, v178
    v_mfma_f32_16x16x32_bf16 v[148:151], a[240:243], a[112:115], v[148:151]
    v_mul_f32 v179, v179, v107
    v_mul_f32 v208, v208, v108
    v_mfma_f32_16x16x32_bf16 v[148:151], a[244:247], a[116:119], v[148:151]
    v_mul_f32 v209, v209, v109
    v_mul_f32 v210, v210, v110
    v_mfma_f32_16x16x32_bf16 v[148:151], a[248:251], a[120:123], v[148:151]
    ds_read_b128 a[16:19], v40 offset:61440
    v_mul_f32 v211, v211, v111
    v_mfma_f32_16x16x32_bf16 v[148:151], a[252:255], a[124:127], v[148:151]
    v_cvt_pk_bf16_f32 v53, v208, v145
    v_cvt_pk_bf16_f32 v54, v177, v209
    v_mfma_f32_16x16x32_bf16 v[148:151], a[176:179], a[128:131], v[148:151]
    ds_write_b64 v26, v[52:53] offset:7424
    v_cvt_pk_bf16_f32 v72, v210, v147
    v_mfma_f32_16x16x32_bf16 v[148:151], a[180:183], a[132:135], v[148:151]
    ds_read_b128 a[20:23], v41 offset:61440
    v_cvt_pk_bf16_f32 v73, v179, v211
    v_mfma_f32_16x16x32_bf16 v[148:151], a[184:187], a[0:3], v[148:151]
    ds_write_b64 v26, v[54:55] offset:7432
    v_mfma_f32_16x16x32_bf16 v[148:151], a[188:191], a[4:7], v[148:151]
    ds_write_b64 v26, v[72:73] offset:7440
    v_mfma_f32_16x16x32_bf16 v[180:183], a[136:139], a[112:115], v[180:183]
    ds_write_b64 v29, v[246:247] offset:4096
    v_mfma_f32_16x16x32_bf16 v[180:183], a[140:143], a[116:119], v[180:183]
    ds_read_b128 a[24:27], v42 offset:12288
    v_mfma_f32_16x16x32_bf16 v[180:183], a[144:147], a[120:123], v[180:183]
    ds_read_b128 a[28:31], v43 offset:12288
    v_mfma_f32_16x16x32_bf16 v[180:183], a[148:151], a[124:127], v[180:183]
    ds_read_b128 a[32:35], v42 offset:28672
    v_mul_f32 v148, v148, v100
    v_mfma_f32_16x16x32_bf16 v[180:183], a[192:195], a[128:131], v[180:183]
    v_mul_f32 v149, v149, v101
    v_mul_f32 v150, v150, v102
    v_mfma_f32_16x16x32_bf16 v[180:183], a[196:199], a[132:135], v[180:183]
    s_waitcnt lgkmcnt(3)
    s_barrier
    v_mfma_f32_16x16x32_bf16 v[180:183], a[200:203], a[0:3], v[180:183]
    ds_read_b128 v[80:83], v24 offset:7424
    ds_read_b64 v[76:77], v30 offset:4096
    v_mfma_f32_16x16x32_bf16 v[180:183], a[204:207], a[4:7], v[180:183]
    ds_read_b128 a[36:39], v43 offset:28672
    v_mul_f32 v151, v151, v103
    v_mfma_f32_16x16x32_bf16 v[212:215], a[152:155], a[112:115], v[212:215]
    ds_read_b128 v[84:87], v24 offset:8352
    v_mfma_f32_16x16x32_bf16 v[212:215], a[156:159], a[116:119], v[212:215]
    v_mfma_f32_16x16x32_bf16 v[212:215], a[160:163], a[120:123], v[212:215]
    ds_read_b128 a[40:43], v40 offset:47104
    v_mfma_f32_16x16x32_bf16 v[212:215], a[164:167], a[124:127], v[212:215]
    v_mul_f32 v180, v180, v104
    v_cvt_pk_bf16_f32 v64, v148, v180
    v_mfma_f32_16x16x32_bf16 v[212:215], a[208:211], a[128:131], v[212:215]
    s_waitcnt lgkmcnt(3)
    v_mul_f32 v181, v181, v105
    v_mfma_f32_16x16x32_bf16 v[212:215], a[212:215], a[132:135], v[212:215]
    buffer_store_dwordx4 v[80:83], v25, s[16:19], s66 offen sc1
    v_mfma_f32_16x16x32_bf16 v[212:215], a[216:219], a[0:3], v[212:215]
    s_mov_b32 s66, 573440
    v_add_f32 v244, v244, v76
    v_mul_f32 v244, v244, v96
    v_mfma_f32_16x16x32_bf16 v[212:215], a[220:223], a[4:7], v[212:215]
    v_add_f32 v245, v245, v77
    v_mul_f32 v245, v245, v97
    v_mfma_f32_16x16x32_bf16 v[248:251], a[232:235], a[10:13], v[248:251]
    s_waitcnt lgkmcnt(1)
    ds_read_b128 a[44:47], v41 offset:47104
    v_mfma_f32_16x16x32_bf16 v[248:251], a[236:239], a[18:21], v[248:251]
    buffer_store_dwordx4 v[84:87], v25, s[16:19], s67 offen sc1
    v_mfma_f32_16x16x32_bf16 v[248:251], a[168:171], a[26:29], v[248:251]
    s_mov_b32 s67, 587776
    v_cvt_pk_bf16_f32 v76, v244, v245
    v_mul_f32 v182, v182, v106
    v_mfma_f32_16x16x32_bf16 v[248:251], a[172:175], a[34:37], v[248:251]
    ds_write_b32 v28, v76 offset:14848
    v_cvt_pk_bf16_f32 v67, v150, v182
    v_mfma_f32_16x16x32_bf16 v[152:155], a[240:243], a[8:11], v[152:155]
    v_mul_f32 v183, v183, v107
    v_mul_f32 v212, v212, v108
    v_mfma_f32_16x16x32_bf16 v[152:155], a[244:247], a[12:15], v[152:155]
    v_mul_f32 v213, v213, v109
    v_mul_f32 v214, v214, v110
    v_mfma_f32_16x16x32_bf16 v[152:155], a[248:251], a[16:19], v[152:155]
    ds_read_b128 a[48:51], v40 offset:63488
    v_mul_f32 v215, v215, v111
    v_mfma_f32_16x16x32_bf16 v[152:155], a[252:255], a[20:23], v[152:155]
    v_cvt_pk_bf16_f32 v65, v212, v149
    v_cvt_pk_bf16_f32 v66, v181, v213
    v_mfma_f32_16x16x32_bf16 v[152:155], a[176:179], a[24:27], v[152:155]
    ds_write_b64 v26, v[64:65] offset:14848
    v_cvt_pk_bf16_f32 v68, v214, v151
    v_mfma_f32_16x16x32_bf16 v[152:155], a[180:183], a[28:31], v[152:155]
    ds_read_b128 a[52:55], v41 offset:63488
    v_cvt_pk_bf16_f32 v69, v183, v215
    v_mfma_f32_16x16x32_bf16 v[152:155], a[184:187], a[32:35], v[152:155]
    ds_write_b64 v26, v[66:67] offset:14856
    v_mfma_f32_16x16x32_bf16 v[152:155], a[188:191], a[36:39], v[152:155]
    ds_write_b64 v26, v[68:69] offset:14864
    v_mfma_f32_16x16x32_bf16 v[184:187], a[136:139], a[8:11], v[184:187]
    ds_write_b64 v29, v[250:251] offset:0
    v_mfma_f32_16x16x32_bf16 v[184:187], a[140:143], a[12:15], v[184:187]
    ds_read_b128 a[56:59], v42 offset:14336
    v_mfma_f32_16x16x32_bf16 v[184:187], a[144:147], a[16:19], v[184:187]
    ds_read_b128 a[60:63], v43 offset:14336
    v_mfma_f32_16x16x32_bf16 v[184:187], a[148:151], a[20:23], v[184:187]
    ds_read_b128 a[64:67], v42 offset:30720
    v_mul_f32 v152, v152, v100
    v_mfma_f32_16x16x32_bf16 v[184:187], a[192:195], a[24:27], v[184:187]
    v_mul_f32 v153, v153, v101
    v_mul_f32 v154, v154, v102
    v_mfma_f32_16x16x32_bf16 v[184:187], a[196:199], a[28:31], v[184:187]
    s_waitcnt lgkmcnt(3)
    s_barrier
    v_mfma_f32_16x16x32_bf16 v[184:187], a[200:203], a[32:35], v[184:187]
    ds_read_b128 v[120:123], v24 offset:14848
    ds_read_b64 v[116:117], v30 offset:0
    v_mfma_f32_16x16x32_bf16 v[184:187], a[204:207], a[36:39], v[184:187]
    ds_read_b128 a[68:71], v43 offset:30720
    v_mul_f32 v155, v155, v103
    v_mfma_f32_16x16x32_bf16 v[216:219], a[152:155], a[8:11], v[216:219]
    ds_read_b128 v[112:115], v24 offset:15776
    v_mfma_f32_16x16x32_bf16 v[216:219], a[156:159], a[12:15], v[216:219]
    v_mfma_f32_16x16x32_bf16 v[216:219], a[160:163], a[16:19], v[216:219]
    v_mfma_f32_16x16x32_bf16 v[216:219], a[164:167], a[20:23], v[216:219]
    v_mul_f32 v184, v184, v104
    v_cvt_pk_bf16_f32 v124, v152, v184
    v_mfma_f32_16x16x32_bf16 v[216:219], a[208:211], a[24:27], v[216:219]
    s_waitcnt lgkmcnt(2)
    v_mul_f32 v185, v185, v105
    v_mfma_f32_16x16x32_bf16 v[216:219], a[212:215], a[28:31], v[216:219]
    buffer_store_dwordx4 v[120:123], v25, s[16:19], s66 offen sc1
    v_mfma_f32_16x16x32_bf16 v[216:219], a[216:219], a[32:35], v[216:219]
    s_mov_b32 s66, 688128
    v_add_f32 v248, v248, v116
    v_mul_f32 v248, v248, v96
    v_mfma_f32_16x16x32_bf16 v[216:219], a[220:223], a[36:39], v[216:219]
    v_add_f32 v249, v249, v117
    v_mul_f32 v249, v249, v97
    v_mfma_f32_16x16x32_bf16 v[252:255], a[232:235], a[42:45], v[252:255]
    s_waitcnt lgkmcnt(0)
    v_cvt_pk_bf16_f32 v116, v248, v249
    v_mfma_f32_16x16x32_bf16 v[252:255], a[236:239], a[50:53], v[252:255]
    buffer_store_dwordx4 v[112:115], v25, s[16:19], s67 offen sc1
    v_mfma_f32_16x16x32_bf16 v[252:255], a[168:171], a[58:61], v[252:255]
    s_mov_b32 s67, 702464
    ds_write_b32 v28, v116 offset:0
    v_mul_f32 v186, v186, v106
    v_mfma_f32_16x16x32_bf16 v[252:255], a[172:175], a[66:69], v[252:255]
    v_cvt_pk_bf16_f32 v127, v154, v186
    v_mul_f32 v187, v187, v107
    v_mfma_f32_16x16x32_bf16 v[156:159], a[240:243], a[40:43], v[156:159]
    v_mul_f32 v216, v216, v108
    v_mul_f32 v217, v217, v109
    v_mfma_f32_16x16x32_bf16 v[156:159], a[244:247], a[44:47], v[156:159]
    v_mul_f32 v218, v218, v110
    v_mul_f32 v219, v219, v111
    v_mfma_f32_16x16x32_bf16 v[156:159], a[248:251], a[48:51], v[156:159]
    v_cvt_pk_bf16_f32 v125, v216, v153
    v_cvt_pk_bf16_f32 v126, v185, v217
    v_mfma_f32_16x16x32_bf16 v[156:159], a[252:255], a[52:55], v[156:159]
    ds_write_b64 v26, v[124:125] offset:0
    v_cvt_pk_bf16_f32 v92, v218, v155
    v_mfma_f32_16x16x32_bf16 v[156:159], a[176:179], a[56:59], v[156:159]
    ds_write_b64 v26, v[126:127] offset:8
    v_cvt_pk_bf16_f32 v93, v187, v219
    v_mfma_f32_16x16x32_bf16 v[156:159], a[180:183], a[60:63], v[156:159]
    s_waitcnt vmcnt(12)
    ds_write_b64 v26, v[92:93] offset:16
    v_xor_b32 v8, 15, v8
    v_mfma_f32_16x16x32_bf16 v[156:159], a[184:187], a[64:67], v[156:159]
    ds_write_b64 v29, v[254:255] offset:2048
    v_or_b32 v8, v8, v0
    v_mfma_f32_16x16x32_bf16 v[156:159], a[188:191], a[68:71], v[156:159]
    v_min_u32 v8, 1, v8
    v_lshlrev_b32 v8, 30, v8
    v_mfma_f32_16x16x32_bf16 v[188:191], a[136:139], a[40:43], v[188:191]
    v_mov_b32 v9, s76
    v_mfma_f32_16x16x32_bf16 v[188:191], a[140:143], a[44:47], v[188:191]
    buffer_store_dword v9, v8, s[12:15], s78 offen sc1
    v_mfma_f32_16x16x32_bf16 v[188:191], a[144:147], a[48:51], v[188:191]
    v_mfma_f32_16x16x32_bf16 v[188:191], a[148:151], a[52:55], v[188:191]
    s_waitcnt lgkmcnt(0)
    s_barrier
    v_mfma_f32_16x16x32_bf16 v[188:191], a[192:195], a[56:59], v[188:191]
    ds_read_b128 v[48:51], v24 offset:0
    ds_read_b64 v[88:89], v30 offset:2048
    v_mfma_f32_16x16x32_bf16 v[188:191], a[196:199], a[60:63], v[188:191]
    ds_read_b128 v[52:55], v24 offset:928
    v_mul_f32 v156, v156, v100
    v_mfma_f32_16x16x32_bf16 v[188:191], a[200:203], a[64:67], v[188:191]
    v_mul_f32 v157, v157, v101
    v_mul_f32 v158, v158, v102
    v_mfma_f32_16x16x32_bf16 v[188:191], a[204:207], a[68:71], v[188:191]
    v_mul_f32 v159, v159, v103
    v_mfma_f32_16x16x32_bf16 v[220:223], a[152:155], a[40:43], v[220:223]
    v_mfma_f32_16x16x32_bf16 v[220:223], a[156:159], a[44:47], v[220:223]
    v_mfma_f32_16x16x32_bf16 v[220:223], a[160:163], a[48:51], v[220:223]
    s_waitcnt lgkmcnt(1)
    v_mfma_f32_16x16x32_bf16 v[220:223], a[164:167], a[52:55], v[220:223]
    buffer_store_dwordx4 v[48:51], v25, s[16:19], s66 offen sc1
    v_mfma_f32_16x16x32_bf16 v[220:223], a[208:211], a[56:59], v[220:223]
    s_mov_b32 s66, 802816
    v_add_f32 v252, v252, v88
    v_mul_f32 v252, v252, v96
    v_mfma_f32_16x16x32_bf16 v[220:223], a[212:215], a[60:63], v[220:223]
    v_add_f32 v253, v253, v89
    v_mul_f32 v253, v253, v97
    v_mfma_f32_16x16x32_bf16 v[220:223], a[216:219], a[64:67], v[220:223]
    s_waitcnt lgkmcnt(0)
    v_cvt_pk_bf16_f32 v88, v252, v253
    v_mfma_f32_16x16x32_bf16 v[220:223], a[220:223], a[68:71], v[220:223]
    buffer_store_dwordx4 v[52:55], v25, s[16:19], s67 offen sc1
    s_mov_b32 s67, 817152
    ds_write_b32 v28, v88 offset:7424
    v_mul_f32 v188, v188, v104
    v_cvt_pk_bf16_f32 v72, v156, v188
    v_mul_f32 v189, v189, v105
    v_mul_f32 v190, v190, v106
    v_cvt_pk_bf16_f32 v75, v158, v190
    v_mul_f32 v191, v191, v107
    v_mul_f32 v220, v220, v108
    v_mul_f32 v221, v221, v109
    v_mul_f32 v222, v222, v110
    v_mul_f32 v223, v223, v111
    v_cvt_pk_bf16_f32 v73, v220, v157
    v_cvt_pk_bf16_f32 v74, v189, v221
    v_cvt_pk_bf16_f32 v80, v222, v159
    v_cvt_pk_bf16_f32 v81, v191, v223
    ds_write_b64 v26, v[72:73] offset:7424
    ds_write_b64 v26, v[74:75] offset:7432
    ds_write_b64 v26, v[80:81] offset:7440
    s_waitcnt lgkmcnt(0)
    s_barrier
    ds_read_b128 v[84:87], v24 offset:7424
    ds_read_b128 v[76:79], v24 offset:8352
    s_waitcnt lgkmcnt(1)
    buffer_store_dwordx4 v[84:87], v25, s[16:19], s66 offen sc1
    s_waitcnt lgkmcnt(0)
    buffer_store_dwordx4 v[76:79], v25, s[16:19], s67 offen sc1
L_end:
    s_endpgm
L_slow0_1:
    s_mov_b32 s22, 0
    s_call_b64 s[20:21], L_tick
    buffer_load_dwordx4 v[72:75], v34, s[12:15], 0 offen sc1
    buffer_load_dwordx4 v[76:79], v44, s[12:15], 0 offen sc1
    s_waitcnt vmcnt(0)
    v_bitop3_b32 v12, v75, v79, s76 bitop3:0x7e
    v_cmp_lt_u32 vcc, 0xffff, v12
    s_cbranch_vccnz L_slow0_1
    s_branch L_back0_1
L_slow1_0:
    s_mov_b32 s22, 1
    s_call_b64 s[20:21], L_tick
    buffer_load_dwordx4 v[80:83], v32, s[12:15], s40 offen sc1
    buffer_load_dwordx4 v[84:87], v33, s[12:15], s40 offen sc1
    s_waitcnt vmcnt(0)
    v_bitop3_b32 v12, v83, v87, s76 bitop3:0x7e
    v_cmp_lt_u32 vcc, 0xffff, v12
    s_cbranch_vccnz L_slow1_0
    s_branch L_back1_0
L_slow1_1:
    s_mov_b32 s22, 1
    s_call_b64 s[20:21], L_tick
    buffer_load_dwordx4 v[88:91], v34, s[12:15], s40 offen sc1
    buffer_load_dwordx4 v[92:95], v44, s[12:15], s40 offen sc1
    s_waitcnt vmcnt(0)
    v_bitop3_b32 v12, v91, v95, s76 bitop3:0x7e
    v_cmp_lt_u32 vcc, 0xffff, v12
    s_cbranch_vccnz L_slow1_1
    s_branch L_back1_1
L_slow2_0:
    s_mov_b32 s22, 2
    s_call_b64 s[20:21], L_tick
    buffer_load_dwordx4 v[48:51], v32, s[12:15], s41 offen sc1
    buffer_load_dwordx4 v[52:55], v33, s[12:15], s41 offen sc1
    s_waitcnt vmcnt(0)
    v_bitop3_b32 v12, v51, v55, s76 bitop3:0x7e
    v_cmp_lt_u32 vcc, 0xffff, v12
    s_cbranch_vccnz L_slow2_0
    s_branch L_back2_0
L_slow2_1:
    s_mov_b32 s22, 2
    s_call_b64 s[20:21], L_tick
    buffer_load_dwordx4 v[64:67], v34, s[12:15], s41 offen sc1
    buffer_load_dwordx4 v[68:71], v44, s[12:15], s41 offen sc1
    s_waitcnt vmcnt(0)
    v_bitop3_b32 v12, v67, v71, s76 bitop3:0x7e
    v_cmp_lt_u32 vcc, 0xffff, v12
    s_cbranch_vccnz L_slow2_1
    s_branch L_back2_1
L_slow3_0:
    s_mov_b32 s22, 3
    s_call_b64 s[20:21], L_tick
    buffer_load_dwordx4 v[72:75], v32, s[12:15], s42 offen sc1
    buffer_load_dwordx4 v[76:79], v33, s[12:15], s42 offen sc1
    s_waitcnt vmcnt(0)
    v_bitop3_b32 v12, v75, v79, s76 bitop3:0x7e
    v_cmp_lt_u32 vcc, 0xffff, v12
    s_cbranch_vccnz L_slow3_0
    s_branch L_back3_0
L_slow3_1:
    s_mov_b32 s22, 3
    s_call_b64 s[20:21], L_tick
    buffer_load_dwordx4 v[80:83], v34, s[12:15], s42 offen sc1
    buffer_load_dwordx4 v[84:87], v44, s[12:15], s42 offen sc1
    s_waitcnt vmcnt(0)
    v_bitop3_b32 v12, v83, v87, s76 bitop3:0x7e
    v_cmp_lt_u32 vcc, 0xffff, v12
    s_cbranch_vccnz L_slow3_1
    s_branch L_back3_1
L_slow4_0:
    s_mov_b32 s22, 4
    s_call_b64 s[20:21], L_tick
    buffer_load_dwordx4 v[96:99], v32, s[12:15], s43 offen sc1
    buffer_load_dwordx4 v[100:103], v33, s[12:15], s43 offen sc1
    s_waitcnt vmcnt(0)
    v_bitop3_b32 v12, v99, v103, s76 bitop3:0x7e
    v_cmp_lt_u32 vcc, 0xffff, v12
    s_cbranch_vccnz L_slow4_0
    s_branch L_back4_0
L_slow4_1:
    s_mov_b32 s22, 4
    s_call_b64 s[20:21], L_tick
    buffer_load_dwordx4 v[104:107], v34, s[12:15], s43 offen sc1
    buffer_load_dwordx4 v[108:111], v44, s[12:15], s43 offen sc1
    s_waitcnt vmcnt(0)
    v_bitop3_b32 v12, v107, v111, s76 bitop3:0x7e
    v_cmp_lt_u32 vcc, 0xffff, v12
    s_cbranch_vccnz L_slow4_1
    s_branch L_back4_1
L_slow5_0:
    s_mov_b32 s22, 5
    s_call_b64 s[20:21], L_tick
    buffer_load_dwordx4 v[112:115], v32, s[12:15], s44 offen sc1
    buffer_load_dwordx4 v[116:119], v33, s[12:15], s44 offen sc1
    s_waitcnt vmcnt(0)
    v_bitop3_b32 v12, v115, v119, s76 bitop3:0x7e
    v_cmp_lt_u32 vcc, 0xffff, v12
    s_cbranch_vccnz L_slow5_0
    s_branch L_back5_0
L_slow5_1:
    s_mov_b32 s22, 5
    s_call_b64 s[20:21], L_tick
    buffer_load_dwordx4 v[120:123], v34, s[12:15], s44 offen sc1
    buffer_load_dwordx4 v[124:127], v44, s[12:15], s44 offen sc1
    s_waitcnt vmcnt(0)
    v_bitop3_b32 v12, v123, v127, s76 bitop3:0x7e
    v_cmp_lt_u32 vcc, 0xffff, v12
    s_cbranch_vccnz L_slow5_1
    s_branch L_back5_1
L_slow6_0:
    s_mov_b32 s22, 6
    s_call_b64 s[20:21], L_tick
    buffer_load_dwordx4 v[88:91], v32, s[12:15], s45 offen sc1
    buffer_load_dwordx4 v[92:95], v33, s[12:15], s45 offen sc1
    s_waitcnt vmcnt(0)
    v_bitop3_b32 v12, v91, v95, s76 bitop3:0x7e
    v_cmp_lt_u32 vcc, 0xffff, v12
    s_cbranch_vccnz L_slow6_0
    s_branch L_back6_0
L_slow6_1:
    s_mov_b32 s22, 6
    s_call_b64 s[20:21], L_tick
    buffer_load_dwordx4 v[48:51], v34, s[12:15], s45 offen sc1
    buffer_load_dwordx4 v[52:55], v44, s[12:15], s45 offen sc1
    s_waitcnt vmcnt(0)
    v_bitop3_b32 v12, v51, v55, s76 bitop3:0x7e
    v_cmp_lt_u32 vcc, 0xffff, v12
    s_cbranch_vccnz L_slow6_1
    s_branch L_back6_1
L_slow7_0:
    s_mov_b32 s22, 7
    s_call_b64 s[20:21], L_tick
    buffer_load_dwordx4 v[72:75], v32, s[12:15], s72 offen sc1
    buffer_load_dwordx4 v[76:79], v33, s[12:15], s72 offen sc1
    s_waitcnt vmcnt(0)
    v_bitop3_b32 v12, v75, v79, s76 bitop3:0x7e
    v_cmp_lt_u32 vcc, 0xffff, v12
    s_cbranch_vccnz L_slow7_0
    s_branch L_back7_0
L_slow7_1:
    s_mov_b32 s22, 7
    s_call_b64 s[20:21], L_tick
    buffer_load_dwordx4 v[80:83], v34, s[12:15], s72 offen sc1
    buffer_load_dwordx4 v[84:87], v44, s[12:15], s72 offen sc1
    s_waitcnt vmcnt(0)
    v_bitop3_b32 v12, v83, v87, s76 bitop3:0x7e
    v_cmp_lt_u32 vcc, 0xffff, v12
    s_cbranch_vccnz L_slow7_1
    s_branch L_back7_1
L_tick:
    s_add_u32 s52, s52, 1
    s_and_b32 s23, s52, 4095
    s_cbranch_scc1 L_tick_ret
L_help:
    s_mov_b32 s53, s61
    s_mov_b32 s54, s62
    s_mul_i32 s61, s22, 1835008
    s_add_u32 s61, s61, s79
    s_lshl_b32 s62, s22, 14
    s_add_u32 s62, s62, s68
    s_mov_b32 s22, 0
L_help_row:
    v_mov_b32 v21, v19
    s_xor_b32 s23, s22, s58
    s_bitcmp0_b32 s23, 2
    s_cbranch_scc1 L_help_same
    v_add_u32 v12, 57344, v19
    v_subrev_u32 v13, 57344, v19
    v_min_u32 v21, v12, v13
L_help_same:
    v_mov_b32 v8, 0
    v_mov_b32 v9, 0
    v_mov_b32 v10, 0
    v_mov_b32 v11, s47
    s_mov_b32 s23, 0
L_help_e:
    v_mov_b32 v15, 0
    buffer_load_dwordx3 v[12:14], v18, s[4:7], s61 offen
    s_cmp_ge_u32 s23, 16
    s_cbranch_scc1 L_help_own
    buffer_load_dword v15, v21, s[4:7], s61 offen
L_help_own:
    s_waitcnt vmcnt(0)
    v_lshl_or_b32 v8, v12, s23, v8
    v_lshl_or_b32 v9, v13, s23, v9
    v_lshl_or_b32 v10, v14, s23, v10
    v_lshl_or_b32 v11, v15, s23, v11
    s_add_u32 s61, s61, 14336
    s_add_u32 s23, s23, 4
    s_cmp_lt_u32 s23, 32
    s_cbranch_scc1 L_help_e
    buffer_store_dwordx4 v[8:11], v20, s[12:15], s62 offen sc1
    s_add_u32 s62, s62, 1024
    s_waitcnt vmcnt(0)
    s_add_u32 s22, s22, 1
    s_cmp_lt_u32 s22, 16
    s_cbranch_scc1 L_help_row
    s_mov_b32 s61, s53
    s_mov_b32 s62, s54
L_tick_ret:
    s_setpc_b64 s[20:21]
L_code_end:

.section .rodata,"a"
.p2align 6
.amdhsa_kernel standalone__normalfloat_lut_af4__prompt_kernel
  .amdhsa_next_free_vgpr 512
  .amdhsa_next_free_sgpr 102
  .amdhsa_accum_offset 256
  .amdhsa_group_segment_fixed_size 0
  .amdhsa_kernarg_size 56
  .amdhsa_user_sgpr_count 2
  .amdhsa_user_sgpr_kernarg_segment_ptr 1
  .amdhsa_system_sgpr_workgroup_id_x 1
.end_amdhsa_kernel
```

```asm
; @launch grid=(256,1,1) block=(256,1,1) lds=163840
.amdgcn_target "amdgcn-amd-amdhsa--gfx950"
.text
.globl standalone__normalfloat_lut_af4__prompt_kernel
.p2align 8
.type standalone__normalfloat_lut_af4__prompt_kernel,@function
standalone__normalfloat_lut_af4__prompt_kernel:
    s_cmp_ge_u32 s2, 256
    s_cbranch_scc1 L_end
    s_load_dwordx2 s[4:5], s[0:1], 8
    s_load_dwordx2 s[12:13], s[0:1], 48
    s_load_dwordx2 s[8:9], s[0:1], 0
    s_load_dwordx2 s[28:29], s[0:1], 16
    s_getpc_b64 s[48:49]
    s_mov_b32 s50, L_code_end-standalone__normalfloat_lut_af4__prompt_kernel-256
    s_mov_b32 s51, 0x20000
    s_lshr_b32 s61, s2, 3
    v_lshl_add_u32 v10, v0, 5, s61
    v_lshlrev_b32 v10, 7, v10
    buffer_load_dword v1, v10, s[48:51], 0 offen offset:256
    v_lshrrev_b32 v5, 6, v0
    v_and_b32 v2, 63, v0
    s_and_b32 s60, s2, 7
    v_readfirstlane_b32 s63, v5
    s_and_b32 s58, s60, 1
    s_lshl_b32 s58, s58, 3
    s_and_b32 s62, s61, 7
    s_add_u32 s58, s58, s62
    s_lshr_b32 s59, s60, 1
    s_lshl_b32 s59, s59, 2
    s_lshr_b32 s62, s61, 3
    s_add_u32 s59, s59, s62
    v_mul_u32_u24 v18, 12, v2
    s_lshl_b32 s60, s63, 4
    s_add_u32 s60, s60, s58
    s_mul_i32 s61, s60, 114688
    s_mul_i32 s79, s59, 896
    s_add_u32 s61, s61, s79
    s_mov_b32 s6, 14680064
    s_mov_b32 s7, 0x20000
    s_lshl_b32 s78, s59, 7
    s_add_u32 s78, s78, 2097152
    v_and_b32 v4, 15, v2
    v_lshrrev_b32 v3, 4, v2
    v_and_b32 v12, 1, v3
    v_lshlrev_b32 v13, 1, v12
    v_xor_b32 v13, v13, v4
    v_lshrrev_b32 v19, 1, v3
    v_lshl_add_u32 v19, v19, 4, v13
    s_bfe_u32 s70, s58, 0x10002
    s_xor_b32 s70, s70, 1
    v_xor_b32 v12, s70, v12
    v_mul_u32_u24 v12, 14336, v12
    v_add_lshl_u32 v19, v19, v12, 2
    v_add_u32 v19, 768, v19
    s_mov_b32 s46, 2
    s_cmp_lg_u32 s63, 0
    s_cbranch_scc1 L_role0
    s_mov_b32 s46, 0
L_role0:
    s_cmp_lg_u32 s63, 1
    s_cbranch_scc1 L_role1
    s_mov_b32 s46, 1
L_role1:
    v_lshlrev_b32 v16, 1, v4
    v_lshrrev_b32 v17, 4, v0
    v_lshlrev_b32 v17, 1, v17
    s_mov_b32 s30, 32
    s_mov_b32 s31, 0x20000
    v_lshrrev_b32 v6, 3, v2
    v_and_b32 v7, 7, v2
    v_xor_b32 v13, v7, v3
    s_lshl_b32 s70, s63, 5
    v_add_lshl_u32 v12, v6, s70, 11
    v_lshl_add_u32 v36, v13, 4, v12
    v_xor_b32 v37, 64, v36
    v_add_u32 v38, 30720, v36
    v_add_u32 v37, 15360, v37
    v_add_u32 v39, 30720, v37
    s_mov_b32 s10, 4194304
    s_mov_b32 s11, 0x20000
    s_lshl_b32 s55, s58, 18
    s_and_b32 s71, s58, 8
    s_lshl_b32 s70, s71, 4
    s_add_u32 s55, s55, s70
    s_xor_b32 s69, s55, 128
    s_lshl_b32 s57, s63, 12
    s_add_u32 s57, s57, 65536
    s_mov_b32 s14, 2099200
    s_mov_b32 s15, 0x20000
    s_lshl_b32 s68, s59, 17
    s_lshl_b32 s62, s60, 10
    s_add_u32 s62, s62, s68
    v_lshlrev_b32 v20, 4, v2
    s_waitcnt lgkmcnt(0)
    s_load_dword s76, s[12:13], s78
    s_cmp_eq_u32 s46, 1
    s_cbranch_scc1 L_L
    s_cmp_eq_u32 s46, 2
    s_cbranch_scc1 L_L
L_X:
    buffer_load_dwordx3 v[128:130], v18, s[4:7], s61 offen
    buffer_load_dword v131, v19, s[4:7], s61 offen
    s_add_u32 s61, s61, 14336
    buffer_load_dwordx3 v[132:134], v18, s[4:7], s61 offen
    buffer_load_dword v135, v19, s[4:7], s61 offen
    s_add_u32 s61, s61, 14336
    buffer_load_dwordx3 v[136:138], v18, s[4:7], s61 offen
    buffer_load_dword v139, v19, s[4:7], s61 offen
    s_add_u32 s61, s61, 14336
    buffer_load_dwordx3 v[140:142], v18, s[4:7], s61 offen
    buffer_load_dword v143, v19, s[4:7], s61 offen
    s_add_u32 s61, s61, 14336
    buffer_load_dwordx3 v[144:146], v18, s[4:7], s61 offen
    s_add_u32 s61, s61, 14336
    buffer_load_dwordx3 v[148:150], v18, s[4:7], s61 offen
    s_add_u32 s61, s61, 14336
    buffer_load_dwordx3 v[152:154], v18, s[4:7], s61 offen
    s_add_u32 s61, s61, 14336
    buffer_load_dwordx3 v[156:158], v18, s[4:7], s61 offen
    s_add_u32 s61, s61, 7239680
    s_cmp_eq_u32 s46, 1
    s_cbranch_scc1 L_D
    s_cmp_eq_u32 s46, 2
    s_cbranch_scc1 L_B
L_L:
    buffer_load_ushort v16, v16, s[28:31], 0 offen
    buffer_load_ushort v17, v17, s[28:31], 0 offen
    s_cmp_eq_u32 s46, 1
    s_cbranch_scc1 L_S
    s_cmp_eq_u32 s46, 2
    s_cbranch_scc1 L_S
L_D:
    s_add_u32 m0, s57, 32768
    s_add_u32 s56, s55, 0
    buffer_load_dwordx4 v36, s[8:11], s56 offen offset:0 lds
    buffer_load_dwordx4 v37, s[8:11], s56 offen offset:1024 lds
    buffer_load_dwordx4 v38, s[8:11], s56 offen offset:2048 lds
    buffer_load_dwordx4 v39, s[8:11], s56 offen offset:3072 lds
    s_cmp_eq_u32 s46, 1
    s_cbranch_scc1 L_G
    s_cmp_eq_u32 s46, 2
    s_cbranch_scc1 L_G
L_S:
    s_load_dwordx2 s[32:33], s[0:1], 24
    s_load_dwordx2 s[16:17], s[0:1], 32
    s_load_dwordx2 s[24:25], s[0:1], 40
    s_and_b32 s64, s63, 1
    s_lshr_b32 s65, s63, 1
    s_and_b32 s70, s58, 8
    s_lshl_b32 s70, s70, 10
    s_lshl_b32 s71, s64, 12
    s_add_u32 s70, s70, s71
    s_lshl_b32 s71, s63, 8
    s_add_u32 s70, s70, s71
    s_add_u32 s70, s70, s68
    v_lshl_add_u32 v32, v4, 4, s70
    v_lshl_add_u32 v32, v3, 10, v32
    v_xor_b32 v33, 4096, v32
    v_xor_b32 v34, 8192, v32
    v_xor_b32 v44, 12288, v32
    s_mov_b32 s36, 202114048
    s_mov_b32 s37, 202114304
    s_mov_b32 s38, 202114560
    s_mov_b32 s39, 202114816
    v_and_b32 v35, 31, v2
    v_lshlrev_b32 v35, 2, v35
    s_lshl_b32 s70, s64, 6
    s_add_u32 s70, s70, 65536
    v_lshrrev_b32 v12, 1, v4
    v_xor_b32 v12, v12, v3
    v_lshlrev_b32 v12, 4, v12
    v_lshl_add_u32 v12, v4, 7, v12
    v_xor_b32 v40, s70, v12
    v_xor_b32 v41, 64, v40
    v_add_u32 v42, 65536, v40
    v_add_u32 v43, 65536, v41
    s_mov_b32 s52, 0
    v_lshlrev_b32 v8, 4, v7
    v_lshl_add_u32 v8, v0, 8, v8
    v_xor_b32 v9, 16, v8
    v_xor_b32 v10, 32, v8
    v_xor_b32 v11, 48, v8
    v_xor_b32 v12, 64, v8
    v_xor_b32 v13, 80, v8
    v_xor_b32 v14, 96, v8
    v_xor_b32 v15, 112, v8
    s_cmp_eq_u32 s46, 1
    s_cbranch_scc1 L_X
    s_cmp_eq_u32 s46, 2
    s_cbranch_scc1 L_D
L_G:
    s_waitcnt lgkmcnt(0)
    s_add_u32 s76, s76, 2654435769
    s_and_b32 s47, s76, 0xffff0000
    s_cmp_eq_u32 s46, 1
    s_cbranch_scc1 L_T
    s_cmp_eq_u32 s46, 2
    s_cbranch_scc1 L_T
L_K:
    s_waitcnt vmcnt(16)
    v_or_b32 v131, s47, v131
    s_waitcnt vmcnt(15)
    v_lshl_or_b32 v128, v132, 4, v128
    v_lshl_or_b32 v129, v133, 4, v129
    v_lshl_or_b32 v130, v134, 4, v130
    s_waitcnt vmcnt(14)
    v_lshl_or_b32 v131, v135, 4, v131
    s_waitcnt vmcnt(13)
    v_lshl_or_b32 v128, v136, 8, v128
    v_lshl_or_b32 v129, v137, 8, v129
    v_lshl_or_b32 v130, v138, 8, v130
    s_waitcnt vmcnt(12)
    v_lshl_or_b32 v131, v139, 8, v131
    s_waitcnt vmcnt(11)
    v_lshl_or_b32 v128, v140, 12, v128
    v_lshl_or_b32 v129, v141, 12, v129
    v_lshl_or_b32 v130, v142, 12, v130
    s_waitcnt vmcnt(10)
    v_lshl_or_b32 v131, v143, 12, v131
    s_waitcnt vmcnt(9)
    v_lshl_or_b32 v128, v144, 16, v128
    v_lshl_or_b32 v129, v145, 16, v129
    v_lshl_or_b32 v130, v146, 16, v130
    s_waitcnt vmcnt(8)
    v_lshl_or_b32 v128, v148, 20, v128
    v_lshl_or_b32 v129, v149, 20, v129
    v_lshl_or_b32 v130, v150, 20, v130
    s_waitcnt vmcnt(7)
    v_lshl_or_b32 v128, v152, 24, v128
    v_lshl_or_b32 v129, v153, 24, v129
    v_lshl_or_b32 v130, v154, 24, v130
    s_waitcnt vmcnt(6)
    v_lshl_or_b32 v128, v156, 28, v128
    v_lshl_or_b32 v129, v157, 28, v129
    v_lshl_or_b32 v130, v158, 28, v130
    buffer_store_dwordx4 v[128:131], v20, s[12:15], s62 offen sc1
    s_add_u32 s62, s62, 65536
    s_cmp_eq_u32 s46, 1
    s_cbranch_scc1 L_B
    s_cmp_eq_u32 s46, 2
    s_cbranch_scc1 L_E
L_T:
    s_waitcnt vmcnt(16)
    s_cmp_eq_u32 s46, 1
    s_cbranch_scc1 L_rw1
    s_waitcnt vmcnt(5)
    s_cmp_eq_u32 s46, 0
    s_cbranch_scc1 L_rw1
    s_waitcnt vmcnt(4)
L_rw1:
    v_lshl_or_b32 v56, v17, 16, v16
    v_lshl_or_b32 v57, v17, 16, v16
    v_lshl_or_b32 v58, v17, 16, v16
    v_lshl_or_b32 v59, v17, 16, v16
    ds_write_b128 v8, v[56:59]
    ds_write_b128 v9, v[56:59]
    ds_write_b128 v10, v[56:59]
    ds_write_b128 v11, v[56:59]
    ds_write_b128 v12, v[56:59]
    ds_write_b128 v13, v[56:59]
    ds_write_b128 v14, v[56:59]
    ds_write_b128 v15, v[56:59]
    s_cmp_lg_u32 s46, 1
    s_cbranch_scc1 L_ed2
    s_waitcnt vmcnt(4)
    s_branch L_K
L_ed2:
    s_cmp_eq_u32 s46, 2
    s_cbranch_scc1 L_X
L_W:
    s_mov_b64 exec, 0
    s_cmp_eq_u32 s63, 0
    s_cbranch_scc1 L_pad0
L_warmed:
    s_mov_b64 exec, -1
L_B:
    s_waitcnt vmcnt(12) lgkmcnt(0)
    s_cmp_eq_u32 s46, 2
    s_cbranch_scc1 L_rw3
    s_waitcnt vmcnt(1)
L_rw3:
    s_barrier
L_Q:
    ds_read_b128 a[0:3], v40 offset:32768
    ds_read_b128 a[4:7], v41 offset:32768
    ds_read_b128 a[8:11], v40 offset:34816
    ds_read_b128 a[12:15], v41 offset:34816
    ds_read_b128 a[16:19], v40 offset:36864
    ds_read_b128 a[20:23], v41 offset:36864
    ds_read_b128 a[24:27], v40 offset:38912
    ds_read_b128 a[28:31], v41 offset:38912
    ds_read_b128 a[32:35], v40 offset:40960
    ds_read_b128 a[36:39], v41 offset:40960
    ds_read_b128 a[40:43], v40 offset:43008
    ds_read_b128 a[44:47], v41 offset:43008
    ds_read_b128 a[48:51], v40 offset:45056
    ds_read_b128 a[52:55], v41 offset:45056
    ds_read_b128 a[56:59], v40 offset:47104
    ds_read_b128 a[60:63], v41 offset:47104
L_P:
    buffer_load_dwordx4 v[64:67], v32, s[12:15], 0 offen sc1
    buffer_load_dwordx4 v[68:71], v33, s[12:15], 0 offen sc1
L_d:
    s_add_u32 m0, s57, 49152
    s_add_u32 s3, s69, 0
    buffer_load_dwordx4 v36, s[8:11], s3 offen offset:0 lds
    buffer_load_dwordx4 v37, s[8:11], s3 offen offset:1024 lds
    buffer_load_dwordx4 v38, s[8:11], s3 offen offset:2048 lds
    buffer_load_dwordx4 v39, s[8:11], s3 offen offset:3072 lds
L_p:
    buffer_load_dwordx4 v[72:75], v34, s[12:15], 0 offen sc1
    buffer_load_dwordx4 v[76:79], v44, s[12:15], 0 offen sc1
    s_cmp_lg_u32 s46, 2
    s_cbranch_scc1 L_ed4
    s_waitcnt vmcnt(8)
    s_branch L_K
L_ed4:
L_E:
L_chk0:
    s_waitcnt vmcnt(7)
    s_cmp_eq_u32 s46, 2
    s_cbranch_scc1 L_rw5
    s_waitcnt vmcnt(6)
L_rw5:
    v_bitop3_b32 v12, v67, v71, s76 bitop3:0x7e
    v_cmp_lt_u32 vcc, 0xffff, v12
    s_cbranch_vccnz L_retry0
    v_perm_b32 v56, v64, v35, s36
    v_perm_b32 v57, v64, v35, s37
    v_perm_b32 v58, v64, v35, s38
    v_perm_b32 v59, v64, v35, s39
    v_perm_b32 v60, v68, v35, s36
    v_perm_b32 v61, v68, v35, s37
    v_perm_b32 v62, v68, v35, s38
    v_perm_b32 v63, v68, v35, s39
    ds_read_b32 a136, v56
    ds_read_b32 a137, v57
    ds_read_b32 a138, v58
    ds_read_b32 a139, v59
    ds_read_b32 a140, v60
    ds_read_b32 a141, v61
    ds_read_b32 a142, v62
    ds_read_b32 a143, v63
    v_perm_b32 v56, v65, v35, s36
    v_perm_b32 v57, v65, v35, s37
    v_perm_b32 v58, v65, v35, s38
    v_perm_b32 v59, v65, v35, s39
    v_perm_b32 v60, v69, v35, s36
    v_perm_b32 v61, v69, v35, s37
    ds_read_b32 a144, v56
    ds_read_b32 a145, v57
    ds_read_b32 a146, v58
    ds_read_b32 a147, v59
    s_cbranch_vccz L_main
L_retry0:
    s_add_u32 s52, s52, 1
    s_and_b32 s23, s52, 4095
    s_cbranch_scc1 L_retry0b
    s_mov_b32 s22, 0
    s_call_b64 s[20:21], L_help
L_retry0b:
    buffer_load_dwordx4 v[64:67], v32, s[12:15], 0 offen sc1
    buffer_load_dwordx4 v[68:71], v33, s[12:15], 0 offen sc1
    buffer_load_dwordx4 v[72:75], v34, s[12:15], 0 offen sc1
    buffer_load_dwordx4 v[76:79], v44, s[12:15], 0 offen sc1
    s_waitcnt vmcnt(0) lgkmcnt(0)
    s_branch L_chk0
.p2align 12
L_main:
L_pad0:
    s_cbranch_execz L_pad1
    s_waitcnt lgkmcnt(8)
    v_mfma_f32_16x16x32_bf16 v[128:131], a[136:139], a[0:3], 0
    s_waitcnt lgkmcnt(4)
    s_mov_b32 s40, 16384
    ds_read_b32 a148, v60
    v_mfma_f32_16x16x32_bf16 v[128:131], a[140:143], a[4:7], v[128:131]
    buffer_load_dwordx4 v[80:83], v32, s[12:15], s40 offen sc1
    v_mfma_f32_16x16x32_bf16 v[132:135], a[136:139], a[8:11], 0
    s_add_u32 m0, s57, 65536
    ds_read_b32 a149, v61
    v_perm_b32 v62, v69, v35, s38
    v_mfma_f32_16x16x32_bf16 v[132:135], a[140:143], a[12:15], v[132:135]
    s_add_u32 s56, s55, 256
    ds_read_b32 a150, v62
    v_perm_b32 v63, v69, v35, s39
    v_mfma_f32_16x16x32_bf16 v[136:139], a[136:139], a[16:19], 0
    s_add_u32 s3, s69, 256
    ds_read_b32 a151, v63
    v_mfma_f32_16x16x32_bf16 v[136:139], a[140:143], a[20:23], v[136:139]
    buffer_load_dwordx4 v[84:87], v33, s[12:15], s40 offen sc1
    v_mfma_f32_16x16x32_bf16 v[140:143], a[136:139], a[24:27], 0
    v_perm_b32 v56, v66, v35, s36
    v_perm_b32 v57, v66, v35, s37
    v_mfma_f32_16x16x32_bf16 v[140:143], a[140:143], a[28:31], v[140:143]
    ds_read_b32 a152, v56
    v_perm_b32 v58, v66, v35, s38
    v_mfma_f32_16x16x32_bf16 v[144:147], a[136:139], a[32:35], 0
    ds_read_b32 a153, v57
    v_mfma_f32_16x16x32_bf16 v[144:147], a[140:143], a[36:39], v[144:147]
    buffer_load_dwordx4 v36, s[8:11], s56 offen offset:0 lds
    v_mfma_f32_16x16x32_bf16 v[148:151], a[136:139], a[40:43], 0
    ds_read_b32 a154, v58
    v_perm_b32 v59, v66, v35, s39
    v_mfma_f32_16x16x32_bf16 v[148:151], a[140:143], a[44:47], v[148:151]
    ds_read_b32 a155, v59
    v_perm_b32 v60, v70, v35, s36
    v_mfma_f32_16x16x32_bf16 v[152:155], a[136:139], a[48:51], 0
    s_mov_b32 s41, 32768
    ds_read_b32 a156, v60
    v_mfma_f32_16x16x32_bf16 v[152:155], a[140:143], a[52:55], v[152:155]
    buffer_load_dwordx4 v37, s[8:11], s56 offen offset:1024 lds
    v_mfma_f32_16x16x32_bf16 v[156:159], a[136:139], a[56:59], 0
    s_waitcnt vmcnt(4)
    v_bitop3_b32 v61, v75, v79, s76 bitop3:0x7e
    v_perm_b32 v62, v70, v35, s37
    v_mfma_f32_16x16x32_bf16 v[156:159], a[140:143], a[60:63], v[156:159]
    s_waitcnt lgkmcnt(5)
    v_cmp_lt_u32 vcc, 0xffff, v61
    v_perm_b32 v63, v70, v35, s38
    v_mfma_f32_16x16x32_bf16 v[160:163], a[144:147], a[0:3], 0
    ds_read_b32 a157, v62
    ds_read_b32 a158, v63
    v_mfma_f32_16x16x32_bf16 v[160:163], a[148:151], a[4:7], v[160:163]
    buffer_load_dwordx4 v38, s[8:11], s56 offen offset:2048 lds
    v_mfma_f32_16x16x32_bf16 v[164:167], a[144:147], a[8:11], 0
    v_perm_b32 v56, v70, v35, s39
    s_cbranch_vccnz L_slow0_1
L_back0_1:
    v_mfma_f32_16x16x32_bf16 v[164:167], a[148:151], a[12:15], v[164:167]
    v_perm_b32 v57, v67, v35, s36
    v_perm_b32 v58, v67, v35, s37
    v_mfma_f32_16x16x32_bf16 v[168:171], a[144:147], a[16:19], 0
    ds_read_b32 a159, v56
    ds_read_b32 a160, v57
    v_mfma_f32_16x16x32_bf16 v[168:171], a[148:151], a[20:23], v[168:171]
    buffer_load_dwordx4 v39, s[8:11], s56 offen offset:3072 lds
    v_mfma_f32_16x16x32_bf16 v[172:175], a[144:147], a[24:27], 0
    s_add_u32 m0, s57, 81920
    ds_read_b32 a161, v58
    v_perm_b32 v59, v71, v35, s36
    v_mfma_f32_16x16x32_bf16 v[172:175], a[148:151], a[28:31], v[172:175]
    s_add_u32 s56, s55, 512
    v_perm_b32 v60, v71, v35, s37
    v_perm_b32 v61, v72, v35, s36
    v_mfma_f32_16x16x32_bf16 v[176:179], a[144:147], a[32:35], 0
    s_mov_b32 s42, 49152
    ds_read_b32 a162, v59
    ds_read_b32 a163, v60
    v_mfma_f32_16x16x32_bf16 v[176:179], a[148:151], a[36:39], v[176:179]
    buffer_load_dwordx4 v[88:91], v34, s[12:15], s40 offen sc1
    v_mfma_f32_16x16x32_bf16 v[180:183], a[144:147], a[40:43], 0
    ds_read_b32 a164, v61
    v_perm_b32 v62, v72, v35, s37
    v_mfma_f32_16x16x32_bf16 v[180:183], a[148:151], a[44:47], v[180:183]
    v_perm_b32 v63, v72, v35, s38
    v_perm_b32 v56, v72, v35, s39
    v_mfma_f32_16x16x32_bf16 v[184:187], a[144:147], a[48:51], 0
    s_barrier
    v_mfma_f32_16x16x32_bf16 v[184:187], a[148:151], a[52:55], v[184:187]
    buffer_load_dwordx4 v[92:95], v44, s[12:15], s40 offen sc1
    v_mfma_f32_16x16x32_bf16 v[188:191], a[144:147], a[56:59], 0
    ds_read_b32 a165, v62
    ds_read_b32 a166, v63
    v_mfma_f32_16x16x32_bf16 v[188:191], a[148:151], a[60:63], v[188:191]
    s_waitcnt lgkmcnt(5)
    ds_read_b32 a167, v56
    v_perm_b32 v57, v76, v35, s36
    v_mfma_f32_16x16x32_bf16 v[192:195], a[152:155], a[0:3], 0
    ds_read_b32 a168, v57
    ds_read_b128 a[64:67], v40 offset:49152
    v_mfma_f32_16x16x32_bf16 v[192:195], a[156:159], a[4:7], v[192:195]
    buffer_load_dwordx4 v36, s[8:11], s3 offen offset:0 lds
    v_mfma_f32_16x16x32_bf16 v[196:199], a[152:155], a[8:11], 0
    ds_read_b128 a[68:71], v41 offset:49152
    v_perm_b32 v58, v76, v35, s37
    v_mfma_f32_16x16x32_bf16 v[196:199], a[156:159], a[12:15], v[196:199]
    ds_read_b32 a169, v58
    v_perm_b32 v59, v76, v35, s38
    v_mfma_f32_16x16x32_bf16 v[200:203], a[152:155], a[16:19], 0
    s_mov_b32 s43, 65536
    ds_read_b32 a170, v59
    ds_read_b128 a[72:75], v40 offset:51200
    v_mfma_f32_16x16x32_bf16 v[200:203], a[156:159], a[20:23], v[200:203]
    buffer_load_dwordx4 v37, s[8:11], s3 offen offset:1024 lds
    v_mfma_f32_16x16x32_bf16 v[204:207], a[152:155], a[24:27], 0
    ds_read_b128 a[76:79], v41 offset:51200
    v_perm_b32 v60, v76, v35, s39
    v_mfma_f32_16x16x32_bf16 v[204:207], a[156:159], a[28:31], v[204:207]
    ds_read_b32 a171, v60
    v_perm_b32 v61, v73, v35, s36
    v_mfma_f32_16x16x32_bf16 v[208:211], a[152:155], a[32:35], 0
    ds_read_b32 a172, v61
    ds_read_b128 a[80:83], v40 offset:53248
    v_mfma_f32_16x16x32_bf16 v[208:211], a[156:159], a[36:39], v[208:211]
    buffer_load_dwordx4 v38, s[8:11], s3 offen offset:2048 lds
    v_mfma_f32_16x16x32_bf16 v[212:215], a[152:155], a[40:43], 0
    ds_read_b128 a[84:87], v41 offset:53248
    v_perm_b32 v62, v73, v35, s37
    v_mfma_f32_16x16x32_bf16 v[212:215], a[156:159], a[44:47], v[212:215]
    ds_read_b32 a173, v62
    ds_read_b128 a[88:91], v40 offset:55296
    v_mfma_f32_16x16x32_bf16 v[216:219], a[152:155], a[48:51], 0
    ds_read_b128 a[92:95], v41 offset:55296
    v_perm_b32 v63, v73, v35, s38
    v_mfma_f32_16x16x32_bf16 v[216:219], a[156:159], a[52:55], v[216:219]
    ds_read_b32 a174, v63
    ds_read_b128 a[96:99], v40 offset:57344
    v_mfma_f32_16x16x32_bf16 v[220:223], a[152:155], a[56:59], 0
    v_perm_b32 v56, v73, v35, s39
    v_perm_b32 v57, v77, v35, s36
    v_mfma_f32_16x16x32_bf16 v[220:223], a[156:159], a[60:63], v[220:223]
    s_waitcnt lgkmcnt(9)
    ds_read_b32 a175, v56
    ds_read_b32 a176, v57
    v_mfma_f32_16x16x32_bf16 v[224:227], a[160:163], a[2:5], 0
    buffer_load_dwordx4 v39, s[8:11], s3 offen offset:3072 lds
    v_mfma_f32_16x16x32_bf16 v[228:231], a[160:163], a[10:13], 0
    s_add_u32 m0, s57, 0
    ds_read_b128 a[100:103], v41 offset:57344
    v_perm_b32 v58, v77, v35, s37
    v_mfma_f32_16x16x32_bf16 v[232:235], a[160:163], a[18:21], 0
    s_add_u32 s3, s69, 512
    ds_read_b32 a177, v58
    ds_read_b128 a[104:107], v40 offset:59392
    v_mfma_f32_16x16x32_bf16 v[236:239], a[160:163], a[26:29], 0
    s_mov_b32 s44, 81920
    v_perm_b32 v59, v77, v35, s38
    v_perm_b32 v60, v77, v35, s39
    v_mfma_f32_16x16x32_bf16 v[240:243], a[160:163], a[34:37], 0
    ds_read_b32 a178, v59
    ds_read_b32 a179, v60
    v_mfma_f32_16x16x32_bf16 v[244:247], a[160:163], a[42:45], 0
    buffer_load_dwordx3 v[96:98], v18, s[4:7], s61 offen
    v_mfma_f32_16x16x32_bf16 v[248:251], a[160:163], a[50:53], 0
    ds_read_b128 a[108:111], v41 offset:59392
    v_perm_b32 v61, v74, v35, s36
    v_mfma_f32_16x16x32_bf16 v[252:255], a[160:163], a[58:61], 0
    ds_read_b32 a180, v61
    v_perm_b32 v62, v74, v35, s37
    v_mfma_f32_16x16x32_bf16 v[128:131], a[164:167], a[64:67], v[128:131]
    s_waitcnt vmcnt(11) lgkmcnt(7)
    ds_read_b128 a[112:115], v40 offset:61440
    ds_read_b32 a181, v62
    v_mfma_f32_16x16x32_bf16 v[128:131], a[168:171], a[68:71], v[128:131]
    buffer_load_dword v99, v19, s[4:7], s61 offen
    v_mfma_f32_16x16x32_bf16 v[132:135], a[164:167], a[72:75], v[132:135]
    s_add_u32 s61, s61, 14336
    ds_read_b128 a[116:119], v41 offset:61440
    v_bitop3_b32 v63, v83, v87, s76 bitop3:0x7e
    v_mfma_f32_16x16x32_bf16 v[132:135], a[168:171], a[76:79], v[132:135]
    v_cmp_lt_u32 vcc, 0xffff, v63
    v_perm_b32 v56, v74, v35, s38
    v_mfma_f32_16x16x32_bf16 v[136:139], a[164:167], a[80:83], v[136:139]
    s_mov_b32 s45, 98304
    ds_read_b128 a[120:123], v40 offset:63488
    ds_read_b32 a182, v56
    v_mfma_f32_16x16x32_bf16 v[136:139], a[168:171], a[84:87], v[136:139]
    buffer_load_dwordx3 v[100:102], v18, s[4:7], s61 offen
    v_mfma_f32_16x16x32_bf16 v[140:143], a[164:167], a[88:91], v[140:143]
    ds_read_b128 a[124:127], v41 offset:63488
    s_cbranch_vccnz L_slow1_0
L_back1_0:
    v_mfma_f32_16x16x32_bf16 v[140:143], a[168:171], a[92:95], v[140:143]
    v_perm_b32 v57, v74, v35, s39
    v_perm_b32 v58, v78, v35, s36
    v_mfma_f32_16x16x32_bf16 v[144:147], a[164:167], a[96:99], v[144:147]
    s_waitcnt lgkmcnt(6)
    ds_read_b32 a183, v57
    ds_read_b32 a184, v58
    v_mfma_f32_16x16x32_bf16 v[144:147], a[168:171], a[100:103], v[144:147]
    buffer_load_dword v103, v19, s[4:7], s61 offen
    v_mfma_f32_16x16x32_bf16 v[148:151], a[164:167], a[104:107], v[148:151]
    s_add_u32 s61, s61, 14336
    v_perm_b32 v59, v78, v35, s37
    v_perm_b32 v60, v78, v35, s38
    v_mfma_f32_16x16x32_bf16 v[148:151], a[168:171], a[108:111], v[148:151]
    s_waitcnt lgkmcnt(5)
    ds_read_b32 a185, v59
    v_perm_b32 v61, v78, v35, s39
    v_mfma_f32_16x16x32_bf16 v[152:155], a[164:167], a[112:115], v[152:155]
    s_waitcnt lgkmcnt(5)
    ds_read_b32 a186, v60
    ds_read_b32 a187, v61
    v_mfma_f32_16x16x32_bf16 v[152:155], a[168:171], a[116:119], v[152:155]
    buffer_load_dwordx3 v[104:106], v18, s[4:7], s61 offen
    v_mfma_f32_16x16x32_bf16 v[156:159], a[164:167], a[120:123], v[156:159]
    s_waitcnt lgkmcnt(5)
    v_perm_b32 v62, v75, v35, s36
    v_perm_b32 v63, v75, v35, s37
    v_mfma_f32_16x16x32_bf16 v[156:159], a[168:171], a[124:127], v[156:159]
    ds_read_b32 a188, v62
    v_perm_b32 v56, v79, v35, s36
    v_mfma_f32_16x16x32_bf16 v[160:163], a[172:175], a[64:67], v[160:163]
    s_mov_b32 s72, 114688
    ds_read_b32 a189, v63
    ds_read_b32 a190, v56
    v_mfma_f32_16x16x32_bf16 v[160:163], a[176:179], a[68:71], v[160:163]
    buffer_load_dword v107, v19, s[4:7], s61 offen
    v_mfma_f32_16x16x32_bf16 v[164:167], a[172:175], a[72:75], v[164:167]
    s_add_u32 s61, s61, 14336
    v_perm_b32 v57, v79, v35, s37
    v_perm_b32 v58, v80, v35, s36
    v_mfma_f32_16x16x32_bf16 v[164:167], a[176:179], a[76:79], v[164:167]
    ds_read_b32 a191, v57
    v_perm_b32 v59, v80, v35, s37
    v_mfma_f32_16x16x32_bf16 v[168:171], a[172:175], a[80:83], v[168:171]
    ds_read_b32 a192, v58
    ds_read_b32 a193, v59
    v_mfma_f32_16x16x32_bf16 v[168:171], a[176:179], a[84:87], v[168:171]
    buffer_load_dwordx3 v[108:110], v18, s[4:7], s61 offen
    v_mfma_f32_16x16x32_bf16 v[172:175], a[172:175], a[88:91], v[172:175]
    v_perm_b32 v60, v80, v35, s38
    v_perm_b32 v61, v80, v35, s39
    v_mfma_f32_16x16x32_bf16 v[172:175], a[176:179], a[92:95], v[172:175]
    ds_read_b32 a194, v60
    v_perm_b32 v62, v84, v35, s36
    v_mfma_f32_16x16x32_bf16 v[176:179], a[172:175], a[96:99], v[176:179]
    ds_read_b32 a195, v61
    ds_read_b32 a196, v62
    v_mfma_f32_16x16x32_bf16 v[176:179], a[176:179], a[100:103], v[176:179]
    buffer_load_dword v111, v19, s[4:7], s61 offen
    v_mfma_f32_16x16x32_bf16 v[180:183], a[172:175], a[104:107], v[180:183]
    s_add_u32 s61, s61, 14336
    v_perm_b32 v63, v84, v35, s37
    v_perm_b32 v56, v84, v35, s38
    v_mfma_f32_16x16x32_bf16 v[180:183], a[176:179], a[108:111], v[180:183]
    ds_read_b32 a197, v63
    v_perm_b32 v57, v84, v35, s39
    v_mfma_f32_16x16x32_bf16 v[184:187], a[172:175], a[112:115], v[184:187]
    ds_read_b32 a198, v56
    ds_read_b32 a199, v57
    v_mfma_f32_16x16x32_bf16 v[184:187], a[176:179], a[116:119], v[184:187]
    buffer_load_dwordx3 v[112:114], v18, s[4:7], s61 offen
    v_mfma_f32_16x16x32_bf16 v[188:191], a[172:175], a[120:123], v[188:191]
    s_add_u32 s61, s61, 14336
    v_perm_b32 v58, v81, v35, s36
    v_perm_b32 v59, v81, v35, s37
    v_mfma_f32_16x16x32_bf16 v[188:191], a[176:179], a[124:127], v[188:191]
    s_waitcnt vmcnt(15) lgkmcnt(6)
    ds_read_b32 a200, v58
    v_perm_b32 v60, v81, v35, s38
    v_mfma_f32_16x16x32_bf16 v[192:195], a[180:183], a[64:67], v[192:195]
    s_barrier
    v_mfma_f32_16x16x32_bf16 v[192:195], a[184:187], a[68:71], v[192:195]
    buffer_load_dwordx3 v[116:118], v18, s[4:7], s61 offen
    v_mfma_f32_16x16x32_bf16 v[196:199], a[180:183], a[72:75], v[196:199]
    s_add_u32 s61, s61, 14336
    ds_read_b128 a[128:131], v42 offset:0
    ds_read_b32 a201, v59
    v_mfma_f32_16x16x32_bf16 v[196:199], a[184:187], a[76:79], v[196:199]
    ds_read_b128 a[132:135], v43 offset:0
    ds_read_b32 a202, v60
    v_mfma_f32_16x16x32_bf16 v[200:203], a[180:183], a[80:83], v[200:203]
    ds_read_b128 a[0:3], v42 offset:2048
    v_perm_b32 v61, v81, v35, s39
    v_mfma_f32_16x16x32_bf16 v[200:203], a[184:187], a[84:87], v[200:203]
    ds_read_b128 a[4:7], v43 offset:2048
    ds_read_b32 a203, v61
    v_mfma_f32_16x16x32_bf16 v[204:207], a[180:183], a[88:91], v[204:207]
    buffer_load_dwordx3 v[120:122], v18, s[4:7], s61 offen
    v_mfma_f32_16x16x32_bf16 v[204:207], a[184:187], a[92:95], v[204:207]
    s_add_u32 s61, s61, 14336
    ds_read_b128 a[8:11], v42 offset:4096
    v_perm_b32 v62, v85, v35, s36
    v_mfma_f32_16x16x32_bf16 v[208:211], a[180:183], a[96:99], v[208:211]
    ds_read_b128 a[12:15], v43 offset:4096
    ds_read_b32 a204, v62
    v_mfma_f32_16x16x32_bf16 v[208:211], a[184:187], a[100:103], v[208:211]
    ds_read_b128 a[16:19], v42 offset:6144
    v_perm_b32 v63, v85, v35, s37
    v_mfma_f32_16x16x32_bf16 v[212:215], a[180:183], a[104:107], v[212:215]
    ds_read_b128 a[20:23], v43 offset:6144
    ds_read_b32 a205, v63
    v_mfma_f32_16x16x32_bf16 v[212:215], a[184:187], a[108:111], v[212:215]
    buffer_load_dwordx3 v[124:126], v18, s[4:7], s61 offen
    v_mfma_f32_16x16x32_bf16 v[216:219], a[180:183], a[112:115], v[216:219]
    s_waitcnt vmcnt(16)
    ds_read_b128 a[24:27], v42 offset:8192
    v_bitop3_b32 v56, v91, v95, s76 bitop3:0x7e
    v_mfma_f32_16x16x32_bf16 v[216:219], a[184:187], a[116:119], v[216:219]
    ds_read_b128 a[28:31], v43 offset:8192
    v_cmp_lt_u32 vcc, 0xffff, v56
    v_mfma_f32_16x16x32_bf16 v[220:223], a[180:183], a[120:123], v[220:223]
    ds_read_b128 a[32:35], v42 offset:10240
    v_perm_b32 v57, v85, v35, s38
    v_mfma_f32_16x16x32_bf16 v[220:223], a[184:187], a[124:127], v[220:223]
    ds_read_b128 a[36:39], v43 offset:10240
    ds_read_b32 a206, v57
    v_mfma_f32_16x16x32_bf16 v[224:227], a[188:191], a[66:69], v[224:227]
    buffer_load_dwordx4 v[48:51], v32, s[12:15], s41 offen sc1
    v_mfma_f32_16x16x32_bf16 v[228:231], a[188:191], a[74:77], v[228:231]
    ds_read_b128 a[40:43], v42 offset:12288
    s_cbranch_vccnz L_slow1_1
L_back1_1:
    v_mfma_f32_16x16x32_bf16 v[232:235], a[188:191], a[82:85], v[232:235]
    ds_read_b128 a[44:47], v43 offset:12288
    v_perm_b32 v58, v85, v35, s39
    v_mfma_f32_16x16x32_bf16 v[236:239], a[188:191], a[90:93], v[236:239]
    ds_read_b32 a207, v58
    v_perm_b32 v59, v82, v35, s36
    v_mfma_f32_16x16x32_bf16 v[240:243], a[188:191], a[98:101], v[240:243]
    ds_read_b32 a208, v59
    ds_read_b128 a[48:51], v42 offset:14336
    v_mfma_f32_16x16x32_bf16 v[244:247], a[188:191], a[106:109], v[244:247]
    buffer_load_dwordx4 v[52:55], v33, s[12:15], s41 offen sc1
    v_mfma_f32_16x16x32_bf16 v[248:251], a[188:191], a[114:117], v[248:251]
    ds_read_b128 a[52:55], v43 offset:14336
    v_perm_b32 v60, v82, v35, s37
    v_mfma_f32_16x16x32_bf16 v[252:255], a[188:191], a[122:125], v[252:255]
    s_waitcnt lgkmcnt(8)
    ds_read_b32 a209, v60
    v_perm_b32 v61, v82, v35, s38
    v_mfma_f32_16x16x32_bf16 v[128:131], a[192:195], a[128:131], v[128:131]
    ds_read_b32 a210, v61
    v_perm_b32 v62, v82, v35, s39
    v_mfma_f32_16x16x32_bf16 v[128:131], a[196:199], a[132:135], v[128:131]
    ds_read_b32 a211, v62
    v_perm_b32 v63, v86, v35, s36
    v_mfma_f32_16x16x32_bf16 v[132:135], a[192:195], a[0:3], v[132:135]
    v_perm_b32 v56, v86, v35, s37
    v_perm_b32 v57, v86, v35, s38
    v_mfma_f32_16x16x32_bf16 v[132:135], a[196:199], a[4:7], v[132:135]
    s_mul_i32 s66, s63, 96
    s_lshl_b32 s67, s65, 5
    s_lshl_b32 s70, s64, 2
    s_add_u32 s67, s67, s70
    s_add_u32 s67, s67, 384
    s_mul_i32 s71, s59, 448
    s_add_u32 s70, s66, s71
    v_mad_u32_u24 v22, v3, 24, s70
    s_add_u32 s70, s67, s71
    v_lshl_add_u32 v23, v3, 3, s70
    s_mov_b32 s34, 7168
    s_mov_b32 s35, 0x20000
    s_mov_b32 s26, 256
    s_mov_b32 s27, 0x20000
    s_lshl_b32 s77, s59, 4
    s_mov_b32 s18, 14680064
    s_mov_b32 s19, 0x20000
    s_sub_u32 s70, 1024, s71
    v_mul_u32_u24 v16, 464, v4
    v_add3_u32 v26, v22, v16, s70
    v_add3_u32 v28, v23, v16, s70
    v_lshlrev_b32 v29, 3, v0
    v_xor_b32 v30, 512, v29
    v_add_u32 v29, 73728, v29
    v_add_u32 v30, 73728, v30
    v_mul_u32_u24 v16, 2341, v2
    v_lshrrev_b32 v16, 16, v16
    s_mul_i32 s73, s63, 1856
    s_add_u32 s73, s73, 1024
    v_add_lshl_u32 v24, v2, v16, 4
    v_add_u32 v24, s73, v24
    s_lshl_b32 s74, s58, 7
    s_lshl_b32 s75, s63, 2
    s_add_u32 s74, s74, s75
    s_mul_i32 s74, s74, 7168
    s_add_u32 s74, s74, s71
    v_mul_u32_u24 v17, 6720, v16
    v_lshl_add_u32 v25, v2, 4, v17
    v_lshrrev_b32 v16, 1, v16
    v_lshlrev_b32 v16, 30, v16
    v_add3_u32 v25, v25, v16, s74
    v_mfma_f32_16x16x32_bf16 v[136:139], a[192:195], a[8:11], v[136:139]
    buffer_load_dwordx4 v36, s[8:11], s56 offen offset:0 lds
    v_mfma_f32_16x16x32_bf16 v[136:139], a[196:199], a[12:15], v[136:139]
    ds_read_b32 a212, v63
    ds_read_b32 a213, v56
    v_mfma_f32_16x16x32_bf16 v[140:143], a[192:195], a[16:19], v[140:143]
    ds_read_b32 a214, v57
    v_perm_b32 v58, v86, v35, s39
    v_perm_b32 v59, v83, v35, s36
    v_mfma_f32_16x16x32_bf16 v[140:143], a[196:199], a[20:23], v[140:143]
    ds_read_b32 a215, v58
    ds_read_b32 a216, v59
    v_mfma_f32_16x16x32_bf16 v[144:147], a[192:195], a[24:27], v[144:147]
    buffer_load_dwordx4 v37, s[8:11], s56 offen offset:1024 lds
    v_mfma_f32_16x16x32_bf16 v[144:147], a[196:199], a[28:31], v[144:147]
    v_perm_b32 v60, v83, v35, s37
    v_perm_b32 v61, v87, v35, s36
    v_mfma_f32_16x16x32_bf16 v[148:151], a[192:195], a[32:35], v[148:151]
    s_waitcnt lgkmcnt(5)
    ds_read_b32 a217, v60
    v_perm_b32 v62, v87, v35, s37
    v_mfma_f32_16x16x32_bf16 v[148:151], a[196:199], a[36:39], v[148:151]
    ds_read_b32 a218, v61
    ds_read_b32 a219, v62
    v_mfma_f32_16x16x32_bf16 v[152:155], a[192:195], a[40:43], v[152:155]
    buffer_load_dwordx4 v38, s[8:11], s56 offen offset:2048 lds
    v_mfma_f32_16x16x32_bf16 v[152:155], a[196:199], a[44:47], v[152:155]
    v_perm_b32 v63, v88, v35, s36
    v_perm_b32 v56, v88, v35, s37
    v_mfma_f32_16x16x32_bf16 v[156:159], a[192:195], a[48:51], v[156:159]
    ds_read_b32 a220, v63
    v_perm_b32 v57, v88, v35, s38
    v_mfma_f32_16x16x32_bf16 v[156:159], a[196:199], a[52:55], v[156:159]
    ds_read_b32 a221, v56
    ds_read_b32 a222, v57
    v_mfma_f32_16x16x32_bf16 v[160:163], a[200:203], a[128:131], v[160:163]
    buffer_load_dwordx4 v39, s[8:11], s56 offen offset:3072 lds
    v_mfma_f32_16x16x32_bf16 v[160:163], a[204:207], a[132:135], v[160:163]
    s_add_u32 m0, s57, 16384
    v_perm_b32 v58, v88, v35, s39
    v_perm_b32 v59, v92, v35, s36
    v_mfma_f32_16x16x32_bf16 v[164:167], a[200:203], a[0:3], v[164:167]
    s_add_u32 s56, s55, 768
    ds_read_b32 a223, v58
    v_perm_b32 v60, v92, v35, s37
    v_mfma_f32_16x16x32_bf16 v[164:167], a[204:207], a[4:7], v[164:167]
    ds_read_b32 a224, v59
    ds_read_b32 a225, v60
    v_mfma_f32_16x16x32_bf16 v[168:171], a[200:203], a[8:11], v[168:171]
    buffer_load_dwordx4 v[64:67], v34, s[12:15], s41 offen sc1
    v_mfma_f32_16x16x32_bf16 v[168:171], a[204:207], a[12:15], v[168:171]
    v_perm_b32 v61, v92, v35, s38
    v_perm_b32 v62, v92, v35, s39
    v_mfma_f32_16x16x32_bf16 v[172:175], a[200:203], a[16:19], v[172:175]
    ds_read_b32 a226, v61
    v_perm_b32 v63, v89, v35, s36
    v_mfma_f32_16x16x32_bf16 v[172:175], a[204:207], a[20:23], v[172:175]
    ds_read_b32 a227, v62
    ds_read_b32 a228, v63
    v_mfma_f32_16x16x32_bf16 v[176:179], a[200:203], a[24:27], v[176:179]
    buffer_load_dwordx4 v[68:71], v44, s[12:15], s41 offen sc1
    v_mfma_f32_16x16x32_bf16 v[176:179], a[204:207], a[28:31], v[176:179]
    v_perm_b32 v56, v89, v35, s37
    v_perm_b32 v57, v89, v35, s38
    v_mfma_f32_16x16x32_bf16 v[180:183], a[200:203], a[32:35], v[180:183]
    ds_read_b32 a229, v56
    v_perm_b32 v58, v89, v35, s39
    v_mfma_f32_16x16x32_bf16 v[180:183], a[204:207], a[36:39], v[180:183]
    s_waitcnt vmcnt(20)
    ds_read_b32 a230, v57
    ds_read_b32 a231, v58
    v_mfma_f32_16x16x32_bf16 v[184:187], a[200:203], a[40:43], v[184:187]
    buffer_load_dwordx4 v[72:75], v32, s[12:15], s42 offen sc1
    v_mfma_f32_16x16x32_bf16 v[184:187], a[204:207], a[44:47], v[184:187]
    s_barrier
    v_mfma_f32_16x16x32_bf16 v[188:191], a[200:203], a[48:51], v[188:191]
    ds_read_b128 a[56:59], v42 offset:16384
    v_perm_b32 v59, v93, v35, s36
    v_mfma_f32_16x16x32_bf16 v[188:191], a[204:207], a[52:55], v[188:191]
    s_waitcnt lgkmcnt(6)
    ds_read_b32 a232, v59
    ds_read_b128 a[60:63], v43 offset:16384
    v_mfma_f32_16x16x32_bf16 v[192:195], a[208:211], a[128:131], v[192:195]
    buffer_load_dwordx4 v[76:79], v33, s[12:15], s42 offen sc1
    v_mfma_f32_16x16x32_bf16 v[192:195], a[212:215], a[132:135], v[192:195]
    ds_read_b128 a[64:67], v42 offset:18432
    v_perm_b32 v60, v93, v35, s37
    v_mfma_f32_16x16x32_bf16 v[196:199], a[208:211], a[0:3], v[196:199]
    ds_read_b32 a233, v60
    v_perm_b32 v61, v93, v35, s38
    v_mfma_f32_16x16x32_bf16 v[196:199], a[212:215], a[4:7], v[196:199]
    ds_read_b32 a234, v61
    ds_read_b128 a[68:71], v43 offset:18432
    v_mfma_f32_16x16x32_bf16 v[200:203], a[208:211], a[8:11], v[200:203]
    v_perm_b32 v62, v93, v35, s39
    v_perm_b32 v63, v90, v35, s36
    v_mfma_f32_16x16x32_bf16 v[200:203], a[212:215], a[12:15], v[200:203]
    ds_read_b32 a235, v62
    ds_read_b32 a236, v63
    v_mfma_f32_16x16x32_bf16 v[204:207], a[208:211], a[16:19], v[204:207]
    ds_read_b128 a[72:75], v42 offset:20480
    v_perm_b32 v56, v90, v35, s37
    v_mfma_f32_16x16x32_bf16 v[204:207], a[212:215], a[20:23], v[204:207]
    ds_read_b32 a237, v56
    ds_read_b128 a[76:79], v43 offset:20480
    v_mfma_f32_16x16x32_bf16 v[208:211], a[208:211], a[24:27], v[208:211]
    buffer_load_dwordx4 v36, s[8:11], s3 offen offset:0 lds
    v_mfma_f32_16x16x32_bf16 v[208:211], a[212:215], a[28:31], v[208:211]
    ds_read_b128 a[80:83], v42 offset:22528
    v_perm_b32 v57, v90, v35, s38
    v_mfma_f32_16x16x32_bf16 v[212:215], a[208:211], a[32:35], v[212:215]
    ds_read_b32 a238, v57
    v_perm_b32 v58, v90, v35, s39
    v_mfma_f32_16x16x32_bf16 v[212:215], a[212:215], a[36:39], v[212:215]
    ds_read_b32 a239, v58
    ds_read_b128 a[84:87], v43 offset:22528
    v_mfma_f32_16x16x32_bf16 v[216:219], a[208:211], a[40:43], v[216:219]
    v_perm_b32 v59, v94, v35, s36
    v_perm_b32 v60, v94, v35, s37
    v_mfma_f32_16x16x32_bf16 v[216:219], a[212:215], a[44:47], v[216:219]
    ds_read_b32 a240, v59
    v_perm_b32 v61, v94, v35, s38
    v_mfma_f32_16x16x32_bf16 v[220:223], a[208:211], a[48:51], v[220:223]
    s_waitcnt vmcnt(19)
    ds_read_b32 a241, v60
    ds_read_b32 a242, v61
    v_mfma_f32_16x16x32_bf16 v[220:223], a[212:215], a[52:55], v[220:223]
    buffer_load_dwordx4 v37, s[8:11], s3 offen offset:1024 lds
    v_mfma_f32_16x16x32_bf16 v[224:227], a[216:219], a[130:133], v[224:227]
    v_or_b32 v99, s47, v99
    v_lshl_or_b32 v96, v100, 4, v96
    v_lshl_or_b32 v97, v101, 4, v97
    v_lshl_or_b32 v98, v102, 4, v98
    v_lshl_or_b32 v99, v103, 4, v99
    s_waitcnt vmcnt(19)
    v_lshl_or_b32 v96, v104, 8, v96
    v_lshl_or_b32 v97, v105, 8, v97
    v_lshl_or_b32 v98, v106, 8, v98
    s_waitcnt vmcnt(18)
    v_lshl_or_b32 v99, v107, 8, v99
    s_waitcnt vmcnt(17)
    v_lshl_or_b32 v96, v108, 12, v96
    v_lshl_or_b32 v97, v109, 12, v97
    v_lshl_or_b32 v98, v110, 12, v98
L_pad1:
    s_cbranch_execz L_pad2
    s_waitcnt vmcnt(16)
    v_lshl_or_b32 v99, v111, 12, v99
    s_waitcnt vmcnt(15)
    v_lshl_or_b32 v96, v112, 16, v96
    v_lshl_or_b32 v97, v113, 16, v97
    v_lshl_or_b32 v98, v114, 16, v98
    s_waitcnt vmcnt(14)
    v_lshl_or_b32 v96, v116, 20, v96
    v_lshl_or_b32 v97, v117, 20, v97
    v_lshl_or_b32 v98, v118, 20, v98
    s_waitcnt vmcnt(13)
    v_lshl_or_b32 v96, v120, 24, v96
    v_lshl_or_b32 v97, v121, 24, v97
    v_lshl_or_b32 v98, v122, 24, v98
    s_waitcnt vmcnt(12)
    v_lshl_or_b32 v96, v124, 28, v96
    v_lshl_or_b32 v97, v125, 28, v97
    v_lshl_or_b32 v98, v126, 28, v98
    buffer_store_dwordx4 v[96:99], v20, s[12:15], s62 offen sc1
    v_mfma_f32_16x16x32_bf16 v[228:231], a[216:219], a[2:5], v[228:231]
    ds_read_b128 a[88:91], v42 offset:24576
    v_perm_b32 v62, v94, v35, s39
    v_mfma_f32_16x16x32_bf16 v[232:235], a[216:219], a[10:13], v[232:235]
    ds_read_b32 a243, v62
    ds_read_b128 a[92:95], v43 offset:24576
    v_mfma_f32_16x16x32_bf16 v[236:239], a[216:219], a[18:21], v[236:239]
    buffer_load_dwordx4 v38, s[8:11], s3 offen offset:2048 lds
    v_mfma_f32_16x16x32_bf16 v[240:243], a[216:219], a[26:29], v[240:243]
    ds_read_b128 a[96:99], v42 offset:26624
    v_perm_b32 v63, v91, v35, s36
    v_mfma_f32_16x16x32_bf16 v[244:247], a[216:219], a[34:37], v[244:247]
    s_waitcnt vmcnt(12)
    ds_read_b32 a244, v63
    v_bitop3_b32 v56, v51, v55, s76 bitop3:0x7e
    v_mfma_f32_16x16x32_bf16 v[248:251], a[216:219], a[42:45], v[248:251]
    s_waitcnt lgkmcnt(7)
    ds_read_b128 a[100:103], v43 offset:26624
    v_mfma_f32_16x16x32_bf16 v[252:255], a[216:219], a[50:53], v[252:255]
    buffer_load_dwordx4 v39, s[8:11], s3 offen offset:3072 lds
    v_mfma_f32_16x16x32_bf16 v[128:131], a[220:223], a[56:59], v[128:131]
    s_add_u32 m0, s57, 32768
    ds_read_b128 a[104:107], v42 offset:28672
    v_cmp_lt_u32 vcc, 0xffff, v56
    v_mfma_f32_16x16x32_bf16 v[128:131], a[224:227], a[60:63], v[128:131]
    s_add_u32 s3, s69, 768
    ds_read_b128 a[108:111], v43 offset:28672
    v_perm_b32 v57, v91, v35, s37
    v_mfma_f32_16x16x32_bf16 v[132:135], a[220:223], a[64:67], v[132:135]
    ds_read_b128 a[112:115], v42 offset:30720
    s_cbranch_vccnz L_slow2_0
L_back2_0:
    v_mfma_f32_16x16x32_bf16 v[132:135], a[224:227], a[68:71], v[132:135]
    ds_read_b128 a[116:119], v43 offset:30720
    ds_read_b32 a245, v57
    v_mfma_f32_16x16x32_bf16 v[136:139], a[220:223], a[72:75], v[136:139]
    buffer_load_dwordx4 v36, s[8:11], s56 offen offset:0 lds
    v_mfma_f32_16x16x32_bf16 v[136:139], a[224:227], a[76:79], v[136:139]
    v_perm_b32 v58, v95, v35, s36
    v_perm_b32 v59, v95, v35, s37
    v_mfma_f32_16x16x32_bf16 v[140:143], a[220:223], a[80:83], v[140:143]
    ds_read_b32 a246, v58
    ds_read_b32 a247, v59
    v_mfma_f32_16x16x32_bf16 v[140:143], a[224:227], a[84:87], v[140:143]
    s_waitcnt lgkmcnt(7)
    v_perm_b32 v60, v48, v35, s36
    v_perm_b32 v61, v48, v35, s37
    v_mfma_f32_16x16x32_bf16 v[144:147], a[220:223], a[88:91], v[144:147]
    ds_read_b32 a248, v60
    ds_read_b32 a249, v61
    v_mfma_f32_16x16x32_bf16 v[144:147], a[224:227], a[92:95], v[144:147]
    v_perm_b32 v62, v48, v35, s38
    v_perm_b32 v63, v48, v35, s39
    v_mfma_f32_16x16x32_bf16 v[148:151], a[220:223], a[96:99], v[148:151]
    s_waitcnt lgkmcnt(7)
    ds_read_b32 a250, v62
    ds_read_b32 a251, v63
    v_mfma_f32_16x16x32_bf16 v[148:151], a[224:227], a[100:103], v[148:151]
    buffer_load_dwordx4 v37, s[8:11], s56 offen offset:1024 lds
    v_mfma_f32_16x16x32_bf16 v[152:155], a[220:223], a[104:107], v[152:155]
    v_perm_b32 v56, v52, v35, s36
    v_perm_b32 v57, v52, v35, s37
    v_mfma_f32_16x16x32_bf16 v[152:155], a[224:227], a[108:111], v[152:155]
    s_waitcnt lgkmcnt(6)
    ds_read_b32 a252, v56
    ds_read_b32 a253, v57
    v_mfma_f32_16x16x32_bf16 v[156:159], a[220:223], a[112:115], v[156:159]
    v_perm_b32 v58, v52, v35, s38
    v_perm_b32 v59, v52, v35, s39
    v_mfma_f32_16x16x32_bf16 v[156:159], a[224:227], a[116:119], v[156:159]
    ds_read_b32 a254, v58
    ds_read_b32 a255, v59
    v_mfma_f32_16x16x32_bf16 v[160:163], a[228:231], a[56:59], v[160:163]
    v_perm_b32 v60, v49, v35, s36
    v_perm_b32 v61, v49, v35, s37
    v_mfma_f32_16x16x32_bf16 v[160:163], a[232:235], a[60:63], v[160:163]
    ds_read_b32 a136, v60
    ds_read_b32 a137, v61
    v_mfma_f32_16x16x32_bf16 v[164:167], a[228:231], a[64:67], v[164:167]
    buffer_load_dwordx4 v38, s[8:11], s56 offen offset:2048 lds
    v_mfma_f32_16x16x32_bf16 v[164:167], a[232:235], a[68:71], v[164:167]
    v_perm_b32 v62, v49, v35, s38
    v_perm_b32 v63, v49, v35, s39
    v_mfma_f32_16x16x32_bf16 v[168:171], a[228:231], a[72:75], v[168:171]
    ds_read_b32 a138, v62
    ds_read_b32 a139, v63
    v_mfma_f32_16x16x32_bf16 v[168:171], a[232:235], a[76:79], v[168:171]
    v_perm_b32 v56, v53, v35, s36
    v_perm_b32 v57, v53, v35, s37
    v_mfma_f32_16x16x32_bf16 v[172:175], a[228:231], a[80:83], v[172:175]
    ds_read_b32 a140, v56
    ds_read_b32 a141, v57
    v_mfma_f32_16x16x32_bf16 v[172:175], a[232:235], a[84:87], v[172:175]
    v_perm_b32 v58, v53, v35, s38
    v_perm_b32 v59, v53, v35, s39
    v_mfma_f32_16x16x32_bf16 v[176:179], a[228:231], a[88:91], v[176:179]
    ds_read_b32 a142, v58
    v_perm_b32 v60, v50, v35, s36
    v_mfma_f32_16x16x32_bf16 v[176:179], a[232:235], a[92:95], v[176:179]
    s_waitcnt vmcnt(12)
    ds_read_b32 a143, v59
    ds_read_b32 a144, v60
    v_mfma_f32_16x16x32_bf16 v[180:183], a[228:231], a[96:99], v[180:183]
    buffer_load_dwordx4 v39, s[8:11], s56 offen offset:3072 lds
    v_mfma_f32_16x16x32_bf16 v[180:183], a[232:235], a[100:103], v[180:183]
    s_barrier
    v_mfma_f32_16x16x32_bf16 v[184:187], a[228:231], a[104:107], v[184:187]
    s_add_u32 m0, s57, 49152
    ds_read_b128 a[120:123], v40 offset:0
    v_perm_b32 v61, v50, v35, s37
    v_mfma_f32_16x16x32_bf16 v[184:187], a[232:235], a[108:111], v[184:187]
    s_add_u32 s56, s55, 1024
    ds_read_b128 a[124:127], v41 offset:0
    ds_read_b32 a145, v61
    v_mfma_f32_16x16x32_bf16 v[188:191], a[228:231], a[112:115], v[188:191]
    ds_read_b128 a[128:131], v40 offset:2048
    v_perm_b32 v62, v50, v35, s38
    v_mfma_f32_16x16x32_bf16 v[188:191], a[232:235], a[116:119], v[188:191]
    ds_read_b128 a[132:135], v41 offset:2048
    ds_read_b32 a146, v62
    v_mfma_f32_16x16x32_bf16 v[192:195], a[236:239], a[56:59], v[192:195]
    ds_read_b128 a[0:3], v40 offset:4096
    v_mfma_f32_16x16x32_bf16 v[192:195], a[240:243], a[60:63], v[192:195]
    buffer_load_dwordx4 v36, s[8:11], s3 offen offset:0 lds
    v_mfma_f32_16x16x32_bf16 v[196:199], a[236:239], a[64:67], v[196:199]
    ds_read_b128 a[4:7], v41 offset:4096
    v_perm_b32 v63, v50, v35, s39
    v_mfma_f32_16x16x32_bf16 v[196:199], a[240:243], a[68:71], v[196:199]
    ds_read_b128 a[8:11], v40 offset:6144
    ds_read_b32 a147, v63
    v_mfma_f32_16x16x32_bf16 v[200:203], a[236:239], a[72:75], v[200:203]
    s_waitcnt vmcnt(12)
    ds_read_b128 a[12:15], v41 offset:6144
    v_bitop3_b32 v56, v67, v71, s76 bitop3:0x7e
    v_mfma_f32_16x16x32_bf16 v[200:203], a[240:243], a[76:79], v[200:203]
    ds_read_b128 a[16:19], v40 offset:8192
    v_cmp_lt_u32 vcc, 0xffff, v56
    v_mfma_f32_16x16x32_bf16 v[204:207], a[236:239], a[80:83], v[204:207]
    ds_read_b128 a[20:23], v41 offset:8192
    v_perm_b32 v57, v54, v35, s36
    v_mfma_f32_16x16x32_bf16 v[204:207], a[240:243], a[84:87], v[204:207]
    ds_read_b32 a148, v57
    s_cbranch_vccnz L_slow2_1
L_back2_1:
    v_mfma_f32_16x16x32_bf16 v[208:211], a[236:239], a[88:91], v[208:211]
    buffer_load_dwordx4 v37, s[8:11], s3 offen offset:1024 lds
    v_mfma_f32_16x16x32_bf16 v[208:211], a[240:243], a[92:95], v[208:211]
    ds_read_b128 a[24:27], v40 offset:10240
    v_perm_b32 v58, v54, v35, s37
    v_mfma_f32_16x16x32_bf16 v[212:215], a[236:239], a[96:99], v[212:215]
    ds_read_b32 a149, v58
    ds_read_b128 a[28:31], v41 offset:10240
    v_mfma_f32_16x16x32_bf16 v[212:215], a[240:243], a[100:103], v[212:215]
    v_perm_b32 v59, v54, v35, s38
    v_perm_b32 v60, v54, v35, s39
    v_mfma_f32_16x16x32_bf16 v[216:219], a[236:239], a[104:107], v[216:219]
    ds_read_b32 a150, v59
    ds_read_b32 a151, v60
    v_mfma_f32_16x16x32_bf16 v[216:219], a[240:243], a[108:111], v[216:219]
    ds_read_b128 a[32:35], v40 offset:12288
    v_perm_b32 v61, v51, v35, s36
    v_mfma_f32_16x16x32_bf16 v[220:223], a[236:239], a[112:115], v[220:223]
    ds_read_b32 a152, v61
    v_perm_b32 v62, v51, v35, s37
    v_perm_b32 v63, v55, v35, s36
    v_mfma_f32_16x16x32_bf16 v[220:223], a[240:243], a[116:119], v[220:223]
    s_waitcnt lgkmcnt(8)
    ds_read_b32 a153, v62
    ds_read_b32 a154, v63
    v_mfma_f32_16x16x32_bf16 v[224:227], a[244:247], a[58:61], v[224:227]
    buffer_load_dwordx4 v38, s[8:11], s3 offen offset:2048 lds
    v_mfma_f32_16x16x32_bf16 v[228:231], a[244:247], a[66:69], v[228:231]
    ds_read_b128 a[36:39], v41 offset:12288
    v_perm_b32 v56, v55, v35, s37
    v_mfma_f32_16x16x32_bf16 v[232:235], a[244:247], a[74:77], v[232:235]
    ds_read_b32 a155, v56
    v_perm_b32 v57, v64, v35, s36
    v_mfma_f32_16x16x32_bf16 v[236:239], a[244:247], a[82:85], v[236:239]
    ds_read_b32 a156, v57
    ds_read_b128 a[40:43], v40 offset:14336
    v_mfma_f32_16x16x32_bf16 v[240:243], a[244:247], a[90:93], v[240:243]
    v_perm_b32 v58, v64, v35, s37
    v_perm_b32 v59, v64, v35, s38
    v_mfma_f32_16x16x32_bf16 v[244:247], a[244:247], a[98:101], v[244:247]
    ds_read_b32 a157, v58
    ds_read_b32 a158, v59
    v_perm_b32 v60, v64, v35, s39
    v_mfma_f32_16x16x32_bf16 v[248:251], a[244:247], a[106:109], v[248:251]
    ds_read_b32 a159, v60
    ds_read_b128 a[44:47], v41 offset:14336
    v_mfma_f32_16x16x32_bf16 v[252:255], a[244:247], a[114:117], v[252:255]
    buffer_load_dwordx4 v39, s[8:11], s3 offen offset:3072 lds
    v_mfma_f32_16x16x32_bf16 v[128:131], a[248:251], a[120:123], v[128:131]
    s_add_u32 m0, s57, 65536
    v_perm_b32 v61, v68, v35, s36
    v_perm_b32 v62, v68, v35, s37
    v_mfma_f32_16x16x32_bf16 v[128:131], a[252:255], a[124:127], v[128:131]
    s_add_u32 s3, s69, 1024
    ds_read_b32 a160, v61
    ds_read_b32 a161, v62
    v_mfma_f32_16x16x32_bf16 v[132:135], a[248:251], a[128:131], v[132:135]
    v_perm_b32 v63, v68, v35, s38
    v_perm_b32 v56, v68, v35, s39
    v_mfma_f32_16x16x32_bf16 v[132:135], a[252:255], a[132:135], v[132:135]
    ds_read_b32 a162, v63
    ds_read_b32 a163, v56
    v_mfma_f32_16x16x32_bf16 v[136:139], a[248:251], a[0:3], v[136:139]
    buffer_load_dwordx4 v[80:83], v34, s[12:15], s42 offen sc1
    v_mfma_f32_16x16x32_bf16 v[136:139], a[252:255], a[4:7], v[136:139]
    v_perm_b32 v57, v65, v35, s36
    v_perm_b32 v58, v65, v35, s37
    v_mfma_f32_16x16x32_bf16 v[140:143], a[248:251], a[8:11], v[140:143]
    ds_read_b32 a164, v57
    ds_read_b32 a165, v58
    v_mfma_f32_16x16x32_bf16 v[140:143], a[252:255], a[12:15], v[140:143]
    s_waitcnt vmcnt(14)
    v_bitop3_b32 v59, v75, v79, s76 bitop3:0x7e
    v_perm_b32 v60, v65, v35, s38
    v_mfma_f32_16x16x32_bf16 v[144:147], a[248:251], a[16:19], v[144:147]
    s_waitcnt lgkmcnt(6)
    ds_read_b32 a166, v60
    v_mfma_f32_16x16x32_bf16 v[144:147], a[252:255], a[20:23], v[144:147]
    buffer_load_dwordx4 v[84:87], v44, s[12:15], s42 offen sc1
    v_mfma_f32_16x16x32_bf16 v[148:151], a[248:251], a[24:27], v[148:151]
    v_cmp_lt_u32 vcc, 0xffff, v59
    v_perm_b32 v61, v65, v35, s39
    v_mfma_f32_16x16x32_bf16 v[148:151], a[252:255], a[28:31], v[148:151]
    ds_read_b32 a167, v61
    v_perm_b32 v62, v69, v35, s36
    v_mfma_f32_16x16x32_bf16 v[152:155], a[248:251], a[32:35], v[152:155]
    ds_read_b32 a168, v62
    s_cbranch_vccnz L_slow3_0
L_back3_0:
    v_mfma_f32_16x16x32_bf16 v[152:155], a[252:255], a[36:39], v[152:155]
    v_perm_b32 v63, v69, v35, s37
    v_perm_b32 v56, v69, v35, s38
    v_mfma_f32_16x16x32_bf16 v[156:159], a[248:251], a[40:43], v[156:159]
    ds_read_b32 a169, v63
    ds_read_b32 a170, v56
    v_perm_b32 v57, v69, v35, s39
    v_mfma_f32_16x16x32_bf16 v[156:159], a[252:255], a[44:47], v[156:159]
    ds_read_b32 a171, v57
    v_mfma_f32_16x16x32_bf16 v[160:163], a[136:139], a[120:123], v[160:163]
    buffer_load_dwordx4 v36, s[8:11], s56 offen offset:0 lds
    v_mfma_f32_16x16x32_bf16 v[160:163], a[140:143], a[124:127], v[160:163]
    v_perm_b32 v58, v66, v35, s36
    v_perm_b32 v60, v66, v35, s37
    v_mfma_f32_16x16x32_bf16 v[164:167], a[136:139], a[128:131], v[164:167]
    ds_read_b32 a172, v58
    ds_read_b32 a173, v60
    v_mfma_f32_16x16x32_bf16 v[164:167], a[140:143], a[132:135], v[164:167]
    v_perm_b32 v59, v66, v35, s38
    v_perm_b32 v61, v66, v35, s39
    v_mfma_f32_16x16x32_bf16 v[168:171], a[136:139], a[0:3], v[168:171]
    ds_read_b32 a174, v59
    ds_read_b32 a175, v61
    v_mfma_f32_16x16x32_bf16 v[168:171], a[140:143], a[4:7], v[168:171]
    buffer_load_dwordx4 v[96:99], v32, s[12:15], s43 offen sc1
    v_mfma_f32_16x16x32_bf16 v[172:175], a[136:139], a[8:11], v[172:175]
    v_perm_b32 v62, v70, v35, s36
    v_perm_b32 v63, v70, v35, s37
    v_mfma_f32_16x16x32_bf16 v[172:175], a[140:143], a[12:15], v[172:175]
    ds_read_b32 a176, v62
    ds_read_b32 a177, v63
    v_mfma_f32_16x16x32_bf16 v[176:179], a[136:139], a[16:19], v[176:179]
    v_perm_b32 v56, v70, v35, s38
    v_perm_b32 v57, v70, v35, s39
    v_mfma_f32_16x16x32_bf16 v[176:179], a[140:143], a[20:23], v[176:179]
    ds_read_b32 a178, v56
    ds_read_b32 a179, v57
    v_mfma_f32_16x16x32_bf16 v[180:183], a[136:139], a[24:27], v[180:183]
    buffer_load_dwordx4 v[100:103], v33, s[12:15], s43 offen sc1
    v_mfma_f32_16x16x32_bf16 v[180:183], a[140:143], a[28:31], v[180:183]
    s_waitcnt vmcnt(13)
    v_perm_b32 v58, v67, v35, s36
    v_perm_b32 v60, v67, v35, s37
    v_mfma_f32_16x16x32_bf16 v[184:187], a[136:139], a[32:35], v[184:187]
    s_barrier
    v_mfma_f32_16x16x32_bf16 v[184:187], a[140:143], a[36:39], v[184:187]
    ds_read_b32 a180, v58
    ds_read_b32 a181, v60
    v_mfma_f32_16x16x32_bf16 v[188:191], a[136:139], a[40:43], v[188:191]
    ds_read_b128 a[48:51], v40 offset:16384
    v_perm_b32 v59, v71, v35, s36
    v_mfma_f32_16x16x32_bf16 v[188:191], a[140:143], a[44:47], v[188:191]
    ds_read_b32 a182, v59
    v_perm_b32 v61, v71, v35, s37
    v_mfma_f32_16x16x32_bf16 v[192:195], a[144:147], a[120:123], v[192:195]
    ds_read_b32 a183, v61
    ds_read_b128 a[52:55], v41 offset:16384
    v_mfma_f32_16x16x32_bf16 v[192:195], a[148:151], a[124:127], v[192:195]
    buffer_load_dwordx4 v37, s[8:11], s56 offen offset:1024 lds
    v_mfma_f32_16x16x32_bf16 v[196:199], a[144:147], a[128:131], v[196:199]
    ds_read_b128 a[56:59], v40 offset:18432
    v_perm_b32 v62, v72, v35, s36
    v_mfma_f32_16x16x32_bf16 v[196:199], a[148:151], a[132:135], v[196:199]
    ds_read_b32 a184, v62
    ds_read_b128 a[60:63], v41 offset:18432
    v_mfma_f32_16x16x32_bf16 v[200:203], a[144:147], a[0:3], v[200:203]
    v_perm_b32 v63, v72, v35, s37
    v_perm_b32 v56, v72, v35, s38
    v_mfma_f32_16x16x32_bf16 v[200:203], a[148:151], a[4:7], v[200:203]
    ds_read_b32 a185, v63
    ds_read_b32 a186, v56
    v_mfma_f32_16x16x32_bf16 v[204:207], a[144:147], a[8:11], v[204:207]
    ds_read_b128 a[64:67], v40 offset:20480
    v_perm_b32 v57, v72, v35, s39
    v_mfma_f32_16x16x32_bf16 v[204:207], a[148:151], a[12:15], v[204:207]
    ds_read_b32 a187, v57
    ds_read_b128 a[68:71], v41 offset:20480
    v_mfma_f32_16x16x32_bf16 v[208:211], a[144:147], a[16:19], v[208:211]
    buffer_load_dwordx4 v38, s[8:11], s56 offen offset:2048 lds
    v_mfma_f32_16x16x32_bf16 v[208:211], a[148:151], a[20:23], v[208:211]
    ds_read_b128 a[72:75], v40 offset:22528
    v_perm_b32 v58, v76, v35, s36
    v_mfma_f32_16x16x32_bf16 v[212:215], a[144:147], a[24:27], v[212:215]
    ds_read_b32 a188, v58
    v_perm_b32 v60, v76, v35, s37
    v_mfma_f32_16x16x32_bf16 v[212:215], a[148:151], a[28:31], v[212:215]
    ds_read_b32 a189, v60
    ds_read_b128 a[76:79], v41 offset:22528
    v_mfma_f32_16x16x32_bf16 v[216:219], a[144:147], a[32:35], v[216:219]
    v_perm_b32 v59, v76, v35, s38
    v_perm_b32 v61, v76, v35, s39
    v_mfma_f32_16x16x32_bf16 v[216:219], a[148:151], a[36:39], v[216:219]
    ds_read_b32 a190, v59
    ds_read_b32 a191, v61
    v_mfma_f32_16x16x32_bf16 v[220:223], a[144:147], a[40:43], v[220:223]
    ds_read_b128 a[80:83], v40 offset:24576
    v_perm_b32 v62, v73, v35, s36
    v_mfma_f32_16x16x32_bf16 v[220:223], a[148:151], a[44:47], v[220:223]
    ds_read_b32 a192, v62
    ds_read_b128 a[84:87], v41 offset:24576
    v_mfma_f32_16x16x32_bf16 v[224:227], a[152:155], a[122:125], v[224:227]
    buffer_load_dwordx4 v39, s[8:11], s56 offen offset:3072 lds
    v_mfma_f32_16x16x32_bf16 v[228:231], a[152:155], a[130:133], v[228:231]
    s_add_u32 m0, s57, 81920
    ds_read_b128 a[88:91], v40 offset:26624
    v_perm_b32 v63, v73, v35, s37
    v_mfma_f32_16x16x32_bf16 v[232:235], a[152:155], a[2:5], v[232:235]
    ds_read_b32 a193, v63
    v_perm_b32 v56, v73, v35, s38
    v_mfma_f32_16x16x32_bf16 v[236:239], a[152:155], a[10:13], v[236:239]
    ds_read_b32 a194, v56
    ds_read_b128 a[92:95], v41 offset:26624
    v_mfma_f32_16x16x32_bf16 v[240:243], a[152:155], a[18:21], v[240:243]
    v_perm_b32 v57, v73, v35, s39
    v_perm_b32 v58, v77, v35, s36
    v_mfma_f32_16x16x32_bf16 v[244:247], a[152:155], a[26:29], v[244:247]
    ds_read_b32 a195, v57
    v_perm_b32 v60, v77, v35, s37
    v_mfma_f32_16x16x32_bf16 v[248:251], a[152:155], a[34:37], v[248:251]
    s_waitcnt lgkmcnt(8)
    ds_read_b32 a196, v58
    ds_read_b32 a197, v60
    v_mfma_f32_16x16x32_bf16 v[252:255], a[152:155], a[42:45], v[252:255]
    buffer_load_dwordx4 v36, s[8:11], s3 offen offset:0 lds
    v_mfma_f32_16x16x32_bf16 v[128:131], a[156:159], a[48:51], v[128:131]
    ds_read_b128 a[96:99], v40 offset:28672
    v_perm_b32 v59, v77, v35, s38
    v_mfma_f32_16x16x32_bf16 v[128:131], a[160:163], a[52:55], v[128:131]
    ds_read_b128 a[100:103], v41 offset:28672
    ds_read_b32 a198, v59
    v_mfma_f32_16x16x32_bf16 v[132:135], a[156:159], a[56:59], v[132:135]
    s_add_u32 s56, s55, 1280
    ds_read_b128 a[104:107], v40 offset:30720
    v_perm_b32 v61, v77, v35, s39
    v_mfma_f32_16x16x32_bf16 v[132:135], a[160:163], a[60:63], v[132:135]
    ds_read_b128 a[108:111], v41 offset:30720
    ds_read_b32 a199, v61
    v_mfma_f32_16x16x32_bf16 v[136:139], a[156:159], a[64:67], v[136:139]
    v_perm_b32 v62, v74, v35, s36
    v_perm_b32 v63, v74, v35, s37
    v_mfma_f32_16x16x32_bf16 v[136:139], a[160:163], a[68:71], v[136:139]
    ds_read_b32 a200, v62
    ds_read_b32 a201, v63
    v_mfma_f32_16x16x32_bf16 v[140:143], a[156:159], a[72:75], v[140:143]
    buffer_load_dwordx4 v37, s[8:11], s3 offen offset:1024 lds
    v_mfma_f32_16x16x32_bf16 v[140:143], a[160:163], a[76:79], v[140:143]
    s_waitcnt lgkmcnt(8)
    v_perm_b32 v56, v74, v35, s38
    v_perm_b32 v57, v74, v35, s39
    v_mfma_f32_16x16x32_bf16 v[144:147], a[156:159], a[80:83], v[144:147]
    ds_read_b32 a202, v56
    ds_read_b32 a203, v57
    v_mfma_f32_16x16x32_bf16 v[144:147], a[160:163], a[84:87], v[144:147]
    v_perm_b32 v58, v78, v35, s36
    v_perm_b32 v60, v78, v35, s37
    v_mfma_f32_16x16x32_bf16 v[148:151], a[156:159], a[88:91], v[148:151]
    ds_read_b32 a204, v58
    ds_read_b32 a205, v60
    v_mfma_f32_16x16x32_bf16 v[148:151], a[160:163], a[92:95], v[148:151]
    s_waitcnt lgkmcnt(8)
    v_perm_b32 v59, v78, v35, s38
    v_perm_b32 v61, v78, v35, s39
    v_mfma_f32_16x16x32_bf16 v[152:155], a[156:159], a[96:99], v[152:155]
    ds_read_b32 a206, v59
    v_perm_b32 v62, v75, v35, s36
    v_mfma_f32_16x16x32_bf16 v[152:155], a[160:163], a[100:103], v[152:155]
    s_waitcnt lgkmcnt(7)
    ds_read_b32 a207, v61
    ds_read_b32 a208, v62
    v_mfma_f32_16x16x32_bf16 v[156:159], a[156:159], a[104:107], v[156:159]
    buffer_load_dwordx4 v38, s[8:11], s3 offen offset:2048 lds
    v_mfma_f32_16x16x32_bf16 v[156:159], a[160:163], a[108:111], v[156:159]
    v_perm_b32 v63, v75, v35, s37
    v_perm_b32 v56, v79, v35, s36
    v_mfma_f32_16x16x32_bf16 v[160:163], a[164:167], a[48:51], v[160:163]
    ds_read_b32 a209, v63
    ds_read_b32 a210, v56
    v_mfma_f32_16x16x32_bf16 v[160:163], a[168:171], a[52:55], v[160:163]
    v_perm_b32 v57, v79, v35, s37
    v_mfma_f32_16x16x32_bf16 v[164:167], a[164:167], a[56:59], v[164:167]
    ds_read_b32 a211, v57
    v_mfma_f32_16x16x32_bf16 v[164:167], a[168:171], a[60:63], v[164:167]
    v_mfma_f32_16x16x32_bf16 v[168:171], a[164:167], a[64:67], v[168:171]
    buffer_load_dwordx4 v[104:107], v34, s[12:15], s43 offen sc1
    v_mfma_f32_16x16x32_bf16 v[168:171], a[168:171], a[68:71], v[168:171]
    s_waitcnt vmcnt(12)
    v_mfma_f32_16x16x32_bf16 v[172:175], a[164:167], a[72:75], v[172:175]
    s_barrier
    v_mfma_f32_16x16x32_bf16 v[172:175], a[168:171], a[76:79], v[172:175]
    ds_read_b128 a[112:115], v40 offset:32768
    v_mfma_f32_16x16x32_bf16 v[176:179], a[164:167], a[80:83], v[176:179]
    buffer_load_dwordx4 v[108:111], v44, s[12:15], s43 offen sc1
    v_mfma_f32_16x16x32_bf16 v[176:179], a[168:171], a[84:87], v[176:179]
    ds_read_b128 a[116:119], v41 offset:32768
    v_mfma_f32_16x16x32_bf16 v[180:183], a[164:167], a[88:91], v[180:183]
    ds_read_b128 a[120:123], v40 offset:34816
    v_mfma_f32_16x16x32_bf16 v[180:183], a[168:171], a[92:95], v[180:183]
    ds_read_b128 a[124:127], v41 offset:34816
    v_mfma_f32_16x16x32_bf16 v[184:187], a[164:167], a[96:99], v[184:187]
    ds_read_b128 a[128:131], v40 offset:36864
    v_mfma_f32_16x16x32_bf16 v[184:187], a[168:171], a[100:103], v[184:187]
    ds_read_b128 a[132:135], v41 offset:36864
    v_mfma_f32_16x16x32_bf16 v[188:191], a[164:167], a[104:107], v[188:191]
    s_waitcnt vmcnt(11)
    ds_read_b128 a[0:3], v40 offset:38912
    v_mfma_f32_16x16x32_bf16 v[188:191], a[168:171], a[108:111], v[188:191]
    buffer_load_dwordx4 v39, s[8:11], s3 offen offset:3072 lds
    v_mfma_f32_16x16x32_bf16 v[192:195], a[172:175], a[48:51], v[192:195]
    s_add_u32 m0, s57, 0
    ds_read_b128 a[4:7], v41 offset:38912
    v_bitop3_b32 v58, v83, v87, s76 bitop3:0x7e
    v_mfma_f32_16x16x32_bf16 v[192:195], a[176:179], a[52:55], v[192:195]
    s_add_u32 s3, s69, 1280
    ds_read_b128 a[8:11], v40 offset:40960
    v_cmp_lt_u32 vcc, 0xffff, v58
    v_mfma_f32_16x16x32_bf16 v[196:199], a[172:175], a[56:59], v[196:199]
    v_mfma_f32_16x16x32_bf16 v[196:199], a[176:179], a[60:63], v[196:199]
    s_cbranch_vccnz L_slow3_1
L_back3_1:
    v_mfma_f32_16x16x32_bf16 v[200:203], a[172:175], a[64:67], v[200:203]
    buffer_load_dwordx4 v[112:115], v32, s[12:15], s44 offen sc1
    v_mfma_f32_16x16x32_bf16 v[200:203], a[176:179], a[68:71], v[200:203]
    v_perm_b32 v60, v83, v35, s36
    v_perm_b32 v59, v83, v35, s37
    v_mfma_f32_16x16x32_bf16 v[204:207], a[172:175], a[72:75], v[204:207]
    ds_read_b32 a212, v60
    ds_read_b32 a213, v59
    v_mfma_f32_16x16x32_bf16 v[204:207], a[176:179], a[76:79], v[204:207]
    ds_read_b128 a[12:15], v41 offset:40960
    v_mfma_f32_16x16x32_bf16 v[208:211], a[172:175], a[80:83], v[208:211]
    buffer_load_dwordx4 v[116:119], v33, s[12:15], s44 offen sc1
    v_mfma_f32_16x16x32_bf16 v[208:211], a[176:179], a[84:87], v[208:211]
    v_perm_b32 v61, v87, v35, s36
    v_perm_b32 v62, v87, v35, s37
    v_mfma_f32_16x16x32_bf16 v[212:215], a[172:175], a[88:91], v[212:215]
    ds_read_b32 a214, v61
    ds_read_b32 a215, v62
    v_mfma_f32_16x16x32_bf16 v[212:215], a[176:179], a[92:95], v[212:215]
    v_perm_b32 v63, v80, v35, s36
    v_perm_b32 v56, v80, v35, s37
    v_mfma_f32_16x16x32_bf16 v[216:219], a[172:175], a[96:99], v[216:219]
    ds_read_b128 a[16:19], v40 offset:43008
    ds_read_b32 a216, v63
    v_mfma_f32_16x16x32_bf16 v[216:219], a[176:179], a[100:103], v[216:219]
    ds_read_b32 a217, v56
    v_perm_b32 v57, v80, v35, s38
    v_mfma_f32_16x16x32_bf16 v[220:223], a[172:175], a[104:107], v[220:223]
    ds_read_b32 a218, v57
    v_perm_b32 v58, v80, v35, s39
    v_mfma_f32_16x16x32_bf16 v[220:223], a[176:179], a[108:111], v[220:223]
    ds_read_b128 a[20:23], v41 offset:43008
    ds_read_b32 a219, v58
    v_mfma_f32_16x16x32_bf16 v[224:227], a[180:183], a[50:53], v[224:227]
    buffer_load_dwordx4 v36, s[8:11], s56 offen offset:0 lds
    v_mfma_f32_16x16x32_bf16 v[228:231], a[180:183], a[58:61], v[228:231]
    s_waitcnt vmcnt(12)
    v_bitop3_b32 v60, v99, v103, s76 bitop3:0x7e
    v_perm_b32 v59, v84, v35, s36
    v_mfma_f32_16x16x32_bf16 v[232:235], a[180:183], a[66:69], v[232:235]
    ds_read_b128 a[24:27], v40 offset:45056
    ds_read_b32 a220, v59
    v_mfma_f32_16x16x32_bf16 v[236:239], a[180:183], a[74:77], v[236:239]
    v_cmp_lt_u32 vcc, 0xffff, v60
    v_perm_b32 v61, v84, v35, s37
    v_mfma_f32_16x16x32_bf16 v[240:243], a[180:183], a[82:85], v[240:243]
    ds_read_b32 a221, v61
    v_perm_b32 v62, v84, v35, s38
    v_mfma_f32_16x16x32_bf16 v[244:247], a[180:183], a[90:93], v[244:247]
    ds_read_b128 a[28:31], v41 offset:45056
    ds_read_b32 a222, v62
    v_mfma_f32_16x16x32_bf16 v[248:251], a[180:183], a[98:101], v[248:251]
    s_waitcnt lgkmcnt(8)
    ds_read_b128 a[32:35], v40 offset:47104
    s_cbranch_vccnz L_slow4_0
L_back4_0:
    v_mfma_f32_16x16x32_bf16 v[252:255], a[180:183], a[106:109], v[252:255]
    buffer_load_dwordx4 v37, s[8:11], s56 offen offset:1024 lds
    v_mfma_f32_16x16x32_bf16 v[128:131], a[184:187], a[112:115], v[128:131]
    v_perm_b32 v63, v84, v35, s39
    v_perm_b32 v56, v81, v35, s36
    v_mfma_f32_16x16x32_bf16 v[128:131], a[188:191], a[116:119], v[128:131]
    ds_read_b32 a223, v63
    ds_read_b32 a224, v56
L_pad2:
    s_cbranch_execz L_pad3
    v_mfma_f32_16x16x32_bf16 v[132:135], a[184:187], a[120:123], v[132:135]
    v_perm_b32 v57, v81, v35, s37
    v_perm_b32 v58, v81, v35, s38
    v_mfma_f32_16x16x32_bf16 v[132:135], a[188:191], a[124:127], v[132:135]
    ds_read_b128 a[36:39], v41 offset:47104
    ds_read_b32 a225, v57
    v_mfma_f32_16x16x32_bf16 v[136:139], a[184:187], a[128:131], v[136:139]
    ds_read_b32 a226, v58
    v_perm_b32 v59, v81, v35, s39
    v_mfma_f32_16x16x32_bf16 v[136:139], a[188:191], a[132:135], v[136:139]
    ds_read_b32 a227, v59
    ds_read_b128 a[40:43], v40 offset:49152
    v_mfma_f32_16x16x32_bf16 v[140:143], a[184:187], a[0:3], v[140:143]
    buffer_load_dwordx4 v38, s[8:11], s56 offen offset:2048 lds
    v_mfma_f32_16x16x32_bf16 v[140:143], a[188:191], a[4:7], v[140:143]
    v_perm_b32 v60, v85, v35, s36
    v_perm_b32 v61, v85, v35, s37
    v_mfma_f32_16x16x32_bf16 v[144:147], a[184:187], a[8:11], v[144:147]
    ds_read_b32 a228, v60
    ds_read_b32 a229, v61
    v_mfma_f32_16x16x32_bf16 v[144:147], a[188:191], a[12:15], v[144:147]
    ds_read_b128 a[44:47], v41 offset:49152
    v_perm_b32 v62, v85, v35, s38
    v_mfma_f32_16x16x32_bf16 v[148:151], a[184:187], a[16:19], v[148:151]
    s_waitcnt lgkmcnt(8)
    ds_read_b32 a230, v62
    v_perm_b32 v63, v85, v35, s39
    v_mfma_f32_16x16x32_bf16 v[148:151], a[188:191], a[20:23], v[148:151]
    ds_read_b32 a231, v63
    v_perm_b32 v56, v82, v35, s36
    v_mfma_f32_16x16x32_bf16 v[152:155], a[184:187], a[24:27], v[152:155]
    ds_read_b32 a232, v56
    ds_read_b128 a[48:51], v40 offset:51200
    v_mfma_f32_16x16x32_bf16 v[152:155], a[188:191], a[28:31], v[152:155]
    v_perm_b32 v57, v82, v35, s37
    v_perm_b32 v58, v82, v35, s38
    v_mfma_f32_16x16x32_bf16 v[156:159], a[184:187], a[32:35], v[156:159]
    s_waitcnt lgkmcnt(7)
    ds_read_b32 a233, v57
    ds_read_b32 a234, v58
    v_mfma_f32_16x16x32_bf16 v[156:159], a[188:191], a[36:39], v[156:159]
    ds_read_b128 a[52:55], v41 offset:51200
    v_perm_b32 v59, v82, v35, s39
    v_mfma_f32_16x16x32_bf16 v[160:163], a[192:195], a[112:115], v[160:163]
    ds_read_b32 a235, v59
    v_perm_b32 v60, v86, v35, s36
    v_mfma_f32_16x16x32_bf16 v[160:163], a[196:199], a[116:119], v[160:163]
    ds_read_b32 a236, v60
    ds_read_b128 a[56:59], v40 offset:53248
    v_mfma_f32_16x16x32_bf16 v[164:167], a[192:195], a[120:123], v[164:167]
    buffer_load_dwordx4 v[120:123], v34, s[12:15], s44 offen sc1
    v_mfma_f32_16x16x32_bf16 v[164:167], a[196:199], a[124:127], v[164:167]
    v_perm_b32 v61, v86, v35, s37
    v_perm_b32 v62, v86, v35, s38
    v_mfma_f32_16x16x32_bf16 v[168:171], a[192:195], a[128:131], v[168:171]
    ds_read_b32 a237, v61
    ds_read_b32 a238, v62
    v_mfma_f32_16x16x32_bf16 v[168:171], a[196:199], a[132:135], v[168:171]
    ds_read_b128 a[60:63], v41 offset:53248
    v_mfma_f32_16x16x32_bf16 v[172:175], a[192:195], a[0:3], v[172:175]
    buffer_load_dwordx4 v[124:127], v44, s[12:15], s44 offen sc1
    v_mfma_f32_16x16x32_bf16 v[172:175], a[196:199], a[4:7], v[172:175]
    v_perm_b32 v63, v86, v35, s39
    v_perm_b32 v56, v96, v35, s36
    v_mfma_f32_16x16x32_bf16 v[176:179], a[192:195], a[8:11], v[176:179]
    ds_read_b128 a[64:67], v40 offset:55296
    ds_read_b32 a239, v63
    v_mfma_f32_16x16x32_bf16 v[176:179], a[196:199], a[12:15], v[176:179]
    ds_read_b32 a240, v56
    ds_read_b128 a[68:71], v41 offset:55296
    v_mfma_f32_16x16x32_bf16 v[180:183], a[192:195], a[16:19], v[180:183]
    buffer_load_dwordx4 v39, s[8:11], s56 offen offset:3072 lds
    v_mfma_f32_16x16x32_bf16 v[180:183], a[196:199], a[20:23], v[180:183]
    s_add_u32 m0, s57, 16384
    v_perm_b32 v57, v96, v35, s37
    v_perm_b32 v58, v96, v35, s38
    v_mfma_f32_16x16x32_bf16 v[184:187], a[192:195], a[24:27], v[184:187]
    ds_read_b32 a241, v57
    ds_read_b32 a242, v58
    v_mfma_f32_16x16x32_bf16 v[184:187], a[196:199], a[28:31], v[184:187]
    ds_read_b128 a[72:75], v40 offset:57344
    v_perm_b32 v59, v96, v35, s39
    v_mfma_f32_16x16x32_bf16 v[188:191], a[192:195], a[32:35], v[188:191]
    ds_read_b32 a243, v59
    ds_read_b128 a[76:79], v41 offset:57344
    v_mfma_f32_16x16x32_bf16 v[188:191], a[196:199], a[36:39], v[188:191]
    buffer_load_dwordx4 v36, s[8:11], s3 offen offset:0 lds
    v_mfma_f32_16x16x32_bf16 v[192:195], a[200:203], a[112:115], v[192:195]
    v_perm_b32 v60, v100, v35, s36
    v_perm_b32 v61, v100, v35, s37
    v_mfma_f32_16x16x32_bf16 v[192:195], a[204:207], a[116:119], v[192:195]
    ds_read_b32 a244, v60
    ds_read_b32 a245, v61
    v_mfma_f32_16x16x32_bf16 v[196:199], a[200:203], a[120:123], v[196:199]
    v_perm_b32 v62, v100, v35, s38
    v_perm_b32 v63, v100, v35, s39
    v_mfma_f32_16x16x32_bf16 v[196:199], a[204:207], a[124:127], v[196:199]
    ds_read_b32 a246, v62
    ds_read_b32 a247, v63
    v_mfma_f32_16x16x32_bf16 v[200:203], a[200:203], a[128:131], v[200:203]
    ds_read_b128 a[80:83], v40 offset:59392
    v_perm_b32 v56, v97, v35, s36
    v_mfma_f32_16x16x32_bf16 v[200:203], a[204:207], a[132:135], v[200:203]
    ds_read_b32 a248, v56
    ds_read_b128 a[84:87], v41 offset:59392
    v_mfma_f32_16x16x32_bf16 v[204:207], a[200:203], a[0:3], v[204:207]
    buffer_load_dwordx4 v37, s[8:11], s3 offen offset:1024 lds
    v_mfma_f32_16x16x32_bf16 v[204:207], a[204:207], a[4:7], v[204:207]
    v_perm_b32 v57, v97, v35, s37
    v_perm_b32 v58, v97, v35, s38
    v_mfma_f32_16x16x32_bf16 v[208:211], a[200:203], a[8:11], v[208:211]
    ds_read_b32 a249, v57
    ds_read_b32 a250, v58
    v_mfma_f32_16x16x32_bf16 v[208:211], a[204:207], a[12:15], v[208:211]
    ds_read_b128 a[88:91], v40 offset:61440
    v_perm_b32 v59, v97, v35, s39
    v_mfma_f32_16x16x32_bf16 v[212:215], a[200:203], a[16:19], v[212:215]
    ds_read_b32 a251, v59
    v_perm_b32 v60, v101, v35, s36
    v_mfma_f32_16x16x32_bf16 v[212:215], a[204:207], a[20:23], v[212:215]
    ds_read_b32 a252, v60
    v_perm_b32 v61, v101, v35, s37
    v_mfma_f32_16x16x32_bf16 v[216:219], a[200:203], a[24:27], v[216:219]
    ds_read_b32 a253, v61
    ds_read_b128 a[92:95], v41 offset:61440
    v_mfma_f32_16x16x32_bf16 v[216:219], a[204:207], a[28:31], v[216:219]
    buffer_load_dwordx4 v38, s[8:11], s3 offen offset:2048 lds
    v_mfma_f32_16x16x32_bf16 v[220:223], a[200:203], a[32:35], v[220:223]
    s_waitcnt vmcnt(12)
    v_bitop3_b32 v62, v107, v111, s76 bitop3:0x7e
    v_perm_b32 v63, v101, v35, s38
    v_mfma_f32_16x16x32_bf16 v[220:223], a[204:207], a[36:39], v[220:223]
    ds_read_b32 a254, v63
    v_cmp_lt_u32 vcc, 0xffff, v62
    v_mfma_f32_16x16x32_bf16 v[224:227], a[208:211], a[114:117], v[224:227]
    s_waitcnt lgkmcnt(8)
    ds_read_b128 a[96:99], v40 offset:63488
    v_perm_b32 v56, v101, v35, s39
    v_mfma_f32_16x16x32_bf16 v[224:227], a[212:215], a[42:45], v[224:227]
    ds_read_b32 a255, v56
    s_cbranch_vccnz L_slow4_1
L_back4_1:
    v_mfma_f32_16x16x32_bf16 v[228:231], a[208:211], a[122:125], v[228:231]
    v_perm_b32 v57, v98, v35, s36
    v_perm_b32 v58, v98, v35, s37
    v_mfma_f32_16x16x32_bf16 v[228:231], a[212:215], a[50:53], v[228:231]
    ds_read_b128 a[100:103], v41 offset:63488
    ds_read_b32 a136, v57
    v_perm_b32 v59, v98, v35, s38
    v_mfma_f32_16x16x32_bf16 v[232:235], a[208:211], a[130:133], v[232:235]
    ds_read_b32 a137, v58
    ds_read_b32 a138, v59
    v_mfma_f32_16x16x32_bf16 v[232:235], a[212:215], a[58:61], v[232:235]
    buffer_load_dwordx4 v39, s[8:11], s3 offen offset:3072 lds
    v_mfma_f32_16x16x32_bf16 v[236:239], a[208:211], a[2:5], v[236:239]
    v_perm_b32 v60, v98, v35, s39
    v_perm_b32 v61, v102, v35, s36
    v_mfma_f32_16x16x32_bf16 v[236:239], a[212:215], a[66:69], v[236:239]
    ds_read_b32 a139, v60
    ds_read_b32 a140, v61
    v_mfma_f32_16x16x32_bf16 v[240:243], a[208:211], a[10:13], v[240:243]
    v_perm_b32 v62, v102, v35, s37
    v_perm_b32 v63, v102, v35, s38
    v_mfma_f32_16x16x32_bf16 v[240:243], a[212:215], a[74:77], v[240:243]
    ds_read_b32 a141, v62
    ds_read_b32 a142, v63
    v_mfma_f32_16x16x32_bf16 v[244:247], a[208:211], a[18:21], v[244:247]
    s_add_u32 s56, s55, 1536
    v_perm_b32 v56, v102, v35, s39
    v_perm_b32 v57, v99, v35, s36
    v_mfma_f32_16x16x32_bf16 v[244:247], a[212:215], a[82:85], v[244:247]
    s_waitcnt vmcnt(12) lgkmcnt(7)
    ds_read_b32 a143, v56
    ds_read_b32 a144, v57
    v_mfma_f32_16x16x32_bf16 v[248:251], a[208:211], a[26:29], v[248:251]
    s_barrier
    v_mfma_f32_16x16x32_bf16 v[248:251], a[212:215], a[90:93], v[248:251]
    s_add_u32 m0, s57, 32768
    v_perm_b32 v58, v99, v35, s37
    v_mfma_f32_16x16x32_bf16 v[252:255], a[208:211], a[34:37], v[252:255]
    buffer_load_dwordx4 v[88:91], v32, s[12:15], s45 offen sc1
    v_mfma_f32_16x16x32_bf16 v[252:255], a[212:215], a[98:101], v[252:255]
    ds_read_b32 a145, v58
    v_perm_b32 v59, v103, v35, s36
    v_mfma_f32_16x16x32_bf16 v[128:131], a[216:219], a[40:43], v[128:131]
    ds_read_b32 a146, v59
    v_perm_b32 v60, v103, v35, s37
    v_mfma_f32_16x16x32_bf16 v[128:131], a[220:223], a[44:47], v[128:131]
    ds_read_b32 a147, v60
    ds_read_b128 a[104:107], v42 offset:0
    v_mfma_f32_16x16x32_bf16 v[132:135], a[216:219], a[48:51], v[132:135]
    buffer_load_dwordx4 v[92:95], v33, s[12:15], s45 offen sc1
    v_mfma_f32_16x16x32_bf16 v[132:135], a[220:223], a[52:55], v[132:135]
    v_perm_b32 v61, v107, v35, s36
    v_perm_b32 v62, v107, v35, s37
    v_mfma_f32_16x16x32_bf16 v[136:139], a[216:219], a[56:59], v[136:139]
    ds_read_b32 a148, v61
    ds_read_b32 a149, v62
    v_perm_b32 v63, v111, v35, s36
    v_mfma_f32_16x16x32_bf16 v[136:139], a[220:223], a[60:63], v[136:139]
    ds_read_b32 a150, v63
    ds_read_b128 a[108:111], v43 offset:0
    v_mfma_f32_16x16x32_bf16 v[140:143], a[216:219], a[64:67], v[140:143]
    buffer_load_dwordx4 v[48:51], v34, s[12:15], s45 offen sc1
    v_mfma_f32_16x16x32_bf16 v[140:143], a[220:223], a[68:71], v[140:143]
    s_waitcnt vmcnt(13)
    v_perm_b32 v57, v111, v35, s37
    v_bitop3_b32 v56, v115, v119, s76 bitop3:0x7e
    v_mfma_f32_16x16x32_bf16 v[144:147], a[216:219], a[72:75], v[144:147]
    ds_read_b32 a151, v57
    v_cmp_lt_u32 vcc, 0xffff, v56
    v_perm_b32 v58, v104, v35, s36
    v_mfma_f32_16x16x32_bf16 v[144:147], a[220:223], a[76:79], v[144:147]
    ds_read_b32 a152, v58
    ds_read_b128 a[112:115], v42 offset:2048
    v_mfma_f32_16x16x32_bf16 v[148:151], a[216:219], a[80:83], v[148:151]
    buffer_load_dwordx4 v[52:55], v44, s[12:15], s45 offen sc1
    v_mfma_f32_16x16x32_bf16 v[148:151], a[220:223], a[84:87], v[148:151]
    v_perm_b32 v59, v104, v35, s37
    s_cbranch_vccnz L_slow5_0
L_back5_0:
    v_mfma_f32_16x16x32_bf16 v[152:155], a[216:219], a[88:91], v[152:155]
    s_add_u32 s3, s69, 1536
    ds_read_b32 a153, v59
    v_perm_b32 v60, v104, v35, s38
    v_mfma_f32_16x16x32_bf16 v[152:155], a[220:223], a[92:95], v[152:155]
    ds_read_b32 a154, v60
    v_perm_b32 v61, v104, v35, s39
    v_mfma_f32_16x16x32_bf16 v[156:159], a[216:219], a[96:99], v[156:159]
    ds_read_b32 a155, v61
    ds_read_b128 a[116:119], v43 offset:2048
    v_mfma_f32_16x16x32_bf16 v[156:159], a[220:223], a[100:103], v[156:159]
    buffer_load_dwordx4 v36, s[8:11], s56 offen offset:0 lds
    v_mfma_f32_16x16x32_bf16 v[160:163], a[224:227], a[40:43], v[160:163]
    v_perm_b32 v62, v108, v35, s36
    v_perm_b32 v63, v108, v35, s37
    v_mfma_f32_16x16x32_bf16 v[160:163], a[228:231], a[44:47], v[160:163]
    ds_read_b32 a156, v62
    ds_read_b32 a157, v63
    v_mfma_f32_16x16x32_bf16 v[164:167], a[224:227], a[48:51], v[164:167]
    ds_read_b128 a[120:123], v42 offset:4096
    v_perm_b32 v56, v108, v35, s38
    v_mfma_f32_16x16x32_bf16 v[164:167], a[228:231], a[52:55], v[164:167]
    ds_read_b32 a158, v56
    ds_read_b128 a[124:127], v43 offset:4096
    v_mfma_f32_16x16x32_bf16 v[168:171], a[224:227], a[56:59], v[168:171]
    v_perm_b32 v57, v108, v35, s39
    v_perm_b32 v58, v105, v35, s36
    v_mfma_f32_16x16x32_bf16 v[168:171], a[228:231], a[60:63], v[168:171]
    ds_read_b32 a159, v57
    ds_read_b32 a160, v58
    v_mfma_f32_16x16x32_bf16 v[172:175], a[224:227], a[64:67], v[172:175]
    ds_read_b128 a[128:131], v42 offset:6144
    v_mfma_f32_16x16x32_bf16 v[172:175], a[228:231], a[68:71], v[172:175]
    buffer_load_dwordx4 v37, s[8:11], s56 offen offset:1024 lds
    v_mfma_f32_16x16x32_bf16 v[176:179], a[224:227], a[72:75], v[176:179]
    v_perm_b32 v59, v105, v35, s37
    v_perm_b32 v60, v105, v35, s38
    v_mfma_f32_16x16x32_bf16 v[176:179], a[228:231], a[76:79], v[176:179]
    ds_read_b32 a161, v59
    ds_read_b32 a162, v60
    v_mfma_f32_16x16x32_bf16 v[180:183], a[224:227], a[80:83], v[180:183]
    ds_read_b128 a[132:135], v43 offset:6144
    v_perm_b32 v61, v105, v35, s39
    v_mfma_f32_16x16x32_bf16 v[180:183], a[228:231], a[84:87], v[180:183]
    ds_read_b32 a163, v61
    v_perm_b32 v62, v109, v35, s36
    v_mfma_f32_16x16x32_bf16 v[184:187], a[224:227], a[88:91], v[184:187]
    ds_read_b32 a164, v62
    v_perm_b32 v63, v109, v35, s37
    v_mfma_f32_16x16x32_bf16 v[184:187], a[228:231], a[92:95], v[184:187]
    ds_read_b32 a165, v63
    ds_read_b128 a[0:3], v42 offset:8192
    v_mfma_f32_16x16x32_bf16 v[188:191], a[224:227], a[96:99], v[188:191]
    buffer_load_dwordx4 v38, s[8:11], s56 offen offset:2048 lds
    v_mfma_f32_16x16x32_bf16 v[188:191], a[228:231], a[100:103], v[188:191]
    ds_read_b128 a[4:7], v43 offset:8192
    v_perm_b32 v56, v109, v35, s38
    v_mfma_f32_16x16x32_bf16 v[192:195], a[232:235], a[40:43], v[192:195]
    ds_read_b32 a166, v56
    v_perm_b32 v57, v109, v35, s39
    v_mfma_f32_16x16x32_bf16 v[192:195], a[236:239], a[44:47], v[192:195]
    ds_read_b32 a167, v57
    v_perm_b32 v58, v106, v35, s36
    v_mfma_f32_16x16x32_bf16 v[196:199], a[232:235], a[48:51], v[196:199]
    ds_read_b32 a168, v58
    ds_read_b128 a[8:11], v42 offset:10240
    v_mfma_f32_16x16x32_bf16 v[196:199], a[236:239], a[52:55], v[196:199]
    v_perm_b32 v59, v106, v35, s37
    v_perm_b32 v60, v106, v35, s38
    v_mfma_f32_16x16x32_bf16 v[200:203], a[232:235], a[56:59], v[200:203]
    ds_read_b32 a169, v59
    ds_read_b32 a170, v60
    v_mfma_f32_16x16x32_bf16 v[200:203], a[236:239], a[60:63], v[200:203]
    buffer_load_dwordx4 v39, s[8:11], s56 offen offset:3072 lds
    v_mfma_f32_16x16x32_bf16 v[204:207], a[232:235], a[64:67], v[204:207]
    s_add_u32 m0, s57, 49152
    ds_read_b128 a[12:15], v43 offset:10240
    v_perm_b32 v61, v106, v35, s39
    v_mfma_f32_16x16x32_bf16 v[204:207], a[236:239], a[68:71], v[204:207]
    s_add_u32 s56, s55, 1792
    ds_read_b32 a171, v61
    v_perm_b32 v62, v110, v35, s36
    v_mfma_f32_16x16x32_bf16 v[208:211], a[232:235], a[72:75], v[208:211]
    ds_read_b32 a172, v62
    ds_read_b128 a[16:19], v42 offset:12288
    v_mfma_f32_16x16x32_bf16 v[208:211], a[236:239], a[76:79], v[208:211]
    v_perm_b32 v63, v110, v35, s37
    v_perm_b32 v56, v110, v35, s38
    v_mfma_f32_16x16x32_bf16 v[212:215], a[232:235], a[80:83], v[212:215]
    ds_read_b32 a173, v63
    ds_read_b32 a174, v56
    v_mfma_f32_16x16x32_bf16 v[212:215], a[236:239], a[84:87], v[212:215]
    ds_read_b128 a[20:23], v43 offset:12288
    v_perm_b32 v57, v110, v35, s39
    v_mfma_f32_16x16x32_bf16 v[216:219], a[232:235], a[88:91], v[216:219]
    ds_read_b32 a175, v57
    ds_read_b128 a[24:27], v42 offset:14336
    v_mfma_f32_16x16x32_bf16 v[216:219], a[236:239], a[92:95], v[216:219]
    buffer_load_dwordx4 v36, s[8:11], s3 offen offset:0 lds
    v_mfma_f32_16x16x32_bf16 v[220:223], a[232:235], a[96:99], v[220:223]
    v_perm_b32 v58, v112, v35, s36
    v_perm_b32 v59, v112, v35, s37
    v_mfma_f32_16x16x32_bf16 v[220:223], a[236:239], a[100:103], v[220:223]
    s_waitcnt lgkmcnt(8)
    ds_read_b32 a176, v58
    ds_read_b32 a177, v59
    v_mfma_f32_16x16x32_bf16 v[128:131], a[240:243], a[104:107], v[128:131]
    ds_read_b128 a[28:31], v43 offset:14336
    v_perm_b32 v60, v112, v35, s38
    v_mfma_f32_16x16x32_bf16 v[128:131], a[244:247], a[108:111], v[128:131]
    ds_read_b32 a178, v60
    v_perm_b32 v61, v112, v35, s39
    v_mfma_f32_16x16x32_bf16 v[132:135], a[240:243], a[112:115], v[132:135]
    ds_read_b32 a179, v61
    v_perm_b32 v62, v116, v35, s36
    v_mfma_f32_16x16x32_bf16 v[132:135], a[244:247], a[116:119], v[132:135]
    ds_read_b32 a180, v62
    ds_read_b128 a[32:35], v42 offset:16384
    v_mfma_f32_16x16x32_bf16 v[136:139], a[240:243], a[120:123], v[136:139]
    buffer_load_dwordx4 v37, s[8:11], s3 offen offset:1024 lds
    v_mfma_f32_16x16x32_bf16 v[136:139], a[244:247], a[124:127], v[136:139]
    s_waitcnt vmcnt(15)
    v_bitop3_b32 v63, v123, v127, s76 bitop3:0x7e
    v_perm_b32 v56, v116, v35, s37
    v_mfma_f32_16x16x32_bf16 v[140:143], a[240:243], a[128:131], v[140:143]
    ds_read_b32 a181, v56
    v_cmp_lt_u32 vcc, 0xffff, v63
    v_mfma_f32_16x16x32_bf16 v[140:143], a[244:247], a[132:135], v[140:143]
    ds_read_b128 a[36:39], v43 offset:16384
    v_perm_b32 v57, v116, v35, s38
    v_mfma_f32_16x16x32_bf16 v[144:147], a[240:243], a[0:3], v[144:147]
    ds_read_b32 a182, v57
    s_cbranch_vccnz L_slow5_1
L_back5_1:
    v_mfma_f32_16x16x32_bf16 v[144:147], a[244:247], a[4:7], v[144:147]
    ds_read_b128 a[40:43], v42 offset:18432
    v_perm_b32 v58, v116, v35, s39
    v_mfma_f32_16x16x32_bf16 v[148:151], a[240:243], a[8:11], v[148:151]
    ds_read_b32 a183, v58
    v_perm_b32 v59, v113, v35, s36
    v_mfma_f32_16x16x32_bf16 v[148:151], a[244:247], a[12:15], v[148:151]
    s_waitcnt lgkmcnt(7)
    ds_read_b32 a184, v59
    ds_read_b128 a[44:47], v43 offset:18432
    v_mfma_f32_16x16x32_bf16 v[152:155], a[240:243], a[16:19], v[152:155]
    buffer_load_dwordx4 v38, s[8:11], s3 offen offset:2048 lds
    v_mfma_f32_16x16x32_bf16 v[152:155], a[244:247], a[20:23], v[152:155]
    v_perm_b32 v60, v113, v35, s37
    v_perm_b32 v61, v113, v35, s38
    v_mfma_f32_16x16x32_bf16 v[156:159], a[240:243], a[24:27], v[156:159]
    ds_read_b32 a185, v60
    ds_read_b32 a186, v61
    v_mfma_f32_16x16x32_bf16 v[156:159], a[244:247], a[28:31], v[156:159]
    ds_read_b128 a[48:51], v42 offset:20480
    v_perm_b32 v62, v113, v35, s39
    v_mfma_f32_16x16x32_bf16 v[160:163], a[248:251], a[104:107], v[160:163]
    ds_read_b32 a187, v62
    v_perm_b32 v63, v117, v35, s36
    v_mfma_f32_16x16x32_bf16 v[160:163], a[252:255], a[108:111], v[160:163]
    ds_read_b32 a188, v63
    v_perm_b32 v56, v117, v35, s37
    v_mfma_f32_16x16x32_bf16 v[164:167], a[248:251], a[112:115], v[164:167]
    ds_read_b32 a189, v56
    ds_read_b128 a[52:55], v43 offset:20480
    v_mfma_f32_16x16x32_bf16 v[164:167], a[252:255], a[116:119], v[164:167]
    buffer_load_dwordx4 v39, s[8:11], s3 offen offset:3072 lds
    v_mfma_f32_16x16x32_bf16 v[168:171], a[248:251], a[120:123], v[168:171]
    s_add_u32 m0, s57, 65536
    v_perm_b32 v57, v117, v35, s38
    v_perm_b32 v58, v117, v35, s39
    v_mfma_f32_16x16x32_bf16 v[168:171], a[252:255], a[124:127], v[168:171]
    s_add_u32 s3, s69, 1792
    ds_read_b32 a190, v57
    ds_read_b32 a191, v58
    v_mfma_f32_16x16x32_bf16 v[172:175], a[248:251], a[128:131], v[172:175]
    ds_read_b128 a[56:59], v42 offset:22528
    v_mfma_f32_16x16x32_bf16 v[172:175], a[252:255], a[132:135], v[172:175]
    buffer_load_dwordx4 v[64:67], v22, s[32:35], 0 offen
    v_mfma_f32_16x16x32_bf16 v[176:179], a[248:251], a[0:3], v[176:179]
    v_perm_b32 v59, v114, v35, s36
    v_perm_b32 v60, v114, v35, s37
    v_mfma_f32_16x16x32_bf16 v[176:179], a[252:255], a[4:7], v[176:179]
    ds_read_b32 a192, v59
    ds_read_b32 a193, v60
    v_mfma_f32_16x16x32_bf16 v[180:183], a[248:251], a[8:11], v[180:183]
    ds_read_b128 a[60:63], v43 offset:22528
    v_perm_b32 v61, v114, v35, s38
    v_mfma_f32_16x16x32_bf16 v[180:183], a[252:255], a[12:15], v[180:183]
    ds_read_b32 a194, v61
    ds_read_b128 a[64:67], v42 offset:24576
    v_mfma_f32_16x16x32_bf16 v[184:187], a[248:251], a[16:19], v[184:187]
    buffer_load_dwordx2 v[68:69], v22, s[32:35], 0 offen offset:16
    v_mfma_f32_16x16x32_bf16 v[184:187], a[252:255], a[20:23], v[184:187]
    v_perm_b32 v62, v114, v35, s39
    v_perm_b32 v63, v118, v35, s36
    v_mfma_f32_16x16x32_bf16 v[188:191], a[248:251], a[24:27], v[188:191]
    ds_read_b32 a195, v62
    ds_read_b32 a196, v63
    v_mfma_f32_16x16x32_bf16 v[188:191], a[252:255], a[28:31], v[188:191]
    ds_read_b128 a[68:71], v43 offset:24576
    v_perm_b32 v56, v118, v35, s37
    v_mfma_f32_16x16x32_bf16 v[192:195], a[136:139], a[104:107], v[192:195]
    ds_read_b32 a197, v56
    v_perm_b32 v57, v118, v35, s38
    v_mfma_f32_16x16x32_bf16 v[192:195], a[140:143], a[108:111], v[192:195]
    ds_read_b32 a198, v57
    ds_read_b128 a[72:75], v42 offset:26624
    v_mfma_f32_16x16x32_bf16 v[196:199], a[136:139], a[112:115], v[196:199]
    buffer_load_dword v70, v23, s[32:35], 0 offen
    v_mfma_f32_16x16x32_bf16 v[196:199], a[140:143], a[116:119], v[196:199]
    v_perm_b32 v58, v118, v35, s39
    v_perm_b32 v59, v115, v35, s36
    v_mfma_f32_16x16x32_bf16 v[200:203], a[136:139], a[120:123], v[200:203]
    ds_read_b32 a199, v58
    ds_read_b32 a200, v59
    v_mfma_f32_16x16x32_bf16 v[200:203], a[140:143], a[124:127], v[200:203]
    ds_read_b128 a[76:79], v43 offset:26624
    v_mfma_f32_16x16x32_bf16 v[204:207], a[136:139], a[128:131], v[204:207]
    buffer_load_dwordx4 v[72:75], v32, s[12:15], s72 offen sc1
    v_mfma_f32_16x16x32_bf16 v[204:207], a[140:143], a[132:135], v[204:207]
    v_perm_b32 v60, v115, v35, s37
    v_perm_b32 v61, v119, v35, s36
    v_mfma_f32_16x16x32_bf16 v[208:211], a[136:139], a[0:3], v[208:211]
    ds_read_b32 a201, v60
    ds_read_b32 a202, v61
    v_mfma_f32_16x16x32_bf16 v[208:211], a[140:143], a[4:7], v[208:211]
    ds_read_b128 a[80:83], v42 offset:28672
    v_mfma_f32_16x16x32_bf16 v[212:215], a[136:139], a[8:11], v[212:215]
    buffer_load_dwordx4 v[76:79], v33, s[12:15], s72 offen sc1
    v_mfma_f32_16x16x32_bf16 v[212:215], a[140:143], a[12:15], v[212:215]
    v_perm_b32 v62, v119, v35, s37
    v_perm_b32 v63, v123, v35, s36
    v_mfma_f32_16x16x32_bf16 v[216:219], a[136:139], a[16:19], v[216:219]
    ds_read_b32 a203, v62
    ds_read_b32 a204, v63
    v_mfma_f32_16x16x32_bf16 v[216:219], a[140:143], a[20:23], v[216:219]
    ds_read_b128 a[84:87], v43 offset:28672
    v_mfma_f32_16x16x32_bf16 v[220:223], a[136:139], a[24:27], v[220:223]
    buffer_load_dwordx4 v[80:83], v34, s[12:15], s72 offen sc1
    v_mfma_f32_16x16x32_bf16 v[220:223], a[140:143], a[28:31], v[220:223]
    v_perm_b32 v56, v123, v35, s37
    v_perm_b32 v57, v127, v35, s36
    v_mfma_f32_16x16x32_bf16 v[224:227], a[144:147], a[106:109], v[224:227]
    s_waitcnt lgkmcnt(6)
    ds_read_b128 a[88:91], v42 offset:30720
    ds_read_b32 a205, v56
    v_mfma_f32_16x16x32_bf16 v[224:227], a[148:151], a[34:37], v[224:227]
    ds_read_b32 a206, v57
    ds_read_b128 a[92:95], v43 offset:30720
    v_mfma_f32_16x16x32_bf16 v[228:231], a[144:147], a[114:117], v[228:231]
    buffer_load_dwordx4 v[84:87], v44, s[12:15], s72 offen sc1
    v_mfma_f32_16x16x32_bf16 v[228:231], a[148:151], a[42:45], v[228:231]
    s_waitcnt vmcnt(17)
    v_perm_b32 v59, v127, v35, s37
    v_bitop3_b32 v58, v91, v95, s76 bitop3:0x7e
    v_mfma_f32_16x16x32_bf16 v[232:235], a[144:147], a[122:125], v[232:235]
    ds_read_b32 a207, v59
    v_cmp_lt_u32 vcc, 0xffff, v58
    v_mfma_f32_16x16x32_bf16 v[232:235], a[148:151], a[50:53], v[232:235]
    v_perm_b32 v60, v120, v35, s36
    v_perm_b32 v61, v120, v35, s37
    v_mfma_f32_16x16x32_bf16 v[236:239], a[144:147], a[130:133], v[236:239]
    ds_read_b32 a208, v60
    ds_read_b32 a209, v61
    v_mfma_f32_16x16x32_bf16 v[236:239], a[148:151], a[58:61], v[236:239]
    v_perm_b32 v62, v120, v35, s38
    s_cbranch_vccnz L_slow6_0
L_back6_0:
    v_mfma_f32_16x16x32_bf16 v[240:243], a[144:147], a[2:5], v[240:243]
    ds_read_b32 a210, v62
    v_perm_b32 v63, v120, v35, s39
    v_mfma_f32_16x16x32_bf16 v[240:243], a[148:151], a[66:69], v[240:243]
    s_waitcnt vmcnt(15)
    ds_read_b32 a211, v63
    v_bitop3_b32 v56, v51, v55, s76 bitop3:0x7e
    v_mfma_f32_16x16x32_bf16 v[244:247], a[144:147], a[10:13], v[244:247]
    v_cmp_lt_u32 vcc, 0xffff, v56
    v_perm_b32 v57, v124, v35, s36
    v_mfma_f32_16x16x32_bf16 v[244:247], a[148:151], a[74:77], v[244:247]
    s_waitcnt lgkmcnt(5)
    ds_read_b32 a212, v57
    v_perm_b32 v58, v124, v35, s37
    v_mfma_f32_16x16x32_bf16 v[248:251], a[144:147], a[18:21], v[248:251]
    s_barrier
    v_mfma_f32_16x16x32_bf16 v[248:251], a[148:151], a[82:85], v[248:251]
    buffer_load_dwordx4 v36, s[8:11], s56 offen offset:0 lds
    v_mfma_f32_16x16x32_bf16 v[252:255], a[144:147], a[26:29], v[252:255]
    ds_read_b32 a213, v58
    s_cbranch_vccnz L_slow6_1
L_back6_1:
    v_mfma_f32_16x16x32_bf16 v[252:255], a[148:151], a[90:93], v[252:255]
    v_perm_b32 v59, v124, v35, s38
    v_perm_b32 v60, v124, v35, s39
    v_mfma_f32_16x16x32_bf16 v[128:131], a[152:155], a[32:35], v[128:131]
    ds_read_b32 a214, v59
    ds_read_b32 a215, v60
    v_mfma_f32_16x16x32_bf16 v[128:131], a[156:159], a[36:39], v[128:131]
    buffer_load_dwordx4 v37, s[8:11], s56 offen offset:1024 lds
    v_mfma_f32_16x16x32_bf16 v[132:135], a[152:155], a[40:43], v[132:135]
    v_perm_b32 v61, v121, v35, s36
    v_perm_b32 v62, v121, v35, s37
    v_mfma_f32_16x16x32_bf16 v[132:135], a[156:159], a[44:47], v[132:135]
    ds_read_b32 a216, v61
    ds_read_b32 a217, v62
    v_mfma_f32_16x16x32_bf16 v[136:139], a[152:155], a[48:51], v[136:139]
    ds_read_b128 a[96:99], v40 offset:0
L_pad3:
    s_cbranch_execz L_pad4
    v_mfma_f32_16x16x32_bf16 v[136:139], a[156:159], a[52:55], v[136:139]
    buffer_load_dwordx4 v38, s[8:11], s56 offen offset:2048 lds
    v_mfma_f32_16x16x32_bf16 v[140:143], a[152:155], a[56:59], v[140:143]
    v_perm_b32 v63, v121, v35, s38
    v_perm_b32 v56, v121, v35, s39
    v_mfma_f32_16x16x32_bf16 v[140:143], a[156:159], a[60:63], v[140:143]
    ds_read_b32 a218, v63
    ds_read_b32 a219, v56
    v_mfma_f32_16x16x32_bf16 v[144:147], a[152:155], a[64:67], v[144:147]
    ds_read_b128 a[100:103], v41 offset:0
    v_mfma_f32_16x16x32_bf16 v[144:147], a[156:159], a[68:71], v[144:147]
    buffer_load_dwordx4 v39, s[8:11], s56 offen offset:3072 lds
    v_mfma_f32_16x16x32_bf16 v[148:151], a[152:155], a[72:75], v[148:151]
    s_add_u32 m0, s57, 81920
    v_perm_b32 v57, v125, v35, s36
    v_perm_b32 v58, v125, v35, s37
    v_mfma_f32_16x16x32_bf16 v[148:151], a[156:159], a[76:79], v[148:151]
    ds_read_b32 a220, v57
    ds_read_b32 a221, v58
    v_mfma_f32_16x16x32_bf16 v[152:155], a[152:155], a[80:83], v[152:155]
    ds_read_b128 a[104:107], v40 offset:2048
    v_mfma_f32_16x16x32_bf16 v[152:155], a[156:159], a[84:87], v[152:155]
    buffer_load_dwordx4 v36, s[8:11], s3 offen offset:0 lds
    v_mfma_f32_16x16x32_bf16 v[156:159], a[152:155], a[88:91], v[156:159]
    v_perm_b32 v59, v125, v35, s38
    v_perm_b32 v60, v125, v35, s39
    v_mfma_f32_16x16x32_bf16 v[156:159], a[156:159], a[92:95], v[156:159]
    ds_read_b128 a[108:111], v41 offset:2048
    ds_read_b32 a222, v59
    v_mfma_f32_16x16x32_bf16 v[160:163], a[160:163], a[32:35], v[160:163]
    ds_read_b32 a223, v60
    v_perm_b32 v61, v122, v35, s36
    v_mfma_f32_16x16x32_bf16 v[160:163], a[164:167], a[36:39], v[160:163]
    ds_read_b32 a224, v61
    ds_read_b128 a[112:115], v40 offset:4096
    v_mfma_f32_16x16x32_bf16 v[164:167], a[160:163], a[40:43], v[164:167]
    buffer_load_dwordx4 v37, s[8:11], s3 offen offset:1024 lds
    v_mfma_f32_16x16x32_bf16 v[164:167], a[164:167], a[44:47], v[164:167]
    v_perm_b32 v62, v122, v35, s37
    v_perm_b32 v63, v122, v35, s38
    v_mfma_f32_16x16x32_bf16 v[168:171], a[160:163], a[48:51], v[168:171]
    ds_read_b32 a225, v62
    ds_read_b32 a226, v63
    v_mfma_f32_16x16x32_bf16 v[168:171], a[164:167], a[52:55], v[168:171]
    ds_read_b128 a[116:119], v41 offset:4096
    v_perm_b32 v56, v122, v35, s39
    v_mfma_f32_16x16x32_bf16 v[172:175], a[160:163], a[56:59], v[172:175]
    ds_read_b32 a227, v56
    v_perm_b32 v57, v126, v35, s36
    v_mfma_f32_16x16x32_bf16 v[172:175], a[164:167], a[60:63], v[172:175]
    ds_read_b32 a228, v57
    v_perm_b32 v58, v126, v35, s37
    v_mfma_f32_16x16x32_bf16 v[176:179], a[160:163], a[64:67], v[176:179]
    ds_read_b128 a[120:123], v40 offset:6144
    ds_read_b32 a229, v58
    v_mfma_f32_16x16x32_bf16 v[176:179], a[164:167], a[68:71], v[176:179]
    ds_read_b128 a[124:127], v41 offset:6144
    v_mfma_f32_16x16x32_bf16 v[180:183], a[160:163], a[72:75], v[180:183]
    buffer_load_dwordx4 v38, s[8:11], s3 offen offset:2048 lds
    v_mfma_f32_16x16x32_bf16 v[180:183], a[164:167], a[76:79], v[180:183]
    v_perm_b32 v59, v126, v35, s38
    v_perm_b32 v60, v126, v35, s39
    v_mfma_f32_16x16x32_bf16 v[184:187], a[160:163], a[80:83], v[184:187]
    ds_read_b32 a230, v59
    ds_read_b32 a231, v60
    v_mfma_f32_16x16x32_bf16 v[184:187], a[164:167], a[84:87], v[184:187]
    v_perm_b32 v61, v91, v35, s36
    v_perm_b32 v62, v91, v35, s37
    v_mfma_f32_16x16x32_bf16 v[188:191], a[160:163], a[88:91], v[188:191]
    ds_read_b128 a[128:131], v40 offset:8192
    ds_read_b32 a232, v61
    v_mfma_f32_16x16x32_bf16 v[188:191], a[164:167], a[92:95], v[188:191]
    ds_read_b32 a233, v62
    v_perm_b32 v63, v95, v35, s36
    v_mfma_f32_16x16x32_bf16 v[192:195], a[168:171], a[32:35], v[192:195]
    ds_read_b32 a234, v63
    ds_read_b128 a[132:135], v41 offset:8192
    v_mfma_f32_16x16x32_bf16 v[192:195], a[172:175], a[36:39], v[192:195]
    buffer_load_dwordx4 v39, s[8:11], s3 offen offset:3072 lds
    v_mfma_f32_16x16x32_bf16 v[196:199], a[168:171], a[40:43], v[196:199]
    v_perm_b32 v56, v95, v35, s37
    v_perm_b32 v57, v51, v35, s36
    v_mfma_f32_16x16x32_bf16 v[196:199], a[172:175], a[44:47], v[196:199]
    ds_read_b32 a235, v56
    ds_read_b32 a236, v57
    v_mfma_f32_16x16x32_bf16 v[200:203], a[168:171], a[48:51], v[200:203]
    ds_read_b128 a[0:3], v40 offset:10240
    v_perm_b32 v58, v51, v35, s37
    v_mfma_f32_16x16x32_bf16 v[200:203], a[172:175], a[52:55], v[200:203]
    ds_read_b32 a237, v58
    v_perm_b32 v59, v55, v35, s36
    v_mfma_f32_16x16x32_bf16 v[204:207], a[168:171], a[56:59], v[204:207]
    ds_read_b32 a238, v59
    v_perm_b32 v60, v55, v35, s37
    v_mfma_f32_16x16x32_bf16 v[204:207], a[172:175], a[60:63], v[204:207]
    ds_read_b128 a[4:7], v41 offset:10240
    ds_read_b32 a239, v60
    v_mfma_f32_16x16x32_bf16 v[208:211], a[168:171], a[64:67], v[208:211]
    v_perm_b32 v61, v88, v35, s36
    v_perm_b32 v62, v88, v35, s37
    v_mfma_f32_16x16x32_bf16 v[208:211], a[172:175], a[68:71], v[208:211]
    ds_read_b32 a240, v61
    ds_read_b32 a241, v62
    v_mfma_f32_16x16x32_bf16 v[212:215], a[168:171], a[72:75], v[212:215]
    ds_read_b128 a[8:11], v40 offset:12288
    v_perm_b32 v63, v88, v35, s38
    v_mfma_f32_16x16x32_bf16 v[212:215], a[172:175], a[76:79], v[212:215]
    ds_read_b32 a242, v63
    v_perm_b32 v56, v88, v35, s39
    v_mfma_f32_16x16x32_bf16 v[216:219], a[168:171], a[80:83], v[216:219]
    ds_read_b32 a243, v56
    v_perm_b32 v57, v92, v35, s36
    v_mfma_f32_16x16x32_bf16 v[216:219], a[172:175], a[84:87], v[216:219]
    ds_read_b128 a[12:15], v41 offset:12288
    ds_read_b32 a244, v57
    v_mfma_f32_16x16x32_bf16 v[220:223], a[168:171], a[88:91], v[220:223]
    v_perm_b32 v58, v92, v35, s37
    v_perm_b32 v59, v92, v35, s38
    v_mfma_f32_16x16x32_bf16 v[220:223], a[172:175], a[92:95], v[220:223]
    s_waitcnt lgkmcnt(9)
    ds_read_b32 a245, v58
    ds_read_b32 a246, v59
    v_mfma_f32_16x16x32_bf16 v[128:131], a[176:179], a[96:99], v[128:131]
    ds_read_b128 a[16:19], v40 offset:14336
    v_perm_b32 v60, v92, v35, s39
    v_mfma_f32_16x16x32_bf16 v[128:131], a[180:183], a[100:103], v[128:131]
    ds_read_b32 a247, v60
    v_perm_b32 v61, v48, v35, s36
    v_mfma_f32_16x16x32_bf16 v[132:135], a[176:179], a[104:107], v[132:135]
    ds_read_b32 a248, v61
    v_perm_b32 v62, v48, v35, s37
    v_mfma_f32_16x16x32_bf16 v[132:135], a[180:183], a[108:111], v[132:135]
    ds_read_b128 a[20:23], v41 offset:14336
    ds_read_b32 a249, v62
    v_mfma_f32_16x16x32_bf16 v[136:139], a[176:179], a[112:115], v[136:139]
    v_perm_b32 v63, v48, v35, s38
    v_perm_b32 v56, v48, v35, s39
    v_mfma_f32_16x16x32_bf16 v[136:139], a[180:183], a[116:119], v[136:139]
    ds_read_b32 a250, v63
    ds_read_b32 a251, v56
    v_mfma_f32_16x16x32_bf16 v[140:143], a[176:179], a[120:123], v[140:143]
    ds_read_b128 a[24:27], v40 offset:16384
    v_perm_b32 v57, v52, v35, s36
    v_mfma_f32_16x16x32_bf16 v[140:143], a[180:183], a[124:127], v[140:143]
    ds_read_b32 a252, v57
    v_perm_b32 v58, v52, v35, s37
    v_mfma_f32_16x16x32_bf16 v[144:147], a[176:179], a[128:131], v[144:147]
    ds_read_b32 a253, v58
    ds_read_b128 a[28:31], v41 offset:16384
    v_mfma_f32_16x16x32_bf16 v[144:147], a[180:183], a[132:135], v[144:147]
    v_perm_b32 v59, v52, v35, s38
    v_perm_b32 v60, v52, v35, s39
    v_mfma_f32_16x16x32_bf16 v[148:151], a[176:179], a[0:3], v[148:151]
    s_waitcnt lgkmcnt(9)
    ds_read_b32 a254, v59
    ds_read_b32 a255, v60
    v_mfma_f32_16x16x32_bf16 v[148:151], a[180:183], a[4:7], v[148:151]
    ds_read_b128 a[32:35], v40 offset:18432
    v_perm_b32 v61, v89, v35, s36
    v_mfma_f32_16x16x32_bf16 v[152:155], a[176:179], a[8:11], v[152:155]
    ds_read_b32 a136, v61
    v_perm_b32 v62, v89, v35, s37
    v_mfma_f32_16x16x32_bf16 v[152:155], a[180:183], a[12:15], v[152:155]
    ds_read_b32 a137, v62
    ds_read_b128 a[36:39], v41 offset:18432
    v_mfma_f32_16x16x32_bf16 v[156:159], a[176:179], a[16:19], v[156:159]
    s_waitcnt lgkmcnt(10)
    ds_read_b128 a[40:43], v40 offset:20480
    v_perm_b32 v63, v89, v35, s38
    v_mfma_f32_16x16x32_bf16 v[156:159], a[180:183], a[20:23], v[156:159]
    ds_read_b32 a138, v63
    v_perm_b32 v56, v89, v35, s39
    v_mfma_f32_16x16x32_bf16 v[160:163], a[184:187], a[96:99], v[160:163]
    ds_read_b32 a139, v56
    v_perm_b32 v57, v93, v35, s36
    v_mfma_f32_16x16x32_bf16 v[160:163], a[188:191], a[100:103], v[160:163]
    ds_read_b32 a140, v57
    ds_read_b128 a[44:47], v41 offset:20480
    v_mfma_f32_16x16x32_bf16 v[164:167], a[184:187], a[104:107], v[164:167]
    v_perm_b32 v58, v93, v35, s37
    v_perm_b32 v59, v93, v35, s38
    v_mfma_f32_16x16x32_bf16 v[164:167], a[188:191], a[108:111], v[164:167]
    ds_read_b32 a141, v58
    ds_read_b32 a142, v59
    v_mfma_f32_16x16x32_bf16 v[168:171], a[184:187], a[112:115], v[168:171]
    ds_read_b128 a[48:51], v40 offset:22528
    v_perm_b32 v60, v93, v35, s39
    v_mfma_f32_16x16x32_bf16 v[168:171], a[188:191], a[116:119], v[168:171]
    ds_read_b32 a143, v60
    v_perm_b32 v61, v49, v35, s36
    v_mfma_f32_16x16x32_bf16 v[172:175], a[184:187], a[120:123], v[172:175]
    ds_read_b32 a144, v61
    ds_read_b128 a[52:55], v41 offset:22528
    v_mfma_f32_16x16x32_bf16 v[172:175], a[188:191], a[124:127], v[172:175]
    s_waitcnt vmcnt(10)
    v_bitop3_b32 v62, v75, v79, s76 bitop3:0x7e
    v_perm_b32 v63, v49, v35, s37
    v_mfma_f32_16x16x32_bf16 v[176:179], a[184:187], a[128:131], v[176:179]
    ds_read_b32 a145, v63
    v_cmp_lt_u32 vcc, 0xffff, v62
    v_mfma_f32_16x16x32_bf16 v[176:179], a[188:191], a[132:135], v[176:179]
    ds_read_b128 a[56:59], v40 offset:24576
    v_perm_b32 v56, v49, v35, s38
    v_mfma_f32_16x16x32_bf16 v[180:183], a[184:187], a[0:3], v[180:183]
    ds_read_b32 a146, v56
    s_cbranch_vccnz L_slow7_0
L_back7_0:
    v_mfma_f32_16x16x32_bf16 v[180:183], a[188:191], a[4:7], v[180:183]
    v_perm_b32 v57, v49, v35, s39
    v_perm_b32 v58, v53, v35, s36
    v_mfma_f32_16x16x32_bf16 v[184:187], a[184:187], a[8:11], v[184:187]
    ds_read_b32 a147, v57
    ds_read_b32 a148, v58
    v_mfma_f32_16x16x32_bf16 v[184:187], a[188:191], a[12:15], v[184:187]
    s_waitcnt vmcnt(8)
    ds_read_b128 a[60:63], v41 offset:24576
    v_bitop3_b32 v59, v83, v87, s76 bitop3:0x7e
    v_mfma_f32_16x16x32_bf16 v[188:191], a[184:187], a[16:19], v[188:191]
    v_cmp_lt_u32 vcc, 0xffff, v59
    v_perm_b32 v60, v53, v35, s37
    v_mfma_f32_16x16x32_bf16 v[188:191], a[188:191], a[20:23], v[188:191]
    ds_read_b32 a149, v60
    v_perm_b32 v61, v53, v35, s38
    v_mfma_f32_16x16x32_bf16 v[192:195], a[192:195], a[96:99], v[192:195]
    ds_read_b32 a150, v61
    s_cbranch_vccnz L_slow7_1
L_back7_1:
    v_mfma_f32_16x16x32_bf16 v[192:195], a[196:199], a[100:103], v[192:195]
    ds_read_b128 a[64:67], v40 offset:26624
    v_perm_b32 v62, v53, v35, s39
    v_mfma_f32_16x16x32_bf16 v[196:199], a[192:195], a[104:107], v[196:199]
    ds_read_b32 a151, v62
    v_perm_b32 v63, v90, v35, s36
    v_mfma_f32_16x16x32_bf16 v[196:199], a[196:199], a[108:111], v[196:199]
    ds_read_b32 a152, v63
    ds_read_b128 a[68:71], v41 offset:26624
    v_mfma_f32_16x16x32_bf16 v[200:203], a[192:195], a[112:115], v[200:203]
    v_perm_b32 v56, v90, v35, s37
    v_perm_b32 v57, v90, v35, s38
    v_mfma_f32_16x16x32_bf16 v[200:203], a[196:199], a[116:119], v[200:203]
    ds_read_b32 a153, v56
    ds_read_b32 a154, v57
    v_mfma_f32_16x16x32_bf16 v[204:207], a[192:195], a[120:123], v[204:207]
    ds_read_b128 a[72:75], v40 offset:28672
    v_perm_b32 v58, v90, v35, s39
    v_mfma_f32_16x16x32_bf16 v[204:207], a[196:199], a[124:127], v[204:207]
    ds_read_b32 a155, v58
    v_perm_b32 v59, v94, v35, s36
    v_mfma_f32_16x16x32_bf16 v[208:211], a[192:195], a[128:131], v[208:211]
    ds_read_b32 a156, v59
    ds_read_b128 a[76:79], v41 offset:28672
    v_mfma_f32_16x16x32_bf16 v[208:211], a[196:199], a[132:135], v[208:211]
    v_perm_b32 v60, v94, v35, s37
    v_perm_b32 v61, v94, v35, s38
    v_mfma_f32_16x16x32_bf16 v[212:215], a[192:195], a[0:3], v[212:215]
    ds_read_b32 a157, v60
    ds_read_b32 a158, v61
    v_mfma_f32_16x16x32_bf16 v[212:215], a[196:199], a[4:7], v[212:215]
    ds_read_b128 a[80:83], v40 offset:30720
    v_perm_b32 v62, v94, v35, s39
    v_mfma_f32_16x16x32_bf16 v[216:219], a[192:195], a[8:11], v[216:219]
    ds_read_b32 a159, v62
    v_perm_b32 v63, v50, v35, s36
    v_mfma_f32_16x16x32_bf16 v[216:219], a[196:199], a[12:15], v[216:219]
    ds_read_b32 a160, v63
    v_perm_b32 v56, v50, v35, s37
    v_mfma_f32_16x16x32_bf16 v[220:223], a[192:195], a[16:19], v[220:223]
    ds_read_b32 a161, v56
    ds_read_b128 a[84:87], v41 offset:30720
    v_mfma_f32_16x16x32_bf16 v[220:223], a[196:199], a[20:23], v[220:223]
    v_perm_b32 v57, v50, v35, s38
    v_perm_b32 v58, v50, v35, s39
    v_mfma_f32_16x16x32_bf16 v[224:227], a[200:203], a[98:101], v[224:227]
    s_waitcnt lgkmcnt(9)
    ds_read_b32 a162, v57
    ds_read_b32 a163, v58
    v_mfma_f32_16x16x32_bf16 v[224:227], a[204:207], a[26:29], v[224:227]
    v_perm_b32 v59, v54, v35, s36
    v_perm_b32 v60, v54, v35, s37
    v_mfma_f32_16x16x32_bf16 v[228:231], a[200:203], a[106:109], v[228:231]
    ds_read_b32 a164, v59
    ds_read_b32 a165, v60
    v_mfma_f32_16x16x32_bf16 v[228:231], a[204:207], a[34:37], v[228:231]
    v_perm_b32 v61, v54, v35, s38
    v_perm_b32 v62, v54, v35, s39
    v_mfma_f32_16x16x32_bf16 v[232:235], a[200:203], a[114:117], v[232:235]
    ds_read_b32 a166, v61
    ds_read_b32 a167, v62
    v_mfma_f32_16x16x32_bf16 v[232:235], a[204:207], a[42:45], v[232:235]
    v_perm_b32 v63, v75, v35, s36
    v_perm_b32 v56, v75, v35, s37
    v_mfma_f32_16x16x32_bf16 v[236:239], a[200:203], a[122:125], v[236:239]
    ds_read_b32 a168, v63
    ds_read_b32 a169, v56
    v_mfma_f32_16x16x32_bf16 v[236:239], a[204:207], a[50:53], v[236:239]
    v_perm_b32 v57, v79, v35, s36
    v_perm_b32 v58, v79, v35, s37
    v_mfma_f32_16x16x32_bf16 v[240:243], a[200:203], a[130:133], v[240:243]
    ds_read_b32 a170, v57
    ds_read_b32 a171, v58
    v_mfma_f32_16x16x32_bf16 v[240:243], a[204:207], a[58:61], v[240:243]
    v_perm_b32 v59, v83, v35, s36
    v_perm_b32 v60, v83, v35, s37
    v_mfma_f32_16x16x32_bf16 v[244:247], a[200:203], a[2:5], v[244:247]
    ds_read_b32 a172, v59
    ds_read_b32 a173, v60
    v_mfma_f32_16x16x32_bf16 v[244:247], a[204:207], a[66:69], v[244:247]
    s_waitcnt lgkmcnt(8)
    v_perm_b32 v61, v87, v35, s36
    v_perm_b32 v62, v87, v35, s37
    v_mfma_f32_16x16x32_bf16 v[248:251], a[200:203], a[10:13], v[248:251]
    s_barrier
    v_mfma_f32_16x16x32_bf16 v[248:251], a[204:207], a[74:77], v[248:251]
    ds_read_b32 a174, v61
    ds_read_b32 a175, v62
    v_mfma_f32_16x16x32_bf16 v[252:255], a[200:203], a[18:21], v[252:255]
    v_perm_b32 v63, v72, v35, s36
    v_perm_b32 v56, v72, v35, s37
    v_mfma_f32_16x16x32_bf16 v[252:255], a[204:207], a[82:85], v[252:255]
    ds_read_b32 a176, v63
    ds_read_b32 a177, v56
    v_mfma_f32_16x16x32_bf16 v[128:131], a[208:211], a[24:27], v[128:131]
    v_perm_b32 v57, v72, v35, s38
    v_perm_b32 v58, v72, v35, s39
    v_mfma_f32_16x16x32_bf16 v[128:131], a[212:215], a[28:31], v[128:131]
    ds_read_b32 a178, v57
    ds_read_b32 a179, v58
    v_mfma_f32_16x16x32_bf16 v[132:135], a[208:211], a[32:35], v[132:135]
    v_perm_b32 v59, v76, v35, s36
    v_perm_b32 v60, v76, v35, s37
    v_mfma_f32_16x16x32_bf16 v[132:135], a[212:215], a[36:39], v[132:135]
    ds_read_b32 a180, v59
    ds_read_b32 a181, v60
    v_mfma_f32_16x16x32_bf16 v[136:139], a[208:211], a[40:43], v[136:139]
    v_perm_b32 v61, v76, v35, s38
    v_perm_b32 v62, v76, v35, s39
    v_mfma_f32_16x16x32_bf16 v[136:139], a[212:215], a[44:47], v[136:139]
    ds_read_b32 a182, v61
    ds_read_b32 a183, v62
    v_mfma_f32_16x16x32_bf16 v[140:143], a[208:211], a[48:51], v[140:143]
    v_perm_b32 v63, v80, v35, s36
    v_perm_b32 v56, v80, v35, s37
    v_mfma_f32_16x16x32_bf16 v[140:143], a[212:215], a[52:55], v[140:143]
    ds_read_b32 a184, v63
    ds_read_b32 a185, v56
    v_mfma_f32_16x16x32_bf16 v[144:147], a[208:211], a[56:59], v[144:147]
    v_perm_b32 v57, v80, v35, s38
    v_perm_b32 v58, v80, v35, s39
    v_mfma_f32_16x16x32_bf16 v[144:147], a[212:215], a[60:63], v[144:147]
    ds_read_b32 a186, v57
    ds_read_b32 a187, v58
    v_mfma_f32_16x16x32_bf16 v[148:151], a[208:211], a[64:67], v[148:151]
    v_perm_b32 v59, v84, v35, s36
    v_perm_b32 v60, v84, v35, s37
    v_mfma_f32_16x16x32_bf16 v[148:151], a[212:215], a[68:71], v[148:151]
    ds_read_b32 a188, v59
    ds_read_b32 a189, v60
    v_mfma_f32_16x16x32_bf16 v[152:155], a[208:211], a[72:75], v[152:155]
    v_perm_b32 v61, v84, v35, s38
    v_perm_b32 v62, v84, v35, s39
    v_mfma_f32_16x16x32_bf16 v[152:155], a[212:215], a[76:79], v[152:155]
    ds_read_b32 a190, v61
    ds_read_b32 a191, v62
    v_mfma_f32_16x16x32_bf16 v[156:159], a[208:211], a[80:83], v[156:159]
    ds_read_b128 a[88:91], v40 offset:32768
    v_perm_b32 v63, v73, v35, s36
    v_mfma_f32_16x16x32_bf16 v[156:159], a[212:215], a[84:87], v[156:159]
    ds_read_b32 a192, v63
    v_perm_b32 v56, v73, v35, s37
    v_mfma_f32_16x16x32_bf16 v[160:163], a[216:219], a[24:27], v[160:163]
    ds_read_b32 a193, v56
    v_perm_b32 v57, v73, v35, s38
    v_mfma_f32_16x16x32_bf16 v[160:163], a[220:223], a[28:31], v[160:163]
    ds_read_b32 a194, v57
    ds_read_b128 a[92:95], v41 offset:32768
    v_mfma_f32_16x16x32_bf16 v[164:167], a[216:219], a[32:35], v[164:167]
    v_perm_b32 v58, v73, v35, s39
    v_perm_b32 v59, v77, v35, s36
    v_mfma_f32_16x16x32_bf16 v[164:167], a[220:223], a[36:39], v[164:167]
    ds_read_b32 a195, v58
    ds_read_b32 a196, v59
    v_mfma_f32_16x16x32_bf16 v[168:171], a[216:219], a[40:43], v[168:171]
    v_perm_b32 v60, v77, v35, s37
    v_perm_b32 v61, v77, v35, s38
    v_mfma_f32_16x16x32_bf16 v[168:171], a[220:223], a[44:47], v[168:171]
    ds_read_b32 a197, v60
    ds_read_b32 a198, v61
    v_mfma_f32_16x16x32_bf16 v[172:175], a[216:219], a[48:51], v[172:175]
    ds_read_b128 a[96:99], v40 offset:49152
    v_perm_b32 v62, v77, v35, s39
    v_mfma_f32_16x16x32_bf16 v[172:175], a[220:223], a[52:55], v[172:175]
    ds_read_b32 a199, v62
    v_perm_b32 v63, v81, v35, s36
    v_mfma_f32_16x16x32_bf16 v[176:179], a[216:219], a[56:59], v[176:179]
    ds_read_b32 a200, v63
    ds_read_b128 a[100:103], v41 offset:49152
    v_mfma_f32_16x16x32_bf16 v[176:179], a[220:223], a[60:63], v[176:179]
    v_perm_b32 v56, v81, v35, s37
    v_perm_b32 v57, v81, v35, s38
    v_mfma_f32_16x16x32_bf16 v[180:183], a[216:219], a[64:67], v[180:183]
    ds_read_b32 a201, v56
    ds_read_b32 a202, v57
    v_mfma_f32_16x16x32_bf16 v[180:183], a[220:223], a[68:71], v[180:183]
    v_perm_b32 v58, v81, v35, s39
    v_perm_b32 v59, v85, v35, s36
    v_mfma_f32_16x16x32_bf16 v[184:187], a[216:219], a[72:75], v[184:187]
    ds_read_b32 a203, v58
    v_perm_b32 v60, v85, v35, s37
    v_mfma_f32_16x16x32_bf16 v[184:187], a[220:223], a[76:79], v[184:187]
    ds_read_b32 a204, v59
    v_lshlrev_b32 v96, 16, v70
    v_mfma_f32_16x16x32_bf16 v[188:191], a[216:219], a[80:83], v[188:191]
    ds_read_b32 a205, v60
    v_perm_b32 v61, v85, v35, s38
    v_mfma_f32_16x16x32_bf16 v[188:191], a[220:223], a[84:87], v[188:191]
    v_perm_b32 v62, v85, v35, s39
    v_and_b32 v97, 0xffff0000, v70
    v_mfma_f32_16x16x32_bf16 v[192:195], a[224:227], a[24:27], v[192:195]
    ds_read_b32 a206, v61
    v_lshlrev_b32 v100, 16, v64
    v_mfma_f32_16x16x32_bf16 v[192:195], a[228:231], a[28:31], v[192:195]
    ds_read_b32 a207, v62
    v_perm_b32 v63, v74, v35, s36
    v_mfma_f32_16x16x32_bf16 v[196:199], a[224:227], a[32:35], v[196:199]
    v_and_b32 v101, 0xffff0000, v65
    v_lshlrev_b32 v102, 16, v67
    v_mfma_f32_16x16x32_bf16 v[196:199], a[228:231], a[36:39], v[196:199]
    s_waitcnt vmcnt(0)
    ds_read_b32 a208, v63
    v_perm_b32 v56, v74, v35, s37
    v_mfma_f32_16x16x32_bf16 v[200:203], a[224:227], a[40:43], v[200:203]
    s_barrier
    v_mfma_f32_16x16x32_bf16 v[200:203], a[228:231], a[44:47], v[200:203]
    ds_read_b32 a209, v56
    ds_read_b128 a[104:107], v42 offset:0
    v_mfma_f32_16x16x32_bf16 v[204:207], a[224:227], a[48:51], v[204:207]
    ds_read_b128 a[108:111], v43 offset:0
    v_perm_b32 v57, v74, v35, s38
    v_mfma_f32_16x16x32_bf16 v[204:207], a[228:231], a[52:55], v[204:207]
    ds_read_b32 a210, v57
    ds_read_b128 a[112:115], v42 offset:16384
    v_mfma_f32_16x16x32_bf16 v[208:211], a[224:227], a[56:59], v[208:211]
    ds_read_b128 a[116:119], v43 offset:16384
    v_perm_b32 v58, v74, v35, s39
    v_mfma_f32_16x16x32_bf16 v[208:211], a[228:231], a[60:63], v[208:211]
    ds_read_b32 a211, v58
    v_perm_b32 v59, v78, v35, s36
    v_mfma_f32_16x16x32_bf16 v[212:215], a[224:227], a[64:67], v[212:215]
    ds_read_b32 a212, v59
    v_perm_b32 v60, v78, v35, s37
    v_mfma_f32_16x16x32_bf16 v[212:215], a[228:231], a[68:71], v[212:215]
    ds_read_b32 a213, v60
    v_perm_b32 v61, v78, v35, s38
    v_mfma_f32_16x16x32_bf16 v[216:219], a[224:227], a[72:75], v[216:219]
    ds_read_b32 a214, v61
    ds_read_b128 a[120:123], v40 offset:34816
    v_mfma_f32_16x16x32_bf16 v[216:219], a[228:231], a[76:79], v[216:219]
    ds_read_b128 a[124:127], v41 offset:34816
    v_perm_b32 v62, v78, v35, s39
    v_mfma_f32_16x16x32_bf16 v[220:223], a[224:227], a[80:83], v[220:223]
    ds_read_b32 a215, v62
    v_perm_b32 v63, v82, v35, s36
    v_mfma_f32_16x16x32_bf16 v[220:223], a[228:231], a[84:87], v[220:223]
    s_waitcnt lgkmcnt(10)
    v_perm_b32 v56, v82, v35, s37
    v_and_b32 v103, 0xffff0000, v68
    v_mfma_f32_16x16x32_bf16 v[224:227], a[232:235], a[90:93], v[224:227]
    s_mov_b32 s66, 0
    ds_read_b32 a216, v63
    v_and_b32 v104, 0xffff0000, v64
    v_mfma_f32_16x16x32_bf16 v[224:227], a[236:239], a[98:101], v[224:227]
    s_mov_b32 s67, 14336
    ds_read_b32 a217, v56
    v_perm_b32 v57, v82, v35, s38
    v_mfma_f32_16x16x32_bf16 v[128:131], a[240:243], a[88:91], v[128:131]
    ds_read_b128 a[128:131], v40 offset:51200
    v_perm_b32 v58, v82, v35, s39
    v_mfma_f32_16x16x32_bf16 v[128:131], a[244:247], a[92:95], v[128:131]
    ds_read_b32 a218, v57
    v_lshlrev_b32 v105, 16, v66
    v_mfma_f32_16x16x32_bf16 v[128:131], a[248:251], a[96:99], v[128:131]
    ds_read_b32 a219, v58
    v_perm_b32 v59, v86, v35, s36
    v_mfma_f32_16x16x32_bf16 v[128:131], a[252:255], a[100:103], v[128:131]
    ds_read_b128 a[132:135], v41 offset:51200
    v_perm_b32 v60, v86, v35, s37
    v_mfma_f32_16x16x32_bf16 v[160:163], a[136:139], a[88:91], v[160:163]
    ds_read_b32 a220, v59
    v_and_b32 v106, 0xffff0000, v67
    v_mfma_f32_16x16x32_bf16 v[160:163], a[140:143], a[92:95], v[160:163]
    ds_read_b32 a221, v60
    v_perm_b32 v61, v86, v35, s38
    v_mfma_f32_16x16x32_bf16 v[160:163], a[144:147], a[96:99], v[160:163]
    ds_read_b128 a[0:3], v42 offset:2048
    v_lshlrev_b32 v107, 16, v69
    v_mfma_f32_16x16x32_bf16 v[160:163], a[148:151], a[100:103], v[160:163]
    ds_read_b32 a222, v61
    v_perm_b32 v62, v86, v35, s39
    v_mfma_f32_16x16x32_bf16 v[192:195], a[152:155], a[88:91], v[192:195]
    v_lshlrev_b32 v108, 16, v65
    v_and_b32 v109, 0xffff0000, v66
    v_mfma_f32_16x16x32_bf16 v[192:195], a[156:159], a[92:95], v[192:195]
    ds_read_b32 a223, v62
    ds_read_b128 a[4:7], v43 offset:2048
    v_mfma_f32_16x16x32_bf16 v[192:195], a[160:163], a[96:99], v[192:195]
    v_lshlrev_b32 v110, 16, v68
    v_and_b32 v111, 0xffff0000, v69
    v_mfma_f32_16x16x32_bf16 v[192:195], a[164:167], a[100:103], v[192:195]
    v_mfma_f32_16x16x32_bf16 v[224:227], a[168:171], a[106:109], v[224:227]
    s_waitcnt lgkmcnt(6)
    v_mfma_f32_16x16x32_bf16 v[224:227], a[172:175], a[114:117], v[224:227]
    ds_read_b128 a[8:11], v42 offset:18432
    v_mfma_f32_16x16x32_bf16 v[128:131], a[176:179], a[104:107], v[128:131]
    v_mfma_f32_16x16x32_bf16 v[128:131], a[180:183], a[108:111], v[128:131]
    v_mov_b32 v8, 1
    v_min_u32 v9, 1, v0
    v_mfma_f32_16x16x32_bf16 v[128:131], a[184:187], a[112:115], v[128:131]
    ds_read_b128 a[12:15], v43 offset:18432
    v_lshlrev_b32 v9, 30, v9
    v_mfma_f32_16x16x32_bf16 v[128:131], a[188:191], a[116:119], v[128:131]
    ds_write_b64 v29, v[226:227] offset:0
    v_mfma_f32_16x16x32_bf16 v[160:163], a[192:195], a[104:107], v[160:163]
    buffer_atomic_add v8, v9, s[24:27], s77 offen sc0 sc1
    v_mfma_f32_16x16x32_bf16 v[160:163], a[196:199], a[108:111], v[160:163]
L_pad4:
    s_cbranch_execz L_warmed
    v_mfma_f32_16x16x32_bf16 v[160:163], a[200:203], a[112:115], v[160:163]
    ds_read_b128 a[16:19], v40 offset:36864
    v_mfma_f32_16x16x32_bf16 v[160:163], a[204:207], a[116:119], v[160:163]
    v_mul_f32 v128, v128, v100
    v_mul_f32 v129, v129, v101
    v_mfma_f32_16x16x32_bf16 v[192:195], a[208:211], a[104:107], v[192:195]
    s_waitcnt lgkmcnt(1)
    s_barrier
    v_mfma_f32_16x16x32_bf16 v[192:195], a[212:215], a[108:111], v[192:195]
    ds_read_b64 v[112:113], v30 offset:0
    ds_read_b128 a[20:23], v41 offset:36864
    v_mfma_f32_16x16x32_bf16 v[192:195], a[216:219], a[112:115], v[192:195]
    v_mul_f32 v130, v130, v102
    v_mul_f32 v131, v131, v103
    v_mfma_f32_16x16x32_bf16 v[192:195], a[220:223], a[116:119], v[192:195]
    v_mul_f32 v160, v160, v104
    v_cvt_pk_bf16_f32 v116, v128, v160
    v_mfma_f32_16x16x32_bf16 v[228:231], a[232:235], a[122:125], v[228:231]
    v_mul_f32 v161, v161, v105
    v_mul_f32 v162, v162, v106
    v_mfma_f32_16x16x32_bf16 v[228:231], a[236:239], a[130:133], v[228:231]
    ds_read_b128 a[24:27], v40 offset:53248
    v_cvt_pk_bf16_f32 v119, v130, v162
    v_mfma_f32_16x16x32_bf16 v[228:231], a[168:171], a[2:5], v[228:231]
    v_mul_f32 v163, v163, v107
    v_mfma_f32_16x16x32_bf16 v[228:231], a[172:175], a[10:13], v[228:231]
    v_mul_f32 v192, v192, v108
    v_mul_f32 v193, v193, v109
    v_mfma_f32_16x16x32_bf16 v[132:135], a[240:243], a[120:123], v[132:135]
    v_mul_f32 v194, v194, v110
    v_mul_f32 v195, v195, v111
    v_mfma_f32_16x16x32_bf16 v[132:135], a[244:247], a[124:127], v[132:135]
    v_cvt_pk_bf16_f32 v117, v192, v129
    v_cvt_pk_bf16_f32 v118, v161, v193
    v_mfma_f32_16x16x32_bf16 v[132:135], a[248:251], a[128:131], v[132:135]
    ds_write_b64 v26, v[116:117] offset:64512
    v_cvt_pk_bf16_f32 v120, v194, v131
    v_mfma_f32_16x16x32_bf16 v[132:135], a[252:255], a[132:135], v[132:135]
    ds_write_b64 v26, v[118:119] offset:64520
    v_cvt_pk_bf16_f32 v121, v163, v195
    v_mfma_f32_16x16x32_bf16 v[132:135], a[176:179], a[0:3], v[132:135]
    s_waitcnt lgkmcnt(3)
    ds_write_b64 v26, v[120:121] offset:64528
    v_add_f32 v224, v224, v112
    v_mfma_f32_16x16x32_bf16 v[132:135], a[180:183], a[4:7], v[132:135]
    ds_read_b128 a[28:31], v41 offset:53248
    v_mul_f32 v224, v224, v96
    v_mfma_f32_16x16x32_bf16 v[132:135], a[184:187], a[8:11], v[132:135]
    v_add_f32 v225, v225, v113
    v_mul_f32 v225, v225, v97
    v_mfma_f32_16x16x32_bf16 v[132:135], a[188:191], a[12:15], v[132:135]
    ds_write_b64 v29, v[230:231] offset:2048
    v_cvt_pk_bf16_f32 v112, v224, v225
    v_mfma_f32_16x16x32_bf16 v[164:167], a[136:139], a[120:123], v[164:167]
    ds_write_b32 v28, v112 offset:64512
    v_mfma_f32_16x16x32_bf16 v[164:167], a[140:143], a[124:127], v[164:167]
    ds_read_b128 a[32:35], v42 offset:4096
    v_mfma_f32_16x16x32_bf16 v[164:167], a[144:147], a[128:131], v[164:167]
    ds_read_b128 a[36:39], v43 offset:4096
    v_mfma_f32_16x16x32_bf16 v[164:167], a[148:151], a[132:135], v[164:167]
    ds_read_b128 a[40:43], v42 offset:20480
    v_mul_f32 v132, v132, v100
    v_mfma_f32_16x16x32_bf16 v[164:167], a[192:195], a[0:3], v[164:167]
    v_mul_f32 v133, v133, v101
    v_mul_f32 v134, v134, v102
    v_mfma_f32_16x16x32_bf16 v[164:167], a[196:199], a[4:7], v[164:167]
    s_waitcnt lgkmcnt(3)
    s_barrier
    v_mfma_f32_16x16x32_bf16 v[164:167], a[200:203], a[8:11], v[164:167]
    ds_read_b128 v[124:127], v24 offset:64512
    ds_read_b64 v[88:89], v30 offset:2048
    v_mfma_f32_16x16x32_bf16 v[164:167], a[204:207], a[12:15], v[164:167]
    ds_read_b128 a[44:47], v43 offset:20480
    v_mul_f32 v135, v135, v103
    v_mfma_f32_16x16x32_bf16 v[196:199], a[152:155], a[120:123], v[196:199]
    ds_read_b128 v[92:95], v24 offset:65440
    v_mfma_f32_16x16x32_bf16 v[196:199], a[156:159], a[124:127], v[196:199]
    v_mfma_f32_16x16x32_bf16 v[196:199], a[160:163], a[128:131], v[196:199]
    ds_read_b128 a[48:51], v40 offset:38912
    v_mfma_f32_16x16x32_bf16 v[196:199], a[164:167], a[132:135], v[196:199]
    v_mul_f32 v164, v164, v104
    v_cvt_pk_bf16_f32 v48, v132, v164
    v_mfma_f32_16x16x32_bf16 v[196:199], a[208:211], a[0:3], v[196:199]
    s_waitcnt lgkmcnt(3)
    v_mul_f32 v165, v165, v105
    v_mfma_f32_16x16x32_bf16 v[196:199], a[212:215], a[4:7], v[196:199]
    buffer_store_dwordx4 v[124:127], v25, s[16:19], s66 offen sc1
    v_mfma_f32_16x16x32_bf16 v[196:199], a[216:219], a[8:11], v[196:199]
    s_mov_b32 s66, 114688
    v_add_f32 v228, v228, v88
    v_mul_f32 v228, v228, v96
    v_mfma_f32_16x16x32_bf16 v[196:199], a[220:223], a[12:15], v[196:199]
    v_add_f32 v229, v229, v89
    v_mul_f32 v229, v229, v97
    v_mfma_f32_16x16x32_bf16 v[232:235], a[232:235], a[18:21], v[232:235]
    s_waitcnt lgkmcnt(1)
    ds_read_b128 a[52:55], v41 offset:38912
    v_mfma_f32_16x16x32_bf16 v[232:235], a[236:239], a[26:29], v[232:235]
    buffer_store_dwordx4 v[92:95], v25, s[16:19], s67 offen sc1
    v_mfma_f32_16x16x32_bf16 v[232:235], a[168:171], a[34:37], v[232:235]
    s_mov_b32 s67, 129024
    v_cvt_pk_bf16_f32 v88, v228, v229
    v_mul_f32 v166, v166, v106
    v_mfma_f32_16x16x32_bf16 v[232:235], a[172:175], a[42:45], v[232:235]
    ds_write_b32 v28, v88 offset:0
    v_cvt_pk_bf16_f32 v51, v134, v166
    v_mfma_f32_16x16x32_bf16 v[136:139], a[240:243], a[16:19], v[136:139]
    v_mul_f32 v167, v167, v107
    v_mul_f32 v196, v196, v108
    v_mfma_f32_16x16x32_bf16 v[136:139], a[244:247], a[20:23], v[136:139]
    v_mul_f32 v197, v197, v109
    v_mul_f32 v198, v198, v110
    v_mfma_f32_16x16x32_bf16 v[136:139], a[248:251], a[24:27], v[136:139]
    ds_read_b128 a[56:59], v40 offset:55296
    v_mul_f32 v199, v199, v111
    v_mfma_f32_16x16x32_bf16 v[136:139], a[252:255], a[28:31], v[136:139]
    v_cvt_pk_bf16_f32 v49, v196, v133
    v_cvt_pk_bf16_f32 v50, v165, v197
    v_mfma_f32_16x16x32_bf16 v[136:139], a[176:179], a[32:35], v[136:139]
    ds_write_b64 v26, v[48:49] offset:0
    v_cvt_pk_bf16_f32 v52, v198, v135
    v_mfma_f32_16x16x32_bf16 v[136:139], a[180:183], a[36:39], v[136:139]
    ds_read_b128 a[60:63], v41 offset:55296
    v_cvt_pk_bf16_f32 v53, v167, v199
    v_mfma_f32_16x16x32_bf16 v[136:139], a[184:187], a[40:43], v[136:139]
    ds_write_b64 v26, v[50:51] offset:8
    v_mfma_f32_16x16x32_bf16 v[136:139], a[188:191], a[44:47], v[136:139]
    ds_write_b64 v26, v[52:53] offset:16
    v_mfma_f32_16x16x32_bf16 v[168:171], a[136:139], a[16:19], v[168:171]
    ds_write_b64 v29, v[234:235] offset:4096
    v_mfma_f32_16x16x32_bf16 v[168:171], a[140:143], a[20:23], v[168:171]
    ds_read_b128 a[64:67], v42 offset:6144
    v_mfma_f32_16x16x32_bf16 v[168:171], a[144:147], a[24:27], v[168:171]
    ds_read_b128 a[68:71], v43 offset:6144
    v_mfma_f32_16x16x32_bf16 v[168:171], a[148:151], a[28:31], v[168:171]
    ds_read_b128 a[72:75], v42 offset:22528
    v_mul_f32 v136, v136, v100
    v_mfma_f32_16x16x32_bf16 v[168:171], a[192:195], a[32:35], v[168:171]
    v_mul_f32 v137, v137, v101
    v_mul_f32 v138, v138, v102
    v_mfma_f32_16x16x32_bf16 v[168:171], a[196:199], a[36:39], v[168:171]
    s_waitcnt lgkmcnt(3)
    s_barrier
    v_mfma_f32_16x16x32_bf16 v[168:171], a[200:203], a[40:43], v[168:171]
    ds_read_b128 v[72:75], v24 offset:0
    ds_read_b64 v[76:77], v30 offset:4096
    v_mfma_f32_16x16x32_bf16 v[168:171], a[204:207], a[44:47], v[168:171]
    ds_read_b128 a[76:79], v43 offset:22528
    v_mul_f32 v139, v139, v103
    v_mfma_f32_16x16x32_bf16 v[200:203], a[152:155], a[16:19], v[200:203]
    ds_read_b128 v[80:83], v24 offset:928
    v_mfma_f32_16x16x32_bf16 v[200:203], a[156:159], a[20:23], v[200:203]
    v_mfma_f32_16x16x32_bf16 v[200:203], a[160:163], a[24:27], v[200:203]
    ds_read_b128 a[80:83], v40 offset:40960
    v_mfma_f32_16x16x32_bf16 v[200:203], a[164:167], a[28:31], v[200:203]
    v_mul_f32 v168, v168, v104
    v_cvt_pk_bf16_f32 v84, v136, v168
    v_mfma_f32_16x16x32_bf16 v[200:203], a[208:211], a[32:35], v[200:203]
    s_waitcnt lgkmcnt(3)
    v_mul_f32 v169, v169, v105
    v_mfma_f32_16x16x32_bf16 v[200:203], a[212:215], a[36:39], v[200:203]
    buffer_store_dwordx4 v[72:75], v25, s[16:19], s66 offen sc1
    v_mfma_f32_16x16x32_bf16 v[200:203], a[216:219], a[40:43], v[200:203]
    s_mov_b32 s66, 229376
    v_add_f32 v232, v232, v76
    v_mul_f32 v232, v232, v96
    v_mfma_f32_16x16x32_bf16 v[200:203], a[220:223], a[44:47], v[200:203]
    v_add_f32 v233, v233, v77
    v_mul_f32 v233, v233, v97
    v_mfma_f32_16x16x32_bf16 v[236:239], a[232:235], a[50:53], v[236:239]
    s_waitcnt lgkmcnt(1)
    ds_read_b128 a[84:87], v41 offset:40960
    v_mfma_f32_16x16x32_bf16 v[236:239], a[236:239], a[58:61], v[236:239]
    buffer_store_dwordx4 v[80:83], v25, s[16:19], s67 offen sc1
    v_mfma_f32_16x16x32_bf16 v[236:239], a[168:171], a[66:69], v[236:239]
    s_mov_b32 s67, 243712
    v_cvt_pk_bf16_f32 v76, v232, v233
    v_mul_f32 v170, v170, v106
    v_mfma_f32_16x16x32_bf16 v[236:239], a[172:175], a[74:77], v[236:239]
    ds_write_b32 v28, v76 offset:7424
    v_cvt_pk_bf16_f32 v87, v138, v170
    v_mfma_f32_16x16x32_bf16 v[140:143], a[240:243], a[48:51], v[140:143]
    v_mul_f32 v171, v171, v107
    v_mul_f32 v200, v200, v108
    v_mfma_f32_16x16x32_bf16 v[140:143], a[244:247], a[52:55], v[140:143]
    v_mul_f32 v201, v201, v109
    v_mul_f32 v202, v202, v110
    v_mfma_f32_16x16x32_bf16 v[140:143], a[248:251], a[56:59], v[140:143]
    ds_read_b128 a[88:91], v40 offset:57344
    v_mul_f32 v203, v203, v111
    v_mfma_f32_16x16x32_bf16 v[140:143], a[252:255], a[60:63], v[140:143]
    v_cvt_pk_bf16_f32 v85, v200, v137
    v_cvt_pk_bf16_f32 v86, v169, v201
    v_mfma_f32_16x16x32_bf16 v[140:143], a[176:179], a[64:67], v[140:143]
    ds_write_b64 v26, v[84:85] offset:7424
    v_cvt_pk_bf16_f32 v64, v202, v139
    v_mfma_f32_16x16x32_bf16 v[140:143], a[180:183], a[68:71], v[140:143]
    ds_read_b128 a[92:95], v41 offset:57344
    v_cvt_pk_bf16_f32 v65, v171, v203
    v_mfma_f32_16x16x32_bf16 v[140:143], a[184:187], a[72:75], v[140:143]
    ds_write_b64 v26, v[86:87] offset:7432
    v_mfma_f32_16x16x32_bf16 v[140:143], a[188:191], a[76:79], v[140:143]
    ds_write_b64 v26, v[64:65] offset:7440
    v_mfma_f32_16x16x32_bf16 v[172:175], a[136:139], a[48:51], v[172:175]
    ds_write_b64 v29, v[238:239] offset:6144
    v_mfma_f32_16x16x32_bf16 v[172:175], a[140:143], a[52:55], v[172:175]
    ds_read_b128 a[96:99], v42 offset:8192
    v_mfma_f32_16x16x32_bf16 v[172:175], a[144:147], a[56:59], v[172:175]
    ds_read_b128 a[100:103], v43 offset:8192
    v_mfma_f32_16x16x32_bf16 v[172:175], a[148:151], a[60:63], v[172:175]
    ds_read_b128 a[104:107], v42 offset:24576
    v_mul_f32 v140, v140, v100
    v_mfma_f32_16x16x32_bf16 v[172:175], a[192:195], a[64:67], v[172:175]
    v_mul_f32 v141, v141, v101
    v_mul_f32 v142, v142, v102
    v_mfma_f32_16x16x32_bf16 v[172:175], a[196:199], a[68:71], v[172:175]
    s_waitcnt lgkmcnt(3)
    s_barrier
    v_mfma_f32_16x16x32_bf16 v[172:175], a[200:203], a[72:75], v[172:175]
    ds_read_b128 v[68:71], v24 offset:7424
    ds_read_b64 v[116:117], v30 offset:6144
    v_mfma_f32_16x16x32_bf16 v[172:175], a[204:207], a[76:79], v[172:175]
    ds_read_b128 a[108:111], v43 offset:24576
    v_mul_f32 v143, v143, v103
    v_mfma_f32_16x16x32_bf16 v[204:207], a[152:155], a[48:51], v[204:207]
    ds_read_b128 v[120:123], v24 offset:8352
    v_mfma_f32_16x16x32_bf16 v[204:207], a[156:159], a[52:55], v[204:207]
    v_mfma_f32_16x16x32_bf16 v[204:207], a[160:163], a[56:59], v[204:207]
    ds_read_b128 a[112:115], v40 offset:43008
    v_mfma_f32_16x16x32_bf16 v[204:207], a[164:167], a[60:63], v[204:207]
    v_mul_f32 v172, v172, v104
    v_cvt_pk_bf16_f32 v112, v140, v172
    v_mfma_f32_16x16x32_bf16 v[204:207], a[208:211], a[64:67], v[204:207]
    s_waitcnt lgkmcnt(3)
    v_mul_f32 v173, v173, v105
    v_mfma_f32_16x16x32_bf16 v[204:207], a[212:215], a[68:71], v[204:207]
    buffer_store_dwordx4 v[68:71], v25, s[16:19], s66 offen sc1
    v_mfma_f32_16x16x32_bf16 v[204:207], a[216:219], a[72:75], v[204:207]
    s_mov_b32 s66, 344064
    v_add_f32 v236, v236, v116
    v_mul_f32 v236, v236, v96
    v_mfma_f32_16x16x32_bf16 v[204:207], a[220:223], a[76:79], v[204:207]
    v_add_f32 v237, v237, v117
    v_mul_f32 v237, v237, v97
    v_mfma_f32_16x16x32_bf16 v[240:243], a[232:235], a[82:85], v[240:243]
    s_waitcnt lgkmcnt(1)
    ds_read_b128 a[116:119], v41 offset:43008
    v_mfma_f32_16x16x32_bf16 v[240:243], a[236:239], a[90:93], v[240:243]
    buffer_store_dwordx4 v[120:123], v25, s[16:19], s67 offen sc1
    v_mfma_f32_16x16x32_bf16 v[240:243], a[168:171], a[98:101], v[240:243]
    s_mov_b32 s67, 358400
    v_cvt_pk_bf16_f32 v116, v236, v237
    v_mul_f32 v174, v174, v106
    v_mfma_f32_16x16x32_bf16 v[240:243], a[172:175], a[106:109], v[240:243]
    ds_write_b32 v28, v116 offset:14848
    v_cvt_pk_bf16_f32 v115, v142, v174
    v_mfma_f32_16x16x32_bf16 v[144:147], a[240:243], a[80:83], v[144:147]
    v_mul_f32 v175, v175, v107
    v_mul_f32 v204, v204, v108
    v_mfma_f32_16x16x32_bf16 v[144:147], a[244:247], a[84:87], v[144:147]
    v_mul_f32 v205, v205, v109
    v_mul_f32 v206, v206, v110
    v_mfma_f32_16x16x32_bf16 v[144:147], a[248:251], a[88:91], v[144:147]
    ds_read_b128 a[120:123], v40 offset:59392
    v_mul_f32 v207, v207, v111
    v_mfma_f32_16x16x32_bf16 v[144:147], a[252:255], a[92:95], v[144:147]
    v_cvt_pk_bf16_f32 v113, v204, v141
    v_cvt_pk_bf16_f32 v114, v173, v205
    v_mfma_f32_16x16x32_bf16 v[144:147], a[176:179], a[96:99], v[144:147]
    ds_write_b64 v26, v[112:113] offset:14848
    v_cvt_pk_bf16_f32 v124, v206, v143
    v_mfma_f32_16x16x32_bf16 v[144:147], a[180:183], a[100:103], v[144:147]
    ds_read_b128 a[124:127], v41 offset:59392
    v_cvt_pk_bf16_f32 v125, v175, v207
    v_mfma_f32_16x16x32_bf16 v[144:147], a[184:187], a[104:107], v[144:147]
    ds_write_b64 v26, v[114:115] offset:14856
    v_mfma_f32_16x16x32_bf16 v[144:147], a[188:191], a[108:111], v[144:147]
    ds_write_b64 v26, v[124:125] offset:14864
    v_mfma_f32_16x16x32_bf16 v[176:179], a[136:139], a[80:83], v[176:179]
    ds_write_b64 v29, v[242:243] offset:8192
    v_mfma_f32_16x16x32_bf16 v[176:179], a[140:143], a[84:87], v[176:179]
    ds_read_b128 a[128:131], v42 offset:10240
    v_mfma_f32_16x16x32_bf16 v[176:179], a[144:147], a[88:91], v[176:179]
    ds_read_b128 a[132:135], v43 offset:10240
    v_mfma_f32_16x16x32_bf16 v[176:179], a[148:151], a[92:95], v[176:179]
    ds_read_b128 a[0:3], v42 offset:26624
    v_mul_f32 v144, v144, v100
    v_mfma_f32_16x16x32_bf16 v[176:179], a[192:195], a[96:99], v[176:179]
    v_mul_f32 v145, v145, v101
    v_mul_f32 v146, v146, v102
    v_mfma_f32_16x16x32_bf16 v[176:179], a[196:199], a[100:103], v[176:179]
    s_waitcnt lgkmcnt(3)
    s_barrier
    v_mfma_f32_16x16x32_bf16 v[176:179], a[200:203], a[104:107], v[176:179]
    ds_read_b128 v[92:95], v24 offset:14848
    ds_read_b64 v[88:89], v30 offset:8192
    v_mfma_f32_16x16x32_bf16 v[176:179], a[204:207], a[108:111], v[176:179]
    ds_read_b128 a[4:7], v43 offset:26624
    v_mul_f32 v147, v147, v103
    v_mfma_f32_16x16x32_bf16 v[208:211], a[152:155], a[80:83], v[208:211]
    ds_read_b128 v[48:51], v24 offset:15776
    v_mfma_f32_16x16x32_bf16 v[208:211], a[156:159], a[84:87], v[208:211]
    v_mfma_f32_16x16x32_bf16 v[208:211], a[160:163], a[88:91], v[208:211]
    ds_read_b128 a[8:11], v40 offset:45056
    v_mfma_f32_16x16x32_bf16 v[208:211], a[164:167], a[92:95], v[208:211]
    v_mul_f32 v176, v176, v104
    v_cvt_pk_bf16_f32 v52, v144, v176
    v_mfma_f32_16x16x32_bf16 v[208:211], a[208:211], a[96:99], v[208:211]
    s_waitcnt lgkmcnt(3)
    v_mul_f32 v177, v177, v105
    v_mfma_f32_16x16x32_bf16 v[208:211], a[212:215], a[100:103], v[208:211]
    buffer_store_dwordx4 v[92:95], v25, s[16:19], s66 offen sc1
    v_mfma_f32_16x16x32_bf16 v[208:211], a[216:219], a[104:107], v[208:211]
    s_mov_b32 s66, 458752
    v_add_f32 v240, v240, v88
    v_mul_f32 v240, v240, v96
    v_mfma_f32_16x16x32_bf16 v[208:211], a[220:223], a[108:111], v[208:211]
    v_add_f32 v241, v241, v89
    v_mul_f32 v241, v241, v97
    v_mfma_f32_16x16x32_bf16 v[244:247], a[232:235], a[114:117], v[244:247]
    s_waitcnt lgkmcnt(1)
    ds_read_b128 a[12:15], v41 offset:45056
    v_mfma_f32_16x16x32_bf16 v[244:247], a[236:239], a[122:125], v[244:247]
    buffer_store_dwordx4 v[48:51], v25, s[16:19], s67 offen sc1
    v_mfma_f32_16x16x32_bf16 v[244:247], a[168:171], a[130:133], v[244:247]
    s_mov_b32 s67, 473088
    v_cvt_pk_bf16_f32 v88, v240, v241
    v_mul_f32 v178, v178, v106
    v_mfma_f32_16x16x32_bf16 v[244:247], a[172:175], a[2:5], v[244:247]
    ds_write_b32 v28, v88 offset:22272
    v_cvt_pk_bf16_f32 v55, v146, v178
    v_mfma_f32_16x16x32_bf16 v[148:151], a[240:243], a[112:115], v[148:151]
    v_mul_f32 v179, v179, v107
    v_mul_f32 v208, v208, v108
    v_mfma_f32_16x16x32_bf16 v[148:151], a[244:247], a[116:119], v[148:151]
    v_mul_f32 v209, v209, v109
    v_mul_f32 v210, v210, v110
    v_mfma_f32_16x16x32_bf16 v[148:151], a[248:251], a[120:123], v[148:151]
    ds_read_b128 a[16:19], v40 offset:61440
    v_mul_f32 v211, v211, v111
    v_mfma_f32_16x16x32_bf16 v[148:151], a[252:255], a[124:127], v[148:151]
    v_cvt_pk_bf16_f32 v53, v208, v145
    v_cvt_pk_bf16_f32 v54, v177, v209
    v_mfma_f32_16x16x32_bf16 v[148:151], a[176:179], a[128:131], v[148:151]
    ds_write_b64 v26, v[52:53] offset:22272
    v_cvt_pk_bf16_f32 v72, v210, v147
    v_mfma_f32_16x16x32_bf16 v[148:151], a[180:183], a[132:135], v[148:151]
    ds_read_b128 a[20:23], v41 offset:61440
    v_cvt_pk_bf16_f32 v73, v179, v211
    v_mfma_f32_16x16x32_bf16 v[148:151], a[184:187], a[0:3], v[148:151]
    ds_write_b64 v26, v[54:55] offset:22280
    v_mfma_f32_16x16x32_bf16 v[148:151], a[188:191], a[4:7], v[148:151]
    ds_write_b64 v26, v[72:73] offset:22288
    v_mfma_f32_16x16x32_bf16 v[180:183], a[136:139], a[112:115], v[180:183]
    ds_write_b64 v29, v[246:247] offset:10240
    v_mfma_f32_16x16x32_bf16 v[180:183], a[140:143], a[116:119], v[180:183]
    ds_read_b128 a[24:27], v42 offset:12288
    v_mfma_f32_16x16x32_bf16 v[180:183], a[144:147], a[120:123], v[180:183]
    ds_read_b128 a[28:31], v43 offset:12288
    v_mfma_f32_16x16x32_bf16 v[180:183], a[148:151], a[124:127], v[180:183]
    ds_read_b128 a[32:35], v42 offset:28672
    v_mul_f32 v148, v148, v100
    v_mfma_f32_16x16x32_bf16 v[180:183], a[192:195], a[128:131], v[180:183]
    v_mul_f32 v149, v149, v101
    v_mul_f32 v150, v150, v102
    v_mfma_f32_16x16x32_bf16 v[180:183], a[196:199], a[132:135], v[180:183]
    s_waitcnt lgkmcnt(3)
    s_barrier
    v_mfma_f32_16x16x32_bf16 v[180:183], a[200:203], a[0:3], v[180:183]
    ds_read_b128 v[80:83], v24 offset:22272
    ds_read_b64 v[76:77], v30 offset:10240
    v_mfma_f32_16x16x32_bf16 v[180:183], a[204:207], a[4:7], v[180:183]
    ds_read_b128 a[36:39], v43 offset:28672
    v_mul_f32 v151, v151, v103
    v_mfma_f32_16x16x32_bf16 v[212:215], a[152:155], a[112:115], v[212:215]
    ds_read_b128 v[84:87], v24 offset:23200
    v_mfma_f32_16x16x32_bf16 v[212:215], a[156:159], a[116:119], v[212:215]
    v_mfma_f32_16x16x32_bf16 v[212:215], a[160:163], a[120:123], v[212:215]
    ds_read_b128 a[40:43], v40 offset:47104
    v_mfma_f32_16x16x32_bf16 v[212:215], a[164:167], a[124:127], v[212:215]
    v_mul_f32 v180, v180, v104
    v_cvt_pk_bf16_f32 v64, v148, v180
    v_mfma_f32_16x16x32_bf16 v[212:215], a[208:211], a[128:131], v[212:215]
    s_waitcnt lgkmcnt(3)
    v_mul_f32 v181, v181, v105
    v_mfma_f32_16x16x32_bf16 v[212:215], a[212:215], a[132:135], v[212:215]
    buffer_store_dwordx4 v[80:83], v25, s[16:19], s66 offen sc1
    v_mfma_f32_16x16x32_bf16 v[212:215], a[216:219], a[0:3], v[212:215]
    s_mov_b32 s66, 573440
    v_add_f32 v244, v244, v76
    v_mul_f32 v244, v244, v96
    v_mfma_f32_16x16x32_bf16 v[212:215], a[220:223], a[4:7], v[212:215]
    v_add_f32 v245, v245, v77
    v_mul_f32 v245, v245, v97
    v_mfma_f32_16x16x32_bf16 v[248:251], a[232:235], a[10:13], v[248:251]
    s_waitcnt lgkmcnt(1)
    ds_read_b128 a[44:47], v41 offset:47104
    v_mfma_f32_16x16x32_bf16 v[248:251], a[236:239], a[18:21], v[248:251]
    buffer_store_dwordx4 v[84:87], v25, s[16:19], s67 offen sc1
    v_mfma_f32_16x16x32_bf16 v[248:251], a[168:171], a[26:29], v[248:251]
    s_mov_b32 s67, 587776
    v_cvt_pk_bf16_f32 v76, v244, v245
    v_mul_f32 v182, v182, v106
    v_mfma_f32_16x16x32_bf16 v[248:251], a[172:175], a[34:37], v[248:251]
    ds_write_b32 v28, v76 offset:29696
    v_cvt_pk_bf16_f32 v67, v150, v182
    v_mfma_f32_16x16x32_bf16 v[152:155], a[240:243], a[8:11], v[152:155]
    v_mul_f32 v183, v183, v107
    v_mul_f32 v212, v212, v108
    v_mfma_f32_16x16x32_bf16 v[152:155], a[244:247], a[12:15], v[152:155]
    v_mul_f32 v213, v213, v109
    v_mul_f32 v214, v214, v110
    v_mfma_f32_16x16x32_bf16 v[152:155], a[248:251], a[16:19], v[152:155]
    ds_read_b128 a[48:51], v40 offset:63488
    v_mul_f32 v215, v215, v111
    v_mfma_f32_16x16x32_bf16 v[152:155], a[252:255], a[20:23], v[152:155]
    v_cvt_pk_bf16_f32 v65, v212, v149
    v_cvt_pk_bf16_f32 v66, v181, v213
    v_mfma_f32_16x16x32_bf16 v[152:155], a[176:179], a[24:27], v[152:155]
    ds_write_b64 v26, v[64:65] offset:29696
    v_cvt_pk_bf16_f32 v68, v214, v151
    v_mfma_f32_16x16x32_bf16 v[152:155], a[180:183], a[28:31], v[152:155]
    ds_read_b128 a[52:55], v41 offset:63488
    v_cvt_pk_bf16_f32 v69, v183, v215
    v_mfma_f32_16x16x32_bf16 v[152:155], a[184:187], a[32:35], v[152:155]
    ds_write_b64 v26, v[66:67] offset:29704
    v_mfma_f32_16x16x32_bf16 v[152:155], a[188:191], a[36:39], v[152:155]
    ds_write_b64 v26, v[68:69] offset:29712
    v_mfma_f32_16x16x32_bf16 v[184:187], a[136:139], a[8:11], v[184:187]
    ds_write_b64 v29, v[250:251] offset:12288
    v_mfma_f32_16x16x32_bf16 v[184:187], a[140:143], a[12:15], v[184:187]
    ds_read_b128 a[56:59], v42 offset:14336
    v_mfma_f32_16x16x32_bf16 v[184:187], a[144:147], a[16:19], v[184:187]
    ds_read_b128 a[60:63], v43 offset:14336
    v_mfma_f32_16x16x32_bf16 v[184:187], a[148:151], a[20:23], v[184:187]
    ds_read_b128 a[64:67], v42 offset:30720
    v_mul_f32 v152, v152, v100
    v_mfma_f32_16x16x32_bf16 v[184:187], a[192:195], a[24:27], v[184:187]
    v_mul_f32 v153, v153, v101
    v_mul_f32 v154, v154, v102
    v_mfma_f32_16x16x32_bf16 v[184:187], a[196:199], a[28:31], v[184:187]
    s_waitcnt lgkmcnt(3)
    s_barrier
    v_mfma_f32_16x16x32_bf16 v[184:187], a[200:203], a[32:35], v[184:187]
    ds_read_b128 v[120:123], v24 offset:29696
    ds_read_b64 v[116:117], v30 offset:12288
    v_mfma_f32_16x16x32_bf16 v[184:187], a[204:207], a[36:39], v[184:187]
    ds_read_b128 a[68:71], v43 offset:30720
    v_mul_f32 v155, v155, v103
    v_mfma_f32_16x16x32_bf16 v[216:219], a[152:155], a[8:11], v[216:219]
    ds_read_b128 v[112:115], v24 offset:30624
    v_mfma_f32_16x16x32_bf16 v[216:219], a[156:159], a[12:15], v[216:219]
    v_mfma_f32_16x16x32_bf16 v[216:219], a[160:163], a[16:19], v[216:219]
    v_mfma_f32_16x16x32_bf16 v[216:219], a[164:167], a[20:23], v[216:219]
    v_mul_f32 v184, v184, v104
    v_cvt_pk_bf16_f32 v124, v152, v184
    v_mfma_f32_16x16x32_bf16 v[216:219], a[208:211], a[24:27], v[216:219]
    s_waitcnt lgkmcnt(2)
    v_mul_f32 v185, v185, v105
    v_mfma_f32_16x16x32_bf16 v[216:219], a[212:215], a[28:31], v[216:219]
    buffer_store_dwordx4 v[120:123], v25, s[16:19], s66 offen sc1
    v_mfma_f32_16x16x32_bf16 v[216:219], a[216:219], a[32:35], v[216:219]
    s_mov_b32 s66, 688128
    v_add_f32 v248, v248, v116
    v_mul_f32 v248, v248, v96
    v_mfma_f32_16x16x32_bf16 v[216:219], a[220:223], a[36:39], v[216:219]
    v_add_f32 v249, v249, v117
    v_mul_f32 v249, v249, v97
    v_mfma_f32_16x16x32_bf16 v[252:255], a[232:235], a[42:45], v[252:255]
    s_waitcnt lgkmcnt(0)
    v_cvt_pk_bf16_f32 v116, v248, v249
    v_mfma_f32_16x16x32_bf16 v[252:255], a[236:239], a[50:53], v[252:255]
    buffer_store_dwordx4 v[112:115], v25, s[16:19], s67 offen sc1
    v_mfma_f32_16x16x32_bf16 v[252:255], a[168:171], a[58:61], v[252:255]
    s_mov_b32 s67, 702464
    ds_write_b32 v28, v116 offset:37120
    v_mul_f32 v186, v186, v106
    v_mfma_f32_16x16x32_bf16 v[252:255], a[172:175], a[66:69], v[252:255]
    v_cvt_pk_bf16_f32 v127, v154, v186
    v_mul_f32 v187, v187, v107
    v_mfma_f32_16x16x32_bf16 v[156:159], a[240:243], a[40:43], v[156:159]
    v_mul_f32 v216, v216, v108
    v_mul_f32 v217, v217, v109
    v_mfma_f32_16x16x32_bf16 v[156:159], a[244:247], a[44:47], v[156:159]
    v_mul_f32 v218, v218, v110
    v_mul_f32 v219, v219, v111
    v_mfma_f32_16x16x32_bf16 v[156:159], a[248:251], a[48:51], v[156:159]
    v_cvt_pk_bf16_f32 v125, v216, v153
    v_cvt_pk_bf16_f32 v126, v185, v217
    v_mfma_f32_16x16x32_bf16 v[156:159], a[252:255], a[52:55], v[156:159]
    ds_write_b64 v26, v[124:125] offset:37120
    v_cvt_pk_bf16_f32 v92, v218, v155
    v_mfma_f32_16x16x32_bf16 v[156:159], a[176:179], a[56:59], v[156:159]
    ds_write_b64 v26, v[126:127] offset:37128
    v_cvt_pk_bf16_f32 v93, v187, v219
    v_mfma_f32_16x16x32_bf16 v[156:159], a[180:183], a[60:63], v[156:159]
    s_waitcnt vmcnt(12)
    ds_write_b64 v26, v[92:93] offset:37136
    v_xor_b32 v8, 15, v8
    v_mfma_f32_16x16x32_bf16 v[156:159], a[184:187], a[64:67], v[156:159]
    ds_write_b64 v29, v[254:255] offset:14336
    v_or_b32 v8, v8, v0
    v_mfma_f32_16x16x32_bf16 v[156:159], a[188:191], a[68:71], v[156:159]
    v_min_u32 v8, 1, v8
    v_lshlrev_b32 v8, 30, v8
    v_mfma_f32_16x16x32_bf16 v[188:191], a[136:139], a[40:43], v[188:191]
    v_mov_b32 v9, s76
    v_mfma_f32_16x16x32_bf16 v[188:191], a[140:143], a[44:47], v[188:191]
    buffer_store_dword v9, v8, s[12:15], s78 offen sc1
    v_mfma_f32_16x16x32_bf16 v[188:191], a[144:147], a[48:51], v[188:191]
    v_mfma_f32_16x16x32_bf16 v[188:191], a[148:151], a[52:55], v[188:191]
    s_waitcnt lgkmcnt(0)
    s_barrier
    v_mfma_f32_16x16x32_bf16 v[188:191], a[192:195], a[56:59], v[188:191]
    ds_read_b128 v[48:51], v24 offset:37120
    ds_read_b64 v[88:89], v30 offset:14336
    v_mfma_f32_16x16x32_bf16 v[188:191], a[196:199], a[60:63], v[188:191]
    ds_read_b128 v[52:55], v24 offset:38048
    v_mul_f32 v156, v156, v100
    v_mfma_f32_16x16x32_bf16 v[188:191], a[200:203], a[64:67], v[188:191]
    v_mul_f32 v157, v157, v101
    v_mul_f32 v158, v158, v102
    v_mfma_f32_16x16x32_bf16 v[188:191], a[204:207], a[68:71], v[188:191]
    v_mul_f32 v159, v159, v103
    v_mfma_f32_16x16x32_bf16 v[220:223], a[152:155], a[40:43], v[220:223]
    v_mfma_f32_16x16x32_bf16 v[220:223], a[156:159], a[44:47], v[220:223]
    v_mfma_f32_16x16x32_bf16 v[220:223], a[160:163], a[48:51], v[220:223]
    s_waitcnt lgkmcnt(1)
    v_mfma_f32_16x16x32_bf16 v[220:223], a[164:167], a[52:55], v[220:223]
    buffer_store_dwordx4 v[48:51], v25, s[16:19], s66 offen sc1
    v_mfma_f32_16x16x32_bf16 v[220:223], a[208:211], a[56:59], v[220:223]
    s_mov_b32 s66, 802816
    v_add_f32 v252, v252, v88
    v_mul_f32 v252, v252, v96
    v_mfma_f32_16x16x32_bf16 v[220:223], a[212:215], a[60:63], v[220:223]
    v_add_f32 v253, v253, v89
    v_mul_f32 v253, v253, v97
    v_mfma_f32_16x16x32_bf16 v[220:223], a[216:219], a[64:67], v[220:223]
    s_waitcnt lgkmcnt(0)
    v_cvt_pk_bf16_f32 v88, v252, v253
    v_mfma_f32_16x16x32_bf16 v[220:223], a[220:223], a[68:71], v[220:223]
    buffer_store_dwordx4 v[52:55], v25, s[16:19], s67 offen sc1
    s_mov_b32 s67, 817152
    ds_write_b32 v28, v88 offset:44544
    v_mul_f32 v188, v188, v104
    v_cvt_pk_bf16_f32 v72, v156, v188
    v_mul_f32 v189, v189, v105
    v_mul_f32 v190, v190, v106
    v_cvt_pk_bf16_f32 v75, v158, v190
    v_mul_f32 v191, v191, v107
    v_mul_f32 v220, v220, v108
    v_mul_f32 v221, v221, v109
    v_mul_f32 v222, v222, v110
    v_mul_f32 v223, v223, v111
    v_cvt_pk_bf16_f32 v73, v220, v157
    v_cvt_pk_bf16_f32 v74, v189, v221
    v_cvt_pk_bf16_f32 v80, v222, v159
    v_cvt_pk_bf16_f32 v81, v191, v223
    ds_write_b64 v26, v[72:73] offset:44544
    ds_write_b64 v26, v[74:75] offset:44552
    ds_write_b64 v26, v[80:81] offset:44560
    s_waitcnt lgkmcnt(0)
    s_barrier
    ds_read_b128 v[84:87], v24 offset:44544
    ds_read_b128 v[76:79], v24 offset:45472
    s_waitcnt lgkmcnt(1)
    buffer_store_dwordx4 v[84:87], v25, s[16:19], s66 offen sc1
    s_waitcnt lgkmcnt(0)
    buffer_store_dwordx4 v[76:79], v25, s[16:19], s67 offen sc1
L_end:
    s_endpgm
L_slow0_1:
    s_mov_b32 s22, 0
    s_call_b64 s[20:21], L_tick
    buffer_load_dwordx4 v[72:75], v34, s[12:15], 0 offen sc1
    buffer_load_dwordx4 v[76:79], v44, s[12:15], 0 offen sc1
    s_waitcnt vmcnt(0)
    v_bitop3_b32 v12, v75, v79, s76 bitop3:0x7e
    v_cmp_lt_u32 vcc, 0xffff, v12
    s_cbranch_vccnz L_slow0_1
    s_branch L_back0_1
L_slow1_0:
    s_mov_b32 s22, 1
    s_call_b64 s[20:21], L_tick
    buffer_load_dwordx4 v[80:83], v32, s[12:15], s40 offen sc1
    buffer_load_dwordx4 v[84:87], v33, s[12:15], s40 offen sc1
    s_waitcnt vmcnt(0)
    v_bitop3_b32 v12, v83, v87, s76 bitop3:0x7e
    v_cmp_lt_u32 vcc, 0xffff, v12
    s_cbranch_vccnz L_slow1_0
    s_branch L_back1_0
L_slow1_1:
    s_mov_b32 s22, 1
    s_call_b64 s[20:21], L_tick
    buffer_load_dwordx4 v[88:91], v34, s[12:15], s40 offen sc1
    buffer_load_dwordx4 v[92:95], v44, s[12:15], s40 offen sc1
    s_waitcnt vmcnt(0)
    v_bitop3_b32 v12, v91, v95, s76 bitop3:0x7e
    v_cmp_lt_u32 vcc, 0xffff, v12
    s_cbranch_vccnz L_slow1_1
    s_branch L_back1_1
L_slow2_0:
    s_mov_b32 s22, 2
    s_call_b64 s[20:21], L_tick
    buffer_load_dwordx4 v[48:51], v32, s[12:15], s41 offen sc1
    buffer_load_dwordx4 v[52:55], v33, s[12:15], s41 offen sc1
    s_waitcnt vmcnt(0)
    v_bitop3_b32 v12, v51, v55, s76 bitop3:0x7e
    v_cmp_lt_u32 vcc, 0xffff, v12
    s_cbranch_vccnz L_slow2_0
    s_branch L_back2_0
L_slow2_1:
    s_mov_b32 s22, 2
    s_call_b64 s[20:21], L_tick
    buffer_load_dwordx4 v[64:67], v34, s[12:15], s41 offen sc1
    buffer_load_dwordx4 v[68:71], v44, s[12:15], s41 offen sc1
    s_waitcnt vmcnt(0)
    v_bitop3_b32 v12, v67, v71, s76 bitop3:0x7e
    v_cmp_lt_u32 vcc, 0xffff, v12
    s_cbranch_vccnz L_slow2_1
    s_branch L_back2_1
L_slow3_0:
    s_mov_b32 s22, 3
    s_call_b64 s[20:21], L_tick
    buffer_load_dwordx4 v[72:75], v32, s[12:15], s42 offen sc1
    buffer_load_dwordx4 v[76:79], v33, s[12:15], s42 offen sc1
    s_waitcnt vmcnt(0)
    v_bitop3_b32 v12, v75, v79, s76 bitop3:0x7e
    v_cmp_lt_u32 vcc, 0xffff, v12
    s_cbranch_vccnz L_slow3_0
    s_branch L_back3_0
L_slow3_1:
    s_mov_b32 s22, 3
    s_call_b64 s[20:21], L_tick
    buffer_load_dwordx4 v[80:83], v34, s[12:15], s42 offen sc1
    buffer_load_dwordx4 v[84:87], v44, s[12:15], s42 offen sc1
    s_waitcnt vmcnt(0)
    v_bitop3_b32 v12, v83, v87, s76 bitop3:0x7e
    v_cmp_lt_u32 vcc, 0xffff, v12
    s_cbranch_vccnz L_slow3_1
    s_branch L_back3_1
L_slow4_0:
    s_mov_b32 s22, 4
    s_call_b64 s[20:21], L_tick
    buffer_load_dwordx4 v[96:99], v32, s[12:15], s43 offen sc1
    buffer_load_dwordx4 v[100:103], v33, s[12:15], s43 offen sc1
    s_waitcnt vmcnt(0)
    v_bitop3_b32 v12, v99, v103, s76 bitop3:0x7e
    v_cmp_lt_u32 vcc, 0xffff, v12
    s_cbranch_vccnz L_slow4_0
    s_branch L_back4_0
L_slow4_1:
    s_mov_b32 s22, 4
    s_call_b64 s[20:21], L_tick
    buffer_load_dwordx4 v[104:107], v34, s[12:15], s43 offen sc1
    buffer_load_dwordx4 v[108:111], v44, s[12:15], s43 offen sc1
    s_waitcnt vmcnt(0)
    v_bitop3_b32 v12, v107, v111, s76 bitop3:0x7e
    v_cmp_lt_u32 vcc, 0xffff, v12
    s_cbranch_vccnz L_slow4_1
    s_branch L_back4_1
L_slow5_0:
    s_mov_b32 s22, 5
    s_call_b64 s[20:21], L_tick
    buffer_load_dwordx4 v[112:115], v32, s[12:15], s44 offen sc1
    buffer_load_dwordx4 v[116:119], v33, s[12:15], s44 offen sc1
    s_waitcnt vmcnt(0)
    v_bitop3_b32 v12, v115, v119, s76 bitop3:0x7e
    v_cmp_lt_u32 vcc, 0xffff, v12
    s_cbranch_vccnz L_slow5_0
    s_branch L_back5_0
L_slow5_1:
    s_mov_b32 s22, 5
    s_call_b64 s[20:21], L_tick
    buffer_load_dwordx4 v[120:123], v34, s[12:15], s44 offen sc1
    buffer_load_dwordx4 v[124:127], v44, s[12:15], s44 offen sc1
    s_waitcnt vmcnt(0)
    v_bitop3_b32 v12, v123, v127, s76 bitop3:0x7e
    v_cmp_lt_u32 vcc, 0xffff, v12
    s_cbranch_vccnz L_slow5_1
    s_branch L_back5_1
L_slow6_0:
    s_mov_b32 s22, 6
    s_call_b64 s[20:21], L_tick
    buffer_load_dwordx4 v[88:91], v32, s[12:15], s45 offen sc1
    buffer_load_dwordx4 v[92:95], v33, s[12:15], s45 offen sc1
    s_waitcnt vmcnt(0)
    v_bitop3_b32 v12, v91, v95, s76 bitop3:0x7e
    v_cmp_lt_u32 vcc, 0xffff, v12
    s_cbranch_vccnz L_slow6_0
    s_branch L_back6_0
L_slow6_1:
    s_mov_b32 s22, 6
    s_call_b64 s[20:21], L_tick
    buffer_load_dwordx4 v[48:51], v34, s[12:15], s45 offen sc1
    buffer_load_dwordx4 v[52:55], v44, s[12:15], s45 offen sc1
    s_waitcnt vmcnt(0)
    v_bitop3_b32 v12, v51, v55, s76 bitop3:0x7e
    v_cmp_lt_u32 vcc, 0xffff, v12
    s_cbranch_vccnz L_slow6_1
    s_branch L_back6_1
L_slow7_0:
    s_mov_b32 s22, 7
    s_call_b64 s[20:21], L_tick
    buffer_load_dwordx4 v[72:75], v32, s[12:15], s72 offen sc1
    buffer_load_dwordx4 v[76:79], v33, s[12:15], s72 offen sc1
    s_waitcnt vmcnt(0)
    v_bitop3_b32 v12, v75, v79, s76 bitop3:0x7e
    v_cmp_lt_u32 vcc, 0xffff, v12
    s_cbranch_vccnz L_slow7_0
    s_branch L_back7_0
L_slow7_1:
    s_mov_b32 s22, 7
    s_call_b64 s[20:21], L_tick
    buffer_load_dwordx4 v[80:83], v34, s[12:15], s72 offen sc1
    buffer_load_dwordx4 v[84:87], v44, s[12:15], s72 offen sc1
    s_waitcnt vmcnt(0)
    v_bitop3_b32 v12, v83, v87, s76 bitop3:0x7e
    v_cmp_lt_u32 vcc, 0xffff, v12
    s_cbranch_vccnz L_slow7_1
    s_branch L_back7_1
L_tick:
    s_add_u32 s52, s52, 1
    s_and_b32 s23, s52, 4095
    s_cbranch_scc1 L_tick_ret
L_help:
    s_mov_b32 s53, s61
    s_mov_b32 s54, s62
    s_mul_i32 s61, s22, 1835008
    s_add_u32 s61, s61, s79
    s_lshl_b32 s62, s22, 14
    s_add_u32 s62, s62, s68
    s_mov_b32 s22, 0
L_help_row:
    v_mov_b32 v21, v19
    s_xor_b32 s23, s22, s58
    s_bitcmp0_b32 s23, 2
    s_cbranch_scc1 L_help_same
    v_add_u32 v12, 57344, v19
    v_subrev_u32 v13, 57344, v19
    v_min_u32 v21, v12, v13
L_help_same:
    v_mov_b32 v8, 0
    v_mov_b32 v9, 0
    v_mov_b32 v10, 0
    v_mov_b32 v11, s47
    s_mov_b32 s23, 0
L_help_e:
    v_mov_b32 v15, 0
    buffer_load_dwordx3 v[12:14], v18, s[4:7], s61 offen
    s_cmp_ge_u32 s23, 16
    s_cbranch_scc1 L_help_own
    buffer_load_dword v15, v21, s[4:7], s61 offen
L_help_own:
    s_waitcnt vmcnt(0)
    v_lshl_or_b32 v8, v12, s23, v8
    v_lshl_or_b32 v9, v13, s23, v9
    v_lshl_or_b32 v10, v14, s23, v10
    v_lshl_or_b32 v11, v15, s23, v11
    s_add_u32 s61, s61, 14336
    s_add_u32 s23, s23, 4
    s_cmp_lt_u32 s23, 32
    s_cbranch_scc1 L_help_e
    buffer_store_dwordx4 v[8:11], v20, s[12:15], s62 offen sc1
    s_add_u32 s62, s62, 1024
    s_waitcnt vmcnt(0)
    s_add_u32 s22, s22, 1
    s_cmp_lt_u32 s22, 16
    s_cbranch_scc1 L_help_row
    s_mov_b32 s61, s53
    s_mov_b32 s62, s54
L_tick_ret:
    s_setpc_b64 s[20:21]
L_code_end:

.section .rodata,"a"
.p2align 6
.amdhsa_kernel standalone__normalfloat_lut_af4__prompt_kernel
  .amdhsa_next_free_vgpr 512
  .amdhsa_next_free_sgpr 102
  .amdhsa_accum_offset 256
  .amdhsa_group_segment_fixed_size 0
  .amdhsa_kernarg_size 56
  .amdhsa_user_sgpr_count 2
  .amdhsa_user_sgpr_kernarg_segment_ptr 1
  .amdhsa_system_sgpr_workgroup_id_x 1
.end_amdhsa_kernel
```

```asm
; @launch grid=(256,1,1) block=(256,1,1) lds=163840
.amdgcn_target "amdgcn-amd-amdhsa--gfx950"
.text
.globl standalone__normalfloat_lut_af4__prompt_kernel
.p2align 8
.type standalone__normalfloat_lut_af4__prompt_kernel,@function
standalone__normalfloat_lut_af4__prompt_kernel:
    s_cmp_ge_u32 s2, 256
    s_cbranch_scc1 L_end
    s_load_dwordx2 s[4:5], s[0:1], 8
    s_load_dwordx2 s[12:13], s[0:1], 48
    s_load_dwordx2 s[8:9], s[0:1], 0
    s_load_dwordx2 s[28:29], s[0:1], 16
    s_getpc_b64 s[48:49]
    s_mov_b32 s50, L_code_end-standalone__normalfloat_lut_af4__prompt_kernel-256
    s_mov_b32 s51, 0x20000
    s_lshr_b32 s61, s2, 3
    v_lshl_add_u32 v10, v0, 5, s61
    v_lshlrev_b32 v10, 7, v10
    buffer_load_dword v1, v10, s[48:51], 0 offen offset:256
    v_lshrrev_b32 v5, 6, v0
    v_and_b32 v2, 63, v0
    s_and_b32 s60, s2, 7
    v_readfirstlane_b32 s63, v5
    s_and_b32 s58, s60, 1
    s_lshl_b32 s58, s58, 3
    s_and_b32 s62, s61, 7
    s_add_u32 s58, s58, s62
    s_lshr_b32 s59, s60, 1
    s_lshl_b32 s59, s59, 2
    s_lshr_b32 s62, s61, 3
    s_add_u32 s59, s59, s62
    v_mul_u32_u24 v18, 12, v2
    s_lshl_b32 s60, s63, 4
    s_add_u32 s60, s60, s58
    s_mul_i32 s61, s60, 114688
    s_mul_i32 s79, s59, 896
    s_add_u32 s61, s61, s79
    s_mov_b32 s6, 14680064
    s_mov_b32 s7, 0x20000
    s_lshl_b32 s78, s59, 7
    s_add_u32 s78, s78, 2097164
    v_and_b32 v4, 15, v2
    v_lshrrev_b32 v3, 4, v2
    v_and_b32 v12, 1, v3
    v_lshlrev_b32 v13, 1, v12
    v_xor_b32 v13, v13, v4
    v_lshrrev_b32 v19, 1, v3
    v_lshl_add_u32 v19, v19, 4, v13
    s_bfe_u32 s70, s58, 0x10002
    s_xor_b32 s70, s70, 1
    v_xor_b32 v12, s70, v12
    v_mul_u32_u24 v12, 14336, v12
    v_add_lshl_u32 v19, v19, v12, 2
    v_add_u32 v19, 768, v19
    s_mov_b32 s46, 2
    s_cmp_lg_u32 s63, 0
    s_cbranch_scc1 L_role0
    s_mov_b32 s46, 0
L_role0:
    s_cmp_lg_u32 s63, 1
    s_cbranch_scc1 L_role1
    s_mov_b32 s46, 1
L_role1:
    v_lshlrev_b32 v16, 1, v4
    v_lshrrev_b32 v17, 4, v0
    v_lshlrev_b32 v17, 1, v17
    s_mov_b32 s30, 32
    s_mov_b32 s31, 0x20000
    v_lshrrev_b32 v6, 3, v2
    v_and_b32 v7, 7, v2
    v_xor_b32 v13, v7, v3
    s_lshl_b32 s70, s63, 5
    v_add_lshl_u32 v12, v6, s70, 11
    v_lshl_add_u32 v36, v13, 4, v12
    v_xor_b32 v37, 64, v36
    v_add_u32 v38, 30720, v36
    v_add_u32 v37, 15360, v37
    v_add_u32 v39, 30720, v37
    s_mov_b32 s10, 4194304
    s_mov_b32 s11, 0x20000
    s_lshl_b32 s55, s58, 18
    s_and_b32 s71, s58, 8
    s_lshl_b32 s70, s71, 4
    s_add_u32 s55, s55, s70
    s_xor_b32 s69, s55, 128
    s_lshl_b32 s57, s63, 12
    s_add_u32 s57, s57, 65536
    s_mov_b32 s14, 2099200
    s_mov_b32 s15, 0x20000
    s_lshl_b32 s68, s59, 17
    s_lshl_b32 s62, s60, 10
    s_add_u32 s62, s62, s68
    v_lshlrev_b32 v20, 4, v2
    s_waitcnt lgkmcnt(0)
    s_load_dword s76, s[12:13], s78
    s_cmp_eq_u32 s46, 1
    s_cbranch_scc1 L_L
    s_cmp_eq_u32 s46, 2
    s_cbranch_scc1 L_L
L_X:
    buffer_load_dwordx3 v[128:130], v18, s[4:7], s61 offen
    buffer_load_dword v131, v19, s[4:7], s61 offen
    s_add_u32 s61, s61, 14336
    buffer_load_dwordx3 v[132:134], v18, s[4:7], s61 offen
    buffer_load_dword v135, v19, s[4:7], s61 offen
    s_add_u32 s61, s61, 14336
    buffer_load_dwordx3 v[136:138], v18, s[4:7], s61 offen
    buffer_load_dword v139, v19, s[4:7], s61 offen
    s_add_u32 s61, s61, 14336
    buffer_load_dwordx3 v[140:142], v18, s[4:7], s61 offen
    buffer_load_dword v143, v19, s[4:7], s61 offen
    s_add_u32 s61, s61, 14336
    buffer_load_dwordx3 v[144:146], v18, s[4:7], s61 offen
    s_add_u32 s61, s61, 14336
    buffer_load_dwordx3 v[148:150], v18, s[4:7], s61 offen
    s_add_u32 s61, s61, 14336
    buffer_load_dwordx3 v[152:154], v18, s[4:7], s61 offen
    s_add_u32 s61, s61, 14336
    buffer_load_dwordx3 v[156:158], v18, s[4:7], s61 offen
    s_add_u32 s61, s61, 7239680
    s_cmp_eq_u32 s46, 1
    s_cbranch_scc1 L_D
    s_cmp_eq_u32 s46, 2
    s_cbranch_scc1 L_B
L_L:
    buffer_load_ushort v16, v16, s[28:31], 0 offen
    buffer_load_ushort v17, v17, s[28:31], 0 offen
    s_cmp_eq_u32 s46, 1
    s_cbranch_scc1 L_S
    s_cmp_eq_u32 s46, 2
    s_cbranch_scc1 L_S
L_D:
    s_add_u32 m0, s57, 32768
    s_add_u32 s56, s55, 0
    buffer_load_dwordx4 v36, s[8:11], s56 offen offset:0 lds
    buffer_load_dwordx4 v37, s[8:11], s56 offen offset:1024 lds
    buffer_load_dwordx4 v38, s[8:11], s56 offen offset:2048 lds
    buffer_load_dwordx4 v39, s[8:11], s56 offen offset:3072 lds
    s_cmp_eq_u32 s46, 1
    s_cbranch_scc1 L_G
    s_cmp_eq_u32 s46, 2
    s_cbranch_scc1 L_G
L_S:
    s_load_dwordx2 s[32:33], s[0:1], 24
    s_load_dwordx2 s[16:17], s[0:1], 32
    s_load_dwordx2 s[24:25], s[0:1], 40
    s_and_b32 s64, s63, 1
    s_lshr_b32 s65, s63, 1
    s_and_b32 s70, s58, 8
    s_lshl_b32 s70, s70, 10
    s_lshl_b32 s71, s64, 12
    s_add_u32 s70, s70, s71
    s_lshl_b32 s71, s63, 8
    s_add_u32 s70, s70, s71
    s_add_u32 s70, s70, s68
    v_lshl_add_u32 v32, v4, 4, s70
    v_lshl_add_u32 v32, v3, 10, v32
    v_xor_b32 v33, 4096, v32
    v_xor_b32 v34, 8192, v32
    v_xor_b32 v44, 12288, v32
    s_mov_b32 s36, 202114048
    s_mov_b32 s37, 202114304
    s_mov_b32 s38, 202114560
    s_mov_b32 s39, 202114816
    v_and_b32 v35, 31, v2
    v_lshlrev_b32 v35, 2, v35
    s_lshl_b32 s70, s64, 6
    s_add_u32 s70, s70, 65536
    v_lshrrev_b32 v12, 1, v4
    v_xor_b32 v12, v12, v3
    v_lshlrev_b32 v12, 4, v12
    v_lshl_add_u32 v12, v4, 7, v12
    v_xor_b32 v40, s70, v12
    v_xor_b32 v41, 64, v40
    v_add_u32 v42, 65536, v40
    v_add_u32 v43, 65536, v41
    s_mov_b32 s52, 0
    v_lshlrev_b32 v8, 4, v7
    v_lshl_add_u32 v8, v0, 8, v8
    v_xor_b32 v9, 16, v8
    v_xor_b32 v10, 32, v8
    v_xor_b32 v11, 48, v8
    v_xor_b32 v12, 64, v8
    v_xor_b32 v13, 80, v8
    v_xor_b32 v14, 96, v8
    v_xor_b32 v15, 112, v8
    s_cmp_eq_u32 s46, 1
    s_cbranch_scc1 L_X
    s_cmp_eq_u32 s46, 2
    s_cbranch_scc1 L_D
L_G:
    s_waitcnt lgkmcnt(0)
    s_add_u32 s76, s76, 2654435769
    s_and_b32 s47, s76, 0xffff0000
    s_cmp_eq_u32 s46, 1
    s_cbranch_scc1 L_T
    s_cmp_eq_u32 s46, 2
    s_cbranch_scc1 L_T
L_K:
    s_waitcnt vmcnt(16)
    v_or_b32 v131, s47, v131
    s_waitcnt vmcnt(15)
    v_lshl_or_b32 v128, v132, 4, v128
    v_lshl_or_b32 v129, v133, 4, v129
    v_lshl_or_b32 v130, v134, 4, v130
    s_waitcnt vmcnt(14)
    v_lshl_or_b32 v131, v135, 4, v131
    s_waitcnt vmcnt(13)
    v_lshl_or_b32 v128, v136, 8, v128
    v_lshl_or_b32 v129, v137, 8, v129
    v_lshl_or_b32 v130, v138, 8, v130
    s_waitcnt vmcnt(12)
    v_lshl_or_b32 v131, v139, 8, v131
    s_waitcnt vmcnt(11)
    v_lshl_or_b32 v128, v140, 12, v128
    v_lshl_or_b32 v129, v141, 12, v129
    v_lshl_or_b32 v130, v142, 12, v130
    s_waitcnt vmcnt(10)
    v_lshl_or_b32 v131, v143, 12, v131
    s_waitcnt vmcnt(9)
    v_lshl_or_b32 v128, v144, 16, v128
    v_lshl_or_b32 v129, v145, 16, v129
    v_lshl_or_b32 v130, v146, 16, v130
    s_waitcnt vmcnt(8)
    v_lshl_or_b32 v128, v148, 20, v128
    v_lshl_or_b32 v129, v149, 20, v129
    v_lshl_or_b32 v130, v150, 20, v130
    s_waitcnt vmcnt(7)
    v_lshl_or_b32 v128, v152, 24, v128
    v_lshl_or_b32 v129, v153, 24, v129
    v_lshl_or_b32 v130, v154, 24, v130
    s_waitcnt vmcnt(6)
    v_lshl_or_b32 v128, v156, 28, v128
    v_lshl_or_b32 v129, v157, 28, v129
    v_lshl_or_b32 v130, v158, 28, v130
    buffer_store_dwordx4 v[128:131], v20, s[12:15], s62 offen sc1
    s_add_u32 s62, s62, 65536
    s_cmp_eq_u32 s46, 1
    s_cbranch_scc1 L_B
    s_cmp_eq_u32 s46, 2
    s_cbranch_scc1 L_E
L_T:
    s_waitcnt vmcnt(16)
    s_cmp_eq_u32 s46, 1
    s_cbranch_scc1 L_rw1
    s_waitcnt vmcnt(5)
    s_cmp_eq_u32 s46, 0
    s_cbranch_scc1 L_rw1
    s_waitcnt vmcnt(4)
L_rw1:
    v_lshl_or_b32 v56, v17, 16, v16
    v_lshl_or_b32 v57, v17, 16, v16
    v_lshl_or_b32 v58, v17, 16, v16
    v_lshl_or_b32 v59, v17, 16, v16
    ds_write_b128 v8, v[56:59]
    ds_write_b128 v9, v[56:59]
    ds_write_b128 v10, v[56:59]
    ds_write_b128 v11, v[56:59]
    ds_write_b128 v12, v[56:59]
    ds_write_b128 v13, v[56:59]
    ds_write_b128 v14, v[56:59]
    ds_write_b128 v15, v[56:59]
    s_cmp_lg_u32 s46, 1
    s_cbranch_scc1 L_ed2
    s_waitcnt vmcnt(4)
    s_branch L_K
L_ed2:
    s_cmp_eq_u32 s46, 2
    s_cbranch_scc1 L_X
L_W:
    s_mov_b64 exec, 0
    s_cmp_eq_u32 s63, 0
    s_cbranch_scc1 L_pad0
L_warmed:
    s_mov_b64 exec, -1
L_B:
    s_waitcnt vmcnt(12) lgkmcnt(0)
    s_cmp_eq_u32 s46, 2
    s_cbranch_scc1 L_rw3
    s_waitcnt vmcnt(1)
L_rw3:
    s_barrier
L_Q:
    ds_read_b128 a[0:3], v40 offset:32768
    ds_read_b128 a[4:7], v41 offset:32768
    ds_read_b128 a[8:11], v40 offset:34816
    ds_read_b128 a[12:15], v41 offset:34816
    ds_read_b128 a[16:19], v40 offset:36864
    ds_read_b128 a[20:23], v41 offset:36864
    ds_read_b128 a[24:27], v40 offset:38912
    ds_read_b128 a[28:31], v41 offset:38912
    ds_read_b128 a[40:43], v40 offset:40960
    ds_read_b128 a[44:47], v41 offset:40960
    ds_read_b128 a[48:51], v40 offset:43008
    ds_read_b128 a[52:55], v41 offset:43008
    ds_read_b128 a[56:59], v40 offset:45056
    ds_read_b128 a[60:63], v41 offset:45056
    ds_read_b128 a[72:75], v40 offset:47104
    ds_read_b128 a[76:79], v41 offset:47104
L_P:
    buffer_load_dwordx4 v[64:67], v32, s[12:15], 0 offen sc1
    buffer_load_dwordx4 v[68:71], v33, s[12:15], 0 offen sc1
L_d:
    s_add_u32 m0, s57, 49152
    s_add_u32 s3, s69, 0
    buffer_load_dwordx4 v36, s[8:11], s3 offen offset:0 lds
    buffer_load_dwordx4 v37, s[8:11], s3 offen offset:1024 lds
    buffer_load_dwordx4 v38, s[8:11], s3 offen offset:2048 lds
    buffer_load_dwordx4 v39, s[8:11], s3 offen offset:3072 lds
L_p:
    buffer_load_dwordx4 v[72:75], v34, s[12:15], 0 offen sc1
    buffer_load_dwordx4 v[76:79], v44, s[12:15], 0 offen sc1
    s_cmp_lg_u32 s46, 2
    s_cbranch_scc1 L_ed4
    s_waitcnt vmcnt(8)
    s_branch L_K
L_ed4:
L_E:
L_chk0:
    s_waitcnt vmcnt(7)
    s_cmp_eq_u32 s46, 2
    s_cbranch_scc1 L_rw5
    s_waitcnt vmcnt(6)
L_rw5:
    v_bitop3_b32 v12, v67, v71, s76 bitop3:0x7e
    v_cmp_lt_u32 vcc, 0xffff, v12
    s_cbranch_vccnz L_retry0
    v_perm_b32 v56, v64, v35, s36
    v_perm_b32 v57, v64, v35, s37
    v_perm_b32 v58, v64, v35, s38
    v_perm_b32 v59, v64, v35, s39
    v_perm_b32 v60, v68, v35, s36
    v_perm_b32 v61, v68, v35, s37
    v_perm_b32 v62, v68, v35, s38
    v_perm_b32 v63, v68, v35, s39
    ds_read_b32 a32, v56
    ds_read_b32 a33, v57
    ds_read_b32 a34, v58
    ds_read_b32 a35, v59
    ds_read_b32 a36, v60
    ds_read_b32 a37, v61
    ds_read_b32 a38, v62
    ds_read_b32 a39, v63
    v_perm_b32 v56, v65, v35, s36
    v_perm_b32 v57, v65, v35, s37
    v_perm_b32 v58, v65, v35, s38
    v_perm_b32 v59, v65, v35, s39
    v_perm_b32 v60, v69, v35, s36
    v_perm_b32 v61, v69, v35, s37
    ds_read_b32 a64, v56
    ds_read_b32 a65, v57
    ds_read_b32 a66, v58
    ds_read_b32 a67, v59
    s_cbranch_vccz L_main
L_retry0:
    s_add_u32 s52, s52, 1
    s_and_b32 s23, s52, 4095
    s_cbranch_scc1 L_retry0b
    s_mov_b32 s22, 0
    s_call_b64 s[20:21], L_help
L_retry0b:
    buffer_load_dwordx4 v[64:67], v32, s[12:15], 0 offen sc1
    buffer_load_dwordx4 v[68:71], v33, s[12:15], 0 offen sc1
    buffer_load_dwordx4 v[72:75], v34, s[12:15], 0 offen sc1
    buffer_load_dwordx4 v[76:79], v44, s[12:15], 0 offen sc1
    s_waitcnt vmcnt(0) lgkmcnt(0)
    s_branch L_chk0
.p2align 12
L_main:
L_pad0:
    s_cbranch_execz L_pad1
    s_waitcnt lgkmcnt(8)
    v_mfma_f32_16x16x32_bf16 v[128:131], a[32:35], a[0:3], 0
    s_waitcnt lgkmcnt(4)
    s_mov_b32 s40, 16384
    ds_read_b32 a68, v60
    v_mfma_f32_16x16x32_bf16 v[128:131], a[36:39], a[4:7], v[128:131]
    buffer_load_dwordx4 v[80:83], v32, s[12:15], s40 offen sc1
    v_mfma_f32_16x16x32_bf16 v[132:135], a[36:39], a[12:15], 0
    s_add_u32 m0, s57, 65536
    ds_read_b32 a69, v61
    v_perm_b32 v62, v69, v35, s38
    v_mfma_f32_16x16x32_bf16 v[132:135], a[32:35], a[8:11], v[132:135]
    s_add_u32 s56, s55, 256
    ds_read_b32 a70, v62
    v_perm_b32 v63, v69, v35, s39
    v_mfma_f32_16x16x32_bf16 v[136:139], a[32:35], a[16:19], 0
    s_add_u32 s3, s69, 256
    ds_read_b32 a71, v63
    v_mfma_f32_16x16x32_bf16 v[136:139], a[36:39], a[20:23], v[136:139]
    buffer_load_dwordx4 v[84:87], v33, s[12:15], s40 offen sc1
    v_mfma_f32_16x16x32_bf16 v[140:143], a[36:39], a[28:31], 0
    v_perm_b32 v56, v66, v35, s36
    v_perm_b32 v57, v66, v35, s37
    v_mfma_f32_16x16x32_bf16 v[140:143], a[32:35], a[24:27], v[140:143]
    ds_read_b32 a80, v56
    v_perm_b32 v58, v66, v35, s38
    v_mfma_f32_16x16x32_bf16 v[144:147], a[32:35], a[40:43], 0
    ds_read_b32 a81, v57
    v_mfma_f32_16x16x32_bf16 v[144:147], a[36:39], a[44:47], v[144:147]
    buffer_load_dwordx4 v36, s[8:11], s56 offen offset:0 lds
    v_mfma_f32_16x16x32_bf16 v[148:151], a[36:39], a[52:55], 0
    ds_read_b32 a82, v58
    v_perm_b32 v59, v66, v35, s39
    v_mfma_f32_16x16x32_bf16 v[148:151], a[32:35], a[48:51], v[148:151]
    s_waitcnt vmcnt(3)
    v_bitop3_b32 v60, v75, v79, s76 bitop3:0x7e
    v_perm_b32 v61, v70, v35, s36
    v_mfma_f32_16x16x32_bf16 v[152:155], a[32:35], a[56:59], 0
    s_mov_b32 s41, 32768
    ds_read_b32 a83, v59
    ds_read_b32 a84, v61
    v_mfma_f32_16x16x32_bf16 v[152:155], a[36:39], a[60:63], v[152:155]
    buffer_load_dwordx4 v37, s[8:11], s56 offen offset:1024 lds
    v_mfma_f32_16x16x32_bf16 v[156:159], a[36:39], a[76:79], 0
    v_cmp_lt_u32 vcc, 0xffff, v60
    v_perm_b32 v62, v70, v35, s37
    v_mfma_f32_16x16x32_bf16 v[156:159], a[32:35], a[72:75], v[156:159]
    s_waitcnt lgkmcnt(5)
    v_perm_b32 v63, v70, v35, s38
    v_perm_b32 v56, v70, v35, s39
    v_mfma_f32_16x16x32_bf16 v[160:163], a[64:67], a[0:3], 0
    ds_read_b32 a85, v62
    s_cbranch_vccnz L_slow0_1
L_back0_1:
    v_mfma_f32_16x16x32_bf16 v[160:163], a[68:71], a[4:7], v[160:163]
    buffer_load_dwordx4 v38, s[8:11], s56 offen offset:2048 lds
    v_mfma_f32_16x16x32_bf16 v[164:167], a[68:71], a[12:15], 0
    ds_read_b32 a86, v63
    ds_read_b32 a87, v56
    v_mfma_f32_16x16x32_bf16 v[164:167], a[64:67], a[8:11], v[164:167]
    v_perm_b32 v57, v67, v35, s36
    v_perm_b32 v58, v67, v35, s37
    v_mfma_f32_16x16x32_bf16 v[168:171], a[64:67], a[16:19], 0
    ds_read_b32 a88, v57
    ds_read_b32 a89, v58
    v_mfma_f32_16x16x32_bf16 v[168:171], a[68:71], a[20:23], v[168:171]
    buffer_load_dwordx4 v39, s[8:11], s56 offen offset:3072 lds
    v_mfma_f32_16x16x32_bf16 v[172:175], a[68:71], a[28:31], 0
    s_add_u32 m0, s57, 81920
    v_perm_b32 v59, v71, v35, s36
    v_perm_b32 v61, v71, v35, s37
    v_mfma_f32_16x16x32_bf16 v[172:175], a[64:67], a[24:27], v[172:175]
    s_add_u32 s56, s55, 512
    ds_read_b32 a90, v59
    v_perm_b32 v60, v72, v35, s36
    v_mfma_f32_16x16x32_bf16 v[176:179], a[64:67], a[40:43], 0
    s_mov_b32 s42, 49152
    ds_read_b32 a91, v61
    ds_read_b32 a96, v60
    v_mfma_f32_16x16x32_bf16 v[176:179], a[68:71], a[44:47], v[176:179]
    buffer_load_dwordx4 v[88:91], v34, s[12:15], s40 offen sc1
    v_mfma_f32_16x16x32_bf16 v[180:183], a[68:71], a[52:55], 0
    v_perm_b32 v62, v72, v35, s37
    v_perm_b32 v63, v72, v35, s38
    v_mfma_f32_16x16x32_bf16 v[180:183], a[64:67], a[48:51], v[180:183]
    ds_read_b32 a97, v62
    v_perm_b32 v56, v72, v35, s39
    v_mfma_f32_16x16x32_bf16 v[184:187], a[64:67], a[56:59], 0
    s_barrier
    v_mfma_f32_16x16x32_bf16 v[184:187], a[68:71], a[60:63], v[184:187]
    buffer_load_dwordx4 v[92:95], v44, s[12:15], s40 offen sc1
    v_mfma_f32_16x16x32_bf16 v[188:191], a[68:71], a[76:79], 0
    ds_read_b32 a98, v63
    ds_read_b32 a99, v56
    v_mfma_f32_16x16x32_bf16 v[188:191], a[64:67], a[72:75], v[188:191]
    s_waitcnt lgkmcnt(6)
    ds_read_b128 a[104:107], v40 offset:49152
    v_perm_b32 v57, v76, v35, s36
    v_mfma_f32_16x16x32_bf16 v[192:195], a[80:83], a[0:3], 0
    ds_read_b32 a100, v57
    ds_read_b128 a[108:111], v41 offset:49152
    v_mfma_f32_16x16x32_bf16 v[192:195], a[84:87], a[4:7], v[192:195]
    buffer_load_dwordx4 v36, s[8:11], s3 offen offset:0 lds
    v_mfma_f32_16x16x32_bf16 v[196:199], a[84:87], a[12:15], 0
    ds_read_b128 a[112:115], v40 offset:51200
    v_perm_b32 v58, v76, v35, s37
    v_mfma_f32_16x16x32_bf16 v[196:199], a[80:83], a[8:11], v[196:199]
    ds_read_b32 a101, v58
    v_perm_b32 v59, v76, v35, s38
    v_mfma_f32_16x16x32_bf16 v[200:203], a[80:83], a[16:19], 0
    s_mov_b32 s43, 65536
    ds_read_b32 a102, v59
    ds_read_b128 a[116:119], v41 offset:51200
    v_mfma_f32_16x16x32_bf16 v[200:203], a[84:87], a[20:23], v[200:203]
    buffer_load_dwordx4 v37, s[8:11], s3 offen offset:1024 lds
    v_mfma_f32_16x16x32_bf16 v[204:207], a[84:87], a[28:31], 0
    ds_read_b128 a[120:123], v40 offset:53248
    v_perm_b32 v61, v76, v35, s39
    v_mfma_f32_16x16x32_bf16 v[204:207], a[80:83], a[24:27], v[204:207]
    ds_read_b32 a103, v61
    v_perm_b32 v60, v73, v35, s36
    v_mfma_f32_16x16x32_bf16 v[208:211], a[80:83], a[40:43], 0
    ds_read_b32 a128, v60
    ds_read_b128 a[124:127], v41 offset:53248
    v_mfma_f32_16x16x32_bf16 v[208:211], a[84:87], a[44:47], v[208:211]
    buffer_load_dwordx4 v38, s[8:11], s3 offen offset:2048 lds
    v_mfma_f32_16x16x32_bf16 v[212:215], a[84:87], a[52:55], 0
    ds_read_b128 a[136:139], v40 offset:55296
    v_perm_b32 v62, v73, v35, s37
    v_mfma_f32_16x16x32_bf16 v[212:215], a[80:83], a[48:51], v[212:215]
    ds_read_b32 a129, v62
    ds_read_b128 a[140:143], v41 offset:55296
    v_mfma_f32_16x16x32_bf16 v[216:219], a[80:83], a[56:59], 0
    v_perm_b32 v63, v73, v35, s38
    v_perm_b32 v56, v73, v35, s39
    v_mfma_f32_16x16x32_bf16 v[216:219], a[84:87], a[60:63], v[216:219]
    ds_read_b32 a130, v63
    ds_read_b32 a131, v56
    v_mfma_f32_16x16x32_bf16 v[220:223], a[84:87], a[76:79], 0
    ds_read_b128 a[144:147], v40 offset:57344
    v_perm_b32 v57, v77, v35, s36
    v_mfma_f32_16x16x32_bf16 v[220:223], a[80:83], a[72:75], v[220:223]
    s_waitcnt lgkmcnt(9)
    ds_read_b32 a132, v57
    ds_read_b128 a[148:151], v41 offset:57344
    v_mfma_f32_16x16x32_bf16 v[224:227], a[88:91], a[2:5], 0
    buffer_load_dwordx4 v39, s[8:11], s3 offen offset:3072 lds
    v_mfma_f32_16x16x32_bf16 v[228:231], a[88:91], a[10:13], 0
    s_add_u32 m0, s57, 0
    ds_read_b128 a[152:155], v40 offset:59392
    v_perm_b32 v58, v77, v35, s37
    v_mfma_f32_16x16x32_bf16 v[232:235], a[88:91], a[18:21], 0
    s_add_u32 s3, s69, 512
    ds_read_b32 a133, v58
    v_perm_b32 v59, v77, v35, s38
    v_mfma_f32_16x16x32_bf16 v[236:239], a[88:91], a[26:29], 0
    s_mov_b32 s44, 81920
    ds_read_b32 a134, v59
    v_perm_b32 v61, v77, v35, s39
    v_mfma_f32_16x16x32_bf16 v[240:243], a[88:91], a[42:45], 0
    ds_read_b32 a135, v61
    ds_read_b128 a[156:159], v41 offset:59392
    v_mfma_f32_16x16x32_bf16 v[244:247], a[88:91], a[50:53], 0
    buffer_load_dwordx3 v[96:98], v18, s[4:7], s61 offen
    v_mfma_f32_16x16x32_bf16 v[248:251], a[88:91], a[58:61], 0
    s_waitcnt vmcnt(11)
    ds_read_b128 a[160:163], v40 offset:61440
    v_bitop3_b32 v60, v83, v87, s76 bitop3:0x7e
    v_mfma_f32_16x16x32_bf16 v[252:255], a[88:91], a[74:77], 0
    v_cmp_lt_u32 vcc, 0xffff, v60
    v_perm_b32 v62, v74, v35, s36
    v_mfma_f32_16x16x32_bf16 v[128:131], a[96:99], a[104:107], v[128:131]
    s_waitcnt lgkmcnt(6)
    ds_read_b32 a168, v62
    ds_read_b128 a[164:167], v41 offset:61440
    v_mfma_f32_16x16x32_bf16 v[128:131], a[100:103], a[108:111], v[128:131]
    buffer_load_dword v99, v19, s[4:7], s61 offen
    v_mfma_f32_16x16x32_bf16 v[132:135], a[100:103], a[116:119], v[132:135]
    s_add_u32 s61, s61, 14336
    ds_read_b128 a[176:179], v40 offset:63488
    v_perm_b32 v63, v74, v35, s37
    v_mfma_f32_16x16x32_bf16 v[132:135], a[96:99], a[112:115], v[132:135]
    v_perm_b32 v56, v74, v35, s38
    s_cbranch_vccnz L_slow1_0
L_back1_0:
    v_mfma_f32_16x16x32_bf16 v[136:139], a[96:99], a[120:123], v[136:139]
    s_mov_b32 s45, 98304
    ds_read_b128 a[180:183], v41 offset:63488
    ds_read_b32 a169, v63
    v_mfma_f32_16x16x32_bf16 v[136:139], a[100:103], a[124:127], v[136:139]
    buffer_load_dwordx3 v[100:102], v18, s[4:7], s61 offen
    v_mfma_f32_16x16x32_bf16 v[140:143], a[100:103], a[140:143], v[140:143]
    ds_read_b32 a170, v56
    v_perm_b32 v57, v74, v35, s39
    v_mfma_f32_16x16x32_bf16 v[140:143], a[96:99], a[136:139], v[140:143]
    v_perm_b32 v58, v78, v35, s36
    v_perm_b32 v59, v78, v35, s37
    v_mfma_f32_16x16x32_bf16 v[144:147], a[96:99], a[144:147], v[144:147]
    s_waitcnt lgkmcnt(6)
    ds_read_b32 a171, v57
    ds_read_b32 a172, v58
    v_mfma_f32_16x16x32_bf16 v[144:147], a[100:103], a[148:151], v[144:147]
    buffer_load_dword v103, v19, s[4:7], s61 offen
    v_mfma_f32_16x16x32_bf16 v[148:151], a[100:103], a[156:159], v[148:151]
    s_add_u32 s61, s61, 14336
    ds_read_b32 a173, v59
    v_perm_b32 v61, v78, v35, s38
    v_mfma_f32_16x16x32_bf16 v[148:151], a[96:99], a[152:155], v[148:151]
    v_perm_b32 v60, v78, v35, s39
    v_perm_b32 v62, v75, v35, s36
    v_mfma_f32_16x16x32_bf16 v[152:155], a[96:99], a[160:163], v[152:155]
    s_waitcnt lgkmcnt(5)
    ds_read_b32 a174, v61
    ds_read_b32 a175, v60
    v_mfma_f32_16x16x32_bf16 v[152:155], a[100:103], a[164:167], v[152:155]
    buffer_load_dwordx3 v[104:106], v18, s[4:7], s61 offen
    v_mfma_f32_16x16x32_bf16 v[156:159], a[100:103], a[180:183], v[156:159]
    ds_read_b32 a92, v62
    v_perm_b32 v63, v75, v35, s37
    v_mfma_f32_16x16x32_bf16 v[156:159], a[96:99], a[176:179], v[156:159]
    v_perm_b32 v56, v79, v35, s36
    v_perm_b32 v57, v79, v35, s37
    v_mfma_f32_16x16x32_bf16 v[160:163], a[128:131], a[104:107], v[160:163]
    s_mov_b32 s72, 114688
    ds_read_b32 a93, v63
    ds_read_b32 a94, v56
    v_mfma_f32_16x16x32_bf16 v[160:163], a[132:135], a[108:111], v[160:163]
    buffer_load_dword v107, v19, s[4:7], s61 offen
    v_mfma_f32_16x16x32_bf16 v[164:167], a[132:135], a[116:119], v[164:167]
    s_add_u32 s61, s61, 14336
    ds_read_b32 a95, v57
    v_perm_b32 v58, v80, v35, s36
    v_mfma_f32_16x16x32_bf16 v[164:167], a[128:131], a[112:115], v[164:167]
    v_perm_b32 v59, v80, v35, s37
    v_perm_b32 v61, v80, v35, s38
    v_mfma_f32_16x16x32_bf16 v[168:171], a[128:131], a[120:123], v[168:171]
    ds_read_b32 a184, v58
    ds_read_b32 a185, v59
    v_mfma_f32_16x16x32_bf16 v[168:171], a[132:135], a[124:127], v[168:171]
    buffer_load_dwordx3 v[108:110], v18, s[4:7], s61 offen
    v_mfma_f32_16x16x32_bf16 v[172:175], a[132:135], a[140:143], v[172:175]
    ds_read_b32 a186, v61
    v_perm_b32 v60, v80, v35, s39
    v_mfma_f32_16x16x32_bf16 v[172:175], a[128:131], a[136:139], v[172:175]
    v_perm_b32 v62, v84, v35, s36
    v_perm_b32 v63, v84, v35, s37
    v_mfma_f32_16x16x32_bf16 v[176:179], a[128:131], a[144:147], v[176:179]
    ds_read_b32 a187, v60
    ds_read_b32 a188, v62
    v_mfma_f32_16x16x32_bf16 v[176:179], a[132:135], a[148:151], v[176:179]
    buffer_load_dword v111, v19, s[4:7], s61 offen
    v_mfma_f32_16x16x32_bf16 v[180:183], a[132:135], a[156:159], v[180:183]
    s_add_u32 s61, s61, 14336
    ds_read_b32 a189, v63
    v_perm_b32 v56, v84, v35, s38
    v_mfma_f32_16x16x32_bf16 v[180:183], a[128:131], a[152:155], v[180:183]
    v_perm_b32 v57, v84, v35, s39
    v_perm_b32 v58, v81, v35, s36
    v_mfma_f32_16x16x32_bf16 v[184:187], a[128:131], a[160:163], v[184:187]
    ds_read_b32 a190, v56
    ds_read_b32 a191, v57
    v_mfma_f32_16x16x32_bf16 v[184:187], a[132:135], a[164:167], v[184:187]
    buffer_load_dwordx3 v[112:114], v18, s[4:7], s61 offen
    v_mfma_f32_16x16x32_bf16 v[188:191], a[132:135], a[180:183], v[188:191]
    s_add_u32 s61, s61, 14336
    ds_read_b32 a192, v58
    v_perm_b32 v59, v81, v35, s37
    v_mfma_f32_16x16x32_bf16 v[188:191], a[128:131], a[176:179], v[188:191]
    s_waitcnt vmcnt(15) lgkmcnt(6)
    v_perm_b32 v61, v81, v35, s38
    v_perm_b32 v60, v81, v35, s39
    v_mfma_f32_16x16x32_bf16 v[192:195], a[168:171], a[104:107], v[192:195]
    s_barrier
    v_mfma_f32_16x16x32_bf16 v[192:195], a[172:175], a[108:111], v[192:195]
    buffer_load_dwordx3 v[116:118], v18, s[4:7], s61 offen
    v_mfma_f32_16x16x32_bf16 v[196:199], a[172:175], a[116:119], v[196:199]
    s_add_u32 s61, s61, 14336
    ds_read_b128 a[200:203], v42 offset:0
    ds_read_b32 a193, v59
    v_mfma_f32_16x16x32_bf16 v[196:199], a[168:171], a[112:115], v[196:199]
    ds_read_b128 a[204:207], v43 offset:0
    ds_read_b32 a194, v61
    v_mfma_f32_16x16x32_bf16 v[200:203], a[168:171], a[120:123], v[200:203]
    ds_read_b128 a[212:215], v43 offset:2048
    ds_read_b32 a195, v60
    v_mfma_f32_16x16x32_bf16 v[200:203], a[172:175], a[124:127], v[200:203]
    ds_read_b128 a[208:211], v42 offset:2048
    v_mfma_f32_16x16x32_bf16 v[204:207], a[172:175], a[140:143], v[204:207]
    buffer_load_dwordx3 v[120:122], v18, s[4:7], s61 offen
    v_mfma_f32_16x16x32_bf16 v[204:207], a[168:171], a[136:139], v[204:207]
    s_add_u32 s61, s61, 14336
    ds_read_b128 a[216:219], v42 offset:4096
    v_perm_b32 v62, v85, v35, s36
    v_mfma_f32_16x16x32_bf16 v[208:211], a[168:171], a[144:147], v[208:211]
    ds_read_b128 a[220:223], v43 offset:4096
    ds_read_b32 a196, v62
    v_mfma_f32_16x16x32_bf16 v[208:211], a[172:175], a[148:151], v[208:211]
    s_waitcnt vmcnt(15)
    ds_read_b128 a[228:231], v43 offset:6144
    v_bitop3_b32 v63, v91, v95, s76 bitop3:0x7e
    v_mfma_f32_16x16x32_bf16 v[212:215], a[172:175], a[156:159], v[212:215]
    ds_read_b128 a[224:227], v42 offset:6144
    v_mfma_f32_16x16x32_bf16 v[212:215], a[168:171], a[152:155], v[212:215]
    buffer_load_dwordx3 v[124:126], v18, s[4:7], s61 offen
    v_mfma_f32_16x16x32_bf16 v[216:219], a[168:171], a[160:163], v[216:219]
    ds_read_b128 a[232:235], v42 offset:8192
    v_cmp_lt_u32 vcc, 0xffff, v63
    v_mfma_f32_16x16x32_bf16 v[216:219], a[172:175], a[164:167], v[216:219]
    ds_read_b128 a[236:239], v43 offset:8192
    v_perm_b32 v56, v85, v35, s37
    v_mfma_f32_16x16x32_bf16 v[220:223], a[172:175], a[180:183], v[220:223]
    ds_read_b128 a[240:243], v42 offset:10240
    ds_read_b32 a197, v56
    v_mfma_f32_16x16x32_bf16 v[220:223], a[168:171], a[176:179], v[220:223]
    ds_read_b128 a[244:247], v43 offset:10240
    s_cbranch_vccnz L_slow1_1
L_back1_1:
    v_mfma_f32_16x16x32_bf16 v[224:227], a[92:95], a[106:109], v[224:227]
    buffer_load_dwordx4 v[48:51], v32, s[12:15], s41 offen sc1
    v_mfma_f32_16x16x32_bf16 v[228:231], a[92:95], a[114:117], v[228:231]
    ds_read_b128 a[248:251], v42 offset:12288
    v_perm_b32 v57, v85, v35, s38
    v_mfma_f32_16x16x32_bf16 v[232:235], a[92:95], a[122:125], v[232:235]
    ds_read_b32 a198, v57
    ds_read_b128 a[252:255], v43 offset:12288
    v_mfma_f32_16x16x32_bf16 v[236:239], a[92:95], a[138:141], v[236:239]
    v_perm_b32 v58, v85, v35, s39
    v_perm_b32 v59, v82, v35, s36
    v_mfma_f32_16x16x32_bf16 v[240:243], a[92:95], a[146:149], v[240:243]
    ds_read_b32 a199, v58
    ds_read_b32 a32, v59
    v_mfma_f32_16x16x32_bf16 v[244:247], a[92:95], a[154:157], v[244:247]
    buffer_load_dwordx4 v[52:55], v33, s[12:15], s41 offen sc1
    v_mfma_f32_16x16x32_bf16 v[248:251], a[92:95], a[162:165], v[248:251]
    ds_read_b128 a[64:67], v42 offset:14336
    v_perm_b32 v61, v82, v35, s37
    v_mfma_f32_16x16x32_bf16 v[252:255], a[92:95], a[178:181], v[252:255]
    s_waitcnt lgkmcnt(7)
    ds_read_b32 a33, v61
    ds_read_b128 a[68:71], v43 offset:14336
    v_mfma_f32_16x16x32_bf16 v[128:131], a[184:187], a[200:203], v[128:131]
    v_perm_b32 v60, v82, v35, s38
    v_perm_b32 v62, v82, v35, s39
    v_mfma_f32_16x16x32_bf16 v[128:131], a[188:191], a[204:207], v[128:131]
    ds_read_b32 a34, v60
    ds_read_b32 a35, v62
    v_mfma_f32_16x16x32_bf16 v[132:135], a[188:191], a[212:215], v[132:135]
    v_perm_b32 v63, v86, v35, s36
    v_perm_b32 v56, v86, v35, s37
    v_mfma_f32_16x16x32_bf16 v[132:135], a[184:187], a[208:211], v[132:135]
    s_mul_i32 s66, s63, 96
    s_lshl_b32 s67, s65, 5
    s_lshl_b32 s70, s64, 2
    s_add_u32 s67, s67, s70
    s_add_u32 s67, s67, 384
    s_mul_i32 s71, s59, 448
    s_add_u32 s70, s66, s71
    v_mad_u32_u24 v22, v3, 24, s70
    s_add_u32 s70, s67, s71
    v_lshl_add_u32 v23, v3, 3, s70
    s_mov_b32 s34, 7168
    s_mov_b32 s35, 0x20000
    s_mov_b32 s26, 256
    s_mov_b32 s27, 0x20000
    s_lshl_b32 s77, s59, 4
    s_mov_b32 s18, 14680064
    s_mov_b32 s19, 0x20000
    s_sub_u32 s70, 1024, s71
    v_mul_u32_u24 v16, 464, v4
    v_add3_u32 v26, v22, v16, s70
    v_add3_u32 v28, v23, v16, s70
    v_lshlrev_b32 v29, 3, v0
    v_xor_b32 v30, 512, v29
    v_add_u32 v29, 52992, v29
    v_add_u32 v30, 52992, v30
    v_mul_u32_u24 v16, 2341, v2
    v_lshrrev_b32 v16, 16, v16
    s_mul_i32 s73, s63, 1856
    s_add_u32 s73, s73, 1024
    v_add_lshl_u32 v24, v2, v16, 4
    v_add_u32 v24, s73, v24
    s_lshl_b32 s74, s58, 7
    s_lshl_b32 s75, s63, 2
    s_add_u32 s74, s74, s75
    s_mul_i32 s74, s74, 7168
    s_add_u32 s74, s74, s71
    v_mul_u32_u24 v17, 6720, v16
    v_lshl_add_u32 v25, v2, 4, v17
    v_lshrrev_b32 v16, 1, v16
    v_lshlrev_b32 v16, 30, v16
    v_add3_u32 v25, v25, v16, s74
    v_mfma_f32_16x16x32_bf16 v[136:139], a[184:187], a[216:219], v[136:139]
    buffer_load_dwordx4 v36, s[8:11], s56 offen offset:0 lds
    v_mfma_f32_16x16x32_bf16 v[136:139], a[188:191], a[220:223], v[136:139]
    ds_read_b32 a36, v63
    ds_read_b32 a37, v56
    v_mfma_f32_16x16x32_bf16 v[140:143], a[188:191], a[228:231], v[140:143]
    v_perm_b32 v57, v86, v35, s38
    v_perm_b32 v58, v86, v35, s39
    v_mfma_f32_16x16x32_bf16 v[140:143], a[184:187], a[224:227], v[140:143]
    ds_read_b32 a38, v57
    ds_read_b32 a39, v58
    v_mfma_f32_16x16x32_bf16 v[144:147], a[184:187], a[232:235], v[144:147]
    buffer_load_dwordx4 v37, s[8:11], s56 offen offset:1024 lds
    v_mfma_f32_16x16x32_bf16 v[144:147], a[188:191], a[236:239], v[144:147]
    s_waitcnt lgkmcnt(6)
    v_perm_b32 v59, v83, v35, s36
    v_perm_b32 v61, v83, v35, s37
    v_mfma_f32_16x16x32_bf16 v[148:151], a[188:191], a[244:247], v[148:151]
    ds_read_b32 a80, v59
    ds_read_b32 a81, v61
    v_perm_b32 v60, v87, v35, s36
    v_mfma_f32_16x16x32_bf16 v[148:151], a[184:187], a[240:243], v[148:151]
    ds_read_b32 a82, v60
    v_mfma_f32_16x16x32_bf16 v[152:155], a[184:187], a[248:251], v[152:155]
    buffer_load_dwordx4 v38, s[8:11], s56 offen offset:2048 lds
    v_mfma_f32_16x16x32_bf16 v[152:155], a[188:191], a[252:255], v[152:155]
    v_perm_b32 v62, v87, v35, s37
    v_perm_b32 v63, v88, v35, s36
    v_mfma_f32_16x16x32_bf16 v[156:159], a[188:191], a[68:71], v[156:159]
    ds_read_b32 a83, v62
    ds_read_b32 a0, v63
    v_perm_b32 v56, v88, v35, s37
    v_mfma_f32_16x16x32_bf16 v[156:159], a[184:187], a[64:67], v[156:159]
    ds_read_b32 a1, v56
    v_mfma_f32_16x16x32_bf16 v[160:163], a[192:195], a[200:203], v[160:163]
    buffer_load_dwordx4 v39, s[8:11], s56 offen offset:3072 lds
    v_mfma_f32_16x16x32_bf16 v[160:163], a[196:199], a[204:207], v[160:163]
    s_add_u32 m0, s57, 16384
    v_perm_b32 v57, v88, v35, s38
    v_perm_b32 v58, v88, v35, s39
    v_mfma_f32_16x16x32_bf16 v[164:167], a[196:199], a[212:215], v[164:167]
    s_add_u32 s56, s55, 768
    ds_read_b32 a2, v57
    v_perm_b32 v59, v92, v35, s36
    v_mfma_f32_16x16x32_bf16 v[164:167], a[192:195], a[208:211], v[164:167]
    ds_read_b32 a3, v58
    ds_read_b32 a4, v59
    v_mfma_f32_16x16x32_bf16 v[168:171], a[192:195], a[216:219], v[168:171]
    buffer_load_dwordx4 v[64:67], v34, s[12:15], s41 offen sc1
    v_mfma_f32_16x16x32_bf16 v[168:171], a[196:199], a[220:223], v[168:171]
    v_perm_b32 v61, v92, v35, s37
    v_perm_b32 v60, v92, v35, s38
    v_mfma_f32_16x16x32_bf16 v[172:175], a[196:199], a[228:231], v[172:175]
    ds_read_b32 a5, v61
    ds_read_b32 a6, v60
    v_perm_b32 v62, v92, v35, s39
    v_mfma_f32_16x16x32_bf16 v[172:175], a[192:195], a[224:227], v[172:175]
    ds_read_b32 a7, v62
    v_mfma_f32_16x16x32_bf16 v[176:179], a[192:195], a[232:235], v[176:179]
    buffer_load_dwordx4 v[68:71], v44, s[12:15], s41 offen sc1
    v_mfma_f32_16x16x32_bf16 v[176:179], a[196:199], a[236:239], v[176:179]
    v_perm_b32 v63, v89, v35, s36
    v_perm_b32 v56, v89, v35, s37
    v_mfma_f32_16x16x32_bf16 v[180:183], a[196:199], a[244:247], v[180:183]
    ds_read_b32 a8, v63
    v_perm_b32 v57, v89, v35, s38
    v_mfma_f32_16x16x32_bf16 v[180:183], a[192:195], a[240:243], v[180:183]
    s_waitcnt vmcnt(20)
    ds_read_b32 a9, v56
    ds_read_b32 a10, v57
    v_mfma_f32_16x16x32_bf16 v[184:187], a[192:195], a[248:251], v[184:187]
    buffer_load_dwordx4 v[72:75], v32, s[12:15], s42 offen sc1
    v_mfma_f32_16x16x32_bf16 v[184:187], a[196:199], a[252:255], v[184:187]
    s_barrier
    v_mfma_f32_16x16x32_bf16 v[188:191], a[196:199], a[68:71], v[188:191]
    ds_read_b128 a[16:19], v42 offset:16384
    v_perm_b32 v58, v89, v35, s39
    v_mfma_f32_16x16x32_bf16 v[188:191], a[192:195], a[64:67], v[188:191]
    s_waitcnt lgkmcnt(5)
    ds_read_b32 a11, v58
    ds_read_b128 a[20:23], v43 offset:16384
    v_mfma_f32_16x16x32_bf16 v[192:195], a[32:35], a[200:203], v[192:195]
    buffer_load_dwordx4 v[76:79], v33, s[12:15], s42 offen sc1
    v_mfma_f32_16x16x32_bf16 v[192:195], a[36:39], a[204:207], v[192:195]
    ds_read_b128 a[24:27], v42 offset:18432
    v_perm_b32 v59, v93, v35, s36
    v_mfma_f32_16x16x32_bf16 v[196:199], a[36:39], a[212:215], v[196:199]
    ds_read_b32 a12, v59
    v_perm_b32 v61, v93, v35, s37
    v_mfma_f32_16x16x32_bf16 v[196:199], a[32:35], a[208:211], v[196:199]
    ds_read_b32 a13, v61
    ds_read_b128 a[28:31], v43 offset:18432
    v_mfma_f32_16x16x32_bf16 v[200:203], a[32:35], a[216:219], v[200:203]
    v_perm_b32 v60, v93, v35, s38
    v_perm_b32 v62, v93, v35, s39
    v_mfma_f32_16x16x32_bf16 v[200:203], a[36:39], a[220:223], v[200:203]
    ds_read_b32 a14, v60
    ds_read_b32 a15, v62
    v_mfma_f32_16x16x32_bf16 v[204:207], a[36:39], a[228:231], v[204:207]
    ds_read_b128 a[40:43], v42 offset:20480
    v_perm_b32 v63, v90, v35, s36
    v_mfma_f32_16x16x32_bf16 v[204:207], a[32:35], a[224:227], v[204:207]
    ds_read_b32 a48, v63
    ds_read_b128 a[44:47], v43 offset:20480
    v_mfma_f32_16x16x32_bf16 v[208:211], a[32:35], a[232:235], v[208:211]
    buffer_load_dwordx4 v36, s[8:11], s3 offen offset:0 lds
    v_mfma_f32_16x16x32_bf16 v[208:211], a[36:39], a[236:239], v[208:211]
    ds_read_b128 a[56:59], v42 offset:22528
    v_perm_b32 v56, v90, v35, s37
    v_mfma_f32_16x16x32_bf16 v[212:215], a[36:39], a[244:247], v[212:215]
    ds_read_b32 a49, v56
    v_perm_b32 v57, v90, v35, s38
    v_mfma_f32_16x16x32_bf16 v[212:215], a[32:35], a[240:243], v[212:215]
    ds_read_b32 a50, v57
    ds_read_b128 a[60:63], v43 offset:22528
    v_mfma_f32_16x16x32_bf16 v[216:219], a[32:35], a[248:251], v[216:219]
    v_perm_b32 v58, v90, v35, s39
    v_perm_b32 v59, v94, v35, s36
    v_mfma_f32_16x16x32_bf16 v[216:219], a[36:39], a[252:255], v[216:219]
    ds_read_b32 a51, v58
    ds_read_b32 a52, v59
    v_perm_b32 v61, v94, v35, s37
    v_mfma_f32_16x16x32_bf16 v[220:223], a[36:39], a[68:71], v[220:223]
    s_waitcnt vmcnt(19)
    ds_read_b32 a53, v61
    ds_read_b128 a[72:75], v42 offset:24576
    v_mfma_f32_16x16x32_bf16 v[220:223], a[32:35], a[64:67], v[220:223]
    buffer_load_dwordx4 v37, s[8:11], s3 offen offset:1024 lds
    v_mfma_f32_16x16x32_bf16 v[224:227], a[80:83], a[202:205], v[224:227]
    v_or_b32 v99, s47, v99
    v_lshl_or_b32 v96, v100, 4, v96
    v_lshl_or_b32 v97, v101, 4, v97
    v_lshl_or_b32 v98, v102, 4, v98
    v_lshl_or_b32 v99, v103, 4, v99
    s_waitcnt vmcnt(19)
    v_lshl_or_b32 v96, v104, 8, v96
    v_lshl_or_b32 v97, v105, 8, v97
    v_lshl_or_b32 v98, v106, 8, v98
    s_waitcnt vmcnt(18)
    v_lshl_or_b32 v99, v107, 8, v99
    s_waitcnt vmcnt(17)
    v_lshl_or_b32 v96, v108, 12, v96
    v_lshl_or_b32 v97, v109, 12, v97
    v_lshl_or_b32 v98, v110, 12, v98
    s_waitcnt vmcnt(16)
    v_lshl_or_b32 v99, v111, 12, v99
L_pad1:
    s_cbranch_execz L_pad2
    s_waitcnt vmcnt(15)
    v_lshl_or_b32 v96, v112, 16, v96
    v_lshl_or_b32 v97, v113, 16, v97
    v_lshl_or_b32 v98, v114, 16, v98
    s_waitcnt vmcnt(14)
    v_lshl_or_b32 v96, v116, 20, v96
    v_lshl_or_b32 v97, v117, 20, v97
    v_lshl_or_b32 v98, v118, 20, v98
    s_waitcnt vmcnt(13)
    v_lshl_or_b32 v96, v120, 24, v96
    v_lshl_or_b32 v97, v121, 24, v97
    v_lshl_or_b32 v98, v122, 24, v98
    s_waitcnt vmcnt(12)
    v_lshl_or_b32 v96, v124, 28, v96
    v_lshl_or_b32 v97, v125, 28, v97
    v_lshl_or_b32 v98, v126, 28, v98
    buffer_store_dwordx4 v[96:99], v20, s[12:15], s62 offen sc1
    v_mfma_f32_16x16x32_bf16 v[228:231], a[80:83], a[210:213], v[228:231]
    ds_read_b128 a[76:79], v43 offset:24576
    v_perm_b32 v60, v94, v35, s38
    v_mfma_f32_16x16x32_bf16 v[232:235], a[80:83], a[218:221], v[232:235]
    ds_read_b32 a54, v60
    ds_read_b128 a[96:99], v42 offset:26624
    v_mfma_f32_16x16x32_bf16 v[236:239], a[80:83], a[226:229], v[236:239]
    buffer_load_dwordx4 v38, s[8:11], s3 offen offset:2048 lds
    v_mfma_f32_16x16x32_bf16 v[240:243], a[80:83], a[234:237], v[240:243]
    s_waitcnt vmcnt(12)
    ds_read_b128 a[100:103], v43 offset:26624
    v_perm_b32 v62, v94, v35, s39
    v_mfma_f32_16x16x32_bf16 v[244:247], a[80:83], a[242:245], v[244:247]
    ds_read_b32 a55, v62
    v_bitop3_b32 v63, v51, v55, s76 bitop3:0x7e
    v_perm_b32 v56, v91, v35, s36
    v_mfma_f32_16x16x32_bf16 v[248:251], a[80:83], a[250:253], v[248:251]
    s_waitcnt lgkmcnt(7)
    ds_read_b32 a84, v56
    ds_read_b128 a[128:131], v42 offset:28672
    v_mfma_f32_16x16x32_bf16 v[252:255], a[80:83], a[66:69], v[252:255]
    buffer_load_dwordx4 v39, s[8:11], s3 offen offset:3072 lds
    v_mfma_f32_16x16x32_bf16 v[128:131], a[0:3], a[16:19], v[128:131]
    s_add_u32 m0, s57, 32768
    ds_read_b128 a[132:135], v43 offset:28672
    v_cmp_lt_u32 vcc, 0xffff, v63
    v_mfma_f32_16x16x32_bf16 v[128:131], a[4:7], a[20:23], v[128:131]
    s_add_u32 s3, s69, 768
    ds_read_b128 a[168:171], v42 offset:30720
    v_perm_b32 v57, v91, v35, s37
    v_mfma_f32_16x16x32_bf16 v[132:135], a[4:7], a[28:31], v[132:135]
    v_perm_b32 v58, v95, v35, s36
    s_cbranch_vccnz L_slow2_0
L_back2_0:
    v_mfma_f32_16x16x32_bf16 v[132:135], a[0:3], a[24:27], v[132:135]
    ds_read_b128 a[172:175], v43 offset:30720
    ds_read_b32 a85, v57
    v_mfma_f32_16x16x32_bf16 v[136:139], a[0:3], a[40:43], v[136:139]
    buffer_load_dwordx4 v36, s[8:11], s56 offen offset:0 lds
    v_mfma_f32_16x16x32_bf16 v[136:139], a[4:7], a[44:47], v[136:139]
    ds_read_b32 a86, v58
    v_perm_b32 v59, v95, v35, s37
    v_mfma_f32_16x16x32_bf16 v[140:143], a[4:7], a[60:63], v[140:143]
    ds_read_b32 a87, v59
    v_perm_b32 v61, v48, v35, s36
    v_mfma_f32_16x16x32_bf16 v[140:143], a[0:3], a[56:59], v[140:143]
    s_waitcnt lgkmcnt(6)
    ds_read_b32 a104, v61
    v_perm_b32 v60, v48, v35, s37
    v_mfma_f32_16x16x32_bf16 v[144:147], a[0:3], a[72:75], v[144:147]
    ds_read_b32 a105, v60
    v_perm_b32 v62, v48, v35, s38
    v_mfma_f32_16x16x32_bf16 v[144:147], a[4:7], a[76:79], v[144:147]
    ds_read_b32 a106, v62
    v_perm_b32 v56, v48, v35, s39
    v_perm_b32 v63, v52, v35, s36
    v_mfma_f32_16x16x32_bf16 v[148:151], a[4:7], a[100:103], v[148:151]
    ds_read_b32 a107, v56
    ds_read_b32 a108, v63
    v_mfma_f32_16x16x32_bf16 v[148:151], a[0:3], a[96:99], v[148:151]
    buffer_load_dwordx4 v37, s[8:11], s56 offen offset:1024 lds
    v_mfma_f32_16x16x32_bf16 v[152:155], a[0:3], a[128:131], v[152:155]
    s_waitcnt lgkmcnt(7)
    v_perm_b32 v57, v52, v35, s37
    v_perm_b32 v58, v52, v35, s38
    v_mfma_f32_16x16x32_bf16 v[152:155], a[4:7], a[132:135], v[152:155]
    ds_read_b32 a109, v57
    ds_read_b32 a110, v58
    v_mfma_f32_16x16x32_bf16 v[156:159], a[4:7], a[172:175], v[156:159]
    v_perm_b32 v59, v52, v35, s39
    v_perm_b32 v61, v49, v35, s36
    v_mfma_f32_16x16x32_bf16 v[156:159], a[0:3], a[168:171], v[156:159]
    ds_read_b32 a111, v59
    ds_read_b32 a112, v61
    v_mfma_f32_16x16x32_bf16 v[160:163], a[8:11], a[16:19], v[160:163]
    v_perm_b32 v60, v49, v35, s37
    v_perm_b32 v62, v49, v35, s38
    v_mfma_f32_16x16x32_bf16 v[160:163], a[12:15], a[20:23], v[160:163]
    ds_read_b32 a113, v60
    ds_read_b32 a114, v62
    v_mfma_f32_16x16x32_bf16 v[164:167], a[12:15], a[28:31], v[164:167]
    buffer_load_dwordx4 v38, s[8:11], s56 offen offset:2048 lds
    v_mfma_f32_16x16x32_bf16 v[164:167], a[8:11], a[24:27], v[164:167]
    v_perm_b32 v56, v49, v35, s39
    v_perm_b32 v63, v53, v35, s36
    v_mfma_f32_16x16x32_bf16 v[168:171], a[8:11], a[40:43], v[168:171]
    ds_read_b32 a115, v56
    ds_read_b32 a116, v63
    v_mfma_f32_16x16x32_bf16 v[168:171], a[12:15], a[44:47], v[168:171]
    v_perm_b32 v57, v53, v35, s37
    v_perm_b32 v58, v53, v35, s38
    v_mfma_f32_16x16x32_bf16 v[172:175], a[12:15], a[60:63], v[172:175]
    ds_read_b32 a117, v57
    ds_read_b32 a118, v58
    v_mfma_f32_16x16x32_bf16 v[172:175], a[8:11], a[56:59], v[172:175]
    v_perm_b32 v59, v53, v35, s39
    v_perm_b32 v61, v50, v35, s36
    v_mfma_f32_16x16x32_bf16 v[176:179], a[8:11], a[72:75], v[176:179]
    ds_read_b32 a119, v59
    v_perm_b32 v60, v50, v35, s37
    v_mfma_f32_16x16x32_bf16 v[176:179], a[12:15], a[76:79], v[176:179]
    s_waitcnt vmcnt(12)
    ds_read_b32 a120, v61
    ds_read_b32 a121, v60
    v_mfma_f32_16x16x32_bf16 v[180:183], a[12:15], a[100:103], v[180:183]
    buffer_load_dwordx4 v39, s[8:11], s56 offen offset:3072 lds
    v_mfma_f32_16x16x32_bf16 v[180:183], a[8:11], a[96:99], v[180:183]
    s_barrier
    v_mfma_f32_16x16x32_bf16 v[184:187], a[8:11], a[128:131], v[184:187]
    s_add_u32 m0, s57, 49152
    ds_read_b128 a[136:139], v40 offset:0
    v_perm_b32 v62, v50, v35, s38
    v_mfma_f32_16x16x32_bf16 v[184:187], a[12:15], a[132:135], v[184:187]
    s_add_u32 s56, s55, 1024
    ds_read_b128 a[140:143], v41 offset:0
    ds_read_b32 a122, v62
    v_mfma_f32_16x16x32_bf16 v[188:191], a[12:15], a[172:175], v[188:191]
    ds_read_b128 a[148:151], v41 offset:2048
    v_perm_b32 v56, v50, v35, s39
    v_mfma_f32_16x16x32_bf16 v[188:191], a[8:11], a[168:171], v[188:191]
    ds_read_b128 a[144:147], v40 offset:2048
    ds_read_b32 a123, v56
    v_mfma_f32_16x16x32_bf16 v[192:195], a[48:51], a[16:19], v[192:195]
    ds_read_b128 a[152:155], v40 offset:4096
    v_mfma_f32_16x16x32_bf16 v[192:195], a[52:55], a[20:23], v[192:195]
    buffer_load_dwordx4 v36, s[8:11], s3 offen offset:0 lds
    v_mfma_f32_16x16x32_bf16 v[196:199], a[52:55], a[28:31], v[196:199]
    ds_read_b128 a[156:159], v41 offset:4096
    v_perm_b32 v63, v54, v35, s36
    v_mfma_f32_16x16x32_bf16 v[196:199], a[48:51], a[24:27], v[196:199]
    ds_read_b128 a[164:167], v41 offset:6144
    ds_read_b32 a124, v63
    v_mfma_f32_16x16x32_bf16 v[200:203], a[48:51], a[40:43], v[200:203]
    s_waitcnt vmcnt(12)
    ds_read_b128 a[160:163], v40 offset:6144
    v_bitop3_b32 v57, v67, v71, s76 bitop3:0x7e
    v_mfma_f32_16x16x32_bf16 v[200:203], a[52:55], a[44:47], v[200:203]
    ds_read_b128 a[88:91], v40 offset:8192
    v_cmp_lt_u32 vcc, 0xffff, v57
    v_mfma_f32_16x16x32_bf16 v[204:207], a[52:55], a[60:63], v[204:207]
    ds_read_b128 a[92:95], v41 offset:8192
    v_perm_b32 v58, v54, v35, s37
    v_mfma_f32_16x16x32_bf16 v[204:207], a[48:51], a[56:59], v[204:207]
    ds_read_b32 a125, v58
    s_cbranch_vccnz L_slow2_1
L_back2_1:
    v_mfma_f32_16x16x32_bf16 v[208:211], a[48:51], a[72:75], v[208:211]
    buffer_load_dwordx4 v37, s[8:11], s3 offen offset:1024 lds
    v_mfma_f32_16x16x32_bf16 v[208:211], a[52:55], a[76:79], v[208:211]
    ds_read_b128 a[176:179], v40 offset:10240
    v_perm_b32 v59, v54, v35, s38
    v_mfma_f32_16x16x32_bf16 v[212:215], a[52:55], a[100:103], v[212:215]
    ds_read_b32 a126, v59
    ds_read_b128 a[180:183], v41 offset:10240
    v_mfma_f32_16x16x32_bf16 v[212:215], a[48:51], a[96:99], v[212:215]
    v_perm_b32 v61, v54, v35, s39
    v_perm_b32 v60, v51, v35, s36
    v_mfma_f32_16x16x32_bf16 v[216:219], a[48:51], a[128:131], v[216:219]
    ds_read_b32 a127, v61
    ds_read_b32 a184, v60
    v_mfma_f32_16x16x32_bf16 v[216:219], a[52:55], a[132:135], v[216:219]
    ds_read_b128 a[192:195], v40 offset:12288
    v_perm_b32 v62, v51, v35, s37
    v_mfma_f32_16x16x32_bf16 v[220:223], a[52:55], a[172:175], v[220:223]
    ds_read_b32 a185, v62
    v_perm_b32 v56, v55, v35, s36
    v_perm_b32 v63, v55, v35, s37
    v_mfma_f32_16x16x32_bf16 v[220:223], a[48:51], a[168:171], v[220:223]
    s_waitcnt lgkmcnt(8)
    ds_read_b32 a186, v56
    ds_read_b32 a187, v63
    v_mfma_f32_16x16x32_bf16 v[224:227], a[84:87], a[18:21], v[224:227]
    buffer_load_dwordx4 v38, s[8:11], s3 offen offset:2048 lds
    v_mfma_f32_16x16x32_bf16 v[228:231], a[84:87], a[26:29], v[228:231]
    ds_read_b128 a[196:199], v41 offset:12288
    v_perm_b32 v57, v64, v35, s36
    v_mfma_f32_16x16x32_bf16 v[232:235], a[84:87], a[42:45], v[232:235]
    ds_read_b32 a32, v57
    v_perm_b32 v58, v64, v35, s37
    v_mfma_f32_16x16x32_bf16 v[236:239], a[84:87], a[58:61], v[236:239]
    ds_read_b32 a33, v58
    ds_read_b128 a[200:203], v40 offset:14336
    v_mfma_f32_16x16x32_bf16 v[240:243], a[84:87], a[74:77], v[240:243]
    v_perm_b32 v59, v64, v35, s38
    v_perm_b32 v61, v64, v35, s39
    v_mfma_f32_16x16x32_bf16 v[244:247], a[84:87], a[98:101], v[244:247]
    ds_read_b32 a34, v59
    ds_read_b32 a35, v61
    v_perm_b32 v60, v68, v35, s36
    v_mfma_f32_16x16x32_bf16 v[248:251], a[84:87], a[130:133], v[248:251]
    ds_read_b32 a36, v60
    ds_read_b128 a[204:207], v41 offset:14336
    v_mfma_f32_16x16x32_bf16 v[252:255], a[84:87], a[170:173], v[252:255]
    buffer_load_dwordx4 v39, s[8:11], s3 offen offset:3072 lds
    v_mfma_f32_16x16x32_bf16 v[128:131], a[104:107], a[136:139], v[128:131]
    s_add_u32 m0, s57, 65536
    v_perm_b32 v62, v68, v35, s37
    v_perm_b32 v56, v68, v35, s38
    v_mfma_f32_16x16x32_bf16 v[128:131], a[108:111], a[140:143], v[128:131]
    s_add_u32 s3, s69, 1024
    ds_read_b32 a37, v62
    ds_read_b32 a38, v56
    v_mfma_f32_16x16x32_bf16 v[132:135], a[108:111], a[148:151], v[132:135]
    s_waitcnt vmcnt(13)
    v_bitop3_b32 v63, v75, v79, s76 bitop3:0x7e
    v_perm_b32 v57, v68, v35, s39
    v_mfma_f32_16x16x32_bf16 v[132:135], a[104:107], a[144:147], v[132:135]
    ds_read_b32 a39, v57
    v_mfma_f32_16x16x32_bf16 v[136:139], a[104:107], a[152:155], v[136:139]
    buffer_load_dwordx4 v[80:83], v34, s[12:15], s42 offen sc1
    v_mfma_f32_16x16x32_bf16 v[136:139], a[108:111], a[156:159], v[136:139]
    v_cmp_lt_u32 vcc, 0xffff, v63
    v_perm_b32 v58, v65, v35, s36
    v_mfma_f32_16x16x32_bf16 v[140:143], a[108:111], a[164:167], v[140:143]
    ds_read_b32 a208, v58
    v_perm_b32 v59, v65, v35, s37
    v_mfma_f32_16x16x32_bf16 v[140:143], a[104:107], a[160:163], v[140:143]
    v_perm_b32 v61, v65, v35, s38
    s_cbranch_vccnz L_slow3_0
L_back3_0:
    v_mfma_f32_16x16x32_bf16 v[144:147], a[104:107], a[88:91], v[144:147]
    s_waitcnt lgkmcnt(4)
    ds_read_b32 a209, v59
    ds_read_b32 a210, v61
    v_mfma_f32_16x16x32_bf16 v[144:147], a[108:111], a[92:95], v[144:147]
    buffer_load_dwordx4 v[84:87], v44, s[12:15], s42 offen sc1
    v_mfma_f32_16x16x32_bf16 v[148:151], a[108:111], a[180:183], v[148:151]
    v_perm_b32 v60, v65, v35, s39
    v_perm_b32 v62, v69, v35, s36
    v_mfma_f32_16x16x32_bf16 v[148:151], a[104:107], a[176:179], v[148:151]
    ds_read_b32 a211, v60
    ds_read_b32 a212, v62
    v_mfma_f32_16x16x32_bf16 v[152:155], a[104:107], a[192:195], v[152:155]
    v_perm_b32 v56, v69, v35, s37
    v_perm_b32 v57, v69, v35, s38
    v_mfma_f32_16x16x32_bf16 v[152:155], a[108:111], a[196:199], v[152:155]
    ds_read_b32 a213, v56
    ds_read_b32 a214, v57
    v_mfma_f32_16x16x32_bf16 v[156:159], a[108:111], a[204:207], v[156:159]
    v_perm_b32 v63, v69, v35, s39
    v_perm_b32 v58, v66, v35, s36
    v_mfma_f32_16x16x32_bf16 v[156:159], a[104:107], a[200:203], v[156:159]
    ds_read_b32 a215, v63
    ds_read_b32 a216, v58
    v_mfma_f32_16x16x32_bf16 v[160:163], a[112:115], a[136:139], v[160:163]
    buffer_load_dwordx4 v36, s[8:11], s56 offen offset:0 lds
    v_mfma_f32_16x16x32_bf16 v[160:163], a[116:119], a[140:143], v[160:163]
    v_perm_b32 v59, v66, v35, s37
    v_perm_b32 v61, v66, v35, s38
    v_mfma_f32_16x16x32_bf16 v[164:167], a[116:119], a[148:151], v[164:167]
    ds_read_b32 a217, v59
    ds_read_b32 a218, v61
    v_mfma_f32_16x16x32_bf16 v[164:167], a[112:115], a[144:147], v[164:167]
    v_perm_b32 v60, v66, v35, s39
    v_perm_b32 v62, v70, v35, s36
    v_mfma_f32_16x16x32_bf16 v[168:171], a[112:115], a[152:155], v[168:171]
    ds_read_b32 a219, v60
    ds_read_b32 a220, v62
    v_mfma_f32_16x16x32_bf16 v[168:171], a[116:119], a[156:159], v[168:171]
    buffer_load_dwordx4 v[96:99], v32, s[12:15], s43 offen sc1
    v_mfma_f32_16x16x32_bf16 v[172:175], a[116:119], a[164:167], v[172:175]
    v_perm_b32 v56, v70, v35, s37
    v_perm_b32 v57, v70, v35, s38
    v_mfma_f32_16x16x32_bf16 v[172:175], a[112:115], a[160:163], v[172:175]
    ds_read_b32 a221, v56
    ds_read_b32 a222, v57
    v_mfma_f32_16x16x32_bf16 v[176:179], a[112:115], a[88:91], v[176:179]
    v_perm_b32 v63, v70, v35, s39
    v_perm_b32 v58, v67, v35, s36
    v_mfma_f32_16x16x32_bf16 v[176:179], a[116:119], a[92:95], v[176:179]
    ds_read_b32 a223, v63
    ds_read_b32 a188, v58
    v_mfma_f32_16x16x32_bf16 v[180:183], a[116:119], a[180:183], v[180:183]
    buffer_load_dwordx4 v[100:103], v33, s[12:15], s43 offen sc1
    v_mfma_f32_16x16x32_bf16 v[180:183], a[112:115], a[176:179], v[180:183]
    s_waitcnt vmcnt(13)
    v_perm_b32 v59, v67, v35, s37
    v_perm_b32 v61, v71, v35, s36
    v_mfma_f32_16x16x32_bf16 v[184:187], a[112:115], a[192:195], v[184:187]
    s_barrier
    v_mfma_f32_16x16x32_bf16 v[184:187], a[116:119], a[196:199], v[184:187]
    ds_read_b32 a189, v59
    ds_read_b32 a190, v61
    v_mfma_f32_16x16x32_bf16 v[188:191], a[116:119], a[204:207], v[188:191]
    ds_read_b128 a[224:227], v40 offset:16384
    v_perm_b32 v60, v71, v35, s37
    v_mfma_f32_16x16x32_bf16 v[188:191], a[112:115], a[200:203], v[188:191]
    ds_read_b32 a191, v60
    v_perm_b32 v62, v72, v35, s36
    v_mfma_f32_16x16x32_bf16 v[192:195], a[120:123], a[136:139], v[192:195]
    ds_read_b32 a232, v62
    ds_read_b128 a[228:231], v41 offset:16384
    v_mfma_f32_16x16x32_bf16 v[192:195], a[124:127], a[140:143], v[192:195]
    buffer_load_dwordx4 v37, s[8:11], s56 offen offset:1024 lds
    v_mfma_f32_16x16x32_bf16 v[196:199], a[124:127], a[148:151], v[196:199]
    ds_read_b128 a[240:243], v40 offset:18432
    v_perm_b32 v56, v72, v35, s37
    v_mfma_f32_16x16x32_bf16 v[196:199], a[120:123], a[144:147], v[196:199]
    ds_read_b32 a233, v56
    ds_read_b128 a[244:247], v41 offset:18432
    v_mfma_f32_16x16x32_bf16 v[200:203], a[120:123], a[152:155], v[200:203]
    v_perm_b32 v57, v72, v35, s38
    v_perm_b32 v63, v72, v35, s39
    v_mfma_f32_16x16x32_bf16 v[200:203], a[124:127], a[156:159], v[200:203]
    ds_read_b32 a234, v57
    ds_read_b32 a235, v63
    v_mfma_f32_16x16x32_bf16 v[204:207], a[124:127], a[164:167], v[204:207]
    ds_read_b128 a[248:251], v40 offset:20480
    v_perm_b32 v58, v76, v35, s36
    v_mfma_f32_16x16x32_bf16 v[204:207], a[120:123], a[160:163], v[204:207]
    ds_read_b32 a236, v58
    ds_read_b128 a[252:255], v41 offset:20480
    v_mfma_f32_16x16x32_bf16 v[208:211], a[120:123], a[88:91], v[208:211]
    buffer_load_dwordx4 v38, s[8:11], s56 offen offset:2048 lds
    v_mfma_f32_16x16x32_bf16 v[208:211], a[124:127], a[92:95], v[208:211]
    ds_read_b128 a[64:67], v40 offset:22528
    v_perm_b32 v59, v76, v35, s37
    v_mfma_f32_16x16x32_bf16 v[212:215], a[124:127], a[180:183], v[212:215]
    ds_read_b32 a237, v59
    v_perm_b32 v61, v76, v35, s38
    v_mfma_f32_16x16x32_bf16 v[212:215], a[120:123], a[176:179], v[212:215]
    ds_read_b32 a238, v61
    ds_read_b128 a[68:71], v41 offset:22528
    v_mfma_f32_16x16x32_bf16 v[216:219], a[120:123], a[192:195], v[216:219]
    v_perm_b32 v60, v76, v35, s39
    v_perm_b32 v62, v73, v35, s36
    v_mfma_f32_16x16x32_bf16 v[216:219], a[124:127], a[196:199], v[216:219]
    ds_read_b32 a239, v60
    ds_read_b32 a0, v62
    v_mfma_f32_16x16x32_bf16 v[220:223], a[124:127], a[204:207], v[220:223]
    ds_read_b128 a[8:11], v40 offset:24576
    v_perm_b32 v56, v73, v35, s37
    v_mfma_f32_16x16x32_bf16 v[220:223], a[120:123], a[200:203], v[220:223]
    ds_read_b32 a1, v56
    ds_read_b128 a[12:15], v41 offset:24576
    v_mfma_f32_16x16x32_bf16 v[224:227], a[184:187], a[138:141], v[224:227]
    buffer_load_dwordx4 v39, s[8:11], s56 offen offset:3072 lds
    v_mfma_f32_16x16x32_bf16 v[228:231], a[184:187], a[146:149], v[228:231]
    s_add_u32 m0, s57, 81920
    ds_read_b128 a[48:51], v40 offset:26624
    v_perm_b32 v57, v73, v35, s38
    v_mfma_f32_16x16x32_bf16 v[232:235], a[184:187], a[154:157], v[232:235]
    ds_read_b32 a2, v57
    v_perm_b32 v63, v73, v35, s39
    v_mfma_f32_16x16x32_bf16 v[236:239], a[184:187], a[162:165], v[236:239]
    ds_read_b32 a3, v63
    ds_read_b128 a[52:55], v41 offset:26624
    v_mfma_f32_16x16x32_bf16 v[240:243], a[184:187], a[90:93], v[240:243]
    v_perm_b32 v58, v77, v35, s36
    v_perm_b32 v59, v77, v35, s37
    v_mfma_f32_16x16x32_bf16 v[244:247], a[184:187], a[178:181], v[244:247]
    ds_read_b32 a4, v58
    ds_read_b32 a5, v59
    v_perm_b32 v61, v77, v35, s38
    v_mfma_f32_16x16x32_bf16 v[248:251], a[184:187], a[194:197], v[248:251]
    s_waitcnt lgkmcnt(9)
    ds_read_b32 a6, v61
    ds_read_b128 a[16:19], v40 offset:28672
    v_mfma_f32_16x16x32_bf16 v[252:255], a[184:187], a[202:205], v[252:255]
    buffer_load_dwordx4 v36, s[8:11], s3 offen offset:0 lds
    v_mfma_f32_16x16x32_bf16 v[128:131], a[32:35], a[224:227], v[128:131]
    ds_read_b128 a[20:23], v41 offset:28672
    v_perm_b32 v60, v77, v35, s39
    v_mfma_f32_16x16x32_bf16 v[128:131], a[36:39], a[228:231], v[128:131]
    ds_read_b32 a7, v60
    ds_read_b128 a[24:27], v40 offset:30720
    v_mfma_f32_16x16x32_bf16 v[132:135], a[36:39], a[244:247], v[132:135]
    s_add_u32 s56, s55, 1280
    v_perm_b32 v62, v74, v35, s36
    v_perm_b32 v56, v74, v35, s37
    v_mfma_f32_16x16x32_bf16 v[132:135], a[32:35], a[240:243], v[132:135]
    ds_read_b128 a[28:31], v41 offset:30720
    ds_read_b32 a40, v62
    v_mfma_f32_16x16x32_bf16 v[136:139], a[32:35], a[248:251], v[136:139]
    ds_read_b32 a41, v56
    v_perm_b32 v57, v74, v35, s38
    v_perm_b32 v63, v74, v35, s39
    v_mfma_f32_16x16x32_bf16 v[136:139], a[36:39], a[252:255], v[136:139]
    ds_read_b32 a42, v57
    ds_read_b32 a43, v63
    v_mfma_f32_16x16x32_bf16 v[140:143], a[36:39], a[68:71], v[140:143]
    buffer_load_dwordx4 v37, s[8:11], s3 offen offset:1024 lds
    v_mfma_f32_16x16x32_bf16 v[140:143], a[32:35], a[64:67], v[140:143]
    s_waitcnt lgkmcnt(8)
    v_perm_b32 v58, v78, v35, s36
    v_perm_b32 v59, v78, v35, s37
    v_mfma_f32_16x16x32_bf16 v[144:147], a[32:35], a[8:11], v[144:147]
    ds_read_b32 a44, v58
    ds_read_b32 a45, v59
    v_mfma_f32_16x16x32_bf16 v[144:147], a[36:39], a[12:15], v[144:147]
    v_perm_b32 v61, v78, v35, s38
    v_perm_b32 v60, v78, v35, s39
    v_mfma_f32_16x16x32_bf16 v[148:151], a[36:39], a[52:55], v[148:151]
    ds_read_b32 a46, v61
    ds_read_b32 a47, v60
    v_mfma_f32_16x16x32_bf16 v[148:151], a[32:35], a[48:51], v[148:151]
    v_perm_b32 v62, v75, v35, s36
    v_perm_b32 v56, v75, v35, s37
    v_mfma_f32_16x16x32_bf16 v[152:155], a[32:35], a[16:19], v[152:155]
    s_waitcnt lgkmcnt(7)
    ds_read_b32 a56, v62
    v_perm_b32 v57, v79, v35, s36
    v_mfma_f32_16x16x32_bf16 v[152:155], a[36:39], a[20:23], v[152:155]
    ds_read_b32 a57, v56
    ds_read_b32 a58, v57
    v_mfma_f32_16x16x32_bf16 v[156:159], a[36:39], a[28:31], v[156:159]
    buffer_load_dwordx4 v38, s[8:11], s3 offen offset:2048 lds
    v_mfma_f32_16x16x32_bf16 v[156:159], a[32:35], a[24:27], v[156:159]
    v_perm_b32 v63, v79, v35, s37
    v_mfma_f32_16x16x32_bf16 v[160:163], a[208:211], a[224:227], v[160:163]
    ds_read_b32 a59, v63
    v_mfma_f32_16x16x32_bf16 v[160:163], a[212:215], a[228:231], v[160:163]
    v_mfma_f32_16x16x32_bf16 v[164:167], a[212:215], a[244:247], v[164:167]
    v_mfma_f32_16x16x32_bf16 v[164:167], a[208:211], a[240:243], v[164:167]
    v_mfma_f32_16x16x32_bf16 v[168:171], a[208:211], a[248:251], v[168:171]
    buffer_load_dwordx4 v[104:107], v34, s[12:15], s43 offen sc1
    v_mfma_f32_16x16x32_bf16 v[168:171], a[212:215], a[252:255], v[168:171]
    s_waitcnt vmcnt(12)
    v_mfma_f32_16x16x32_bf16 v[172:175], a[212:215], a[68:71], v[172:175]
    s_barrier
    v_mfma_f32_16x16x32_bf16 v[172:175], a[208:211], a[64:67], v[172:175]
    ds_read_b128 a[72:75], v40 offset:32768
    v_mfma_f32_16x16x32_bf16 v[176:179], a[208:211], a[8:11], v[176:179]
    buffer_load_dwordx4 v[108:111], v44, s[12:15], s43 offen sc1
    v_mfma_f32_16x16x32_bf16 v[176:179], a[212:215], a[12:15], v[176:179]
    ds_read_b128 a[76:79], v41 offset:32768
    v_mfma_f32_16x16x32_bf16 v[180:183], a[212:215], a[52:55], v[180:183]
    ds_read_b128 a[100:103], v41 offset:34816
    v_mfma_f32_16x16x32_bf16 v[180:183], a[208:211], a[48:51], v[180:183]
    ds_read_b128 a[96:99], v40 offset:34816
    v_mfma_f32_16x16x32_bf16 v[184:187], a[208:211], a[16:19], v[184:187]
    ds_read_b128 a[128:131], v40 offset:36864
    v_mfma_f32_16x16x32_bf16 v[184:187], a[212:215], a[20:23], v[184:187]
    ds_read_b128 a[132:135], v41 offset:36864
    v_mfma_f32_16x16x32_bf16 v[188:191], a[212:215], a[28:31], v[188:191]
    s_waitcnt vmcnt(11)
    ds_read_b128 a[80:83], v40 offset:38912
    v_mfma_f32_16x16x32_bf16 v[188:191], a[208:211], a[24:27], v[188:191]
    buffer_load_dwordx4 v39, s[8:11], s3 offen offset:3072 lds
    v_mfma_f32_16x16x32_bf16 v[192:195], a[216:219], a[224:227], v[192:195]
    s_add_u32 m0, s57, 0
    ds_read_b128 a[84:87], v41 offset:38912
    v_bitop3_b32 v58, v83, v87, s76 bitop3:0x7e
    v_mfma_f32_16x16x32_bf16 v[192:195], a[220:223], a[228:231], v[192:195]
    s_add_u32 s3, s69, 1280
    ds_read_b128 a[168:171], v40 offset:40960
    v_cmp_lt_u32 vcc, 0xffff, v58
    v_mfma_f32_16x16x32_bf16 v[196:199], a[220:223], a[244:247], v[196:199]
    v_mfma_f32_16x16x32_bf16 v[196:199], a[216:219], a[240:243], v[196:199]
    s_cbranch_vccnz L_slow3_1
L_back3_1:
    v_mfma_f32_16x16x32_bf16 v[200:203], a[216:219], a[248:251], v[200:203]
    buffer_load_dwordx4 v[112:115], v32, s[12:15], s44 offen sc1
    v_mfma_f32_16x16x32_bf16 v[200:203], a[220:223], a[252:255], v[200:203]
    v_perm_b32 v59, v83, v35, s36
    v_perm_b32 v61, v83, v35, s37
    v_mfma_f32_16x16x32_bf16 v[204:207], a[220:223], a[68:71], v[204:207]
    ds_read_b32 a60, v59
    ds_read_b32 a61, v61
    v_mfma_f32_16x16x32_bf16 v[204:207], a[216:219], a[64:67], v[204:207]
    ds_read_b128 a[172:175], v41 offset:40960
    v_mfma_f32_16x16x32_bf16 v[208:211], a[216:219], a[8:11], v[208:211]
    buffer_load_dwordx4 v[116:119], v33, s[12:15], s44 offen sc1
    v_mfma_f32_16x16x32_bf16 v[208:211], a[220:223], a[12:15], v[208:211]
    v_perm_b32 v60, v87, v35, s36
    v_perm_b32 v62, v87, v35, s37
    v_mfma_f32_16x16x32_bf16 v[212:215], a[220:223], a[52:55], v[212:215]
    ds_read_b32 a62, v60
    ds_read_b32 a63, v62
    v_mfma_f32_16x16x32_bf16 v[212:215], a[216:219], a[48:51], v[212:215]
    v_perm_b32 v56, v80, v35, s36
    v_perm_b32 v57, v80, v35, s37
    v_mfma_f32_16x16x32_bf16 v[216:219], a[216:219], a[16:19], v[216:219]
    ds_read_b128 a[104:107], v40 offset:43008
    ds_read_b32 a112, v56
    v_mfma_f32_16x16x32_bf16 v[216:219], a[220:223], a[20:23], v[216:219]
    ds_read_b32 a113, v57
    v_perm_b32 v63, v80, v35, s38
    v_mfma_f32_16x16x32_bf16 v[220:223], a[220:223], a[28:31], v[220:223]
    ds_read_b32 a114, v63
    v_perm_b32 v58, v80, v35, s39
    v_mfma_f32_16x16x32_bf16 v[220:223], a[216:219], a[24:27], v[220:223]
    ds_read_b128 a[108:111], v41 offset:43008
    ds_read_b32 a115, v58
    v_mfma_f32_16x16x32_bf16 v[224:227], a[188:191], a[226:229], v[224:227]
    buffer_load_dwordx4 v36, s[8:11], s56 offen offset:0 lds
    v_mfma_f32_16x16x32_bf16 v[228:231], a[188:191], a[242:245], v[228:231]
    s_waitcnt vmcnt(12)
    v_bitop3_b32 v59, v99, v103, s76 bitop3:0x7e
    v_perm_b32 v61, v84, v35, s36
    v_mfma_f32_16x16x32_bf16 v[232:235], a[188:191], a[250:253], v[232:235]
    ds_read_b128 a[120:123], v40 offset:45056
    ds_read_b32 a116, v61
    v_cmp_lt_u32 vcc, 0xffff, v59
    v_mfma_f32_16x16x32_bf16 v[236:239], a[188:191], a[66:69], v[236:239]
    v_perm_b32 v60, v84, v35, s37
    v_perm_b32 v62, v84, v35, s38
    v_mfma_f32_16x16x32_bf16 v[240:243], a[188:191], a[10:13], v[240:243]
    ds_read_b32 a117, v60
    ds_read_b32 a118, v62
    v_mfma_f32_16x16x32_bf16 v[244:247], a[188:191], a[50:53], v[244:247]
    ds_read_b128 a[124:127], v41 offset:45056
    s_cbranch_vccnz L_slow4_0
L_back4_0:
    v_mfma_f32_16x16x32_bf16 v[248:251], a[188:191], a[18:21], v[248:251]
    s_waitcnt lgkmcnt(8)
    ds_read_b128 a[136:139], v40 offset:47104
    v_mfma_f32_16x16x32_bf16 v[252:255], a[188:191], a[26:29], v[252:255]
    buffer_load_dwordx4 v37, s[8:11], s56 offen offset:1024 lds
    v_mfma_f32_16x16x32_bf16 v[128:131], a[232:235], a[72:75], v[128:131]
    v_perm_b32 v56, v84, v35, s39
    v_perm_b32 v57, v81, v35, s36
    v_mfma_f32_16x16x32_bf16 v[128:131], a[236:239], a[76:79], v[128:131]
    ds_read_b32 a119, v56
    ds_read_b32 a144, v57
L_pad2:
    s_cbranch_execz L_pad3
    v_mfma_f32_16x16x32_bf16 v[132:135], a[236:239], a[100:103], v[132:135]
    ds_read_b128 a[140:143], v41 offset:47104
    v_perm_b32 v63, v81, v35, s37
    v_mfma_f32_16x16x32_bf16 v[132:135], a[232:235], a[96:99], v[132:135]
    ds_read_b32 a145, v63
    v_perm_b32 v58, v81, v35, s38
    v_mfma_f32_16x16x32_bf16 v[136:139], a[232:235], a[128:131], v[136:139]
    ds_read_b32 a146, v58
    v_perm_b32 v59, v81, v35, s39
    v_mfma_f32_16x16x32_bf16 v[136:139], a[236:239], a[132:135], v[136:139]
    ds_read_b32 a147, v59
    v_perm_b32 v61, v85, v35, s36
    v_mfma_f32_16x16x32_bf16 v[140:143], a[236:239], a[84:87], v[140:143]
    ds_read_b32 a148, v61
    v_perm_b32 v60, v85, v35, s37
    v_mfma_f32_16x16x32_bf16 v[140:143], a[232:235], a[80:83], v[140:143]
    ds_read_b32 a149, v60
    v_perm_b32 v62, v85, v35, s38
    v_mfma_f32_16x16x32_bf16 v[144:147], a[232:235], a[168:171], v[144:147]
    s_waitcnt lgkmcnt(8)
    ds_read_b32 a150, v62
    ds_read_b128 a[152:155], v40 offset:49152
    v_mfma_f32_16x16x32_bf16 v[144:147], a[236:239], a[172:175], v[144:147]
    buffer_load_dwordx4 v[120:123], v34, s[12:15], s44 offen sc1
    v_mfma_f32_16x16x32_bf16 v[148:151], a[236:239], a[108:111], v[148:151]
    v_perm_b32 v56, v85, v35, s39
    v_perm_b32 v57, v82, v35, s36
    v_mfma_f32_16x16x32_bf16 v[148:151], a[232:235], a[104:107], v[148:151]
    ds_read_b32 a151, v56
    ds_read_b32 a160, v57
    v_mfma_f32_16x16x32_bf16 v[152:155], a[232:235], a[120:123], v[152:155]
    s_waitcnt lgkmcnt(8)
    ds_read_b128 a[156:159], v41 offset:49152
    v_mfma_f32_16x16x32_bf16 v[152:155], a[236:239], a[124:127], v[152:155]
    buffer_load_dwordx4 v[124:127], v44, s[12:15], s44 offen sc1
    v_mfma_f32_16x16x32_bf16 v[156:159], a[236:239], a[140:143], v[156:159]
    ds_read_b128 a[88:91], v40 offset:51200
    v_perm_b32 v63, v82, v35, s37
    v_mfma_f32_16x16x32_bf16 v[156:159], a[232:235], a[136:139], v[156:159]
    ds_read_b128 a[92:95], v41 offset:51200
    ds_read_b32 a161, v63
    v_mfma_f32_16x16x32_bf16 v[160:163], a[0:3], a[72:75], v[160:163]
    ds_read_b128 a[176:179], v40 offset:53248
    v_mfma_f32_16x16x32_bf16 v[160:163], a[4:7], a[76:79], v[160:163]
    buffer_load_dwordx4 v38, s[8:11], s56 offen offset:2048 lds
    v_mfma_f32_16x16x32_bf16 v[164:167], a[4:7], a[100:103], v[164:167]
    v_perm_b32 v58, v82, v35, s38
    v_perm_b32 v59, v82, v35, s39
    v_mfma_f32_16x16x32_bf16 v[164:167], a[0:3], a[96:99], v[164:167]
    ds_read_b32 a162, v58
    ds_read_b32 a163, v59
    v_mfma_f32_16x16x32_bf16 v[168:171], a[0:3], a[128:131], v[168:171]
    v_perm_b32 v61, v86, v35, s36
    v_perm_b32 v60, v86, v35, s37
    v_mfma_f32_16x16x32_bf16 v[168:171], a[4:7], a[132:135], v[168:171]
    ds_read_b128 a[180:183], v41 offset:53248
    ds_read_b32 a164, v61
    v_mfma_f32_16x16x32_bf16 v[172:175], a[4:7], a[84:87], v[172:175]
    ds_read_b32 a165, v60
    ds_read_b128 a[192:195], v40 offset:55296
    v_mfma_f32_16x16x32_bf16 v[172:175], a[0:3], a[80:83], v[172:175]
    buffer_load_dwordx4 v39, s[8:11], s56 offen offset:3072 lds
    v_mfma_f32_16x16x32_bf16 v[176:179], a[0:3], a[168:171], v[176:179]
    s_add_u32 m0, s57, 16384
    v_perm_b32 v62, v86, v35, s38
    v_perm_b32 v56, v86, v35, s39
    v_mfma_f32_16x16x32_bf16 v[176:179], a[4:7], a[172:175], v[176:179]
    ds_read_b32 a166, v62
    ds_read_b32 a167, v56
    v_mfma_f32_16x16x32_bf16 v[180:183], a[4:7], a[108:111], v[180:183]
    v_perm_b32 v57, v96, v35, s36
    v_perm_b32 v63, v96, v35, s37
    v_mfma_f32_16x16x32_bf16 v[180:183], a[0:3], a[104:107], v[180:183]
    ds_read_b128 a[196:199], v41 offset:55296
    ds_read_b32 a200, v57
    v_mfma_f32_16x16x32_bf16 v[184:187], a[0:3], a[120:123], v[184:187]
    ds_read_b32 a201, v63
    v_perm_b32 v58, v96, v35, s38
    v_mfma_f32_16x16x32_bf16 v[184:187], a[4:7], a[124:127], v[184:187]
    ds_read_b32 a202, v58
    v_perm_b32 v59, v96, v35, s39
    v_mfma_f32_16x16x32_bf16 v[188:191], a[4:7], a[140:143], v[188:191]
    ds_read_b128 a[32:35], v40 offset:57344
    ds_read_b32 a203, v59
    v_mfma_f32_16x16x32_bf16 v[188:191], a[0:3], a[136:139], v[188:191]
    buffer_load_dwordx4 v36, s[8:11], s3 offen offset:0 lds
    v_mfma_f32_16x16x32_bf16 v[192:195], a[40:43], a[72:75], v[192:195]
    v_perm_b32 v61, v100, v35, s36
    v_perm_b32 v60, v100, v35, s37
    v_mfma_f32_16x16x32_bf16 v[192:195], a[44:47], a[76:79], v[192:195]
    ds_read_b128 a[36:39], v41 offset:57344
    ds_read_b32 a204, v61
    v_mfma_f32_16x16x32_bf16 v[196:199], a[44:47], a[100:103], v[196:199]
    ds_read_b32 a205, v60
    v_perm_b32 v62, v100, v35, s38
    v_mfma_f32_16x16x32_bf16 v[196:199], a[40:43], a[96:99], v[196:199]
    ds_read_b32 a206, v62
    v_perm_b32 v56, v100, v35, s39
    v_mfma_f32_16x16x32_bf16 v[200:203], a[40:43], a[128:131], v[200:203]
    ds_read_b128 a[208:211], v40 offset:59392
    ds_read_b32 a207, v56
    v_mfma_f32_16x16x32_bf16 v[200:203], a[44:47], a[132:135], v[200:203]
    ds_read_b128 a[212:215], v41 offset:59392
    v_mfma_f32_16x16x32_bf16 v[204:207], a[44:47], a[84:87], v[204:207]
    buffer_load_dwordx4 v37, s[8:11], s3 offen offset:1024 lds
    v_mfma_f32_16x16x32_bf16 v[204:207], a[40:43], a[80:83], v[204:207]
    v_perm_b32 v57, v97, v35, s36
    v_perm_b32 v63, v97, v35, s37
    v_mfma_f32_16x16x32_bf16 v[208:211], a[40:43], a[168:171], v[208:211]
    ds_read_b32 a216, v57
    ds_read_b32 a217, v63
    v_mfma_f32_16x16x32_bf16 v[208:211], a[44:47], a[172:175], v[208:211]
    v_perm_b32 v58, v97, v35, s38
    v_perm_b32 v59, v97, v35, s39
    v_mfma_f32_16x16x32_bf16 v[212:215], a[44:47], a[108:111], v[212:215]
    ds_read_b128 a[224:227], v40 offset:61440
    ds_read_b32 a218, v58
    v_mfma_f32_16x16x32_bf16 v[212:215], a[40:43], a[104:107], v[212:215]
    ds_read_b32 a219, v59
    v_perm_b32 v61, v101, v35, s36
    v_mfma_f32_16x16x32_bf16 v[216:219], a[40:43], a[120:123], v[216:219]
    ds_read_b32 a220, v61
    ds_read_b128 a[228:231], v41 offset:61440
    v_mfma_f32_16x16x32_bf16 v[216:219], a[44:47], a[124:127], v[216:219]
    buffer_load_dwordx4 v38, s[8:11], s3 offen offset:2048 lds
    v_mfma_f32_16x16x32_bf16 v[220:223], a[44:47], a[140:143], v[220:223]
    s_waitcnt vmcnt(12)
    v_bitop3_b32 v60, v107, v111, s76 bitop3:0x7e
    v_perm_b32 v62, v101, v35, s37
    v_mfma_f32_16x16x32_bf16 v[220:223], a[40:43], a[136:139], v[220:223]
    ds_read_b32 a221, v62
    v_cmp_lt_u32 vcc, 0xffff, v60
    v_mfma_f32_16x16x32_bf16 v[224:227], a[56:59], a[74:77], v[224:227]
    s_waitcnt lgkmcnt(8)
    ds_read_b128 a[240:243], v40 offset:63488
    v_perm_b32 v56, v101, v35, s38
    v_mfma_f32_16x16x32_bf16 v[224:227], a[60:63], a[154:157], v[224:227]
    ds_read_b32 a222, v56
    s_cbranch_vccnz L_slow4_1
L_back4_1:
    v_mfma_f32_16x16x32_bf16 v[228:231], a[60:63], a[90:93], v[228:231]
    s_add_u32 s56, s55, 1536
    v_perm_b32 v57, v101, v35, s39
    v_perm_b32 v63, v98, v35, s36
    v_mfma_f32_16x16x32_bf16 v[228:231], a[56:59], a[98:101], v[228:231]
    ds_read_b128 a[244:247], v41 offset:63488
    ds_read_b32 a223, v57
    v_mfma_f32_16x16x32_bf16 v[232:235], a[56:59], a[130:133], v[232:235]
    buffer_load_dwordx4 v[88:91], v32, s[12:15], s45 offen sc1
    v_mfma_f32_16x16x32_bf16 v[232:235], a[60:63], a[178:181], v[232:235]
    ds_read_b32 a248, v63
    v_perm_b32 v58, v98, v35, s37
    v_mfma_f32_16x16x32_bf16 v[236:239], a[60:63], a[194:197], v[236:239]
    ds_read_b32 a249, v58
    v_perm_b32 v59, v98, v35, s38
    v_perm_b32 v61, v98, v35, s39
    v_mfma_f32_16x16x32_bf16 v[236:239], a[56:59], a[82:85], v[236:239]
    ds_read_b32 a250, v59
    ds_read_b32 a251, v61
    v_mfma_f32_16x16x32_bf16 v[240:243], a[56:59], a[170:173], v[240:243]
    buffer_load_dwordx4 v[92:95], v33, s[12:15], s45 offen sc1
    v_mfma_f32_16x16x32_bf16 v[240:243], a[60:63], a[34:37], v[240:243]
    v_perm_b32 v60, v102, v35, s36
    v_perm_b32 v62, v102, v35, s37
    v_mfma_f32_16x16x32_bf16 v[244:247], a[60:63], a[210:213], v[244:247]
    ds_read_b32 a252, v60
    ds_read_b32 a253, v62
    v_mfma_f32_16x16x32_bf16 v[244:247], a[56:59], a[106:109], v[244:247]
    s_waitcnt vmcnt(13) lgkmcnt(7)
    v_perm_b32 v56, v102, v35, s38
    v_perm_b32 v57, v102, v35, s39
    v_mfma_f32_16x16x32_bf16 v[248:251], a[56:59], a[122:125], v[248:251]
    s_barrier
    v_mfma_f32_16x16x32_bf16 v[248:251], a[60:63], a[226:229], v[248:251]
    ds_read_b32 a254, v56
    ds_read_b32 a255, v57
    v_mfma_f32_16x16x32_bf16 v[252:255], a[60:63], a[242:245], v[252:255]
    buffer_load_dwordx4 v39, s[8:11], s3 offen offset:3072 lds
    v_mfma_f32_16x16x32_bf16 v[252:255], a[56:59], a[138:141], v[252:255]
    s_add_u32 m0, s57, 32768
    v_perm_b32 v63, v99, v35, s36
    v_perm_b32 v58, v99, v35, s37
    v_mfma_f32_16x16x32_bf16 v[128:131], a[112:115], a[152:155], v[128:131]
    ds_read_b32 a64, v63
    ds_read_b32 a65, v58
    v_mfma_f32_16x16x32_bf16 v[128:131], a[116:119], a[156:159], v[128:131]
    v_perm_b32 v59, v103, v35, s36
    v_perm_b32 v61, v103, v35, s37
    v_mfma_f32_16x16x32_bf16 v[132:135], a[116:119], a[92:95], v[132:135]
    s_add_u32 s3, s69, 1536
    ds_read_b32 a66, v59
    ds_read_b32 a67, v61
    v_mfma_f32_16x16x32_bf16 v[132:135], a[112:115], a[88:91], v[132:135]
    buffer_load_dwordx4 v[48:51], v34, s[12:15], s45 offen sc1
    v_mfma_f32_16x16x32_bf16 v[136:139], a[112:115], a[176:179], v[136:139]
    v_perm_b32 v60, v107, v35, s36
    v_perm_b32 v62, v107, v35, s37
    v_mfma_f32_16x16x32_bf16 v[136:139], a[116:119], a[180:183], v[136:139]
    ds_read_b32 a68, v60
    ds_read_b32 a69, v62
    v_mfma_f32_16x16x32_bf16 v[140:143], a[116:119], a[196:199], v[140:143]
    v_perm_b32 v56, v111, v35, s36
    v_perm_b32 v57, v111, v35, s37
    v_mfma_f32_16x16x32_bf16 v[140:143], a[112:115], a[192:195], v[140:143]
    ds_read_b32 a70, v56
    ds_read_b32 a71, v57
    v_mfma_f32_16x16x32_bf16 v[144:147], a[112:115], a[32:35], v[144:147]
    buffer_load_dwordx4 v[52:55], v44, s[12:15], s45 offen sc1
    v_mfma_f32_16x16x32_bf16 v[144:147], a[116:119], a[36:39], v[144:147]
    s_waitcnt vmcnt(14)
    v_bitop3_b32 v63, v115, v119, s76 bitop3:0x7e
    v_perm_b32 v58, v104, v35, s36
    v_mfma_f32_16x16x32_bf16 v[148:151], a[116:119], a[212:215], v[148:151]
    ds_read_b32 a8, v58
    v_cmp_lt_u32 vcc, 0xffff, v63
    v_mfma_f32_16x16x32_bf16 v[148:151], a[112:115], a[208:211], v[148:151]
    ds_read_b128 a[48:51], v42 offset:0
    v_perm_b32 v59, v104, v35, s37
    v_mfma_f32_16x16x32_bf16 v[152:155], a[112:115], a[224:227], v[152:155]
    ds_read_b128 a[52:55], v43 offset:0
    ds_read_b32 a9, v59
    v_mfma_f32_16x16x32_bf16 v[152:155], a[116:119], a[228:231], v[152:155]
    v_perm_b32 v61, v104, v35, s38
    s_cbranch_vccnz L_slow5_0
L_back5_0:
    v_mfma_f32_16x16x32_bf16 v[156:159], a[116:119], a[244:247], v[156:159]
    ds_read_b128 a[16:19], v42 offset:2048
    ds_read_b32 a10, v61
    v_mfma_f32_16x16x32_bf16 v[156:159], a[112:115], a[240:243], v[156:159]
    buffer_load_dwordx4 v36, s[8:11], s56 offen offset:0 lds
    v_mfma_f32_16x16x32_bf16 v[160:163], a[144:147], a[152:155], v[160:163]
    ds_read_b128 a[20:23], v43 offset:2048
    v_perm_b32 v60, v104, v35, s39
    v_mfma_f32_16x16x32_bf16 v[160:163], a[148:151], a[156:159], v[160:163]
    ds_read_b32 a11, v60
    v_perm_b32 v62, v108, v35, s36
    v_mfma_f32_16x16x32_bf16 v[164:167], a[148:151], a[92:95], v[164:167]
    ds_read_b128 a[184:187], v42 offset:4096
    ds_read_b32 a12, v62
    v_mfma_f32_16x16x32_bf16 v[164:167], a[144:147], a[88:91], v[164:167]
    v_perm_b32 v56, v108, v35, s37
    v_perm_b32 v57, v108, v35, s38
    v_mfma_f32_16x16x32_bf16 v[168:171], a[144:147], a[176:179], v[168:171]
    ds_read_b32 a13, v56
    ds_read_b32 a14, v57
    v_mfma_f32_16x16x32_bf16 v[168:171], a[148:151], a[180:183], v[168:171]
    ds_read_b128 a[188:191], v43 offset:4096
    v_perm_b32 v63, v108, v35, s39
    v_mfma_f32_16x16x32_bf16 v[172:175], a[148:151], a[196:199], v[172:175]
    ds_read_b32 a15, v63
    ds_read_b128 a[24:27], v42 offset:6144
    v_mfma_f32_16x16x32_bf16 v[172:175], a[144:147], a[192:195], v[172:175]
    buffer_load_dwordx4 v37, s[8:11], s56 offen offset:1024 lds
    v_mfma_f32_16x16x32_bf16 v[176:179], a[144:147], a[32:35], v[176:179]
    v_perm_b32 v58, v105, v35, s36
    v_perm_b32 v59, v105, v35, s37
    v_mfma_f32_16x16x32_bf16 v[176:179], a[148:151], a[36:39], v[176:179]
    ds_read_b32 a232, v58
    ds_read_b32 a233, v59
    v_mfma_f32_16x16x32_bf16 v[180:183], a[148:151], a[212:215], v[180:183]
    v_perm_b32 v61, v105, v35, s38
    v_perm_b32 v60, v105, v35, s39
    v_mfma_f32_16x16x32_bf16 v[180:183], a[144:147], a[208:211], v[180:183]
    ds_read_b128 a[28:31], v43 offset:6144
    ds_read_b32 a234, v61
    v_mfma_f32_16x16x32_bf16 v[184:187], a[144:147], a[224:227], v[184:187]
    ds_read_b32 a235, v60
    v_perm_b32 v62, v109, v35, s36
    v_mfma_f32_16x16x32_bf16 v[184:187], a[148:151], a[228:231], v[184:187]
    ds_read_b32 a236, v62
    ds_read_b128 a[0:3], v42 offset:8192
    v_mfma_f32_16x16x32_bf16 v[188:191], a[148:151], a[244:247], v[188:191]
    buffer_load_dwordx4 v38, s[8:11], s56 offen offset:2048 lds
    v_mfma_f32_16x16x32_bf16 v[188:191], a[144:147], a[240:243], v[188:191]
    v_perm_b32 v56, v109, v35, s37
    v_perm_b32 v57, v109, v35, s38
    v_mfma_f32_16x16x32_bf16 v[192:195], a[160:163], a[152:155], v[192:195]
    ds_read_b32 a237, v56
    ds_read_b32 a238, v57
    v_mfma_f32_16x16x32_bf16 v[192:195], a[164:167], a[156:159], v[192:195]
    ds_read_b128 a[4:7], v43 offset:8192
    v_perm_b32 v63, v109, v35, s39
    v_mfma_f32_16x16x32_bf16 v[196:199], a[164:167], a[92:95], v[196:199]
    ds_read_b32 a239, v63
    v_perm_b32 v58, v106, v35, s36
    v_mfma_f32_16x16x32_bf16 v[196:199], a[160:163], a[88:91], v[196:199]
    ds_read_b32 a40, v58
    v_perm_b32 v59, v106, v35, s37
    v_mfma_f32_16x16x32_bf16 v[200:203], a[160:163], a[176:179], v[200:203]
    ds_read_b128 a[72:75], v42 offset:10240
    ds_read_b32 a41, v59
    v_mfma_f32_16x16x32_bf16 v[200:203], a[164:167], a[180:183], v[200:203]
    buffer_load_dwordx4 v39, s[8:11], s56 offen offset:3072 lds
    v_mfma_f32_16x16x32_bf16 v[204:207], a[164:167], a[196:199], v[204:207]
    s_add_u32 m0, s57, 49152
    v_perm_b32 v61, v106, v35, s38
    v_perm_b32 v60, v106, v35, s39
    v_mfma_f32_16x16x32_bf16 v[204:207], a[160:163], a[192:195], v[204:207]
    s_add_u32 s56, s55, 1792
    ds_read_b128 a[76:79], v43 offset:10240
    ds_read_b32 a42, v61
    v_mfma_f32_16x16x32_bf16 v[208:211], a[160:163], a[32:35], v[208:211]
    ds_read_b32 a43, v60
    v_perm_b32 v62, v110, v35, s36
    v_mfma_f32_16x16x32_bf16 v[208:211], a[164:167], a[36:39], v[208:211]
    ds_read_b32 a44, v62
    v_perm_b32 v56, v110, v35, s37
    v_mfma_f32_16x16x32_bf16 v[212:215], a[164:167], a[212:215], v[212:215]
    ds_read_b128 a[96:99], v42 offset:12288
    ds_read_b32 a45, v56
    v_mfma_f32_16x16x32_bf16 v[212:215], a[160:163], a[208:211], v[212:215]
    v_perm_b32 v57, v110, v35, s38
    v_perm_b32 v63, v110, v35, s39
    v_mfma_f32_16x16x32_bf16 v[216:219], a[160:163], a[224:227], v[216:219]
    ds_read_b32 a46, v57
    ds_read_b32 a47, v63
    v_mfma_f32_16x16x32_bf16 v[216:219], a[164:167], a[228:231], v[216:219]
    buffer_load_dwordx4 v36, s[8:11], s3 offen offset:0 lds
    v_mfma_f32_16x16x32_bf16 v[220:223], a[164:167], a[244:247], v[220:223]
    ds_read_b128 a[100:103], v43 offset:12288
    v_perm_b32 v58, v112, v35, s36
    v_mfma_f32_16x16x32_bf16 v[220:223], a[160:163], a[240:243], v[220:223]
    s_waitcnt lgkmcnt(9)
    ds_read_b32 a128, v58
    v_perm_b32 v59, v112, v35, s37
    v_mfma_f32_16x16x32_bf16 v[128:131], a[200:203], a[48:51], v[128:131]
    ds_read_b128 a[80:83], v42 offset:14336
    ds_read_b32 a129, v59
    v_mfma_f32_16x16x32_bf16 v[128:131], a[204:207], a[52:55], v[128:131]
    v_perm_b32 v61, v112, v35, s38
    v_perm_b32 v60, v112, v35, s39
    v_mfma_f32_16x16x32_bf16 v[132:135], a[204:207], a[20:23], v[132:135]
    ds_read_b128 a[84:87], v43 offset:14336
    ds_read_b32 a130, v61
    v_mfma_f32_16x16x32_bf16 v[132:135], a[200:203], a[16:19], v[132:135]
    ds_read_b32 a131, v60
    ds_read_b128 a[168:171], v42 offset:16384
    v_mfma_f32_16x16x32_bf16 v[136:139], a[200:203], a[184:187], v[136:139]
    buffer_load_dwordx4 v37, s[8:11], s3 offen offset:1024 lds
    v_mfma_f32_16x16x32_bf16 v[136:139], a[204:207], a[188:191], v[136:139]
    s_waitcnt vmcnt(16)
    v_bitop3_b32 v62, v123, v127, s76 bitop3:0x7e
    v_perm_b32 v56, v116, v35, s36
    v_mfma_f32_16x16x32_bf16 v[140:143], a[204:207], a[28:31], v[140:143]
    ds_read_b32 a132, v56
    v_cmp_lt_u32 vcc, 0xffff, v62
    v_mfma_f32_16x16x32_bf16 v[140:143], a[200:203], a[24:27], v[140:143]
    v_perm_b32 v57, v116, v35, s37
    v_perm_b32 v63, v116, v35, s38
    v_mfma_f32_16x16x32_bf16 v[144:147], a[200:203], a[0:3], v[144:147]
    ds_read_b32 a133, v57
    ds_read_b32 a134, v63
    v_mfma_f32_16x16x32_bf16 v[144:147], a[204:207], a[4:7], v[144:147]
    s_waitcnt lgkmcnt(7)
    v_perm_b32 v58, v116, v35, s39
    s_cbranch_vccnz L_slow5_1
L_back5_1:
    v_mfma_f32_16x16x32_bf16 v[148:151], a[204:207], a[76:79], v[148:151]
    ds_read_b32 a135, v58
    v_perm_b32 v59, v113, v35, s36
    v_mfma_f32_16x16x32_bf16 v[148:151], a[200:203], a[72:75], v[148:151]
    ds_read_b32 a104, v59
    ds_read_b128 a[172:175], v43 offset:16384
    v_mfma_f32_16x16x32_bf16 v[152:155], a[200:203], a[96:99], v[152:155]
    buffer_load_dwordx4 v38, s[8:11], s3 offen offset:2048 lds
    v_mfma_f32_16x16x32_bf16 v[152:155], a[204:207], a[100:103], v[152:155]
    s_waitcnt lgkmcnt(6)
    ds_read_b128 a[120:123], v42 offset:18432
    v_perm_b32 v61, v113, v35, s37
    v_mfma_f32_16x16x32_bf16 v[156:159], a[204:207], a[84:87], v[156:159]
    ds_read_b32 a105, v61
    v_perm_b32 v60, v113, v35, s38
    v_mfma_f32_16x16x32_bf16 v[156:159], a[200:203], a[80:83], v[156:159]
    ds_read_b128 a[124:127], v43 offset:18432
    ds_read_b32 a106, v60
    v_mfma_f32_16x16x32_bf16 v[160:163], a[216:219], a[48:51], v[160:163]
    v_perm_b32 v62, v113, v35, s39
    v_perm_b32 v56, v117, v35, s36
    v_mfma_f32_16x16x32_bf16 v[160:163], a[220:223], a[52:55], v[160:163]
    ds_read_b32 a107, v62
    ds_read_b32 a108, v56
    v_mfma_f32_16x16x32_bf16 v[164:167], a[220:223], a[20:23], v[164:167]
    ds_read_b128 a[56:59], v42 offset:20480
    v_mfma_f32_16x16x32_bf16 v[164:167], a[216:219], a[16:19], v[164:167]
    buffer_load_dwordx4 v39, s[8:11], s3 offen offset:3072 lds
    v_mfma_f32_16x16x32_bf16 v[168:171], a[216:219], a[184:187], v[168:171]
    s_add_u32 m0, s57, 65536
    v_perm_b32 v57, v117, v35, s37
    v_perm_b32 v63, v117, v35, s38
    v_mfma_f32_16x16x32_bf16 v[168:171], a[220:223], a[188:191], v[168:171]
    s_add_u32 s3, s69, 1792
    ds_read_b128 a[60:63], v43 offset:20480
    ds_read_b32 a109, v57
    v_mfma_f32_16x16x32_bf16 v[172:175], a[220:223], a[28:31], v[172:175]
    ds_read_b32 a110, v63
    ds_read_b128 a[136:139], v42 offset:22528
    v_mfma_f32_16x16x32_bf16 v[172:175], a[216:219], a[24:27], v[172:175]
    buffer_load_dwordx4 v[64:67], v22, s[32:35], 0 offen
    v_mfma_f32_16x16x32_bf16 v[176:179], a[216:219], a[0:3], v[176:179]
    v_perm_b32 v58, v117, v35, s39
    v_perm_b32 v59, v114, v35, s36
    v_mfma_f32_16x16x32_bf16 v[176:179], a[220:223], a[4:7], v[176:179]
    ds_read_b32 a111, v58
    ds_read_b32 a112, v59
    v_mfma_f32_16x16x32_bf16 v[180:183], a[220:223], a[76:79], v[180:183]
    ds_read_b128 a[140:143], v43 offset:22528
    v_mfma_f32_16x16x32_bf16 v[180:183], a[216:219], a[72:75], v[180:183]
    buffer_load_dwordx4 v[68:71], v32, s[12:15], s72 offen sc1
    v_mfma_f32_16x16x32_bf16 v[184:187], a[216:219], a[96:99], v[184:187]
    v_perm_b32 v61, v114, v35, s37
    v_perm_b32 v60, v114, v35, s38
    v_mfma_f32_16x16x32_bf16 v[184:187], a[220:223], a[100:103], v[184:187]
    ds_read_b32 a113, v61
    ds_read_b32 a114, v60
    v_mfma_f32_16x16x32_bf16 v[188:191], a[220:223], a[84:87], v[188:191]
    ds_read_b128 a[144:147], v42 offset:24576
    v_mfma_f32_16x16x32_bf16 v[188:191], a[216:219], a[80:83], v[188:191]
    buffer_load_dwordx4 v[72:75], v33, s[12:15], s72 offen sc1
    v_mfma_f32_16x16x32_bf16 v[192:195], a[248:251], a[48:51], v[192:195]
    v_perm_b32 v62, v114, v35, s39
    v_perm_b32 v56, v118, v35, s36
    v_mfma_f32_16x16x32_bf16 v[192:195], a[252:255], a[52:55], v[192:195]
    ds_read_b128 a[148:151], v43 offset:24576
    ds_read_b32 a115, v62
    v_mfma_f32_16x16x32_bf16 v[196:199], a[252:255], a[20:23], v[196:199]
    ds_read_b32 a116, v56
    ds_read_b128 a[152:155], v42 offset:26624
    v_mfma_f32_16x16x32_bf16 v[196:199], a[248:251], a[16:19], v[196:199]
    buffer_load_dwordx4 v[76:79], v34, s[12:15], s72 offen sc1
    v_mfma_f32_16x16x32_bf16 v[200:203], a[248:251], a[184:187], v[200:203]
    v_perm_b32 v57, v118, v35, s37
    v_perm_b32 v63, v118, v35, s38
    v_mfma_f32_16x16x32_bf16 v[200:203], a[252:255], a[188:191], v[200:203]
    ds_read_b32 a117, v57
    ds_read_b32 a118, v63
    v_mfma_f32_16x16x32_bf16 v[204:207], a[252:255], a[28:31], v[204:207]
    ds_read_b128 a[156:159], v43 offset:26624
    v_mfma_f32_16x16x32_bf16 v[204:207], a[248:251], a[24:27], v[204:207]
    buffer_load_dwordx4 v[80:83], v44, s[12:15], s72 offen sc1
    v_mfma_f32_16x16x32_bf16 v[208:211], a[248:251], a[0:3], v[208:211]
    v_perm_b32 v58, v118, v35, s39
    v_perm_b32 v59, v115, v35, s36
    v_mfma_f32_16x16x32_bf16 v[208:211], a[252:255], a[4:7], v[208:211]
    ds_read_b32 a119, v58
    ds_read_b32 a88, v59
    v_mfma_f32_16x16x32_bf16 v[212:215], a[252:255], a[76:79], v[212:215]
    ds_read_b128 a[176:179], v42 offset:28672
    v_mfma_f32_16x16x32_bf16 v[212:215], a[248:251], a[72:75], v[212:215]
    buffer_load_dwordx2 v[84:85], v22, s[32:35], 0 offen offset:16
    v_mfma_f32_16x16x32_bf16 v[216:219], a[248:251], a[96:99], v[216:219]
    v_perm_b32 v61, v115, v35, s37
    v_perm_b32 v60, v119, v35, s36
    v_mfma_f32_16x16x32_bf16 v[216:219], a[252:255], a[100:103], v[216:219]
    ds_read_b128 a[180:183], v43 offset:28672
    ds_read_b32 a89, v61
    v_perm_b32 v62, v119, v35, s37
    v_mfma_f32_16x16x32_bf16 v[220:223], a[252:255], a[84:87], v[220:223]
    s_waitcnt lgkmcnt(6)
    ds_read_b32 a90, v60
    ds_read_b32 a91, v62
    v_mfma_f32_16x16x32_bf16 v[220:223], a[248:251], a[80:83], v[220:223]
    buffer_load_dword v86, v23, s[32:35], 0 offen
    v_mfma_f32_16x16x32_bf16 v[224:227], a[64:67], a[50:53], v[224:227]
    ds_read_b128 a[192:195], v42 offset:30720
    v_perm_b32 v56, v123, v35, s36
    v_perm_b32 v57, v123, v35, s37
    v_mfma_f32_16x16x32_bf16 v[224:227], a[68:71], a[170:173], v[224:227]
    ds_read_b32 a92, v56
    ds_read_b32 a93, v57
    v_mfma_f32_16x16x32_bf16 v[228:231], a[68:71], a[122:125], v[228:231]
    ds_read_b128 a[196:199], v43 offset:30720
    v_perm_b32 v63, v127, v35, s36
    v_mfma_f32_16x16x32_bf16 v[228:231], a[64:67], a[18:21], v[228:231]
    ds_read_b32 a94, v63
    v_perm_b32 v58, v127, v35, s37
    v_mfma_f32_16x16x32_bf16 v[232:235], a[64:67], a[186:189], v[232:235]
    s_waitcnt vmcnt(18)
    ds_read_b32 a95, v58
    v_bitop3_b32 v59, v91, v95, s76 bitop3:0x7e
    v_mfma_f32_16x16x32_bf16 v[232:235], a[68:71], a[58:61], v[232:235]
    v_cmp_lt_u32 vcc, 0xffff, v59
    v_perm_b32 v61, v120, v35, s36
    v_mfma_f32_16x16x32_bf16 v[236:239], a[68:71], a[138:141], v[236:239]
    ds_read_b32 a32, v61
    v_perm_b32 v60, v120, v35, s37
    v_mfma_f32_16x16x32_bf16 v[236:239], a[64:67], a[26:29], v[236:239]
    ds_read_b32 a33, v60
    s_cbranch_vccnz L_slow6_0
L_back6_0:
    v_mfma_f32_16x16x32_bf16 v[240:243], a[64:67], a[2:5], v[240:243]
    v_perm_b32 v62, v120, v35, s38
    v_perm_b32 v56, v120, v35, s39
    v_mfma_f32_16x16x32_bf16 v[240:243], a[68:71], a[146:149], v[240:243]
    s_waitcnt lgkmcnt(7)
    ds_read_b32 a34, v62
    ds_read_b32 a35, v56
    v_mfma_f32_16x16x32_bf16 v[244:247], a[68:71], a[154:157], v[244:247]
    s_waitcnt vmcnt(15)
    v_bitop3_b32 v57, v51, v55, s76 bitop3:0x7e
    v_perm_b32 v63, v124, v35, s36
    v_mfma_f32_16x16x32_bf16 v[244:247], a[64:67], a[74:77], v[244:247]
    s_waitcnt lgkmcnt(6)
    ds_read_b32 a36, v63
    v_cmp_lt_u32 vcc, 0xffff, v57
    v_mfma_f32_16x16x32_bf16 v[248:251], a[64:67], a[98:101], v[248:251]
    s_barrier
    v_mfma_f32_16x16x32_bf16 v[248:251], a[68:71], a[178:181], v[248:251]
    buffer_load_dwordx4 v36, s[8:11], s56 offen offset:0 lds
    v_mfma_f32_16x16x32_bf16 v[252:255], a[68:71], a[194:197], v[252:255]
    v_perm_b32 v58, v124, v35, s37
    s_cbranch_vccnz L_slow6_1
L_back6_1:
    v_mfma_f32_16x16x32_bf16 v[252:255], a[64:67], a[82:85], v[252:255]
    ds_read_b32 a37, v58
    v_perm_b32 v59, v124, v35, s38
    v_perm_b32 v61, v124, v35, s39
    v_mfma_f32_16x16x32_bf16 v[128:131], a[8:11], a[168:171], v[128:131]
    ds_read_b32 a38, v59
    ds_read_b32 a39, v61
    v_mfma_f32_16x16x32_bf16 v[128:131], a[12:15], a[172:175], v[128:131]
    buffer_load_dwordx4 v37, s[8:11], s56 offen offset:1024 lds
    v_mfma_f32_16x16x32_bf16 v[132:135], a[12:15], a[124:127], v[132:135]
    v_perm_b32 v60, v121, v35, s36
    v_perm_b32 v62, v121, v35, s37
    v_mfma_f32_16x16x32_bf16 v[132:135], a[8:11], a[120:123], v[132:135]
    ds_read_b32 a208, v60
    ds_read_b32 a209, v62
    v_mfma_f32_16x16x32_bf16 v[136:139], a[8:11], a[56:59], v[136:139]
    ds_read_b128 a[224:227], v40 offset:0
L_pad3:
    s_cbranch_execz L_pad4
    v_mfma_f32_16x16x32_bf16 v[136:139], a[12:15], a[60:63], v[136:139]
    buffer_load_dwordx4 v38, s[8:11], s56 offen offset:2048 lds
    v_mfma_f32_16x16x32_bf16 v[140:143], a[12:15], a[140:143], v[140:143]
    v_perm_b32 v56, v121, v35, s38
    v_perm_b32 v57, v121, v35, s39
    v_mfma_f32_16x16x32_bf16 v[140:143], a[8:11], a[136:139], v[140:143]
    ds_read_b32 a210, v56
    ds_read_b32 a211, v57
    v_perm_b32 v63, v125, v35, s36
    v_mfma_f32_16x16x32_bf16 v[144:147], a[8:11], a[144:147], v[144:147]
    ds_read_b32 a212, v63
    ds_read_b128 a[228:231], v41 offset:0
    v_mfma_f32_16x16x32_bf16 v[144:147], a[12:15], a[148:151], v[144:147]
    buffer_load_dwordx4 v39, s[8:11], s56 offen offset:3072 lds
    v_mfma_f32_16x16x32_bf16 v[148:151], a[12:15], a[156:159], v[148:151]
    s_add_u32 m0, s57, 81920
    v_perm_b32 v58, v125, v35, s37
    v_perm_b32 v59, v125, v35, s38
    v_mfma_f32_16x16x32_bf16 v[148:151], a[8:11], a[152:155], v[148:151]
    ds_read_b32 a213, v58
    ds_read_b32 a214, v59
    v_mfma_f32_16x16x32_bf16 v[152:155], a[8:11], a[176:179], v[152:155]
    ds_read_b128 a[160:163], v40 offset:2048
    v_mfma_f32_16x16x32_bf16 v[152:155], a[12:15], a[180:183], v[152:155]
    buffer_load_dwordx4 v36, s[8:11], s3 offen offset:0 lds
    v_mfma_f32_16x16x32_bf16 v[156:159], a[12:15], a[196:199], v[156:159]
    v_perm_b32 v61, v125, v35, s39
    v_perm_b32 v60, v122, v35, s36
    v_mfma_f32_16x16x32_bf16 v[156:159], a[8:11], a[192:195], v[156:159]
    ds_read_b128 a[164:167], v41 offset:2048
    ds_read_b32 a215, v61
    v_perm_b32 v62, v122, v35, s37
    v_mfma_f32_16x16x32_bf16 v[160:163], a[232:235], a[168:171], v[160:163]
    ds_read_b32 a240, v60
    ds_read_b32 a241, v62
    v_mfma_f32_16x16x32_bf16 v[160:163], a[236:239], a[172:175], v[160:163]
    ds_read_b128 a[200:203], v40 offset:4096
    v_mfma_f32_16x16x32_bf16 v[164:167], a[236:239], a[124:127], v[164:167]
    buffer_load_dwordx4 v37, s[8:11], s3 offen offset:1024 lds
    v_mfma_f32_16x16x32_bf16 v[164:167], a[232:235], a[120:123], v[164:167]
    v_perm_b32 v56, v122, v35, s38
    v_perm_b32 v57, v122, v35, s39
    v_mfma_f32_16x16x32_bf16 v[168:171], a[232:235], a[56:59], v[168:171]
    ds_read_b32 a242, v56
    ds_read_b32 a243, v57
    v_perm_b32 v63, v126, v35, s36
    v_mfma_f32_16x16x32_bf16 v[168:171], a[236:239], a[60:63], v[168:171]
    ds_read_b128 a[204:207], v41 offset:4096
    ds_read_b32 a244, v63
    v_perm_b32 v58, v126, v35, s37
    v_mfma_f32_16x16x32_bf16 v[172:175], a[236:239], a[140:143], v[172:175]
    ds_read_b32 a245, v58
    v_perm_b32 v59, v126, v35, s38
    v_mfma_f32_16x16x32_bf16 v[172:175], a[232:235], a[136:139], v[172:175]
    ds_read_b32 a246, v59
    v_perm_b32 v61, v126, v35, s39
    v_mfma_f32_16x16x32_bf16 v[176:179], a[232:235], a[144:147], v[176:179]
    ds_read_b128 a[216:219], v40 offset:6144
    ds_read_b32 a247, v61
    v_mfma_f32_16x16x32_bf16 v[176:179], a[236:239], a[148:151], v[176:179]
    ds_read_b128 a[220:223], v41 offset:6144
    v_mfma_f32_16x16x32_bf16 v[180:183], a[236:239], a[156:159], v[180:183]
    buffer_load_dwordx4 v38, s[8:11], s3 offen offset:2048 lds
    v_mfma_f32_16x16x32_bf16 v[180:183], a[232:235], a[152:155], v[180:183]
    v_perm_b32 v60, v91, v35, s36
    v_perm_b32 v62, v91, v35, s37
    v_mfma_f32_16x16x32_bf16 v[184:187], a[232:235], a[176:179], v[184:187]
    ds_read_b32 a248, v60
    ds_read_b32 a249, v62
    v_mfma_f32_16x16x32_bf16 v[184:187], a[236:239], a[180:183], v[184:187]
    v_perm_b32 v56, v95, v35, s36
    v_perm_b32 v57, v95, v35, s37
    v_mfma_f32_16x16x32_bf16 v[188:191], a[236:239], a[196:199], v[188:191]
    ds_read_b128 a[48:51], v40 offset:8192
    ds_read_b32 a250, v56
    v_mfma_f32_16x16x32_bf16 v[188:191], a[232:235], a[192:195], v[188:191]
    ds_read_b32 a251, v57
    v_perm_b32 v63, v51, v35, s36
    v_mfma_f32_16x16x32_bf16 v[192:195], a[40:43], a[168:171], v[192:195]
    ds_read_b32 a252, v63
    ds_read_b128 a[52:55], v41 offset:8192
    v_mfma_f32_16x16x32_bf16 v[192:195], a[44:47], a[172:175], v[192:195]
    buffer_load_dwordx4 v39, s[8:11], s3 offen offset:3072 lds
    v_mfma_f32_16x16x32_bf16 v[196:199], a[44:47], a[124:127], v[196:199]
    v_perm_b32 v58, v51, v35, s37
    v_perm_b32 v59, v55, v35, s36
    v_mfma_f32_16x16x32_bf16 v[196:199], a[40:43], a[120:123], v[196:199]
    ds_read_b32 a253, v58
    ds_read_b32 a254, v59
    v_mfma_f32_16x16x32_bf16 v[200:203], a[40:43], a[56:59], v[200:203]
    ds_read_b128 a[16:19], v40 offset:10240
    v_perm_b32 v61, v55, v35, s37
    v_mfma_f32_16x16x32_bf16 v[200:203], a[44:47], a[60:63], v[200:203]
    ds_read_b32 a255, v61
    v_perm_b32 v60, v88, v35, s36
    v_mfma_f32_16x16x32_bf16 v[204:207], a[44:47], a[140:143], v[204:207]
    ds_read_b32 a184, v60
    v_perm_b32 v62, v88, v35, s37
    v_mfma_f32_16x16x32_bf16 v[204:207], a[40:43], a[136:139], v[204:207]
    ds_read_b128 a[20:23], v41 offset:10240
    ds_read_b32 a185, v62
    v_mfma_f32_16x16x32_bf16 v[208:211], a[40:43], a[144:147], v[208:211]
    v_perm_b32 v56, v88, v35, s38
    v_perm_b32 v57, v88, v35, s39
    v_mfma_f32_16x16x32_bf16 v[208:211], a[44:47], a[148:151], v[208:211]
    ds_read_b32 a186, v56
    ds_read_b32 a187, v57
    v_mfma_f32_16x16x32_bf16 v[212:215], a[44:47], a[156:159], v[212:215]
    ds_read_b128 a[24:27], v40 offset:12288
    v_perm_b32 v63, v92, v35, s36
    v_mfma_f32_16x16x32_bf16 v[212:215], a[40:43], a[152:155], v[212:215]
    ds_read_b32 a188, v63
    v_perm_b32 v58, v92, v35, s37
    v_mfma_f32_16x16x32_bf16 v[216:219], a[40:43], a[176:179], v[216:219]
    ds_read_b32 a189, v58
    v_perm_b32 v59, v92, v35, s38
    v_mfma_f32_16x16x32_bf16 v[216:219], a[44:47], a[180:183], v[216:219]
    ds_read_b128 a[28:31], v41 offset:12288
    ds_read_b32 a190, v59
    v_mfma_f32_16x16x32_bf16 v[220:223], a[44:47], a[196:199], v[220:223]
    v_perm_b32 v61, v92, v35, s39
    v_perm_b32 v60, v48, v35, s36
    v_mfma_f32_16x16x32_bf16 v[220:223], a[40:43], a[192:195], v[220:223]
    s_waitcnt lgkmcnt(9)
    ds_read_b32 a191, v61
    ds_read_b32 a0, v60
    v_mfma_f32_16x16x32_bf16 v[128:131], a[128:131], a[224:227], v[128:131]
    v_perm_b32 v62, v48, v35, s37
    v_perm_b32 v56, v48, v35, s38
    v_mfma_f32_16x16x32_bf16 v[128:131], a[132:135], a[228:231], v[128:131]
    ds_read_b32 a1, v62
    ds_read_b32 a2, v56
    v_mfma_f32_16x16x32_bf16 v[132:135], a[132:135], a[164:167], v[132:135]
    v_perm_b32 v57, v48, v35, s39
    v_perm_b32 v63, v52, v35, s36
    v_mfma_f32_16x16x32_bf16 v[132:135], a[128:131], a[160:163], v[132:135]
    ds_read_b32 a3, v57
    ds_read_b32 a4, v63
    v_mfma_f32_16x16x32_bf16 v[136:139], a[128:131], a[200:203], v[136:139]
    v_perm_b32 v58, v52, v35, s37
    v_perm_b32 v59, v52, v35, s38
    v_mfma_f32_16x16x32_bf16 v[136:139], a[132:135], a[204:207], v[136:139]
    ds_read_b32 a5, v58
    ds_read_b32 a6, v59
    v_mfma_f32_16x16x32_bf16 v[140:143], a[132:135], a[220:223], v[140:143]
    ds_read_b128 a[72:75], v40 offset:16384
    v_perm_b32 v61, v52, v35, s39
    v_mfma_f32_16x16x32_bf16 v[140:143], a[128:131], a[216:219], v[140:143]
    ds_read_b32 a7, v61
    v_perm_b32 v60, v89, v35, s36
    v_mfma_f32_16x16x32_bf16 v[144:147], a[128:131], a[48:51], v[144:147]
    ds_read_b32 a96, v60
    v_perm_b32 v62, v89, v35, s37
    v_mfma_f32_16x16x32_bf16 v[144:147], a[132:135], a[52:55], v[144:147]
    s_waitcnt lgkmcnt(9)
    ds_read_b128 a[76:79], v41 offset:16384
    ds_read_b32 a97, v62
    v_mfma_f32_16x16x32_bf16 v[148:151], a[132:135], a[20:23], v[148:151]
    v_perm_b32 v56, v89, v35, s38
    v_perm_b32 v57, v89, v35, s39
    v_mfma_f32_16x16x32_bf16 v[148:151], a[128:131], a[16:19], v[148:151]
    ds_read_b32 a98, v56
    ds_read_b32 a99, v57
    v_mfma_f32_16x16x32_bf16 v[152:155], a[128:131], a[24:27], v[152:155]
    ds_read_b128 a[64:67], v40 offset:18432
    v_perm_b32 v63, v93, v35, s36
    v_mfma_f32_16x16x32_bf16 v[152:155], a[132:135], a[28:31], v[152:155]
    ds_read_b32 a100, v63
    v_perm_b32 v58, v93, v35, s37
    v_mfma_f32_16x16x32_bf16 v[160:163], a[104:107], a[224:227], v[160:163]
    ds_read_b32 a101, v58
    v_perm_b32 v59, v93, v35, s38
    v_mfma_f32_16x16x32_bf16 v[160:163], a[108:111], a[228:231], v[160:163]
    ds_read_b128 a[68:71], v41 offset:18432
    ds_read_b32 a102, v59
    v_mfma_f32_16x16x32_bf16 v[164:167], a[108:111], a[164:167], v[164:167]
    s_waitcnt vmcnt(12)
    v_perm_b32 v60, v93, v35, s39
    v_bitop3_b32 v61, v71, v75, s76 bitop3:0x7e
    v_mfma_f32_16x16x32_bf16 v[164:167], a[104:107], a[160:163], v[164:167]
    ds_read_b32 a103, v60
    v_cmp_lt_u32 vcc, 0xffff, v61
    v_mfma_f32_16x16x32_bf16 v[168:171], a[104:107], a[200:203], v[168:171]
    ds_read_b128 a[80:83], v40 offset:20480
    v_perm_b32 v62, v49, v35, s36
    v_mfma_f32_16x16x32_bf16 v[168:171], a[108:111], a[204:207], v[168:171]
    ds_read_b32 a8, v62
    s_cbranch_vccnz L_slow7_0
L_back7_0:
    v_mfma_f32_16x16x32_bf16 v[172:175], a[108:111], a[220:223], v[172:175]
    v_perm_b32 v56, v49, v35, s37
    v_perm_b32 v57, v49, v35, s38
    v_mfma_f32_16x16x32_bf16 v[172:175], a[104:107], a[216:219], v[172:175]
    ds_read_b128 a[84:87], v41 offset:20480
    ds_read_b32 a9, v56
    v_mfma_f32_16x16x32_bf16 v[176:179], a[104:107], a[48:51], v[176:179]
    ds_read_b32 a10, v57
    v_perm_b32 v63, v49, v35, s39
    v_mfma_f32_16x16x32_bf16 v[176:179], a[108:111], a[52:55], v[176:179]
    s_waitcnt vmcnt(10)
    ds_read_b32 a11, v63
    v_bitop3_b32 v58, v79, v83, s76 bitop3:0x7e
    v_mfma_f32_16x16x32_bf16 v[180:183], a[108:111], a[20:23], v[180:183]
    ds_read_b128 a[232:235], v40 offset:22528
    v_cmp_lt_u32 vcc, 0xffff, v58
    v_mfma_f32_16x16x32_bf16 v[180:183], a[104:107], a[16:19], v[180:183]
    v_perm_b32 v59, v53, v35, s36
    v_perm_b32 v61, v53, v35, s37
    v_mfma_f32_16x16x32_bf16 v[184:187], a[104:107], a[24:27], v[184:187]
    ds_read_b32 a12, v59
    ds_read_b32 a13, v61
    v_mfma_f32_16x16x32_bf16 v[184:187], a[108:111], a[28:31], v[184:187]
    ds_read_b128 a[236:239], v41 offset:22528
    s_cbranch_vccnz L_slow7_1
L_back7_1:
    v_mfma_f32_16x16x32_bf16 v[192:195], a[112:115], a[224:227], v[192:195]
    v_perm_b32 v60, v53, v35, s38
    v_perm_b32 v62, v53, v35, s39
    v_mfma_f32_16x16x32_bf16 v[192:195], a[116:119], a[228:231], v[192:195]
    ds_read_b32 a14, v60
    ds_read_b32 a15, v62
    v_mfma_f32_16x16x32_bf16 v[196:199], a[116:119], a[164:167], v[196:199]
    ds_read_b128 a[168:171], v40 offset:24576
    v_perm_b32 v56, v90, v35, s36
    v_mfma_f32_16x16x32_bf16 v[196:199], a[112:115], a[160:163], v[196:199]
    ds_read_b32 a120, v56
    v_perm_b32 v57, v90, v35, s37
    v_mfma_f32_16x16x32_bf16 v[200:203], a[112:115], a[200:203], v[200:203]
    ds_read_b32 a121, v57
    v_perm_b32 v63, v90, v35, s38
    v_mfma_f32_16x16x32_bf16 v[200:203], a[116:119], a[204:207], v[200:203]
    ds_read_b128 a[172:175], v41 offset:24576
    ds_read_b32 a122, v63
    v_mfma_f32_16x16x32_bf16 v[204:207], a[116:119], a[220:223], v[204:207]
    v_perm_b32 v58, v90, v35, s39
    v_perm_b32 v59, v94, v35, s36
    v_mfma_f32_16x16x32_bf16 v[204:207], a[112:115], a[216:219], v[204:207]
    ds_read_b32 a123, v58
    ds_read_b32 a124, v59
    v_mfma_f32_16x16x32_bf16 v[208:211], a[112:115], a[48:51], v[208:211]
    ds_read_b128 a[56:59], v40 offset:26624
    v_perm_b32 v61, v94, v35, s37
    v_mfma_f32_16x16x32_bf16 v[208:211], a[116:119], a[52:55], v[208:211]
    ds_read_b32 a125, v61
    v_perm_b32 v60, v94, v35, s38
    v_mfma_f32_16x16x32_bf16 v[212:215], a[116:119], a[20:23], v[212:215]
    ds_read_b32 a126, v60
    v_perm_b32 v62, v94, v35, s39
    v_mfma_f32_16x16x32_bf16 v[212:215], a[112:115], a[16:19], v[212:215]
    ds_read_b128 a[60:63], v41 offset:26624
    ds_read_b32 a127, v62
    v_mfma_f32_16x16x32_bf16 v[216:219], a[112:115], a[24:27], v[216:219]
    v_perm_b32 v56, v50, v35, s36
    v_perm_b32 v57, v50, v35, s37
    v_mfma_f32_16x16x32_bf16 v[216:219], a[116:119], a[28:31], v[216:219]
    ds_read_b32 a136, v56
    ds_read_b32 a137, v57
    v_mfma_f32_16x16x32_bf16 v[224:227], a[88:91], a[226:229], v[224:227]
    s_waitcnt lgkmcnt(9)
    ds_read_b128 a[144:147], v40 offset:28672
    v_perm_b32 v63, v50, v35, s38
    v_mfma_f32_16x16x32_bf16 v[224:227], a[92:95], a[74:77], v[224:227]
    ds_read_b128 a[148:151], v41 offset:28672
    ds_read_b32 a138, v63
    v_mfma_f32_16x16x32_bf16 v[228:231], a[92:95], a[66:69], v[228:231]
    v_perm_b32 v58, v50, v35, s39
    v_perm_b32 v59, v54, v35, s36
    v_mfma_f32_16x16x32_bf16 v[228:231], a[88:91], a[162:165], v[228:231]
    ds_read_b32 a139, v58
    ds_read_b32 a140, v59
    v_mfma_f32_16x16x32_bf16 v[232:235], a[88:91], a[202:205], v[232:235]
    v_perm_b32 v61, v54, v35, s37
    v_perm_b32 v60, v54, v35, s38
    v_mfma_f32_16x16x32_bf16 v[232:235], a[92:95], a[82:85], v[232:235]
    ds_read_b32 a141, v61
    ds_read_b32 a142, v60
    v_mfma_f32_16x16x32_bf16 v[236:239], a[92:95], a[234:237], v[236:239]
    v_perm_b32 v62, v54, v35, s39
    v_perm_b32 v56, v71, v35, s36
    v_mfma_f32_16x16x32_bf16 v[236:239], a[88:91], a[218:221], v[236:239]
    ds_read_b32 a143, v62
    ds_read_b32 a152, v56
    v_mfma_f32_16x16x32_bf16 v[240:243], a[88:91], a[50:53], v[240:243]
    v_perm_b32 v57, v71, v35, s37
    v_perm_b32 v63, v75, v35, s36
    v_mfma_f32_16x16x32_bf16 v[240:243], a[92:95], a[170:173], v[240:243]
    s_waitcnt lgkmcnt(7)
    ds_read_b32 a153, v57
    ds_read_b32 a154, v63
    v_mfma_f32_16x16x32_bf16 v[244:247], a[92:95], a[58:61], v[244:247]
    s_barrier
    v_mfma_f32_16x16x32_bf16 v[244:247], a[88:91], a[18:21], v[244:247]
    v_perm_b32 v58, v75, v35, s37
    v_perm_b32 v59, v79, v35, s36
    v_mfma_f32_16x16x32_bf16 v[248:251], a[88:91], a[26:29], v[248:251]
    ds_read_b32 a155, v58
    ds_read_b32 a156, v59
    v_mfma_f32_16x16x32_bf16 v[248:251], a[92:95], a[146:149], v[248:251]
    v_perm_b32 v61, v79, v35, s37
    v_perm_b32 v60, v83, v35, s36
    v_mfma_f32_16x16x32_bf16 v[128:131], a[32:35], a[72:75], v[128:131]
    ds_read_b32 a157, v61
    ds_read_b32 a158, v60
    v_mfma_f32_16x16x32_bf16 v[128:131], a[36:39], a[76:79], v[128:131]
    v_perm_b32 v62, v83, v35, s37
    v_perm_b32 v56, v68, v35, s36
    v_mfma_f32_16x16x32_bf16 v[132:135], a[36:39], a[68:71], v[132:135]
    ds_read_b32 a159, v62
    ds_read_b32 a176, v56
    v_mfma_f32_16x16x32_bf16 v[132:135], a[32:35], a[64:67], v[132:135]
    v_perm_b32 v57, v68, v35, s37
    v_perm_b32 v63, v68, v35, s38
    v_mfma_f32_16x16x32_bf16 v[136:139], a[32:35], a[80:83], v[136:139]
    ds_read_b32 a177, v57
    ds_read_b32 a178, v63
    v_mfma_f32_16x16x32_bf16 v[136:139], a[36:39], a[84:87], v[136:139]
    v_perm_b32 v58, v68, v35, s39
    v_perm_b32 v59, v72, v35, s36
    v_mfma_f32_16x16x32_bf16 v[140:143], a[36:39], a[236:239], v[140:143]
    ds_read_b32 a179, v58
    ds_read_b32 a180, v59
    v_mfma_f32_16x16x32_bf16 v[140:143], a[32:35], a[232:235], v[140:143]
    v_perm_b32 v61, v72, v35, s37
    v_perm_b32 v60, v72, v35, s38
    v_mfma_f32_16x16x32_bf16 v[144:147], a[32:35], a[168:171], v[144:147]
    ds_read_b32 a181, v61
    ds_read_b32 a182, v60
    v_mfma_f32_16x16x32_bf16 v[144:147], a[36:39], a[172:175], v[144:147]
    v_perm_b32 v62, v72, v35, s39
    v_perm_b32 v56, v76, v35, s36
    v_mfma_f32_16x16x32_bf16 v[148:151], a[36:39], a[60:63], v[148:151]
    ds_read_b32 a183, v62
    ds_read_b32 a40, v56
    v_mfma_f32_16x16x32_bf16 v[148:151], a[32:35], a[56:59], v[148:151]
    v_perm_b32 v57, v76, v35, s37
    v_perm_b32 v63, v76, v35, s38
    v_mfma_f32_16x16x32_bf16 v[152:155], a[32:35], a[144:147], v[152:155]
    ds_read_b32 a41, v57
    ds_read_b32 a42, v63
    v_mfma_f32_16x16x32_bf16 v[152:155], a[36:39], a[148:151], v[152:155]
    ds_read_b128 a[192:195], v40 offset:32768
    v_perm_b32 v58, v76, v35, s39
    v_mfma_f32_16x16x32_bf16 v[160:163], a[208:211], a[72:75], v[160:163]
    ds_read_b32 a43, v58
    v_perm_b32 v59, v80, v35, s36
    v_mfma_f32_16x16x32_bf16 v[160:163], a[212:215], a[76:79], v[160:163]
    ds_read_b32 a44, v59
    v_perm_b32 v61, v80, v35, s37
    v_mfma_f32_16x16x32_bf16 v[164:167], a[212:215], a[68:71], v[164:167]
    ds_read_b128 a[196:199], v41 offset:32768
    ds_read_b32 a45, v61
    v_mfma_f32_16x16x32_bf16 v[164:167], a[208:211], a[64:67], v[164:167]
    v_perm_b32 v60, v80, v35, s38
    v_perm_b32 v62, v80, v35, s39
    v_mfma_f32_16x16x32_bf16 v[168:171], a[208:211], a[80:83], v[168:171]
    ds_read_b32 a46, v60
    ds_read_b32 a47, v62
    v_mfma_f32_16x16x32_bf16 v[168:171], a[212:215], a[84:87], v[168:171]
    v_perm_b32 v56, v69, v35, s36
    v_perm_b32 v57, v69, v35, s37
    v_mfma_f32_16x16x32_bf16 v[172:175], a[212:215], a[236:239], v[172:175]
    ds_read_b128 a[224:227], v40 offset:49152
    ds_read_b32 a160, v56
    v_mfma_f32_16x16x32_bf16 v[172:175], a[208:211], a[232:235], v[172:175]
    ds_read_b32 a161, v57
    v_perm_b32 v63, v69, v35, s38
    v_mfma_f32_16x16x32_bf16 v[176:179], a[208:211], a[168:171], v[176:179]
    ds_read_b32 a162, v63
    v_perm_b32 v58, v73, v35, s36
    v_mfma_f32_16x16x32_bf16 v[176:179], a[212:215], a[172:175], v[176:179]
    ds_read_b128 a[228:231], v41 offset:49152
    ds_read_b32 a164, v58
    v_mfma_f32_16x16x32_bf16 v[180:183], a[212:215], a[60:63], v[180:183]
    v_perm_b32 v61, v73, v35, s37
    v_perm_b32 v59, v69, v35, s39
    v_mfma_f32_16x16x32_bf16 v[180:183], a[208:211], a[56:59], v[180:183]
    ds_read_b32 a165, v61
    ds_read_b32 a163, v59
    v_perm_b32 v60, v73, v35, s38
    v_mfma_f32_16x16x32_bf16 v[184:187], a[208:211], a[144:147], v[184:187]
    ds_read_b32 a166, v60
    v_perm_b32 v62, v77, v35, s36
    v_mfma_f32_16x16x32_bf16 v[184:187], a[212:215], a[148:151], v[184:187]
    ds_read_b32 a200, v62
    v_perm_b32 v56, v77, v35, s37
    v_mfma_f32_16x16x32_bf16 v[192:195], a[240:243], a[72:75], v[192:195]
    ds_read_b32 a201, v56
    v_perm_b32 v57, v73, v35, s39
    v_mfma_f32_16x16x32_bf16 v[192:195], a[244:247], a[76:79], v[192:195]
    s_waitcnt vmcnt(0)
    ds_read_b32 a167, v57
    v_perm_b32 v63, v77, v35, s38
    v_mfma_f32_16x16x32_bf16 v[196:199], a[244:247], a[68:71], v[196:199]
    s_barrier
    v_mfma_f32_16x16x32_bf16 v[196:199], a[240:243], a[64:67], v[196:199]
    v_perm_b32 v58, v81, v35, s36
    v_perm_b32 v59, v81, v35, s37
    v_mfma_f32_16x16x32_bf16 v[200:203], a[240:243], a[80:83], v[200:203]
    ds_read_b32 a204, v58
    ds_read_b32 a202, v63
    v_mfma_f32_16x16x32_bf16 v[200:203], a[244:247], a[84:87], v[200:203]
    ds_read_b32 a205, v59
    v_perm_b32 v61, v77, v35, s39
    v_mfma_f32_16x16x32_bf16 v[204:207], a[244:247], a[236:239], v[204:207]
    v_perm_b32 v62, v70, v35, s36
    v_perm_b32 v60, v81, v35, s38
    v_mfma_f32_16x16x32_bf16 v[204:207], a[240:243], a[232:235], v[204:207]
    ds_read_b128 a[216:219], v42 offset:0
    ds_read_b32 a48, v62
    v_mfma_f32_16x16x32_bf16 v[208:211], a[240:243], a[168:171], v[208:211]
    ds_read_b128 a[220:223], v43 offset:0
    v_perm_b32 v56, v70, v35, s37
    v_mfma_f32_16x16x32_bf16 v[208:211], a[244:247], a[172:175], v[208:211]
    ds_read_b128 a[16:19], v42 offset:16384
    ds_read_b32 a203, v61
    v_mfma_f32_16x16x32_bf16 v[212:215], a[244:247], a[60:63], v[212:215]
    ds_read_b128 a[20:23], v43 offset:16384
    v_perm_b32 v57, v74, v35, s36
    v_mfma_f32_16x16x32_bf16 v[212:215], a[240:243], a[56:59], v[212:215]
    ds_read_b32 a206, v60
    v_perm_b32 v63, v81, v35, s39
    v_mfma_f32_16x16x32_bf16 v[216:219], a[240:243], a[144:147], v[216:219]
    ds_read_b32 a49, v56
    v_perm_b32 v58, v70, v35, s38
    v_mfma_f32_16x16x32_bf16 v[216:219], a[244:247], a[148:151], v[216:219]
    s_waitcnt lgkmcnt(9)
    ds_read_b32 a52, v57
    v_perm_b32 v59, v74, v35, s37
    v_mfma_f32_16x16x32_bf16 v[224:227], a[248:251], a[194:197], v[224:227]
    s_mov_b32 s66, 0
    ds_read_b32 a207, v63
    v_perm_b32 v62, v78, v35, s36
    v_mfma_f32_16x16x32_bf16 v[224:227], a[252:255], a[226:229], v[224:227]
    s_mov_b32 s67, 14336
    ds_read_b32 a50, v58
    v_perm_b32 v61, v70, v35, s39
    v_mfma_f32_16x16x32_bf16 v[128:131], a[184:187], a[192:195], v[128:131]
    ds_read_b32 a53, v59
    v_perm_b32 v60, v74, v35, s38
    v_mfma_f32_16x16x32_bf16 v[128:131], a[188:191], a[196:199], v[128:131]
    ds_read_b32 a24, v62
    v_perm_b32 v56, v78, v35, s37
    v_mfma_f32_16x16x32_bf16 v[128:131], a[0:3], a[224:227], v[128:131]
    ds_read_b32 a51, v61
    ds_read_b32 a54, v60
    v_mfma_f32_16x16x32_bf16 v[128:131], a[4:7], a[228:231], v[128:131]
    ds_read_b32 a25, v56
    v_perm_b32 v57, v74, v35, s39
    v_mfma_f32_16x16x32_bf16 v[160:163], a[96:99], a[192:195], v[160:163]
    v_perm_b32 v58, v82, v35, s36
    v_perm_b32 v63, v78, v35, s38
    v_mfma_f32_16x16x32_bf16 v[160:163], a[100:103], a[196:199], v[160:163]
    ds_read_b32 a55, v57
    v_perm_b32 v59, v82, v35, s37
    v_mfma_f32_16x16x32_bf16 v[160:163], a[8:11], a[224:227], v[160:163]
    ds_read_b32 a28, v58
    ds_read_b32 a26, v63
    v_mfma_f32_16x16x32_bf16 v[160:163], a[12:15], a[228:231], v[160:163]
    ds_read_b32 a29, v59
    v_perm_b32 v62, v78, v35, s39
    v_mfma_f32_16x16x32_bf16 v[192:195], a[120:123], a[192:195], v[192:195]
    ds_read_b32 a27, v62
    v_perm_b32 v61, v82, v35, s38
    v_mfma_f32_16x16x32_bf16 v[192:195], a[124:127], a[196:199], v[192:195]
    ds_read_b32 a30, v61
    v_perm_b32 v60, v82, v35, s39
    v_mfma_f32_16x16x32_bf16 v[192:195], a[136:139], a[224:227], v[192:195]
    ds_read_b128 a[72:75], v40 offset:34816
    ds_read_b32 a31, v60
    v_mfma_f32_16x16x32_bf16 v[192:195], a[140:143], a[228:231], v[192:195]
    s_waitcnt lgkmcnt(9)
    v_lshlrev_b32 v96, 16, v86
    v_and_b32 v97, 0xffff0000, v86
    v_mfma_f32_16x16x32_bf16 v[224:227], a[152:155], a[218:221], v[224:227]
    ds_read_b128 a[76:79], v41 offset:34816
    v_lshlrev_b32 v100, 16, v64
    v_mfma_f32_16x16x32_bf16 v[224:227], a[156:159], a[18:21], v[224:227]
    ds_read_b128 a[64:67], v40 offset:51200
    v_and_b32 v101, 0xffff0000, v65
    v_mfma_f32_16x16x32_bf16 v[128:131], a[176:179], a[216:219], v[128:131]
    ds_read_b128 a[68:71], v41 offset:51200
    v_lshlrev_b32 v102, 16, v67
    v_mfma_f32_16x16x32_bf16 v[128:131], a[180:183], a[220:223], v[128:131]
    ds_read_b128 a[80:83], v42 offset:2048
    v_and_b32 v103, 0xffff0000, v84
    v_mfma_f32_16x16x32_bf16 v[128:131], a[40:43], a[16:19], v[128:131]
    ds_read_b128 a[84:87], v43 offset:2048
    v_and_b32 v104, 0xffff0000, v64
    v_mfma_f32_16x16x32_bf16 v[128:131], a[44:47], a[20:23], v[128:131]
    ds_read_b128 a[232:235], v42 offset:18432
    v_lshlrev_b32 v105, 16, v66
    v_mfma_f32_16x16x32_bf16 v[160:163], a[160:163], a[216:219], v[160:163]
    ds_read_b128 a[236:239], v43 offset:18432
    v_and_b32 v106, 0xffff0000, v67
    v_mfma_f32_16x16x32_bf16 v[160:163], a[164:167], a[220:223], v[160:163]
    ds_write_b64 v29, v[226:227] offset:28928
    v_lshlrev_b32 v107, 16, v85
    v_mfma_f32_16x16x32_bf16 v[160:163], a[200:203], a[16:19], v[160:163]
    v_lshlrev_b32 v108, 16, v65
    v_and_b32 v109, 0xffff0000, v66
    v_mfma_f32_16x16x32_bf16 v[160:163], a[204:207], a[20:23], v[160:163]
    v_lshlrev_b32 v110, 16, v84
    v_and_b32 v111, 0xffff0000, v85
    v_mfma_f32_16x16x32_bf16 v[192:195], a[48:51], a[216:219], v[192:195]
    s_waitcnt lgkmcnt(6)
    ds_read_b128 a[168:171], v40 offset:36864
    v_mul_f32 v128, v128, v100
    v_mfma_f32_16x16x32_bf16 v[192:195], a[52:55], a[220:223], v[192:195]
    ds_read_b128 a[172:175], v41 offset:36864
    v_mul_f32 v129, v129, v101
    v_mfma_f32_16x16x32_bf16 v[192:195], a[24:27], a[16:19], v[192:195]
    s_waitcnt lgkmcnt(2)
    s_barrier
    v_mfma_f32_16x16x32_bf16 v[192:195], a[28:31], a[20:23], v[192:195]
    ds_read_b64 v[112:113], v30 offset:28928
    v_mul_f32 v130, v130, v102
    v_mfma_f32_16x16x32_bf16 v[228:231], a[248:251], a[74:77], v[228:231]
    v_mul_f32 v131, v131, v103
    v_mul_f32 v160, v160, v104
    v_mfma_f32_16x16x32_bf16 v[228:231], a[252:255], a[66:69], v[228:231]
    ds_read_b128 a[56:59], v40 offset:53248
    v_cvt_pk_bf16_f32 v116, v128, v160
    v_mfma_f32_16x16x32_bf16 v[228:231], a[152:155], a[82:85], v[228:231]
    v_mul_f32 v161, v161, v105
    v_mul_f32 v162, v162, v106
    v_mfma_f32_16x16x32_bf16 v[228:231], a[156:159], a[234:237], v[228:231]
    v_cvt_pk_bf16_f32 v119, v130, v162
    v_mul_f32 v192, v192, v108
L_pad4:
    s_cbranch_execz L_warmed
    v_mfma_f32_16x16x32_bf16 v[132:135], a[184:187], a[72:75], v[132:135]
    v_mul_f32 v193, v193, v109
    v_mul_f32 v194, v194, v110
    v_mfma_f32_16x16x32_bf16 v[132:135], a[188:191], a[76:79], v[132:135]
    v_mul_f32 v195, v195, v111
    v_cvt_pk_bf16_f32 v117, v192, v129
    v_mfma_f32_16x16x32_bf16 v[132:135], a[0:3], a[64:67], v[132:135]
    ds_write_b64 v26, v[116:117] offset:64512
    v_mul_f32 v163, v163, v107
    v_mfma_f32_16x16x32_bf16 v[132:135], a[4:7], a[68:71], v[132:135]
    v_cvt_pk_bf16_f32 v118, v161, v193
    v_cvt_pk_bf16_f32 v120, v194, v131
    v_mfma_f32_16x16x32_bf16 v[132:135], a[176:179], a[80:83], v[132:135]
    ds_write_b64 v26, v[118:119] offset:64520
    v_cvt_pk_bf16_f32 v121, v163, v195
    v_mfma_f32_16x16x32_bf16 v[132:135], a[180:183], a[84:87], v[132:135]
    s_waitcnt lgkmcnt(3)
    ds_read_b128 a[60:63], v41 offset:53248
    v_add_f32 v224, v224, v112
    v_mfma_f32_16x16x32_bf16 v[132:135], a[40:43], a[232:235], v[132:135]
    ds_write_b64 v26, v[120:121] offset:64528
    v_mul_f32 v224, v224, v96
    v_mfma_f32_16x16x32_bf16 v[132:135], a[44:47], a[236:239], v[132:135]
    v_add_f32 v225, v225, v113
    v_mul_f32 v225, v225, v97
    v_mfma_f32_16x16x32_bf16 v[164:167], a[96:99], a[72:75], v[164:167]
    ds_write_b64 v29, v[230:231] offset:30976
    v_cvt_pk_bf16_f32 v112, v224, v225
    v_mfma_f32_16x16x32_bf16 v[164:167], a[100:103], a[76:79], v[164:167]
    ds_read_b128 a[144:147], v42 offset:4096
    v_mov_b32 v8, 1
    v_mfma_f32_16x16x32_bf16 v[164:167], a[8:11], a[64:67], v[164:167]
    ds_write_b32 v28, v112 offset:64512
    v_min_u32 v9, 1, v0
    v_mfma_f32_16x16x32_bf16 v[164:167], a[12:15], a[68:71], v[164:167]
    ds_read_b128 a[148:151], v43 offset:4096
    v_lshlrev_b32 v9, 30, v9
    v_mfma_f32_16x16x32_bf16 v[164:167], a[160:163], a[80:83], v[164:167]
    ds_read_b128 a[192:195], v42 offset:20480
    v_mfma_f32_16x16x32_bf16 v[164:167], a[164:167], a[84:87], v[164:167]
    buffer_atomic_add v8, v9, s[24:27], s77 offen sc0 sc1
    v_mfma_f32_16x16x32_bf16 v[164:167], a[200:203], a[232:235], v[164:167]
    v_mul_f32 v132, v132, v100
    v_mul_f32 v133, v133, v101
    v_mfma_f32_16x16x32_bf16 v[164:167], a[204:207], a[236:239], v[164:167]
    s_waitcnt lgkmcnt(2)
    s_barrier
    v_mfma_f32_16x16x32_bf16 v[196:199], a[120:123], a[72:75], v[196:199]
    ds_read_b128 a[196:199], v43 offset:20480
    ds_read_b64 v[124:125], v30 offset:30976
    v_mfma_f32_16x16x32_bf16 v[196:199], a[124:127], a[76:79], v[196:199]
    ds_read_b128 v[88:91], v24 offset:64512
    v_mul_f32 v134, v134, v102
    v_mfma_f32_16x16x32_bf16 v[196:199], a[136:139], a[64:67], v[196:199]
    ds_read_b128 v[92:95], v24 offset:65440
    v_mul_f32 v135, v135, v103
    v_mfma_f32_16x16x32_bf16 v[196:199], a[140:143], a[68:71], v[196:199]
    ds_read_b128 a[224:227], v40 offset:38912
    v_mul_f32 v164, v164, v104
    v_mfma_f32_16x16x32_bf16 v[196:199], a[48:51], a[80:83], v[196:199]
    v_cvt_pk_bf16_f32 v48, v132, v164
    v_mul_f32 v165, v165, v105
    v_mfma_f32_16x16x32_bf16 v[196:199], a[52:55], a[84:87], v[196:199]
    ds_read_b128 a[228:231], v41 offset:38912
    v_mul_f32 v166, v166, v106
    v_mfma_f32_16x16x32_bf16 v[196:199], a[24:27], a[232:235], v[196:199]
    v_cvt_pk_bf16_f32 v51, v134, v166
    v_mul_f32 v167, v167, v107
    v_mfma_f32_16x16x32_bf16 v[196:199], a[28:31], a[236:239], v[196:199]
    s_waitcnt lgkmcnt(3)
    v_add_f32 v228, v228, v124
    v_mfma_f32_16x16x32_bf16 v[232:235], a[248:251], a[170:173], v[232:235]
    buffer_store_dwordx4 v[88:91], v25, s[16:19], s66 offen sc1
    v_mfma_f32_16x16x32_bf16 v[232:235], a[252:255], a[58:61], v[232:235]
    s_mov_b32 s66, 114688
    v_mul_f32 v228, v228, v96
    v_add_f32 v229, v229, v125
    v_mfma_f32_16x16x32_bf16 v[232:235], a[152:155], a[146:149], v[232:235]
    v_mul_f32 v229, v229, v97
    v_cvt_pk_bf16_f32 v124, v228, v229
    v_mfma_f32_16x16x32_bf16 v[232:235], a[156:159], a[194:197], v[232:235]
    s_waitcnt lgkmcnt(2)
    ds_write_b32 v28, v124 offset:0
    v_mfma_f32_16x16x32_bf16 v[136:139], a[184:187], a[168:171], v[136:139]
    buffer_store_dwordx4 v[92:95], v25, s[16:19], s67 offen sc1
    v_mfma_f32_16x16x32_bf16 v[136:139], a[188:191], a[172:175], v[136:139]
    s_mov_b32 s67, 129024
    v_mul_f32 v196, v196, v108
    v_mul_f32 v197, v197, v109
    v_mfma_f32_16x16x32_bf16 v[136:139], a[0:3], a[56:59], v[136:139]
    ds_read_b128 a[216:219], v40 offset:55296
    v_mul_f32 v198, v198, v110
    v_mfma_f32_16x16x32_bf16 v[136:139], a[4:7], a[60:63], v[136:139]
    v_mul_f32 v199, v199, v111
    v_cvt_pk_bf16_f32 v49, v196, v133
    v_mfma_f32_16x16x32_bf16 v[136:139], a[176:179], a[144:147], v[136:139]
    ds_write_b64 v26, v[48:49] offset:0
    v_cvt_pk_bf16_f32 v50, v165, v197
    v_mfma_f32_16x16x32_bf16 v[136:139], a[180:183], a[148:151], v[136:139]
    ds_read_b128 a[220:223], v41 offset:55296
    v_cvt_pk_bf16_f32 v52, v198, v135
    v_mfma_f32_16x16x32_bf16 v[136:139], a[40:43], a[192:195], v[136:139]
    ds_write_b64 v26, v[50:51] offset:8
    v_cvt_pk_bf16_f32 v53, v167, v199
    v_mfma_f32_16x16x32_bf16 v[136:139], a[44:47], a[196:199], v[136:139]
    ds_write_b64 v26, v[52:53] offset:16
    v_mfma_f32_16x16x32_bf16 v[168:171], a[96:99], a[168:171], v[168:171]
    ds_write_b64 v29, v[234:235] offset:33024
    v_mfma_f32_16x16x32_bf16 v[168:171], a[100:103], a[172:175], v[168:171]
    ds_read_b128 a[16:19], v42 offset:6144
    v_mfma_f32_16x16x32_bf16 v[168:171], a[8:11], a[56:59], v[168:171]
    ds_read_b128 a[20:23], v43 offset:6144
    v_mfma_f32_16x16x32_bf16 v[168:171], a[12:15], a[60:63], v[168:171]
    ds_read_b128 a[72:75], v42 offset:22528
    v_mul_f32 v136, v136, v100
    v_mfma_f32_16x16x32_bf16 v[168:171], a[160:163], a[144:147], v[168:171]
    v_mul_f32 v137, v137, v101
    v_mul_f32 v138, v138, v102
    v_mfma_f32_16x16x32_bf16 v[168:171], a[164:167], a[148:151], v[168:171]
    s_waitcnt lgkmcnt(3)
    s_barrier
    v_mfma_f32_16x16x32_bf16 v[168:171], a[200:203], a[192:195], v[168:171]
    ds_read_b128 v[68:71], v24 offset:0
    ds_read_b64 v[72:73], v30 offset:33024
    v_mfma_f32_16x16x32_bf16 v[168:171], a[204:207], a[196:199], v[168:171]
    ds_read_b128 a[76:79], v43 offset:22528
    v_mul_f32 v139, v139, v103
    v_mfma_f32_16x16x32_bf16 v[200:203], a[120:123], a[168:171], v[200:203]
    ds_read_b128 v[76:79], v24 offset:928
    v_mfma_f32_16x16x32_bf16 v[200:203], a[124:127], a[172:175], v[200:203]
    v_mfma_f32_16x16x32_bf16 v[200:203], a[136:139], a[56:59], v[200:203]
    ds_read_b128 a[64:67], v40 offset:40960
    v_mfma_f32_16x16x32_bf16 v[200:203], a[140:143], a[60:63], v[200:203]
    v_mul_f32 v168, v168, v104
    v_cvt_pk_bf16_f32 v80, v136, v168
    v_mfma_f32_16x16x32_bf16 v[200:203], a[48:51], a[144:147], v[200:203]
    s_waitcnt lgkmcnt(3)
    v_mul_f32 v169, v169, v105
    v_mfma_f32_16x16x32_bf16 v[200:203], a[52:55], a[148:151], v[200:203]
    buffer_store_dwordx4 v[68:71], v25, s[16:19], s66 offen sc1
    v_mfma_f32_16x16x32_bf16 v[200:203], a[24:27], a[192:195], v[200:203]
    s_mov_b32 s66, 229376
    v_add_f32 v232, v232, v72
    v_mul_f32 v232, v232, v96
    v_mfma_f32_16x16x32_bf16 v[200:203], a[28:31], a[196:199], v[200:203]
    v_add_f32 v233, v233, v73
    v_mul_f32 v233, v233, v97
    v_mfma_f32_16x16x32_bf16 v[236:239], a[248:251], a[226:229], v[236:239]
    s_waitcnt lgkmcnt(1)
    ds_read_b128 a[68:71], v41 offset:40960
    v_mfma_f32_16x16x32_bf16 v[236:239], a[252:255], a[218:221], v[236:239]
    buffer_store_dwordx4 v[76:79], v25, s[16:19], s67 offen sc1
    v_mfma_f32_16x16x32_bf16 v[236:239], a[152:155], a[18:21], v[236:239]
    s_mov_b32 s67, 243712
    v_cvt_pk_bf16_f32 v72, v232, v233
    v_mul_f32 v170, v170, v106
    v_mfma_f32_16x16x32_bf16 v[236:239], a[156:159], a[74:77], v[236:239]
    ds_write_b32 v28, v72 offset:7424
    v_cvt_pk_bf16_f32 v83, v138, v170
    v_mfma_f32_16x16x32_bf16 v[140:143], a[184:187], a[224:227], v[140:143]
    v_mul_f32 v171, v171, v107
    v_mul_f32 v200, v200, v108
    v_mfma_f32_16x16x32_bf16 v[140:143], a[188:191], a[228:231], v[140:143]
    v_mul_f32 v201, v201, v109
    v_mul_f32 v202, v202, v110
    v_mfma_f32_16x16x32_bf16 v[140:143], a[0:3], a[216:219], v[140:143]
    ds_read_b128 a[80:83], v40 offset:57344
    v_mul_f32 v203, v203, v111
    v_mfma_f32_16x16x32_bf16 v[140:143], a[4:7], a[220:223], v[140:143]
    v_cvt_pk_bf16_f32 v81, v200, v137
    v_cvt_pk_bf16_f32 v82, v169, v201
    v_mfma_f32_16x16x32_bf16 v[140:143], a[176:179], a[16:19], v[140:143]
    ds_write_b64 v26, v[80:81] offset:7424
    v_cvt_pk_bf16_f32 v64, v202, v139
    v_mfma_f32_16x16x32_bf16 v[140:143], a[180:183], a[20:23], v[140:143]
    ds_read_b128 a[84:87], v41 offset:57344
    v_cvt_pk_bf16_f32 v65, v171, v203
    v_mfma_f32_16x16x32_bf16 v[140:143], a[40:43], a[72:75], v[140:143]
    ds_write_b64 v26, v[82:83] offset:7432
    v_mfma_f32_16x16x32_bf16 v[140:143], a[44:47], a[76:79], v[140:143]
    ds_write_b64 v26, v[64:65] offset:7440
    v_mfma_f32_16x16x32_bf16 v[172:175], a[96:99], a[224:227], v[172:175]
    ds_write_b64 v29, v[238:239] offset:0
    v_mfma_f32_16x16x32_bf16 v[172:175], a[100:103], a[228:231], v[172:175]
    ds_read_b128 a[232:235], v42 offset:8192
    v_mfma_f32_16x16x32_bf16 v[172:175], a[8:11], a[216:219], v[172:175]
    ds_read_b128 a[236:239], v43 offset:8192
    v_mfma_f32_16x16x32_bf16 v[172:175], a[12:15], a[220:223], v[172:175]
    ds_read_b128 a[168:171], v42 offset:24576
    v_mul_f32 v140, v140, v100
    v_mfma_f32_16x16x32_bf16 v[172:175], a[160:163], a[16:19], v[172:175]
    v_mul_f32 v141, v141, v101
    v_mul_f32 v142, v142, v102
    v_mfma_f32_16x16x32_bf16 v[172:175], a[164:167], a[20:23], v[172:175]
    s_waitcnt lgkmcnt(3)
    s_barrier
    v_mfma_f32_16x16x32_bf16 v[172:175], a[200:203], a[72:75], v[172:175]
    ds_read_b128 v[84:87], v24 offset:7424
    ds_read_b64 v[116:117], v30 offset:0
    v_mfma_f32_16x16x32_bf16 v[172:175], a[204:207], a[76:79], v[172:175]
    ds_read_b128 a[172:175], v43 offset:24576
    v_mul_f32 v143, v143, v103
    v_mfma_f32_16x16x32_bf16 v[204:207], a[120:123], a[224:227], v[204:207]
    ds_read_b128 v[120:123], v24 offset:8352
    v_mfma_f32_16x16x32_bf16 v[204:207], a[124:127], a[228:231], v[204:207]
    v_mfma_f32_16x16x32_bf16 v[204:207], a[136:139], a[216:219], v[204:207]
    ds_read_b128 a[56:59], v40 offset:43008
    v_mfma_f32_16x16x32_bf16 v[204:207], a[140:143], a[220:223], v[204:207]
    v_mul_f32 v172, v172, v104
    v_cvt_pk_bf16_f32 v112, v140, v172
    v_mfma_f32_16x16x32_bf16 v[204:207], a[48:51], a[16:19], v[204:207]
    s_waitcnt lgkmcnt(3)
    v_mul_f32 v173, v173, v105
    v_mfma_f32_16x16x32_bf16 v[204:207], a[52:55], a[20:23], v[204:207]
    buffer_store_dwordx4 v[84:87], v25, s[16:19], s66 offen sc1
    v_mfma_f32_16x16x32_bf16 v[204:207], a[24:27], a[72:75], v[204:207]
    s_mov_b32 s66, 344064
    v_add_f32 v236, v236, v116
    v_mul_f32 v236, v236, v96
    v_mfma_f32_16x16x32_bf16 v[204:207], a[28:31], a[76:79], v[204:207]
    v_add_f32 v237, v237, v117
    v_mul_f32 v237, v237, v97
    v_mfma_f32_16x16x32_bf16 v[240:243], a[248:251], a[66:69], v[240:243]
    s_waitcnt lgkmcnt(1)
    ds_read_b128 a[60:63], v41 offset:43008
    v_mfma_f32_16x16x32_bf16 v[240:243], a[252:255], a[82:85], v[240:243]
    buffer_store_dwordx4 v[120:123], v25, s[16:19], s67 offen sc1
    v_mfma_f32_16x16x32_bf16 v[240:243], a[152:155], a[234:237], v[240:243]
    s_mov_b32 s67, 358400
    v_cvt_pk_bf16_f32 v116, v236, v237
    v_mul_f32 v174, v174, v106
    v_mfma_f32_16x16x32_bf16 v[240:243], a[156:159], a[170:173], v[240:243]
    ds_write_b32 v28, v116 offset:14848
    v_cvt_pk_bf16_f32 v115, v142, v174
    v_mfma_f32_16x16x32_bf16 v[144:147], a[184:187], a[64:67], v[144:147]
    v_mul_f32 v175, v175, v107
    v_mul_f32 v204, v204, v108
    v_mfma_f32_16x16x32_bf16 v[144:147], a[188:191], a[68:71], v[144:147]
    v_mul_f32 v205, v205, v109
    v_mul_f32 v206, v206, v110
    v_mfma_f32_16x16x32_bf16 v[144:147], a[0:3], a[80:83], v[144:147]
    ds_read_b128 a[144:147], v40 offset:59392
    v_mul_f32 v207, v207, v111
    v_mfma_f32_16x16x32_bf16 v[144:147], a[4:7], a[84:87], v[144:147]
    v_cvt_pk_bf16_f32 v113, v204, v141
    v_cvt_pk_bf16_f32 v114, v173, v205
    v_mfma_f32_16x16x32_bf16 v[144:147], a[176:179], a[232:235], v[144:147]
    ds_write_b64 v26, v[112:113] offset:14848
    v_cvt_pk_bf16_f32 v88, v206, v143
    v_mfma_f32_16x16x32_bf16 v[144:147], a[180:183], a[236:239], v[144:147]
    ds_read_b128 a[148:151], v41 offset:59392
    v_cvt_pk_bf16_f32 v89, v175, v207
    v_mfma_f32_16x16x32_bf16 v[144:147], a[40:43], a[168:171], v[144:147]
    ds_write_b64 v26, v[114:115] offset:14856
    v_mfma_f32_16x16x32_bf16 v[144:147], a[44:47], a[172:175], v[144:147]
    ds_write_b64 v26, v[88:89] offset:14864
    v_mfma_f32_16x16x32_bf16 v[176:179], a[96:99], a[64:67], v[176:179]
    ds_write_b64 v29, v[242:243] offset:2048
    v_mfma_f32_16x16x32_bf16 v[176:179], a[100:103], a[68:71], v[176:179]
    ds_read_b128 a[192:195], v42 offset:10240
    v_mfma_f32_16x16x32_bf16 v[176:179], a[8:11], a[80:83], v[176:179]
    ds_read_b128 a[196:199], v43 offset:10240
    v_mfma_f32_16x16x32_bf16 v[176:179], a[12:15], a[84:87], v[176:179]
    ds_read_b128 a[224:227], v42 offset:26624
    v_mul_f32 v144, v144, v100
    v_mfma_f32_16x16x32_bf16 v[176:179], a[160:163], a[232:235], v[176:179]
    v_mul_f32 v145, v145, v101
    v_mul_f32 v146, v146, v102
    v_mfma_f32_16x16x32_bf16 v[176:179], a[164:167], a[236:239], v[176:179]
    s_waitcnt lgkmcnt(3)
    s_barrier
    v_mfma_f32_16x16x32_bf16 v[176:179], a[200:203], a[168:171], v[176:179]
    ds_read_b128 v[124:127], v24 offset:14848
    ds_read_b64 v[92:93], v30 offset:2048
    v_mfma_f32_16x16x32_bf16 v[176:179], a[204:207], a[172:175], v[176:179]
    ds_read_b128 a[228:231], v43 offset:26624
    v_mul_f32 v147, v147, v103
    v_mfma_f32_16x16x32_bf16 v[208:211], a[120:123], a[64:67], v[208:211]
    ds_read_b128 v[48:51], v24 offset:15776
    v_mfma_f32_16x16x32_bf16 v[208:211], a[124:127], a[68:71], v[208:211]
    v_mfma_f32_16x16x32_bf16 v[208:211], a[136:139], a[80:83], v[208:211]
    ds_read_b128 a[216:219], v40 offset:45056
    v_mfma_f32_16x16x32_bf16 v[208:211], a[140:143], a[84:87], v[208:211]
    v_mul_f32 v176, v176, v104
    v_cvt_pk_bf16_f32 v52, v144, v176
    v_mfma_f32_16x16x32_bf16 v[208:211], a[48:51], a[232:235], v[208:211]
    s_waitcnt lgkmcnt(3)
    v_mul_f32 v177, v177, v105
    v_mfma_f32_16x16x32_bf16 v[208:211], a[52:55], a[236:239], v[208:211]
    buffer_store_dwordx4 v[124:127], v25, s[16:19], s66 offen sc1
    v_mfma_f32_16x16x32_bf16 v[208:211], a[24:27], a[168:171], v[208:211]
    s_mov_b32 s66, 458752
    v_add_f32 v240, v240, v92
    v_mul_f32 v240, v240, v96
    v_mfma_f32_16x16x32_bf16 v[208:211], a[28:31], a[172:175], v[208:211]
    v_add_f32 v241, v241, v93
    v_mul_f32 v241, v241, v97
    v_mfma_f32_16x16x32_bf16 v[244:247], a[248:251], a[58:61], v[244:247]
    s_waitcnt lgkmcnt(1)
    ds_read_b128 a[220:223], v41 offset:45056
    v_mfma_f32_16x16x32_bf16 v[244:247], a[252:255], a[146:149], v[244:247]
    buffer_store_dwordx4 v[48:51], v25, s[16:19], s67 offen sc1
    v_mfma_f32_16x16x32_bf16 v[244:247], a[152:155], a[194:197], v[244:247]
    s_mov_b32 s67, 473088
    v_cvt_pk_bf16_f32 v92, v240, v241
    v_mul_f32 v178, v178, v106
    v_mfma_f32_16x16x32_bf16 v[244:247], a[156:159], a[226:229], v[244:247]
    ds_write_b32 v28, v92 offset:22272
    v_cvt_pk_bf16_f32 v55, v146, v178
    v_mfma_f32_16x16x32_bf16 v[148:151], a[184:187], a[56:59], v[148:151]
    v_mul_f32 v179, v179, v107
    v_mul_f32 v208, v208, v108
    v_mfma_f32_16x16x32_bf16 v[148:151], a[188:191], a[60:63], v[148:151]
    v_mul_f32 v209, v209, v109
    v_mul_f32 v210, v210, v110
    v_mfma_f32_16x16x32_bf16 v[148:151], a[0:3], a[144:147], v[148:151]
    ds_read_b128 a[16:19], v40 offset:61440
    v_mul_f32 v211, v211, v111
    v_mfma_f32_16x16x32_bf16 v[148:151], a[4:7], a[148:151], v[148:151]
    v_cvt_pk_bf16_f32 v53, v208, v145
    v_cvt_pk_bf16_f32 v54, v177, v209
    v_mfma_f32_16x16x32_bf16 v[148:151], a[176:179], a[192:195], v[148:151]
    ds_write_b64 v26, v[52:53] offset:22272
    v_cvt_pk_bf16_f32 v68, v210, v147
    v_mfma_f32_16x16x32_bf16 v[148:151], a[180:183], a[196:199], v[148:151]
    ds_read_b128 a[20:23], v41 offset:61440
    v_cvt_pk_bf16_f32 v69, v179, v211
    v_mfma_f32_16x16x32_bf16 v[148:151], a[40:43], a[224:227], v[148:151]
    ds_write_b64 v26, v[54:55] offset:22280
    v_mfma_f32_16x16x32_bf16 v[148:151], a[44:47], a[228:231], v[148:151]
    ds_write_b64 v26, v[68:69] offset:22288
    v_mfma_f32_16x16x32_bf16 v[180:183], a[96:99], a[56:59], v[180:183]
    ds_write_b64 v29, v[246:247] offset:4096
    v_mfma_f32_16x16x32_bf16 v[180:183], a[100:103], a[60:63], v[180:183]
    ds_read_b128 a[72:75], v42 offset:12288
    v_mfma_f32_16x16x32_bf16 v[180:183], a[8:11], a[144:147], v[180:183]
    ds_read_b128 a[76:79], v43 offset:12288
    v_mfma_f32_16x16x32_bf16 v[180:183], a[12:15], a[148:151], v[180:183]
    ds_read_b128 a[64:67], v42 offset:28672
    v_mul_f32 v148, v148, v100
    v_mfma_f32_16x16x32_bf16 v[180:183], a[160:163], a[192:195], v[180:183]
    v_mul_f32 v149, v149, v101
    v_mul_f32 v150, v150, v102
    v_mfma_f32_16x16x32_bf16 v[180:183], a[164:167], a[196:199], v[180:183]
    s_waitcnt lgkmcnt(3)
    s_barrier
    v_mfma_f32_16x16x32_bf16 v[180:183], a[200:203], a[224:227], v[180:183]
    ds_read_b128 v[76:79], v24 offset:22272
    ds_read_b64 v[72:73], v30 offset:4096
    v_mfma_f32_16x16x32_bf16 v[180:183], a[204:207], a[228:231], v[180:183]
    ds_read_b128 a[68:71], v43 offset:28672
    v_mul_f32 v151, v151, v103
    v_mfma_f32_16x16x32_bf16 v[212:215], a[120:123], a[56:59], v[212:215]
    ds_read_b128 v[80:83], v24 offset:23200
    v_mfma_f32_16x16x32_bf16 v[212:215], a[124:127], a[60:63], v[212:215]
    v_mfma_f32_16x16x32_bf16 v[212:215], a[136:139], a[144:147], v[212:215]
    ds_read_b128 a[80:83], v40 offset:14336
    v_mfma_f32_16x16x32_bf16 v[212:215], a[140:143], a[148:151], v[212:215]
    v_mul_f32 v180, v180, v104
    v_cvt_pk_bf16_f32 v64, v148, v180
    v_mfma_f32_16x16x32_bf16 v[212:215], a[48:51], a[192:195], v[212:215]
    s_waitcnt lgkmcnt(3)
    v_mul_f32 v181, v181, v105
    v_mfma_f32_16x16x32_bf16 v[212:215], a[52:55], a[196:199], v[212:215]
    buffer_store_dwordx4 v[76:79], v25, s[16:19], s66 offen sc1
    v_mfma_f32_16x16x32_bf16 v[212:215], a[24:27], a[224:227], v[212:215]
    s_mov_b32 s66, 573440
    v_add_f32 v244, v244, v72
    v_mul_f32 v244, v244, v96
    v_mfma_f32_16x16x32_bf16 v[212:215], a[28:31], a[228:231], v[212:215]
    v_add_f32 v245, v245, v73
    v_mul_f32 v245, v245, v97
    v_mfma_f32_16x16x32_bf16 v[248:251], a[248:251], a[218:221], v[248:251]
    s_waitcnt lgkmcnt(1)
    ds_read_b128 a[84:87], v41 offset:14336
    v_mfma_f32_16x16x32_bf16 v[248:251], a[252:255], a[18:21], v[248:251]
    buffer_store_dwordx4 v[80:83], v25, s[16:19], s67 offen sc1
    v_mfma_f32_16x16x32_bf16 v[248:251], a[152:155], a[74:77], v[248:251]
    s_mov_b32 s67, 587776
    v_cvt_pk_bf16_f32 v72, v244, v245
    v_mul_f32 v182, v182, v106
    v_mfma_f32_16x16x32_bf16 v[248:251], a[156:159], a[66:69], v[248:251]
    ds_write_b32 v28, v72 offset:29696
    v_cvt_pk_bf16_f32 v67, v150, v182
    v_mfma_f32_16x16x32_bf16 v[152:155], a[184:187], a[216:219], v[152:155]
    v_mul_f32 v183, v183, v107
    v_mul_f32 v212, v212, v108
    v_mfma_f32_16x16x32_bf16 v[152:155], a[188:191], a[220:223], v[152:155]
    v_mul_f32 v213, v213, v109
    v_mul_f32 v214, v214, v110
    v_mfma_f32_16x16x32_bf16 v[152:155], a[0:3], a[16:19], v[152:155]
    ds_read_b128 a[232:235], v40 offset:30720
    v_mul_f32 v215, v215, v111
    v_mfma_f32_16x16x32_bf16 v[152:155], a[4:7], a[20:23], v[152:155]
    v_cvt_pk_bf16_f32 v65, v212, v149
    v_cvt_pk_bf16_f32 v66, v181, v213
    v_mfma_f32_16x16x32_bf16 v[152:155], a[176:179], a[72:75], v[152:155]
    ds_write_b64 v26, v[64:65] offset:29696
    v_cvt_pk_bf16_f32 v84, v214, v151
    v_mfma_f32_16x16x32_bf16 v[152:155], a[180:183], a[76:79], v[152:155]
    ds_read_b128 a[236:239], v41 offset:30720
    v_cvt_pk_bf16_f32 v85, v183, v215
    v_mfma_f32_16x16x32_bf16 v[152:155], a[40:43], a[64:67], v[152:155]
    ds_write_b64 v26, v[66:67] offset:29704
    v_mfma_f32_16x16x32_bf16 v[152:155], a[44:47], a[68:71], v[152:155]
    ds_write_b64 v26, v[84:85] offset:29712
    v_mfma_f32_16x16x32_bf16 v[184:187], a[96:99], a[216:219], v[184:187]
    ds_write_b64 v29, v[250:251] offset:6144
    v_mfma_f32_16x16x32_bf16 v[184:187], a[100:103], a[220:223], v[184:187]
    ds_read_b128 a[168:171], v40 offset:47104
    v_mfma_f32_16x16x32_bf16 v[184:187], a[8:11], a[16:19], v[184:187]
    ds_read_b128 a[172:175], v41 offset:47104
    v_mfma_f32_16x16x32_bf16 v[184:187], a[12:15], a[20:23], v[184:187]
    ds_read_b128 a[56:59], v40 offset:63488
    v_mul_f32 v152, v152, v100
    v_mfma_f32_16x16x32_bf16 v[184:187], a[160:163], a[72:75], v[184:187]
    v_mul_f32 v153, v153, v101
    v_mul_f32 v154, v154, v102
    v_mfma_f32_16x16x32_bf16 v[184:187], a[164:167], a[76:79], v[184:187]
    s_waitcnt lgkmcnt(3)
    s_barrier
    v_mfma_f32_16x16x32_bf16 v[184:187], a[200:203], a[64:67], v[184:187]
    ds_read_b128 v[120:123], v24 offset:29696
    ds_read_b64 v[116:117], v30 offset:6144
    v_mfma_f32_16x16x32_bf16 v[184:187], a[204:207], a[68:71], v[184:187]
    ds_read_b128 a[60:63], v41 offset:63488
    v_mul_f32 v155, v155, v103
    v_mfma_f32_16x16x32_bf16 v[216:219], a[120:123], a[216:219], v[216:219]
    ds_read_b128 a[144:147], v42 offset:14336
    v_mfma_f32_16x16x32_bf16 v[216:219], a[124:127], a[220:223], v[216:219]
    ds_read_b128 a[148:151], v43 offset:14336
    v_mfma_f32_16x16x32_bf16 v[216:219], a[136:139], a[16:19], v[216:219]
    ds_read_b128 a[192:195], v42 offset:30720
    v_mfma_f32_16x16x32_bf16 v[216:219], a[140:143], a[20:23], v[216:219]
    v_mul_f32 v184, v184, v104
    v_cvt_pk_bf16_f32 v112, v152, v184
    v_mfma_f32_16x16x32_bf16 v[216:219], a[48:51], a[72:75], v[216:219]
    s_waitcnt lgkmcnt(4)
    ds_read_b128 a[196:199], v43 offset:30720
    v_mfma_f32_16x16x32_bf16 v[216:219], a[52:55], a[76:79], v[216:219]
    buffer_store_dwordx4 v[120:123], v25, s[16:19], s66 offen sc1
    v_mfma_f32_16x16x32_bf16 v[216:219], a[24:27], a[64:67], v[216:219]
    s_mov_b32 s66, 688128
    ds_read_b128 v[88:91], v24 offset:30624
    v_add_f32 v248, v248, v116
    v_mfma_f32_16x16x32_bf16 v[216:219], a[28:31], a[68:71], v[216:219]
    v_mul_f32 v248, v248, v96
    v_add_f32 v249, v249, v117
    v_mfma_f32_16x16x32_bf16 v[252:255], a[88:91], a[82:85], v[252:255]
    v_mul_f32 v249, v249, v97
    v_cvt_pk_bf16_f32 v116, v248, v249
    v_mfma_f32_16x16x32_bf16 v[252:255], a[92:95], a[234:237], v[252:255]
    ds_write_b32 v28, v116 offset:37120
    v_mul_f32 v185, v185, v105
    v_mfma_f32_16x16x32_bf16 v[252:255], a[248:251], a[170:173], v[252:255]
    s_waitcnt lgkmcnt(4)
    v_mul_f32 v186, v186, v106
    v_cvt_pk_bf16_f32 v115, v154, v186
    v_mfma_f32_16x16x32_bf16 v[252:255], a[252:255], a[58:61], v[252:255]
    v_mul_f32 v187, v187, v107
    v_mul_f32 v216, v216, v108
    v_mfma_f32_16x16x32_bf16 v[252:255], a[152:155], a[146:149], v[252:255]
    s_waitcnt lgkmcnt(1)
    v_mul_f32 v217, v217, v109
    v_mfma_f32_16x16x32_bf16 v[252:255], a[156:159], a[194:197], v[252:255]
    buffer_store_dwordx4 v[88:91], v25, s[16:19], s67 offen sc1
    v_mfma_f32_16x16x32_bf16 v[156:159], a[128:131], a[80:83], v[156:159]
    s_mov_b32 s67, 702464
    v_mul_f32 v218, v218, v110
    v_mul_f32 v219, v219, v111
    v_mfma_f32_16x16x32_bf16 v[156:159], a[132:135], a[84:87], v[156:159]
    v_cvt_pk_bf16_f32 v113, v216, v153
    v_cvt_pk_bf16_f32 v114, v185, v217
    v_mfma_f32_16x16x32_bf16 v[156:159], a[32:35], a[232:235], v[156:159]
    ds_write_b64 v26, v[112:113] offset:37120
    v_cvt_pk_bf16_f32 v124, v218, v155
    v_mfma_f32_16x16x32_bf16 v[156:159], a[36:39], a[236:239], v[156:159]
    ds_write_b64 v26, v[114:115] offset:37128
    v_cvt_pk_bf16_f32 v125, v187, v219
    v_mfma_f32_16x16x32_bf16 v[156:159], a[184:187], a[168:171], v[156:159]
    ds_write_b64 v26, v[124:125] offset:37136
    v_mfma_f32_16x16x32_bf16 v[156:159], a[188:191], a[172:175], v[156:159]
    ds_write_b64 v29, v[254:255] offset:8192
    v_mfma_f32_16x16x32_bf16 v[156:159], a[0:3], a[56:59], v[156:159]
    v_mfma_f32_16x16x32_bf16 v[156:159], a[4:7], a[60:63], v[156:159]
    v_mfma_f32_16x16x32_bf16 v[156:159], a[176:179], a[144:147], v[156:159]
    v_mfma_f32_16x16x32_bf16 v[156:159], a[180:183], a[148:151], v[156:159]
    v_mfma_f32_16x16x32_bf16 v[156:159], a[40:43], a[192:195], v[156:159]
    s_waitcnt lgkmcnt(0)
    s_barrier
    v_mfma_f32_16x16x32_bf16 v[156:159], a[44:47], a[196:199], v[156:159]
    ds_read_b128 v[48:51], v24 offset:37120
    ds_read_b64 v[92:93], v30 offset:8192
    v_mfma_f32_16x16x32_bf16 v[188:191], a[104:107], a[80:83], v[188:191]
    ds_read_b128 v[52:55], v24 offset:38048
    v_mfma_f32_16x16x32_bf16 v[188:191], a[108:111], a[84:87], v[188:191]
    v_mfma_f32_16x16x32_bf16 v[188:191], a[208:211], a[232:235], v[188:191]
    s_waitcnt vmcnt(12)
    v_xor_b32 v8, 15, v8
    v_or_b32 v8, v8, v0
    v_mfma_f32_16x16x32_bf16 v[188:191], a[212:215], a[236:239], v[188:191]
    v_mul_f32 v156, v156, v100
    v_mul_f32 v157, v157, v101
    v_mfma_f32_16x16x32_bf16 v[188:191], a[96:99], a[168:171], v[188:191]
    v_mul_f32 v158, v158, v102
    v_mul_f32 v159, v159, v103
    v_mfma_f32_16x16x32_bf16 v[188:191], a[100:103], a[172:175], v[188:191]
    s_waitcnt lgkmcnt(1)
    v_min_u32 v8, 1, v8
    v_mfma_f32_16x16x32_bf16 v[188:191], a[8:11], a[56:59], v[188:191]
    buffer_store_dwordx4 v[48:51], v25, s[16:19], s66 offen sc1
    v_mfma_f32_16x16x32_bf16 v[188:191], a[12:15], a[60:63], v[188:191]
    s_mov_b32 s66, 802816
    v_add_f32 v252, v252, v92
    v_mul_f32 v252, v252, v96
    v_mfma_f32_16x16x32_bf16 v[188:191], a[160:163], a[144:147], v[188:191]
    v_add_f32 v253, v253, v93
    v_mul_f32 v253, v253, v97
    v_mfma_f32_16x16x32_bf16 v[188:191], a[164:167], a[148:151], v[188:191]
    s_waitcnt lgkmcnt(0)
    v_cvt_pk_bf16_f32 v92, v252, v253
    v_mfma_f32_16x16x32_bf16 v[188:191], a[200:203], a[192:195], v[188:191]
    buffer_store_dwordx4 v[52:55], v25, s[16:19], s67 offen sc1
    v_mfma_f32_16x16x32_bf16 v[188:191], a[204:207], a[196:199], v[188:191]
    s_mov_b32 s67, 817152
    ds_write_b32 v28, v92 offset:44544
    v_lshlrev_b32 v8, 30, v8
    v_mfma_f32_16x16x32_bf16 v[220:223], a[112:115], a[80:83], v[220:223]
    v_mov_b32 v9, s76
    v_mfma_f32_16x16x32_bf16 v[220:223], a[116:119], a[84:87], v[220:223]
    v_mfma_f32_16x16x32_bf16 v[220:223], a[240:243], a[232:235], v[220:223]
    buffer_store_dword v9, v8, s[12:15], s78 offen sc1
    v_mfma_f32_16x16x32_bf16 v[220:223], a[244:247], a[236:239], v[220:223]
    v_mul_f32 v188, v188, v104
    v_cvt_pk_bf16_f32 v68, v156, v188
    v_mfma_f32_16x16x32_bf16 v[220:223], a[120:123], a[168:171], v[220:223]
    v_mul_f32 v189, v189, v105
    v_mul_f32 v190, v190, v106
    v_mfma_f32_16x16x32_bf16 v[220:223], a[124:127], a[172:175], v[220:223]
    v_cvt_pk_bf16_f32 v71, v158, v190
    v_mul_f32 v191, v191, v107
    v_mfma_f32_16x16x32_bf16 v[220:223], a[136:139], a[56:59], v[220:223]
    v_mfma_f32_16x16x32_bf16 v[220:223], a[140:143], a[60:63], v[220:223]
    v_mfma_f32_16x16x32_bf16 v[220:223], a[48:51], a[144:147], v[220:223]
    v_mfma_f32_16x16x32_bf16 v[220:223], a[52:55], a[148:151], v[220:223]
    v_mfma_f32_16x16x32_bf16 v[220:223], a[24:27], a[192:195], v[220:223]
    v_mfma_f32_16x16x32_bf16 v[220:223], a[28:31], a[196:199], v[220:223]
    s_nop 7
    v_mul_f32 v220, v220, v108
    v_mul_f32 v221, v221, v109
    v_mul_f32 v222, v222, v110
    v_mul_f32 v223, v223, v111
    v_cvt_pk_bf16_f32 v69, v220, v157
    v_cvt_pk_bf16_f32 v70, v189, v221
    v_cvt_pk_bf16_f32 v76, v222, v159
    v_cvt_pk_bf16_f32 v77, v191, v223
    ds_write_b64 v26, v[68:69] offset:44544
    ds_write_b64 v26, v[70:71] offset:44552
    ds_write_b64 v26, v[76:77] offset:44560
    s_waitcnt lgkmcnt(0)
    s_barrier
    ds_read_b128 v[80:83], v24 offset:44544
    ds_read_b128 v[72:75], v24 offset:45472
    s_waitcnt lgkmcnt(1)
    buffer_store_dwordx4 v[80:83], v25, s[16:19], s66 offen sc1
    s_waitcnt lgkmcnt(0)
    buffer_store_dwordx4 v[72:75], v25, s[16:19], s67 offen sc1
L_end:
    s_endpgm
L_slow0_1:
    s_mov_b32 s22, 0
    s_call_b64 s[20:21], L_tick
    buffer_load_dwordx4 v[72:75], v34, s[12:15], 0 offen sc1
    buffer_load_dwordx4 v[76:79], v44, s[12:15], 0 offen sc1
    s_waitcnt vmcnt(0)
    v_bitop3_b32 v12, v75, v79, s76 bitop3:0x7e
    v_cmp_lt_u32 vcc, 0xffff, v12
    s_cbranch_vccnz L_slow0_1
    s_branch L_back0_1
L_slow1_0:
    s_mov_b32 s22, 1
    s_call_b64 s[20:21], L_tick
    buffer_load_dwordx4 v[80:83], v32, s[12:15], s40 offen sc1
    buffer_load_dwordx4 v[84:87], v33, s[12:15], s40 offen sc1
    s_waitcnt vmcnt(0)
    v_bitop3_b32 v12, v83, v87, s76 bitop3:0x7e
    v_cmp_lt_u32 vcc, 0xffff, v12
    s_cbranch_vccnz L_slow1_0
    s_branch L_back1_0
L_slow1_1:
    s_mov_b32 s22, 1
    s_call_b64 s[20:21], L_tick
    buffer_load_dwordx4 v[88:91], v34, s[12:15], s40 offen sc1
    buffer_load_dwordx4 v[92:95], v44, s[12:15], s40 offen sc1
    s_waitcnt vmcnt(0)
    v_bitop3_b32 v12, v91, v95, s76 bitop3:0x7e
    v_cmp_lt_u32 vcc, 0xffff, v12
    s_cbranch_vccnz L_slow1_1
    s_branch L_back1_1
L_slow2_0:
    s_mov_b32 s22, 2
    s_call_b64 s[20:21], L_tick
    buffer_load_dwordx4 v[48:51], v32, s[12:15], s41 offen sc1
    buffer_load_dwordx4 v[52:55], v33, s[12:15], s41 offen sc1
    s_waitcnt vmcnt(0)
    v_bitop3_b32 v12, v51, v55, s76 bitop3:0x7e
    v_cmp_lt_u32 vcc, 0xffff, v12
    s_cbranch_vccnz L_slow2_0
    s_branch L_back2_0
L_slow2_1:
    s_mov_b32 s22, 2
    s_call_b64 s[20:21], L_tick
    buffer_load_dwordx4 v[64:67], v34, s[12:15], s41 offen sc1
    buffer_load_dwordx4 v[68:71], v44, s[12:15], s41 offen sc1
    s_waitcnt vmcnt(0)
    v_bitop3_b32 v12, v67, v71, s76 bitop3:0x7e
    v_cmp_lt_u32 vcc, 0xffff, v12
    s_cbranch_vccnz L_slow2_1
    s_branch L_back2_1
L_slow3_0:
    s_mov_b32 s22, 3
    s_call_b64 s[20:21], L_tick
    buffer_load_dwordx4 v[72:75], v32, s[12:15], s42 offen sc1
    buffer_load_dwordx4 v[76:79], v33, s[12:15], s42 offen sc1
    s_waitcnt vmcnt(0)
    v_bitop3_b32 v12, v75, v79, s76 bitop3:0x7e
    v_cmp_lt_u32 vcc, 0xffff, v12
    s_cbranch_vccnz L_slow3_0
    s_branch L_back3_0
L_slow3_1:
    s_mov_b32 s22, 3
    s_call_b64 s[20:21], L_tick
    buffer_load_dwordx4 v[80:83], v34, s[12:15], s42 offen sc1
    buffer_load_dwordx4 v[84:87], v44, s[12:15], s42 offen sc1
    s_waitcnt vmcnt(0)
    v_bitop3_b32 v12, v83, v87, s76 bitop3:0x7e
    v_cmp_lt_u32 vcc, 0xffff, v12
    s_cbranch_vccnz L_slow3_1
    s_branch L_back3_1
L_slow4_0:
    s_mov_b32 s22, 4
    s_call_b64 s[20:21], L_tick
    buffer_load_dwordx4 v[96:99], v32, s[12:15], s43 offen sc1
    buffer_load_dwordx4 v[100:103], v33, s[12:15], s43 offen sc1
    s_waitcnt vmcnt(0)
    v_bitop3_b32 v12, v99, v103, s76 bitop3:0x7e
    v_cmp_lt_u32 vcc, 0xffff, v12
    s_cbranch_vccnz L_slow4_0
    s_branch L_back4_0
L_slow4_1:
    s_mov_b32 s22, 4
    s_call_b64 s[20:21], L_tick
    buffer_load_dwordx4 v[104:107], v34, s[12:15], s43 offen sc1
    buffer_load_dwordx4 v[108:111], v44, s[12:15], s43 offen sc1
    s_waitcnt vmcnt(0)
    v_bitop3_b32 v12, v107, v111, s76 bitop3:0x7e
    v_cmp_lt_u32 vcc, 0xffff, v12
    s_cbranch_vccnz L_slow4_1
    s_branch L_back4_1
L_slow5_0:
    s_mov_b32 s22, 5
    s_call_b64 s[20:21], L_tick
    buffer_load_dwordx4 v[112:115], v32, s[12:15], s44 offen sc1
    buffer_load_dwordx4 v[116:119], v33, s[12:15], s44 offen sc1
    s_waitcnt vmcnt(0)
    v_bitop3_b32 v12, v115, v119, s76 bitop3:0x7e
    v_cmp_lt_u32 vcc, 0xffff, v12
    s_cbranch_vccnz L_slow5_0
    s_branch L_back5_0
L_slow5_1:
    s_mov_b32 s22, 5
    s_call_b64 s[20:21], L_tick
    buffer_load_dwordx4 v[120:123], v34, s[12:15], s44 offen sc1
    buffer_load_dwordx4 v[124:127], v44, s[12:15], s44 offen sc1
    s_waitcnt vmcnt(0)
    v_bitop3_b32 v12, v123, v127, s76 bitop3:0x7e
    v_cmp_lt_u32 vcc, 0xffff, v12
    s_cbranch_vccnz L_slow5_1
    s_branch L_back5_1
L_slow6_0:
    s_mov_b32 s22, 6
    s_call_b64 s[20:21], L_tick
    buffer_load_dwordx4 v[88:91], v32, s[12:15], s45 offen sc1
    buffer_load_dwordx4 v[92:95], v33, s[12:15], s45 offen sc1
    s_waitcnt vmcnt(0)
    v_bitop3_b32 v12, v91, v95, s76 bitop3:0x7e
    v_cmp_lt_u32 vcc, 0xffff, v12
    s_cbranch_vccnz L_slow6_0
    s_branch L_back6_0
L_slow6_1:
    s_mov_b32 s22, 6
    s_call_b64 s[20:21], L_tick
    buffer_load_dwordx4 v[48:51], v34, s[12:15], s45 offen sc1
    buffer_load_dwordx4 v[52:55], v44, s[12:15], s45 offen sc1
    s_waitcnt vmcnt(0)
    v_bitop3_b32 v12, v51, v55, s76 bitop3:0x7e
    v_cmp_lt_u32 vcc, 0xffff, v12
    s_cbranch_vccnz L_slow6_1
    s_branch L_back6_1
L_slow7_0:
    s_mov_b32 s22, 7
    s_call_b64 s[20:21], L_tick
    buffer_load_dwordx4 v[68:71], v32, s[12:15], s72 offen sc1
    buffer_load_dwordx4 v[72:75], v33, s[12:15], s72 offen sc1
    s_waitcnt vmcnt(0)
    v_bitop3_b32 v12, v71, v75, s76 bitop3:0x7e
    v_cmp_lt_u32 vcc, 0xffff, v12
    s_cbranch_vccnz L_slow7_0
    s_branch L_back7_0
L_slow7_1:
    s_mov_b32 s22, 7
    s_call_b64 s[20:21], L_tick
    buffer_load_dwordx4 v[76:79], v34, s[12:15], s72 offen sc1
    buffer_load_dwordx4 v[80:83], v44, s[12:15], s72 offen sc1
    s_waitcnt vmcnt(0)
    v_bitop3_b32 v12, v79, v83, s76 bitop3:0x7e
    v_cmp_lt_u32 vcc, 0xffff, v12
    s_cbranch_vccnz L_slow7_1
    s_branch L_back7_1
L_tick:
    s_add_u32 s52, s52, 1
    s_and_b32 s23, s52, 4095
    s_cbranch_scc1 L_tick_ret
L_help:
    s_mov_b32 s53, s61
    s_mov_b32 s54, s62
    s_mul_i32 s61, s22, 1835008
    s_add_u32 s61, s61, s79
    s_lshl_b32 s62, s22, 14
    s_add_u32 s62, s62, s68
    s_mov_b32 s22, 0
L_help_row:
    v_mov_b32 v21, v19
    s_xor_b32 s23, s22, s58
    s_bitcmp0_b32 s23, 2
    s_cbranch_scc1 L_help_same
    v_add_u32 v12, 57344, v19
    v_subrev_u32 v13, 57344, v19
    v_min_u32 v21, v12, v13
L_help_same:
    v_mov_b32 v8, 0
    v_mov_b32 v9, 0
    v_mov_b32 v10, 0
    v_mov_b32 v11, s47
    s_mov_b32 s23, 0
L_help_e:
    v_mov_b32 v15, 0
    buffer_load_dwordx3 v[12:14], v18, s[4:7], s61 offen
    s_cmp_ge_u32 s23, 16
    s_cbranch_scc1 L_help_own
    buffer_load_dword v15, v21, s[4:7], s61 offen
L_help_own:
    s_waitcnt vmcnt(0)
    v_lshl_or_b32 v8, v12, s23, v8
    v_lshl_or_b32 v9, v13, s23, v9
    v_lshl_or_b32 v10, v14, s23, v10
    v_lshl_or_b32 v11, v15, s23, v11
    s_add_u32 s61, s61, 14336
    s_add_u32 s23, s23, 4
    s_cmp_lt_u32 s23, 32
    s_cbranch_scc1 L_help_e
    buffer_store_dwordx4 v[8:11], v20, s[12:15], s62 offen sc1
    s_add_u32 s62, s62, 1024
    s_waitcnt vmcnt(0)
    s_add_u32 s22, s22, 1
    s_cmp_lt_u32 s22, 16
    s_cbranch_scc1 L_help_row
    s_mov_b32 s61, s53
    s_mov_b32 s62, s54
L_tick_ret:
    s_setpc_b64 s[20:21]
L_code_end:

.section .rodata,"a"
.p2align 6
.amdhsa_kernel standalone__normalfloat_lut_af4__prompt_kernel
  .amdhsa_next_free_vgpr 512
  .amdhsa_next_free_sgpr 102
  .amdhsa_accum_offset 256
  .amdhsa_group_segment_fixed_size 0
  .amdhsa_kernarg_size 56
  .amdhsa_user_sgpr_count 2
  .amdhsa_user_sgpr_kernarg_segment_ptr 1
  .amdhsa_system_sgpr_workgroup_id_x 1
.end_amdhsa_kernel
```

```asm
; @launch grid=(256,1,1) block=(256,1,1) lds=163840
.amdgcn_target "amdgcn-amd-amdhsa--gfx950"
.text
.globl standalone__normalfloat_lut_af4__prompt_kernel
.p2align 8
.type standalone__normalfloat_lut_af4__prompt_kernel,@function
standalone__normalfloat_lut_af4__prompt_kernel:
    s_cmp_ge_u32 s2, 256
    s_cbranch_scc1 L_end
    s_load_dwordx2 s[4:5], s[0:1], 8
    s_load_dwordx2 s[12:13], s[0:1], 48
    s_load_dwordx2 s[8:9], s[0:1], 0
    s_load_dwordx2 s[28:29], s[0:1], 16
    s_getpc_b64 s[48:49]
    s_mov_b32 s50, L_code_end-standalone__normalfloat_lut_af4__prompt_kernel-256
    s_mov_b32 s51, 0x20000
    s_lshr_b32 s61, s2, 3
    v_lshl_add_u32 v10, v0, 5, s61
    v_lshlrev_b32 v10, 7, v10
    buffer_load_dword v1, v10, s[48:51], 0 offen offset:256
    v_lshrrev_b32 v5, 6, v0
    v_and_b32 v2, 63, v0
    s_and_b32 s60, s2, 7
    v_readfirstlane_b32 s63, v5
    s_and_b32 s58, s60, 1
    s_lshl_b32 s58, s58, 3
    s_and_b32 s62, s61, 7
    s_add_u32 s58, s58, s62
    s_lshr_b32 s59, s60, 1
    s_lshl_b32 s59, s59, 2
    s_lshr_b32 s62, s61, 3
    s_add_u32 s59, s59, s62
    v_mul_u32_u24 v18, 12, v2
    s_lshl_b32 s60, s63, 4
    s_add_u32 s60, s60, s58
    s_mul_i32 s61, s60, 114688
    s_mul_i32 s79, s59, 896
    s_add_u32 s61, s61, s79
    s_mov_b32 s6, 14680064
    s_mov_b32 s7, 0x20000
    s_lshl_b32 s78, s59, 7
    s_add_u32 s78, s78, 2097164
    v_and_b32 v4, 15, v2
    v_lshrrev_b32 v3, 4, v2
    v_and_b32 v12, 1, v3
    v_lshlrev_b32 v13, 1, v12
    v_xor_b32 v13, v13, v4
    v_lshrrev_b32 v19, 1, v3
    v_lshl_add_u32 v19, v19, 4, v13
    s_bfe_u32 s70, s58, 0x10002
    s_xor_b32 s70, s70, 1
    v_xor_b32 v12, s70, v12
    v_mul_u32_u24 v12, 14336, v12
    v_add_lshl_u32 v19, v19, v12, 2
    v_add_u32 v19, 768, v19
    s_mov_b32 s46, 2
    s_cmp_lg_u32 s63, 0
    s_cbranch_scc1 L_role0
    s_mov_b32 s46, 0
L_role0:
    s_cmp_lg_u32 s63, 1
    s_cbranch_scc1 L_role1
    s_mov_b32 s46, 1
L_role1:
    v_lshlrev_b32 v16, 1, v4
    v_lshrrev_b32 v17, 4, v0
    v_lshlrev_b32 v17, 1, v17
    s_mov_b32 s30, 32
    s_mov_b32 s31, 0x20000
    v_lshrrev_b32 v6, 3, v2
    v_and_b32 v7, 7, v2
    v_xor_b32 v13, v7, v3
    s_lshl_b32 s70, s63, 5
    v_add_lshl_u32 v12, v6, s70, 11
    v_lshl_add_u32 v36, v13, 4, v12
    v_xor_b32 v37, 64, v36
    v_add_u32 v37, 15360, v37
    v_add_u32 v38, 30720, v36
    v_add_u32 v39, 30720, v37
    s_mov_b32 s10, 4194304
    s_mov_b32 s11, 0x20000
    s_lshl_b32 s55, s58, 18
    s_and_b32 s71, s58, 8
    s_lshl_b32 s70, s71, 4
    s_add_u32 s55, s55, s70
    s_lshl_b32 s57, s63, 12
    s_xor_b32 s69, s55, 128
    s_add_u32 s57, s57, 65536
    s_mov_b32 s14, 2099200
    s_mov_b32 s15, 0x20000
    s_lshl_b32 s68, s59, 17
    s_lshl_b32 s62, s60, 10
    s_add_u32 s62, s62, s68
    v_lshlrev_b32 v20, 4, v2
    s_waitcnt lgkmcnt(0)
    s_load_dword s76, s[12:13], s78
    s_cmp_eq_u32 s46, 1
    s_cbranch_scc1 L_L
    s_cmp_eq_u32 s46, 2
    s_cbranch_scc1 L_L
L_X:
    buffer_load_dwordx3 v[128:130], v18, s[4:7], s61 offen
    buffer_load_dword v131, v19, s[4:7], s61 offen
    s_add_u32 s61, s61, 14336
    buffer_load_dwordx3 v[132:134], v18, s[4:7], s61 offen
    buffer_load_dword v135, v19, s[4:7], s61 offen
    s_add_u32 s61, s61, 14336
    buffer_load_dwordx3 v[136:138], v18, s[4:7], s61 offen
    buffer_load_dword v139, v19, s[4:7], s61 offen
    s_add_u32 s61, s61, 14336
    buffer_load_dwordx3 v[140:142], v18, s[4:7], s61 offen
    buffer_load_dword v143, v19, s[4:7], s61 offen
    s_add_u32 s61, s61, 14336
    buffer_load_dwordx3 v[144:146], v18, s[4:7], s61 offen
    s_add_u32 s61, s61, 14336
    buffer_load_dwordx3 v[148:150], v18, s[4:7], s61 offen
    s_add_u32 s61, s61, 14336
    buffer_load_dwordx3 v[152:154], v18, s[4:7], s61 offen
    s_add_u32 s61, s61, 14336
    buffer_load_dwordx3 v[156:158], v18, s[4:7], s61 offen
    s_add_u32 s61, s61, 7239680
    s_cmp_eq_u32 s46, 1
    s_cbranch_scc1 L_D
    s_cmp_eq_u32 s46, 2
    s_cbranch_scc1 L_B
L_L:
    buffer_load_ushort v16, v16, s[28:31], 0 offen
    buffer_load_ushort v17, v17, s[28:31], 0 offen
    s_cmp_eq_u32 s46, 1
    s_cbranch_scc1 L_S
    s_cmp_eq_u32 s46, 2
    s_cbranch_scc1 L_S
L_D:
    s_add_u32 m0, s57, 32768
    s_add_u32 s56, s55, 0
    buffer_load_dwordx4 v36, s[8:11], s56 offen offset:0 lds
    buffer_load_dwordx4 v37, s[8:11], s56 offen offset:1024 lds
    buffer_load_dwordx4 v38, s[8:11], s56 offen offset:2048 lds
    buffer_load_dwordx4 v39, s[8:11], s56 offen offset:3072 lds
    s_cmp_eq_u32 s46, 1
    s_cbranch_scc1 L_G
    s_cmp_eq_u32 s46, 2
    s_cbranch_scc1 L_G
L_S:
    s_load_dwordx2 s[32:33], s[0:1], 24
    s_load_dwordx2 s[16:17], s[0:1], 32
    s_load_dwordx2 s[24:25], s[0:1], 40
    s_and_b32 s64, s63, 1
    s_lshr_b32 s65, s63, 1
    s_and_b32 s70, s58, 8
    s_lshl_b32 s70, s70, 10
    s_lshl_b32 s71, s64, 12
    s_add_u32 s70, s70, s71
    s_lshl_b32 s71, s63, 8
    s_add_u32 s70, s70, s71
    s_add_u32 s70, s70, s68
    v_lshl_add_u32 v32, v4, 4, s70
    v_lshl_add_u32 v32, v3, 10, v32
    v_xor_b32 v33, 4096, v32
    v_xor_b32 v34, 8192, v32
    v_xor_b32 v44, 12288, v32
    s_mov_b32 s36, 202114048
    s_mov_b32 s37, 202114304
    s_mov_b32 s38, 202114560
    s_mov_b32 s39, 202114816
    v_and_b32 v35, 31, v2
    v_lshlrev_b32 v35, 2, v35
    s_lshl_b32 s70, s64, 6
    s_add_u32 s70, s70, 65536
    v_lshrrev_b32 v12, 1, v4
    v_xor_b32 v12, v12, v3
    v_lshlrev_b32 v12, 4, v12
    v_lshl_add_u32 v12, v4, 7, v12
    v_xor_b32 v40, s70, v12
    v_xor_b32 v41, 64, v40
    v_add_u32 v42, 65536, v40
    v_add_u32 v43, 65536, v41
    s_mov_b32 s52, 0
    v_lshlrev_b32 v8, 4, v7
    v_lshl_add_u32 v8, v0, 8, v8
    v_xor_b32 v9, 16, v8
    v_xor_b32 v10, 32, v8
    v_xor_b32 v11, 48, v8
    v_xor_b32 v12, 64, v8
    v_xor_b32 v13, 80, v8
    v_xor_b32 v14, 96, v8
    v_xor_b32 v15, 112, v8
    s_cmp_eq_u32 s46, 1
    s_cbranch_scc1 L_X
    s_cmp_eq_u32 s46, 2
    s_cbranch_scc1 L_D
L_G:
    s_waitcnt lgkmcnt(0)
    s_add_u32 s76, s76, 2654435769
    s_and_b32 s47, s76, 0xffff0000
    s_cmp_eq_u32 s46, 1
    s_cbranch_scc1 L_T
    s_cmp_eq_u32 s46, 2
    s_cbranch_scc1 L_T
L_K:
    s_waitcnt vmcnt(16)
    v_or_b32 v131, s47, v131
    s_waitcnt vmcnt(15)
    v_lshl_or_b32 v128, v132, 4, v128
    v_lshl_or_b32 v129, v133, 4, v129
    v_lshl_or_b32 v130, v134, 4, v130
    s_waitcnt vmcnt(14)
    v_lshl_or_b32 v131, v135, 4, v131
    s_waitcnt vmcnt(13)
    v_lshl_or_b32 v128, v136, 8, v128
    v_lshl_or_b32 v129, v137, 8, v129
    v_lshl_or_b32 v130, v138, 8, v130
    s_waitcnt vmcnt(12)
    v_lshl_or_b32 v131, v139, 8, v131
    s_waitcnt vmcnt(11)
    v_lshl_or_b32 v128, v140, 12, v128
    v_lshl_or_b32 v129, v141, 12, v129
    v_lshl_or_b32 v130, v142, 12, v130
    s_waitcnt vmcnt(10)
    v_lshl_or_b32 v131, v143, 12, v131
    s_waitcnt vmcnt(9)
    v_lshl_or_b32 v128, v144, 16, v128
    v_lshl_or_b32 v129, v145, 16, v129
    v_lshl_or_b32 v130, v146, 16, v130
    s_waitcnt vmcnt(8)
    v_lshl_or_b32 v128, v148, 20, v128
    v_lshl_or_b32 v129, v149, 20, v129
    v_lshl_or_b32 v130, v150, 20, v130
    s_waitcnt vmcnt(7)
    v_lshl_or_b32 v128, v152, 24, v128
    v_lshl_or_b32 v129, v153, 24, v129
    v_lshl_or_b32 v130, v154, 24, v130
    s_waitcnt vmcnt(6)
    v_lshl_or_b32 v128, v156, 28, v128
    v_lshl_or_b32 v129, v157, 28, v129
    v_lshl_or_b32 v130, v158, 28, v130
    buffer_store_dwordx4 v[128:131], v20, s[12:15], s62 offen sc1
    s_add_u32 s62, s62, 65536
    s_cmp_eq_u32 s46, 1
    s_cbranch_scc1 L_B
    s_cmp_eq_u32 s46, 2
    s_cbranch_scc1 L_E
L_T:
    s_waitcnt vmcnt(16)
    s_cmp_eq_u32 s46, 1
    s_cbranch_scc1 L_rw1
    s_waitcnt vmcnt(5)
    s_cmp_eq_u32 s46, 0
    s_cbranch_scc1 L_rw1
    s_waitcnt vmcnt(4)
L_rw1:
    v_lshl_or_b32 v56, v17, 16, v16
    v_lshl_or_b32 v57, v17, 16, v16
    v_lshl_or_b32 v58, v17, 16, v16
    v_lshl_or_b32 v59, v17, 16, v16
    ds_write_b128 v8, v[56:59]
    ds_write_b128 v9, v[56:59]
    ds_write_b128 v10, v[56:59]
    ds_write_b128 v11, v[56:59]
    ds_write_b128 v12, v[56:59]
    ds_write_b128 v13, v[56:59]
    ds_write_b128 v14, v[56:59]
    ds_write_b128 v15, v[56:59]
    s_cmp_lg_u32 s46, 1
    s_cbranch_scc1 L_ed2
    s_waitcnt vmcnt(4)
    s_branch L_K
L_ed2:
    s_cmp_eq_u32 s46, 2
    s_cbranch_scc1 L_X
L_W:
    s_mov_b64 exec, 0
    s_cmp_eq_u32 s63, 0
    s_cbranch_scc1 L_pad0
L_warmed:
    s_mov_b64 exec, -1
L_B:
    s_waitcnt vmcnt(12) lgkmcnt(0)
    s_cmp_eq_u32 s46, 2
    s_cbranch_scc1 L_rw3
    s_waitcnt vmcnt(1)
L_rw3:
    s_barrier
L_Q:
    ds_read_b128 a[0:3], v40 offset:32768
    ds_read_b128 a[4:7], v41 offset:32768
    ds_read_b128 a[8:11], v40 offset:34816
    ds_read_b128 a[12:15], v41 offset:34816
    ds_read_b128 a[16:19], v40 offset:36864
    ds_read_b128 a[20:23], v41 offset:36864
    ds_read_b128 a[24:27], v40 offset:38912
    ds_read_b128 a[28:31], v41 offset:38912
    ds_read_b128 a[40:43], v40 offset:40960
    ds_read_b128 a[44:47], v41 offset:40960
    ds_read_b128 a[48:51], v40 offset:43008
    ds_read_b128 a[52:55], v41 offset:43008
    ds_read_b128 a[56:59], v40 offset:45056
    ds_read_b128 a[60:63], v41 offset:45056
    ds_read_b128 a[72:75], v40 offset:47104
    ds_read_b128 a[76:79], v41 offset:47104
L_P:
    buffer_load_dwordx4 v[64:67], v32, s[12:15], 0 offen sc1
    buffer_load_dwordx4 v[68:71], v33, s[12:15], 0 offen sc1
L_d:
    s_add_u32 m0, s57, 49152
    s_add_u32 s3, s69, 0
    buffer_load_dwordx4 v36, s[8:11], s3 offen offset:0 lds
    buffer_load_dwordx4 v37, s[8:11], s3 offen offset:1024 lds
    buffer_load_dwordx4 v38, s[8:11], s3 offen offset:2048 lds
    buffer_load_dwordx4 v39, s[8:11], s3 offen offset:3072 lds
    s_cmp_lg_u32 s46, 2
    s_cbranch_scc1 L_ed4
    s_waitcnt vmcnt(6)
    s_branch L_K
L_ed4:
L_E:
L_chk0:
    s_waitcnt vmcnt(5)
    s_cmp_eq_u32 s46, 2
    s_cbranch_scc1 L_rw5
    s_waitcnt vmcnt(4)
L_rw5:
    v_bitop3_b32 v12, v67, v71, s76 bitop3:0x7e
    v_cmp_lt_u32 vcc, 0xffff, v12
    s_cbranch_vccnz L_retry0
    buffer_load_dwordx4 v[72:75], v34, s[12:15], 0 offen sc1
    buffer_load_dwordx4 v[76:79], v44, s[12:15], 0 offen sc1
    v_perm_b32 v56, v64, v35, s36
    v_perm_b32 v57, v64, v35, s37
    v_perm_b32 v58, v64, v35, s38
    v_perm_b32 v59, v64, v35, s39
    v_perm_b32 v60, v68, v35, s36
    v_perm_b32 v61, v68, v35, s37
    v_perm_b32 v62, v68, v35, s38
    v_perm_b32 v63, v68, v35, s39
    ds_read_b32 a32, v56
    ds_read_b32 a33, v57
    ds_read_b32 a34, v58
    ds_read_b32 a35, v59
    ds_read_b32 a36, v60
    ds_read_b32 a37, v61
    ds_read_b32 a38, v62
    ds_read_b32 a39, v63
    v_perm_b32 v56, v65, v35, s36
    v_perm_b32 v57, v65, v35, s37
    v_perm_b32 v58, v65, v35, s38
    v_perm_b32 v59, v65, v35, s39
    v_perm_b32 v60, v69, v35, s36
    v_perm_b32 v61, v69, v35, s37
    ds_read_b32 a64, v56
    ds_read_b32 a65, v57
    ds_read_b32 a66, v58
    ds_read_b32 a67, v59
    s_cbranch_vccz L_main
L_retry0:
    s_add_u32 s52, s52, 1
    s_and_b32 s23, s52, 4095
    s_cbranch_scc1 L_retry0b
    s_mov_b32 s22, 0
    s_call_b64 s[20:21], L_help
L_retry0b:
    buffer_load_dwordx4 v[64:67], v32, s[12:15], 0 offen sc1
    buffer_load_dwordx4 v[68:71], v33, s[12:15], 0 offen sc1
    s_waitcnt vmcnt(0) lgkmcnt(0)
    s_branch L_chk0
.p2align 12
L_main:
L_pad0:
    s_cbranch_execz L_pad1
    s_waitcnt lgkmcnt(8)
    v_mfma_f32_16x16x32_bf16 v[128:131], a[32:35], a[0:3], 0
    s_waitcnt lgkmcnt(4)
    s_mov_b32 s40, 16384
    ds_read_b32 a68, v60
    v_mfma_f32_16x16x32_bf16 v[128:131], a[36:39], a[4:7], v[128:131]
    buffer_load_dwordx4 v[80:83], v32, s[12:15], s40 offen sc1
    v_mfma_f32_16x16x32_bf16 v[132:135], a[36:39], a[12:15], 0
    s_add_u32 m0, s57, 65536
    ds_read_b32 a69, v61
    v_perm_b32 v62, v69, v35, s38
    v_mfma_f32_16x16x32_bf16 v[132:135], a[32:35], a[8:11], v[132:135]
    s_add_u32 s56, s55, 256
    ds_read_b32 a70, v62
    v_perm_b32 v63, v69, v35, s39
    v_mfma_f32_16x16x32_bf16 v[136:139], a[32:35], a[16:19], 0
    s_add_u32 s3, s69, 256
    ds_read_b32 a71, v63
    v_mfma_f32_16x16x32_bf16 v[136:139], a[36:39], a[20:23], v[136:139]
    buffer_load_dwordx4 v[84:87], v33, s[12:15], s40 offen sc1
    v_mfma_f32_16x16x32_bf16 v[140:143], a[36:39], a[28:31], 0
    v_perm_b32 v56, v66, v35, s36
    v_perm_b32 v57, v66, v35, s37
    v_mfma_f32_16x16x32_bf16 v[140:143], a[32:35], a[24:27], v[140:143]
    ds_read_b32 a80, v56
    v_perm_b32 v58, v66, v35, s38
    v_mfma_f32_16x16x32_bf16 v[144:147], a[32:35], a[40:43], 0
    ds_read_b32 a81, v57
    v_mfma_f32_16x16x32_bf16 v[144:147], a[36:39], a[44:47], v[144:147]
    buffer_load_dwordx4 v36, s[8:11], s56 offen offset:0 lds
    v_mfma_f32_16x16x32_bf16 v[148:151], a[36:39], a[52:55], 0
    ds_read_b32 a82, v58
    v_perm_b32 v59, v66, v35, s39
    v_mfma_f32_16x16x32_bf16 v[148:151], a[32:35], a[48:51], v[148:151]
    v_perm_b32 v60, v70, v35, s36
    v_perm_b32 v61, v70, v35, s37
    v_mfma_f32_16x16x32_bf16 v[152:155], a[32:35], a[56:59], 0
    s_mov_b32 s41, 32768
    ds_read_b32 a83, v59
    ds_read_b32 a84, v60
    v_mfma_f32_16x16x32_bf16 v[152:155], a[36:39], a[60:63], v[152:155]
    buffer_load_dwordx4 v37, s[8:11], s56 offen offset:1024 lds
    v_mfma_f32_16x16x32_bf16 v[156:159], a[36:39], a[76:79], 0
    ds_read_b32 a85, v61
    v_perm_b32 v62, v70, v35, s38
    v_mfma_f32_16x16x32_bf16 v[156:159], a[32:35], a[72:75], v[156:159]
    s_waitcnt lgkmcnt(6)
    ds_read_b32 a86, v62
    v_perm_b32 v63, v70, v35, s39
    v_mfma_f32_16x16x32_bf16 v[160:163], a[64:67], a[0:3], 0
    ds_read_b32 a87, v63
    v_mfma_f32_16x16x32_bf16 v[160:163], a[68:71], a[4:7], v[160:163]
    buffer_load_dwordx4 v38, s[8:11], s56 offen offset:2048 lds
    v_mfma_f32_16x16x32_bf16 v[164:167], a[68:71], a[12:15], 0
    v_perm_b32 v56, v67, v35, s36
    v_perm_b32 v57, v67, v35, s37
    v_mfma_f32_16x16x32_bf16 v[164:167], a[64:67], a[8:11], v[164:167]
    ds_read_b32 a88, v56
    v_perm_b32 v58, v71, v35, s36
    v_mfma_f32_16x16x32_bf16 v[168:171], a[64:67], a[16:19], 0
    ds_read_b32 a89, v57
    v_mfma_f32_16x16x32_bf16 v[168:171], a[68:71], a[20:23], v[168:171]
    buffer_load_dwordx4 v39, s[8:11], s56 offen offset:3072 lds
    v_mfma_f32_16x16x32_bf16 v[172:175], a[68:71], a[28:31], 0
    s_add_u32 m0, s57, 81920
    ds_read_b32 a90, v58
    v_perm_b32 v59, v71, v35, s37
    v_mfma_f32_16x16x32_bf16 v[172:175], a[64:67], a[24:27], v[172:175]
    s_add_u32 s56, s55, 512
    ds_read_b32 a91, v59
    v_mfma_f32_16x16x32_bf16 v[176:179], a[64:67], a[40:43], 0
    s_waitcnt vmcnt(6)
    s_mov_b32 s42, 49152
    v_bitop3_b32 v60, v75, v79, s76 bitop3:0x7e
    v_mfma_f32_16x16x32_bf16 v[176:179], a[68:71], a[44:47], v[176:179]
    buffer_load_dwordx4 v[88:91], v34, s[12:15], s40 offen sc1
    v_mfma_f32_16x16x32_bf16 v[180:183], a[68:71], a[52:55], 0
    v_cmp_lt_u32 vcc, 0xffff, v60
    v_mfma_f32_16x16x32_bf16 v[180:183], a[64:67], a[48:51], v[180:183]
    v_mfma_f32_16x16x32_bf16 v[184:187], a[64:67], a[56:59], 0
    s_cbranch_vccnz L_slow0_1
L_back0_1:
    v_mfma_f32_16x16x32_bf16 v[184:187], a[68:71], a[60:63], v[184:187]
    buffer_load_dwordx4 v[92:95], v44, s[12:15], s40 offen sc1
    v_mfma_f32_16x16x32_bf16 v[188:191], a[68:71], a[76:79], 0
    v_perm_b32 v61, v72, v35, s36
    v_perm_b32 v62, v72, v35, s37
    v_mfma_f32_16x16x32_bf16 v[188:191], a[64:67], a[72:75], v[188:191]
    s_waitcnt lgkmcnt(1)
    ds_read_b32 a96, v61
    v_perm_b32 v63, v72, v35, s38
    v_mfma_f32_16x16x32_bf16 v[192:195], a[80:83], a[0:3], 0
    s_barrier
    v_mfma_f32_16x16x32_bf16 v[192:195], a[84:87], a[4:7], v[192:195]
    buffer_load_dwordx4 v36, s[8:11], s3 offen offset:0 lds
    v_mfma_f32_16x16x32_bf16 v[196:199], a[84:87], a[12:15], 0
    ds_read_b32 a97, v62
    ds_read_b32 a98, v63
    v_mfma_f32_16x16x32_bf16 v[196:199], a[80:83], a[8:11], v[196:199]
    ds_read_b128 a[104:107], v40 offset:49152
    v_perm_b32 v56, v72, v35, s39
    v_mfma_f32_16x16x32_bf16 v[200:203], a[80:83], a[16:19], 0
    s_mov_b32 s43, 65536
    ds_read_b32 a99, v56
    ds_read_b128 a[108:111], v41 offset:49152
    v_mfma_f32_16x16x32_bf16 v[200:203], a[84:87], a[20:23], v[200:203]
    buffer_load_dwordx4 v37, s[8:11], s3 offen offset:1024 lds
    v_mfma_f32_16x16x32_bf16 v[204:207], a[84:87], a[28:31], 0
    ds_read_b128 a[112:115], v40 offset:51200
    v_perm_b32 v57, v76, v35, s36
    v_mfma_f32_16x16x32_bf16 v[204:207], a[80:83], a[24:27], v[204:207]
    ds_read_b32 a100, v57
    v_perm_b32 v58, v76, v35, s37
    v_mfma_f32_16x16x32_bf16 v[208:211], a[80:83], a[40:43], 0
    ds_read_b32 a101, v58
    ds_read_b128 a[116:119], v41 offset:51200
    v_mfma_f32_16x16x32_bf16 v[208:211], a[84:87], a[44:47], v[208:211]
    buffer_load_dwordx4 v38, s[8:11], s3 offen offset:2048 lds
    v_mfma_f32_16x16x32_bf16 v[212:215], a[84:87], a[52:55], 0
    ds_read_b128 a[120:123], v40 offset:53248
    v_perm_b32 v59, v76, v35, s38
    v_mfma_f32_16x16x32_bf16 v[212:215], a[80:83], a[48:51], v[212:215]
    ds_read_b32 a102, v59
    v_perm_b32 v60, v76, v35, s39
    v_mfma_f32_16x16x32_bf16 v[216:219], a[80:83], a[56:59], 0
    ds_read_b32 a103, v60
    ds_read_b128 a[124:127], v41 offset:53248
    v_mfma_f32_16x16x32_bf16 v[216:219], a[84:87], a[60:63], v[216:219]
    ds_read_b128 a[128:131], v40 offset:55296
    v_perm_b32 v61, v73, v35, s36
    v_mfma_f32_16x16x32_bf16 v[220:223], a[84:87], a[76:79], 0
    ds_read_b32 a136, v61
    v_perm_b32 v62, v73, v35, s37
    v_mfma_f32_16x16x32_bf16 v[220:223], a[80:83], a[72:75], v[220:223]
    s_waitcnt lgkmcnt(9)
    ds_read_b32 a137, v62
    ds_read_b128 a[132:135], v41 offset:55296
    v_mfma_f32_16x16x32_bf16 v[224:227], a[88:91], a[2:5], 0
    buffer_load_dwordx4 v39, s[8:11], s3 offen offset:3072 lds
    v_mfma_f32_16x16x32_bf16 v[228:231], a[88:91], a[10:13], 0
    s_add_u32 m0, s57, 0
    ds_read_b128 a[144:147], v40 offset:57344
    v_perm_b32 v63, v73, v35, s38
    v_mfma_f32_16x16x32_bf16 v[232:235], a[88:91], a[18:21], 0
    s_add_u32 s3, s69, 512
    ds_read_b32 a138, v63
    v_perm_b32 v56, v73, v35, s39
    v_mfma_f32_16x16x32_bf16 v[236:239], a[88:91], a[26:29], 0
    s_mov_b32 s44, 81920
    ds_read_b32 a139, v56
    v_perm_b32 v57, v77, v35, s36
    v_mfma_f32_16x16x32_bf16 v[240:243], a[88:91], a[42:45], 0
    ds_read_b32 a140, v57
    ds_read_b128 a[148:151], v41 offset:57344
    v_mfma_f32_16x16x32_bf16 v[244:247], a[88:91], a[50:53], 0
    buffer_load_dwordx3 v[96:98], v18, s[4:7], s61 offen
    v_mfma_f32_16x16x32_bf16 v[248:251], a[88:91], a[58:61], 0
    ds_read_b128 a[152:155], v40 offset:59392
    v_perm_b32 v58, v77, v35, s37
    v_mfma_f32_16x16x32_bf16 v[252:255], a[88:91], a[74:77], 0
    ds_read_b128 a[156:159], v41 offset:59392
    v_perm_b32 v59, v77, v35, s38
    v_mfma_f32_16x16x32_bf16 v[128:131], a[96:99], a[104:107], v[128:131]
    s_waitcnt lgkmcnt(7)
    ds_read_b32 a141, v58
    ds_read_b32 a142, v59
    v_mfma_f32_16x16x32_bf16 v[128:131], a[100:103], a[108:111], v[128:131]
    buffer_load_dword v99, v19, s[4:7], s61 offen
    v_mfma_f32_16x16x32_bf16 v[132:135], a[100:103], a[116:119], v[132:135]
    s_add_u32 s61, s61, 14336
    ds_read_b128 a[160:163], v40 offset:61440
    v_perm_b32 v60, v77, v35, s39
    v_mfma_f32_16x16x32_bf16 v[132:135], a[96:99], a[112:115], v[132:135]
    s_waitcnt vmcnt(12)
    v_bitop3_b32 v61, v83, v87, s76 bitop3:0x7e
    v_perm_b32 v62, v74, v35, s36
    v_mfma_f32_16x16x32_bf16 v[136:139], a[96:99], a[120:123], v[136:139]
    s_mov_b32 s45, 98304
    ds_read_b128 a[164:167], v41 offset:61440
    ds_read_b32 a143, v60
    v_mfma_f32_16x16x32_bf16 v[136:139], a[100:103], a[124:127], v[136:139]
    buffer_load_dwordx3 v[100:102], v18, s[4:7], s61 offen
    v_mfma_f32_16x16x32_bf16 v[140:143], a[100:103], a[132:135], v[140:143]
    ds_read_b128 a[168:171], v40 offset:63488
    ds_read_b32 a176, v62
    v_mfma_f32_16x16x32_bf16 v[140:143], a[96:99], a[128:131], v[140:143]
    s_waitcnt lgkmcnt(8)
    ds_read_b128 a[172:175], v41 offset:63488
    v_cmp_lt_u32 vcc, 0xffff, v61
    v_mfma_f32_16x16x32_bf16 v[144:147], a[96:99], a[144:147], v[144:147]
    s_waitcnt lgkmcnt(8)
    v_perm_b32 v63, v74, v35, s37
    v_mfma_f32_16x16x32_bf16 v[144:147], a[100:103], a[148:151], v[144:147]
    buffer_load_dword v103, v19, s[4:7], s61 offen
    v_mfma_f32_16x16x32_bf16 v[148:151], a[100:103], a[156:159], v[148:151]
    s_add_u32 s61, s61, 14336
    ds_read_b32 a177, v63
    v_perm_b32 v56, v74, v35, s38
    v_mfma_f32_16x16x32_bf16 v[148:151], a[96:99], a[152:155], v[148:151]
    s_waitcnt lgkmcnt(6)
    v_perm_b32 v57, v74, v35, s39
    s_cbranch_vccnz L_slow1_0
L_back1_0:
    v_mfma_f32_16x16x32_bf16 v[152:155], a[96:99], a[160:163], v[152:155]
    s_waitcnt lgkmcnt(5)
    ds_read_b32 a178, v56
    ds_read_b32 a179, v57
    v_mfma_f32_16x16x32_bf16 v[152:155], a[100:103], a[164:167], v[152:155]
    s_waitcnt lgkmcnt(3)
    buffer_load_dwordx3 v[104:106], v18, s[4:7], s61 offen
    v_mfma_f32_16x16x32_bf16 v[156:159], a[100:103], a[172:175], v[156:159]
    v_perm_b32 v58, v78, v35, s36
    v_perm_b32 v59, v78, v35, s37
    v_mfma_f32_16x16x32_bf16 v[156:159], a[96:99], a[168:171], v[156:159]
    ds_read_b32 a180, v58
    ds_read_b32 a181, v59
    v_perm_b32 v60, v78, v35, s38
    v_mfma_f32_16x16x32_bf16 v[160:163], a[136:139], a[104:107], v[160:163]
    s_mov_b32 s72, 114688
    ds_read_b32 a182, v60
    v_mfma_f32_16x16x32_bf16 v[160:163], a[140:143], a[108:111], v[160:163]
    buffer_load_dword v107, v19, s[4:7], s61 offen
    v_mfma_f32_16x16x32_bf16 v[164:167], a[140:143], a[116:119], v[164:167]
    s_add_u32 s61, s61, 14336
    v_perm_b32 v62, v78, v35, s39
    v_perm_b32 v61, v75, v35, s36
    v_mfma_f32_16x16x32_bf16 v[164:167], a[136:139], a[112:115], v[164:167]
    ds_read_b32 a183, v62
    v_perm_b32 v63, v75, v35, s37
    v_mfma_f32_16x16x32_bf16 v[168:171], a[136:139], a[120:123], v[168:171]
    ds_read_b32 a92, v61
    ds_read_b32 a93, v63
    v_mfma_f32_16x16x32_bf16 v[168:171], a[140:143], a[124:127], v[168:171]
    buffer_load_dwordx3 v[108:110], v18, s[4:7], s61 offen
    v_mfma_f32_16x16x32_bf16 v[172:175], a[140:143], a[132:135], v[172:175]
    v_perm_b32 v56, v79, v35, s36
    v_perm_b32 v57, v79, v35, s37
    v_mfma_f32_16x16x32_bf16 v[172:175], a[136:139], a[128:131], v[172:175]
    ds_read_b32 a94, v56
    v_perm_b32 v58, v80, v35, s36
    v_mfma_f32_16x16x32_bf16 v[176:179], a[136:139], a[144:147], v[176:179]
    ds_read_b32 a95, v57
    ds_read_b32 a184, v58
    v_mfma_f32_16x16x32_bf16 v[176:179], a[140:143], a[148:151], v[176:179]
    buffer_load_dword v111, v19, s[4:7], s61 offen
    v_mfma_f32_16x16x32_bf16 v[180:183], a[140:143], a[156:159], v[180:183]
    s_add_u32 s61, s61, 14336
    v_perm_b32 v59, v80, v35, s37
    v_perm_b32 v60, v80, v35, s38
    v_mfma_f32_16x16x32_bf16 v[180:183], a[136:139], a[152:155], v[180:183]
    ds_read_b32 a185, v59
    v_perm_b32 v62, v80, v35, s39
    v_mfma_f32_16x16x32_bf16 v[184:187], a[136:139], a[160:163], v[184:187]
    ds_read_b32 a186, v60
    ds_read_b32 a187, v62
    v_mfma_f32_16x16x32_bf16 v[184:187], a[140:143], a[164:167], v[184:187]
    buffer_load_dwordx3 v[112:114], v18, s[4:7], s61 offen
    v_mfma_f32_16x16x32_bf16 v[188:191], a[140:143], a[172:175], v[188:191]
    s_add_u32 s61, s61, 14336
    v_perm_b32 v61, v84, v35, s36
    v_perm_b32 v63, v84, v35, s37
    v_mfma_f32_16x16x32_bf16 v[188:191], a[136:139], a[168:171], v[188:191]
    s_waitcnt vmcnt(15) lgkmcnt(6)
    ds_read_b32 a188, v61
    v_perm_b32 v56, v84, v35, s38
    v_mfma_f32_16x16x32_bf16 v[192:195], a[176:179], a[104:107], v[192:195]
    s_barrier
    v_mfma_f32_16x16x32_bf16 v[192:195], a[180:183], a[108:111], v[192:195]
    buffer_load_dwordx3 v[116:118], v18, s[4:7], s61 offen
    v_mfma_f32_16x16x32_bf16 v[196:199], a[180:183], a[116:119], v[196:199]
    s_add_u32 s61, s61, 14336
    ds_read_b32 a189, v63
    ds_read_b128 a[192:195], v42 offset:0
    v_mfma_f32_16x16x32_bf16 v[196:199], a[176:179], a[112:115], v[196:199]
    ds_read_b32 a190, v56
    ds_read_b128 a[196:199], v43 offset:0
    v_mfma_f32_16x16x32_bf16 v[200:203], a[176:179], a[120:123], v[200:203]
    ds_read_b128 a[204:207], v43 offset:2048
    v_perm_b32 v57, v84, v35, s39
    v_mfma_f32_16x16x32_bf16 v[200:203], a[180:183], a[124:127], v[200:203]
    ds_read_b32 a191, v57
    ds_read_b128 a[200:203], v42 offset:2048
    v_mfma_f32_16x16x32_bf16 v[204:207], a[180:183], a[132:135], v[204:207]
    buffer_load_dwordx3 v[120:122], v18, s[4:7], s61 offen
    v_mfma_f32_16x16x32_bf16 v[204:207], a[176:179], a[128:131], v[204:207]
    s_add_u32 s61, s61, 14336
    ds_read_b128 a[208:211], v42 offset:4096
    v_perm_b32 v58, v81, v35, s36
    v_mfma_f32_16x16x32_bf16 v[208:211], a[176:179], a[144:147], v[208:211]
    ds_read_b128 a[212:215], v43 offset:4096
    ds_read_b32 a216, v58
    v_mfma_f32_16x16x32_bf16 v[208:211], a[180:183], a[148:151], v[208:211]
    s_waitcnt vmcnt(15)
    ds_read_b128 a[228:231], v43 offset:6144
    v_bitop3_b32 v59, v91, v95, s76 bitop3:0x7e
    v_mfma_f32_16x16x32_bf16 v[212:215], a[180:183], a[156:159], v[212:215]
    ds_read_b128 a[224:227], v42 offset:6144
    v_mfma_f32_16x16x32_bf16 v[212:215], a[176:179], a[152:155], v[212:215]
    buffer_load_dwordx3 v[124:126], v18, s[4:7], s61 offen
    v_mfma_f32_16x16x32_bf16 v[216:219], a[176:179], a[160:163], v[216:219]
    ds_read_b128 a[232:235], v42 offset:8192
    v_cmp_lt_u32 vcc, 0xffff, v59
    v_mfma_f32_16x16x32_bf16 v[216:219], a[180:183], a[164:167], v[216:219]
    ds_read_b128 a[236:239], v43 offset:8192
    v_perm_b32 v60, v81, v35, s37
    v_mfma_f32_16x16x32_bf16 v[220:223], a[180:183], a[172:175], v[220:223]
    ds_read_b128 a[240:243], v42 offset:10240
    ds_read_b32 a217, v60
    v_mfma_f32_16x16x32_bf16 v[220:223], a[176:179], a[168:171], v[220:223]
    s_waitcnt lgkmcnt(9)
    ds_read_b128 a[244:247], v43 offset:10240
    s_cbranch_vccnz L_slow1_1
L_back1_1:
    v_mfma_f32_16x16x32_bf16 v[224:227], a[92:95], a[106:109], v[224:227]
    buffer_load_dwordx4 v[48:51], v32, s[12:15], s41 offen sc1
    v_mfma_f32_16x16x32_bf16 v[228:231], a[92:95], a[114:117], v[228:231]
    ds_read_b128 a[248:251], v42 offset:12288
    v_perm_b32 v62, v81, v35, s38
    v_mfma_f32_16x16x32_bf16 v[232:235], a[92:95], a[122:125], v[232:235]
    ds_read_b32 a218, v62
    ds_read_b128 a[252:255], v43 offset:12288
    v_mfma_f32_16x16x32_bf16 v[236:239], a[92:95], a[130:133], v[236:239]
    v_perm_b32 v61, v81, v35, s39
    v_perm_b32 v63, v85, v35, s36
    v_mfma_f32_16x16x32_bf16 v[240:243], a[92:95], a[146:149], v[240:243]
    ds_read_b32 a219, v61
    ds_read_b32 a220, v63
    v_mfma_f32_16x16x32_bf16 v[244:247], a[92:95], a[154:157], v[244:247]
    buffer_load_dwordx4 v[52:55], v33, s[12:15], s41 offen sc1
    v_mfma_f32_16x16x32_bf16 v[248:251], a[92:95], a[162:165], v[248:251]
    ds_read_b128 a[32:35], v42 offset:14336
    v_perm_b32 v56, v85, v35, s37
    v_mfma_f32_16x16x32_bf16 v[252:255], a[92:95], a[170:173], v[252:255]
    ds_read_b32 a221, v56
    ds_read_b128 a[36:39], v43 offset:14336
    v_mfma_f32_16x16x32_bf16 v[128:131], a[184:187], a[192:195], v[128:131]
    v_perm_b32 v57, v85, v35, s38
    v_perm_b32 v58, v85, v35, s39
    v_mfma_f32_16x16x32_bf16 v[128:131], a[188:191], a[196:199], v[128:131]
    ds_read_b32 a222, v57
    ds_read_b32 a223, v58
    v_mfma_f32_16x16x32_bf16 v[132:135], a[188:191], a[204:207], v[132:135]
    v_perm_b32 v59, v82, v35, s36
    v_perm_b32 v60, v82, v35, s37
    v_mfma_f32_16x16x32_bf16 v[132:135], a[184:187], a[200:203], v[132:135]
    s_mul_i32 s66, s63, 96
    s_lshl_b32 s67, s65, 5
    s_lshl_b32 s70, s64, 2
    s_add_u32 s67, s67, s70
    s_add_u32 s67, s67, 384
    s_mul_i32 s71, s59, 448
    s_add_u32 s70, s66, s71
    v_mad_u32_u24 v22, v3, 24, s70
    s_add_u32 s70, s67, s71
    v_lshl_add_u32 v23, v3, 3, s70
    s_mov_b32 s34, 7168
    s_mov_b32 s35, 0x20000
    s_mov_b32 s26, 256
    s_mov_b32 s27, 0x20000
    s_lshl_b32 s77, s59, 4
    s_mov_b32 s18, 14680064
    s_mov_b32 s19, 0x20000
    s_sub_u32 s70, 1024, s71
    v_mul_u32_u24 v16, 464, v4
    v_add3_u32 v26, v22, v16, s70
    v_add3_u32 v28, v23, v16, s70
    v_lshlrev_b32 v29, 3, v0
    v_xor_b32 v30, 512, v29
    v_add_u32 v29, 52992, v29
    v_add_u32 v30, 52992, v30
    v_mul_u32_u24 v16, 2341, v2
    v_lshrrev_b32 v16, 16, v16
    s_mul_i32 s73, s63, 1856
    s_add_u32 s73, s73, 1024
    v_add_lshl_u32 v24, v2, v16, 4
    v_add_u32 v24, s73, v24
    s_lshl_b32 s74, s58, 7
    s_lshl_b32 s75, s63, 2
    s_add_u32 s74, s74, s75
    s_mul_i32 s74, s74, 7168
    s_add_u32 s74, s74, s71
    v_mul_u32_u24 v17, 6720, v16
    v_lshl_add_u32 v25, v2, 4, v17
    v_lshrrev_b32 v16, 1, v16
    v_lshlrev_b32 v16, 30, v16
    v_add3_u32 v25, v25, v16, s74
    s_waitcnt lgkmcnt(7)
    v_mfma_f32_16x16x32_bf16 v[136:139], a[184:187], a[208:211], v[136:139]
    buffer_load_dwordx4 v36, s[8:11], s56 offen offset:0 lds
    v_mfma_f32_16x16x32_bf16 v[136:139], a[188:191], a[212:215], v[136:139]
    ds_read_b32 a64, v59
    ds_read_b32 a65, v60
    v_mfma_f32_16x16x32_bf16 v[140:143], a[188:191], a[228:231], v[140:143]
    v_perm_b32 v62, v82, v35, s38
    v_perm_b32 v61, v82, v35, s39
    v_mfma_f32_16x16x32_bf16 v[140:143], a[184:187], a[224:227], v[140:143]
    ds_read_b32 a66, v62
    ds_read_b32 a67, v61
    v_mfma_f32_16x16x32_bf16 v[144:147], a[184:187], a[232:235], v[144:147]
    buffer_load_dwordx4 v37, s[8:11], s56 offen offset:1024 lds
    v_mfma_f32_16x16x32_bf16 v[144:147], a[188:191], a[236:239], v[144:147]
    v_perm_b32 v63, v86, v35, s36
    v_perm_b32 v56, v86, v35, s37
    v_mfma_f32_16x16x32_bf16 v[148:151], a[188:191], a[244:247], v[148:151]
    ds_read_b32 a68, v63
    ds_read_b32 a69, v56
    v_perm_b32 v57, v86, v35, s38
    v_mfma_f32_16x16x32_bf16 v[148:151], a[184:187], a[240:243], v[148:151]
    ds_read_b32 a70, v57
    v_mfma_f32_16x16x32_bf16 v[152:155], a[184:187], a[248:251], v[152:155]
    buffer_load_dwordx4 v38, s[8:11], s56 offen offset:2048 lds
    v_mfma_f32_16x16x32_bf16 v[152:155], a[188:191], a[252:255], v[152:155]
    s_waitcnt lgkmcnt(7)
    v_perm_b32 v58, v86, v35, s39
    v_perm_b32 v59, v83, v35, s36
    v_mfma_f32_16x16x32_bf16 v[156:159], a[188:191], a[36:39], v[156:159]
    ds_read_b32 a71, v58
    ds_read_b32 a80, v59
    v_perm_b32 v60, v83, v35, s37
    v_mfma_f32_16x16x32_bf16 v[156:159], a[184:187], a[32:35], v[156:159]
    ds_read_b32 a81, v60
    v_mfma_f32_16x16x32_bf16 v[160:163], a[216:219], a[192:195], v[160:163]
    buffer_load_dwordx4 v39, s[8:11], s56 offen offset:3072 lds
    v_mfma_f32_16x16x32_bf16 v[160:163], a[220:223], a[196:199], v[160:163]
    s_add_u32 m0, s57, 16384
    v_perm_b32 v62, v87, v35, s36
    v_perm_b32 v61, v87, v35, s37
    v_mfma_f32_16x16x32_bf16 v[164:167], a[220:223], a[204:207], v[164:167]
    s_add_u32 s56, s55, 768
    ds_read_b32 a82, v62
    v_perm_b32 v63, v88, v35, s36
    v_mfma_f32_16x16x32_bf16 v[164:167], a[216:219], a[200:203], v[164:167]
    ds_read_b32 a83, v61
    ds_read_b32 a0, v63
    v_mfma_f32_16x16x32_bf16 v[168:171], a[216:219], a[208:211], v[168:171]
    buffer_load_dwordx4 v[64:67], v34, s[12:15], s41 offen sc1
    v_mfma_f32_16x16x32_bf16 v[168:171], a[220:223], a[212:215], v[168:171]
    v_perm_b32 v56, v88, v35, s37
    v_perm_b32 v57, v88, v35, s38
    v_mfma_f32_16x16x32_bf16 v[172:175], a[220:223], a[228:231], v[172:175]
    ds_read_b32 a1, v56
    ds_read_b32 a2, v57
    v_perm_b32 v58, v88, v35, s39
    v_mfma_f32_16x16x32_bf16 v[172:175], a[216:219], a[224:227], v[172:175]
    ds_read_b32 a3, v58
    v_mfma_f32_16x16x32_bf16 v[176:179], a[216:219], a[232:235], v[176:179]
    buffer_load_dwordx4 v[68:71], v44, s[12:15], s41 offen sc1
    v_mfma_f32_16x16x32_bf16 v[176:179], a[220:223], a[236:239], v[176:179]
    v_perm_b32 v59, v92, v35, s36
    v_perm_b32 v60, v92, v35, s37
    v_mfma_f32_16x16x32_bf16 v[180:183], a[220:223], a[244:247], v[180:183]
    ds_read_b32 a4, v59
    ds_read_b32 a5, v60
    v_perm_b32 v62, v92, v35, s38
    v_mfma_f32_16x16x32_bf16 v[180:183], a[216:219], a[240:243], v[180:183]
    ds_read_b32 a6, v62
    v_mfma_f32_16x16x32_bf16 v[184:187], a[216:219], a[248:251], v[184:187]
    buffer_load_dwordx4 v[72:75], v32, s[12:15], s42 offen sc1
    v_mfma_f32_16x16x32_bf16 v[184:187], a[220:223], a[252:255], v[184:187]
    v_perm_b32 v61, v92, v35, s39
    v_perm_b32 v63, v89, v35, s36
    v_mfma_f32_16x16x32_bf16 v[188:191], a[220:223], a[36:39], v[188:191]
    ds_read_b32 a7, v61
    ds_read_b32 a8, v63
    v_perm_b32 v56, v89, v35, s37
    v_mfma_f32_16x16x32_bf16 v[188:191], a[216:219], a[32:35], v[188:191]
    s_waitcnt vmcnt(21) lgkmcnt(6)
    ds_read_b32 a9, v56
    v_mfma_f32_16x16x32_bf16 v[192:195], a[64:67], a[192:195], v[192:195]
    buffer_load_dwordx4 v[76:79], v33, s[12:15], s42 offen sc1
    v_mfma_f32_16x16x32_bf16 v[192:195], a[68:71], a[196:199], v[192:195]
    s_barrier
    v_mfma_f32_16x16x32_bf16 v[196:199], a[68:71], a[204:207], v[196:199]
    ds_read_b128 a[16:19], v42 offset:16384
    v_perm_b32 v57, v89, v35, s38
    v_mfma_f32_16x16x32_bf16 v[196:199], a[64:67], a[200:203], v[196:199]
    ds_read_b32 a10, v57
    ds_read_b128 a[20:23], v43 offset:16384
    v_mfma_f32_16x16x32_bf16 v[200:203], a[64:67], a[208:211], v[200:203]
    v_perm_b32 v58, v89, v35, s39
    v_perm_b32 v59, v93, v35, s36
    v_mfma_f32_16x16x32_bf16 v[200:203], a[68:71], a[212:215], v[200:203]
    ds_read_b32 a11, v58
    ds_read_b32 a12, v59
    v_mfma_f32_16x16x32_bf16 v[204:207], a[68:71], a[228:231], v[204:207]
    ds_read_b128 a[24:27], v42 offset:18432
    v_perm_b32 v60, v93, v35, s37
    v_mfma_f32_16x16x32_bf16 v[204:207], a[64:67], a[224:227], v[204:207]
    ds_read_b32 a13, v60
    ds_read_b128 a[28:31], v43 offset:18432
    v_mfma_f32_16x16x32_bf16 v[208:211], a[64:67], a[232:235], v[208:211]
    buffer_load_dwordx4 v36, s[8:11], s3 offen offset:0 lds
    v_mfma_f32_16x16x32_bf16 v[208:211], a[68:71], a[236:239], v[208:211]
    ds_read_b128 a[40:43], v42 offset:20480
    v_perm_b32 v62, v93, v35, s38
    v_mfma_f32_16x16x32_bf16 v[212:215], a[68:71], a[244:247], v[212:215]
    ds_read_b32 a14, v62
    v_perm_b32 v61, v93, v35, s39
    v_mfma_f32_16x16x32_bf16 v[212:215], a[64:67], a[240:243], v[212:215]
    ds_read_b32 a15, v61
    ds_read_b128 a[44:47], v43 offset:20480
    v_mfma_f32_16x16x32_bf16 v[216:219], a[64:67], a[248:251], v[216:219]
    v_perm_b32 v63, v90, v35, s36
    v_perm_b32 v56, v90, v35, s37
    v_mfma_f32_16x16x32_bf16 v[216:219], a[68:71], a[252:255], v[216:219]
    ds_read_b32 a48, v63
    ds_read_b32 a49, v56
    v_perm_b32 v57, v90, v35, s38
    v_mfma_f32_16x16x32_bf16 v[220:223], a[68:71], a[36:39], v[220:223]
    s_waitcnt vmcnt(19)
    ds_read_b32 a50, v57
    ds_read_b128 a[56:59], v42 offset:22528
    v_mfma_f32_16x16x32_bf16 v[220:223], a[64:67], a[32:35], v[220:223]
    buffer_load_dwordx4 v37, s[8:11], s3 offen offset:1024 lds
    v_mfma_f32_16x16x32_bf16 v[224:227], a[80:83], a[194:197], v[224:227]
    v_or_b32 v99, s47, v99
    v_lshl_or_b32 v96, v100, 4, v96
    v_lshl_or_b32 v97, v101, 4, v97
    v_lshl_or_b32 v98, v102, 4, v98
    v_lshl_or_b32 v99, v103, 4, v99
    s_waitcnt vmcnt(19)
    v_lshl_or_b32 v96, v104, 8, v96
    v_lshl_or_b32 v97, v105, 8, v97
    v_lshl_or_b32 v98, v106, 8, v98
    s_waitcnt vmcnt(18)
    v_lshl_or_b32 v99, v107, 8, v99
    s_waitcnt vmcnt(17)
    v_lshl_or_b32 v96, v108, 12, v96
    v_lshl_or_b32 v97, v109, 12, v97
    v_lshl_or_b32 v98, v110, 12, v98
    s_waitcnt vmcnt(16)
    v_lshl_or_b32 v99, v111, 12, v99
    s_waitcnt vmcnt(15)
    v_lshl_or_b32 v96, v112, 16, v96
    v_lshl_or_b32 v97, v113, 16, v97
    v_lshl_or_b32 v98, v114, 16, v98
    s_waitcnt vmcnt(14)
    v_lshl_or_b32 v96, v116, 20, v96
    v_lshl_or_b32 v97, v117, 20, v97
L_pad1:
    s_cbranch_execz L_pad2
    v_lshl_or_b32 v98, v118, 20, v98
    s_waitcnt vmcnt(13)
    v_lshl_or_b32 v96, v120, 24, v96
    v_lshl_or_b32 v97, v121, 24, v97
    v_lshl_or_b32 v98, v122, 24, v98
    s_waitcnt vmcnt(12)
    v_lshl_or_b32 v96, v124, 28, v96
    v_lshl_or_b32 v97, v125, 28, v97
    v_lshl_or_b32 v98, v126, 28, v98
    buffer_store_dwordx4 v[96:99], v20, s[12:15], s62 offen sc1
    v_mfma_f32_16x16x32_bf16 v[228:231], a[80:83], a[202:205], v[228:231]
    ds_read_b128 a[60:63], v43 offset:22528
    v_perm_b32 v58, v90, v35, s39
    v_mfma_f32_16x16x32_bf16 v[232:235], a[80:83], a[210:213], v[232:235]
    ds_read_b32 a51, v58
    ds_read_b128 a[72:75], v42 offset:24576
    v_mfma_f32_16x16x32_bf16 v[236:239], a[80:83], a[226:229], v[236:239]
    buffer_load_dwordx4 v38, s[8:11], s3 offen offset:2048 lds
    v_mfma_f32_16x16x32_bf16 v[240:243], a[80:83], a[234:237], v[240:243]
    s_waitcnt vmcnt(12)
    ds_read_b128 a[76:79], v43 offset:24576
    v_perm_b32 v59, v94, v35, s36
    v_mfma_f32_16x16x32_bf16 v[244:247], a[80:83], a[242:245], v[244:247]
    ds_read_b32 a52, v59
    v_bitop3_b32 v60, v51, v55, s76 bitop3:0x7e
    v_perm_b32 v62, v94, v35, s37
    v_mfma_f32_16x16x32_bf16 v[248:251], a[80:83], a[250:253], v[248:251]
    s_waitcnt lgkmcnt(7)
    ds_read_b32 a53, v62
    ds_read_b128 a[96:99], v42 offset:26624
    v_mfma_f32_16x16x32_bf16 v[252:255], a[80:83], a[34:37], v[252:255]
    buffer_load_dwordx4 v39, s[8:11], s3 offen offset:3072 lds
    v_mfma_f32_16x16x32_bf16 v[128:131], a[0:3], a[16:19], v[128:131]
    s_add_u32 m0, s57, 32768
    ds_read_b128 a[100:103], v43 offset:26624
    v_cmp_lt_u32 vcc, 0xffff, v60
    v_mfma_f32_16x16x32_bf16 v[128:131], a[4:7], a[20:23], v[128:131]
    s_add_u32 s3, s69, 768
    ds_read_b128 a[136:139], v42 offset:28672
    v_perm_b32 v61, v94, v35, s38
    v_mfma_f32_16x16x32_bf16 v[132:135], a[4:7], a[28:31], v[132:135]
    v_perm_b32 v63, v94, v35, s39
    s_cbranch_vccnz L_slow2_0
L_back2_0:
    v_mfma_f32_16x16x32_bf16 v[132:135], a[0:3], a[24:27], v[132:135]
    ds_read_b128 a[140:143], v43 offset:28672
    ds_read_b32 a54, v61
    v_mfma_f32_16x16x32_bf16 v[136:139], a[0:3], a[40:43], v[136:139]
    buffer_load_dwordx4 v36, s[8:11], s56 offen offset:0 lds
    v_mfma_f32_16x16x32_bf16 v[136:139], a[4:7], a[44:47], v[136:139]
    s_waitcnt lgkmcnt(7)
    ds_read_b128 a[176:179], v42 offset:30720
    ds_read_b32 a55, v63
    v_mfma_f32_16x16x32_bf16 v[140:143], a[4:7], a[60:63], v[140:143]
    v_perm_b32 v56, v91, v35, s36
    v_perm_b32 v57, v91, v35, s37
    v_mfma_f32_16x16x32_bf16 v[140:143], a[0:3], a[56:59], v[140:143]
    ds_read_b128 a[180:183], v43 offset:30720
    ds_read_b32 a84, v56
    v_mfma_f32_16x16x32_bf16 v[144:147], a[0:3], a[72:75], v[144:147]
    s_waitcnt lgkmcnt(7)
    ds_read_b32 a85, v57
    v_perm_b32 v58, v95, v35, s36
    v_mfma_f32_16x16x32_bf16 v[144:147], a[4:7], a[76:79], v[144:147]
    ds_read_b32 a86, v58
    v_perm_b32 v59, v95, v35, s37
    v_perm_b32 v62, v48, v35, s36
    v_mfma_f32_16x16x32_bf16 v[148:151], a[4:7], a[100:103], v[148:151]
    s_waitcnt lgkmcnt(8)
    ds_read_b32 a87, v59
    ds_read_b32 a104, v62
    v_mfma_f32_16x16x32_bf16 v[148:151], a[0:3], a[96:99], v[148:151]
    buffer_load_dwordx4 v37, s[8:11], s56 offen offset:1024 lds
    v_mfma_f32_16x16x32_bf16 v[152:155], a[0:3], a[136:139], v[152:155]
    s_waitcnt lgkmcnt(8)
    v_perm_b32 v60, v48, v35, s37
    v_perm_b32 v61, v48, v35, s38
    v_mfma_f32_16x16x32_bf16 v[152:155], a[4:7], a[140:143], v[152:155]
    s_waitcnt lgkmcnt(5)
    ds_read_b32 a105, v60
    ds_read_b32 a106, v61
    v_mfma_f32_16x16x32_bf16 v[156:159], a[4:7], a[180:183], v[156:159]
    v_perm_b32 v63, v48, v35, s39
    v_perm_b32 v56, v52, v35, s36
    v_mfma_f32_16x16x32_bf16 v[156:159], a[0:3], a[176:179], v[156:159]
    ds_read_b32 a107, v63
    ds_read_b32 a108, v56
    v_mfma_f32_16x16x32_bf16 v[160:163], a[8:11], a[16:19], v[160:163]
    v_perm_b32 v57, v52, v35, s37
    v_perm_b32 v58, v52, v35, s38
    v_mfma_f32_16x16x32_bf16 v[160:163], a[12:15], a[20:23], v[160:163]
    ds_read_b32 a109, v57
    ds_read_b32 a110, v58
    v_mfma_f32_16x16x32_bf16 v[164:167], a[12:15], a[28:31], v[164:167]
    buffer_load_dwordx4 v38, s[8:11], s56 offen offset:2048 lds
    v_mfma_f32_16x16x32_bf16 v[164:167], a[8:11], a[24:27], v[164:167]
    v_perm_b32 v59, v52, v35, s39
    v_perm_b32 v62, v49, v35, s36
    v_mfma_f32_16x16x32_bf16 v[168:171], a[8:11], a[40:43], v[168:171]
    ds_read_b32 a111, v59
    ds_read_b32 a112, v62
    v_mfma_f32_16x16x32_bf16 v[168:171], a[12:15], a[44:47], v[168:171]
    v_perm_b32 v60, v49, v35, s37
    v_perm_b32 v61, v49, v35, s38
    v_mfma_f32_16x16x32_bf16 v[172:175], a[12:15], a[60:63], v[172:175]
    ds_read_b32 a113, v60
    ds_read_b32 a114, v61
    v_mfma_f32_16x16x32_bf16 v[172:175], a[8:11], a[56:59], v[172:175]
    v_perm_b32 v63, v49, v35, s39
    v_perm_b32 v56, v53, v35, s36
    v_mfma_f32_16x16x32_bf16 v[176:179], a[8:11], a[72:75], v[176:179]
    ds_read_b32 a115, v63
    ds_read_b32 a116, v56
    v_perm_b32 v57, v53, v35, s37
    v_mfma_f32_16x16x32_bf16 v[176:179], a[12:15], a[76:79], v[176:179]
    s_waitcnt vmcnt(12)
    ds_read_b32 a117, v57
    v_mfma_f32_16x16x32_bf16 v[180:183], a[12:15], a[100:103], v[180:183]
    buffer_load_dwordx4 v39, s[8:11], s56 offen offset:3072 lds
    v_mfma_f32_16x16x32_bf16 v[180:183], a[8:11], a[96:99], v[180:183]
    s_barrier
    v_mfma_f32_16x16x32_bf16 v[184:187], a[8:11], a[136:139], v[184:187]
    s_add_u32 m0, s57, 49152
    ds_read_b128 a[120:123], v40 offset:0
    v_perm_b32 v58, v53, v35, s38
    v_mfma_f32_16x16x32_bf16 v[184:187], a[12:15], a[140:143], v[184:187]
    s_add_u32 s56, s55, 1024
    ds_read_b128 a[124:127], v41 offset:0
    ds_read_b32 a118, v58
    v_mfma_f32_16x16x32_bf16 v[188:191], a[12:15], a[180:183], v[188:191]
    ds_read_b128 a[132:135], v41 offset:2048
    v_perm_b32 v59, v53, v35, s39
    v_mfma_f32_16x16x32_bf16 v[188:191], a[8:11], a[176:179], v[188:191]
    ds_read_b128 a[128:131], v40 offset:2048
    ds_read_b32 a119, v59
    v_mfma_f32_16x16x32_bf16 v[192:195], a[48:51], a[16:19], v[192:195]
    ds_read_b128 a[144:147], v40 offset:4096
    v_mfma_f32_16x16x32_bf16 v[192:195], a[52:55], a[20:23], v[192:195]
    buffer_load_dwordx4 v36, s[8:11], s3 offen offset:0 lds
    v_mfma_f32_16x16x32_bf16 v[196:199], a[52:55], a[28:31], v[196:199]
    ds_read_b128 a[148:151], v41 offset:4096
    v_perm_b32 v62, v50, v35, s36
    v_mfma_f32_16x16x32_bf16 v[196:199], a[48:51], a[24:27], v[196:199]
    ds_read_b128 a[156:159], v41 offset:6144
    ds_read_b32 a160, v62
    v_mfma_f32_16x16x32_bf16 v[200:203], a[48:51], a[40:43], v[200:203]
    s_waitcnt vmcnt(12)
    ds_read_b128 a[152:155], v40 offset:6144
    v_bitop3_b32 v60, v67, v71, s76 bitop3:0x7e
    v_mfma_f32_16x16x32_bf16 v[200:203], a[52:55], a[44:47], v[200:203]
    ds_read_b128 a[88:91], v40 offset:8192
    v_cmp_lt_u32 vcc, 0xffff, v60
    v_mfma_f32_16x16x32_bf16 v[204:207], a[52:55], a[60:63], v[204:207]
    v_perm_b32 v61, v50, v35, s37
    v_perm_b32 v63, v50, v35, s38
    v_mfma_f32_16x16x32_bf16 v[204:207], a[48:51], a[56:59], v[204:207]
    ds_read_b32 a161, v61
    ds_read_b32 a162, v63
    v_mfma_f32_16x16x32_bf16 v[208:211], a[48:51], a[72:75], v[208:211]
    buffer_load_dwordx4 v37, s[8:11], s3 offen offset:1024 lds
    v_mfma_f32_16x16x32_bf16 v[208:211], a[52:55], a[76:79], v[208:211]
    ds_read_b128 a[92:95], v41 offset:8192
    s_cbranch_vccnz L_slow2_1
L_back2_1:
    v_mfma_f32_16x16x32_bf16 v[212:215], a[52:55], a[100:103], v[212:215]
    v_perm_b32 v56, v50, v35, s39
    v_perm_b32 v57, v54, v35, s36
    v_mfma_f32_16x16x32_bf16 v[212:215], a[48:51], a[96:99], v[212:215]
    ds_read_b32 a163, v56
    ds_read_b32 a164, v57
    v_mfma_f32_16x16x32_bf16 v[216:219], a[48:51], a[136:139], v[216:219]
    ds_read_b128 a[168:171], v40 offset:10240
    v_perm_b32 v58, v54, v35, s37
    v_mfma_f32_16x16x32_bf16 v[216:219], a[52:55], a[140:143], v[216:219]
    ds_read_b32 a165, v58
    v_perm_b32 v59, v54, v35, s38
    v_mfma_f32_16x16x32_bf16 v[220:223], a[52:55], a[180:183], v[220:223]
    ds_read_b32 a166, v59
    v_perm_b32 v62, v54, v35, s39
    v_mfma_f32_16x16x32_bf16 v[220:223], a[48:51], a[176:179], v[220:223]
    s_waitcnt lgkmcnt(8)
    ds_read_b128 a[172:175], v41 offset:10240
    ds_read_b32 a167, v62
    v_mfma_f32_16x16x32_bf16 v[224:227], a[84:87], a[18:21], v[224:227]
    buffer_load_dwordx4 v38, s[8:11], s3 offen offset:2048 lds
    v_mfma_f32_16x16x32_bf16 v[228:231], a[84:87], a[26:29], v[228:231]
    ds_read_b128 a[184:187], v40 offset:12288
    v_perm_b32 v60, v51, v35, s36
    v_mfma_f32_16x16x32_bf16 v[232:235], a[84:87], a[42:45], v[232:235]
    ds_read_b32 a216, v60
    v_perm_b32 v61, v51, v35, s37
    v_mfma_f32_16x16x32_bf16 v[236:239], a[84:87], a[58:61], v[236:239]
    ds_read_b32 a217, v61
    v_perm_b32 v63, v55, v35, s36
    v_mfma_f32_16x16x32_bf16 v[240:243], a[84:87], a[74:77], v[240:243]
    ds_read_b32 a218, v63
    ds_read_b128 a[188:191], v41 offset:12288
    v_mfma_f32_16x16x32_bf16 v[244:247], a[84:87], a[98:101], v[244:247]
    v_perm_b32 v56, v55, v35, s37
    v_perm_b32 v57, v64, v35, s36
    v_mfma_f32_16x16x32_bf16 v[248:251], a[84:87], a[138:141], v[248:251]
    ds_read_b32 a219, v56
    ds_read_b32 a64, v57
    v_mfma_f32_16x16x32_bf16 v[252:255], a[84:87], a[178:181], v[252:255]
    buffer_load_dwordx4 v39, s[8:11], s3 offen offset:3072 lds
    v_mfma_f32_16x16x32_bf16 v[128:131], a[104:107], a[120:123], v[128:131]
    s_add_u32 m0, s57, 65536
    ds_read_b128 a[192:195], v40 offset:14336
    v_perm_b32 v58, v64, v35, s37
    v_mfma_f32_16x16x32_bf16 v[128:131], a[108:111], a[124:127], v[128:131]
    s_add_u32 s3, s69, 1024
    ds_read_b32 a65, v58
    v_perm_b32 v59, v64, v35, s38
    v_mfma_f32_16x16x32_bf16 v[132:135], a[108:111], a[132:135], v[132:135]
    ds_read_b128 a[196:199], v41 offset:14336
    ds_read_b32 a66, v59
    v_perm_b32 v62, v64, v35, s39
    v_mfma_f32_16x16x32_bf16 v[132:135], a[104:107], a[128:131], v[132:135]
    ds_read_b32 a67, v62
    v_mfma_f32_16x16x32_bf16 v[136:139], a[104:107], a[144:147], v[136:139]
    buffer_load_dwordx4 v[80:83], v34, s[12:15], s42 offen sc1
    v_mfma_f32_16x16x32_bf16 v[136:139], a[108:111], a[148:151], v[136:139]
    s_waitcnt vmcnt(14)
    v_bitop3_b32 v60, v75, v79, s76 bitop3:0x7e
    v_perm_b32 v61, v68, v35, s36
    v_mfma_f32_16x16x32_bf16 v[140:143], a[108:111], a[156:159], v[140:143]
    ds_read_b32 a68, v61
    v_cmp_lt_u32 vcc, 0xffff, v60
    v_mfma_f32_16x16x32_bf16 v[140:143], a[104:107], a[152:155], v[140:143]
    v_perm_b32 v63, v68, v35, s37
    v_perm_b32 v56, v68, v35, s38
    v_mfma_f32_16x16x32_bf16 v[144:147], a[104:107], a[88:91], v[144:147]
    s_waitcnt lgkmcnt(6)
    ds_read_b32 a69, v63
    ds_read_b32 a70, v56
    v_mfma_f32_16x16x32_bf16 v[144:147], a[108:111], a[92:95], v[144:147]
    buffer_load_dwordx4 v[84:87], v44, s[12:15], s42 offen sc1
    v_mfma_f32_16x16x32_bf16 v[148:151], a[108:111], a[172:175], v[148:151]
    v_perm_b32 v57, v68, v35, s39
    s_cbranch_vccnz L_slow3_0
L_back3_0:
    v_mfma_f32_16x16x32_bf16 v[148:151], a[104:107], a[168:171], v[148:151]
    ds_read_b32 a71, v57
    v_perm_b32 v58, v65, v35, s36
    v_mfma_f32_16x16x32_bf16 v[152:155], a[104:107], a[184:187], v[152:155]
    ds_read_b32 a200, v58
    v_perm_b32 v59, v65, v35, s37
    v_mfma_f32_16x16x32_bf16 v[152:155], a[108:111], a[188:191], v[152:155]
    s_waitcnt lgkmcnt(5)
    ds_read_b32 a201, v59
    v_perm_b32 v62, v65, v35, s38
    v_mfma_f32_16x16x32_bf16 v[156:159], a[108:111], a[196:199], v[156:159]
    ds_read_b32 a202, v62
    v_perm_b32 v60, v65, v35, s39
    v_perm_b32 v61, v69, v35, s36
    v_mfma_f32_16x16x32_bf16 v[156:159], a[104:107], a[192:195], v[156:159]
    ds_read_b32 a203, v60
    ds_read_b32 a204, v61
    v_mfma_f32_16x16x32_bf16 v[160:163], a[112:115], a[120:123], v[160:163]
    buffer_load_dwordx4 v36, s[8:11], s56 offen offset:0 lds
    v_mfma_f32_16x16x32_bf16 v[160:163], a[116:119], a[124:127], v[160:163]
    v_perm_b32 v63, v69, v35, s37
    v_perm_b32 v56, v69, v35, s38
    v_mfma_f32_16x16x32_bf16 v[164:167], a[116:119], a[132:135], v[164:167]
    ds_read_b32 a205, v63
    ds_read_b32 a206, v56
    v_mfma_f32_16x16x32_bf16 v[164:167], a[112:115], a[128:131], v[164:167]
    v_perm_b32 v57, v69, v35, s39
    v_perm_b32 v58, v66, v35, s36
    v_mfma_f32_16x16x32_bf16 v[168:171], a[112:115], a[144:147], v[168:171]
    ds_read_b32 a207, v57
    ds_read_b32 a208, v58
    v_mfma_f32_16x16x32_bf16 v[168:171], a[116:119], a[148:151], v[168:171]
    buffer_load_dwordx4 v[96:99], v32, s[12:15], s43 offen sc1
    v_mfma_f32_16x16x32_bf16 v[172:175], a[116:119], a[156:159], v[172:175]
    v_perm_b32 v59, v66, v35, s37
    v_perm_b32 v62, v66, v35, s38
    v_mfma_f32_16x16x32_bf16 v[172:175], a[112:115], a[152:155], v[172:175]
    ds_read_b32 a209, v59
    ds_read_b32 a210, v62
    v_mfma_f32_16x16x32_bf16 v[176:179], a[112:115], a[88:91], v[176:179]
    v_perm_b32 v60, v66, v35, s39
    v_perm_b32 v61, v70, v35, s36
    v_mfma_f32_16x16x32_bf16 v[176:179], a[116:119], a[92:95], v[176:179]
    ds_read_b32 a211, v60
    ds_read_b32 a212, v61
    v_mfma_f32_16x16x32_bf16 v[180:183], a[116:119], a[172:175], v[180:183]
    buffer_load_dwordx4 v[100:103], v33, s[12:15], s43 offen sc1
    v_mfma_f32_16x16x32_bf16 v[180:183], a[112:115], a[168:171], v[180:183]
    v_perm_b32 v63, v70, v35, s37
    v_perm_b32 v56, v70, v35, s38
    v_mfma_f32_16x16x32_bf16 v[184:187], a[112:115], a[184:187], v[184:187]
    ds_read_b32 a213, v63
    ds_read_b32 a214, v56
    v_mfma_f32_16x16x32_bf16 v[184:187], a[116:119], a[188:191], v[184:187]
    v_perm_b32 v57, v70, v35, s39
    v_perm_b32 v58, v67, v35, s36
    v_mfma_f32_16x16x32_bf16 v[188:191], a[116:119], a[196:199], v[188:191]
    ds_read_b32 a215, v57
    ds_read_b32 a220, v58
    v_mfma_f32_16x16x32_bf16 v[188:191], a[112:115], a[192:195], v[188:191]
    s_waitcnt vmcnt(13)
    v_perm_b32 v59, v67, v35, s37
    v_perm_b32 v62, v71, v35, s36
    v_mfma_f32_16x16x32_bf16 v[192:195], a[160:163], a[120:123], v[192:195]
    s_barrier
    v_mfma_f32_16x16x32_bf16 v[192:195], a[164:167], a[124:127], v[192:195]
    buffer_load_dwordx4 v37, s[8:11], s56 offen offset:1024 lds
    v_mfma_f32_16x16x32_bf16 v[196:199], a[164:167], a[132:135], v[196:199]
    ds_read_b32 a221, v59
    ds_read_b32 a222, v62
    v_mfma_f32_16x16x32_bf16 v[196:199], a[160:163], a[128:131], v[196:199]
    ds_read_b128 a[224:227], v40 offset:16384
    v_perm_b32 v60, v71, v35, s37
    v_mfma_f32_16x16x32_bf16 v[200:203], a[160:163], a[144:147], v[200:203]
    ds_read_b32 a223, v60
    ds_read_b128 a[228:231], v41 offset:16384
    v_mfma_f32_16x16x32_bf16 v[200:203], a[164:167], a[148:151], v[200:203]
    ds_read_b128 a[232:235], v40 offset:18432
    v_perm_b32 v61, v72, v35, s36
    v_mfma_f32_16x16x32_bf16 v[204:207], a[164:167], a[156:159], v[204:207]
    ds_read_b32 a240, v61
    v_perm_b32 v63, v72, v35, s37
    v_mfma_f32_16x16x32_bf16 v[204:207], a[160:163], a[152:155], v[204:207]
    ds_read_b32 a241, v63
    ds_read_b128 a[236:239], v41 offset:18432
    v_mfma_f32_16x16x32_bf16 v[208:211], a[160:163], a[88:91], v[208:211]
    buffer_load_dwordx4 v38, s[8:11], s56 offen offset:2048 lds
    v_mfma_f32_16x16x32_bf16 v[208:211], a[164:167], a[92:95], v[208:211]
    ds_read_b128 a[248:251], v40 offset:20480
    v_perm_b32 v56, v72, v35, s38
    v_mfma_f32_16x16x32_bf16 v[212:215], a[164:167], a[172:175], v[212:215]
    ds_read_b32 a242, v56
    v_perm_b32 v57, v72, v35, s39
    v_mfma_f32_16x16x32_bf16 v[212:215], a[160:163], a[168:171], v[212:215]
    ds_read_b32 a243, v57
    ds_read_b128 a[252:255], v41 offset:20480
    v_mfma_f32_16x16x32_bf16 v[216:219], a[160:163], a[184:187], v[216:219]
    v_perm_b32 v58, v76, v35, s36
    v_perm_b32 v59, v76, v35, s37
    v_mfma_f32_16x16x32_bf16 v[216:219], a[164:167], a[188:191], v[216:219]
    ds_read_b32 a244, v58
    ds_read_b32 a245, v59
    v_mfma_f32_16x16x32_bf16 v[220:223], a[164:167], a[196:199], v[220:223]
    ds_read_b128 a[32:35], v40 offset:22528
    v_perm_b32 v62, v76, v35, s38
    v_mfma_f32_16x16x32_bf16 v[220:223], a[160:163], a[192:195], v[220:223]
    ds_read_b32 a246, v62
    ds_read_b128 a[36:39], v41 offset:22528
    v_mfma_f32_16x16x32_bf16 v[224:227], a[216:219], a[122:125], v[224:227]
    buffer_load_dwordx4 v39, s[8:11], s56 offen offset:3072 lds
    v_mfma_f32_16x16x32_bf16 v[228:231], a[216:219], a[130:133], v[228:231]
    s_add_u32 m0, s57, 81920
    ds_read_b128 a[0:3], v40 offset:24576
    v_perm_b32 v60, v76, v35, s39
    v_mfma_f32_16x16x32_bf16 v[232:235], a[216:219], a[146:149], v[232:235]
    ds_read_b32 a247, v60
    v_perm_b32 v61, v73, v35, s36
    v_mfma_f32_16x16x32_bf16 v[236:239], a[216:219], a[154:157], v[236:239]
    ds_read_b32 a8, v61
    ds_read_b128 a[4:7], v41 offset:24576
    v_mfma_f32_16x16x32_bf16 v[240:243], a[216:219], a[90:93], v[240:243]
    v_perm_b32 v63, v73, v35, s37
    v_perm_b32 v56, v73, v35, s38
    v_mfma_f32_16x16x32_bf16 v[244:247], a[216:219], a[170:173], v[244:247]
    ds_read_b32 a9, v63
    ds_read_b32 a10, v56
    v_perm_b32 v57, v73, v35, s39
    v_mfma_f32_16x16x32_bf16 v[248:251], a[216:219], a[186:189], v[248:251]
    s_waitcnt lgkmcnt(9)
    ds_read_b32 a11, v57
    ds_read_b128 a[48:51], v40 offset:26624
    v_mfma_f32_16x16x32_bf16 v[252:255], a[216:219], a[194:197], v[252:255]
    buffer_load_dwordx4 v36, s[8:11], s3 offen offset:0 lds
    v_mfma_f32_16x16x32_bf16 v[128:131], a[64:67], a[224:227], v[128:131]
    ds_read_b128 a[52:55], v41 offset:26624
    v_perm_b32 v58, v77, v35, s36
    v_mfma_f32_16x16x32_bf16 v[128:131], a[68:71], a[228:231], v[128:131]
    ds_read_b128 a[16:19], v40 offset:28672
    ds_read_b32 a12, v58
    v_mfma_f32_16x16x32_bf16 v[132:135], a[68:71], a[236:239], v[132:135]
    s_add_u32 s56, s55, 1280
    v_perm_b32 v59, v77, v35, s37
    v_perm_b32 v62, v77, v35, s38
    v_mfma_f32_16x16x32_bf16 v[132:135], a[64:67], a[232:235], v[132:135]
    ds_read_b128 a[20:23], v41 offset:28672
    ds_read_b32 a13, v59
    v_mfma_f32_16x16x32_bf16 v[136:139], a[64:67], a[248:251], v[136:139]
    ds_read_b32 a14, v62
    v_perm_b32 v60, v77, v35, s39
    v_mfma_f32_16x16x32_bf16 v[136:139], a[68:71], a[252:255], v[136:139]
    s_waitcnt lgkmcnt(10)
    ds_read_b128 a[24:27], v40 offset:30720
    ds_read_b32 a15, v60
    v_mfma_f32_16x16x32_bf16 v[140:143], a[68:71], a[36:39], v[140:143]
    buffer_load_dwordx4 v37, s[8:11], s3 offen offset:1024 lds
    v_mfma_f32_16x16x32_bf16 v[140:143], a[64:67], a[32:35], v[140:143]
    ds_read_b128 a[28:31], v41 offset:30720
    v_perm_b32 v61, v74, v35, s36
    v_mfma_f32_16x16x32_bf16 v[144:147], a[64:67], a[0:3], v[144:147]
    ds_read_b32 a40, v61
    v_perm_b32 v63, v74, v35, s37
    v_mfma_f32_16x16x32_bf16 v[144:147], a[68:71], a[4:7], v[144:147]
    s_waitcnt lgkmcnt(9)
    ds_read_b32 a41, v63
    v_perm_b32 v56, v74, v35, s38
    v_mfma_f32_16x16x32_bf16 v[148:151], a[68:71], a[52:55], v[148:151]
    ds_read_b32 a42, v56
    v_perm_b32 v57, v74, v35, s39
    v_mfma_f32_16x16x32_bf16 v[148:151], a[64:67], a[48:51], v[148:151]
    s_waitcnt lgkmcnt(8)
    ds_read_b32 a43, v57
    v_perm_b32 v58, v78, v35, s36
    v_mfma_f32_16x16x32_bf16 v[152:155], a[64:67], a[16:19], v[152:155]
    ds_read_b32 a44, v58
    v_perm_b32 v59, v78, v35, s37
    v_perm_b32 v62, v78, v35, s38
    v_mfma_f32_16x16x32_bf16 v[152:155], a[68:71], a[20:23], v[152:155]
    s_waitcnt lgkmcnt(5)
    ds_read_b32 a45, v59
    ds_read_b32 a46, v62
    v_mfma_f32_16x16x32_bf16 v[156:159], a[68:71], a[28:31], v[156:159]
    buffer_load_dwordx4 v38, s[8:11], s3 offen offset:2048 lds
    v_mfma_f32_16x16x32_bf16 v[156:159], a[64:67], a[24:27], v[156:159]
    v_perm_b32 v60, v78, v35, s39
    v_perm_b32 v61, v75, v35, s36
    v_mfma_f32_16x16x32_bf16 v[160:163], a[200:203], a[224:227], v[160:163]
    ds_read_b32 a47, v60
    ds_read_b32 a56, v61
    v_mfma_f32_16x16x32_bf16 v[160:163], a[204:207], a[228:231], v[160:163]
    v_perm_b32 v63, v75, v35, s37
    v_perm_b32 v56, v79, v35, s36
    v_mfma_f32_16x16x32_bf16 v[164:167], a[204:207], a[236:239], v[164:167]
    ds_read_b32 a57, v63
    ds_read_b32 a58, v56
    v_perm_b32 v57, v79, v35, s37
    v_mfma_f32_16x16x32_bf16 v[164:167], a[200:203], a[232:235], v[164:167]
    ds_read_b32 a59, v57
    v_mfma_f32_16x16x32_bf16 v[168:171], a[200:203], a[248:251], v[168:171]
    buffer_load_dwordx4 v[104:107], v34, s[12:15], s43 offen sc1
    v_mfma_f32_16x16x32_bf16 v[168:171], a[204:207], a[252:255], v[168:171]
    s_waitcnt vmcnt(12)
    v_mfma_f32_16x16x32_bf16 v[172:175], a[204:207], a[36:39], v[172:175]
    s_barrier
    v_mfma_f32_16x16x32_bf16 v[172:175], a[200:203], a[32:35], v[172:175]
    ds_read_b128 a[72:75], v40 offset:32768
    v_mfma_f32_16x16x32_bf16 v[176:179], a[200:203], a[0:3], v[176:179]
    buffer_load_dwordx4 v[108:111], v44, s[12:15], s43 offen sc1
    v_mfma_f32_16x16x32_bf16 v[176:179], a[204:207], a[4:7], v[176:179]
    ds_read_b128 a[76:79], v41 offset:32768
    v_mfma_f32_16x16x32_bf16 v[180:183], a[204:207], a[52:55], v[180:183]
    ds_read_b128 a[100:103], v41 offset:34816
    v_mfma_f32_16x16x32_bf16 v[180:183], a[200:203], a[48:51], v[180:183]
    ds_read_b128 a[96:99], v40 offset:34816
    v_mfma_f32_16x16x32_bf16 v[184:187], a[200:203], a[16:19], v[184:187]
    ds_read_b128 a[136:139], v40 offset:36864
    v_mfma_f32_16x16x32_bf16 v[184:187], a[204:207], a[20:23], v[184:187]
    ds_read_b128 a[140:143], v41 offset:36864
    v_mfma_f32_16x16x32_bf16 v[188:191], a[204:207], a[28:31], v[188:191]
    s_waitcnt vmcnt(11)
    ds_read_b128 a[80:83], v40 offset:38912
    v_mfma_f32_16x16x32_bf16 v[188:191], a[200:203], a[24:27], v[188:191]
    buffer_load_dwordx4 v39, s[8:11], s3 offen offset:3072 lds
    v_mfma_f32_16x16x32_bf16 v[192:195], a[208:211], a[224:227], v[192:195]
    s_add_u32 m0, s57, 0
    ds_read_b128 a[84:87], v41 offset:38912
    v_bitop3_b32 v58, v83, v87, s76 bitop3:0x7e
    v_mfma_f32_16x16x32_bf16 v[192:195], a[212:215], a[228:231], v[192:195]
    s_add_u32 s3, s69, 1280
    ds_read_b128 a[176:179], v40 offset:40960
    v_cmp_lt_u32 vcc, 0xffff, v58
    v_mfma_f32_16x16x32_bf16 v[196:199], a[212:215], a[236:239], v[196:199]
    v_mfma_f32_16x16x32_bf16 v[196:199], a[208:211], a[232:235], v[196:199]
    s_cbranch_vccnz L_slow3_1
L_back3_1:
    v_mfma_f32_16x16x32_bf16 v[200:203], a[208:211], a[248:251], v[200:203]
    buffer_load_dwordx4 v[112:115], v32, s[12:15], s44 offen sc1
    v_mfma_f32_16x16x32_bf16 v[200:203], a[212:215], a[252:255], v[200:203]
    v_perm_b32 v59, v83, v35, s36
    v_perm_b32 v62, v83, v35, s37
    v_mfma_f32_16x16x32_bf16 v[204:207], a[212:215], a[36:39], v[204:207]
    ds_read_b32 a60, v59
    ds_read_b32 a61, v62
    v_mfma_f32_16x16x32_bf16 v[204:207], a[208:211], a[32:35], v[204:207]
    ds_read_b128 a[180:183], v41 offset:40960
    v_mfma_f32_16x16x32_bf16 v[208:211], a[208:211], a[0:3], v[208:211]
    buffer_load_dwordx4 v[116:119], v33, s[12:15], s44 offen sc1
    v_mfma_f32_16x16x32_bf16 v[208:211], a[212:215], a[4:7], v[208:211]
    v_perm_b32 v60, v87, v35, s36
    v_perm_b32 v61, v87, v35, s37
    v_mfma_f32_16x16x32_bf16 v[212:215], a[212:215], a[52:55], v[212:215]
    ds_read_b32 a62, v60
    ds_read_b32 a63, v61
    v_mfma_f32_16x16x32_bf16 v[212:215], a[208:211], a[48:51], v[212:215]
    v_perm_b32 v63, v80, v35, s36
    v_perm_b32 v56, v80, v35, s37
    v_mfma_f32_16x16x32_bf16 v[216:219], a[208:211], a[16:19], v[216:219]
    ds_read_b128 a[104:107], v40 offset:43008
    ds_read_b32 a112, v63
    v_mfma_f32_16x16x32_bf16 v[216:219], a[212:215], a[20:23], v[216:219]
    ds_read_b32 a113, v56
    v_perm_b32 v57, v80, v35, s38
    v_mfma_f32_16x16x32_bf16 v[220:223], a[212:215], a[28:31], v[220:223]
    ds_read_b32 a114, v57
    v_perm_b32 v58, v80, v35, s39
    v_mfma_f32_16x16x32_bf16 v[220:223], a[208:211], a[24:27], v[220:223]
    ds_read_b128 a[108:111], v41 offset:43008
    ds_read_b32 a115, v58
    v_mfma_f32_16x16x32_bf16 v[224:227], a[220:223], a[226:229], v[224:227]
    buffer_load_dwordx4 v36, s[8:11], s56 offen offset:0 lds
    v_mfma_f32_16x16x32_bf16 v[228:231], a[220:223], a[234:237], v[228:231]
    s_waitcnt vmcnt(12)
    v_bitop3_b32 v59, v99, v103, s76 bitop3:0x7e
    v_perm_b32 v62, v84, v35, s36
    v_mfma_f32_16x16x32_bf16 v[232:235], a[220:223], a[250:253], v[232:235]
    ds_read_b128 a[160:163], v40 offset:45056
    ds_read_b32 a116, v62
    v_cmp_lt_u32 vcc, 0xffff, v59
    v_mfma_f32_16x16x32_bf16 v[236:239], a[220:223], a[34:37], v[236:239]
    v_perm_b32 v60, v84, v35, s37
    v_perm_b32 v61, v84, v35, s38
    v_mfma_f32_16x16x32_bf16 v[240:243], a[220:223], a[2:5], v[240:243]
    ds_read_b32 a117, v60
    ds_read_b32 a118, v61
    v_mfma_f32_16x16x32_bf16 v[244:247], a[220:223], a[50:53], v[244:247]
    ds_read_b128 a[164:167], v41 offset:45056
    s_cbranch_vccnz L_slow4_0
L_back4_0:
    v_mfma_f32_16x16x32_bf16 v[248:251], a[220:223], a[18:21], v[248:251]
    s_waitcnt lgkmcnt(8)
    ds_read_b128 a[120:123], v40 offset:47104
    v_mfma_f32_16x16x32_bf16 v[252:255], a[220:223], a[26:29], v[252:255]
    buffer_load_dwordx4 v37, s[8:11], s56 offen offset:1024 lds
    v_mfma_f32_16x16x32_bf16 v[128:131], a[240:243], a[72:75], v[128:131]
    v_perm_b32 v63, v84, v35, s39
    v_perm_b32 v56, v81, v35, s36
L_pad2:
    s_cbranch_execz L_pad3
    v_mfma_f32_16x16x32_bf16 v[128:131], a[244:247], a[76:79], v[128:131]
    ds_read_b32 a119, v63
    ds_read_b32 a128, v56
    v_mfma_f32_16x16x32_bf16 v[132:135], a[244:247], a[100:103], v[132:135]
    ds_read_b128 a[124:127], v41 offset:47104
    v_perm_b32 v57, v81, v35, s37
    v_mfma_f32_16x16x32_bf16 v[132:135], a[240:243], a[96:99], v[132:135]
    ds_read_b32 a129, v57
    v_perm_b32 v58, v81, v35, s38
    v_mfma_f32_16x16x32_bf16 v[136:139], a[240:243], a[136:139], v[136:139]
    ds_read_b32 a130, v58
    v_perm_b32 v59, v81, v35, s39
    v_mfma_f32_16x16x32_bf16 v[136:139], a[244:247], a[140:143], v[136:139]
    ds_read_b32 a131, v59
    v_perm_b32 v62, v85, v35, s36
    v_mfma_f32_16x16x32_bf16 v[140:143], a[244:247], a[84:87], v[140:143]
    ds_read_b32 a132, v62
    v_perm_b32 v60, v85, v35, s37
    v_mfma_f32_16x16x32_bf16 v[140:143], a[240:243], a[80:83], v[140:143]
    ds_read_b32 a133, v60
    v_perm_b32 v61, v85, v35, s38
    v_mfma_f32_16x16x32_bf16 v[144:147], a[240:243], a[176:179], v[144:147]
    s_waitcnt lgkmcnt(8)
    ds_read_b32 a134, v61
    ds_read_b128 a[144:147], v40 offset:49152
    v_mfma_f32_16x16x32_bf16 v[144:147], a[244:247], a[180:183], v[144:147]
    buffer_load_dwordx4 v[120:123], v34, s[12:15], s44 offen sc1
    v_mfma_f32_16x16x32_bf16 v[148:151], a[244:247], a[108:111], v[148:151]
    v_perm_b32 v63, v85, v35, s39
    v_perm_b32 v56, v82, v35, s36
    v_mfma_f32_16x16x32_bf16 v[148:151], a[240:243], a[104:107], v[148:151]
    ds_read_b32 a135, v63
    ds_read_b32 a152, v56
    v_mfma_f32_16x16x32_bf16 v[152:155], a[240:243], a[160:163], v[152:155]
    s_waitcnt lgkmcnt(8)
    ds_read_b128 a[148:151], v41 offset:49152
    v_mfma_f32_16x16x32_bf16 v[152:155], a[244:247], a[164:167], v[152:155]
    buffer_load_dwordx4 v[124:127], v44, s[12:15], s44 offen sc1
    v_mfma_f32_16x16x32_bf16 v[156:159], a[244:247], a[124:127], v[156:159]
    ds_read_b128 a[88:91], v40 offset:51200
    v_perm_b32 v57, v82, v35, s37
    v_mfma_f32_16x16x32_bf16 v[156:159], a[240:243], a[120:123], v[156:159]
    ds_read_b128 a[92:95], v41 offset:51200
    ds_read_b32 a153, v57
    v_mfma_f32_16x16x32_bf16 v[160:163], a[8:11], a[72:75], v[160:163]
    ds_read_b128 a[168:171], v40 offset:53248
    v_mfma_f32_16x16x32_bf16 v[160:163], a[12:15], a[76:79], v[160:163]
    buffer_load_dwordx4 v38, s[8:11], s56 offen offset:2048 lds
    v_mfma_f32_16x16x32_bf16 v[164:167], a[12:15], a[100:103], v[164:167]
    v_perm_b32 v58, v82, v35, s38
    v_perm_b32 v59, v82, v35, s39
    v_mfma_f32_16x16x32_bf16 v[164:167], a[8:11], a[96:99], v[164:167]
    ds_read_b32 a154, v58
    ds_read_b32 a155, v59
    v_mfma_f32_16x16x32_bf16 v[168:171], a[8:11], a[136:139], v[168:171]
    v_perm_b32 v62, v86, v35, s36
    v_perm_b32 v60, v86, v35, s37
    v_mfma_f32_16x16x32_bf16 v[168:171], a[12:15], a[140:143], v[168:171]
    ds_read_b128 a[172:175], v41 offset:53248
    ds_read_b32 a156, v62
    v_mfma_f32_16x16x32_bf16 v[172:175], a[12:15], a[84:87], v[172:175]
    ds_read_b32 a157, v60
    ds_read_b128 a[184:187], v40 offset:55296
    v_mfma_f32_16x16x32_bf16 v[172:175], a[8:11], a[80:83], v[172:175]
    buffer_load_dwordx4 v39, s[8:11], s56 offen offset:3072 lds
    v_mfma_f32_16x16x32_bf16 v[176:179], a[8:11], a[176:179], v[176:179]
    s_add_u32 m0, s57, 16384
    v_perm_b32 v61, v86, v35, s38
    v_perm_b32 v63, v86, v35, s39
    v_mfma_f32_16x16x32_bf16 v[176:179], a[12:15], a[180:183], v[176:179]
    ds_read_b32 a158, v61
    ds_read_b32 a159, v63
    v_mfma_f32_16x16x32_bf16 v[180:183], a[12:15], a[108:111], v[180:183]
    v_perm_b32 v56, v96, v35, s36
    v_perm_b32 v57, v96, v35, s37
    v_mfma_f32_16x16x32_bf16 v[180:183], a[8:11], a[104:107], v[180:183]
    ds_read_b128 a[188:191], v41 offset:55296
    ds_read_b32 a192, v56
    v_mfma_f32_16x16x32_bf16 v[184:187], a[8:11], a[160:163], v[184:187]
    ds_read_b32 a193, v57
    v_perm_b32 v58, v96, v35, s38
    v_mfma_f32_16x16x32_bf16 v[184:187], a[12:15], a[164:167], v[184:187]
    ds_read_b32 a194, v58
    v_perm_b32 v59, v96, v35, s39
    v_mfma_f32_16x16x32_bf16 v[188:191], a[12:15], a[124:127], v[188:191]
    ds_read_b128 a[64:67], v40 offset:57344
    ds_read_b32 a195, v59
    v_mfma_f32_16x16x32_bf16 v[188:191], a[8:11], a[120:123], v[188:191]
    buffer_load_dwordx4 v36, s[8:11], s3 offen offset:0 lds
    v_mfma_f32_16x16x32_bf16 v[192:195], a[40:43], a[72:75], v[192:195]
    v_perm_b32 v62, v100, v35, s36
    v_perm_b32 v60, v100, v35, s37
    v_mfma_f32_16x16x32_bf16 v[192:195], a[44:47], a[76:79], v[192:195]
    ds_read_b128 a[68:71], v41 offset:57344
    ds_read_b32 a196, v62
    v_mfma_f32_16x16x32_bf16 v[196:199], a[44:47], a[100:103], v[196:199]
    ds_read_b32 a197, v60
    v_perm_b32 v61, v100, v35, s38
    v_mfma_f32_16x16x32_bf16 v[196:199], a[40:43], a[96:99], v[196:199]
    ds_read_b32 a198, v61
    v_perm_b32 v63, v100, v35, s39
    v_mfma_f32_16x16x32_bf16 v[200:203], a[40:43], a[136:139], v[200:203]
    ds_read_b128 a[200:203], v40 offset:59392
    ds_read_b32 a199, v63
    v_mfma_f32_16x16x32_bf16 v[200:203], a[44:47], a[140:143], v[200:203]
    ds_read_b128 a[204:207], v41 offset:59392
    v_mfma_f32_16x16x32_bf16 v[204:207], a[44:47], a[84:87], v[204:207]
    buffer_load_dwordx4 v37, s[8:11], s3 offen offset:1024 lds
    v_mfma_f32_16x16x32_bf16 v[204:207], a[40:43], a[80:83], v[204:207]
    v_perm_b32 v56, v97, v35, s36
    v_perm_b32 v57, v97, v35, s37
    v_mfma_f32_16x16x32_bf16 v[208:211], a[40:43], a[176:179], v[208:211]
    ds_read_b32 a208, v56
    ds_read_b32 a209, v57
    v_mfma_f32_16x16x32_bf16 v[208:211], a[44:47], a[180:183], v[208:211]
    v_perm_b32 v58, v97, v35, s38
    v_perm_b32 v59, v97, v35, s39
    v_mfma_f32_16x16x32_bf16 v[212:215], a[44:47], a[108:111], v[212:215]
    ds_read_b128 a[224:227], v40 offset:61440
    ds_read_b32 a210, v58
    v_mfma_f32_16x16x32_bf16 v[212:215], a[40:43], a[104:107], v[212:215]
    ds_read_b32 a211, v59
    v_perm_b32 v62, v101, v35, s36
    v_mfma_f32_16x16x32_bf16 v[216:219], a[40:43], a[160:163], v[216:219]
    ds_read_b32 a212, v62
    ds_read_b128 a[228:231], v41 offset:61440
    v_mfma_f32_16x16x32_bf16 v[216:219], a[44:47], a[164:167], v[216:219]
    buffer_load_dwordx4 v38, s[8:11], s3 offen offset:2048 lds
    v_mfma_f32_16x16x32_bf16 v[220:223], a[44:47], a[124:127], v[220:223]
    s_waitcnt vmcnt(12)
    v_bitop3_b32 v60, v107, v111, s76 bitop3:0x7e
    v_perm_b32 v61, v101, v35, s37
    v_mfma_f32_16x16x32_bf16 v[220:223], a[40:43], a[120:123], v[220:223]
    ds_read_b32 a213, v61
    v_cmp_lt_u32 vcc, 0xffff, v60
    v_mfma_f32_16x16x32_bf16 v[224:227], a[56:59], a[74:77], v[224:227]
    s_waitcnt lgkmcnt(8)
    ds_read_b128 a[232:235], v40 offset:63488
    v_perm_b32 v63, v101, v35, s38
    v_mfma_f32_16x16x32_bf16 v[224:227], a[60:63], a[146:149], v[224:227]
    ds_read_b32 a214, v63
    s_cbranch_vccnz L_slow4_1
L_back4_1:
    v_mfma_f32_16x16x32_bf16 v[228:231], a[60:63], a[90:93], v[228:231]
    v_perm_b32 v56, v101, v35, s39
    v_perm_b32 v57, v98, v35, s36
    v_mfma_f32_16x16x32_bf16 v[228:231], a[56:59], a[98:101], v[228:231]
    ds_read_b128 a[236:239], v41 offset:63488
    ds_read_b32 a215, v56
    v_mfma_f32_16x16x32_bf16 v[232:235], a[56:59], a[138:141], v[232:235]
    buffer_load_dwordx4 v[88:91], v32, s[12:15], s45 offen sc1
    v_mfma_f32_16x16x32_bf16 v[232:235], a[60:63], a[170:173], v[232:235]
    ds_read_b32 a248, v57
    v_perm_b32 v58, v98, v35, s37
    v_mfma_f32_16x16x32_bf16 v[236:239], a[60:63], a[186:189], v[236:239]
    ds_read_b32 a249, v58
    v_perm_b32 v59, v98, v35, s38
    v_perm_b32 v62, v98, v35, s39
    v_mfma_f32_16x16x32_bf16 v[236:239], a[56:59], a[82:85], v[236:239]
    ds_read_b32 a250, v59
    ds_read_b32 a251, v62
    v_mfma_f32_16x16x32_bf16 v[240:243], a[56:59], a[178:181], v[240:243]
    buffer_load_dwordx4 v[92:95], v33, s[12:15], s45 offen sc1
    v_mfma_f32_16x16x32_bf16 v[240:243], a[60:63], a[66:69], v[240:243]
    v_perm_b32 v60, v102, v35, s36
    v_perm_b32 v61, v102, v35, s37
    v_mfma_f32_16x16x32_bf16 v[244:247], a[60:63], a[202:205], v[244:247]
    ds_read_b32 a252, v60
    ds_read_b32 a253, v61
    v_mfma_f32_16x16x32_bf16 v[244:247], a[56:59], a[106:109], v[244:247]
    s_waitcnt vmcnt(13) lgkmcnt(7)
    v_perm_b32 v63, v102, v35, s38
    v_perm_b32 v56, v102, v35, s39
    v_mfma_f32_16x16x32_bf16 v[248:251], a[56:59], a[162:165], v[248:251]
    s_barrier
    v_mfma_f32_16x16x32_bf16 v[248:251], a[60:63], a[226:229], v[248:251]
    ds_read_b32 a254, v63
    ds_read_b32 a255, v56
    v_mfma_f32_16x16x32_bf16 v[252:255], a[60:63], a[234:237], v[252:255]
    buffer_load_dwordx4 v39, s[8:11], s3 offen offset:3072 lds
    v_mfma_f32_16x16x32_bf16 v[252:255], a[56:59], a[122:125], v[252:255]
    s_add_u32 s56, s55, 1536
    v_perm_b32 v57, v99, v35, s36
    v_perm_b32 v58, v99, v35, s37
    v_mfma_f32_16x16x32_bf16 v[128:131], a[112:115], a[144:147], v[128:131]
    ds_read_b32 a32, v57
    ds_read_b32 a33, v58
    v_mfma_f32_16x16x32_bf16 v[128:131], a[116:119], a[148:151], v[128:131]
    s_add_u32 m0, s57, 32768
    v_perm_b32 v59, v103, v35, s36
    v_perm_b32 v62, v103, v35, s37
    v_mfma_f32_16x16x32_bf16 v[132:135], a[116:119], a[92:95], v[132:135]
    ds_read_b32 a34, v59
    ds_read_b32 a35, v62
    v_mfma_f32_16x16x32_bf16 v[132:135], a[112:115], a[88:91], v[132:135]
    buffer_load_dwordx4 v[48:51], v34, s[12:15], s45 offen sc1
    v_mfma_f32_16x16x32_bf16 v[136:139], a[112:115], a[168:171], v[136:139]
    v_perm_b32 v60, v107, v35, s36
    v_perm_b32 v61, v107, v35, s37
    v_mfma_f32_16x16x32_bf16 v[136:139], a[116:119], a[172:175], v[136:139]
    ds_read_b32 a36, v60
    ds_read_b32 a37, v61
    v_mfma_f32_16x16x32_bf16 v[140:143], a[116:119], a[188:191], v[140:143]
    v_perm_b32 v63, v111, v35, s36
    v_perm_b32 v56, v111, v35, s37
    v_mfma_f32_16x16x32_bf16 v[140:143], a[112:115], a[184:187], v[140:143]
    ds_read_b32 a38, v63
    ds_read_b32 a39, v56
    v_mfma_f32_16x16x32_bf16 v[144:147], a[112:115], a[64:67], v[144:147]
    buffer_load_dwordx4 v[52:55], v44, s[12:15], s45 offen sc1
    v_mfma_f32_16x16x32_bf16 v[144:147], a[116:119], a[68:71], v[144:147]
    s_waitcnt vmcnt(14)
    v_bitop3_b32 v57, v115, v119, s76 bitop3:0x7e
    v_perm_b32 v58, v104, v35, s36
    v_mfma_f32_16x16x32_bf16 v[148:151], a[116:119], a[204:207], v[148:151]
    ds_read_b32 a0, v58
    v_cmp_lt_u32 vcc, 0xffff, v57
    v_mfma_f32_16x16x32_bf16 v[148:151], a[112:115], a[200:203], v[148:151]
    ds_read_b128 a[48:51], v42 offset:0
    v_perm_b32 v59, v104, v35, s37
    v_mfma_f32_16x16x32_bf16 v[152:155], a[112:115], a[224:227], v[152:155]
    ds_read_b128 a[52:55], v43 offset:0
    ds_read_b32 a1, v59
    v_mfma_f32_16x16x32_bf16 v[152:155], a[116:119], a[228:231], v[152:155]
    v_perm_b32 v62, v104, v35, s38
    s_cbranch_vccnz L_slow5_0
L_back5_0:
    v_mfma_f32_16x16x32_bf16 v[156:159], a[116:119], a[236:239], v[156:159]
    s_add_u32 s3, s69, 1536
    ds_read_b128 a[16:19], v42 offset:2048
    ds_read_b32 a2, v62
    v_mfma_f32_16x16x32_bf16 v[156:159], a[112:115], a[232:235], v[156:159]
    buffer_load_dwordx4 v36, s[8:11], s56 offen offset:0 lds
    v_mfma_f32_16x16x32_bf16 v[160:163], a[128:131], a[144:147], v[160:163]
    ds_read_b128 a[20:23], v43 offset:2048
    v_perm_b32 v60, v104, v35, s39
    v_mfma_f32_16x16x32_bf16 v[160:163], a[132:135], a[148:151], v[160:163]
    ds_read_b32 a3, v60
    v_perm_b32 v61, v108, v35, s36
    v_mfma_f32_16x16x32_bf16 v[164:167], a[132:135], a[92:95], v[164:167]
    ds_read_b128 a[216:219], v42 offset:4096
    ds_read_b32 a4, v61
    v_mfma_f32_16x16x32_bf16 v[164:167], a[128:131], a[88:91], v[164:167]
    v_perm_b32 v63, v108, v35, s37
    v_perm_b32 v56, v108, v35, s38
    v_mfma_f32_16x16x32_bf16 v[168:171], a[128:131], a[168:171], v[168:171]
    ds_read_b32 a5, v63
    ds_read_b32 a6, v56
    v_mfma_f32_16x16x32_bf16 v[168:171], a[132:135], a[172:175], v[168:171]
    ds_read_b128 a[220:223], v43 offset:4096
    v_perm_b32 v57, v108, v35, s39
    v_mfma_f32_16x16x32_bf16 v[172:175], a[132:135], a[188:191], v[172:175]
    ds_read_b32 a7, v57
    ds_read_b128 a[24:27], v42 offset:6144
    v_mfma_f32_16x16x32_bf16 v[172:175], a[128:131], a[184:187], v[172:175]
    buffer_load_dwordx4 v37, s[8:11], s56 offen offset:1024 lds
    v_mfma_f32_16x16x32_bf16 v[176:179], a[128:131], a[64:67], v[176:179]
    v_perm_b32 v58, v105, v35, s36
    v_perm_b32 v59, v105, v35, s37
    v_mfma_f32_16x16x32_bf16 v[176:179], a[132:135], a[68:71], v[176:179]
    ds_read_b32 a240, v58
    ds_read_b32 a241, v59
    v_mfma_f32_16x16x32_bf16 v[180:183], a[132:135], a[204:207], v[180:183]
    v_perm_b32 v62, v105, v35, s38
    v_perm_b32 v60, v105, v35, s39
    v_mfma_f32_16x16x32_bf16 v[180:183], a[128:131], a[200:203], v[180:183]
    ds_read_b128 a[28:31], v43 offset:6144
    ds_read_b32 a242, v62
    v_mfma_f32_16x16x32_bf16 v[184:187], a[128:131], a[224:227], v[184:187]
    ds_read_b32 a243, v60
    v_perm_b32 v61, v109, v35, s36
    v_mfma_f32_16x16x32_bf16 v[184:187], a[132:135], a[228:231], v[184:187]
    ds_read_b32 a244, v61
    ds_read_b128 a[8:11], v42 offset:8192
    v_mfma_f32_16x16x32_bf16 v[188:191], a[132:135], a[236:239], v[188:191]
    buffer_load_dwordx4 v38, s[8:11], s56 offen offset:2048 lds
    v_mfma_f32_16x16x32_bf16 v[188:191], a[128:131], a[232:235], v[188:191]
    v_perm_b32 v63, v109, v35, s37
    v_perm_b32 v56, v109, v35, s38
    v_mfma_f32_16x16x32_bf16 v[192:195], a[152:155], a[144:147], v[192:195]
    ds_read_b32 a245, v63
    ds_read_b32 a246, v56
    v_mfma_f32_16x16x32_bf16 v[192:195], a[156:159], a[148:151], v[192:195]
    ds_read_b128 a[12:15], v43 offset:8192
    v_perm_b32 v57, v109, v35, s39
    v_mfma_f32_16x16x32_bf16 v[196:199], a[156:159], a[92:95], v[196:199]
    ds_read_b32 a247, v57
    v_perm_b32 v58, v106, v35, s36
    v_mfma_f32_16x16x32_bf16 v[196:199], a[152:155], a[88:91], v[196:199]
    ds_read_b32 a40, v58
    v_perm_b32 v59, v106, v35, s37
    v_mfma_f32_16x16x32_bf16 v[200:203], a[152:155], a[168:171], v[200:203]
    ds_read_b128 a[72:75], v42 offset:10240
    ds_read_b32 a41, v59
    v_mfma_f32_16x16x32_bf16 v[200:203], a[156:159], a[172:175], v[200:203]
    buffer_load_dwordx4 v39, s[8:11], s56 offen offset:3072 lds
    v_mfma_f32_16x16x32_bf16 v[204:207], a[156:159], a[188:191], v[204:207]
    s_add_u32 m0, s57, 49152
    v_perm_b32 v62, v106, v35, s38
    v_perm_b32 v60, v106, v35, s39
    v_mfma_f32_16x16x32_bf16 v[204:207], a[152:155], a[184:187], v[204:207]
    s_add_u32 s56, s55, 1792
    ds_read_b128 a[76:79], v43 offset:10240
    ds_read_b32 a42, v62
    v_mfma_f32_16x16x32_bf16 v[208:211], a[152:155], a[64:67], v[208:211]
    ds_read_b32 a43, v60
    v_perm_b32 v61, v110, v35, s36
    v_mfma_f32_16x16x32_bf16 v[208:211], a[156:159], a[68:71], v[208:211]
    ds_read_b32 a44, v61
    v_perm_b32 v63, v110, v35, s37
    v_mfma_f32_16x16x32_bf16 v[212:215], a[156:159], a[204:207], v[212:215]
    ds_read_b128 a[96:99], v42 offset:12288
    ds_read_b32 a45, v63
    v_mfma_f32_16x16x32_bf16 v[212:215], a[152:155], a[200:203], v[212:215]
    v_perm_b32 v56, v110, v35, s38
    v_perm_b32 v57, v110, v35, s39
    v_mfma_f32_16x16x32_bf16 v[216:219], a[152:155], a[224:227], v[216:219]
    ds_read_b32 a46, v56
    ds_read_b32 a47, v57
    v_mfma_f32_16x16x32_bf16 v[216:219], a[156:159], a[228:231], v[216:219]
    buffer_load_dwordx4 v36, s[8:11], s3 offen offset:0 lds
    v_mfma_f32_16x16x32_bf16 v[220:223], a[156:159], a[236:239], v[220:223]
    ds_read_b128 a[100:103], v43 offset:12288
    v_perm_b32 v58, v112, v35, s36
    v_mfma_f32_16x16x32_bf16 v[220:223], a[152:155], a[232:235], v[220:223]
    s_waitcnt lgkmcnt(9)
    ds_read_b32 a136, v58
    v_perm_b32 v59, v112, v35, s37
    v_mfma_f32_16x16x32_bf16 v[128:131], a[192:195], a[48:51], v[128:131]
    ds_read_b128 a[80:83], v42 offset:14336
    ds_read_b32 a137, v59
    v_mfma_f32_16x16x32_bf16 v[128:131], a[196:199], a[52:55], v[128:131]
    v_perm_b32 v62, v112, v35, s38
    v_perm_b32 v60, v112, v35, s39
    v_mfma_f32_16x16x32_bf16 v[132:135], a[196:199], a[20:23], v[132:135]
    ds_read_b128 a[84:87], v43 offset:14336
    ds_read_b32 a138, v62
    v_mfma_f32_16x16x32_bf16 v[132:135], a[192:195], a[16:19], v[132:135]
    ds_read_b32 a139, v60
    ds_read_b128 a[176:179], v42 offset:16384
    v_mfma_f32_16x16x32_bf16 v[136:139], a[192:195], a[216:219], v[136:139]
    buffer_load_dwordx4 v37, s[8:11], s3 offen offset:1024 lds
    v_mfma_f32_16x16x32_bf16 v[136:139], a[196:199], a[220:223], v[136:139]
    s_waitcnt vmcnt(16)
    v_bitop3_b32 v61, v123, v127, s76 bitop3:0x7e
    v_perm_b32 v63, v116, v35, s36
    v_mfma_f32_16x16x32_bf16 v[140:143], a[196:199], a[28:31], v[140:143]
    ds_read_b32 a140, v63
    v_cmp_lt_u32 vcc, 0xffff, v61
    v_mfma_f32_16x16x32_bf16 v[140:143], a[192:195], a[24:27], v[140:143]
    v_perm_b32 v56, v116, v35, s37
    v_perm_b32 v57, v116, v35, s38
    v_mfma_f32_16x16x32_bf16 v[144:147], a[192:195], a[8:11], v[144:147]
    ds_read_b32 a141, v56
    ds_read_b32 a142, v57
    v_mfma_f32_16x16x32_bf16 v[144:147], a[196:199], a[12:15], v[144:147]
    s_waitcnt lgkmcnt(7)
    v_perm_b32 v58, v116, v35, s39
    s_cbranch_vccnz L_slow5_1
L_back5_1:
    v_mfma_f32_16x16x32_bf16 v[148:151], a[196:199], a[76:79], v[148:151]
    ds_read_b32 a143, v58
    v_perm_b32 v59, v113, v35, s36
    v_mfma_f32_16x16x32_bf16 v[148:151], a[192:195], a[72:75], v[148:151]
    ds_read_b32 a104, v59
    ds_read_b128 a[180:183], v43 offset:16384
    v_mfma_f32_16x16x32_bf16 v[152:155], a[192:195], a[96:99], v[152:155]
    buffer_load_dwordx4 v38, s[8:11], s3 offen offset:2048 lds
    v_mfma_f32_16x16x32_bf16 v[152:155], a[196:199], a[100:103], v[152:155]
    s_waitcnt lgkmcnt(6)
    ds_read_b128 a[160:163], v42 offset:18432
    v_perm_b32 v62, v113, v35, s37
    v_mfma_f32_16x16x32_bf16 v[156:159], a[196:199], a[84:87], v[156:159]
    ds_read_b32 a105, v62
    v_perm_b32 v60, v113, v35, s38
    v_mfma_f32_16x16x32_bf16 v[156:159], a[192:195], a[80:83], v[156:159]
    ds_read_b128 a[164:167], v43 offset:18432
    ds_read_b32 a106, v60
    v_mfma_f32_16x16x32_bf16 v[160:163], a[208:211], a[48:51], v[160:163]
    v_perm_b32 v61, v113, v35, s39
    v_perm_b32 v63, v117, v35, s36
    v_mfma_f32_16x16x32_bf16 v[160:163], a[212:215], a[52:55], v[160:163]
    ds_read_b32 a107, v61
    ds_read_b32 a108, v63
    v_mfma_f32_16x16x32_bf16 v[164:167], a[212:215], a[20:23], v[164:167]
    ds_read_b128 a[56:59], v42 offset:20480
    v_mfma_f32_16x16x32_bf16 v[164:167], a[208:211], a[16:19], v[164:167]
    buffer_load_dwordx4 v39, s[8:11], s3 offen offset:3072 lds
    v_mfma_f32_16x16x32_bf16 v[168:171], a[208:211], a[216:219], v[168:171]
    s_add_u32 m0, s57, 65536
    v_perm_b32 v56, v117, v35, s37
    v_perm_b32 v57, v117, v35, s38
    v_mfma_f32_16x16x32_bf16 v[168:171], a[212:215], a[220:223], v[168:171]
    s_add_u32 s3, s69, 1792
    ds_read_b128 a[60:63], v43 offset:20480
    ds_read_b32 a109, v56
    v_mfma_f32_16x16x32_bf16 v[172:175], a[212:215], a[28:31], v[172:175]
    ds_read_b32 a110, v57
    ds_read_b128 a[120:123], v42 offset:22528
    v_mfma_f32_16x16x32_bf16 v[172:175], a[208:211], a[24:27], v[172:175]
    buffer_load_dwordx4 v[64:67], v22, s[32:35], 0 offen
    v_mfma_f32_16x16x32_bf16 v[176:179], a[208:211], a[8:11], v[176:179]
    v_perm_b32 v58, v117, v35, s39
    v_perm_b32 v59, v114, v35, s36
    v_mfma_f32_16x16x32_bf16 v[176:179], a[212:215], a[12:15], v[176:179]
    ds_read_b32 a111, v58
    ds_read_b32 a112, v59
    v_mfma_f32_16x16x32_bf16 v[180:183], a[212:215], a[76:79], v[180:183]
    ds_read_b128 a[124:127], v43 offset:22528
    v_mfma_f32_16x16x32_bf16 v[180:183], a[208:211], a[72:75], v[180:183]
    buffer_load_dwordx4 v[68:71], v32, s[12:15], s72 offen sc1
    v_mfma_f32_16x16x32_bf16 v[184:187], a[208:211], a[96:99], v[184:187]
    v_perm_b32 v62, v114, v35, s37
    v_perm_b32 v60, v114, v35, s38
    v_mfma_f32_16x16x32_bf16 v[184:187], a[212:215], a[100:103], v[184:187]
    ds_read_b32 a113, v62
    ds_read_b32 a114, v60
    v_mfma_f32_16x16x32_bf16 v[188:191], a[212:215], a[84:87], v[188:191]
    ds_read_b128 a[128:131], v42 offset:24576
    v_mfma_f32_16x16x32_bf16 v[188:191], a[208:211], a[80:83], v[188:191]
    buffer_load_dwordx4 v[72:75], v33, s[12:15], s72 offen sc1
    v_mfma_f32_16x16x32_bf16 v[192:195], a[248:251], a[48:51], v[192:195]
    v_perm_b32 v61, v114, v35, s39
    v_perm_b32 v63, v118, v35, s36
    v_mfma_f32_16x16x32_bf16 v[192:195], a[252:255], a[52:55], v[192:195]
    ds_read_b128 a[132:135], v43 offset:24576
    ds_read_b32 a115, v61
    v_mfma_f32_16x16x32_bf16 v[196:199], a[252:255], a[20:23], v[196:199]
    ds_read_b32 a116, v63
    ds_read_b128 a[144:147], v42 offset:26624
    v_mfma_f32_16x16x32_bf16 v[196:199], a[248:251], a[16:19], v[196:199]
    buffer_load_dwordx4 v[76:79], v34, s[12:15], s72 offen sc1
    v_mfma_f32_16x16x32_bf16 v[200:203], a[248:251], a[216:219], v[200:203]
    v_perm_b32 v56, v118, v35, s37
    v_perm_b32 v57, v118, v35, s38
    v_mfma_f32_16x16x32_bf16 v[200:203], a[252:255], a[220:223], v[200:203]
    ds_read_b32 a117, v56
    ds_read_b32 a118, v57
    v_mfma_f32_16x16x32_bf16 v[204:207], a[252:255], a[28:31], v[204:207]
    ds_read_b128 a[148:151], v43 offset:26624
    v_mfma_f32_16x16x32_bf16 v[204:207], a[248:251], a[24:27], v[204:207]
    buffer_load_dwordx4 v[80:83], v44, s[12:15], s72 offen sc1
    v_mfma_f32_16x16x32_bf16 v[208:211], a[248:251], a[8:11], v[208:211]
    v_perm_b32 v58, v118, v35, s39
    v_perm_b32 v59, v115, v35, s36
    v_mfma_f32_16x16x32_bf16 v[208:211], a[252:255], a[12:15], v[208:211]
    ds_read_b32 a119, v58
    ds_read_b32 a88, v59
    v_mfma_f32_16x16x32_bf16 v[212:215], a[252:255], a[76:79], v[212:215]
    ds_read_b128 a[168:171], v42 offset:28672
    v_mfma_f32_16x16x32_bf16 v[212:215], a[248:251], a[72:75], v[212:215]
    buffer_load_dwordx2 v[84:85], v22, s[32:35], 0 offen offset:16
    v_mfma_f32_16x16x32_bf16 v[216:219], a[248:251], a[96:99], v[216:219]
    v_perm_b32 v62, v115, v35, s37
    v_perm_b32 v60, v119, v35, s36
    v_mfma_f32_16x16x32_bf16 v[216:219], a[252:255], a[100:103], v[216:219]
    ds_read_b128 a[172:175], v43 offset:28672
    ds_read_b32 a89, v62
    v_perm_b32 v61, v119, v35, s37
    v_mfma_f32_16x16x32_bf16 v[220:223], a[252:255], a[84:87], v[220:223]
    s_waitcnt lgkmcnt(6)
    ds_read_b32 a90, v60
    ds_read_b32 a91, v61
    v_mfma_f32_16x16x32_bf16 v[220:223], a[248:251], a[80:83], v[220:223]
    buffer_load_dword v86, v23, s[32:35], 0 offen
    v_mfma_f32_16x16x32_bf16 v[224:227], a[32:35], a[50:53], v[224:227]
    ds_read_b128 a[184:187], v42 offset:30720
    v_perm_b32 v63, v123, v35, s36
    v_perm_b32 v56, v123, v35, s37
    v_mfma_f32_16x16x32_bf16 v[224:227], a[36:39], a[178:181], v[224:227]
    ds_read_b32 a92, v63
    ds_read_b32 a93, v56
    v_mfma_f32_16x16x32_bf16 v[228:231], a[36:39], a[162:165], v[228:231]
    ds_read_b128 a[188:191], v43 offset:30720
    v_perm_b32 v57, v127, v35, s36
    v_mfma_f32_16x16x32_bf16 v[228:231], a[32:35], a[18:21], v[228:231]
    ds_read_b32 a94, v57
    v_perm_b32 v58, v127, v35, s37
    v_mfma_f32_16x16x32_bf16 v[232:235], a[32:35], a[218:221], v[232:235]
    s_waitcnt vmcnt(18)
    ds_read_b32 a95, v58
    v_bitop3_b32 v59, v91, v95, s76 bitop3:0x7e
    v_mfma_f32_16x16x32_bf16 v[232:235], a[36:39], a[58:61], v[232:235]
    v_cmp_lt_u32 vcc, 0xffff, v59
    v_perm_b32 v62, v120, v35, s36
    v_mfma_f32_16x16x32_bf16 v[236:239], a[36:39], a[122:125], v[236:239]
    ds_read_b32 a64, v62
    v_perm_b32 v60, v120, v35, s37
    v_mfma_f32_16x16x32_bf16 v[236:239], a[32:35], a[26:29], v[236:239]
    ds_read_b32 a65, v60
    s_cbranch_vccnz L_slow6_0
L_back6_0:
    v_mfma_f32_16x16x32_bf16 v[240:243], a[32:35], a[10:13], v[240:243]
    v_perm_b32 v61, v120, v35, s38
    v_perm_b32 v63, v120, v35, s39
    v_mfma_f32_16x16x32_bf16 v[240:243], a[36:39], a[130:133], v[240:243]
    s_waitcnt lgkmcnt(7)
    ds_read_b32 a66, v61
    ds_read_b32 a67, v63
    v_mfma_f32_16x16x32_bf16 v[244:247], a[36:39], a[146:149], v[244:247]
    s_waitcnt vmcnt(15)
    v_bitop3_b32 v56, v51, v55, s76 bitop3:0x7e
    v_perm_b32 v57, v124, v35, s36
    v_mfma_f32_16x16x32_bf16 v[244:247], a[32:35], a[74:77], v[244:247]
    s_waitcnt lgkmcnt(6)
    ds_read_b32 a68, v57
    v_cmp_lt_u32 vcc, 0xffff, v56
    v_mfma_f32_16x16x32_bf16 v[248:251], a[32:35], a[98:101], v[248:251]
    s_barrier
    v_mfma_f32_16x16x32_bf16 v[248:251], a[36:39], a[170:173], v[248:251]
    buffer_load_dwordx4 v36, s[8:11], s56 offen offset:0 lds
    v_mfma_f32_16x16x32_bf16 v[252:255], a[36:39], a[186:189], v[252:255]
    v_perm_b32 v58, v124, v35, s37
    s_cbranch_vccnz L_slow6_1
L_back6_1:
    v_mfma_f32_16x16x32_bf16 v[252:255], a[32:35], a[82:85], v[252:255]
    ds_read_b32 a69, v58
    v_perm_b32 v59, v124, v35, s38
    v_perm_b32 v62, v124, v35, s39
    v_mfma_f32_16x16x32_bf16 v[128:131], a[0:3], a[176:179], v[128:131]
    ds_read_b32 a70, v59
    ds_read_b32 a71, v62
    v_mfma_f32_16x16x32_bf16 v[128:131], a[4:7], a[180:183], v[128:131]
    buffer_load_dwordx4 v37, s[8:11], s56 offen offset:1024 lds
    v_mfma_f32_16x16x32_bf16 v[132:135], a[4:7], a[164:167], v[132:135]
    v_perm_b32 v60, v121, v35, s36
    v_perm_b32 v61, v121, v35, s37
    v_mfma_f32_16x16x32_bf16 v[132:135], a[0:3], a[160:163], v[132:135]
    ds_read_b32 a200, v60
    ds_read_b32 a201, v61
    v_mfma_f32_16x16x32_bf16 v[136:139], a[0:3], a[56:59], v[136:139]
    ds_read_b128 a[224:227], v40 offset:0
L_pad3:
    s_cbranch_execz L_pad4
    v_mfma_f32_16x16x32_bf16 v[136:139], a[4:7], a[60:63], v[136:139]
    buffer_load_dwordx4 v38, s[8:11], s56 offen offset:2048 lds
    v_mfma_f32_16x16x32_bf16 v[140:143], a[4:7], a[124:127], v[140:143]
    v_perm_b32 v63, v121, v35, s38
    v_perm_b32 v56, v121, v35, s39
    v_mfma_f32_16x16x32_bf16 v[140:143], a[0:3], a[120:123], v[140:143]
    ds_read_b32 a202, v63
    ds_read_b32 a203, v56
    v_perm_b32 v57, v125, v35, s36
    v_mfma_f32_16x16x32_bf16 v[144:147], a[0:3], a[128:131], v[144:147]
    ds_read_b32 a204, v57
    ds_read_b128 a[228:231], v41 offset:0
    v_mfma_f32_16x16x32_bf16 v[144:147], a[4:7], a[132:135], v[144:147]
    buffer_load_dwordx4 v39, s[8:11], s56 offen offset:3072 lds
    v_mfma_f32_16x16x32_bf16 v[148:151], a[4:7], a[148:151], v[148:151]
    s_add_u32 m0, s57, 81920
    v_perm_b32 v58, v125, v35, s37
    v_perm_b32 v59, v125, v35, s38
    v_mfma_f32_16x16x32_bf16 v[148:151], a[0:3], a[144:147], v[148:151]
    ds_read_b32 a205, v58
    ds_read_b32 a206, v59
    v_mfma_f32_16x16x32_bf16 v[152:155], a[0:3], a[168:171], v[152:155]
    ds_read_b128 a[152:155], v40 offset:2048
    v_mfma_f32_16x16x32_bf16 v[152:155], a[4:7], a[172:175], v[152:155]
    buffer_load_dwordx4 v36, s[8:11], s3 offen offset:0 lds
    v_mfma_f32_16x16x32_bf16 v[156:159], a[4:7], a[188:191], v[156:159]
    v_perm_b32 v62, v125, v35, s39
    v_perm_b32 v60, v122, v35, s36
    v_mfma_f32_16x16x32_bf16 v[156:159], a[0:3], a[184:187], v[156:159]
    ds_read_b128 a[156:159], v41 offset:2048
    ds_read_b32 a207, v62
    v_perm_b32 v61, v122, v35, s37
    v_mfma_f32_16x16x32_bf16 v[160:163], a[240:243], a[176:179], v[160:163]
    ds_read_b32 a232, v60
    ds_read_b32 a233, v61
    v_mfma_f32_16x16x32_bf16 v[160:163], a[244:247], a[180:183], v[160:163]
    ds_read_b128 a[192:195], v40 offset:4096
    v_mfma_f32_16x16x32_bf16 v[164:167], a[244:247], a[164:167], v[164:167]
    buffer_load_dwordx4 v37, s[8:11], s3 offen offset:1024 lds
    v_mfma_f32_16x16x32_bf16 v[164:167], a[240:243], a[160:163], v[164:167]
    v_perm_b32 v63, v122, v35, s38
    v_perm_b32 v56, v122, v35, s39
    v_mfma_f32_16x16x32_bf16 v[168:171], a[240:243], a[56:59], v[168:171]
    ds_read_b32 a234, v63
    ds_read_b32 a235, v56
    v_perm_b32 v57, v126, v35, s36
    v_mfma_f32_16x16x32_bf16 v[168:171], a[244:247], a[60:63], v[168:171]
    ds_read_b128 a[196:199], v41 offset:4096
    ds_read_b32 a236, v57
    v_perm_b32 v58, v126, v35, s37
    v_mfma_f32_16x16x32_bf16 v[172:175], a[244:247], a[124:127], v[172:175]
    ds_read_b32 a237, v58
    v_perm_b32 v59, v126, v35, s38
    v_mfma_f32_16x16x32_bf16 v[172:175], a[240:243], a[120:123], v[172:175]
    ds_read_b32 a238, v59
    v_perm_b32 v62, v126, v35, s39
    v_mfma_f32_16x16x32_bf16 v[176:179], a[240:243], a[128:131], v[176:179]
    ds_read_b128 a[208:211], v40 offset:6144
    ds_read_b32 a239, v62
    v_mfma_f32_16x16x32_bf16 v[176:179], a[244:247], a[132:135], v[176:179]
    ds_read_b128 a[212:215], v41 offset:6144
    v_mfma_f32_16x16x32_bf16 v[180:183], a[244:247], a[148:151], v[180:183]
    buffer_load_dwordx4 v38, s[8:11], s3 offen offset:2048 lds
    v_mfma_f32_16x16x32_bf16 v[180:183], a[240:243], a[144:147], v[180:183]
    v_perm_b32 v60, v91, v35, s36
    v_perm_b32 v61, v91, v35, s37
    v_mfma_f32_16x16x32_bf16 v[184:187], a[240:243], a[168:171], v[184:187]
    ds_read_b32 a248, v60
    ds_read_b32 a249, v61
    v_mfma_f32_16x16x32_bf16 v[184:187], a[244:247], a[172:175], v[184:187]
    v_perm_b32 v63, v95, v35, s36
    v_perm_b32 v56, v95, v35, s37
    v_mfma_f32_16x16x32_bf16 v[188:191], a[244:247], a[188:191], v[188:191]
    ds_read_b128 a[48:51], v40 offset:8192
    ds_read_b32 a250, v63
    v_mfma_f32_16x16x32_bf16 v[188:191], a[240:243], a[184:187], v[188:191]
    ds_read_b32 a251, v56
    v_perm_b32 v57, v51, v35, s36
    v_mfma_f32_16x16x32_bf16 v[192:195], a[40:43], a[176:179], v[192:195]
    ds_read_b32 a252, v57
    ds_read_b128 a[52:55], v41 offset:8192
    v_mfma_f32_16x16x32_bf16 v[192:195], a[44:47], a[180:183], v[192:195]
    buffer_load_dwordx4 v39, s[8:11], s3 offen offset:3072 lds
    v_mfma_f32_16x16x32_bf16 v[196:199], a[44:47], a[164:167], v[196:199]
    v_perm_b32 v58, v51, v35, s37
    v_perm_b32 v59, v55, v35, s36
    v_mfma_f32_16x16x32_bf16 v[196:199], a[40:43], a[160:163], v[196:199]
    ds_read_b32 a253, v58
    ds_read_b32 a254, v59
    v_mfma_f32_16x16x32_bf16 v[200:203], a[40:43], a[56:59], v[200:203]
    ds_read_b128 a[16:19], v40 offset:10240
    v_perm_b32 v62, v55, v35, s37
    v_mfma_f32_16x16x32_bf16 v[200:203], a[44:47], a[60:63], v[200:203]
    ds_read_b32 a255, v62
    v_perm_b32 v60, v88, v35, s36
    v_mfma_f32_16x16x32_bf16 v[204:207], a[44:47], a[124:127], v[204:207]
    ds_read_b32 a216, v60
    v_perm_b32 v61, v88, v35, s37
    v_mfma_f32_16x16x32_bf16 v[204:207], a[40:43], a[120:123], v[204:207]
    ds_read_b128 a[20:23], v41 offset:10240
    ds_read_b32 a217, v61
    v_mfma_f32_16x16x32_bf16 v[208:211], a[40:43], a[128:131], v[208:211]
    v_perm_b32 v63, v88, v35, s38
    v_perm_b32 v56, v88, v35, s39
    v_mfma_f32_16x16x32_bf16 v[208:211], a[44:47], a[132:135], v[208:211]
    ds_read_b32 a218, v63
    ds_read_b32 a219, v56
    v_mfma_f32_16x16x32_bf16 v[212:215], a[44:47], a[148:151], v[212:215]
    ds_read_b128 a[24:27], v40 offset:12288
    v_perm_b32 v57, v92, v35, s36
    v_mfma_f32_16x16x32_bf16 v[212:215], a[40:43], a[144:147], v[212:215]
    ds_read_b32 a220, v57
    v_perm_b32 v58, v92, v35, s37
    v_mfma_f32_16x16x32_bf16 v[216:219], a[40:43], a[168:171], v[216:219]
    ds_read_b32 a221, v58
    v_perm_b32 v59, v92, v35, s38
    v_mfma_f32_16x16x32_bf16 v[216:219], a[44:47], a[172:175], v[216:219]
    ds_read_b128 a[28:31], v41 offset:12288
    ds_read_b32 a222, v59
    v_mfma_f32_16x16x32_bf16 v[220:223], a[44:47], a[188:191], v[220:223]
    v_perm_b32 v62, v92, v35, s39
    v_perm_b32 v60, v48, v35, s36
    v_mfma_f32_16x16x32_bf16 v[220:223], a[40:43], a[184:187], v[220:223]
    s_waitcnt lgkmcnt(9)
    ds_read_b32 a223, v62
    ds_read_b32 a8, v60
    v_mfma_f32_16x16x32_bf16 v[128:131], a[136:139], a[224:227], v[128:131]
    v_perm_b32 v61, v48, v35, s37
    v_perm_b32 v63, v48, v35, s38
    v_mfma_f32_16x16x32_bf16 v[128:131], a[140:143], a[228:231], v[128:131]
    ds_read_b32 a9, v61
    ds_read_b32 a10, v63
    v_mfma_f32_16x16x32_bf16 v[132:135], a[140:143], a[156:159], v[132:135]
    v_perm_b32 v56, v48, v35, s39
    v_perm_b32 v57, v52, v35, s36
    v_mfma_f32_16x16x32_bf16 v[132:135], a[136:139], a[152:155], v[132:135]
    ds_read_b32 a11, v56
    ds_read_b32 a12, v57
    v_mfma_f32_16x16x32_bf16 v[136:139], a[136:139], a[192:195], v[136:139]
    v_perm_b32 v58, v52, v35, s37
    v_perm_b32 v59, v52, v35, s38
    v_mfma_f32_16x16x32_bf16 v[136:139], a[140:143], a[196:199], v[136:139]
    ds_read_b32 a13, v58
    ds_read_b32 a14, v59
    v_mfma_f32_16x16x32_bf16 v[140:143], a[140:143], a[212:215], v[140:143]
    ds_read_b128 a[72:75], v40 offset:16384
    v_perm_b32 v62, v52, v35, s39
    v_mfma_f32_16x16x32_bf16 v[140:143], a[136:139], a[208:211], v[140:143]
    ds_read_b32 a15, v62
    v_perm_b32 v60, v89, v35, s36
    v_mfma_f32_16x16x32_bf16 v[144:147], a[136:139], a[48:51], v[144:147]
    ds_read_b32 a96, v60
    v_perm_b32 v61, v89, v35, s37
    v_mfma_f32_16x16x32_bf16 v[144:147], a[140:143], a[52:55], v[144:147]
    s_waitcnt lgkmcnt(9)
    ds_read_b128 a[76:79], v41 offset:16384
    ds_read_b32 a97, v61
    v_mfma_f32_16x16x32_bf16 v[148:151], a[140:143], a[20:23], v[148:151]
    v_perm_b32 v63, v89, v35, s38
    v_perm_b32 v56, v89, v35, s39
    v_mfma_f32_16x16x32_bf16 v[148:151], a[136:139], a[16:19], v[148:151]
    ds_read_b32 a98, v63
    ds_read_b32 a99, v56
    v_mfma_f32_16x16x32_bf16 v[152:155], a[136:139], a[24:27], v[152:155]
    ds_read_b128 a[32:35], v40 offset:18432
    v_perm_b32 v57, v93, v35, s36
    v_mfma_f32_16x16x32_bf16 v[152:155], a[140:143], a[28:31], v[152:155]
    ds_read_b32 a100, v57
    v_perm_b32 v58, v93, v35, s37
    v_mfma_f32_16x16x32_bf16 v[160:163], a[104:107], a[224:227], v[160:163]
    ds_read_b32 a101, v58
    v_perm_b32 v59, v93, v35, s38
    v_mfma_f32_16x16x32_bf16 v[160:163], a[108:111], a[228:231], v[160:163]
    ds_read_b128 a[36:39], v41 offset:18432
    ds_read_b32 a102, v59
    v_mfma_f32_16x16x32_bf16 v[164:167], a[108:111], a[156:159], v[164:167]
    s_waitcnt vmcnt(12)
    v_perm_b32 v60, v93, v35, s39
    v_bitop3_b32 v62, v71, v75, s76 bitop3:0x7e
    v_mfma_f32_16x16x32_bf16 v[164:167], a[104:107], a[152:155], v[164:167]
    ds_read_b32 a103, v60
    v_cmp_lt_u32 vcc, 0xffff, v62
    v_mfma_f32_16x16x32_bf16 v[168:171], a[104:107], a[192:195], v[168:171]
    ds_read_b128 a[80:83], v40 offset:20480
    v_perm_b32 v61, v49, v35, s36
    v_mfma_f32_16x16x32_bf16 v[168:171], a[108:111], a[196:199], v[168:171]
    ds_read_b32 a0, v61
    s_cbranch_vccnz L_slow7_0
L_back7_0:
    v_mfma_f32_16x16x32_bf16 v[172:175], a[108:111], a[212:215], v[172:175]
    v_perm_b32 v63, v49, v35, s37
    v_perm_b32 v56, v49, v35, s38
    v_mfma_f32_16x16x32_bf16 v[172:175], a[104:107], a[208:211], v[172:175]
    ds_read_b128 a[84:87], v41 offset:20480
    ds_read_b32 a1, v63
    v_mfma_f32_16x16x32_bf16 v[176:179], a[104:107], a[48:51], v[176:179]
    ds_read_b32 a2, v56
    v_perm_b32 v57, v49, v35, s39
    v_mfma_f32_16x16x32_bf16 v[176:179], a[108:111], a[52:55], v[176:179]
    s_waitcnt vmcnt(10)
    ds_read_b32 a3, v57
    v_bitop3_b32 v58, v79, v83, s76 bitop3:0x7e
    v_mfma_f32_16x16x32_bf16 v[180:183], a[108:111], a[20:23], v[180:183]
    ds_read_b128 a[240:243], v40 offset:22528
    v_cmp_lt_u32 vcc, 0xffff, v58
    v_mfma_f32_16x16x32_bf16 v[180:183], a[104:107], a[16:19], v[180:183]
    v_perm_b32 v59, v53, v35, s36
    v_perm_b32 v62, v53, v35, s37
    v_mfma_f32_16x16x32_bf16 v[184:187], a[104:107], a[24:27], v[184:187]
    ds_read_b32 a4, v59
    ds_read_b32 a5, v62
    v_mfma_f32_16x16x32_bf16 v[184:187], a[108:111], a[28:31], v[184:187]
    ds_read_b128 a[244:247], v41 offset:22528
    s_cbranch_vccnz L_slow7_1
L_back7_1:
    v_mfma_f32_16x16x32_bf16 v[192:195], a[112:115], a[224:227], v[192:195]
    v_perm_b32 v60, v53, v35, s38
    v_perm_b32 v61, v53, v35, s39
    v_mfma_f32_16x16x32_bf16 v[192:195], a[116:119], a[228:231], v[192:195]
    ds_read_b32 a6, v60
    ds_read_b32 a7, v61
    v_mfma_f32_16x16x32_bf16 v[196:199], a[116:119], a[156:159], v[196:199]
    ds_read_b128 a[176:179], v40 offset:24576
    v_perm_b32 v63, v90, v35, s36
    v_mfma_f32_16x16x32_bf16 v[196:199], a[112:115], a[152:155], v[196:199]
    ds_read_b32 a160, v63
    v_perm_b32 v56, v90, v35, s37
    v_mfma_f32_16x16x32_bf16 v[200:203], a[112:115], a[192:195], v[200:203]
    ds_read_b32 a161, v56
    v_perm_b32 v57, v90, v35, s38
    v_mfma_f32_16x16x32_bf16 v[200:203], a[116:119], a[196:199], v[200:203]
    ds_read_b128 a[180:183], v41 offset:24576
    ds_read_b32 a162, v57
    v_mfma_f32_16x16x32_bf16 v[204:207], a[116:119], a[212:215], v[204:207]
    v_perm_b32 v58, v90, v35, s39
    v_perm_b32 v59, v94, v35, s36
    v_mfma_f32_16x16x32_bf16 v[204:207], a[112:115], a[208:211], v[204:207]
    ds_read_b32 a163, v58
    ds_read_b32 a164, v59
    v_mfma_f32_16x16x32_bf16 v[208:211], a[112:115], a[48:51], v[208:211]
    ds_read_b128 a[56:59], v40 offset:26624
    v_perm_b32 v62, v94, v35, s37
    v_mfma_f32_16x16x32_bf16 v[208:211], a[116:119], a[52:55], v[208:211]
    ds_read_b32 a165, v62
    v_perm_b32 v60, v94, v35, s38
    v_mfma_f32_16x16x32_bf16 v[212:215], a[116:119], a[20:23], v[212:215]
    ds_read_b32 a166, v60
    v_perm_b32 v61, v94, v35, s39
    v_mfma_f32_16x16x32_bf16 v[212:215], a[112:115], a[16:19], v[212:215]
    ds_read_b128 a[60:63], v41 offset:26624
    ds_read_b32 a167, v61
    v_mfma_f32_16x16x32_bf16 v[216:219], a[112:115], a[24:27], v[216:219]
    v_perm_b32 v63, v50, v35, s36
    v_perm_b32 v56, v50, v35, s37
    v_mfma_f32_16x16x32_bf16 v[216:219], a[116:119], a[28:31], v[216:219]
    ds_read_b32 a120, v63
    ds_read_b32 a121, v56
    v_mfma_f32_16x16x32_bf16 v[224:227], a[88:91], a[226:229], v[224:227]
    s_waitcnt lgkmcnt(9)
    ds_read_b128 a[128:131], v40 offset:28672
    v_perm_b32 v57, v50, v35, s38
    v_mfma_f32_16x16x32_bf16 v[224:227], a[92:95], a[74:77], v[224:227]
    ds_read_b128 a[132:135], v41 offset:28672
    ds_read_b32 a122, v57
    v_mfma_f32_16x16x32_bf16 v[228:231], a[92:95], a[34:37], v[228:231]
    v_perm_b32 v58, v50, v35, s39
    v_perm_b32 v59, v54, v35, s36
    v_mfma_f32_16x16x32_bf16 v[228:231], a[88:91], a[154:157], v[228:231]
    ds_read_b32 a123, v58
    ds_read_b32 a124, v59
    v_mfma_f32_16x16x32_bf16 v[232:235], a[88:91], a[194:197], v[232:235]
    v_perm_b32 v62, v54, v35, s37
    v_perm_b32 v60, v54, v35, s38
    v_mfma_f32_16x16x32_bf16 v[232:235], a[92:95], a[82:85], v[232:235]
    ds_read_b32 a125, v62
    ds_read_b32 a126, v60
    v_mfma_f32_16x16x32_bf16 v[236:239], a[92:95], a[242:245], v[236:239]
    v_perm_b32 v61, v54, v35, s39
    v_perm_b32 v63, v71, v35, s36
    v_mfma_f32_16x16x32_bf16 v[236:239], a[88:91], a[210:213], v[236:239]
    ds_read_b32 a127, v61
    ds_read_b32 a144, v63
    v_mfma_f32_16x16x32_bf16 v[240:243], a[88:91], a[50:53], v[240:243]
    v_perm_b32 v56, v71, v35, s37
    v_perm_b32 v57, v75, v35, s36
    v_mfma_f32_16x16x32_bf16 v[240:243], a[92:95], a[178:181], v[240:243]
    s_waitcnt lgkmcnt(8)
    ds_read_b32 a145, v56
    ds_read_b32 a146, v57
    v_mfma_f32_16x16x32_bf16 v[244:247], a[92:95], a[58:61], v[244:247]
    v_perm_b32 v58, v75, v35, s37
    v_perm_b32 v59, v79, v35, s36
    v_mfma_f32_16x16x32_bf16 v[244:247], a[88:91], a[18:21], v[244:247]
    ds_read_b32 a147, v58
    ds_read_b32 a148, v59
    v_mfma_f32_16x16x32_bf16 v[248:251], a[88:91], a[26:29], v[248:251]
    s_waitcnt lgkmcnt(8)
    v_perm_b32 v62, v79, v35, s37
    v_perm_b32 v60, v83, v35, s36
    v_mfma_f32_16x16x32_bf16 v[248:251], a[92:95], a[130:133], v[248:251]
    ds_read_b32 a149, v62
    ds_read_b32 a150, v60
    v_mfma_f32_16x16x32_bf16 v[128:131], a[64:67], a[72:75], v[128:131]
    v_perm_b32 v61, v83, v35, s37
    v_perm_b32 v63, v68, v35, s36
    v_mfma_f32_16x16x32_bf16 v[128:131], a[68:71], a[76:79], v[128:131]
    ds_read_b32 a151, v61
    ds_read_b32 a168, v63
    v_mfma_f32_16x16x32_bf16 v[132:135], a[68:71], a[36:39], v[132:135]
    v_perm_b32 v56, v68, v35, s37
    v_perm_b32 v57, v68, v35, s38
    v_mfma_f32_16x16x32_bf16 v[132:135], a[64:67], a[32:35], v[132:135]
    ds_read_b32 a169, v56
    ds_read_b32 a170, v57
    v_mfma_f32_16x16x32_bf16 v[136:139], a[64:67], a[80:83], v[136:139]
    v_perm_b32 v58, v68, v35, s39
    v_perm_b32 v59, v72, v35, s36
    v_mfma_f32_16x16x32_bf16 v[136:139], a[68:71], a[84:87], v[136:139]
    ds_read_b32 a171, v58
    ds_read_b32 a172, v59
    v_mfma_f32_16x16x32_bf16 v[140:143], a[68:71], a[244:247], v[140:143]
    v_perm_b32 v62, v72, v35, s37
    v_perm_b32 v60, v72, v35, s38
    v_mfma_f32_16x16x32_bf16 v[140:143], a[64:67], a[240:243], v[140:143]
    s_waitcnt vmcnt(0)
    ds_read_b32 a173, v62
    ds_read_b32 a174, v60
    v_mfma_f32_16x16x32_bf16 v[144:147], a[64:67], a[176:179], v[144:147]
    s_barrier
    v_mfma_f32_16x16x32_bf16 v[144:147], a[68:71], a[180:183], v[144:147]
    v_perm_b32 v61, v72, v35, s39
    v_perm_b32 v63, v76, v35, s36
    v_mfma_f32_16x16x32_bf16 v[148:151], a[68:71], a[60:63], v[148:151]
    ds_read_b32 a175, v61
    ds_read_b32 a40, v63
    v_mfma_f32_16x16x32_bf16 v[148:151], a[64:67], a[56:59], v[148:151]
    v_perm_b32 v56, v76, v35, s37
    v_perm_b32 v57, v76, v35, s38
    v_mfma_f32_16x16x32_bf16 v[152:155], a[64:67], a[128:131], v[152:155]
    ds_read_b32 a41, v56
    ds_read_b32 a42, v57
    v_mfma_f32_16x16x32_bf16 v[152:155], a[68:71], a[132:135], v[152:155]
    ds_read_b128 a[184:187], v40 offset:32768
    v_perm_b32 v58, v76, v35, s39
    v_mfma_f32_16x16x32_bf16 v[160:163], a[200:203], a[72:75], v[160:163]
    ds_read_b32 a43, v58
    v_perm_b32 v59, v80, v35, s36
    v_mfma_f32_16x16x32_bf16 v[160:163], a[204:207], a[76:79], v[160:163]
    ds_read_b32 a44, v59
    v_perm_b32 v62, v80, v35, s37
    v_mfma_f32_16x16x32_bf16 v[164:167], a[204:207], a[36:39], v[164:167]
    ds_read_b128 a[188:191], v41 offset:32768
    ds_read_b32 a45, v62
    v_mfma_f32_16x16x32_bf16 v[164:167], a[200:203], a[32:35], v[164:167]
    v_perm_b32 v60, v80, v35, s38
    v_perm_b32 v61, v80, v35, s39
    v_mfma_f32_16x16x32_bf16 v[168:171], a[200:203], a[80:83], v[168:171]
    ds_read_b32 a46, v60
    ds_read_b32 a47, v61
    v_mfma_f32_16x16x32_bf16 v[168:171], a[204:207], a[84:87], v[168:171]
    v_perm_b32 v63, v69, v35, s36
    v_perm_b32 v56, v69, v35, s37
    v_mfma_f32_16x16x32_bf16 v[172:175], a[204:207], a[244:247], v[172:175]
    ds_read_b128 a[224:227], v40 offset:49152
    ds_read_b32 a152, v63
    v_mfma_f32_16x16x32_bf16 v[172:175], a[200:203], a[240:243], v[172:175]
    ds_read_b32 a153, v56
    v_perm_b32 v57, v69, v35, s38
    v_mfma_f32_16x16x32_bf16 v[176:179], a[200:203], a[176:179], v[176:179]
    ds_read_b32 a154, v57
    v_perm_b32 v58, v73, v35, s36
    v_mfma_f32_16x16x32_bf16 v[176:179], a[204:207], a[180:183], v[176:179]
    ds_read_b128 a[228:231], v41 offset:49152
    ds_read_b32 a156, v58
    v_mfma_f32_16x16x32_bf16 v[180:183], a[204:207], a[60:63], v[180:183]
    v_perm_b32 v62, v73, v35, s37
    v_perm_b32 v59, v69, v35, s39
    v_mfma_f32_16x16x32_bf16 v[180:183], a[200:203], a[56:59], v[180:183]
    ds_read_b32 a157, v62
    ds_read_b32 a155, v59
    v_perm_b32 v60, v73, v35, s38
    v_mfma_f32_16x16x32_bf16 v[184:187], a[200:203], a[128:131], v[184:187]
    ds_read_b32 a158, v60
    v_perm_b32 v61, v77, v35, s36
    v_mfma_f32_16x16x32_bf16 v[184:187], a[204:207], a[132:135], v[184:187]
    ds_read_b128 a[192:195], v42 offset:0
    ds_read_b32 a208, v61
    v_mfma_f32_16x16x32_bf16 v[192:195], a[232:235], a[72:75], v[192:195]
    v_perm_b32 v56, v77, v35, s37
    v_perm_b32 v63, v73, v35, s39
    v_mfma_f32_16x16x32_bf16 v[192:195], a[236:239], a[76:79], v[192:195]
    ds_read_b32 a209, v56
    v_perm_b32 v57, v77, v35, s38
    v_mfma_f32_16x16x32_bf16 v[196:199], a[236:239], a[36:39], v[196:199]
    ds_read_b128 a[196:199], v43 offset:0
    v_perm_b32 v58, v81, v35, s36
    v_mfma_f32_16x16x32_bf16 v[196:199], a[232:235], a[32:35], v[196:199]
    ds_read_b32 a212, v58
    ds_read_b32 a159, v63
    v_perm_b32 v59, v81, v35, s37
    v_mfma_f32_16x16x32_bf16 v[200:203], a[232:235], a[80:83], v[200:203]
    ds_read_b32 a210, v57
    v_perm_b32 v62, v77, v35, s39
    v_mfma_f32_16x16x32_bf16 v[200:203], a[236:239], a[84:87], v[200:203]
    ds_read_b32 a213, v59
    v_perm_b32 v60, v81, v35, s38
    v_mfma_f32_16x16x32_bf16 v[204:207], a[236:239], a[244:247], v[204:207]
    ds_read_b128 a[48:51], v42 offset:16384
    v_perm_b32 v61, v70, v35, s36
    v_mfma_f32_16x16x32_bf16 v[204:207], a[232:235], a[240:243], v[204:207]
    ds_read_b32 a16, v61
    v_perm_b32 v56, v70, v35, s37
    v_mfma_f32_16x16x32_bf16 v[208:211], a[232:235], a[176:179], v[208:211]
    ds_read_b32 a211, v62
    ds_read_b32 a214, v60
    v_mfma_f32_16x16x32_bf16 v[208:211], a[236:239], a[180:183], v[208:211]
    ds_read_b128 a[52:55], v43 offset:16384
    v_perm_b32 v63, v81, v35, s39
    v_mfma_f32_16x16x32_bf16 v[212:215], a[236:239], a[60:63], v[212:215]
    ds_read_b32 a17, v56
    v_perm_b32 v58, v74, v35, s36
    v_mfma_f32_16x16x32_bf16 v[212:215], a[232:235], a[56:59], v[212:215]
    ds_read_b32 a20, v58
    v_perm_b32 v57, v70, v35, s38
    v_mfma_f32_16x16x32_bf16 v[216:219], a[232:235], a[128:131], v[216:219]
    ds_read_b32 a215, v63
    v_perm_b32 v59, v74, v35, s37
    v_mfma_f32_16x16x32_bf16 v[216:219], a[236:239], a[132:135], v[216:219]
    s_waitcnt lgkmcnt(9)
    ds_read_b32 a18, v57
    v_perm_b32 v61, v70, v35, s39
    v_mfma_f32_16x16x32_bf16 v[224:227], a[248:251], a[186:189], v[224:227]
    s_mov_b32 s66, 0
    ds_read_b32 a21, v59
    v_perm_b32 v62, v78, v35, s36
    v_mfma_f32_16x16x32_bf16 v[224:227], a[252:255], a[226:229], v[224:227]
    s_mov_b32 s67, 14336
    v_perm_b32 v60, v74, v35, s38
    v_perm_b32 v56, v78, v35, s37
    v_mfma_f32_16x16x32_bf16 v[128:131], a[216:219], a[184:187], v[128:131]
    ds_read_b32 a24, v62
    ds_read_b32 a19, v61
    v_mfma_f32_16x16x32_bf16 v[128:131], a[220:223], a[188:191], v[128:131]
    ds_read_b32 a22, v60
    v_perm_b32 v58, v74, v35, s39
    v_mfma_f32_16x16x32_bf16 v[128:131], a[8:11], a[224:227], v[128:131]
    ds_read_b32 a25, v56
    v_perm_b32 v63, v78, v35, s38
    v_mfma_f32_16x16x32_bf16 v[128:131], a[12:15], a[228:231], v[128:131]
    ds_read_b32 a23, v58
    ds_read_b32 a26, v63
    v_mfma_f32_16x16x32_bf16 v[160:163], a[96:99], a[184:187], v[160:163]
    v_perm_b32 v59, v82, v35, s36
    v_perm_b32 v57, v78, v35, s39
    v_mfma_f32_16x16x32_bf16 v[160:163], a[100:103], a[188:191], v[160:163]
    ds_read_b32 a27, v57
    v_perm_b32 v61, v82, v35, s37
    v_mfma_f32_16x16x32_bf16 v[160:163], a[0:3], a[224:227], v[160:163]
    ds_read_b32 a28, v59
    ds_read_b128 a[72:75], v40 offset:34816
    v_mfma_f32_16x16x32_bf16 v[160:163], a[4:7], a[228:231], v[160:163]
    ds_read_b32 a29, v61
    v_perm_b32 v62, v82, v35, s38
    v_mfma_f32_16x16x32_bf16 v[192:195], a[160:163], a[184:187], v[192:195]
    ds_read_b128 a[76:79], v41 offset:34816
    ds_read_b32 a30, v62
    v_mfma_f32_16x16x32_bf16 v[192:195], a[164:167], a[188:191], v[192:195]
    ds_read_b128 a[32:35], v40 offset:51200
    v_perm_b32 v60, v82, v35, s39
    v_mfma_f32_16x16x32_bf16 v[192:195], a[120:123], a[224:227], v[192:195]
    ds_read_b128 a[36:39], v41 offset:51200
    ds_read_b32 a31, v60
    v_mfma_f32_16x16x32_bf16 v[192:195], a[124:127], a[228:231], v[192:195]
    v_lshlrev_b32 v96, 16, v86
    v_and_b32 v97, 0xffff0000, v86
    v_mfma_f32_16x16x32_bf16 v[224:227], a[144:147], a[194:197], v[224:227]
    s_waitcnt lgkmcnt(9)
    ds_read_b128 a[80:83], v42 offset:2048
    v_lshlrev_b32 v100, 16, v64
    v_mfma_f32_16x16x32_bf16 v[224:227], a[148:151], a[50:53], v[224:227]
    ds_read_b128 a[84:87], v43 offset:2048
    v_and_b32 v101, 0xffff0000, v65
    v_mfma_f32_16x16x32_bf16 v[128:131], a[168:171], a[192:195], v[128:131]
    v_lshlrev_b32 v102, 16, v67
    v_and_b32 v103, 0xffff0000, v84
    v_mfma_f32_16x16x32_bf16 v[128:131], a[172:175], a[196:199], v[128:131]
    ds_read_b128 a[240:243], v42 offset:18432
    v_and_b32 v104, 0xffff0000, v64
    v_mfma_f32_16x16x32_bf16 v[128:131], a[40:43], a[48:51], v[128:131]
    v_lshlrev_b32 v105, 16, v66
    v_and_b32 v106, 0xffff0000, v67
    v_mfma_f32_16x16x32_bf16 v[128:131], a[44:47], a[52:55], v[128:131]
    ds_read_b128 a[244:247], v43 offset:18432
    v_lshlrev_b32 v107, 16, v85
    v_mfma_f32_16x16x32_bf16 v[160:163], a[152:155], a[192:195], v[160:163]
    ds_write_b64 v29, v[226:227] offset:28928
    v_lshlrev_b32 v108, 16, v65
    v_mfma_f32_16x16x32_bf16 v[160:163], a[156:159], a[196:199], v[160:163]
    v_and_b32 v109, 0xffff0000, v66
    v_lshlrev_b32 v110, 16, v84
    v_mfma_f32_16x16x32_bf16 v[160:163], a[208:211], a[48:51], v[160:163]
    ds_read_b128 a[176:179], v40 offset:36864
    v_and_b32 v111, 0xffff0000, v85
    v_mfma_f32_16x16x32_bf16 v[160:163], a[212:215], a[52:55], v[160:163]
    v_mul_f32 v128, v128, v100
    v_mul_f32 v129, v129, v101
    v_mfma_f32_16x16x32_bf16 v[192:195], a[16:19], a[192:195], v[192:195]
    v_mul_f32 v130, v130, v102
    v_mul_f32 v131, v131, v103
    v_mfma_f32_16x16x32_bf16 v[192:195], a[20:23], a[196:199], v[192:195]
    s_waitcnt lgkmcnt(1)
    s_barrier
    v_mfma_f32_16x16x32_bf16 v[192:195], a[24:27], a[48:51], v[192:195]
    ds_read_b64 v[112:113], v30 offset:28928
    ds_read_b128 a[180:183], v41 offset:36864
    v_mfma_f32_16x16x32_bf16 v[192:195], a[28:31], a[52:55], v[192:195]
    v_mul_f32 v160, v160, v104
    v_cvt_pk_bf16_f32 v116, v128, v160
    v_mfma_f32_16x16x32_bf16 v[228:231], a[248:251], a[74:77], v[228:231]
    v_mul_f32 v161, v161, v105
    v_mul_f32 v162, v162, v106
    v_mfma_f32_16x16x32_bf16 v[228:231], a[252:255], a[34:37], v[228:231]
    ds_read_b128 a[56:59], v40 offset:53248
    v_cvt_pk_bf16_f32 v119, v130, v162
L_pad4:
    s_cbranch_execz L_warmed
    v_mfma_f32_16x16x32_bf16 v[228:231], a[144:147], a[82:85], v[228:231]
    v_mul_f32 v163, v163, v107
    v_mov_b32 v8, 1
    v_mfma_f32_16x16x32_bf16 v[228:231], a[148:151], a[242:245], v[228:231]
    v_mul_f32 v192, v192, v108
    v_mul_f32 v193, v193, v109
    v_mfma_f32_16x16x32_bf16 v[132:135], a[216:219], a[72:75], v[132:135]
    v_mul_f32 v194, v194, v110
    v_mul_f32 v195, v195, v111
    v_mfma_f32_16x16x32_bf16 v[132:135], a[220:223], a[76:79], v[132:135]
    v_cvt_pk_bf16_f32 v117, v192, v129
    v_cvt_pk_bf16_f32 v118, v161, v193
    v_mfma_f32_16x16x32_bf16 v[132:135], a[8:11], a[32:35], v[132:135]
    ds_write_b64 v26, v[116:117] offset:64512
    v_cvt_pk_bf16_f32 v120, v194, v131
    v_mfma_f32_16x16x32_bf16 v[132:135], a[12:15], a[36:39], v[132:135]
    ds_write_b64 v26, v[118:119] offset:64520
    v_cvt_pk_bf16_f32 v121, v163, v195
    v_mfma_f32_16x16x32_bf16 v[132:135], a[168:171], a[80:83], v[132:135]
    s_waitcnt lgkmcnt(3)
    ds_write_b64 v26, v[120:121] offset:64528
    v_add_f32 v224, v224, v112
    v_mfma_f32_16x16x32_bf16 v[132:135], a[172:175], a[84:87], v[132:135]
    ds_read_b128 a[60:63], v41 offset:53248
    v_mul_f32 v224, v224, v96
    v_mfma_f32_16x16x32_bf16 v[132:135], a[40:43], a[240:243], v[132:135]
    v_add_f32 v225, v225, v113
    v_mul_f32 v225, v225, v97
    v_mfma_f32_16x16x32_bf16 v[132:135], a[44:47], a[244:247], v[132:135]
    ds_write_b64 v29, v[230:231] offset:30976
    v_cvt_pk_bf16_f32 v112, v224, v225
    v_mfma_f32_16x16x32_bf16 v[164:167], a[96:99], a[72:75], v[164:167]
    ds_write_b32 v28, v112 offset:64512
    v_min_u32 v9, 1, v0
    v_mfma_f32_16x16x32_bf16 v[164:167], a[100:103], a[76:79], v[164:167]
    ds_read_b128 a[128:131], v42 offset:4096
    v_lshlrev_b32 v9, 30, v9
    v_mfma_f32_16x16x32_bf16 v[164:167], a[0:3], a[32:35], v[164:167]
    ds_read_b128 a[132:135], v43 offset:4096
    v_mfma_f32_16x16x32_bf16 v[164:167], a[4:7], a[36:39], v[164:167]
    buffer_atomic_add v8, v9, s[24:27], s77 offen sc0 sc1
    v_mfma_f32_16x16x32_bf16 v[164:167], a[152:155], a[80:83], v[164:167]
    ds_read_b128 a[184:187], v42 offset:20480
    v_mul_f32 v132, v132, v100
    v_mfma_f32_16x16x32_bf16 v[164:167], a[156:159], a[84:87], v[164:167]
    s_waitcnt lgkmcnt(3)
    s_barrier
    v_mfma_f32_16x16x32_bf16 v[164:167], a[208:211], a[240:243], v[164:167]
    ds_read_b128 v[124:127], v24 offset:64512
    ds_read_b64 v[88:89], v30 offset:30976
    v_mfma_f32_16x16x32_bf16 v[164:167], a[212:215], a[244:247], v[164:167]
    ds_read_b128 a[188:191], v43 offset:20480
    v_mul_f32 v133, v133, v101
    v_mfma_f32_16x16x32_bf16 v[196:199], a[160:163], a[72:75], v[196:199]
    ds_read_b128 v[92:95], v24 offset:65440
    v_mul_f32 v134, v134, v102
    v_mfma_f32_16x16x32_bf16 v[196:199], a[164:167], a[76:79], v[196:199]
    v_mul_f32 v135, v135, v103
    v_mfma_f32_16x16x32_bf16 v[196:199], a[120:123], a[32:35], v[196:199]
    ds_read_b128 a[224:227], v40 offset:38912
    v_mfma_f32_16x16x32_bf16 v[196:199], a[124:127], a[36:39], v[196:199]
    v_mul_f32 v164, v164, v104
    v_cvt_pk_bf16_f32 v48, v132, v164
    v_mfma_f32_16x16x32_bf16 v[196:199], a[16:19], a[80:83], v[196:199]
    s_waitcnt lgkmcnt(3)
    v_mul_f32 v165, v165, v105
    v_mfma_f32_16x16x32_bf16 v[196:199], a[20:23], a[84:87], v[196:199]
    buffer_store_dwordx4 v[124:127], v25, s[16:19], s66 offen sc1
    v_mfma_f32_16x16x32_bf16 v[196:199], a[24:27], a[240:243], v[196:199]
    s_mov_b32 s66, 114688
    v_add_f32 v228, v228, v88
    v_mul_f32 v228, v228, v96
    v_mfma_f32_16x16x32_bf16 v[196:199], a[28:31], a[244:247], v[196:199]
    v_add_f32 v229, v229, v89
    v_mul_f32 v229, v229, v97
    v_mfma_f32_16x16x32_bf16 v[232:235], a[248:251], a[178:181], v[232:235]
    s_waitcnt lgkmcnt(1)
    ds_read_b128 a[228:231], v41 offset:38912
    v_mfma_f32_16x16x32_bf16 v[232:235], a[252:255], a[58:61], v[232:235]
    buffer_store_dwordx4 v[92:95], v25, s[16:19], s67 offen sc1
    v_mfma_f32_16x16x32_bf16 v[232:235], a[144:147], a[130:133], v[232:235]
    s_mov_b32 s67, 129024
    v_cvt_pk_bf16_f32 v88, v228, v229
    v_mul_f32 v166, v166, v106
    v_mfma_f32_16x16x32_bf16 v[232:235], a[148:151], a[186:189], v[232:235]
    ds_write_b32 v28, v88 offset:0
    v_cvt_pk_bf16_f32 v51, v134, v166
    v_mfma_f32_16x16x32_bf16 v[136:139], a[216:219], a[176:179], v[136:139]
    v_mul_f32 v167, v167, v107
    v_mul_f32 v196, v196, v108
    v_mfma_f32_16x16x32_bf16 v[136:139], a[220:223], a[180:183], v[136:139]
    v_mul_f32 v197, v197, v109
    v_mul_f32 v198, v198, v110
    v_mfma_f32_16x16x32_bf16 v[136:139], a[8:11], a[56:59], v[136:139]
    ds_read_b128 a[192:195], v40 offset:55296
    v_mul_f32 v199, v199, v111
    v_mfma_f32_16x16x32_bf16 v[136:139], a[12:15], a[60:63], v[136:139]
    v_cvt_pk_bf16_f32 v49, v196, v133
    v_cvt_pk_bf16_f32 v50, v165, v197
    v_mfma_f32_16x16x32_bf16 v[136:139], a[168:171], a[128:131], v[136:139]
    ds_write_b64 v26, v[48:49] offset:0
    v_cvt_pk_bf16_f32 v52, v198, v135
    v_mfma_f32_16x16x32_bf16 v[136:139], a[172:175], a[132:135], v[136:139]
    ds_read_b128 a[196:199], v41 offset:55296
    v_cvt_pk_bf16_f32 v53, v167, v199
    v_mfma_f32_16x16x32_bf16 v[136:139], a[40:43], a[184:187], v[136:139]
    ds_write_b64 v26, v[50:51] offset:8
    v_mfma_f32_16x16x32_bf16 v[136:139], a[44:47], a[188:191], v[136:139]
    ds_write_b64 v26, v[52:53] offset:16
    v_mfma_f32_16x16x32_bf16 v[168:171], a[96:99], a[176:179], v[168:171]
    ds_write_b64 v29, v[234:235] offset:33024
    v_mfma_f32_16x16x32_bf16 v[168:171], a[100:103], a[180:183], v[168:171]
    ds_read_b128 a[48:51], v42 offset:6144
    v_mfma_f32_16x16x32_bf16 v[168:171], a[0:3], a[56:59], v[168:171]
    ds_read_b128 a[52:55], v43 offset:6144
    v_mfma_f32_16x16x32_bf16 v[168:171], a[4:7], a[60:63], v[168:171]
    ds_read_b128 a[72:75], v42 offset:22528
    v_mul_f32 v136, v136, v100
    v_mfma_f32_16x16x32_bf16 v[168:171], a[152:155], a[128:131], v[168:171]
    v_mul_f32 v137, v137, v101
    v_mul_f32 v138, v138, v102
    v_mfma_f32_16x16x32_bf16 v[168:171], a[156:159], a[132:135], v[168:171]
    s_waitcnt lgkmcnt(3)
    s_barrier
    v_mfma_f32_16x16x32_bf16 v[168:171], a[208:211], a[184:187], v[168:171]
    ds_read_b128 v[68:71], v24 offset:0
    ds_read_b64 v[72:73], v30 offset:33024
    v_mfma_f32_16x16x32_bf16 v[168:171], a[212:215], a[188:191], v[168:171]
    ds_read_b128 a[76:79], v43 offset:22528
    v_mul_f32 v139, v139, v103
    v_mfma_f32_16x16x32_bf16 v[200:203], a[160:163], a[176:179], v[200:203]
    ds_read_b128 v[76:79], v24 offset:928
    v_mfma_f32_16x16x32_bf16 v[200:203], a[164:167], a[180:183], v[200:203]
    v_mfma_f32_16x16x32_bf16 v[200:203], a[120:123], a[56:59], v[200:203]
    ds_read_b128 a[32:35], v40 offset:40960
    v_mfma_f32_16x16x32_bf16 v[200:203], a[124:127], a[60:63], v[200:203]
    v_mul_f32 v168, v168, v104
    v_cvt_pk_bf16_f32 v80, v136, v168
    v_mfma_f32_16x16x32_bf16 v[200:203], a[16:19], a[128:131], v[200:203]
    s_waitcnt lgkmcnt(3)
    v_mul_f32 v169, v169, v105
    v_mfma_f32_16x16x32_bf16 v[200:203], a[20:23], a[132:135], v[200:203]
    buffer_store_dwordx4 v[68:71], v25, s[16:19], s66 offen sc1
    v_mfma_f32_16x16x32_bf16 v[200:203], a[24:27], a[184:187], v[200:203]
    s_mov_b32 s66, 229376
    v_add_f32 v232, v232, v72
    v_mul_f32 v232, v232, v96
    v_mfma_f32_16x16x32_bf16 v[200:203], a[28:31], a[188:191], v[200:203]
    v_add_f32 v233, v233, v73
    v_mul_f32 v233, v233, v97
    v_mfma_f32_16x16x32_bf16 v[236:239], a[248:251], a[226:229], v[236:239]
    s_waitcnt lgkmcnt(1)
    ds_read_b128 a[36:39], v41 offset:40960
    v_mfma_f32_16x16x32_bf16 v[236:239], a[252:255], a[194:197], v[236:239]
    buffer_store_dwordx4 v[76:79], v25, s[16:19], s67 offen sc1
    v_mfma_f32_16x16x32_bf16 v[236:239], a[144:147], a[50:53], v[236:239]
    s_mov_b32 s67, 243712
    v_cvt_pk_bf16_f32 v72, v232, v233
    v_mul_f32 v170, v170, v106
    v_mfma_f32_16x16x32_bf16 v[236:239], a[148:151], a[74:77], v[236:239]
    ds_write_b32 v28, v72 offset:7424
    v_cvt_pk_bf16_f32 v83, v138, v170
    v_mfma_f32_16x16x32_bf16 v[140:143], a[216:219], a[224:227], v[140:143]
    v_mul_f32 v171, v171, v107
    v_mul_f32 v200, v200, v108
    v_mfma_f32_16x16x32_bf16 v[140:143], a[220:223], a[228:231], v[140:143]
    v_mul_f32 v201, v201, v109
    v_mul_f32 v202, v202, v110
    v_mfma_f32_16x16x32_bf16 v[140:143], a[8:11], a[192:195], v[140:143]
    ds_read_b128 a[80:83], v40 offset:57344
    v_mul_f32 v203, v203, v111
    v_mfma_f32_16x16x32_bf16 v[140:143], a[12:15], a[196:199], v[140:143]
    v_cvt_pk_bf16_f32 v81, v200, v137
    v_cvt_pk_bf16_f32 v82, v169, v201
    v_mfma_f32_16x16x32_bf16 v[140:143], a[168:171], a[48:51], v[140:143]
    ds_write_b64 v26, v[80:81] offset:7424
    v_cvt_pk_bf16_f32 v64, v202, v139
    v_mfma_f32_16x16x32_bf16 v[140:143], a[172:175], a[52:55], v[140:143]
    ds_read_b128 a[84:87], v41 offset:57344
    v_cvt_pk_bf16_f32 v65, v171, v203
    v_mfma_f32_16x16x32_bf16 v[140:143], a[40:43], a[72:75], v[140:143]
    ds_write_b64 v26, v[82:83] offset:7432
    v_mfma_f32_16x16x32_bf16 v[140:143], a[44:47], a[76:79], v[140:143]
    ds_write_b64 v26, v[64:65] offset:7440
    v_mfma_f32_16x16x32_bf16 v[172:175], a[96:99], a[224:227], v[172:175]
    ds_write_b64 v29, v[238:239] offset:0
    v_mfma_f32_16x16x32_bf16 v[172:175], a[100:103], a[228:231], v[172:175]
    ds_read_b128 a[240:243], v42 offset:8192
    v_mfma_f32_16x16x32_bf16 v[172:175], a[0:3], a[192:195], v[172:175]
    ds_read_b128 a[244:247], v43 offset:8192
    v_mfma_f32_16x16x32_bf16 v[172:175], a[4:7], a[196:199], v[172:175]
    ds_read_b128 a[176:179], v42 offset:24576
    v_mul_f32 v140, v140, v100
    v_mfma_f32_16x16x32_bf16 v[172:175], a[152:155], a[48:51], v[172:175]
    v_mul_f32 v141, v141, v101
    v_mul_f32 v142, v142, v102
    v_mfma_f32_16x16x32_bf16 v[172:175], a[156:159], a[52:55], v[172:175]
    s_waitcnt lgkmcnt(3)
    s_barrier
    v_mfma_f32_16x16x32_bf16 v[172:175], a[208:211], a[72:75], v[172:175]
    ds_read_b128 v[84:87], v24 offset:7424
    ds_read_b64 v[116:117], v30 offset:0
    v_mfma_f32_16x16x32_bf16 v[172:175], a[212:215], a[76:79], v[172:175]
    ds_read_b128 a[180:183], v43 offset:24576
    v_mul_f32 v143, v143, v103
    v_mfma_f32_16x16x32_bf16 v[204:207], a[160:163], a[224:227], v[204:207]
    ds_read_b128 v[120:123], v24 offset:8352
    v_mfma_f32_16x16x32_bf16 v[204:207], a[164:167], a[228:231], v[204:207]
    v_mfma_f32_16x16x32_bf16 v[204:207], a[120:123], a[192:195], v[204:207]
    ds_read_b128 a[56:59], v40 offset:43008
    v_mfma_f32_16x16x32_bf16 v[204:207], a[124:127], a[196:199], v[204:207]
    v_mul_f32 v172, v172, v104
    v_cvt_pk_bf16_f32 v112, v140, v172
    v_mfma_f32_16x16x32_bf16 v[204:207], a[16:19], a[48:51], v[204:207]
    s_waitcnt lgkmcnt(3)
    v_mul_f32 v173, v173, v105
    v_mfma_f32_16x16x32_bf16 v[204:207], a[20:23], a[52:55], v[204:207]
    buffer_store_dwordx4 v[84:87], v25, s[16:19], s66 offen sc1
    v_mfma_f32_16x16x32_bf16 v[204:207], a[24:27], a[72:75], v[204:207]
    s_mov_b32 s66, 344064
    v_add_f32 v236, v236, v116
    v_mul_f32 v236, v236, v96
    v_mfma_f32_16x16x32_bf16 v[204:207], a[28:31], a[76:79], v[204:207]
    v_add_f32 v237, v237, v117
    v_mul_f32 v237, v237, v97
    v_mfma_f32_16x16x32_bf16 v[240:243], a[248:251], a[34:37], v[240:243]
    s_waitcnt lgkmcnt(1)
    ds_read_b128 a[60:63], v41 offset:43008
    v_mfma_f32_16x16x32_bf16 v[240:243], a[252:255], a[82:85], v[240:243]
    buffer_store_dwordx4 v[120:123], v25, s[16:19], s67 offen sc1
    v_mfma_f32_16x16x32_bf16 v[240:243], a[144:147], a[242:245], v[240:243]
    s_mov_b32 s67, 358400
    v_cvt_pk_bf16_f32 v116, v236, v237
    v_mul_f32 v174, v174, v106
    v_mfma_f32_16x16x32_bf16 v[240:243], a[148:151], a[178:181], v[240:243]
    ds_write_b32 v28, v116 offset:14848
    v_cvt_pk_bf16_f32 v115, v142, v174
    v_mfma_f32_16x16x32_bf16 v[144:147], a[216:219], a[32:35], v[144:147]
    v_mul_f32 v175, v175, v107
    v_mul_f32 v204, v204, v108
    v_mfma_f32_16x16x32_bf16 v[144:147], a[220:223], a[36:39], v[144:147]
    v_mul_f32 v205, v205, v109
    v_mul_f32 v206, v206, v110
    v_mfma_f32_16x16x32_bf16 v[144:147], a[8:11], a[80:83], v[144:147]
    ds_read_b128 a[128:131], v40 offset:59392
    v_mul_f32 v207, v207, v111
    v_mfma_f32_16x16x32_bf16 v[144:147], a[12:15], a[84:87], v[144:147]
    v_cvt_pk_bf16_f32 v113, v204, v141
    v_cvt_pk_bf16_f32 v114, v173, v205
    v_mfma_f32_16x16x32_bf16 v[144:147], a[168:171], a[240:243], v[144:147]
    ds_write_b64 v26, v[112:113] offset:14848
    v_cvt_pk_bf16_f32 v124, v206, v143
    v_mfma_f32_16x16x32_bf16 v[144:147], a[172:175], a[244:247], v[144:147]
    ds_read_b128 a[132:135], v41 offset:59392
    v_cvt_pk_bf16_f32 v125, v175, v207
    v_mfma_f32_16x16x32_bf16 v[144:147], a[40:43], a[176:179], v[144:147]
    ds_write_b64 v26, v[114:115] offset:14856
    v_mfma_f32_16x16x32_bf16 v[144:147], a[44:47], a[180:183], v[144:147]
    ds_write_b64 v26, v[124:125] offset:14864
    v_mfma_f32_16x16x32_bf16 v[176:179], a[96:99], a[32:35], v[176:179]
    ds_write_b64 v29, v[242:243] offset:2048
    v_mfma_f32_16x16x32_bf16 v[176:179], a[100:103], a[36:39], v[176:179]
    ds_read_b128 a[184:187], v42 offset:10240
    v_mfma_f32_16x16x32_bf16 v[176:179], a[0:3], a[80:83], v[176:179]
    ds_read_b128 a[188:191], v43 offset:10240
    v_mfma_f32_16x16x32_bf16 v[176:179], a[4:7], a[84:87], v[176:179]
    ds_read_b128 a[224:227], v42 offset:26624
    v_mul_f32 v144, v144, v100
    v_mfma_f32_16x16x32_bf16 v[176:179], a[152:155], a[240:243], v[176:179]
    v_mul_f32 v145, v145, v101
    v_mul_f32 v146, v146, v102
    v_mfma_f32_16x16x32_bf16 v[176:179], a[156:159], a[244:247], v[176:179]
    s_waitcnt lgkmcnt(3)
    s_barrier
    v_mfma_f32_16x16x32_bf16 v[176:179], a[208:211], a[176:179], v[176:179]
    ds_read_b128 v[92:95], v24 offset:14848
    ds_read_b64 v[88:89], v30 offset:2048
    v_mfma_f32_16x16x32_bf16 v[176:179], a[212:215], a[180:183], v[176:179]
    ds_read_b128 a[228:231], v43 offset:26624
    v_mul_f32 v147, v147, v103
    v_mfma_f32_16x16x32_bf16 v[208:211], a[160:163], a[32:35], v[208:211]
    ds_read_b128 v[48:51], v24 offset:15776
    v_mfma_f32_16x16x32_bf16 v[208:211], a[164:167], a[36:39], v[208:211]
    v_mfma_f32_16x16x32_bf16 v[208:211], a[120:123], a[80:83], v[208:211]
    ds_read_b128 a[192:195], v40 offset:45056
    v_mfma_f32_16x16x32_bf16 v[208:211], a[124:127], a[84:87], v[208:211]
    v_mul_f32 v176, v176, v104
    v_cvt_pk_bf16_f32 v52, v144, v176
    v_mfma_f32_16x16x32_bf16 v[208:211], a[16:19], a[240:243], v[208:211]
    s_waitcnt lgkmcnt(3)
    v_mul_f32 v177, v177, v105
    v_mfma_f32_16x16x32_bf16 v[208:211], a[20:23], a[244:247], v[208:211]
    buffer_store_dwordx4 v[92:95], v25, s[16:19], s66 offen sc1
    v_mfma_f32_16x16x32_bf16 v[208:211], a[24:27], a[176:179], v[208:211]
    s_mov_b32 s66, 458752
    v_add_f32 v240, v240, v88
    v_mul_f32 v240, v240, v96
    v_mfma_f32_16x16x32_bf16 v[208:211], a[28:31], a[180:183], v[208:211]
    v_add_f32 v241, v241, v89
    v_mul_f32 v241, v241, v97
    v_mfma_f32_16x16x32_bf16 v[244:247], a[248:251], a[58:61], v[244:247]
    s_waitcnt lgkmcnt(1)
    ds_read_b128 a[196:199], v41 offset:45056
    v_mfma_f32_16x16x32_bf16 v[244:247], a[252:255], a[130:133], v[244:247]
    buffer_store_dwordx4 v[48:51], v25, s[16:19], s67 offen sc1
    v_mfma_f32_16x16x32_bf16 v[244:247], a[144:147], a[186:189], v[244:247]
    s_mov_b32 s67, 473088
    v_cvt_pk_bf16_f32 v88, v240, v241
    v_mul_f32 v178, v178, v106
    v_mfma_f32_16x16x32_bf16 v[244:247], a[148:151], a[226:229], v[244:247]
    ds_write_b32 v28, v88 offset:22272
    v_cvt_pk_bf16_f32 v55, v146, v178
    v_mfma_f32_16x16x32_bf16 v[148:151], a[216:219], a[56:59], v[148:151]
    v_mul_f32 v179, v179, v107
    v_mul_f32 v208, v208, v108
    v_mfma_f32_16x16x32_bf16 v[148:151], a[220:223], a[60:63], v[148:151]
    v_mul_f32 v209, v209, v109
    v_mul_f32 v210, v210, v110
    v_mfma_f32_16x16x32_bf16 v[148:151], a[8:11], a[128:131], v[148:151]
    ds_read_b128 a[48:51], v40 offset:61440
    v_mul_f32 v211, v211, v111
    v_mfma_f32_16x16x32_bf16 v[148:151], a[12:15], a[132:135], v[148:151]
    v_cvt_pk_bf16_f32 v53, v208, v145
    v_cvt_pk_bf16_f32 v54, v177, v209
    v_mfma_f32_16x16x32_bf16 v[148:151], a[168:171], a[184:187], v[148:151]
    ds_write_b64 v26, v[52:53] offset:22272
    v_cvt_pk_bf16_f32 v68, v210, v147
    v_mfma_f32_16x16x32_bf16 v[148:151], a[172:175], a[188:191], v[148:151]
    ds_read_b128 a[52:55], v41 offset:61440
    v_cvt_pk_bf16_f32 v69, v179, v211
    v_mfma_f32_16x16x32_bf16 v[148:151], a[40:43], a[224:227], v[148:151]
    ds_write_b64 v26, v[54:55] offset:22280
    v_mfma_f32_16x16x32_bf16 v[148:151], a[44:47], a[228:231], v[148:151]
    ds_write_b64 v26, v[68:69] offset:22288
    v_mfma_f32_16x16x32_bf16 v[180:183], a[96:99], a[56:59], v[180:183]
    ds_write_b64 v29, v[246:247] offset:4096
    v_mfma_f32_16x16x32_bf16 v[180:183], a[100:103], a[60:63], v[180:183]
    ds_read_b128 a[72:75], v42 offset:12288
    v_mfma_f32_16x16x32_bf16 v[180:183], a[0:3], a[128:131], v[180:183]
    ds_read_b128 a[76:79], v43 offset:12288
    v_mfma_f32_16x16x32_bf16 v[180:183], a[4:7], a[132:135], v[180:183]
    ds_read_b128 a[32:35], v42 offset:28672
    v_mul_f32 v148, v148, v100
    v_mfma_f32_16x16x32_bf16 v[180:183], a[152:155], a[184:187], v[180:183]
    v_mul_f32 v149, v149, v101
    v_mul_f32 v150, v150, v102
    v_mfma_f32_16x16x32_bf16 v[180:183], a[156:159], a[188:191], v[180:183]
    s_waitcnt lgkmcnt(3)
    s_barrier
    v_mfma_f32_16x16x32_bf16 v[180:183], a[208:211], a[224:227], v[180:183]
    ds_read_b128 v[76:79], v24 offset:22272
    ds_read_b64 v[72:73], v30 offset:4096
    v_mfma_f32_16x16x32_bf16 v[180:183], a[212:215], a[228:231], v[180:183]
    ds_read_b128 a[36:39], v43 offset:28672
    v_mul_f32 v151, v151, v103
    v_mfma_f32_16x16x32_bf16 v[212:215], a[160:163], a[56:59], v[212:215]
    ds_read_b128 v[80:83], v24 offset:23200
    v_mfma_f32_16x16x32_bf16 v[212:215], a[164:167], a[60:63], v[212:215]
    v_mfma_f32_16x16x32_bf16 v[212:215], a[120:123], a[128:131], v[212:215]
    ds_read_b128 a[80:83], v40 offset:14336
    v_mfma_f32_16x16x32_bf16 v[212:215], a[124:127], a[132:135], v[212:215]
    v_mul_f32 v180, v180, v104
    v_cvt_pk_bf16_f32 v64, v148, v180
    v_mfma_f32_16x16x32_bf16 v[212:215], a[16:19], a[184:187], v[212:215]
    s_waitcnt lgkmcnt(3)
    v_mul_f32 v181, v181, v105
    v_mfma_f32_16x16x32_bf16 v[212:215], a[20:23], a[188:191], v[212:215]
    buffer_store_dwordx4 v[76:79], v25, s[16:19], s66 offen sc1
    v_mfma_f32_16x16x32_bf16 v[212:215], a[24:27], a[224:227], v[212:215]
    s_mov_b32 s66, 573440
    v_add_f32 v244, v244, v72
    v_mul_f32 v244, v244, v96
    v_mfma_f32_16x16x32_bf16 v[212:215], a[28:31], a[228:231], v[212:215]
    v_add_f32 v245, v245, v73
    v_mul_f32 v245, v245, v97
    v_mfma_f32_16x16x32_bf16 v[248:251], a[248:251], a[194:197], v[248:251]
    s_waitcnt lgkmcnt(1)
    ds_read_b128 a[84:87], v41 offset:14336
    v_mfma_f32_16x16x32_bf16 v[248:251], a[252:255], a[50:53], v[248:251]
    buffer_store_dwordx4 v[80:83], v25, s[16:19], s67 offen sc1
    v_mfma_f32_16x16x32_bf16 v[248:251], a[144:147], a[74:77], v[248:251]
    s_mov_b32 s67, 587776
    v_cvt_pk_bf16_f32 v72, v244, v245
    v_mul_f32 v182, v182, v106
    v_mfma_f32_16x16x32_bf16 v[248:251], a[148:151], a[34:37], v[248:251]
    ds_write_b32 v28, v72 offset:29696
    v_cvt_pk_bf16_f32 v67, v150, v182
    v_mfma_f32_16x16x32_bf16 v[152:155], a[216:219], a[192:195], v[152:155]
    v_mul_f32 v183, v183, v107
    v_mul_f32 v212, v212, v108
    v_mfma_f32_16x16x32_bf16 v[152:155], a[220:223], a[196:199], v[152:155]
    v_mul_f32 v213, v213, v109
    v_mul_f32 v214, v214, v110
    v_mfma_f32_16x16x32_bf16 v[152:155], a[8:11], a[48:51], v[152:155]
    ds_read_b128 a[240:243], v40 offset:30720
    v_mul_f32 v215, v215, v111
    v_mfma_f32_16x16x32_bf16 v[152:155], a[12:15], a[52:55], v[152:155]
    v_cvt_pk_bf16_f32 v65, v212, v149
    v_cvt_pk_bf16_f32 v66, v181, v213
    v_mfma_f32_16x16x32_bf16 v[152:155], a[168:171], a[72:75], v[152:155]
    ds_write_b64 v26, v[64:65] offset:29696
    v_cvt_pk_bf16_f32 v84, v214, v151
    v_mfma_f32_16x16x32_bf16 v[152:155], a[172:175], a[76:79], v[152:155]
    ds_read_b128 a[244:247], v41 offset:30720
    v_cvt_pk_bf16_f32 v85, v183, v215
    v_mfma_f32_16x16x32_bf16 v[152:155], a[40:43], a[32:35], v[152:155]
    ds_write_b64 v26, v[66:67] offset:29704
    v_mfma_f32_16x16x32_bf16 v[152:155], a[44:47], a[36:39], v[152:155]
    ds_write_b64 v26, v[84:85] offset:29712
    v_mfma_f32_16x16x32_bf16 v[184:187], a[96:99], a[192:195], v[184:187]
    ds_write_b64 v29, v[250:251] offset:6144
    v_mfma_f32_16x16x32_bf16 v[184:187], a[100:103], a[196:199], v[184:187]
    ds_read_b128 a[176:179], v40 offset:47104
    v_mfma_f32_16x16x32_bf16 v[184:187], a[0:3], a[48:51], v[184:187]
    ds_read_b128 a[180:183], v41 offset:47104
    v_mfma_f32_16x16x32_bf16 v[184:187], a[4:7], a[52:55], v[184:187]
    ds_read_b128 a[56:59], v40 offset:63488
    v_mul_f32 v152, v152, v100
    v_mfma_f32_16x16x32_bf16 v[184:187], a[152:155], a[72:75], v[184:187]
    v_mul_f32 v153, v153, v101
    v_mul_f32 v154, v154, v102
    v_mfma_f32_16x16x32_bf16 v[184:187], a[156:159], a[76:79], v[184:187]
    s_waitcnt lgkmcnt(3)
    s_barrier
    v_mfma_f32_16x16x32_bf16 v[184:187], a[208:211], a[32:35], v[184:187]
    ds_read_b128 v[120:123], v24 offset:29696
    ds_read_b64 v[116:117], v30 offset:6144
    v_mfma_f32_16x16x32_bf16 v[184:187], a[212:215], a[36:39], v[184:187]
    ds_read_b128 a[60:63], v41 offset:63488
    v_mul_f32 v155, v155, v103
    v_mfma_f32_16x16x32_bf16 v[216:219], a[160:163], a[192:195], v[216:219]
    ds_read_b128 a[128:131], v42 offset:14336
    v_mfma_f32_16x16x32_bf16 v[216:219], a[164:167], a[196:199], v[216:219]
    ds_read_b128 a[132:135], v43 offset:14336
    v_mfma_f32_16x16x32_bf16 v[216:219], a[120:123], a[48:51], v[216:219]
    ds_read_b128 a[184:187], v42 offset:30720
    v_mfma_f32_16x16x32_bf16 v[216:219], a[124:127], a[52:55], v[216:219]
    v_mul_f32 v184, v184, v104
    v_cvt_pk_bf16_f32 v112, v152, v184
    v_mfma_f32_16x16x32_bf16 v[216:219], a[16:19], a[72:75], v[216:219]
    s_waitcnt lgkmcnt(4)
    ds_read_b128 a[188:191], v43 offset:30720
    v_mfma_f32_16x16x32_bf16 v[216:219], a[20:23], a[76:79], v[216:219]
    buffer_store_dwordx4 v[120:123], v25, s[16:19], s66 offen sc1
    v_mfma_f32_16x16x32_bf16 v[216:219], a[24:27], a[32:35], v[216:219]
    s_mov_b32 s66, 688128
    ds_read_b128 v[124:127], v24 offset:30624
    v_add_f32 v248, v248, v116
    v_mfma_f32_16x16x32_bf16 v[216:219], a[28:31], a[36:39], v[216:219]
    v_mul_f32 v248, v248, v96
    v_add_f32 v249, v249, v117
    v_mfma_f32_16x16x32_bf16 v[252:255], a[88:91], a[82:85], v[252:255]
    v_mul_f32 v249, v249, v97
    v_cvt_pk_bf16_f32 v116, v248, v249
    v_mfma_f32_16x16x32_bf16 v[252:255], a[92:95], a[242:245], v[252:255]
    ds_write_b32 v28, v116 offset:37120
    v_mul_f32 v185, v185, v105
    v_mfma_f32_16x16x32_bf16 v[252:255], a[248:251], a[178:181], v[252:255]
    s_waitcnt lgkmcnt(4)
    v_mul_f32 v186, v186, v106
    v_cvt_pk_bf16_f32 v115, v154, v186
    v_mfma_f32_16x16x32_bf16 v[252:255], a[252:255], a[58:61], v[252:255]
    v_mul_f32 v187, v187, v107
    v_mul_f32 v216, v216, v108
    v_mfma_f32_16x16x32_bf16 v[252:255], a[144:147], a[130:133], v[252:255]
    s_waitcnt lgkmcnt(1)
    v_mul_f32 v217, v217, v109
    v_mfma_f32_16x16x32_bf16 v[252:255], a[148:151], a[186:189], v[252:255]
    buffer_store_dwordx4 v[124:127], v25, s[16:19], s67 offen sc1
    v_mfma_f32_16x16x32_bf16 v[156:159], a[136:139], a[80:83], v[156:159]
    s_mov_b32 s67, 702464
    v_mul_f32 v218, v218, v110
    v_mul_f32 v219, v219, v111
    v_mfma_f32_16x16x32_bf16 v[156:159], a[140:143], a[84:87], v[156:159]
    v_cvt_pk_bf16_f32 v113, v216, v153
    v_cvt_pk_bf16_f32 v114, v185, v217
    v_mfma_f32_16x16x32_bf16 v[156:159], a[64:67], a[240:243], v[156:159]
    ds_write_b64 v26, v[112:113] offset:37120
    v_cvt_pk_bf16_f32 v92, v218, v155
    v_mfma_f32_16x16x32_bf16 v[156:159], a[68:71], a[244:247], v[156:159]
    ds_write_b64 v26, v[114:115] offset:37128
    v_cvt_pk_bf16_f32 v93, v187, v219
    v_mfma_f32_16x16x32_bf16 v[156:159], a[216:219], a[176:179], v[156:159]
    ds_write_b64 v26, v[92:93] offset:37136
    v_mfma_f32_16x16x32_bf16 v[156:159], a[220:223], a[180:183], v[156:159]
    ds_write_b64 v29, v[254:255] offset:8192
    v_mfma_f32_16x16x32_bf16 v[156:159], a[8:11], a[56:59], v[156:159]
    v_mfma_f32_16x16x32_bf16 v[156:159], a[12:15], a[60:63], v[156:159]
    v_mfma_f32_16x16x32_bf16 v[156:159], a[168:171], a[128:131], v[156:159]
    v_mfma_f32_16x16x32_bf16 v[156:159], a[172:175], a[132:135], v[156:159]
    v_mfma_f32_16x16x32_bf16 v[156:159], a[40:43], a[184:187], v[156:159]
    s_waitcnt lgkmcnt(0)
    s_barrier
    v_mfma_f32_16x16x32_bf16 v[156:159], a[44:47], a[188:191], v[156:159]
    ds_read_b128 v[48:51], v24 offset:37120
    ds_read_b64 v[88:89], v30 offset:8192
    v_mfma_f32_16x16x32_bf16 v[188:191], a[104:107], a[80:83], v[188:191]
    ds_read_b128 v[52:55], v24 offset:38048
    v_mfma_f32_16x16x32_bf16 v[188:191], a[108:111], a[84:87], v[188:191]
    v_mfma_f32_16x16x32_bf16 v[188:191], a[200:203], a[240:243], v[188:191]
    s_waitcnt vmcnt(12)
    v_xor_b32 v8, 15, v8
    v_or_b32 v8, v8, v0
    v_mfma_f32_16x16x32_bf16 v[188:191], a[204:207], a[244:247], v[188:191]
    v_mul_f32 v156, v156, v100
    v_mul_f32 v157, v157, v101
    v_mfma_f32_16x16x32_bf16 v[188:191], a[96:99], a[176:179], v[188:191]
    v_mul_f32 v158, v158, v102
    v_mul_f32 v159, v159, v103
    v_mfma_f32_16x16x32_bf16 v[188:191], a[100:103], a[180:183], v[188:191]
    s_waitcnt lgkmcnt(1)
    v_min_u32 v8, 1, v8
    v_mfma_f32_16x16x32_bf16 v[188:191], a[0:3], a[56:59], v[188:191]
    buffer_store_dwordx4 v[48:51], v25, s[16:19], s66 offen sc1
    v_mfma_f32_16x16x32_bf16 v[188:191], a[4:7], a[60:63], v[188:191]
    s_mov_b32 s66, 802816
    v_add_f32 v252, v252, v88
    v_mul_f32 v252, v252, v96
    v_mfma_f32_16x16x32_bf16 v[188:191], a[152:155], a[128:131], v[188:191]
    v_add_f32 v253, v253, v89
    v_mul_f32 v253, v253, v97
    v_mfma_f32_16x16x32_bf16 v[188:191], a[156:159], a[132:135], v[188:191]
    s_waitcnt lgkmcnt(0)
    v_cvt_pk_bf16_f32 v88, v252, v253
    v_mfma_f32_16x16x32_bf16 v[188:191], a[208:211], a[184:187], v[188:191]
    buffer_store_dwordx4 v[52:55], v25, s[16:19], s67 offen sc1
    v_mfma_f32_16x16x32_bf16 v[188:191], a[212:215], a[188:191], v[188:191]
    s_mov_b32 s67, 817152
    ds_write_b32 v28, v88 offset:44544
    v_lshlrev_b32 v8, 30, v8
    v_mfma_f32_16x16x32_bf16 v[220:223], a[112:115], a[80:83], v[220:223]
    v_mov_b32 v9, s76
    v_mfma_f32_16x16x32_bf16 v[220:223], a[116:119], a[84:87], v[220:223]
    v_mfma_f32_16x16x32_bf16 v[220:223], a[232:235], a[240:243], v[220:223]
    buffer_store_dword v9, v8, s[12:15], s78 offen sc1
    v_mfma_f32_16x16x32_bf16 v[220:223], a[236:239], a[244:247], v[220:223]
    v_mul_f32 v188, v188, v104
    v_cvt_pk_bf16_f32 v68, v156, v188
    v_mfma_f32_16x16x32_bf16 v[220:223], a[160:163], a[176:179], v[220:223]
    v_mul_f32 v189, v189, v105
    v_mul_f32 v190, v190, v106
    v_mfma_f32_16x16x32_bf16 v[220:223], a[164:167], a[180:183], v[220:223]
    v_cvt_pk_bf16_f32 v71, v158, v190
    v_mul_f32 v191, v191, v107
    v_mfma_f32_16x16x32_bf16 v[220:223], a[120:123], a[56:59], v[220:223]
    v_mfma_f32_16x16x32_bf16 v[220:223], a[124:127], a[60:63], v[220:223]
    v_mfma_f32_16x16x32_bf16 v[220:223], a[16:19], a[128:131], v[220:223]
    v_mfma_f32_16x16x32_bf16 v[220:223], a[20:23], a[132:135], v[220:223]
    v_mfma_f32_16x16x32_bf16 v[220:223], a[24:27], a[184:187], v[220:223]
    v_mfma_f32_16x16x32_bf16 v[220:223], a[28:31], a[188:191], v[220:223]
    s_nop 7
    v_mul_f32 v220, v220, v108
    v_mul_f32 v221, v221, v109
    v_mul_f32 v222, v222, v110
    v_mul_f32 v223, v223, v111
    v_cvt_pk_bf16_f32 v69, v220, v157
    v_cvt_pk_bf16_f32 v70, v189, v221
    v_cvt_pk_bf16_f32 v76, v222, v159
    v_cvt_pk_bf16_f32 v77, v191, v223
    ds_write_b64 v26, v[68:69] offset:44544
    ds_write_b64 v26, v[70:71] offset:44552
    ds_write_b64 v26, v[76:77] offset:44560
    s_waitcnt lgkmcnt(0)
    s_barrier
    ds_read_b128 v[80:83], v24 offset:44544
    ds_read_b128 v[72:75], v24 offset:45472
    s_waitcnt lgkmcnt(1)
    buffer_store_dwordx4 v[80:83], v25, s[16:19], s66 offen sc1
    s_waitcnt lgkmcnt(0)
    buffer_store_dwordx4 v[72:75], v25, s[16:19], s67 offen sc1
L_end:
    s_endpgm
L_slow0_1:
    s_mov_b32 s22, 0
    s_call_b64 s[20:21], L_tick
    buffer_load_dwordx4 v[72:75], v34, s[12:15], 0 offen sc1
    buffer_load_dwordx4 v[76:79], v44, s[12:15], 0 offen sc1
    s_waitcnt vmcnt(0)
    v_bitop3_b32 v12, v75, v79, s76 bitop3:0x7e
    v_cmp_lt_u32 vcc, 0xffff, v12
    s_cbranch_vccnz L_slow0_1
    s_branch L_back0_1
L_slow1_0:
    s_mov_b32 s22, 1
    s_call_b64 s[20:21], L_tick
    buffer_load_dwordx4 v[80:83], v32, s[12:15], s40 offen sc1
    buffer_load_dwordx4 v[84:87], v33, s[12:15], s40 offen sc1
    s_waitcnt vmcnt(0)
    v_bitop3_b32 v12, v83, v87, s76 bitop3:0x7e
    v_cmp_lt_u32 vcc, 0xffff, v12
    s_cbranch_vccnz L_slow1_0
    s_branch L_back1_0
L_slow1_1:
    s_mov_b32 s22, 1
    s_call_b64 s[20:21], L_tick
    buffer_load_dwordx4 v[88:91], v34, s[12:15], s40 offen sc1
    buffer_load_dwordx4 v[92:95], v44, s[12:15], s40 offen sc1
    s_waitcnt vmcnt(0)
    v_bitop3_b32 v12, v91, v95, s76 bitop3:0x7e
    v_cmp_lt_u32 vcc, 0xffff, v12
    s_cbranch_vccnz L_slow1_1
    s_branch L_back1_1
L_slow2_0:
    s_mov_b32 s22, 2
    s_call_b64 s[20:21], L_tick
    buffer_load_dwordx4 v[48:51], v32, s[12:15], s41 offen sc1
    buffer_load_dwordx4 v[52:55], v33, s[12:15], s41 offen sc1
    s_waitcnt vmcnt(0)
    v_bitop3_b32 v12, v51, v55, s76 bitop3:0x7e
    v_cmp_lt_u32 vcc, 0xffff, v12
    s_cbranch_vccnz L_slow2_0
    s_branch L_back2_0
L_slow2_1:
    s_mov_b32 s22, 2
    s_call_b64 s[20:21], L_tick
    buffer_load_dwordx4 v[64:67], v34, s[12:15], s41 offen sc1
    buffer_load_dwordx4 v[68:71], v44, s[12:15], s41 offen sc1
    s_waitcnt vmcnt(0)
    v_bitop3_b32 v12, v67, v71, s76 bitop3:0x7e
    v_cmp_lt_u32 vcc, 0xffff, v12
    s_cbranch_vccnz L_slow2_1
    s_branch L_back2_1
L_slow3_0:
    s_mov_b32 s22, 3
    s_call_b64 s[20:21], L_tick
    buffer_load_dwordx4 v[72:75], v32, s[12:15], s42 offen sc1
    buffer_load_dwordx4 v[76:79], v33, s[12:15], s42 offen sc1
    s_waitcnt vmcnt(0)
    v_bitop3_b32 v12, v75, v79, s76 bitop3:0x7e
    v_cmp_lt_u32 vcc, 0xffff, v12
    s_cbranch_vccnz L_slow3_0
    s_branch L_back3_0
L_slow3_1:
    s_mov_b32 s22, 3
    s_call_b64 s[20:21], L_tick
    buffer_load_dwordx4 v[80:83], v34, s[12:15], s42 offen sc1
    buffer_load_dwordx4 v[84:87], v44, s[12:15], s42 offen sc1
    s_waitcnt vmcnt(0)
    v_bitop3_b32 v12, v83, v87, s76 bitop3:0x7e
    v_cmp_lt_u32 vcc, 0xffff, v12
    s_cbranch_vccnz L_slow3_1
    s_branch L_back3_1
L_slow4_0:
    s_mov_b32 s22, 4
    s_call_b64 s[20:21], L_tick
    buffer_load_dwordx4 v[96:99], v32, s[12:15], s43 offen sc1
    buffer_load_dwordx4 v[100:103], v33, s[12:15], s43 offen sc1
    s_waitcnt vmcnt(0)
    v_bitop3_b32 v12, v99, v103, s76 bitop3:0x7e
    v_cmp_lt_u32 vcc, 0xffff, v12
    s_cbranch_vccnz L_slow4_0
    s_branch L_back4_0
L_slow4_1:
    s_mov_b32 s22, 4
    s_call_b64 s[20:21], L_tick
    buffer_load_dwordx4 v[104:107], v34, s[12:15], s43 offen sc1
    buffer_load_dwordx4 v[108:111], v44, s[12:15], s43 offen sc1
    s_waitcnt vmcnt(0)
    v_bitop3_b32 v12, v107, v111, s76 bitop3:0x7e
    v_cmp_lt_u32 vcc, 0xffff, v12
    s_cbranch_vccnz L_slow4_1
    s_branch L_back4_1
L_slow5_0:
    s_mov_b32 s22, 5
    s_call_b64 s[20:21], L_tick
    buffer_load_dwordx4 v[112:115], v32, s[12:15], s44 offen sc1
    buffer_load_dwordx4 v[116:119], v33, s[12:15], s44 offen sc1
    s_waitcnt vmcnt(0)
    v_bitop3_b32 v12, v115, v119, s76 bitop3:0x7e
    v_cmp_lt_u32 vcc, 0xffff, v12
    s_cbranch_vccnz L_slow5_0
    s_branch L_back5_0
L_slow5_1:
    s_mov_b32 s22, 5
    s_call_b64 s[20:21], L_tick
    buffer_load_dwordx4 v[120:123], v34, s[12:15], s44 offen sc1
    buffer_load_dwordx4 v[124:127], v44, s[12:15], s44 offen sc1
    s_waitcnt vmcnt(0)
    v_bitop3_b32 v12, v123, v127, s76 bitop3:0x7e
    v_cmp_lt_u32 vcc, 0xffff, v12
    s_cbranch_vccnz L_slow5_1
    s_branch L_back5_1
L_slow6_0:
    s_mov_b32 s22, 6
    s_call_b64 s[20:21], L_tick
    buffer_load_dwordx4 v[88:91], v32, s[12:15], s45 offen sc1
    buffer_load_dwordx4 v[92:95], v33, s[12:15], s45 offen sc1
    s_waitcnt vmcnt(0)
    v_bitop3_b32 v12, v91, v95, s76 bitop3:0x7e
    v_cmp_lt_u32 vcc, 0xffff, v12
    s_cbranch_vccnz L_slow6_0
    s_branch L_back6_0
L_slow6_1:
    s_mov_b32 s22, 6
    s_call_b64 s[20:21], L_tick
    buffer_load_dwordx4 v[48:51], v34, s[12:15], s45 offen sc1
    buffer_load_dwordx4 v[52:55], v44, s[12:15], s45 offen sc1
    s_waitcnt vmcnt(0)
    v_bitop3_b32 v12, v51, v55, s76 bitop3:0x7e
    v_cmp_lt_u32 vcc, 0xffff, v12
    s_cbranch_vccnz L_slow6_1
    s_branch L_back6_1
L_slow7_0:
    s_mov_b32 s22, 7
    s_call_b64 s[20:21], L_tick
    buffer_load_dwordx4 v[68:71], v32, s[12:15], s72 offen sc1
    buffer_load_dwordx4 v[72:75], v33, s[12:15], s72 offen sc1
    s_waitcnt vmcnt(0)
    v_bitop3_b32 v12, v71, v75, s76 bitop3:0x7e
    v_cmp_lt_u32 vcc, 0xffff, v12
    s_cbranch_vccnz L_slow7_0
    s_branch L_back7_0
L_slow7_1:
    s_mov_b32 s22, 7
    s_call_b64 s[20:21], L_tick
    buffer_load_dwordx4 v[76:79], v34, s[12:15], s72 offen sc1
    buffer_load_dwordx4 v[80:83], v44, s[12:15], s72 offen sc1
    s_waitcnt vmcnt(0)
    v_bitop3_b32 v12, v79, v83, s76 bitop3:0x7e
    v_cmp_lt_u32 vcc, 0xffff, v12
    s_cbranch_vccnz L_slow7_1
    s_branch L_back7_1
L_tick:
    s_add_u32 s52, s52, 1
    s_and_b32 s23, s52, 4095
    s_cbranch_scc1 L_tick_ret
L_help:
    s_mov_b32 s53, s61
    s_mov_b32 s54, s62
    s_mul_i32 s61, s22, 1835008
    s_add_u32 s61, s61, s79
    s_lshl_b32 s62, s22, 14
    s_add_u32 s62, s62, s68
    s_mov_b32 s22, 0
L_help_row:
    v_mov_b32 v21, v19
    s_xor_b32 s23, s22, s58
    s_bitcmp0_b32 s23, 2
    s_cbranch_scc1 L_help_same
    v_add_u32 v12, 57344, v19
    v_subrev_u32 v13, 57344, v19
    v_min_u32 v21, v12, v13
L_help_same:
    v_mov_b32 v8, 0
    v_mov_b32 v9, 0
    v_mov_b32 v10, 0
    v_mov_b32 v11, s47
    s_mov_b32 s23, 0
L_help_e:
    v_mov_b32 v15, 0
    buffer_load_dwordx3 v[12:14], v18, s[4:7], s61 offen
    s_cmp_ge_u32 s23, 16
    s_cbranch_scc1 L_help_own
    buffer_load_dword v15, v21, s[4:7], s61 offen
L_help_own:
    s_waitcnt vmcnt(0)
    v_lshl_or_b32 v8, v12, s23, v8
    v_lshl_or_b32 v9, v13, s23, v9
    v_lshl_or_b32 v10, v14, s23, v10
    v_lshl_or_b32 v11, v15, s23, v11
    s_add_u32 s61, s61, 14336
    s_add_u32 s23, s23, 4
    s_cmp_lt_u32 s23, 32
    s_cbranch_scc1 L_help_e
    buffer_store_dwordx4 v[8:11], v20, s[12:15], s62 offen sc1
    s_add_u32 s62, s62, 1024
    s_waitcnt vmcnt(0)
    s_add_u32 s22, s22, 1
    s_cmp_lt_u32 s22, 16
    s_cbranch_scc1 L_help_row
    s_mov_b32 s61, s53
    s_mov_b32 s62, s54
L_tick_ret:
    s_setpc_b64 s[20:21]
L_code_end:

.section .rodata,"a"
.p2align 6
.amdhsa_kernel standalone__normalfloat_lut_af4__prompt_kernel
  .amdhsa_next_free_vgpr 512
  .amdhsa_next_free_sgpr 102
  .amdhsa_accum_offset 256
  .amdhsa_group_segment_fixed_size 0
  .amdhsa_kernarg_size 56
  .amdhsa_user_sgpr_count 2
  .amdhsa_user_sgpr_kernarg_segment_ptr 1
  .amdhsa_system_sgpr_workgroup_id_x 1
.end_amdhsa_kernel
```

```asm
; @launch grid=(256,1,1) block=(256,1,1) lds=163840
.amdgcn_target "amdgcn-amd-amdhsa--gfx950"
.text
.globl standalone__normalfloat_lut_af4__prompt_kernel
.p2align 8
.type standalone__normalfloat_lut_af4__prompt_kernel,@function
standalone__normalfloat_lut_af4__prompt_kernel:
    s_cmp_ge_u32 s2, 256
    s_cbranch_scc1 L_end
    s_load_dwordx2 s[4:5], s[0:1], 8
    s_load_dwordx2 s[12:13], s[0:1], 48
    s_load_dwordx2 s[8:9], s[0:1], 0
    s_load_dwordx2 s[28:29], s[0:1], 16
    s_getpc_b64 s[48:49]
    s_mov_b32 s50, L_code_end-standalone__normalfloat_lut_af4__prompt_kernel-256
    s_mov_b32 s51, 0x20000
    s_lshr_b32 s61, s2, 3
    v_lshl_add_u32 v46, v0, 5, s61
    v_lshlrev_b32 v46, 7, v46
    buffer_load_dword v1, v46, s[48:51], 0 offen offset:256
    v_lshrrev_b32 v5, 6, v0
    v_and_b32 v2, 63, v0
    s_and_b32 s60, s2, 7
    v_readfirstlane_b32 s63, v5
    s_and_b32 s58, s60, 1
    s_lshl_b32 s58, s58, 3
    s_and_b32 s62, s61, 7
    s_add_u32 s58, s58, s62
    s_lshr_b32 s59, s60, 1
    s_lshl_b32 s59, s59, 2
    s_lshr_b32 s62, s61, 3
    s_add_u32 s59, s59, s62
    v_mul_u32_u24 v18, 12, v2
    s_lshl_b32 s60, s63, 4
    s_add_u32 s60, s60, s58
    s_mul_i32 s61, s60, 114688
    s_mul_i32 s79, s59, 896
    s_add_u32 s61, s61, s79
    s_mov_b32 s6, 14680064
    s_mov_b32 s7, 0x20000
    s_lshl_b32 s78, s59, 7
    s_add_u32 s78, s78, 2097164
    v_and_b32 v4, 15, v2
    v_lshrrev_b32 v3, 4, v2
    v_and_b32 v12, 1, v3
    v_lshlrev_b32 v13, 1, v12
    v_xor_b32 v13, v13, v4
    v_lshrrev_b32 v19, 1, v3
    v_lshl_add_u32 v19, v19, 4, v13
    s_bfe_u32 s70, s58, 0x10002
    s_xor_b32 s70, s70, 1
    v_xor_b32 v12, s70, v12
    v_mul_u32_u24 v12, 14336, v12
    v_add_lshl_u32 v19, v19, v12, 2
    v_add_u32 v19, 768, v19
    s_mov_b32 s46, 2
    s_cmp_lg_u32 s63, 0
    s_cbranch_scc1 L_role0
    s_mov_b32 s46, 0
L_role0:
    s_cmp_lg_u32 s63, 1
    s_cbranch_scc1 L_role1
    s_mov_b32 s46, 1
L_role1:
    v_lshlrev_b32 v16, 1, v4
    v_lshrrev_b32 v17, 4, v0
    v_lshlrev_b32 v17, 1, v17
    s_mov_b32 s30, 32
    s_mov_b32 s31, 0x20000
    v_lshrrev_b32 v6, 3, v2
    v_and_b32 v7, 7, v2
    v_xor_b32 v13, v7, v3
    s_lshl_b32 s70, s63, 5
    v_add_lshl_u32 v12, v6, s70, 11
    v_lshl_add_u32 v36, v13, 4, v12
    v_xor_b32 v37, 64, v36
    v_add_u32 v37, 15360, v37
    v_add_u32 v38, 30720, v36
    v_add_u32 v39, 30720, v37
    s_mov_b32 s10, 4194304
    s_mov_b32 s11, 0x20000
    s_lshl_b32 s55, s58, 18
    s_and_b32 s71, s58, 8
    s_lshl_b32 s70, s71, 4
    s_add_u32 s55, s55, s70
    s_lshl_b32 s57, s63, 12
    s_xor_b32 s69, s55, 128
    s_add_u32 s57, s57, 65536
    s_mov_b32 s14, 2099200
    s_mov_b32 s15, 0x20000
    s_lshl_b32 s68, s59, 17
    s_lshl_b32 s62, s60, 10
    s_add_u32 s62, s62, s68
    v_lshlrev_b32 v20, 4, v2
    s_waitcnt lgkmcnt(0)
    s_load_dword s76, s[12:13], s78
    s_cmp_eq_u32 s46, 1
    s_cbranch_scc1 L_L
    s_cmp_eq_u32 s46, 2
    s_cbranch_scc1 L_L
L_X:
    buffer_load_dwordx3 v[128:130], v18, s[4:7], s61 offen nt
    buffer_load_dword v131, v19, s[4:7], s61 offen nt
    s_add_u32 s61, s61, 14336
    buffer_load_dwordx3 v[132:134], v18, s[4:7], s61 offen nt
    buffer_load_dword v135, v19, s[4:7], s61 offen nt
    s_add_u32 s61, s61, 14336
    buffer_load_dwordx3 v[136:138], v18, s[4:7], s61 offen nt
    buffer_load_dword v139, v19, s[4:7], s61 offen nt
    s_add_u32 s61, s61, 14336
    buffer_load_dwordx3 v[140:142], v18, s[4:7], s61 offen nt
    buffer_load_dword v143, v19, s[4:7], s61 offen nt
    s_add_u32 s61, s61, 14336
    buffer_load_dwordx3 v[144:146], v18, s[4:7], s61 offen nt
    s_add_u32 s61, s61, 14336
    buffer_load_dwordx3 v[148:150], v18, s[4:7], s61 offen nt
    s_add_u32 s61, s61, 14336
    buffer_load_dwordx3 v[152:154], v18, s[4:7], s61 offen nt
    s_add_u32 s61, s61, 14336
    buffer_load_dwordx3 v[156:158], v18, s[4:7], s61 offen nt
    s_add_u32 s61, s61, 7239680
    s_cmp_eq_u32 s46, 1
    s_cbranch_scc1 L_D
    s_cmp_eq_u32 s46, 2
    s_cbranch_scc1 L_B
L_L:
    buffer_load_ushort v16, v16, s[28:31], 0 offen
    buffer_load_ushort v17, v17, s[28:31], 0 offen
    s_cmp_eq_u32 s46, 1
    s_cbranch_scc1 L_S
    s_cmp_eq_u32 s46, 2
    s_cbranch_scc1 L_S
L_D:
    s_add_u32 m0, s57, 32768
    s_add_u32 s56, s55, 0
    buffer_load_dwordx4 v36, s[8:11], s56 offen offset:0  lds
    buffer_load_dwordx4 v37, s[8:11], s56 offen offset:1024  lds
    buffer_load_dwordx4 v38, s[8:11], s56 offen offset:2048  lds
    buffer_load_dwordx4 v39, s[8:11], s56 offen offset:3072  lds
    s_cmp_eq_u32 s46, 1
    s_cbranch_scc1 L_G
    s_cmp_eq_u32 s46, 2
    s_cbranch_scc1 L_G
L_S:
    s_load_dwordx2 s[32:33], s[0:1], 24
    s_load_dwordx2 s[16:17], s[0:1], 32
    s_load_dwordx2 s[24:25], s[0:1], 40
    s_and_b32 s64, s63, 1
    s_lshr_b32 s65, s63, 1
    s_and_b32 s70, s58, 8
    s_lshl_b32 s70, s70, 10
    s_lshl_b32 s71, s64, 12
    s_add_u32 s70, s70, s71
    s_lshl_b32 s71, s63, 8
    s_add_u32 s70, s70, s71
    s_add_u32 s70, s70, s68
    v_lshl_add_u32 v32, v4, 4, s70
    v_lshl_add_u32 v32, v3, 10, v32
    v_xor_b32 v33, 4096, v32
    v_xor_b32 v34, 8192, v32
    v_xor_b32 v44, 12288, v32
    s_mov_b32 s36, 202114048
    s_mov_b32 s37, 202114304
    s_mov_b32 s38, 202114560
    s_mov_b32 s39, 202114816
    v_and_b32 v35, 31, v2
    v_lshlrev_b32 v35, 2, v35
    s_lshl_b32 s70, s64, 6
    s_add_u32 s70, s70, 65536
    v_lshrrev_b32 v12, 1, v4
    v_xor_b32 v12, v12, v3
    v_lshlrev_b32 v12, 4, v12
    v_lshl_add_u32 v12, v4, 7, v12
    v_xor_b32 v40, s70, v12
    v_xor_b32 v41, 64, v40
    v_add_u32 v42, 65536, v40
    v_add_u32 v43, 65536, v41
    s_mov_b32 s52, 0
    v_lshlrev_b32 v8, 4, v7
    v_lshl_add_u32 v8, v0, 8, v8
    v_xor_b32 v9, 16, v8
    v_xor_b32 v10, 32, v8
    v_xor_b32 v11, 48, v8
    v_xor_b32 v12, 64, v8
    v_xor_b32 v13, 80, v8
    v_xor_b32 v14, 96, v8
    v_xor_b32 v15, 112, v8
    s_cmp_eq_u32 s46, 1
    s_cbranch_scc1 L_X
    s_cmp_eq_u32 s46, 2
    s_cbranch_scc1 L_D
L_G:
    s_waitcnt lgkmcnt(0)
    s_add_u32 s76, s76, 2654435769
    s_and_b32 s47, s76, 0xffff0000
    s_cmp_eq_u32 s46, 1
    s_cbranch_scc1 L_T
    s_cmp_eq_u32 s46, 2
    s_cbranch_scc1 L_T
L_K:
    s_waitcnt vmcnt(16)
    v_or_b32 v131, s47, v131
    s_waitcnt vmcnt(15)
    v_lshl_or_b32 v128, v132, 4, v128
    v_lshl_or_b32 v129, v133, 4, v129
    v_lshl_or_b32 v130, v134, 4, v130
    s_waitcnt vmcnt(14)
    v_lshl_or_b32 v131, v135, 4, v131
    s_waitcnt vmcnt(13)
    v_lshl_or_b32 v128, v136, 8, v128
    v_lshl_or_b32 v129, v137, 8, v129
    v_lshl_or_b32 v130, v138, 8, v130
    s_waitcnt vmcnt(12)
    v_lshl_or_b32 v131, v139, 8, v131
    s_waitcnt vmcnt(11)
    v_lshl_or_b32 v128, v140, 12, v128
    v_lshl_or_b32 v129, v141, 12, v129
    v_lshl_or_b32 v130, v142, 12, v130
    s_waitcnt vmcnt(10)
    v_lshl_or_b32 v131, v143, 12, v131
    s_waitcnt vmcnt(9)
    v_lshl_or_b32 v128, v144, 16, v128
    v_lshl_or_b32 v129, v145, 16, v129
    v_lshl_or_b32 v130, v146, 16, v130
    s_waitcnt vmcnt(8)
    v_lshl_or_b32 v128, v148, 20, v128
    v_lshl_or_b32 v129, v149, 20, v129
    v_lshl_or_b32 v130, v150, 20, v130
    s_waitcnt vmcnt(7)
    v_lshl_or_b32 v128, v152, 24, v128
    v_lshl_or_b32 v129, v153, 24, v129
    v_lshl_or_b32 v130, v154, 24, v130
    s_waitcnt vmcnt(6)
    v_lshl_or_b32 v128, v156, 28, v128
    v_lshl_or_b32 v129, v157, 28, v129
    v_lshl_or_b32 v130, v158, 28, v130
    buffer_store_dwordx4 v[128:131], v20, s[12:15], s62 offen sc1
    s_add_u32 s62, s62, 65536
    s_cmp_eq_u32 s46, 1
    s_cbranch_scc1 L_B
    s_cmp_eq_u32 s46, 2
    s_cbranch_scc1 L_E
L_T:
    s_waitcnt vmcnt(16)
    s_cmp_eq_u32 s46, 1
    s_cbranch_scc1 L_rw1
    s_waitcnt vmcnt(5)
    s_cmp_eq_u32 s46, 0
    s_cbranch_scc1 L_rw1
    s_waitcnt vmcnt(4)
L_rw1:
    v_lshl_or_b32 v56, v17, 16, v16
    v_lshl_or_b32 v57, v17, 16, v16
    v_lshl_or_b32 v58, v17, 16, v16
    v_lshl_or_b32 v59, v17, 16, v16
    ds_write_b128 v8, v[56:59]
    ds_write_b128 v9, v[56:59]
    ds_write_b128 v10, v[56:59]
    ds_write_b128 v11, v[56:59]
    ds_write_b128 v12, v[56:59]
    ds_write_b128 v13, v[56:59]
    ds_write_b128 v14, v[56:59]
    ds_write_b128 v15, v[56:59]
    s_cmp_lg_u32 s46, 1
    s_cbranch_scc1 L_ed2
    s_waitcnt vmcnt(4)
    s_branch L_K
L_ed2:
    s_cmp_eq_u32 s46, 2
    s_cbranch_scc1 L_X
L_W:
    s_mov_b64 exec, 0
    s_cmp_eq_u32 s63, 0
    s_cbranch_scc1 L_pad0
L_warmed:
    s_mov_b64 exec, -1
L_B:
    s_waitcnt vmcnt(12) lgkmcnt(0)
    s_cmp_eq_u32 s46, 2
    s_cbranch_scc1 L_rw3
    s_waitcnt vmcnt(1)
L_rw3:
    s_barrier
L_Q:
    ds_read_b128 a[0:3], v40 offset:32768
    ds_read_b128 a[4:7], v41 offset:32768
    ds_read_b128 a[8:11], v40 offset:34816
    ds_read_b128 a[12:15], v41 offset:34816
    ds_read_b128 a[16:19], v40 offset:36864
    ds_read_b128 a[20:23], v41 offset:36864
    ds_read_b128 a[24:27], v40 offset:38912
    ds_read_b128 a[28:31], v41 offset:38912
    ds_read_b128 a[40:43], v40 offset:40960
    ds_read_b128 a[44:47], v41 offset:40960
    ds_read_b128 a[48:51], v40 offset:43008
    ds_read_b128 a[52:55], v41 offset:43008
    ds_read_b128 a[56:59], v40 offset:45056
    ds_read_b128 a[60:63], v41 offset:45056
    ds_read_b128 a[72:75], v40 offset:47104
    ds_read_b128 a[76:79], v41 offset:47104
L_P:
    buffer_load_dwordx4 v[64:67], v32, s[12:15], 0 offen sc1
    buffer_load_dwordx4 v[68:71], v33, s[12:15], 0 offen sc1
L_d:
    s_add_u32 m0, s57, 49152
    s_add_u32 s3, s69, 0
    buffer_load_dwordx4 v36, s[8:11], s3 offen offset:0  lds
    buffer_load_dwordx4 v37, s[8:11], s3 offen offset:1024  lds
    buffer_load_dwordx4 v38, s[8:11], s3 offen offset:2048  lds
    buffer_load_dwordx4 v39, s[8:11], s3 offen offset:3072  lds
    s_cmp_lg_u32 s46, 2
    s_cbranch_scc1 L_ed4
    s_waitcnt vmcnt(6)
    s_branch L_K
L_ed4:
L_E:
L_chk0:
    s_waitcnt vmcnt(5)
    s_cmp_eq_u32 s46, 2
    s_cbranch_scc1 L_rw5
    s_waitcnt vmcnt(4)
L_rw5:
    v_bitop3_b32 v12, v67, v71, s76 bitop3:0x7e
    v_cmp_lt_u32 vcc, 0xffff, v12
    s_cbranch_vccnz L_retry0
    buffer_load_dwordx4 v[72:75], v34, s[12:15], 0 offen sc1
    buffer_load_dwordx4 v[76:79], v44, s[12:15], 0 offen sc1
    v_perm_b32 v56, v64, v35, s36
    v_perm_b32 v57, v64, v35, s37
    v_perm_b32 v58, v64, v35, s38
    v_perm_b32 v59, v64, v35, s39
    v_perm_b32 v60, v68, v35, s36
    v_perm_b32 v61, v68, v35, s37
    v_perm_b32 v62, v68, v35, s38
    v_perm_b32 v63, v68, v35, s39
    ds_read_b32 a32, v56
    ds_read_b32 a33, v57
    ds_read_b32 a34, v58
    ds_read_b32 a35, v59
    ds_read_b32 a36, v60
    ds_read_b32 a37, v61
    ds_read_b32 a38, v62
    ds_read_b32 a39, v63
    v_perm_b32 v56, v65, v35, s36
    v_perm_b32 v57, v65, v35, s37
    v_perm_b32 v58, v65, v35, s38
    v_perm_b32 v59, v65, v35, s39
    v_perm_b32 v60, v69, v35, s36
    v_perm_b32 v61, v69, v35, s37
    ds_read_b32 a64, v56
    ds_read_b32 a65, v57
    ds_read_b32 a66, v58
    ds_read_b32 a67, v59
    s_cbranch_vccz L_main
L_retry0:
    s_add_u32 s52, s52, 1
    s_and_b32 s23, s52, 4095
    s_cbranch_scc1 L_retry0b
    s_mov_b32 s22, 0
    s_call_b64 s[20:21], L_help
L_retry0b:
    buffer_load_dwordx4 v[64:67], v32, s[12:15], 0 offen sc1
    buffer_load_dwordx4 v[68:71], v33, s[12:15], 0 offen sc1
    s_waitcnt vmcnt(0) lgkmcnt(0)
    s_branch L_chk0
.p2align 12
L_main:
L_pad0:
    s_cbranch_execz L_pad1
    s_waitcnt lgkmcnt(8)
    v_mfma_f32_16x16x32_bf16 v[128:131], a[32:35], a[0:3], 0
    s_waitcnt lgkmcnt(4)
    s_mov_b32 s40, 16384
    ds_read_b32 a68, v60
    v_mfma_f32_16x16x32_bf16 v[128:131], a[36:39], a[4:7], v[128:131]
    buffer_load_dwordx4 v[80:83], v32, s[12:15], s40 offen sc1
    v_mfma_f32_16x16x32_bf16 v[132:135], a[36:39], a[12:15], 0
    s_add_u32 m0, s57, 65536
    ds_read_b32 a69, v61
    v_perm_b32 v62, v69, v35, s38
    v_mfma_f32_16x16x32_bf16 v[132:135], a[32:35], a[8:11], v[132:135]
    s_add_u32 s56, s55, 256
    ds_read_b32 a70, v62
    v_perm_b32 v63, v69, v35, s39
    v_mfma_f32_16x16x32_bf16 v[136:139], a[32:35], a[16:19], 0
    s_add_u32 s3, s69, 256
    ds_read_b32 a71, v63
    v_mfma_f32_16x16x32_bf16 v[136:139], a[36:39], a[20:23], v[136:139]
    buffer_load_dwordx4 v[84:87], v33, s[12:15], s40 offen sc1
    v_mfma_f32_16x16x32_bf16 v[140:143], a[36:39], a[28:31], 0
    v_perm_b32 v56, v66, v35, s36
    v_perm_b32 v57, v66, v35, s37
    v_mfma_f32_16x16x32_bf16 v[140:143], a[32:35], a[24:27], v[140:143]
    ds_read_b32 a80, v56
    v_perm_b32 v58, v66, v35, s38
    v_mfma_f32_16x16x32_bf16 v[144:147], a[32:35], a[40:43], 0
    ds_read_b32 a81, v57
    v_mfma_f32_16x16x32_bf16 v[144:147], a[36:39], a[44:47], v[144:147]
    buffer_load_dwordx4 v36, s[8:11], s56 offen offset:0  lds
    v_mfma_f32_16x16x32_bf16 v[148:151], a[36:39], a[52:55], 0
    ds_read_b32 a82, v58
    v_perm_b32 v59, v66, v35, s39
    v_mfma_f32_16x16x32_bf16 v[148:151], a[32:35], a[48:51], v[148:151]
    v_perm_b32 v60, v70, v35, s36
    v_perm_b32 v61, v70, v35, s37
    v_mfma_f32_16x16x32_bf16 v[152:155], a[32:35], a[56:59], 0
    s_mov_b32 s41, 32768
    ds_read_b32 a83, v59
    ds_read_b32 a84, v60
    v_mfma_f32_16x16x32_bf16 v[152:155], a[36:39], a[60:63], v[152:155]
    buffer_load_dwordx4 v37, s[8:11], s56 offen offset:1024  lds
    v_mfma_f32_16x16x32_bf16 v[156:159], a[36:39], a[76:79], 0
    ds_read_b32 a85, v61
    v_perm_b32 v62, v70, v35, s38
    v_mfma_f32_16x16x32_bf16 v[156:159], a[32:35], a[72:75], v[156:159]
    s_waitcnt lgkmcnt(6)
    ds_read_b32 a86, v62
    v_perm_b32 v63, v70, v35, s39
    v_mfma_f32_16x16x32_bf16 v[160:163], a[64:67], a[0:3], 0
    ds_read_b32 a87, v63
    v_mfma_f32_16x16x32_bf16 v[160:163], a[68:71], a[4:7], v[160:163]
    buffer_load_dwordx4 v38, s[8:11], s56 offen offset:2048  lds
    v_mfma_f32_16x16x32_bf16 v[164:167], a[68:71], a[12:15], 0
    v_perm_b32 v56, v67, v35, s36
    v_perm_b32 v57, v67, v35, s37
    v_mfma_f32_16x16x32_bf16 v[164:167], a[64:67], a[8:11], v[164:167]
    ds_read_b32 a88, v56
    v_perm_b32 v58, v71, v35, s36
    v_mfma_f32_16x16x32_bf16 v[168:171], a[64:67], a[16:19], 0
    ds_read_b32 a89, v57
    v_mfma_f32_16x16x32_bf16 v[168:171], a[68:71], a[20:23], v[168:171]
    buffer_load_dwordx4 v39, s[8:11], s56 offen offset:3072  lds
    v_mfma_f32_16x16x32_bf16 v[172:175], a[68:71], a[28:31], 0
    s_add_u32 m0, s57, 81920
    ds_read_b32 a90, v58
    v_perm_b32 v59, v71, v35, s37
    v_mfma_f32_16x16x32_bf16 v[172:175], a[64:67], a[24:27], v[172:175]
    s_add_u32 s56, s55, 512
    ds_read_b32 a91, v59
    v_mfma_f32_16x16x32_bf16 v[176:179], a[64:67], a[40:43], 0
    s_waitcnt vmcnt(6)
    s_mov_b32 s42, 49152
    v_bitop3_b32 v60, v75, v79, s76 bitop3:0x7e
    v_mfma_f32_16x16x32_bf16 v[176:179], a[68:71], a[44:47], v[176:179]
    buffer_load_dwordx4 v[88:91], v34, s[12:15], s40 offen sc1
    v_mfma_f32_16x16x32_bf16 v[180:183], a[68:71], a[52:55], 0
    v_cmp_lt_u32 vcc, 0xffff, v60
    v_mfma_f32_16x16x32_bf16 v[180:183], a[64:67], a[48:51], v[180:183]
    v_mfma_f32_16x16x32_bf16 v[184:187], a[64:67], a[56:59], 0
    s_cbranch_vccnz L_slow0_1
L_back0_1:
    v_mfma_f32_16x16x32_bf16 v[184:187], a[68:71], a[60:63], v[184:187]
    buffer_load_dwordx4 v[92:95], v44, s[12:15], s40 offen sc1
    v_mfma_f32_16x16x32_bf16 v[188:191], a[68:71], a[76:79], 0
    v_perm_b32 v61, v72, v35, s36
    v_perm_b32 v62, v72, v35, s37
    v_mfma_f32_16x16x32_bf16 v[188:191], a[64:67], a[72:75], v[188:191]
    s_waitcnt lgkmcnt(1)
    ds_read_b32 a96, v61
    v_perm_b32 v63, v72, v35, s38
    v_mfma_f32_16x16x32_bf16 v[192:195], a[80:83], a[0:3], 0
    s_barrier
    v_mfma_f32_16x16x32_bf16 v[192:195], a[84:87], a[4:7], v[192:195]
    buffer_load_dwordx4 v36, s[8:11], s3 offen offset:0  lds
    v_mfma_f32_16x16x32_bf16 v[196:199], a[84:87], a[12:15], 0
    ds_read_b32 a97, v62
    ds_read_b32 a98, v63
    v_mfma_f32_16x16x32_bf16 v[196:199], a[80:83], a[8:11], v[196:199]
    ds_read_b128 a[104:107], v40 offset:49152
    v_perm_b32 v56, v72, v35, s39
    v_mfma_f32_16x16x32_bf16 v[200:203], a[80:83], a[16:19], 0
    s_mov_b32 s43, 65536
    ds_read_b32 a99, v56
    ds_read_b128 a[108:111], v41 offset:49152
    v_mfma_f32_16x16x32_bf16 v[200:203], a[84:87], a[20:23], v[200:203]
    buffer_load_dwordx4 v37, s[8:11], s3 offen offset:1024  lds
    v_mfma_f32_16x16x32_bf16 v[204:207], a[84:87], a[28:31], 0
    ds_read_b128 a[112:115], v40 offset:51200
    v_perm_b32 v57, v76, v35, s36
    v_mfma_f32_16x16x32_bf16 v[204:207], a[80:83], a[24:27], v[204:207]
    ds_read_b32 a100, v57
    v_perm_b32 v58, v76, v35, s37
    v_mfma_f32_16x16x32_bf16 v[208:211], a[80:83], a[40:43], 0
    ds_read_b32 a101, v58
    ds_read_b128 a[116:119], v41 offset:51200
    v_mfma_f32_16x16x32_bf16 v[208:211], a[84:87], a[44:47], v[208:211]
    buffer_load_dwordx4 v38, s[8:11], s3 offen offset:2048  lds
    v_mfma_f32_16x16x32_bf16 v[212:215], a[84:87], a[52:55], 0
    ds_read_b128 a[120:123], v40 offset:53248
    v_perm_b32 v59, v76, v35, s38
    v_mfma_f32_16x16x32_bf16 v[212:215], a[80:83], a[48:51], v[212:215]
    ds_read_b32 a102, v59
    v_perm_b32 v60, v76, v35, s39
    v_mfma_f32_16x16x32_bf16 v[216:219], a[80:83], a[56:59], 0
    ds_read_b32 a103, v60
    ds_read_b128 a[124:127], v41 offset:53248
    v_mfma_f32_16x16x32_bf16 v[216:219], a[84:87], a[60:63], v[216:219]
    ds_read_b128 a[128:131], v40 offset:55296
    v_perm_b32 v61, v73, v35, s36
    v_mfma_f32_16x16x32_bf16 v[220:223], a[84:87], a[76:79], 0
    ds_read_b32 a136, v61
    v_perm_b32 v62, v73, v35, s37
    v_mfma_f32_16x16x32_bf16 v[220:223], a[80:83], a[72:75], v[220:223]
    s_waitcnt lgkmcnt(9)
    ds_read_b32 a137, v62
    ds_read_b128 a[132:135], v41 offset:55296
    v_mfma_f32_16x16x32_bf16 v[224:227], a[88:91], a[2:5], 0
    buffer_load_dwordx4 v39, s[8:11], s3 offen offset:3072  lds
    v_mfma_f32_16x16x32_bf16 v[228:231], a[88:91], a[10:13], 0
    s_add_u32 m0, s57, 0
    ds_read_b128 a[144:147], v40 offset:57344
    v_perm_b32 v63, v73, v35, s38
    v_mfma_f32_16x16x32_bf16 v[232:235], a[88:91], a[18:21], 0
    s_add_u32 s3, s69, 512
    ds_read_b32 a138, v63
    v_perm_b32 v56, v73, v35, s39
    v_mfma_f32_16x16x32_bf16 v[236:239], a[88:91], a[26:29], 0
    s_mov_b32 s44, 81920
    ds_read_b32 a139, v56
    v_perm_b32 v57, v77, v35, s36
    v_mfma_f32_16x16x32_bf16 v[240:243], a[88:91], a[42:45], 0
    ds_read_b32 a140, v57
    ds_read_b128 a[148:151], v41 offset:57344
    v_mfma_f32_16x16x32_bf16 v[244:247], a[88:91], a[50:53], 0
    buffer_load_dwordx3 v[96:98], v18, s[4:7], s61 offen nt
    v_mfma_f32_16x16x32_bf16 v[248:251], a[88:91], a[58:61], 0
    ds_read_b128 a[152:155], v40 offset:59392
    v_perm_b32 v58, v77, v35, s37
    v_mfma_f32_16x16x32_bf16 v[252:255], a[88:91], a[74:77], 0
    ds_read_b128 a[156:159], v41 offset:59392
    v_perm_b32 v59, v77, v35, s38
    v_mfma_f32_16x16x32_bf16 v[128:131], a[96:99], a[104:107], v[128:131]
    s_waitcnt lgkmcnt(7)
    ds_read_b32 a141, v58
    ds_read_b32 a142, v59
    v_mfma_f32_16x16x32_bf16 v[128:131], a[100:103], a[108:111], v[128:131]
    buffer_load_dword v99, v19, s[4:7], s61 offen nt
    v_mfma_f32_16x16x32_bf16 v[132:135], a[100:103], a[116:119], v[132:135]
    s_add_u32 s61, s61, 14336
    ds_read_b128 a[160:163], v40 offset:61440
    v_perm_b32 v60, v77, v35, s39
    v_mfma_f32_16x16x32_bf16 v[132:135], a[96:99], a[112:115], v[132:135]
    s_waitcnt vmcnt(12)
    v_bitop3_b32 v61, v83, v87, s76 bitop3:0x7e
    v_perm_b32 v62, v74, v35, s36
    v_mfma_f32_16x16x32_bf16 v[136:139], a[96:99], a[120:123], v[136:139]
    s_mov_b32 s45, 98304
    ds_read_b128 a[164:167], v41 offset:61440
    ds_read_b32 a143, v60
    v_mfma_f32_16x16x32_bf16 v[136:139], a[100:103], a[124:127], v[136:139]
    buffer_load_dwordx3 v[100:102], v18, s[4:7], s61 offen nt
    v_mfma_f32_16x16x32_bf16 v[140:143], a[100:103], a[132:135], v[140:143]
    ds_read_b128 a[168:171], v40 offset:63488
    ds_read_b32 a176, v62
    v_mfma_f32_16x16x32_bf16 v[140:143], a[96:99], a[128:131], v[140:143]
    s_waitcnt lgkmcnt(8)
    ds_read_b128 a[172:175], v41 offset:63488
    v_cmp_lt_u32 vcc, 0xffff, v61
    v_mfma_f32_16x16x32_bf16 v[144:147], a[96:99], a[144:147], v[144:147]
    s_waitcnt lgkmcnt(8)
    v_perm_b32 v63, v74, v35, s37
    v_mfma_f32_16x16x32_bf16 v[144:147], a[100:103], a[148:151], v[144:147]
    buffer_load_dword v103, v19, s[4:7], s61 offen nt
    v_mfma_f32_16x16x32_bf16 v[148:151], a[100:103], a[156:159], v[148:151]
    s_add_u32 s61, s61, 14336
    ds_read_b32 a177, v63
    v_perm_b32 v56, v74, v35, s38
    v_mfma_f32_16x16x32_bf16 v[148:151], a[96:99], a[152:155], v[148:151]
    s_waitcnt lgkmcnt(6)
    v_perm_b32 v57, v74, v35, s39
    s_cbranch_vccnz L_slow1_0
L_back1_0:
    v_mfma_f32_16x16x32_bf16 v[152:155], a[96:99], a[160:163], v[152:155]
    s_waitcnt lgkmcnt(5)
    ds_read_b32 a178, v56
    ds_read_b32 a179, v57
    v_mfma_f32_16x16x32_bf16 v[152:155], a[100:103], a[164:167], v[152:155]
    s_waitcnt lgkmcnt(3)
    buffer_load_dwordx3 v[104:106], v18, s[4:7], s61 offen nt
    v_mfma_f32_16x16x32_bf16 v[156:159], a[100:103], a[172:175], v[156:159]
    v_perm_b32 v58, v78, v35, s36
    v_perm_b32 v59, v78, v35, s37
    v_mfma_f32_16x16x32_bf16 v[156:159], a[96:99], a[168:171], v[156:159]
    ds_read_b32 a180, v58
    ds_read_b32 a181, v59
    v_perm_b32 v60, v78, v35, s38
    v_mfma_f32_16x16x32_bf16 v[160:163], a[136:139], a[104:107], v[160:163]
    s_mov_b32 s72, 114688
    ds_read_b32 a182, v60
    v_mfma_f32_16x16x32_bf16 v[160:163], a[140:143], a[108:111], v[160:163]
    buffer_load_dword v107, v19, s[4:7], s61 offen nt
    v_mfma_f32_16x16x32_bf16 v[164:167], a[140:143], a[116:119], v[164:167]
    s_add_u32 s61, s61, 14336
    v_perm_b32 v62, v78, v35, s39
    v_perm_b32 v61, v75, v35, s36
    v_mfma_f32_16x16x32_bf16 v[164:167], a[136:139], a[112:115], v[164:167]
    ds_read_b32 a183, v62
    v_perm_b32 v63, v75, v35, s37
    v_mfma_f32_16x16x32_bf16 v[168:171], a[136:139], a[120:123], v[168:171]
    ds_read_b32 a92, v61
    ds_read_b32 a93, v63
    v_mfma_f32_16x16x32_bf16 v[168:171], a[140:143], a[124:127], v[168:171]
    buffer_load_dwordx3 v[108:110], v18, s[4:7], s61 offen nt
    v_mfma_f32_16x16x32_bf16 v[172:175], a[140:143], a[132:135], v[172:175]
    v_perm_b32 v56, v79, v35, s36
    v_perm_b32 v57, v79, v35, s37
    v_mfma_f32_16x16x32_bf16 v[172:175], a[136:139], a[128:131], v[172:175]
    ds_read_b32 a94, v56
    v_perm_b32 v58, v80, v35, s36
    v_mfma_f32_16x16x32_bf16 v[176:179], a[136:139], a[144:147], v[176:179]
    ds_read_b32 a95, v57
    ds_read_b32 a184, v58
    v_mfma_f32_16x16x32_bf16 v[176:179], a[140:143], a[148:151], v[176:179]
    buffer_load_dword v111, v19, s[4:7], s61 offen nt
    v_mfma_f32_16x16x32_bf16 v[180:183], a[140:143], a[156:159], v[180:183]
    s_add_u32 s61, s61, 14336
    v_perm_b32 v59, v80, v35, s37
    v_perm_b32 v60, v80, v35, s38
    v_mfma_f32_16x16x32_bf16 v[180:183], a[136:139], a[152:155], v[180:183]
    ds_read_b32 a185, v59
    v_perm_b32 v62, v80, v35, s39
    v_mfma_f32_16x16x32_bf16 v[184:187], a[136:139], a[160:163], v[184:187]
    ds_read_b32 a186, v60
    ds_read_b32 a187, v62
    v_mfma_f32_16x16x32_bf16 v[184:187], a[140:143], a[164:167], v[184:187]
    buffer_load_dwordx3 v[112:114], v18, s[4:7], s61 offen nt
    v_mfma_f32_16x16x32_bf16 v[188:191], a[140:143], a[172:175], v[188:191]
    s_add_u32 s61, s61, 14336
    v_perm_b32 v61, v84, v35, s36
    v_perm_b32 v63, v84, v35, s37
    v_mfma_f32_16x16x32_bf16 v[188:191], a[136:139], a[168:171], v[188:191]
    s_waitcnt vmcnt(15) lgkmcnt(6)
    ds_read_b32 a188, v61
    v_perm_b32 v56, v84, v35, s38
    v_mfma_f32_16x16x32_bf16 v[192:195], a[176:179], a[104:107], v[192:195]
    s_barrier
    v_mfma_f32_16x16x32_bf16 v[192:195], a[180:183], a[108:111], v[192:195]
    buffer_load_dwordx3 v[116:118], v18, s[4:7], s61 offen nt
    v_mfma_f32_16x16x32_bf16 v[196:199], a[180:183], a[116:119], v[196:199]
    s_add_u32 s61, s61, 14336
    ds_read_b32 a189, v63
    ds_read_b128 a[192:195], v42 offset:0
    v_mfma_f32_16x16x32_bf16 v[196:199], a[176:179], a[112:115], v[196:199]
    ds_read_b32 a190, v56
    ds_read_b128 a[196:199], v43 offset:0
    v_mfma_f32_16x16x32_bf16 v[200:203], a[176:179], a[120:123], v[200:203]
    ds_read_b128 a[204:207], v43 offset:2048
    v_perm_b32 v57, v84, v35, s39
    v_mfma_f32_16x16x32_bf16 v[200:203], a[180:183], a[124:127], v[200:203]
    ds_read_b32 a191, v57
    ds_read_b128 a[200:203], v42 offset:2048
    v_mfma_f32_16x16x32_bf16 v[204:207], a[180:183], a[132:135], v[204:207]
    buffer_load_dwordx3 v[120:122], v18, s[4:7], s61 offen nt
    v_mfma_f32_16x16x32_bf16 v[204:207], a[176:179], a[128:131], v[204:207]
    s_add_u32 s61, s61, 14336
    ds_read_b128 a[208:211], v42 offset:4096
    v_perm_b32 v58, v81, v35, s36
    v_mfma_f32_16x16x32_bf16 v[208:211], a[176:179], a[144:147], v[208:211]
    ds_read_b128 a[212:215], v43 offset:4096
    ds_read_b32 a216, v58
    v_mfma_f32_16x16x32_bf16 v[208:211], a[180:183], a[148:151], v[208:211]
    s_waitcnt vmcnt(15)
    ds_read_b128 a[228:231], v43 offset:6144
    v_bitop3_b32 v59, v91, v95, s76 bitop3:0x7e
    v_mfma_f32_16x16x32_bf16 v[212:215], a[180:183], a[156:159], v[212:215]
    ds_read_b128 a[224:227], v42 offset:6144
    v_mfma_f32_16x16x32_bf16 v[212:215], a[176:179], a[152:155], v[212:215]
    buffer_load_dwordx3 v[124:126], v18, s[4:7], s61 offen nt
    v_mfma_f32_16x16x32_bf16 v[216:219], a[176:179], a[160:163], v[216:219]
    ds_read_b128 a[232:235], v42 offset:8192
    v_cmp_lt_u32 vcc, 0xffff, v59
    v_mfma_f32_16x16x32_bf16 v[216:219], a[180:183], a[164:167], v[216:219]
    ds_read_b128 a[236:239], v43 offset:8192
    v_perm_b32 v60, v81, v35, s37
    v_mfma_f32_16x16x32_bf16 v[220:223], a[180:183], a[172:175], v[220:223]
    ds_read_b128 a[240:243], v42 offset:10240
    ds_read_b32 a217, v60
    v_mfma_f32_16x16x32_bf16 v[220:223], a[176:179], a[168:171], v[220:223]
    s_waitcnt lgkmcnt(9)
    ds_read_b128 a[244:247], v43 offset:10240
    s_cbranch_vccnz L_slow1_1
L_back1_1:
    v_mfma_f32_16x16x32_bf16 v[224:227], a[92:95], a[106:109], v[224:227]
    buffer_load_dwordx4 v[48:51], v32, s[12:15], s41 offen sc1
    v_mfma_f32_16x16x32_bf16 v[228:231], a[92:95], a[114:117], v[228:231]
    ds_read_b128 a[248:251], v42 offset:12288
    v_perm_b32 v62, v81, v35, s38
    v_mfma_f32_16x16x32_bf16 v[232:235], a[92:95], a[122:125], v[232:235]
    ds_read_b32 a218, v62
    ds_read_b128 a[252:255], v43 offset:12288
    v_mfma_f32_16x16x32_bf16 v[236:239], a[92:95], a[130:133], v[236:239]
    v_perm_b32 v61, v81, v35, s39
    v_perm_b32 v63, v85, v35, s36
    v_mfma_f32_16x16x32_bf16 v[240:243], a[92:95], a[146:149], v[240:243]
    ds_read_b32 a219, v61
    ds_read_b32 a220, v63
    v_mfma_f32_16x16x32_bf16 v[244:247], a[92:95], a[154:157], v[244:247]
    buffer_load_dwordx4 v[52:55], v33, s[12:15], s41 offen sc1
    v_mfma_f32_16x16x32_bf16 v[248:251], a[92:95], a[162:165], v[248:251]
    ds_read_b128 a[32:35], v42 offset:14336
    v_perm_b32 v56, v85, v35, s37
    v_mfma_f32_16x16x32_bf16 v[252:255], a[92:95], a[170:173], v[252:255]
    ds_read_b32 a221, v56
    ds_read_b128 a[36:39], v43 offset:14336
    v_mfma_f32_16x16x32_bf16 v[128:131], a[184:187], a[192:195], v[128:131]
    v_perm_b32 v57, v85, v35, s38
    v_perm_b32 v58, v85, v35, s39
    v_mfma_f32_16x16x32_bf16 v[128:131], a[188:191], a[196:199], v[128:131]
    ds_read_b32 a222, v57
    ds_read_b32 a223, v58
    v_mfma_f32_16x16x32_bf16 v[132:135], a[188:191], a[204:207], v[132:135]
    v_perm_b32 v59, v82, v35, s36
    v_perm_b32 v60, v82, v35, s37
    v_mfma_f32_16x16x32_bf16 v[132:135], a[184:187], a[200:203], v[132:135]
    s_mul_i32 s66, s63, 96
    s_lshl_b32 s67, s65, 5
    s_lshl_b32 s70, s64, 2
    s_add_u32 s67, s67, s70
    s_add_u32 s67, s67, 384
    s_mul_i32 s71, s59, 448
    s_add_u32 s70, s66, s71
    v_mad_u32_u24 v22, v3, 24, s70
    s_add_u32 s70, s67, s71
    v_lshl_add_u32 v23, v3, 3, s70
    s_mov_b32 s34, 7168
    s_mov_b32 s35, 0x20000
    s_mov_b32 s26, 256
    s_mov_b32 s27, 0x20000
    s_lshl_b32 s77, s59, 4
    s_mov_b32 s18, 14680064
    s_mov_b32 s19, 0x20000
    s_sub_u32 s70, 1024, s71
    v_mul_u32_u24 v16, 464, v4
    v_add3_u32 v26, v22, v16, s70
    v_add3_u32 v28, v23, v16, s70
    v_lshlrev_b32 v29, 3, v0
    v_xor_b32 v30, 512, v29
    v_add_u32 v29, 52992, v29
    v_add_u32 v30, 52992, v30
    v_mul_u32_u24 v16, 2341, v2
    v_lshrrev_b32 v16, 16, v16
    s_mul_i32 s73, s63, 1856
    s_add_u32 s73, s73, 1024
    v_add_lshl_u32 v24, v2, v16, 4
    v_add_u32 v24, s73, v24
    s_lshl_b32 s74, s58, 7
    s_lshl_b32 s75, s63, 2
    s_add_u32 s74, s74, s75
    s_mul_i32 s74, s74, 7168
    s_add_u32 s74, s74, s71
    v_mul_u32_u24 v17, 6720, v16
    v_lshl_add_u32 v25, v2, 4, v17
    v_lshrrev_b32 v16, 1, v16
    v_lshlrev_b32 v16, 30, v16
    v_add3_u32 v25, v25, v16, s74
    s_waitcnt lgkmcnt(7)
    v_mfma_f32_16x16x32_bf16 v[136:139], a[184:187], a[208:211], v[136:139]
    buffer_load_dwordx4 v36, s[8:11], s56 offen offset:0  lds
    v_mfma_f32_16x16x32_bf16 v[136:139], a[188:191], a[212:215], v[136:139]
    ds_read_b32 a64, v59
    ds_read_b32 a65, v60
    v_mfma_f32_16x16x32_bf16 v[140:143], a[188:191], a[228:231], v[140:143]
    v_perm_b32 v62, v82, v35, s38
    v_perm_b32 v61, v82, v35, s39
    v_mfma_f32_16x16x32_bf16 v[140:143], a[184:187], a[224:227], v[140:143]
    ds_read_b32 a66, v62
    ds_read_b32 a67, v61
    v_mfma_f32_16x16x32_bf16 v[144:147], a[184:187], a[232:235], v[144:147]
    buffer_load_dwordx4 v37, s[8:11], s56 offen offset:1024  lds
    v_mfma_f32_16x16x32_bf16 v[144:147], a[188:191], a[236:239], v[144:147]
    v_perm_b32 v63, v86, v35, s36
    v_perm_b32 v56, v86, v35, s37
    v_mfma_f32_16x16x32_bf16 v[148:151], a[188:191], a[244:247], v[148:151]
    ds_read_b32 a68, v63
    ds_read_b32 a69, v56
    v_perm_b32 v57, v86, v35, s38
    v_mfma_f32_16x16x32_bf16 v[148:151], a[184:187], a[240:243], v[148:151]
    ds_read_b32 a70, v57
    v_mfma_f32_16x16x32_bf16 v[152:155], a[184:187], a[248:251], v[152:155]
    buffer_load_dwordx4 v38, s[8:11], s56 offen offset:2048  lds
    v_mfma_f32_16x16x32_bf16 v[152:155], a[188:191], a[252:255], v[152:155]
    s_waitcnt lgkmcnt(7)
    v_perm_b32 v58, v86, v35, s39
    v_perm_b32 v59, v83, v35, s36
    v_mfma_f32_16x16x32_bf16 v[156:159], a[188:191], a[36:39], v[156:159]
    ds_read_b32 a71, v58
    ds_read_b32 a80, v59
    v_perm_b32 v60, v83, v35, s37
    v_mfma_f32_16x16x32_bf16 v[156:159], a[184:187], a[32:35], v[156:159]
    ds_read_b32 a81, v60
    v_mfma_f32_16x16x32_bf16 v[160:163], a[216:219], a[192:195], v[160:163]
    buffer_load_dwordx4 v39, s[8:11], s56 offen offset:3072  lds
    v_mfma_f32_16x16x32_bf16 v[160:163], a[220:223], a[196:199], v[160:163]
    s_add_u32 m0, s57, 16384
    v_perm_b32 v62, v87, v35, s36
    v_perm_b32 v61, v87, v35, s37
    v_mfma_f32_16x16x32_bf16 v[164:167], a[220:223], a[204:207], v[164:167]
    s_add_u32 s56, s55, 768
    ds_read_b32 a82, v62
    v_perm_b32 v63, v88, v35, s36
    v_mfma_f32_16x16x32_bf16 v[164:167], a[216:219], a[200:203], v[164:167]
    ds_read_b32 a83, v61
    ds_read_b32 a0, v63
    v_mfma_f32_16x16x32_bf16 v[168:171], a[216:219], a[208:211], v[168:171]
    buffer_load_dwordx4 v[64:67], v34, s[12:15], s41 offen sc1
    v_mfma_f32_16x16x32_bf16 v[168:171], a[220:223], a[212:215], v[168:171]
    v_perm_b32 v56, v88, v35, s37
    v_perm_b32 v57, v88, v35, s38
    v_mfma_f32_16x16x32_bf16 v[172:175], a[220:223], a[228:231], v[172:175]
    ds_read_b32 a1, v56
    ds_read_b32 a2, v57
    v_perm_b32 v58, v88, v35, s39
    v_mfma_f32_16x16x32_bf16 v[172:175], a[216:219], a[224:227], v[172:175]
    ds_read_b32 a3, v58
    v_mfma_f32_16x16x32_bf16 v[176:179], a[216:219], a[232:235], v[176:179]
    buffer_load_dwordx4 v[68:71], v44, s[12:15], s41 offen sc1
    v_mfma_f32_16x16x32_bf16 v[176:179], a[220:223], a[236:239], v[176:179]
    v_perm_b32 v59, v92, v35, s36
    v_perm_b32 v60, v92, v35, s37
    v_mfma_f32_16x16x32_bf16 v[180:183], a[220:223], a[244:247], v[180:183]
    ds_read_b32 a4, v59
    ds_read_b32 a5, v60
    v_perm_b32 v62, v92, v35, s38
    v_mfma_f32_16x16x32_bf16 v[180:183], a[216:219], a[240:243], v[180:183]
    ds_read_b32 a6, v62
    v_mfma_f32_16x16x32_bf16 v[184:187], a[216:219], a[248:251], v[184:187]
    buffer_load_dwordx4 v[72:75], v32, s[12:15], s42 offen sc1
    v_mfma_f32_16x16x32_bf16 v[184:187], a[220:223], a[252:255], v[184:187]
    v_perm_b32 v61, v92, v35, s39
    v_perm_b32 v63, v89, v35, s36
    v_mfma_f32_16x16x32_bf16 v[188:191], a[220:223], a[36:39], v[188:191]
    ds_read_b32 a7, v61
    ds_read_b32 a8, v63
    v_perm_b32 v56, v89, v35, s37
    v_mfma_f32_16x16x32_bf16 v[188:191], a[216:219], a[32:35], v[188:191]
    s_waitcnt vmcnt(21) lgkmcnt(6)
    ds_read_b32 a9, v56
    v_mfma_f32_16x16x32_bf16 v[192:195], a[64:67], a[192:195], v[192:195]
    buffer_load_dwordx4 v[76:79], v33, s[12:15], s42 offen sc1
    v_mfma_f32_16x16x32_bf16 v[192:195], a[68:71], a[196:199], v[192:195]
    s_barrier
    v_mfma_f32_16x16x32_bf16 v[196:199], a[68:71], a[204:207], v[196:199]
    ds_read_b128 a[16:19], v42 offset:16384
    v_perm_b32 v57, v89, v35, s38
    v_mfma_f32_16x16x32_bf16 v[196:199], a[64:67], a[200:203], v[196:199]
    ds_read_b32 a10, v57
    ds_read_b128 a[20:23], v43 offset:16384
    v_mfma_f32_16x16x32_bf16 v[200:203], a[64:67], a[208:211], v[200:203]
    v_perm_b32 v58, v89, v35, s39
    v_perm_b32 v59, v93, v35, s36
    v_mfma_f32_16x16x32_bf16 v[200:203], a[68:71], a[212:215], v[200:203]
    ds_read_b32 a11, v58
    ds_read_b32 a12, v59
    v_mfma_f32_16x16x32_bf16 v[204:207], a[68:71], a[228:231], v[204:207]
    ds_read_b128 a[24:27], v42 offset:18432
    v_perm_b32 v60, v93, v35, s37
    v_mfma_f32_16x16x32_bf16 v[204:207], a[64:67], a[224:227], v[204:207]
    ds_read_b32 a13, v60
    ds_read_b128 a[28:31], v43 offset:18432
    v_mfma_f32_16x16x32_bf16 v[208:211], a[64:67], a[232:235], v[208:211]
    buffer_load_dwordx4 v36, s[8:11], s3 offen offset:0  lds
    v_mfma_f32_16x16x32_bf16 v[208:211], a[68:71], a[236:239], v[208:211]
    ds_read_b128 a[40:43], v42 offset:20480
    v_perm_b32 v62, v93, v35, s38
    v_mfma_f32_16x16x32_bf16 v[212:215], a[68:71], a[244:247], v[212:215]
    ds_read_b32 a14, v62
    v_perm_b32 v61, v93, v35, s39
    v_mfma_f32_16x16x32_bf16 v[212:215], a[64:67], a[240:243], v[212:215]
    ds_read_b32 a15, v61
    ds_read_b128 a[44:47], v43 offset:20480
    v_mfma_f32_16x16x32_bf16 v[216:219], a[64:67], a[248:251], v[216:219]
    v_perm_b32 v63, v90, v35, s36
    v_perm_b32 v56, v90, v35, s37
    v_mfma_f32_16x16x32_bf16 v[216:219], a[68:71], a[252:255], v[216:219]
    ds_read_b32 a48, v63
    ds_read_b32 a49, v56
    v_perm_b32 v57, v90, v35, s38
    v_mfma_f32_16x16x32_bf16 v[220:223], a[68:71], a[36:39], v[220:223]
    s_waitcnt vmcnt(19)
    ds_read_b32 a50, v57
    ds_read_b128 a[56:59], v42 offset:22528
    v_mfma_f32_16x16x32_bf16 v[220:223], a[64:67], a[32:35], v[220:223]
    buffer_load_dwordx4 v37, s[8:11], s3 offen offset:1024  lds
    v_mfma_f32_16x16x32_bf16 v[224:227], a[80:83], a[194:197], v[224:227]
    v_or_b32 v99, s47, v99
    v_lshl_or_b32 v96, v100, 4, v96
    v_lshl_or_b32 v97, v101, 4, v97
    v_lshl_or_b32 v98, v102, 4, v98
    v_lshl_or_b32 v99, v103, 4, v99
    s_waitcnt vmcnt(19)
    v_lshl_or_b32 v96, v104, 8, v96
    v_lshl_or_b32 v97, v105, 8, v97
    v_lshl_or_b32 v98, v106, 8, v98
    s_waitcnt vmcnt(18)
    v_lshl_or_b32 v99, v107, 8, v99
    s_waitcnt vmcnt(17)
    v_lshl_or_b32 v96, v108, 12, v96
    v_lshl_or_b32 v97, v109, 12, v97
    v_lshl_or_b32 v98, v110, 12, v98
    s_waitcnt vmcnt(16)
    v_lshl_or_b32 v99, v111, 12, v99
    s_waitcnt vmcnt(15)
    v_lshl_or_b32 v96, v112, 16, v96
    v_lshl_or_b32 v97, v113, 16, v97
    v_lshl_or_b32 v98, v114, 16, v98
    s_waitcnt vmcnt(14)
    v_lshl_or_b32 v96, v116, 20, v96
    v_lshl_or_b32 v97, v117, 20, v97
L_pad1:
    s_cbranch_execz L_pad2
    v_lshl_or_b32 v98, v118, 20, v98
    s_waitcnt vmcnt(13)
    v_lshl_or_b32 v96, v120, 24, v96
    v_lshl_or_b32 v97, v121, 24, v97
    v_lshl_or_b32 v98, v122, 24, v98
    s_waitcnt vmcnt(12)
    v_lshl_or_b32 v96, v124, 28, v96
    v_lshl_or_b32 v97, v125, 28, v97
    v_lshl_or_b32 v98, v126, 28, v98
    buffer_store_dwordx4 v[96:99], v20, s[12:15], s62 offen sc1
    v_mfma_f32_16x16x32_bf16 v[228:231], a[80:83], a[202:205], v[228:231]
    ds_read_b128 a[60:63], v43 offset:22528
    v_perm_b32 v58, v90, v35, s39
    v_mfma_f32_16x16x32_bf16 v[232:235], a[80:83], a[210:213], v[232:235]
    ds_read_b32 a51, v58
    ds_read_b128 a[72:75], v42 offset:24576
    v_mfma_f32_16x16x32_bf16 v[236:239], a[80:83], a[226:229], v[236:239]
    buffer_load_dwordx4 v38, s[8:11], s3 offen offset:2048  lds
    v_mfma_f32_16x16x32_bf16 v[240:243], a[80:83], a[234:237], v[240:243]
    s_waitcnt vmcnt(12)
    ds_read_b128 a[76:79], v43 offset:24576
    v_perm_b32 v59, v94, v35, s36
    v_mfma_f32_16x16x32_bf16 v[244:247], a[80:83], a[242:245], v[244:247]
    ds_read_b32 a52, v59
    v_bitop3_b32 v60, v51, v55, s76 bitop3:0x7e
    v_perm_b32 v62, v94, v35, s37
    v_mfma_f32_16x16x32_bf16 v[248:251], a[80:83], a[250:253], v[248:251]
    s_waitcnt lgkmcnt(7)
    ds_read_b32 a53, v62
    ds_read_b128 a[96:99], v42 offset:26624
    v_mfma_f32_16x16x32_bf16 v[252:255], a[80:83], a[34:37], v[252:255]
    buffer_load_dwordx4 v39, s[8:11], s3 offen offset:3072  lds
    v_mfma_f32_16x16x32_bf16 v[128:131], a[0:3], a[16:19], v[128:131]
    s_add_u32 m0, s57, 32768
    ds_read_b128 a[100:103], v43 offset:26624
    v_cmp_lt_u32 vcc, 0xffff, v60
    v_mfma_f32_16x16x32_bf16 v[128:131], a[4:7], a[20:23], v[128:131]
    s_add_u32 s3, s69, 768
    ds_read_b128 a[136:139], v42 offset:28672
    v_perm_b32 v61, v94, v35, s38
    v_mfma_f32_16x16x32_bf16 v[132:135], a[4:7], a[28:31], v[132:135]
    v_perm_b32 v63, v94, v35, s39
    s_cbranch_vccnz L_slow2_0
L_back2_0:
    v_mfma_f32_16x16x32_bf16 v[132:135], a[0:3], a[24:27], v[132:135]
    ds_read_b128 a[140:143], v43 offset:28672
    ds_read_b32 a54, v61
    v_mfma_f32_16x16x32_bf16 v[136:139], a[0:3], a[40:43], v[136:139]
    buffer_load_dwordx4 v36, s[8:11], s56 offen offset:0  lds
    v_mfma_f32_16x16x32_bf16 v[136:139], a[4:7], a[44:47], v[136:139]
    s_waitcnt lgkmcnt(7)
    ds_read_b128 a[176:179], v42 offset:30720
    ds_read_b32 a55, v63
    v_mfma_f32_16x16x32_bf16 v[140:143], a[4:7], a[60:63], v[140:143]
    v_perm_b32 v56, v91, v35, s36
    v_perm_b32 v57, v91, v35, s37
    v_mfma_f32_16x16x32_bf16 v[140:143], a[0:3], a[56:59], v[140:143]
    ds_read_b128 a[180:183], v43 offset:30720
    ds_read_b32 a84, v56
    v_mfma_f32_16x16x32_bf16 v[144:147], a[0:3], a[72:75], v[144:147]
    s_waitcnt lgkmcnt(7)
    ds_read_b32 a85, v57
    v_perm_b32 v58, v95, v35, s36
    v_mfma_f32_16x16x32_bf16 v[144:147], a[4:7], a[76:79], v[144:147]
    ds_read_b32 a86, v58
    v_perm_b32 v59, v95, v35, s37
    v_perm_b32 v62, v48, v35, s36
    v_mfma_f32_16x16x32_bf16 v[148:151], a[4:7], a[100:103], v[148:151]
    s_waitcnt lgkmcnt(8)
    ds_read_b32 a87, v59
    ds_read_b32 a104, v62
    v_mfma_f32_16x16x32_bf16 v[148:151], a[0:3], a[96:99], v[148:151]
    buffer_load_dwordx4 v37, s[8:11], s56 offen offset:1024  lds
    v_mfma_f32_16x16x32_bf16 v[152:155], a[0:3], a[136:139], v[152:155]
    s_waitcnt lgkmcnt(8)
    v_perm_b32 v60, v48, v35, s37
    v_perm_b32 v61, v48, v35, s38
    v_mfma_f32_16x16x32_bf16 v[152:155], a[4:7], a[140:143], v[152:155]
    s_waitcnt lgkmcnt(5)
    ds_read_b32 a105, v60
    ds_read_b32 a106, v61
    v_mfma_f32_16x16x32_bf16 v[156:159], a[4:7], a[180:183], v[156:159]
    v_perm_b32 v63, v48, v35, s39
    v_perm_b32 v56, v52, v35, s36
    v_mfma_f32_16x16x32_bf16 v[156:159], a[0:3], a[176:179], v[156:159]
    ds_read_b32 a107, v63
    ds_read_b32 a108, v56
    v_mfma_f32_16x16x32_bf16 v[160:163], a[8:11], a[16:19], v[160:163]
    v_perm_b32 v57, v52, v35, s37
    v_perm_b32 v58, v52, v35, s38
    v_mfma_f32_16x16x32_bf16 v[160:163], a[12:15], a[20:23], v[160:163]
    ds_read_b32 a109, v57
    ds_read_b32 a110, v58
    v_mfma_f32_16x16x32_bf16 v[164:167], a[12:15], a[28:31], v[164:167]
    buffer_load_dwordx4 v38, s[8:11], s56 offen offset:2048  lds
    v_mfma_f32_16x16x32_bf16 v[164:167], a[8:11], a[24:27], v[164:167]
    v_perm_b32 v59, v52, v35, s39
    v_perm_b32 v62, v49, v35, s36
    v_mfma_f32_16x16x32_bf16 v[168:171], a[8:11], a[40:43], v[168:171]
    ds_read_b32 a111, v59
    ds_read_b32 a112, v62
    v_mfma_f32_16x16x32_bf16 v[168:171], a[12:15], a[44:47], v[168:171]
    v_perm_b32 v60, v49, v35, s37
    v_perm_b32 v61, v49, v35, s38
    v_mfma_f32_16x16x32_bf16 v[172:175], a[12:15], a[60:63], v[172:175]
    ds_read_b32 a113, v60
    ds_read_b32 a114, v61
    v_mfma_f32_16x16x32_bf16 v[172:175], a[8:11], a[56:59], v[172:175]
    v_perm_b32 v63, v49, v35, s39
    v_perm_b32 v56, v53, v35, s36
    v_mfma_f32_16x16x32_bf16 v[176:179], a[8:11], a[72:75], v[176:179]
    ds_read_b32 a115, v63
    ds_read_b32 a116, v56
    v_perm_b32 v57, v53, v35, s37
    v_mfma_f32_16x16x32_bf16 v[176:179], a[12:15], a[76:79], v[176:179]
    s_waitcnt vmcnt(12)
    ds_read_b32 a117, v57
    v_mfma_f32_16x16x32_bf16 v[180:183], a[12:15], a[100:103], v[180:183]
    buffer_load_dwordx4 v39, s[8:11], s56 offen offset:3072  lds
    v_mfma_f32_16x16x32_bf16 v[180:183], a[8:11], a[96:99], v[180:183]
    s_barrier
    v_mfma_f32_16x16x32_bf16 v[184:187], a[8:11], a[136:139], v[184:187]
    s_add_u32 m0, s57, 49152
    ds_read_b128 a[120:123], v40 offset:0
    v_perm_b32 v58, v53, v35, s38
    v_mfma_f32_16x16x32_bf16 v[184:187], a[12:15], a[140:143], v[184:187]
    s_add_u32 s56, s55, 1024
    ds_read_b128 a[124:127], v41 offset:0
    ds_read_b32 a118, v58
    v_mfma_f32_16x16x32_bf16 v[188:191], a[12:15], a[180:183], v[188:191]
    ds_read_b128 a[132:135], v41 offset:2048
    v_perm_b32 v59, v53, v35, s39
    v_mfma_f32_16x16x32_bf16 v[188:191], a[8:11], a[176:179], v[188:191]
    ds_read_b128 a[128:131], v40 offset:2048
    ds_read_b32 a119, v59
    v_mfma_f32_16x16x32_bf16 v[192:195], a[48:51], a[16:19], v[192:195]
    ds_read_b128 a[144:147], v40 offset:4096
    v_mfma_f32_16x16x32_bf16 v[192:195], a[52:55], a[20:23], v[192:195]
    buffer_load_dwordx4 v36, s[8:11], s3 offen offset:0  lds
    v_mfma_f32_16x16x32_bf16 v[196:199], a[52:55], a[28:31], v[196:199]
    ds_read_b128 a[148:151], v41 offset:4096
    v_perm_b32 v62, v50, v35, s36
    v_mfma_f32_16x16x32_bf16 v[196:199], a[48:51], a[24:27], v[196:199]
    ds_read_b128 a[156:159], v41 offset:6144
    ds_read_b32 a160, v62
    v_mfma_f32_16x16x32_bf16 v[200:203], a[48:51], a[40:43], v[200:203]
    s_waitcnt vmcnt(12)
    ds_read_b128 a[152:155], v40 offset:6144
    v_bitop3_b32 v60, v67, v71, s76 bitop3:0x7e
    v_mfma_f32_16x16x32_bf16 v[200:203], a[52:55], a[44:47], v[200:203]
    ds_read_b128 a[88:91], v40 offset:8192
    v_cmp_lt_u32 vcc, 0xffff, v60
    v_mfma_f32_16x16x32_bf16 v[204:207], a[52:55], a[60:63], v[204:207]
    v_perm_b32 v61, v50, v35, s37
    v_perm_b32 v63, v50, v35, s38
    v_mfma_f32_16x16x32_bf16 v[204:207], a[48:51], a[56:59], v[204:207]
    ds_read_b32 a161, v61
    ds_read_b32 a162, v63
    v_mfma_f32_16x16x32_bf16 v[208:211], a[48:51], a[72:75], v[208:211]
    buffer_load_dwordx4 v37, s[8:11], s3 offen offset:1024  lds
    v_mfma_f32_16x16x32_bf16 v[208:211], a[52:55], a[76:79], v[208:211]
    ds_read_b128 a[92:95], v41 offset:8192
    s_cbranch_vccnz L_slow2_1
L_back2_1:
    v_mfma_f32_16x16x32_bf16 v[212:215], a[52:55], a[100:103], v[212:215]
    v_perm_b32 v56, v50, v35, s39
    v_perm_b32 v57, v54, v35, s36
    v_mfma_f32_16x16x32_bf16 v[212:215], a[48:51], a[96:99], v[212:215]
    ds_read_b32 a163, v56
    ds_read_b32 a164, v57
    v_mfma_f32_16x16x32_bf16 v[216:219], a[48:51], a[136:139], v[216:219]
    ds_read_b128 a[168:171], v40 offset:10240
    v_perm_b32 v58, v54, v35, s37
    v_mfma_f32_16x16x32_bf16 v[216:219], a[52:55], a[140:143], v[216:219]
    ds_read_b32 a165, v58
    v_perm_b32 v59, v54, v35, s38
    v_mfma_f32_16x16x32_bf16 v[220:223], a[52:55], a[180:183], v[220:223]
    ds_read_b32 a166, v59
    v_perm_b32 v62, v54, v35, s39
    v_mfma_f32_16x16x32_bf16 v[220:223], a[48:51], a[176:179], v[220:223]
    s_waitcnt lgkmcnt(8)
    ds_read_b128 a[172:175], v41 offset:10240
    ds_read_b32 a167, v62
    v_mfma_f32_16x16x32_bf16 v[224:227], a[84:87], a[18:21], v[224:227]
    buffer_load_dwordx4 v38, s[8:11], s3 offen offset:2048  lds
    v_mfma_f32_16x16x32_bf16 v[228:231], a[84:87], a[26:29], v[228:231]
    ds_read_b128 a[184:187], v40 offset:12288
    v_perm_b32 v60, v51, v35, s36
    v_mfma_f32_16x16x32_bf16 v[232:235], a[84:87], a[42:45], v[232:235]
    ds_read_b32 a216, v60
    v_perm_b32 v61, v51, v35, s37
    v_mfma_f32_16x16x32_bf16 v[236:239], a[84:87], a[58:61], v[236:239]
    ds_read_b32 a217, v61
    v_perm_b32 v63, v55, v35, s36
    v_mfma_f32_16x16x32_bf16 v[240:243], a[84:87], a[74:77], v[240:243]
    ds_read_b32 a218, v63
    ds_read_b128 a[188:191], v41 offset:12288
    v_mfma_f32_16x16x32_bf16 v[244:247], a[84:87], a[98:101], v[244:247]
    v_perm_b32 v56, v55, v35, s37
    v_perm_b32 v57, v64, v35, s36
    v_mfma_f32_16x16x32_bf16 v[248:251], a[84:87], a[138:141], v[248:251]
    ds_read_b32 a219, v56
    ds_read_b32 a64, v57
    v_mfma_f32_16x16x32_bf16 v[252:255], a[84:87], a[178:181], v[252:255]
    buffer_load_dwordx4 v39, s[8:11], s3 offen offset:3072  lds
    v_mfma_f32_16x16x32_bf16 v[128:131], a[104:107], a[120:123], v[128:131]
    s_add_u32 m0, s57, 65536
    ds_read_b128 a[192:195], v40 offset:14336
    v_perm_b32 v58, v64, v35, s37
    v_mfma_f32_16x16x32_bf16 v[128:131], a[108:111], a[124:127], v[128:131]
    s_add_u32 s3, s69, 1024
    ds_read_b32 a65, v58
    v_perm_b32 v59, v64, v35, s38
    v_mfma_f32_16x16x32_bf16 v[132:135], a[108:111], a[132:135], v[132:135]
    ds_read_b128 a[196:199], v41 offset:14336
    ds_read_b32 a66, v59
    v_perm_b32 v62, v64, v35, s39
    v_mfma_f32_16x16x32_bf16 v[132:135], a[104:107], a[128:131], v[132:135]
    ds_read_b32 a67, v62
    v_mfma_f32_16x16x32_bf16 v[136:139], a[104:107], a[144:147], v[136:139]
    buffer_load_dwordx4 v[80:83], v34, s[12:15], s42 offen sc1
    v_mfma_f32_16x16x32_bf16 v[136:139], a[108:111], a[148:151], v[136:139]
    s_waitcnt vmcnt(14)
    v_bitop3_b32 v60, v75, v79, s76 bitop3:0x7e
    v_perm_b32 v61, v68, v35, s36
    v_mfma_f32_16x16x32_bf16 v[140:143], a[108:111], a[156:159], v[140:143]
    ds_read_b32 a68, v61
    v_cmp_lt_u32 vcc, 0xffff, v60
    v_mfma_f32_16x16x32_bf16 v[140:143], a[104:107], a[152:155], v[140:143]
    v_perm_b32 v63, v68, v35, s37
    v_perm_b32 v56, v68, v35, s38
    v_mfma_f32_16x16x32_bf16 v[144:147], a[104:107], a[88:91], v[144:147]
    s_waitcnt lgkmcnt(6)
    ds_read_b32 a69, v63
    ds_read_b32 a70, v56
    v_mfma_f32_16x16x32_bf16 v[144:147], a[108:111], a[92:95], v[144:147]
    buffer_load_dwordx4 v[84:87], v44, s[12:15], s42 offen sc1
    v_mfma_f32_16x16x32_bf16 v[148:151], a[108:111], a[172:175], v[148:151]
    v_perm_b32 v57, v68, v35, s39
    s_cbranch_vccnz L_slow3_0
L_back3_0:
    v_mfma_f32_16x16x32_bf16 v[148:151], a[104:107], a[168:171], v[148:151]
    ds_read_b32 a71, v57
    v_perm_b32 v58, v65, v35, s36
    v_mfma_f32_16x16x32_bf16 v[152:155], a[104:107], a[184:187], v[152:155]
    ds_read_b32 a200, v58
    v_perm_b32 v59, v65, v35, s37
    v_mfma_f32_16x16x32_bf16 v[152:155], a[108:111], a[188:191], v[152:155]
    s_waitcnt lgkmcnt(5)
    ds_read_b32 a201, v59
    v_perm_b32 v62, v65, v35, s38
    v_mfma_f32_16x16x32_bf16 v[156:159], a[108:111], a[196:199], v[156:159]
    ds_read_b32 a202, v62
    v_perm_b32 v60, v65, v35, s39
    v_perm_b32 v61, v69, v35, s36
    v_mfma_f32_16x16x32_bf16 v[156:159], a[104:107], a[192:195], v[156:159]
    ds_read_b32 a203, v60
    ds_read_b32 a204, v61
    v_mfma_f32_16x16x32_bf16 v[160:163], a[112:115], a[120:123], v[160:163]
    buffer_load_dwordx4 v36, s[8:11], s56 offen offset:0  lds
    v_mfma_f32_16x16x32_bf16 v[160:163], a[116:119], a[124:127], v[160:163]
    v_perm_b32 v63, v69, v35, s37
    v_perm_b32 v56, v69, v35, s38
    v_mfma_f32_16x16x32_bf16 v[164:167], a[116:119], a[132:135], v[164:167]
    ds_read_b32 a205, v63
    ds_read_b32 a206, v56
    v_mfma_f32_16x16x32_bf16 v[164:167], a[112:115], a[128:131], v[164:167]
    v_perm_b32 v57, v69, v35, s39
    v_perm_b32 v58, v66, v35, s36
    v_mfma_f32_16x16x32_bf16 v[168:171], a[112:115], a[144:147], v[168:171]
    ds_read_b32 a207, v57
    ds_read_b32 a208, v58
    v_mfma_f32_16x16x32_bf16 v[168:171], a[116:119], a[148:151], v[168:171]
    buffer_load_dwordx4 v[96:99], v32, s[12:15], s43 offen sc1
    v_mfma_f32_16x16x32_bf16 v[172:175], a[116:119], a[156:159], v[172:175]
    v_perm_b32 v59, v66, v35, s37
    v_perm_b32 v62, v66, v35, s38
    v_mfma_f32_16x16x32_bf16 v[172:175], a[112:115], a[152:155], v[172:175]
    ds_read_b32 a209, v59
    ds_read_b32 a210, v62
    v_mfma_f32_16x16x32_bf16 v[176:179], a[112:115], a[88:91], v[176:179]
    v_perm_b32 v60, v66, v35, s39
    v_perm_b32 v61, v70, v35, s36
    v_mfma_f32_16x16x32_bf16 v[176:179], a[116:119], a[92:95], v[176:179]
    ds_read_b32 a211, v60
    ds_read_b32 a212, v61
    v_mfma_f32_16x16x32_bf16 v[180:183], a[116:119], a[172:175], v[180:183]
    buffer_load_dwordx4 v[100:103], v33, s[12:15], s43 offen sc1
    v_mfma_f32_16x16x32_bf16 v[180:183], a[112:115], a[168:171], v[180:183]
    v_perm_b32 v63, v70, v35, s37
    v_perm_b32 v56, v70, v35, s38
    v_mfma_f32_16x16x32_bf16 v[184:187], a[112:115], a[184:187], v[184:187]
    ds_read_b32 a213, v63
    ds_read_b32 a214, v56
    v_mfma_f32_16x16x32_bf16 v[184:187], a[116:119], a[188:191], v[184:187]
    v_perm_b32 v57, v70, v35, s39
    v_perm_b32 v58, v67, v35, s36
    v_mfma_f32_16x16x32_bf16 v[188:191], a[116:119], a[196:199], v[188:191]
    ds_read_b32 a215, v57
    ds_read_b32 a220, v58
    v_mfma_f32_16x16x32_bf16 v[188:191], a[112:115], a[192:195], v[188:191]
    s_waitcnt vmcnt(13)
    v_perm_b32 v59, v67, v35, s37
    v_perm_b32 v62, v71, v35, s36
    v_mfma_f32_16x16x32_bf16 v[192:195], a[160:163], a[120:123], v[192:195]
    s_barrier
    v_mfma_f32_16x16x32_bf16 v[192:195], a[164:167], a[124:127], v[192:195]
    buffer_load_dwordx4 v37, s[8:11], s56 offen offset:1024  lds
    v_mfma_f32_16x16x32_bf16 v[196:199], a[164:167], a[132:135], v[196:199]
    ds_read_b32 a221, v59
    ds_read_b32 a222, v62
    v_mfma_f32_16x16x32_bf16 v[196:199], a[160:163], a[128:131], v[196:199]
    ds_read_b128 a[224:227], v40 offset:16384
    v_perm_b32 v60, v71, v35, s37
    v_mfma_f32_16x16x32_bf16 v[200:203], a[160:163], a[144:147], v[200:203]
    ds_read_b32 a223, v60
    ds_read_b128 a[228:231], v41 offset:16384
    v_mfma_f32_16x16x32_bf16 v[200:203], a[164:167], a[148:151], v[200:203]
    ds_read_b128 a[232:235], v40 offset:18432
    v_perm_b32 v61, v72, v35, s36
    v_mfma_f32_16x16x32_bf16 v[204:207], a[164:167], a[156:159], v[204:207]
    ds_read_b32 a240, v61
    v_perm_b32 v63, v72, v35, s37
    v_mfma_f32_16x16x32_bf16 v[204:207], a[160:163], a[152:155], v[204:207]
    ds_read_b32 a241, v63
    ds_read_b128 a[236:239], v41 offset:18432
    v_mfma_f32_16x16x32_bf16 v[208:211], a[160:163], a[88:91], v[208:211]
    buffer_load_dwordx4 v38, s[8:11], s56 offen offset:2048  lds
    v_mfma_f32_16x16x32_bf16 v[208:211], a[164:167], a[92:95], v[208:211]
    ds_read_b128 a[248:251], v40 offset:20480
    v_perm_b32 v56, v72, v35, s38
    v_mfma_f32_16x16x32_bf16 v[212:215], a[164:167], a[172:175], v[212:215]
    ds_read_b32 a242, v56
    v_perm_b32 v57, v72, v35, s39
    v_mfma_f32_16x16x32_bf16 v[212:215], a[160:163], a[168:171], v[212:215]
    ds_read_b32 a243, v57
    ds_read_b128 a[252:255], v41 offset:20480
    v_mfma_f32_16x16x32_bf16 v[216:219], a[160:163], a[184:187], v[216:219]
    v_perm_b32 v58, v76, v35, s36
    v_perm_b32 v59, v76, v35, s37
    v_mfma_f32_16x16x32_bf16 v[216:219], a[164:167], a[188:191], v[216:219]
    ds_read_b32 a244, v58
    ds_read_b32 a245, v59
    v_mfma_f32_16x16x32_bf16 v[220:223], a[164:167], a[196:199], v[220:223]
    ds_read_b128 a[32:35], v40 offset:22528
    v_perm_b32 v62, v76, v35, s38
    v_mfma_f32_16x16x32_bf16 v[220:223], a[160:163], a[192:195], v[220:223]
    ds_read_b32 a246, v62
    ds_read_b128 a[36:39], v41 offset:22528
    v_mfma_f32_16x16x32_bf16 v[224:227], a[216:219], a[122:125], v[224:227]
    buffer_load_dwordx4 v39, s[8:11], s56 offen offset:3072  lds
    v_mfma_f32_16x16x32_bf16 v[228:231], a[216:219], a[130:133], v[228:231]
    s_add_u32 m0, s57, 81920
    ds_read_b128 a[0:3], v40 offset:24576
    v_perm_b32 v60, v76, v35, s39
    v_mfma_f32_16x16x32_bf16 v[232:235], a[216:219], a[146:149], v[232:235]
    ds_read_b32 a247, v60
    v_perm_b32 v61, v73, v35, s36
    v_mfma_f32_16x16x32_bf16 v[236:239], a[216:219], a[154:157], v[236:239]
    ds_read_b32 a8, v61
    ds_read_b128 a[4:7], v41 offset:24576
    v_mfma_f32_16x16x32_bf16 v[240:243], a[216:219], a[90:93], v[240:243]
    v_perm_b32 v63, v73, v35, s37
    v_perm_b32 v56, v73, v35, s38
    v_mfma_f32_16x16x32_bf16 v[244:247], a[216:219], a[170:173], v[244:247]
    ds_read_b32 a9, v63
    ds_read_b32 a10, v56
    v_perm_b32 v57, v73, v35, s39
    v_mfma_f32_16x16x32_bf16 v[248:251], a[216:219], a[186:189], v[248:251]
    s_waitcnt lgkmcnt(9)
    ds_read_b32 a11, v57
    ds_read_b128 a[48:51], v40 offset:26624
    v_mfma_f32_16x16x32_bf16 v[252:255], a[216:219], a[194:197], v[252:255]
    buffer_load_dwordx4 v36, s[8:11], s3 offen offset:0  lds
    v_mfma_f32_16x16x32_bf16 v[128:131], a[64:67], a[224:227], v[128:131]
    ds_read_b128 a[52:55], v41 offset:26624
    v_perm_b32 v58, v77, v35, s36
    v_mfma_f32_16x16x32_bf16 v[128:131], a[68:71], a[228:231], v[128:131]
    ds_read_b128 a[16:19], v40 offset:28672
    ds_read_b32 a12, v58
    v_mfma_f32_16x16x32_bf16 v[132:135], a[68:71], a[236:239], v[132:135]
    s_add_u32 s56, s55, 1280
    v_perm_b32 v59, v77, v35, s37
    v_perm_b32 v62, v77, v35, s38
    v_mfma_f32_16x16x32_bf16 v[132:135], a[64:67], a[232:235], v[132:135]
    ds_read_b128 a[20:23], v41 offset:28672
    ds_read_b32 a13, v59
    v_mfma_f32_16x16x32_bf16 v[136:139], a[64:67], a[248:251], v[136:139]
    ds_read_b32 a14, v62
    v_perm_b32 v60, v77, v35, s39
    v_mfma_f32_16x16x32_bf16 v[136:139], a[68:71], a[252:255], v[136:139]
    s_waitcnt lgkmcnt(10)
    ds_read_b128 a[24:27], v40 offset:30720
    ds_read_b32 a15, v60
    v_mfma_f32_16x16x32_bf16 v[140:143], a[68:71], a[36:39], v[140:143]
    buffer_load_dwordx4 v37, s[8:11], s3 offen offset:1024  lds
    v_mfma_f32_16x16x32_bf16 v[140:143], a[64:67], a[32:35], v[140:143]
    ds_read_b128 a[28:31], v41 offset:30720
    v_perm_b32 v61, v74, v35, s36
    v_mfma_f32_16x16x32_bf16 v[144:147], a[64:67], a[0:3], v[144:147]
    ds_read_b32 a40, v61
    v_perm_b32 v63, v74, v35, s37
    v_mfma_f32_16x16x32_bf16 v[144:147], a[68:71], a[4:7], v[144:147]
    s_waitcnt lgkmcnt(9)
    ds_read_b32 a41, v63
    v_perm_b32 v56, v74, v35, s38
    v_mfma_f32_16x16x32_bf16 v[148:151], a[68:71], a[52:55], v[148:151]
    ds_read_b32 a42, v56
    v_perm_b32 v57, v74, v35, s39
    v_mfma_f32_16x16x32_bf16 v[148:151], a[64:67], a[48:51], v[148:151]
    s_waitcnt lgkmcnt(8)
    ds_read_b32 a43, v57
    v_perm_b32 v58, v78, v35, s36
    v_mfma_f32_16x16x32_bf16 v[152:155], a[64:67], a[16:19], v[152:155]
    ds_read_b32 a44, v58
    v_perm_b32 v59, v78, v35, s37
    v_perm_b32 v62, v78, v35, s38
    v_mfma_f32_16x16x32_bf16 v[152:155], a[68:71], a[20:23], v[152:155]
    s_waitcnt lgkmcnt(5)
    ds_read_b32 a45, v59
    ds_read_b32 a46, v62
    v_mfma_f32_16x16x32_bf16 v[156:159], a[68:71], a[28:31], v[156:159]
    buffer_load_dwordx4 v38, s[8:11], s3 offen offset:2048  lds
    v_mfma_f32_16x16x32_bf16 v[156:159], a[64:67], a[24:27], v[156:159]
    v_perm_b32 v60, v78, v35, s39
    v_perm_b32 v61, v75, v35, s36
    v_mfma_f32_16x16x32_bf16 v[160:163], a[200:203], a[224:227], v[160:163]
    ds_read_b32 a47, v60
    ds_read_b32 a56, v61
    v_mfma_f32_16x16x32_bf16 v[160:163], a[204:207], a[228:231], v[160:163]
    v_perm_b32 v63, v75, v35, s37
    v_perm_b32 v56, v79, v35, s36
    v_mfma_f32_16x16x32_bf16 v[164:167], a[204:207], a[236:239], v[164:167]
    ds_read_b32 a57, v63
    ds_read_b32 a58, v56
    v_perm_b32 v57, v79, v35, s37
    v_mfma_f32_16x16x32_bf16 v[164:167], a[200:203], a[232:235], v[164:167]
    ds_read_b32 a59, v57
    v_mfma_f32_16x16x32_bf16 v[168:171], a[200:203], a[248:251], v[168:171]
    buffer_load_dwordx4 v[104:107], v34, s[12:15], s43 offen sc1
    v_mfma_f32_16x16x32_bf16 v[168:171], a[204:207], a[252:255], v[168:171]
    s_waitcnt vmcnt(12)
    v_mfma_f32_16x16x32_bf16 v[172:175], a[204:207], a[36:39], v[172:175]
    s_barrier
    v_mfma_f32_16x16x32_bf16 v[172:175], a[200:203], a[32:35], v[172:175]
    ds_read_b128 a[72:75], v40 offset:32768
    v_mfma_f32_16x16x32_bf16 v[176:179], a[200:203], a[0:3], v[176:179]
    buffer_load_dwordx4 v[108:111], v44, s[12:15], s43 offen sc1
    v_mfma_f32_16x16x32_bf16 v[176:179], a[204:207], a[4:7], v[176:179]
    ds_read_b128 a[76:79], v41 offset:32768
    v_mfma_f32_16x16x32_bf16 v[180:183], a[204:207], a[52:55], v[180:183]
    ds_read_b128 a[100:103], v41 offset:34816
    v_mfma_f32_16x16x32_bf16 v[180:183], a[200:203], a[48:51], v[180:183]
    ds_read_b128 a[96:99], v40 offset:34816
    v_mfma_f32_16x16x32_bf16 v[184:187], a[200:203], a[16:19], v[184:187]
    ds_read_b128 a[136:139], v40 offset:36864
    v_mfma_f32_16x16x32_bf16 v[184:187], a[204:207], a[20:23], v[184:187]
    ds_read_b128 a[140:143], v41 offset:36864
    v_mfma_f32_16x16x32_bf16 v[188:191], a[204:207], a[28:31], v[188:191]
    s_waitcnt vmcnt(11)
    ds_read_b128 a[80:83], v40 offset:38912
    v_mfma_f32_16x16x32_bf16 v[188:191], a[200:203], a[24:27], v[188:191]
    buffer_load_dwordx4 v39, s[8:11], s3 offen offset:3072  lds
    v_mfma_f32_16x16x32_bf16 v[192:195], a[208:211], a[224:227], v[192:195]
    s_add_u32 m0, s57, 0
    ds_read_b128 a[84:87], v41 offset:38912
    v_bitop3_b32 v58, v83, v87, s76 bitop3:0x7e
    v_mfma_f32_16x16x32_bf16 v[192:195], a[212:215], a[228:231], v[192:195]
    s_add_u32 s3, s69, 1280
    ds_read_b128 a[176:179], v40 offset:40960
    v_cmp_lt_u32 vcc, 0xffff, v58
    v_mfma_f32_16x16x32_bf16 v[196:199], a[212:215], a[236:239], v[196:199]
    v_mfma_f32_16x16x32_bf16 v[196:199], a[208:211], a[232:235], v[196:199]
    s_cbranch_vccnz L_slow3_1
L_back3_1:
    v_mfma_f32_16x16x32_bf16 v[200:203], a[208:211], a[248:251], v[200:203]
    buffer_load_dwordx4 v[112:115], v32, s[12:15], s44 offen sc1
    v_mfma_f32_16x16x32_bf16 v[200:203], a[212:215], a[252:255], v[200:203]
    v_perm_b32 v59, v83, v35, s36
    v_perm_b32 v62, v83, v35, s37
    v_mfma_f32_16x16x32_bf16 v[204:207], a[212:215], a[36:39], v[204:207]
    ds_read_b32 a60, v59
    ds_read_b32 a61, v62
    v_mfma_f32_16x16x32_bf16 v[204:207], a[208:211], a[32:35], v[204:207]
    ds_read_b128 a[180:183], v41 offset:40960
    v_mfma_f32_16x16x32_bf16 v[208:211], a[208:211], a[0:3], v[208:211]
    buffer_load_dwordx4 v[116:119], v33, s[12:15], s44 offen sc1
    v_mfma_f32_16x16x32_bf16 v[208:211], a[212:215], a[4:7], v[208:211]
    v_perm_b32 v60, v87, v35, s36
    v_perm_b32 v61, v87, v35, s37
    v_mfma_f32_16x16x32_bf16 v[212:215], a[212:215], a[52:55], v[212:215]
    ds_read_b32 a62, v60
    ds_read_b32 a63, v61
    v_mfma_f32_16x16x32_bf16 v[212:215], a[208:211], a[48:51], v[212:215]
    v_perm_b32 v63, v80, v35, s36
    v_perm_b32 v56, v80, v35, s37
    v_mfma_f32_16x16x32_bf16 v[216:219], a[208:211], a[16:19], v[216:219]
    ds_read_b128 a[104:107], v40 offset:43008
    ds_read_b32 a112, v63
    v_mfma_f32_16x16x32_bf16 v[216:219], a[212:215], a[20:23], v[216:219]
    ds_read_b32 a113, v56
    v_perm_b32 v57, v80, v35, s38
    v_mfma_f32_16x16x32_bf16 v[220:223], a[212:215], a[28:31], v[220:223]
    ds_read_b32 a114, v57
    v_perm_b32 v58, v80, v35, s39
    v_mfma_f32_16x16x32_bf16 v[220:223], a[208:211], a[24:27], v[220:223]
    ds_read_b128 a[108:111], v41 offset:43008
    ds_read_b32 a115, v58
    v_mfma_f32_16x16x32_bf16 v[224:227], a[220:223], a[226:229], v[224:227]
    buffer_load_dwordx4 v36, s[8:11], s56 offen offset:0  lds
    v_mfma_f32_16x16x32_bf16 v[228:231], a[220:223], a[234:237], v[228:231]
    s_waitcnt vmcnt(12)
    v_bitop3_b32 v59, v99, v103, s76 bitop3:0x7e
    v_perm_b32 v62, v84, v35, s36
    v_mfma_f32_16x16x32_bf16 v[232:235], a[220:223], a[250:253], v[232:235]
    ds_read_b128 a[160:163], v40 offset:45056
    ds_read_b32 a116, v62
    v_cmp_lt_u32 vcc, 0xffff, v59
    v_mfma_f32_16x16x32_bf16 v[236:239], a[220:223], a[34:37], v[236:239]
    v_perm_b32 v60, v84, v35, s37
    v_perm_b32 v61, v84, v35, s38
    v_mfma_f32_16x16x32_bf16 v[240:243], a[220:223], a[2:5], v[240:243]
    ds_read_b32 a117, v60
    ds_read_b32 a118, v61
    v_mfma_f32_16x16x32_bf16 v[244:247], a[220:223], a[50:53], v[244:247]
    ds_read_b128 a[164:167], v41 offset:45056
    s_cbranch_vccnz L_slow4_0
L_back4_0:
    v_mfma_f32_16x16x32_bf16 v[248:251], a[220:223], a[18:21], v[248:251]
    s_waitcnt lgkmcnt(8)
    ds_read_b128 a[120:123], v40 offset:47104
    v_mfma_f32_16x16x32_bf16 v[252:255], a[220:223], a[26:29], v[252:255]
    buffer_load_dwordx4 v37, s[8:11], s56 offen offset:1024  lds
    v_mfma_f32_16x16x32_bf16 v[128:131], a[240:243], a[72:75], v[128:131]
    v_perm_b32 v63, v84, v35, s39
    v_perm_b32 v56, v81, v35, s36
L_pad2:
    s_cbranch_execz L_pad3
    v_mfma_f32_16x16x32_bf16 v[128:131], a[244:247], a[76:79], v[128:131]
    ds_read_b32 a119, v63
    ds_read_b32 a128, v56
    v_mfma_f32_16x16x32_bf16 v[132:135], a[244:247], a[100:103], v[132:135]
    ds_read_b128 a[124:127], v41 offset:47104
    v_perm_b32 v57, v81, v35, s37
    v_mfma_f32_16x16x32_bf16 v[132:135], a[240:243], a[96:99], v[132:135]
    ds_read_b32 a129, v57
    v_perm_b32 v58, v81, v35, s38
    v_mfma_f32_16x16x32_bf16 v[136:139], a[240:243], a[136:139], v[136:139]
    ds_read_b32 a130, v58
    v_perm_b32 v59, v81, v35, s39
    v_mfma_f32_16x16x32_bf16 v[136:139], a[244:247], a[140:143], v[136:139]
    ds_read_b32 a131, v59
    v_perm_b32 v62, v85, v35, s36
    v_mfma_f32_16x16x32_bf16 v[140:143], a[244:247], a[84:87], v[140:143]
    ds_read_b32 a132, v62
    v_perm_b32 v60, v85, v35, s37
    v_mfma_f32_16x16x32_bf16 v[140:143], a[240:243], a[80:83], v[140:143]
    ds_read_b32 a133, v60
    v_perm_b32 v61, v85, v35, s38
    v_mfma_f32_16x16x32_bf16 v[144:147], a[240:243], a[176:179], v[144:147]
    s_waitcnt lgkmcnt(8)
    ds_read_b32 a134, v61
    ds_read_b128 a[144:147], v40 offset:49152
    v_mfma_f32_16x16x32_bf16 v[144:147], a[244:247], a[180:183], v[144:147]
    buffer_load_dwordx4 v[120:123], v34, s[12:15], s44 offen sc1
    v_mfma_f32_16x16x32_bf16 v[148:151], a[244:247], a[108:111], v[148:151]
    v_perm_b32 v63, v85, v35, s39
    v_perm_b32 v56, v82, v35, s36
    v_mfma_f32_16x16x32_bf16 v[148:151], a[240:243], a[104:107], v[148:151]
    ds_read_b32 a135, v63
    ds_read_b32 a152, v56
    v_mfma_f32_16x16x32_bf16 v[152:155], a[240:243], a[160:163], v[152:155]
    s_waitcnt lgkmcnt(8)
    ds_read_b128 a[148:151], v41 offset:49152
    v_mfma_f32_16x16x32_bf16 v[152:155], a[244:247], a[164:167], v[152:155]
    buffer_load_dwordx4 v[124:127], v44, s[12:15], s44 offen sc1
    v_mfma_f32_16x16x32_bf16 v[156:159], a[244:247], a[124:127], v[156:159]
    ds_read_b128 a[88:91], v40 offset:51200
    v_perm_b32 v57, v82, v35, s37
    v_mfma_f32_16x16x32_bf16 v[156:159], a[240:243], a[120:123], v[156:159]
    ds_read_b128 a[92:95], v41 offset:51200
    ds_read_b32 a153, v57
    v_mfma_f32_16x16x32_bf16 v[160:163], a[8:11], a[72:75], v[160:163]
    ds_read_b128 a[168:171], v40 offset:53248
    v_mfma_f32_16x16x32_bf16 v[160:163], a[12:15], a[76:79], v[160:163]
    buffer_load_dwordx4 v38, s[8:11], s56 offen offset:2048  lds
    v_mfma_f32_16x16x32_bf16 v[164:167], a[12:15], a[100:103], v[164:167]
    v_perm_b32 v58, v82, v35, s38
    v_perm_b32 v59, v82, v35, s39
    v_mfma_f32_16x16x32_bf16 v[164:167], a[8:11], a[96:99], v[164:167]
    ds_read_b32 a154, v58
    ds_read_b32 a155, v59
    v_mfma_f32_16x16x32_bf16 v[168:171], a[8:11], a[136:139], v[168:171]
    v_perm_b32 v62, v86, v35, s36
    v_perm_b32 v60, v86, v35, s37
    v_mfma_f32_16x16x32_bf16 v[168:171], a[12:15], a[140:143], v[168:171]
    ds_read_b128 a[172:175], v41 offset:53248
    ds_read_b32 a156, v62
    v_mfma_f32_16x16x32_bf16 v[172:175], a[12:15], a[84:87], v[172:175]
    ds_read_b32 a157, v60
    ds_read_b128 a[184:187], v40 offset:55296
    v_mfma_f32_16x16x32_bf16 v[172:175], a[8:11], a[80:83], v[172:175]
    buffer_load_dwordx4 v39, s[8:11], s56 offen offset:3072  lds
    v_mfma_f32_16x16x32_bf16 v[176:179], a[8:11], a[176:179], v[176:179]
    s_add_u32 m0, s57, 16384
    v_perm_b32 v61, v86, v35, s38
    v_perm_b32 v63, v86, v35, s39
    v_mfma_f32_16x16x32_bf16 v[176:179], a[12:15], a[180:183], v[176:179]
    ds_read_b32 a158, v61
    ds_read_b32 a159, v63
    v_mfma_f32_16x16x32_bf16 v[180:183], a[12:15], a[108:111], v[180:183]
    v_perm_b32 v56, v96, v35, s36
    v_perm_b32 v57, v96, v35, s37
    v_mfma_f32_16x16x32_bf16 v[180:183], a[8:11], a[104:107], v[180:183]
    ds_read_b128 a[188:191], v41 offset:55296
    ds_read_b32 a192, v56
    v_mfma_f32_16x16x32_bf16 v[184:187], a[8:11], a[160:163], v[184:187]
    ds_read_b32 a193, v57
    v_perm_b32 v58, v96, v35, s38
    v_mfma_f32_16x16x32_bf16 v[184:187], a[12:15], a[164:167], v[184:187]
    ds_read_b32 a194, v58
    v_perm_b32 v59, v96, v35, s39
    v_mfma_f32_16x16x32_bf16 v[188:191], a[12:15], a[124:127], v[188:191]
    ds_read_b128 a[64:67], v40 offset:57344
    ds_read_b32 a195, v59
    v_mfma_f32_16x16x32_bf16 v[188:191], a[8:11], a[120:123], v[188:191]
    buffer_load_dwordx4 v36, s[8:11], s3 offen offset:0  lds
    v_mfma_f32_16x16x32_bf16 v[192:195], a[40:43], a[72:75], v[192:195]
    v_perm_b32 v62, v100, v35, s36
    v_perm_b32 v60, v100, v35, s37
    v_mfma_f32_16x16x32_bf16 v[192:195], a[44:47], a[76:79], v[192:195]
    ds_read_b128 a[68:71], v41 offset:57344
    ds_read_b32 a196, v62
    v_mfma_f32_16x16x32_bf16 v[196:199], a[44:47], a[100:103], v[196:199]
    ds_read_b32 a197, v60
    v_perm_b32 v61, v100, v35, s38
    v_mfma_f32_16x16x32_bf16 v[196:199], a[40:43], a[96:99], v[196:199]
    ds_read_b32 a198, v61
    v_perm_b32 v63, v100, v35, s39
    v_mfma_f32_16x16x32_bf16 v[200:203], a[40:43], a[136:139], v[200:203]
    ds_read_b128 a[200:203], v40 offset:59392
    ds_read_b32 a199, v63
    v_mfma_f32_16x16x32_bf16 v[200:203], a[44:47], a[140:143], v[200:203]
    ds_read_b128 a[204:207], v41 offset:59392
    v_mfma_f32_16x16x32_bf16 v[204:207], a[44:47], a[84:87], v[204:207]
    buffer_load_dwordx4 v37, s[8:11], s3 offen offset:1024  lds
    v_mfma_f32_16x16x32_bf16 v[204:207], a[40:43], a[80:83], v[204:207]
    v_perm_b32 v56, v97, v35, s36
    v_perm_b32 v57, v97, v35, s37
    v_mfma_f32_16x16x32_bf16 v[208:211], a[40:43], a[176:179], v[208:211]
    ds_read_b32 a208, v56
    ds_read_b32 a209, v57
    v_mfma_f32_16x16x32_bf16 v[208:211], a[44:47], a[180:183], v[208:211]
    v_perm_b32 v58, v97, v35, s38
    v_perm_b32 v59, v97, v35, s39
    v_mfma_f32_16x16x32_bf16 v[212:215], a[44:47], a[108:111], v[212:215]
    ds_read_b128 a[224:227], v40 offset:61440
    ds_read_b32 a210, v58
    v_mfma_f32_16x16x32_bf16 v[212:215], a[40:43], a[104:107], v[212:215]
    ds_read_b32 a211, v59
    v_perm_b32 v62, v101, v35, s36
    v_mfma_f32_16x16x32_bf16 v[216:219], a[40:43], a[160:163], v[216:219]
    ds_read_b32 a212, v62
    ds_read_b128 a[228:231], v41 offset:61440
    v_mfma_f32_16x16x32_bf16 v[216:219], a[44:47], a[164:167], v[216:219]
    buffer_load_dwordx4 v38, s[8:11], s3 offen offset:2048  lds
    v_mfma_f32_16x16x32_bf16 v[220:223], a[44:47], a[124:127], v[220:223]
    s_waitcnt vmcnt(12)
    v_bitop3_b32 v60, v107, v111, s76 bitop3:0x7e
    v_perm_b32 v61, v101, v35, s37
    v_mfma_f32_16x16x32_bf16 v[220:223], a[40:43], a[120:123], v[220:223]
    ds_read_b32 a213, v61
    v_cmp_lt_u32 vcc, 0xffff, v60
    v_mfma_f32_16x16x32_bf16 v[224:227], a[56:59], a[74:77], v[224:227]
    s_waitcnt lgkmcnt(8)
    ds_read_b128 a[232:235], v40 offset:63488
    v_perm_b32 v63, v101, v35, s38
    v_mfma_f32_16x16x32_bf16 v[224:227], a[60:63], a[146:149], v[224:227]
    ds_read_b32 a214, v63
    s_cbranch_vccnz L_slow4_1
L_back4_1:
    v_mfma_f32_16x16x32_bf16 v[228:231], a[60:63], a[90:93], v[228:231]
    v_perm_b32 v56, v101, v35, s39
    v_perm_b32 v57, v98, v35, s36
    v_mfma_f32_16x16x32_bf16 v[228:231], a[56:59], a[98:101], v[228:231]
    ds_read_b128 a[236:239], v41 offset:63488
    ds_read_b32 a215, v56
    v_mfma_f32_16x16x32_bf16 v[232:235], a[56:59], a[138:141], v[232:235]
    buffer_load_dwordx4 v[88:91], v32, s[12:15], s45 offen sc1
    v_mfma_f32_16x16x32_bf16 v[232:235], a[60:63], a[170:173], v[232:235]
    ds_read_b32 a248, v57
    v_perm_b32 v58, v98, v35, s37
    v_mfma_f32_16x16x32_bf16 v[236:239], a[60:63], a[186:189], v[236:239]
    ds_read_b32 a249, v58
    v_perm_b32 v59, v98, v35, s38
    v_perm_b32 v62, v98, v35, s39
    v_mfma_f32_16x16x32_bf16 v[236:239], a[56:59], a[82:85], v[236:239]
    ds_read_b32 a250, v59
    ds_read_b32 a251, v62
    v_mfma_f32_16x16x32_bf16 v[240:243], a[56:59], a[178:181], v[240:243]
    buffer_load_dwordx4 v[92:95], v33, s[12:15], s45 offen sc1
    v_mfma_f32_16x16x32_bf16 v[240:243], a[60:63], a[66:69], v[240:243]
    v_perm_b32 v60, v102, v35, s36
    v_perm_b32 v61, v102, v35, s37
    v_mfma_f32_16x16x32_bf16 v[244:247], a[60:63], a[202:205], v[244:247]
    ds_read_b32 a252, v60
    ds_read_b32 a253, v61
    v_mfma_f32_16x16x32_bf16 v[244:247], a[56:59], a[106:109], v[244:247]
    s_waitcnt vmcnt(13) lgkmcnt(7)
    v_perm_b32 v63, v102, v35, s38
    v_perm_b32 v56, v102, v35, s39
    v_mfma_f32_16x16x32_bf16 v[248:251], a[56:59], a[162:165], v[248:251]
    s_barrier
    v_mfma_f32_16x16x32_bf16 v[248:251], a[60:63], a[226:229], v[248:251]
    ds_read_b32 a254, v63
    ds_read_b32 a255, v56
    v_mfma_f32_16x16x32_bf16 v[252:255], a[60:63], a[234:237], v[252:255]
    buffer_load_dwordx4 v39, s[8:11], s3 offen offset:3072  lds
    v_mfma_f32_16x16x32_bf16 v[252:255], a[56:59], a[122:125], v[252:255]
    s_add_u32 s56, s55, 1536
    v_perm_b32 v57, v99, v35, s36
    v_perm_b32 v58, v99, v35, s37
    v_mfma_f32_16x16x32_bf16 v[128:131], a[112:115], a[144:147], v[128:131]
    ds_read_b32 a32, v57
    ds_read_b32 a33, v58
    v_mfma_f32_16x16x32_bf16 v[128:131], a[116:119], a[148:151], v[128:131]
    s_add_u32 m0, s57, 32768
    v_perm_b32 v59, v103, v35, s36
    v_perm_b32 v62, v103, v35, s37
    v_mfma_f32_16x16x32_bf16 v[132:135], a[116:119], a[92:95], v[132:135]
    ds_read_b32 a34, v59
    ds_read_b32 a35, v62
    v_mfma_f32_16x16x32_bf16 v[132:135], a[112:115], a[88:91], v[132:135]
    buffer_load_dwordx4 v[48:51], v34, s[12:15], s45 offen sc1
    v_mfma_f32_16x16x32_bf16 v[136:139], a[112:115], a[168:171], v[136:139]
    v_perm_b32 v60, v107, v35, s36
    v_perm_b32 v61, v107, v35, s37
    v_mfma_f32_16x16x32_bf16 v[136:139], a[116:119], a[172:175], v[136:139]
    ds_read_b32 a36, v60
    ds_read_b32 a37, v61
    v_mfma_f32_16x16x32_bf16 v[140:143], a[116:119], a[188:191], v[140:143]
    v_perm_b32 v63, v111, v35, s36
    v_perm_b32 v56, v111, v35, s37
    v_mfma_f32_16x16x32_bf16 v[140:143], a[112:115], a[184:187], v[140:143]
    ds_read_b32 a38, v63
    ds_read_b32 a39, v56
    v_mfma_f32_16x16x32_bf16 v[144:147], a[112:115], a[64:67], v[144:147]
    buffer_load_dwordx4 v[52:55], v44, s[12:15], s45 offen sc1
    v_mfma_f32_16x16x32_bf16 v[144:147], a[116:119], a[68:71], v[144:147]
    s_waitcnt vmcnt(14)
    v_bitop3_b32 v57, v115, v119, s76 bitop3:0x7e
    v_perm_b32 v58, v104, v35, s36
    v_mfma_f32_16x16x32_bf16 v[148:151], a[116:119], a[204:207], v[148:151]
    ds_read_b32 a0, v58
    v_cmp_lt_u32 vcc, 0xffff, v57
    v_mfma_f32_16x16x32_bf16 v[148:151], a[112:115], a[200:203], v[148:151]
    ds_read_b128 a[48:51], v42 offset:0
    v_perm_b32 v59, v104, v35, s37
    v_mfma_f32_16x16x32_bf16 v[152:155], a[112:115], a[224:227], v[152:155]
    ds_read_b128 a[52:55], v43 offset:0
    ds_read_b32 a1, v59
    v_mfma_f32_16x16x32_bf16 v[152:155], a[116:119], a[228:231], v[152:155]
    v_perm_b32 v62, v104, v35, s38
    s_cbranch_vccnz L_slow5_0
L_back5_0:
    v_mfma_f32_16x16x32_bf16 v[156:159], a[116:119], a[236:239], v[156:159]
    s_add_u32 s3, s69, 1536
    ds_read_b128 a[16:19], v42 offset:2048
    ds_read_b32 a2, v62
    v_mfma_f32_16x16x32_bf16 v[156:159], a[112:115], a[232:235], v[156:159]
    buffer_load_dwordx4 v36, s[8:11], s56 offen offset:0  lds
    v_mfma_f32_16x16x32_bf16 v[160:163], a[128:131], a[144:147], v[160:163]
    ds_read_b128 a[20:23], v43 offset:2048
    v_perm_b32 v60, v104, v35, s39
    v_mfma_f32_16x16x32_bf16 v[160:163], a[132:135], a[148:151], v[160:163]
    ds_read_b32 a3, v60
    v_perm_b32 v61, v108, v35, s36
    v_mfma_f32_16x16x32_bf16 v[164:167], a[132:135], a[92:95], v[164:167]
    ds_read_b128 a[216:219], v42 offset:4096
    ds_read_b32 a4, v61
    v_mfma_f32_16x16x32_bf16 v[164:167], a[128:131], a[88:91], v[164:167]
    v_perm_b32 v63, v108, v35, s37
    v_perm_b32 v56, v108, v35, s38
    v_mfma_f32_16x16x32_bf16 v[168:171], a[128:131], a[168:171], v[168:171]
    ds_read_b32 a5, v63
    ds_read_b32 a6, v56
    v_mfma_f32_16x16x32_bf16 v[168:171], a[132:135], a[172:175], v[168:171]
    ds_read_b128 a[220:223], v43 offset:4096
    v_perm_b32 v57, v108, v35, s39
    v_mfma_f32_16x16x32_bf16 v[172:175], a[132:135], a[188:191], v[172:175]
    ds_read_b32 a7, v57
    ds_read_b128 a[24:27], v42 offset:6144
    v_mfma_f32_16x16x32_bf16 v[172:175], a[128:131], a[184:187], v[172:175]
    buffer_load_dwordx4 v37, s[8:11], s56 offen offset:1024  lds
    v_mfma_f32_16x16x32_bf16 v[176:179], a[128:131], a[64:67], v[176:179]
    v_perm_b32 v58, v105, v35, s36
    v_perm_b32 v59, v105, v35, s37
    v_mfma_f32_16x16x32_bf16 v[176:179], a[132:135], a[68:71], v[176:179]
    ds_read_b32 a240, v58
    ds_read_b32 a241, v59
    v_mfma_f32_16x16x32_bf16 v[180:183], a[132:135], a[204:207], v[180:183]
    v_perm_b32 v62, v105, v35, s38
    v_perm_b32 v60, v105, v35, s39
    v_mfma_f32_16x16x32_bf16 v[180:183], a[128:131], a[200:203], v[180:183]
    ds_read_b128 a[28:31], v43 offset:6144
    ds_read_b32 a242, v62
    v_mfma_f32_16x16x32_bf16 v[184:187], a[128:131], a[224:227], v[184:187]
    ds_read_b32 a243, v60
    v_perm_b32 v61, v109, v35, s36
    v_mfma_f32_16x16x32_bf16 v[184:187], a[132:135], a[228:231], v[184:187]
    ds_read_b32 a244, v61
    ds_read_b128 a[8:11], v42 offset:8192
    v_mfma_f32_16x16x32_bf16 v[188:191], a[132:135], a[236:239], v[188:191]
    buffer_load_dwordx4 v38, s[8:11], s56 offen offset:2048  lds
    v_mfma_f32_16x16x32_bf16 v[188:191], a[128:131], a[232:235], v[188:191]
    v_perm_b32 v63, v109, v35, s37
    v_perm_b32 v56, v109, v35, s38
    v_mfma_f32_16x16x32_bf16 v[192:195], a[152:155], a[144:147], v[192:195]
    ds_read_b32 a245, v63
    ds_read_b32 a246, v56
    v_mfma_f32_16x16x32_bf16 v[192:195], a[156:159], a[148:151], v[192:195]
    ds_read_b128 a[12:15], v43 offset:8192
    v_perm_b32 v57, v109, v35, s39
    v_mfma_f32_16x16x32_bf16 v[196:199], a[156:159], a[92:95], v[196:199]
    ds_read_b32 a247, v57
    v_perm_b32 v58, v106, v35, s36
    v_mfma_f32_16x16x32_bf16 v[196:199], a[152:155], a[88:91], v[196:199]
    ds_read_b32 a40, v58
    v_perm_b32 v59, v106, v35, s37
    v_mfma_f32_16x16x32_bf16 v[200:203], a[152:155], a[168:171], v[200:203]
    ds_read_b128 a[72:75], v42 offset:10240
    ds_read_b32 a41, v59
    v_mfma_f32_16x16x32_bf16 v[200:203], a[156:159], a[172:175], v[200:203]
    buffer_load_dwordx4 v39, s[8:11], s56 offen offset:3072  lds
    v_mfma_f32_16x16x32_bf16 v[204:207], a[156:159], a[188:191], v[204:207]
    s_add_u32 m0, s57, 49152
    v_perm_b32 v62, v106, v35, s38
    v_perm_b32 v60, v106, v35, s39
    v_mfma_f32_16x16x32_bf16 v[204:207], a[152:155], a[184:187], v[204:207]
    s_add_u32 s56, s55, 1792
    ds_read_b128 a[76:79], v43 offset:10240
    ds_read_b32 a42, v62
    v_mfma_f32_16x16x32_bf16 v[208:211], a[152:155], a[64:67], v[208:211]
    ds_read_b32 a43, v60
    v_perm_b32 v61, v110, v35, s36
    v_mfma_f32_16x16x32_bf16 v[208:211], a[156:159], a[68:71], v[208:211]
    ds_read_b32 a44, v61
    v_perm_b32 v63, v110, v35, s37
    v_mfma_f32_16x16x32_bf16 v[212:215], a[156:159], a[204:207], v[212:215]
    ds_read_b128 a[96:99], v42 offset:12288
    ds_read_b32 a45, v63
    v_mfma_f32_16x16x32_bf16 v[212:215], a[152:155], a[200:203], v[212:215]
    v_perm_b32 v56, v110, v35, s38
    v_perm_b32 v57, v110, v35, s39
    v_mfma_f32_16x16x32_bf16 v[216:219], a[152:155], a[224:227], v[216:219]
    ds_read_b32 a46, v56
    ds_read_b32 a47, v57
    v_mfma_f32_16x16x32_bf16 v[216:219], a[156:159], a[228:231], v[216:219]
    buffer_load_dwordx4 v36, s[8:11], s3 offen offset:0  lds
    v_mfma_f32_16x16x32_bf16 v[220:223], a[156:159], a[236:239], v[220:223]
    ds_read_b128 a[100:103], v43 offset:12288
    v_perm_b32 v58, v112, v35, s36
    v_mfma_f32_16x16x32_bf16 v[220:223], a[152:155], a[232:235], v[220:223]
    s_waitcnt lgkmcnt(9)
    ds_read_b32 a136, v58
    v_perm_b32 v59, v112, v35, s37
    v_mfma_f32_16x16x32_bf16 v[128:131], a[192:195], a[48:51], v[128:131]
    ds_read_b128 a[80:83], v42 offset:14336
    ds_read_b32 a137, v59
    v_mfma_f32_16x16x32_bf16 v[128:131], a[196:199], a[52:55], v[128:131]
    v_perm_b32 v62, v112, v35, s38
    v_perm_b32 v60, v112, v35, s39
    v_mfma_f32_16x16x32_bf16 v[132:135], a[196:199], a[20:23], v[132:135]
    ds_read_b128 a[84:87], v43 offset:14336
    ds_read_b32 a138, v62
    v_mfma_f32_16x16x32_bf16 v[132:135], a[192:195], a[16:19], v[132:135]
    ds_read_b32 a139, v60
    ds_read_b128 a[176:179], v42 offset:16384
    v_mfma_f32_16x16x32_bf16 v[136:139], a[192:195], a[216:219], v[136:139]
    buffer_load_dwordx4 v37, s[8:11], s3 offen offset:1024  lds
    v_mfma_f32_16x16x32_bf16 v[136:139], a[196:199], a[220:223], v[136:139]
    s_waitcnt vmcnt(16)
    v_bitop3_b32 v61, v123, v127, s76 bitop3:0x7e
    v_perm_b32 v63, v116, v35, s36
    v_mfma_f32_16x16x32_bf16 v[140:143], a[196:199], a[28:31], v[140:143]
    ds_read_b32 a140, v63
    v_cmp_lt_u32 vcc, 0xffff, v61
    v_mfma_f32_16x16x32_bf16 v[140:143], a[192:195], a[24:27], v[140:143]
    v_perm_b32 v56, v116, v35, s37
    v_perm_b32 v57, v116, v35, s38
    v_mfma_f32_16x16x32_bf16 v[144:147], a[192:195], a[8:11], v[144:147]
    ds_read_b32 a141, v56
    ds_read_b32 a142, v57
    v_mfma_f32_16x16x32_bf16 v[144:147], a[196:199], a[12:15], v[144:147]
    s_waitcnt lgkmcnt(7)
    v_perm_b32 v58, v116, v35, s39
    s_cbranch_vccnz L_slow5_1
L_back5_1:
    v_mfma_f32_16x16x32_bf16 v[148:151], a[196:199], a[76:79], v[148:151]
    ds_read_b32 a143, v58
    v_perm_b32 v59, v113, v35, s36
    v_mfma_f32_16x16x32_bf16 v[148:151], a[192:195], a[72:75], v[148:151]
    ds_read_b32 a104, v59
    ds_read_b128 a[180:183], v43 offset:16384
    v_mfma_f32_16x16x32_bf16 v[152:155], a[192:195], a[96:99], v[152:155]
    buffer_load_dwordx4 v38, s[8:11], s3 offen offset:2048  lds
    v_mfma_f32_16x16x32_bf16 v[152:155], a[196:199], a[100:103], v[152:155]
    s_waitcnt lgkmcnt(6)
    ds_read_b128 a[160:163], v42 offset:18432
    v_perm_b32 v62, v113, v35, s37
    v_mfma_f32_16x16x32_bf16 v[156:159], a[196:199], a[84:87], v[156:159]
    ds_read_b32 a105, v62
    v_perm_b32 v60, v113, v35, s38
    v_mfma_f32_16x16x32_bf16 v[156:159], a[192:195], a[80:83], v[156:159]
    ds_read_b128 a[164:167], v43 offset:18432
    ds_read_b32 a106, v60
    v_mfma_f32_16x16x32_bf16 v[160:163], a[208:211], a[48:51], v[160:163]
    v_perm_b32 v61, v113, v35, s39
    v_perm_b32 v63, v117, v35, s36
    v_mfma_f32_16x16x32_bf16 v[160:163], a[212:215], a[52:55], v[160:163]
    ds_read_b32 a107, v61
    ds_read_b32 a108, v63
    v_mfma_f32_16x16x32_bf16 v[164:167], a[212:215], a[20:23], v[164:167]
    ds_read_b128 a[56:59], v42 offset:20480
    v_mfma_f32_16x16x32_bf16 v[164:167], a[208:211], a[16:19], v[164:167]
    buffer_load_dwordx4 v39, s[8:11], s3 offen offset:3072  lds
    v_mfma_f32_16x16x32_bf16 v[168:171], a[208:211], a[216:219], v[168:171]
    s_add_u32 m0, s57, 65536
    v_perm_b32 v56, v117, v35, s37
    v_perm_b32 v57, v117, v35, s38
    v_mfma_f32_16x16x32_bf16 v[168:171], a[212:215], a[220:223], v[168:171]
    s_add_u32 s3, s69, 1792
    ds_read_b128 a[60:63], v43 offset:20480
    ds_read_b32 a109, v56
    v_mfma_f32_16x16x32_bf16 v[172:175], a[212:215], a[28:31], v[172:175]
    ds_read_b32 a110, v57
    ds_read_b128 a[120:123], v42 offset:22528
    v_mfma_f32_16x16x32_bf16 v[172:175], a[208:211], a[24:27], v[172:175]
    buffer_load_dwordx4 v[64:67], v22, s[32:35], 0 offen
    v_mfma_f32_16x16x32_bf16 v[176:179], a[208:211], a[8:11], v[176:179]
    v_perm_b32 v58, v117, v35, s39
    v_perm_b32 v59, v114, v35, s36
    v_mfma_f32_16x16x32_bf16 v[176:179], a[212:215], a[12:15], v[176:179]
    ds_read_b32 a111, v58
    ds_read_b32 a112, v59
    v_mfma_f32_16x16x32_bf16 v[180:183], a[212:215], a[76:79], v[180:183]
    ds_read_b128 a[124:127], v43 offset:22528
    v_mfma_f32_16x16x32_bf16 v[180:183], a[208:211], a[72:75], v[180:183]
    buffer_load_dwordx4 v[68:71], v32, s[12:15], s72 offen sc1
    v_mfma_f32_16x16x32_bf16 v[184:187], a[208:211], a[96:99], v[184:187]
    v_perm_b32 v62, v114, v35, s37
    v_perm_b32 v60, v114, v35, s38
    v_mfma_f32_16x16x32_bf16 v[184:187], a[212:215], a[100:103], v[184:187]
    ds_read_b32 a113, v62
    ds_read_b32 a114, v60
    v_mfma_f32_16x16x32_bf16 v[188:191], a[212:215], a[84:87], v[188:191]
    ds_read_b128 a[128:131], v42 offset:24576
    v_mfma_f32_16x16x32_bf16 v[188:191], a[208:211], a[80:83], v[188:191]
    buffer_load_dwordx4 v[72:75], v33, s[12:15], s72 offen sc1
    v_mfma_f32_16x16x32_bf16 v[192:195], a[248:251], a[48:51], v[192:195]
    v_perm_b32 v61, v114, v35, s39
    v_perm_b32 v63, v118, v35, s36
    v_mfma_f32_16x16x32_bf16 v[192:195], a[252:255], a[52:55], v[192:195]
    ds_read_b128 a[132:135], v43 offset:24576
    ds_read_b32 a115, v61
    v_mfma_f32_16x16x32_bf16 v[196:199], a[252:255], a[20:23], v[196:199]
    ds_read_b32 a116, v63
    ds_read_b128 a[144:147], v42 offset:26624
    v_mfma_f32_16x16x32_bf16 v[196:199], a[248:251], a[16:19], v[196:199]
    buffer_load_dwordx4 v[76:79], v34, s[12:15], s72 offen sc1
    v_mfma_f32_16x16x32_bf16 v[200:203], a[248:251], a[216:219], v[200:203]
    v_perm_b32 v56, v118, v35, s37
    v_perm_b32 v57, v118, v35, s38
    v_mfma_f32_16x16x32_bf16 v[200:203], a[252:255], a[220:223], v[200:203]
    ds_read_b32 a117, v56
    ds_read_b32 a118, v57
    v_mfma_f32_16x16x32_bf16 v[204:207], a[252:255], a[28:31], v[204:207]
    ds_read_b128 a[148:151], v43 offset:26624
    v_mfma_f32_16x16x32_bf16 v[204:207], a[248:251], a[24:27], v[204:207]
    buffer_load_dwordx4 v[80:83], v44, s[12:15], s72 offen sc1
    v_mfma_f32_16x16x32_bf16 v[208:211], a[248:251], a[8:11], v[208:211]
    v_perm_b32 v58, v118, v35, s39
    v_perm_b32 v59, v115, v35, s36
    v_mfma_f32_16x16x32_bf16 v[208:211], a[252:255], a[12:15], v[208:211]
    ds_read_b32 a119, v58
    ds_read_b32 a88, v59
    v_mfma_f32_16x16x32_bf16 v[212:215], a[252:255], a[76:79], v[212:215]
    ds_read_b128 a[168:171], v42 offset:28672
    v_mfma_f32_16x16x32_bf16 v[212:215], a[248:251], a[72:75], v[212:215]
    buffer_load_dwordx2 v[84:85], v22, s[32:35], 0 offen offset:16
    v_mfma_f32_16x16x32_bf16 v[216:219], a[248:251], a[96:99], v[216:219]
    v_perm_b32 v62, v115, v35, s37
    v_perm_b32 v60, v119, v35, s36
    v_mfma_f32_16x16x32_bf16 v[216:219], a[252:255], a[100:103], v[216:219]
    ds_read_b128 a[172:175], v43 offset:28672
    ds_read_b32 a89, v62
    v_perm_b32 v61, v119, v35, s37
    v_mfma_f32_16x16x32_bf16 v[220:223], a[252:255], a[84:87], v[220:223]
    s_waitcnt lgkmcnt(6)
    ds_read_b32 a90, v60
    ds_read_b32 a91, v61
    v_mfma_f32_16x16x32_bf16 v[220:223], a[248:251], a[80:83], v[220:223]
    buffer_load_dword v86, v23, s[32:35], 0 offen
    v_mfma_f32_16x16x32_bf16 v[224:227], a[32:35], a[50:53], v[224:227]
    ds_read_b128 a[184:187], v42 offset:30720
    v_perm_b32 v63, v123, v35, s36
    v_perm_b32 v56, v123, v35, s37
    v_mfma_f32_16x16x32_bf16 v[224:227], a[36:39], a[178:181], v[224:227]
    ds_read_b32 a92, v63
    ds_read_b32 a93, v56
    v_mfma_f32_16x16x32_bf16 v[228:231], a[36:39], a[162:165], v[228:231]
    ds_read_b128 a[188:191], v43 offset:30720
    v_perm_b32 v57, v127, v35, s36
    v_mfma_f32_16x16x32_bf16 v[228:231], a[32:35], a[18:21], v[228:231]
    ds_read_b32 a94, v57
    v_perm_b32 v58, v127, v35, s37
    v_mfma_f32_16x16x32_bf16 v[232:235], a[32:35], a[218:221], v[232:235]
    s_waitcnt vmcnt(18)
    ds_read_b32 a95, v58
    v_bitop3_b32 v59, v91, v95, s76 bitop3:0x7e
    v_mfma_f32_16x16x32_bf16 v[232:235], a[36:39], a[58:61], v[232:235]
    v_cmp_lt_u32 vcc, 0xffff, v59
    v_perm_b32 v62, v120, v35, s36
    v_mfma_f32_16x16x32_bf16 v[236:239], a[36:39], a[122:125], v[236:239]
    ds_read_b32 a64, v62
    v_perm_b32 v60, v120, v35, s37
    v_mfma_f32_16x16x32_bf16 v[236:239], a[32:35], a[26:29], v[236:239]
    ds_read_b32 a65, v60
    s_cbranch_vccnz L_slow6_0
L_back6_0:
    v_mfma_f32_16x16x32_bf16 v[240:243], a[32:35], a[10:13], v[240:243]
    v_perm_b32 v61, v120, v35, s38
    v_perm_b32 v63, v120, v35, s39
    v_mfma_f32_16x16x32_bf16 v[240:243], a[36:39], a[130:133], v[240:243]
    s_waitcnt lgkmcnt(7)
    ds_read_b32 a66, v61
    ds_read_b32 a67, v63
    v_mfma_f32_16x16x32_bf16 v[244:247], a[36:39], a[146:149], v[244:247]
    s_waitcnt vmcnt(15)
    v_bitop3_b32 v56, v51, v55, s76 bitop3:0x7e
    v_perm_b32 v57, v124, v35, s36
    v_mfma_f32_16x16x32_bf16 v[244:247], a[32:35], a[74:77], v[244:247]
    s_waitcnt lgkmcnt(6)
    ds_read_b32 a68, v57
    v_cmp_lt_u32 vcc, 0xffff, v56
    v_mfma_f32_16x16x32_bf16 v[248:251], a[32:35], a[98:101], v[248:251]
    s_barrier
    v_mfma_f32_16x16x32_bf16 v[248:251], a[36:39], a[170:173], v[248:251]
    buffer_load_dwordx4 v36, s[8:11], s56 offen offset:0  lds
    v_mfma_f32_16x16x32_bf16 v[252:255], a[36:39], a[186:189], v[252:255]
    v_perm_b32 v58, v124, v35, s37
    s_cbranch_vccnz L_slow6_1
L_back6_1:
    v_mfma_f32_16x16x32_bf16 v[252:255], a[32:35], a[82:85], v[252:255]
    ds_read_b32 a69, v58
    v_perm_b32 v59, v124, v35, s38
    v_perm_b32 v62, v124, v35, s39
    v_mfma_f32_16x16x32_bf16 v[128:131], a[0:3], a[176:179], v[128:131]
    ds_read_b32 a70, v59
    ds_read_b32 a71, v62
    v_mfma_f32_16x16x32_bf16 v[128:131], a[4:7], a[180:183], v[128:131]
    buffer_load_dwordx4 v37, s[8:11], s56 offen offset:1024  lds
    v_mfma_f32_16x16x32_bf16 v[132:135], a[4:7], a[164:167], v[132:135]
    v_perm_b32 v60, v121, v35, s36
    v_perm_b32 v61, v121, v35, s37
    v_mfma_f32_16x16x32_bf16 v[132:135], a[0:3], a[160:163], v[132:135]
    ds_read_b32 a200, v60
    ds_read_b32 a201, v61
    v_mfma_f32_16x16x32_bf16 v[136:139], a[0:3], a[56:59], v[136:139]
    ds_read_b128 a[224:227], v40 offset:0
L_pad3:
    s_cbranch_execz L_pad4
    v_mfma_f32_16x16x32_bf16 v[136:139], a[4:7], a[60:63], v[136:139]
    buffer_load_dwordx4 v38, s[8:11], s56 offen offset:2048  lds
    v_mfma_f32_16x16x32_bf16 v[140:143], a[4:7], a[124:127], v[140:143]
    v_perm_b32 v63, v121, v35, s38
    v_perm_b32 v56, v121, v35, s39
    v_mfma_f32_16x16x32_bf16 v[140:143], a[0:3], a[120:123], v[140:143]
    ds_read_b32 a202, v63
    ds_read_b32 a203, v56
    v_perm_b32 v57, v125, v35, s36
    v_mfma_f32_16x16x32_bf16 v[144:147], a[0:3], a[128:131], v[144:147]
    ds_read_b32 a204, v57
    ds_read_b128 a[228:231], v41 offset:0
    v_mfma_f32_16x16x32_bf16 v[144:147], a[4:7], a[132:135], v[144:147]
    buffer_load_dwordx4 v39, s[8:11], s56 offen offset:3072  lds
    v_mfma_f32_16x16x32_bf16 v[148:151], a[4:7], a[148:151], v[148:151]
    s_add_u32 m0, s57, 81920
    v_perm_b32 v58, v125, v35, s37
    v_perm_b32 v59, v125, v35, s38
    v_mfma_f32_16x16x32_bf16 v[148:151], a[0:3], a[144:147], v[148:151]
    ds_read_b32 a205, v58
    ds_read_b32 a206, v59
    v_mfma_f32_16x16x32_bf16 v[152:155], a[0:3], a[168:171], v[152:155]
    ds_read_b128 a[152:155], v40 offset:2048
    v_mfma_f32_16x16x32_bf16 v[152:155], a[4:7], a[172:175], v[152:155]
    buffer_load_dwordx4 v36, s[8:11], s3 offen offset:0  lds
    v_mfma_f32_16x16x32_bf16 v[156:159], a[4:7], a[188:191], v[156:159]
    v_perm_b32 v62, v125, v35, s39
    v_perm_b32 v60, v122, v35, s36
    v_mfma_f32_16x16x32_bf16 v[156:159], a[0:3], a[184:187], v[156:159]
    ds_read_b128 a[156:159], v41 offset:2048
    ds_read_b32 a207, v62
    v_perm_b32 v61, v122, v35, s37
    v_mfma_f32_16x16x32_bf16 v[160:163], a[240:243], a[176:179], v[160:163]
    ds_read_b32 a232, v60
    ds_read_b32 a233, v61
    v_mfma_f32_16x16x32_bf16 v[160:163], a[244:247], a[180:183], v[160:163]
    ds_read_b128 a[192:195], v40 offset:4096
    v_mfma_f32_16x16x32_bf16 v[164:167], a[244:247], a[164:167], v[164:167]
    buffer_load_dwordx4 v37, s[8:11], s3 offen offset:1024  lds
    v_mfma_f32_16x16x32_bf16 v[164:167], a[240:243], a[160:163], v[164:167]
    v_perm_b32 v63, v122, v35, s38
    v_perm_b32 v56, v122, v35, s39
    v_mfma_f32_16x16x32_bf16 v[168:171], a[240:243], a[56:59], v[168:171]
    ds_read_b32 a234, v63
    ds_read_b32 a235, v56
    v_perm_b32 v57, v126, v35, s36
    v_mfma_f32_16x16x32_bf16 v[168:171], a[244:247], a[60:63], v[168:171]
    ds_read_b128 a[196:199], v41 offset:4096
    ds_read_b32 a236, v57
    v_perm_b32 v58, v126, v35, s37
    v_mfma_f32_16x16x32_bf16 v[172:175], a[244:247], a[124:127], v[172:175]
    ds_read_b32 a237, v58
    v_perm_b32 v59, v126, v35, s38
    v_mfma_f32_16x16x32_bf16 v[172:175], a[240:243], a[120:123], v[172:175]
    ds_read_b32 a238, v59
    v_perm_b32 v62, v126, v35, s39
    v_mfma_f32_16x16x32_bf16 v[176:179], a[240:243], a[128:131], v[176:179]
    ds_read_b128 a[208:211], v40 offset:6144
    ds_read_b32 a239, v62
    v_mfma_f32_16x16x32_bf16 v[176:179], a[244:247], a[132:135], v[176:179]
    ds_read_b128 a[212:215], v41 offset:6144
    v_mfma_f32_16x16x32_bf16 v[180:183], a[244:247], a[148:151], v[180:183]
    buffer_load_dwordx4 v38, s[8:11], s3 offen offset:2048  lds
    v_mfma_f32_16x16x32_bf16 v[180:183], a[240:243], a[144:147], v[180:183]
    v_perm_b32 v60, v91, v35, s36
    v_perm_b32 v61, v91, v35, s37
    v_mfma_f32_16x16x32_bf16 v[184:187], a[240:243], a[168:171], v[184:187]
    ds_read_b32 a248, v60
    ds_read_b32 a249, v61
    v_mfma_f32_16x16x32_bf16 v[184:187], a[244:247], a[172:175], v[184:187]
    v_perm_b32 v63, v95, v35, s36
    v_perm_b32 v56, v95, v35, s37
    v_mfma_f32_16x16x32_bf16 v[188:191], a[244:247], a[188:191], v[188:191]
    ds_read_b128 a[48:51], v40 offset:8192
    ds_read_b32 a250, v63
    v_mfma_f32_16x16x32_bf16 v[188:191], a[240:243], a[184:187], v[188:191]
    ds_read_b32 a251, v56
    v_perm_b32 v57, v51, v35, s36
    v_mfma_f32_16x16x32_bf16 v[192:195], a[40:43], a[176:179], v[192:195]
    ds_read_b32 a252, v57
    ds_read_b128 a[52:55], v41 offset:8192
    v_mfma_f32_16x16x32_bf16 v[192:195], a[44:47], a[180:183], v[192:195]
    buffer_load_dwordx4 v39, s[8:11], s3 offen offset:3072  lds
    v_mfma_f32_16x16x32_bf16 v[196:199], a[44:47], a[164:167], v[196:199]
    v_perm_b32 v58, v51, v35, s37
    v_perm_b32 v59, v55, v35, s36
    v_mfma_f32_16x16x32_bf16 v[196:199], a[40:43], a[160:163], v[196:199]
    ds_read_b32 a253, v58
    ds_read_b32 a254, v59
    v_mfma_f32_16x16x32_bf16 v[200:203], a[40:43], a[56:59], v[200:203]
    ds_read_b128 a[16:19], v40 offset:10240
    v_perm_b32 v62, v55, v35, s37
    v_mfma_f32_16x16x32_bf16 v[200:203], a[44:47], a[60:63], v[200:203]
    ds_read_b32 a255, v62
    v_perm_b32 v60, v88, v35, s36
    v_mfma_f32_16x16x32_bf16 v[204:207], a[44:47], a[124:127], v[204:207]
    ds_read_b32 a216, v60
    v_perm_b32 v61, v88, v35, s37
    v_mfma_f32_16x16x32_bf16 v[204:207], a[40:43], a[120:123], v[204:207]
    ds_read_b128 a[20:23], v41 offset:10240
    ds_read_b32 a217, v61
    v_mfma_f32_16x16x32_bf16 v[208:211], a[40:43], a[128:131], v[208:211]
    v_perm_b32 v63, v88, v35, s38
    v_perm_b32 v56, v88, v35, s39
    v_mfma_f32_16x16x32_bf16 v[208:211], a[44:47], a[132:135], v[208:211]
    ds_read_b32 a218, v63
    ds_read_b32 a219, v56
    v_mfma_f32_16x16x32_bf16 v[212:215], a[44:47], a[148:151], v[212:215]
    ds_read_b128 a[24:27], v40 offset:12288
    v_perm_b32 v57, v92, v35, s36
    v_mfma_f32_16x16x32_bf16 v[212:215], a[40:43], a[144:147], v[212:215]
    ds_read_b32 a220, v57
    v_perm_b32 v58, v92, v35, s37
    v_mfma_f32_16x16x32_bf16 v[216:219], a[40:43], a[168:171], v[216:219]
    ds_read_b32 a221, v58
    v_perm_b32 v59, v92, v35, s38
    v_mfma_f32_16x16x32_bf16 v[216:219], a[44:47], a[172:175], v[216:219]
    ds_read_b128 a[28:31], v41 offset:12288
    ds_read_b32 a222, v59
    v_mfma_f32_16x16x32_bf16 v[220:223], a[44:47], a[188:191], v[220:223]
    v_perm_b32 v62, v92, v35, s39
    v_perm_b32 v60, v48, v35, s36
    v_mfma_f32_16x16x32_bf16 v[220:223], a[40:43], a[184:187], v[220:223]
    s_waitcnt lgkmcnt(9)
    ds_read_b32 a223, v62
    ds_read_b32 a8, v60
    v_mfma_f32_16x16x32_bf16 v[128:131], a[136:139], a[224:227], v[128:131]
    v_perm_b32 v61, v48, v35, s37
    v_perm_b32 v63, v48, v35, s38
    v_mfma_f32_16x16x32_bf16 v[128:131], a[140:143], a[228:231], v[128:131]
    ds_read_b32 a9, v61
    ds_read_b32 a10, v63
    v_mfma_f32_16x16x32_bf16 v[132:135], a[140:143], a[156:159], v[132:135]
    v_perm_b32 v56, v48, v35, s39
    v_perm_b32 v57, v52, v35, s36
    v_mfma_f32_16x16x32_bf16 v[132:135], a[136:139], a[152:155], v[132:135]
    ds_read_b32 a11, v56
    ds_read_b32 a12, v57
    v_mfma_f32_16x16x32_bf16 v[136:139], a[136:139], a[192:195], v[136:139]
    v_perm_b32 v58, v52, v35, s37
    v_perm_b32 v59, v52, v35, s38
    v_mfma_f32_16x16x32_bf16 v[136:139], a[140:143], a[196:199], v[136:139]
    ds_read_b32 a13, v58
    ds_read_b32 a14, v59
    v_mfma_f32_16x16x32_bf16 v[140:143], a[140:143], a[212:215], v[140:143]
    ds_read_b128 a[72:75], v40 offset:16384
    v_perm_b32 v62, v52, v35, s39
    v_mfma_f32_16x16x32_bf16 v[140:143], a[136:139], a[208:211], v[140:143]
    ds_read_b32 a15, v62
    v_perm_b32 v60, v89, v35, s36
    v_mfma_f32_16x16x32_bf16 v[144:147], a[136:139], a[48:51], v[144:147]
    ds_read_b32 a96, v60
    v_perm_b32 v61, v89, v35, s37
    v_mfma_f32_16x16x32_bf16 v[144:147], a[140:143], a[52:55], v[144:147]
    s_waitcnt lgkmcnt(9)
    ds_read_b128 a[76:79], v41 offset:16384
    ds_read_b32 a97, v61
    v_mfma_f32_16x16x32_bf16 v[148:151], a[140:143], a[20:23], v[148:151]
    v_perm_b32 v63, v89, v35, s38
    v_perm_b32 v56, v89, v35, s39
    v_mfma_f32_16x16x32_bf16 v[148:151], a[136:139], a[16:19], v[148:151]
    ds_read_b32 a98, v63
    ds_read_b32 a99, v56
    v_mfma_f32_16x16x32_bf16 v[152:155], a[136:139], a[24:27], v[152:155]
    ds_read_b128 a[32:35], v40 offset:18432
    v_perm_b32 v57, v93, v35, s36
    v_mfma_f32_16x16x32_bf16 v[152:155], a[140:143], a[28:31], v[152:155]
    ds_read_b32 a100, v57
    v_perm_b32 v58, v93, v35, s37
    v_mfma_f32_16x16x32_bf16 v[160:163], a[104:107], a[224:227], v[160:163]
    ds_read_b32 a101, v58
    v_perm_b32 v59, v93, v35, s38
    v_mfma_f32_16x16x32_bf16 v[160:163], a[108:111], a[228:231], v[160:163]
    ds_read_b128 a[36:39], v41 offset:18432
    ds_read_b32 a102, v59
    v_mfma_f32_16x16x32_bf16 v[164:167], a[108:111], a[156:159], v[164:167]
    s_waitcnt vmcnt(12)
    v_perm_b32 v60, v93, v35, s39
    v_bitop3_b32 v62, v71, v75, s76 bitop3:0x7e
    v_mfma_f32_16x16x32_bf16 v[164:167], a[104:107], a[152:155], v[164:167]
    ds_read_b32 a103, v60
    v_cmp_lt_u32 vcc, 0xffff, v62
    v_mfma_f32_16x16x32_bf16 v[168:171], a[104:107], a[192:195], v[168:171]
    ds_read_b128 a[80:83], v40 offset:20480
    v_perm_b32 v61, v49, v35, s36
    v_mfma_f32_16x16x32_bf16 v[168:171], a[108:111], a[196:199], v[168:171]
    ds_read_b32 a0, v61
    s_cbranch_vccnz L_slow7_0
L_back7_0:
    v_mfma_f32_16x16x32_bf16 v[172:175], a[108:111], a[212:215], v[172:175]
    v_perm_b32 v63, v49, v35, s37
    v_perm_b32 v56, v49, v35, s38
    v_mfma_f32_16x16x32_bf16 v[172:175], a[104:107], a[208:211], v[172:175]
    ds_read_b128 a[84:87], v41 offset:20480
    ds_read_b32 a1, v63
    v_mfma_f32_16x16x32_bf16 v[176:179], a[104:107], a[48:51], v[176:179]
    ds_read_b32 a2, v56
    v_perm_b32 v57, v49, v35, s39
    v_mfma_f32_16x16x32_bf16 v[176:179], a[108:111], a[52:55], v[176:179]
    s_waitcnt vmcnt(10)
    ds_read_b32 a3, v57
    v_bitop3_b32 v58, v79, v83, s76 bitop3:0x7e
    v_mfma_f32_16x16x32_bf16 v[180:183], a[108:111], a[20:23], v[180:183]
    ds_read_b128 a[240:243], v40 offset:22528
    v_cmp_lt_u32 vcc, 0xffff, v58
    v_mfma_f32_16x16x32_bf16 v[180:183], a[104:107], a[16:19], v[180:183]
    v_perm_b32 v59, v53, v35, s36
    v_perm_b32 v62, v53, v35, s37
    v_mfma_f32_16x16x32_bf16 v[184:187], a[104:107], a[24:27], v[184:187]
    ds_read_b32 a4, v59
    ds_read_b32 a5, v62
    v_mfma_f32_16x16x32_bf16 v[184:187], a[108:111], a[28:31], v[184:187]
    ds_read_b128 a[244:247], v41 offset:22528
    s_cbranch_vccnz L_slow7_1
L_back7_1:
    v_mfma_f32_16x16x32_bf16 v[192:195], a[112:115], a[224:227], v[192:195]
    v_perm_b32 v60, v53, v35, s38
    v_perm_b32 v61, v53, v35, s39
    v_mfma_f32_16x16x32_bf16 v[192:195], a[116:119], a[228:231], v[192:195]
    ds_read_b32 a6, v60
    ds_read_b32 a7, v61
    v_mfma_f32_16x16x32_bf16 v[196:199], a[116:119], a[156:159], v[196:199]
    ds_read_b128 a[176:179], v40 offset:24576
    v_perm_b32 v63, v90, v35, s36
    v_mfma_f32_16x16x32_bf16 v[196:199], a[112:115], a[152:155], v[196:199]
    ds_read_b32 a160, v63
    v_perm_b32 v56, v90, v35, s37
    v_mfma_f32_16x16x32_bf16 v[200:203], a[112:115], a[192:195], v[200:203]
    ds_read_b32 a161, v56
    v_perm_b32 v57, v90, v35, s38
    v_mfma_f32_16x16x32_bf16 v[200:203], a[116:119], a[196:199], v[200:203]
    ds_read_b128 a[180:183], v41 offset:24576
    ds_read_b32 a162, v57
    v_mfma_f32_16x16x32_bf16 v[204:207], a[116:119], a[212:215], v[204:207]
    v_perm_b32 v58, v90, v35, s39
    v_perm_b32 v59, v94, v35, s36
    v_mfma_f32_16x16x32_bf16 v[204:207], a[112:115], a[208:211], v[204:207]
    ds_read_b32 a163, v58
    ds_read_b32 a164, v59
    v_mfma_f32_16x16x32_bf16 v[208:211], a[112:115], a[48:51], v[208:211]
    ds_read_b128 a[56:59], v40 offset:26624
    v_perm_b32 v62, v94, v35, s37
    v_mfma_f32_16x16x32_bf16 v[208:211], a[116:119], a[52:55], v[208:211]
    ds_read_b32 a165, v62
    v_perm_b32 v60, v94, v35, s38
    v_mfma_f32_16x16x32_bf16 v[212:215], a[116:119], a[20:23], v[212:215]
    ds_read_b32 a166, v60
    v_perm_b32 v61, v94, v35, s39
    v_mfma_f32_16x16x32_bf16 v[212:215], a[112:115], a[16:19], v[212:215]
    ds_read_b128 a[60:63], v41 offset:26624
    ds_read_b32 a167, v61
    v_mfma_f32_16x16x32_bf16 v[216:219], a[112:115], a[24:27], v[216:219]
    v_perm_b32 v63, v50, v35, s36
    v_perm_b32 v56, v50, v35, s37
    v_mfma_f32_16x16x32_bf16 v[216:219], a[116:119], a[28:31], v[216:219]
    ds_read_b32 a120, v63
    ds_read_b32 a121, v56
    v_mfma_f32_16x16x32_bf16 v[224:227], a[88:91], a[226:229], v[224:227]
    s_waitcnt lgkmcnt(9)
    ds_read_b128 a[128:131], v40 offset:28672
    v_perm_b32 v57, v50, v35, s38
    v_mfma_f32_16x16x32_bf16 v[224:227], a[92:95], a[74:77], v[224:227]
    ds_read_b128 a[132:135], v41 offset:28672
    ds_read_b32 a122, v57
    v_mfma_f32_16x16x32_bf16 v[228:231], a[92:95], a[34:37], v[228:231]
    v_perm_b32 v58, v50, v35, s39
    v_perm_b32 v59, v54, v35, s36
    v_mfma_f32_16x16x32_bf16 v[228:231], a[88:91], a[154:157], v[228:231]
    ds_read_b32 a123, v58
    ds_read_b32 a124, v59
    v_mfma_f32_16x16x32_bf16 v[232:235], a[88:91], a[194:197], v[232:235]
    v_perm_b32 v62, v54, v35, s37
    v_perm_b32 v60, v54, v35, s38
    v_mfma_f32_16x16x32_bf16 v[232:235], a[92:95], a[82:85], v[232:235]
    ds_read_b32 a125, v62
    ds_read_b32 a126, v60
    v_mfma_f32_16x16x32_bf16 v[236:239], a[92:95], a[242:245], v[236:239]
    v_perm_b32 v61, v54, v35, s39
    v_perm_b32 v63, v71, v35, s36
    v_mfma_f32_16x16x32_bf16 v[236:239], a[88:91], a[210:213], v[236:239]
    ds_read_b32 a127, v61
    ds_read_b32 a144, v63
    v_mfma_f32_16x16x32_bf16 v[240:243], a[88:91], a[50:53], v[240:243]
    v_perm_b32 v56, v71, v35, s37
    v_perm_b32 v57, v75, v35, s36
    v_mfma_f32_16x16x32_bf16 v[240:243], a[92:95], a[178:181], v[240:243]
    s_waitcnt lgkmcnt(8)
    ds_read_b32 a145, v56
    ds_read_b32 a146, v57
    v_mfma_f32_16x16x32_bf16 v[244:247], a[92:95], a[58:61], v[244:247]
    v_perm_b32 v58, v75, v35, s37
    v_perm_b32 v59, v79, v35, s36
    v_mfma_f32_16x16x32_bf16 v[244:247], a[88:91], a[18:21], v[244:247]
    ds_read_b32 a147, v58
    ds_read_b32 a148, v59
    v_mfma_f32_16x16x32_bf16 v[248:251], a[88:91], a[26:29], v[248:251]
    s_waitcnt lgkmcnt(8)
    v_perm_b32 v62, v79, v35, s37
    v_perm_b32 v60, v83, v35, s36
    v_mfma_f32_16x16x32_bf16 v[248:251], a[92:95], a[130:133], v[248:251]
    ds_read_b32 a149, v62
    ds_read_b32 a150, v60
    v_mfma_f32_16x16x32_bf16 v[128:131], a[64:67], a[72:75], v[128:131]
    v_perm_b32 v61, v83, v35, s37
    v_perm_b32 v63, v68, v35, s36
    v_mfma_f32_16x16x32_bf16 v[128:131], a[68:71], a[76:79], v[128:131]
    ds_read_b32 a151, v61
    ds_read_b32 a168, v63
    v_mfma_f32_16x16x32_bf16 v[132:135], a[68:71], a[36:39], v[132:135]
    v_perm_b32 v56, v68, v35, s37
    v_perm_b32 v57, v68, v35, s38
    v_mfma_f32_16x16x32_bf16 v[132:135], a[64:67], a[32:35], v[132:135]
    ds_read_b32 a169, v56
    ds_read_b32 a170, v57
    v_mfma_f32_16x16x32_bf16 v[136:139], a[64:67], a[80:83], v[136:139]
    v_perm_b32 v58, v68, v35, s39
    v_perm_b32 v59, v72, v35, s36
    v_mfma_f32_16x16x32_bf16 v[136:139], a[68:71], a[84:87], v[136:139]
    ds_read_b32 a171, v58
    ds_read_b32 a172, v59
    v_mfma_f32_16x16x32_bf16 v[140:143], a[68:71], a[244:247], v[140:143]
    v_perm_b32 v62, v72, v35, s37
    v_perm_b32 v60, v72, v35, s38
    v_mfma_f32_16x16x32_bf16 v[140:143], a[64:67], a[240:243], v[140:143]
    s_waitcnt vmcnt(0)
    ds_read_b32 a173, v62
    ds_read_b32 a174, v60
    v_mfma_f32_16x16x32_bf16 v[144:147], a[64:67], a[176:179], v[144:147]
    s_barrier
    v_mfma_f32_16x16x32_bf16 v[144:147], a[68:71], a[180:183], v[144:147]
    v_perm_b32 v61, v72, v35, s39
    v_perm_b32 v63, v76, v35, s36
    v_mfma_f32_16x16x32_bf16 v[148:151], a[68:71], a[60:63], v[148:151]
    ds_read_b32 a175, v61
    ds_read_b32 a40, v63
    v_mfma_f32_16x16x32_bf16 v[148:151], a[64:67], a[56:59], v[148:151]
    v_perm_b32 v56, v76, v35, s37
    v_perm_b32 v57, v76, v35, s38
    v_mfma_f32_16x16x32_bf16 v[152:155], a[64:67], a[128:131], v[152:155]
    ds_read_b32 a41, v56
    ds_read_b32 a42, v57
    v_mfma_f32_16x16x32_bf16 v[152:155], a[68:71], a[132:135], v[152:155]
    ds_read_b128 a[184:187], v40 offset:32768
    v_perm_b32 v58, v76, v35, s39
    v_mfma_f32_16x16x32_bf16 v[160:163], a[200:203], a[72:75], v[160:163]
    ds_read_b32 a43, v58
    v_perm_b32 v59, v80, v35, s36
    v_mfma_f32_16x16x32_bf16 v[160:163], a[204:207], a[76:79], v[160:163]
    ds_read_b32 a44, v59
    v_perm_b32 v62, v80, v35, s37
    v_mfma_f32_16x16x32_bf16 v[164:167], a[204:207], a[36:39], v[164:167]
    ds_read_b128 a[188:191], v41 offset:32768
    ds_read_b32 a45, v62
    v_mfma_f32_16x16x32_bf16 v[164:167], a[200:203], a[32:35], v[164:167]
    v_perm_b32 v60, v80, v35, s38
    v_perm_b32 v61, v80, v35, s39
    v_mfma_f32_16x16x32_bf16 v[168:171], a[200:203], a[80:83], v[168:171]
    ds_read_b32 a46, v60
    ds_read_b32 a47, v61
    v_mfma_f32_16x16x32_bf16 v[168:171], a[204:207], a[84:87], v[168:171]
    v_perm_b32 v63, v69, v35, s36
    v_perm_b32 v56, v69, v35, s37
    v_mfma_f32_16x16x32_bf16 v[172:175], a[204:207], a[244:247], v[172:175]
    ds_read_b128 a[224:227], v40 offset:49152
    ds_read_b32 a152, v63
    v_mfma_f32_16x16x32_bf16 v[172:175], a[200:203], a[240:243], v[172:175]
    ds_read_b32 a153, v56
    v_perm_b32 v57, v69, v35, s38
    v_mfma_f32_16x16x32_bf16 v[176:179], a[200:203], a[176:179], v[176:179]
    ds_read_b32 a154, v57
    v_perm_b32 v58, v73, v35, s36
    v_mfma_f32_16x16x32_bf16 v[176:179], a[204:207], a[180:183], v[176:179]
    ds_read_b128 a[228:231], v41 offset:49152
    ds_read_b32 a156, v58
    v_mfma_f32_16x16x32_bf16 v[180:183], a[204:207], a[60:63], v[180:183]
    v_perm_b32 v62, v73, v35, s37
    v_perm_b32 v59, v69, v35, s39
    v_mfma_f32_16x16x32_bf16 v[180:183], a[200:203], a[56:59], v[180:183]
    ds_read_b32 a157, v62
    ds_read_b32 a155, v59
    v_perm_b32 v60, v73, v35, s38
    v_mfma_f32_16x16x32_bf16 v[184:187], a[200:203], a[128:131], v[184:187]
    ds_read_b32 a158, v60
    v_perm_b32 v61, v77, v35, s36
    v_mfma_f32_16x16x32_bf16 v[184:187], a[204:207], a[132:135], v[184:187]
    ds_read_b128 a[192:195], v42 offset:0
    ds_read_b32 a208, v61
    v_mfma_f32_16x16x32_bf16 v[192:195], a[232:235], a[72:75], v[192:195]
    v_perm_b32 v56, v77, v35, s37
    v_perm_b32 v63, v73, v35, s39
    v_mfma_f32_16x16x32_bf16 v[192:195], a[236:239], a[76:79], v[192:195]
    ds_read_b32 a209, v56
    v_perm_b32 v57, v77, v35, s38
    v_mfma_f32_16x16x32_bf16 v[196:199], a[236:239], a[36:39], v[196:199]
    ds_read_b128 a[196:199], v43 offset:0
    v_perm_b32 v58, v81, v35, s36
    v_mfma_f32_16x16x32_bf16 v[196:199], a[232:235], a[32:35], v[196:199]
    ds_read_b32 a212, v58
    ds_read_b32 a159, v63
    v_perm_b32 v59, v81, v35, s37
    v_mfma_f32_16x16x32_bf16 v[200:203], a[232:235], a[80:83], v[200:203]
    ds_read_b32 a210, v57
    v_perm_b32 v62, v77, v35, s39
    v_mfma_f32_16x16x32_bf16 v[200:203], a[236:239], a[84:87], v[200:203]
    ds_read_b32 a213, v59
    v_perm_b32 v60, v81, v35, s38
    v_mfma_f32_16x16x32_bf16 v[204:207], a[236:239], a[244:247], v[204:207]
    ds_read_b128 a[48:51], v42 offset:16384
    v_perm_b32 v61, v70, v35, s36
    v_mfma_f32_16x16x32_bf16 v[204:207], a[232:235], a[240:243], v[204:207]
    ds_read_b32 a16, v61
    v_perm_b32 v56, v70, v35, s37
    v_mfma_f32_16x16x32_bf16 v[208:211], a[232:235], a[176:179], v[208:211]
    ds_read_b32 a211, v62
    ds_read_b32 a214, v60
    v_mfma_f32_16x16x32_bf16 v[208:211], a[236:239], a[180:183], v[208:211]
    ds_read_b128 a[52:55], v43 offset:16384
    v_perm_b32 v63, v81, v35, s39
    v_mfma_f32_16x16x32_bf16 v[212:215], a[236:239], a[60:63], v[212:215]
    ds_read_b32 a17, v56
    v_perm_b32 v58, v74, v35, s36
    v_mfma_f32_16x16x32_bf16 v[212:215], a[232:235], a[56:59], v[212:215]
    ds_read_b32 a20, v58
    v_perm_b32 v57, v70, v35, s38
    v_mfma_f32_16x16x32_bf16 v[216:219], a[232:235], a[128:131], v[216:219]
    ds_read_b32 a215, v63
    v_perm_b32 v59, v74, v35, s37
    v_mfma_f32_16x16x32_bf16 v[216:219], a[236:239], a[132:135], v[216:219]
    s_waitcnt lgkmcnt(9)
    ds_read_b32 a18, v57
    v_perm_b32 v61, v70, v35, s39
    v_mfma_f32_16x16x32_bf16 v[224:227], a[248:251], a[186:189], v[224:227]
    s_mov_b32 s66, 0
    ds_read_b32 a21, v59
    v_perm_b32 v62, v78, v35, s36
    v_mfma_f32_16x16x32_bf16 v[224:227], a[252:255], a[226:229], v[224:227]
    s_mov_b32 s67, 14336
    v_perm_b32 v60, v74, v35, s38
    v_perm_b32 v56, v78, v35, s37
    v_mfma_f32_16x16x32_bf16 v[128:131], a[216:219], a[184:187], v[128:131]
    ds_read_b32 a24, v62
    ds_read_b32 a19, v61
    v_mfma_f32_16x16x32_bf16 v[128:131], a[220:223], a[188:191], v[128:131]
    ds_read_b32 a22, v60
    v_perm_b32 v58, v74, v35, s39
    v_mfma_f32_16x16x32_bf16 v[128:131], a[8:11], a[224:227], v[128:131]
    ds_read_b32 a25, v56
    v_perm_b32 v63, v78, v35, s38
    v_mfma_f32_16x16x32_bf16 v[128:131], a[12:15], a[228:231], v[128:131]
    ds_read_b32 a23, v58
    ds_read_b32 a26, v63
    v_mfma_f32_16x16x32_bf16 v[160:163], a[96:99], a[184:187], v[160:163]
    v_perm_b32 v59, v82, v35, s36
    v_perm_b32 v57, v78, v35, s39
    v_mfma_f32_16x16x32_bf16 v[160:163], a[100:103], a[188:191], v[160:163]
    ds_read_b32 a27, v57
    v_perm_b32 v61, v82, v35, s37
    v_mfma_f32_16x16x32_bf16 v[160:163], a[0:3], a[224:227], v[160:163]
    ds_read_b32 a28, v59
    ds_read_b128 a[72:75], v40 offset:34816
    v_mfma_f32_16x16x32_bf16 v[160:163], a[4:7], a[228:231], v[160:163]
    ds_read_b32 a29, v61
    v_perm_b32 v62, v82, v35, s38
    v_mfma_f32_16x16x32_bf16 v[192:195], a[160:163], a[184:187], v[192:195]
    ds_read_b128 a[76:79], v41 offset:34816
    ds_read_b32 a30, v62
    v_mfma_f32_16x16x32_bf16 v[192:195], a[164:167], a[188:191], v[192:195]
    ds_read_b128 a[32:35], v40 offset:51200
    v_perm_b32 v60, v82, v35, s39
    v_mfma_f32_16x16x32_bf16 v[192:195], a[120:123], a[224:227], v[192:195]
    ds_read_b128 a[36:39], v41 offset:51200
    ds_read_b32 a31, v60
    v_mfma_f32_16x16x32_bf16 v[192:195], a[124:127], a[228:231], v[192:195]
    v_lshlrev_b32 v96, 16, v86
    v_and_b32 v97, 0xffff0000, v86
    v_mfma_f32_16x16x32_bf16 v[224:227], a[144:147], a[194:197], v[224:227]
    s_waitcnt lgkmcnt(9)
    ds_read_b128 a[80:83], v42 offset:2048
    v_lshlrev_b32 v100, 16, v64
    v_mfma_f32_16x16x32_bf16 v[224:227], a[148:151], a[50:53], v[224:227]
    ds_read_b128 a[84:87], v43 offset:2048
    v_and_b32 v101, 0xffff0000, v65
    v_mfma_f32_16x16x32_bf16 v[128:131], a[168:171], a[192:195], v[128:131]
    v_lshlrev_b32 v102, 16, v67
    v_and_b32 v103, 0xffff0000, v84
    v_mfma_f32_16x16x32_bf16 v[128:131], a[172:175], a[196:199], v[128:131]
    ds_read_b128 a[240:243], v42 offset:18432
    v_and_b32 v104, 0xffff0000, v64
    v_mfma_f32_16x16x32_bf16 v[128:131], a[40:43], a[48:51], v[128:131]
    v_lshlrev_b32 v105, 16, v66
    v_and_b32 v106, 0xffff0000, v67
    v_mfma_f32_16x16x32_bf16 v[128:131], a[44:47], a[52:55], v[128:131]
    ds_read_b128 a[244:247], v43 offset:18432
    v_lshlrev_b32 v107, 16, v85
    v_mfma_f32_16x16x32_bf16 v[160:163], a[152:155], a[192:195], v[160:163]
    ds_write_b64 v29, v[226:227] offset:28928
    v_lshlrev_b32 v108, 16, v65
    v_mfma_f32_16x16x32_bf16 v[160:163], a[156:159], a[196:199], v[160:163]
    v_and_b32 v109, 0xffff0000, v66
    v_lshlrev_b32 v110, 16, v84
    v_mfma_f32_16x16x32_bf16 v[160:163], a[208:211], a[48:51], v[160:163]
    ds_read_b128 a[176:179], v40 offset:36864
    v_and_b32 v111, 0xffff0000, v85
    v_mfma_f32_16x16x32_bf16 v[160:163], a[212:215], a[52:55], v[160:163]
    v_mul_f32 v128, v128, v100
    v_mul_f32 v129, v129, v101
    v_mfma_f32_16x16x32_bf16 v[192:195], a[16:19], a[192:195], v[192:195]
    v_mul_f32 v130, v130, v102
    v_mul_f32 v131, v131, v103
    v_mfma_f32_16x16x32_bf16 v[192:195], a[20:23], a[196:199], v[192:195]
    s_waitcnt lgkmcnt(1)
    s_barrier
    v_mfma_f32_16x16x32_bf16 v[192:195], a[24:27], a[48:51], v[192:195]
    ds_read_b64 v[112:113], v30 offset:28928
    ds_read_b128 a[180:183], v41 offset:36864
    v_mfma_f32_16x16x32_bf16 v[192:195], a[28:31], a[52:55], v[192:195]
    v_mul_f32 v160, v160, v104
    v_cvt_pk_bf16_f32 v116, v128, v160
    v_mfma_f32_16x16x32_bf16 v[228:231], a[248:251], a[74:77], v[228:231]
    v_mul_f32 v161, v161, v105
    v_mul_f32 v162, v162, v106
    v_mfma_f32_16x16x32_bf16 v[228:231], a[252:255], a[34:37], v[228:231]
    ds_read_b128 a[56:59], v40 offset:53248
    v_cvt_pk_bf16_f32 v119, v130, v162
L_pad4:
    s_cbranch_execz L_warmed
    v_mfma_f32_16x16x32_bf16 v[228:231], a[144:147], a[82:85], v[228:231]
    v_mul_f32 v163, v163, v107
    v_mov_b32 v8, 1
    v_mfma_f32_16x16x32_bf16 v[228:231], a[148:151], a[242:245], v[228:231]
    v_mul_f32 v192, v192, v108
    v_mul_f32 v193, v193, v109
    v_mfma_f32_16x16x32_bf16 v[132:135], a[216:219], a[72:75], v[132:135]
    v_mul_f32 v194, v194, v110
    v_mul_f32 v195, v195, v111
    v_mfma_f32_16x16x32_bf16 v[132:135], a[220:223], a[76:79], v[132:135]
    v_cvt_pk_bf16_f32 v117, v192, v129
    v_cvt_pk_bf16_f32 v118, v161, v193
    v_mfma_f32_16x16x32_bf16 v[132:135], a[8:11], a[32:35], v[132:135]
    ds_write_b64 v26, v[116:117] offset:64512
    v_cvt_pk_bf16_f32 v120, v194, v131
    v_mfma_f32_16x16x32_bf16 v[132:135], a[12:15], a[36:39], v[132:135]
    ds_write_b64 v26, v[118:119] offset:64520
    v_cvt_pk_bf16_f32 v121, v163, v195
    v_mfma_f32_16x16x32_bf16 v[132:135], a[168:171], a[80:83], v[132:135]
    s_waitcnt lgkmcnt(3)
    ds_write_b64 v26, v[120:121] offset:64528
    v_add_f32 v224, v224, v112
    v_mfma_f32_16x16x32_bf16 v[132:135], a[172:175], a[84:87], v[132:135]
    ds_read_b128 a[60:63], v41 offset:53248
    v_mul_f32 v224, v224, v96
    v_mfma_f32_16x16x32_bf16 v[132:135], a[40:43], a[240:243], v[132:135]
    v_add_f32 v225, v225, v113
    v_mul_f32 v225, v225, v97
    v_mfma_f32_16x16x32_bf16 v[132:135], a[44:47], a[244:247], v[132:135]
    ds_write_b64 v29, v[230:231] offset:30976
    v_cvt_pk_bf16_f32 v112, v224, v225
    v_mfma_f32_16x16x32_bf16 v[164:167], a[96:99], a[72:75], v[164:167]
    ds_write_b32 v28, v112 offset:64512
    v_min_u32 v9, 1, v0
    v_mfma_f32_16x16x32_bf16 v[164:167], a[100:103], a[76:79], v[164:167]
    ds_read_b128 a[128:131], v42 offset:4096
    v_lshlrev_b32 v9, 30, v9
    v_mfma_f32_16x16x32_bf16 v[164:167], a[0:3], a[32:35], v[164:167]
    ds_read_b128 a[132:135], v43 offset:4096
    v_mfma_f32_16x16x32_bf16 v[164:167], a[4:7], a[36:39], v[164:167]
    buffer_atomic_add v8, v9, s[24:27], s77 offen sc0 sc1
    v_mfma_f32_16x16x32_bf16 v[164:167], a[152:155], a[80:83], v[164:167]
    ds_read_b128 a[184:187], v42 offset:20480
    v_mul_f32 v132, v132, v100
    v_mfma_f32_16x16x32_bf16 v[164:167], a[156:159], a[84:87], v[164:167]
    s_waitcnt lgkmcnt(3)
    s_barrier
    v_mfma_f32_16x16x32_bf16 v[164:167], a[208:211], a[240:243], v[164:167]
    ds_read_b128 v[124:127], v24 offset:64512
    ds_read_b64 v[88:89], v30 offset:30976
    v_mfma_f32_16x16x32_bf16 v[164:167], a[212:215], a[244:247], v[164:167]
    ds_read_b128 a[188:191], v43 offset:20480
    v_mul_f32 v133, v133, v101
    v_mfma_f32_16x16x32_bf16 v[196:199], a[160:163], a[72:75], v[196:199]
    ds_read_b128 v[92:95], v24 offset:65440
    v_mul_f32 v134, v134, v102
    v_mfma_f32_16x16x32_bf16 v[196:199], a[164:167], a[76:79], v[196:199]
    v_mul_f32 v135, v135, v103
    v_mfma_f32_16x16x32_bf16 v[196:199], a[120:123], a[32:35], v[196:199]
    ds_read_b128 a[224:227], v40 offset:38912
    v_mfma_f32_16x16x32_bf16 v[196:199], a[124:127], a[36:39], v[196:199]
    v_mul_f32 v164, v164, v104
    v_cvt_pk_bf16_f32 v48, v132, v164
    v_mfma_f32_16x16x32_bf16 v[196:199], a[16:19], a[80:83], v[196:199]
    s_waitcnt lgkmcnt(3)
    v_mul_f32 v165, v165, v105
    v_mfma_f32_16x16x32_bf16 v[196:199], a[20:23], a[84:87], v[196:199]
    buffer_store_dwordx4 v[124:127], v25, s[16:19], s66 offen sc1
    v_mfma_f32_16x16x32_bf16 v[196:199], a[24:27], a[240:243], v[196:199]
    s_mov_b32 s66, 114688
    v_add_f32 v228, v228, v88
    v_mul_f32 v228, v228, v96
    v_mfma_f32_16x16x32_bf16 v[196:199], a[28:31], a[244:247], v[196:199]
    v_add_f32 v229, v229, v89
    v_mul_f32 v229, v229, v97
    v_mfma_f32_16x16x32_bf16 v[232:235], a[248:251], a[178:181], v[232:235]
    s_waitcnt lgkmcnt(1)
    ds_read_b128 a[228:231], v41 offset:38912
    v_mfma_f32_16x16x32_bf16 v[232:235], a[252:255], a[58:61], v[232:235]
    buffer_store_dwordx4 v[92:95], v25, s[16:19], s67 offen sc1
    v_mfma_f32_16x16x32_bf16 v[232:235], a[144:147], a[130:133], v[232:235]
    s_mov_b32 s67, 129024
    v_cvt_pk_bf16_f32 v88, v228, v229
    v_mul_f32 v166, v166, v106
    v_mfma_f32_16x16x32_bf16 v[232:235], a[148:151], a[186:189], v[232:235]
    ds_write_b32 v28, v88 offset:0
    v_cvt_pk_bf16_f32 v51, v134, v166
    v_mfma_f32_16x16x32_bf16 v[136:139], a[216:219], a[176:179], v[136:139]
    v_mul_f32 v167, v167, v107
    v_mul_f32 v196, v196, v108
    v_mfma_f32_16x16x32_bf16 v[136:139], a[220:223], a[180:183], v[136:139]
    v_mul_f32 v197, v197, v109
    v_mul_f32 v198, v198, v110
    v_mfma_f32_16x16x32_bf16 v[136:139], a[8:11], a[56:59], v[136:139]
    ds_read_b128 a[192:195], v40 offset:55296
    v_mul_f32 v199, v199, v111
    v_mfma_f32_16x16x32_bf16 v[136:139], a[12:15], a[60:63], v[136:139]
    v_cvt_pk_bf16_f32 v49, v196, v133
    v_cvt_pk_bf16_f32 v50, v165, v197
    v_mfma_f32_16x16x32_bf16 v[136:139], a[168:171], a[128:131], v[136:139]
    ds_write_b64 v26, v[48:49] offset:0
    v_cvt_pk_bf16_f32 v52, v198, v135
    v_mfma_f32_16x16x32_bf16 v[136:139], a[172:175], a[132:135], v[136:139]
    ds_read_b128 a[196:199], v41 offset:55296
    v_cvt_pk_bf16_f32 v53, v167, v199
    v_mfma_f32_16x16x32_bf16 v[136:139], a[40:43], a[184:187], v[136:139]
    ds_write_b64 v26, v[50:51] offset:8
    v_mfma_f32_16x16x32_bf16 v[136:139], a[44:47], a[188:191], v[136:139]
    ds_write_b64 v26, v[52:53] offset:16
    v_mfma_f32_16x16x32_bf16 v[168:171], a[96:99], a[176:179], v[168:171]
    ds_write_b64 v29, v[234:235] offset:33024
    v_mfma_f32_16x16x32_bf16 v[168:171], a[100:103], a[180:183], v[168:171]
    ds_read_b128 a[48:51], v42 offset:6144
    v_mfma_f32_16x16x32_bf16 v[168:171], a[0:3], a[56:59], v[168:171]
    ds_read_b128 a[52:55], v43 offset:6144
    v_mfma_f32_16x16x32_bf16 v[168:171], a[4:7], a[60:63], v[168:171]
    ds_read_b128 a[72:75], v42 offset:22528
    v_mul_f32 v136, v136, v100
    v_mfma_f32_16x16x32_bf16 v[168:171], a[152:155], a[128:131], v[168:171]
    v_mul_f32 v137, v137, v101
    v_mul_f32 v138, v138, v102
    v_mfma_f32_16x16x32_bf16 v[168:171], a[156:159], a[132:135], v[168:171]
    s_waitcnt lgkmcnt(3)
    s_barrier
    v_mfma_f32_16x16x32_bf16 v[168:171], a[208:211], a[184:187], v[168:171]
    ds_read_b128 v[68:71], v24 offset:0
    ds_read_b64 v[72:73], v30 offset:33024
    v_mfma_f32_16x16x32_bf16 v[168:171], a[212:215], a[188:191], v[168:171]
    ds_read_b128 a[76:79], v43 offset:22528
    v_mul_f32 v139, v139, v103
    v_mfma_f32_16x16x32_bf16 v[200:203], a[160:163], a[176:179], v[200:203]
    ds_read_b128 v[76:79], v24 offset:928
    v_mfma_f32_16x16x32_bf16 v[200:203], a[164:167], a[180:183], v[200:203]
    v_mfma_f32_16x16x32_bf16 v[200:203], a[120:123], a[56:59], v[200:203]
    ds_read_b128 a[32:35], v40 offset:40960
    v_mfma_f32_16x16x32_bf16 v[200:203], a[124:127], a[60:63], v[200:203]
    v_mul_f32 v168, v168, v104
    v_cvt_pk_bf16_f32 v80, v136, v168
    v_mfma_f32_16x16x32_bf16 v[200:203], a[16:19], a[128:131], v[200:203]
    s_waitcnt lgkmcnt(3)
    v_mul_f32 v169, v169, v105
    v_mfma_f32_16x16x32_bf16 v[200:203], a[20:23], a[132:135], v[200:203]
    buffer_store_dwordx4 v[68:71], v25, s[16:19], s66 offen sc1
    v_mfma_f32_16x16x32_bf16 v[200:203], a[24:27], a[184:187], v[200:203]
    s_mov_b32 s66, 229376
    v_add_f32 v232, v232, v72
    v_mul_f32 v232, v232, v96
    v_mfma_f32_16x16x32_bf16 v[200:203], a[28:31], a[188:191], v[200:203]
    v_add_f32 v233, v233, v73
    v_mul_f32 v233, v233, v97
    v_mfma_f32_16x16x32_bf16 v[236:239], a[248:251], a[226:229], v[236:239]
    s_waitcnt lgkmcnt(1)
    ds_read_b128 a[36:39], v41 offset:40960
    v_mfma_f32_16x16x32_bf16 v[236:239], a[252:255], a[194:197], v[236:239]
    buffer_store_dwordx4 v[76:79], v25, s[16:19], s67 offen sc1
    v_mfma_f32_16x16x32_bf16 v[236:239], a[144:147], a[50:53], v[236:239]
    s_mov_b32 s67, 243712
    v_cvt_pk_bf16_f32 v72, v232, v233
    v_mul_f32 v170, v170, v106
    v_mfma_f32_16x16x32_bf16 v[236:239], a[148:151], a[74:77], v[236:239]
    ds_write_b32 v28, v72 offset:7424
    v_cvt_pk_bf16_f32 v83, v138, v170
    v_mfma_f32_16x16x32_bf16 v[140:143], a[216:219], a[224:227], v[140:143]
    v_mul_f32 v171, v171, v107
    v_mul_f32 v200, v200, v108
    v_mfma_f32_16x16x32_bf16 v[140:143], a[220:223], a[228:231], v[140:143]
    v_mul_f32 v201, v201, v109
    v_mul_f32 v202, v202, v110
    v_mfma_f32_16x16x32_bf16 v[140:143], a[8:11], a[192:195], v[140:143]
    ds_read_b128 a[80:83], v40 offset:57344
    v_mul_f32 v203, v203, v111
    v_mfma_f32_16x16x32_bf16 v[140:143], a[12:15], a[196:199], v[140:143]
    v_cvt_pk_bf16_f32 v81, v200, v137
    v_cvt_pk_bf16_f32 v82, v169, v201
    v_mfma_f32_16x16x32_bf16 v[140:143], a[168:171], a[48:51], v[140:143]
    ds_write_b64 v26, v[80:81] offset:7424
    v_cvt_pk_bf16_f32 v64, v202, v139
    v_mfma_f32_16x16x32_bf16 v[140:143], a[172:175], a[52:55], v[140:143]
    ds_read_b128 a[84:87], v41 offset:57344
    v_cvt_pk_bf16_f32 v65, v171, v203
    v_mfma_f32_16x16x32_bf16 v[140:143], a[40:43], a[72:75], v[140:143]
    ds_write_b64 v26, v[82:83] offset:7432
    v_mfma_f32_16x16x32_bf16 v[140:143], a[44:47], a[76:79], v[140:143]
    ds_write_b64 v26, v[64:65] offset:7440
    v_mfma_f32_16x16x32_bf16 v[172:175], a[96:99], a[224:227], v[172:175]
    ds_write_b64 v29, v[238:239] offset:0
    v_mfma_f32_16x16x32_bf16 v[172:175], a[100:103], a[228:231], v[172:175]
    ds_read_b128 a[240:243], v42 offset:8192
    v_mfma_f32_16x16x32_bf16 v[172:175], a[0:3], a[192:195], v[172:175]
    ds_read_b128 a[244:247], v43 offset:8192
    v_mfma_f32_16x16x32_bf16 v[172:175], a[4:7], a[196:199], v[172:175]
    ds_read_b128 a[176:179], v42 offset:24576
    v_mul_f32 v140, v140, v100
    v_mfma_f32_16x16x32_bf16 v[172:175], a[152:155], a[48:51], v[172:175]
    v_mul_f32 v141, v141, v101
    v_mul_f32 v142, v142, v102
    v_mfma_f32_16x16x32_bf16 v[172:175], a[156:159], a[52:55], v[172:175]
    s_waitcnt lgkmcnt(3)
    s_barrier
    v_mfma_f32_16x16x32_bf16 v[172:175], a[208:211], a[72:75], v[172:175]
    ds_read_b128 v[84:87], v24 offset:7424
    ds_read_b64 v[116:117], v30 offset:0
    v_mfma_f32_16x16x32_bf16 v[172:175], a[212:215], a[76:79], v[172:175]
    ds_read_b128 a[180:183], v43 offset:24576
    v_mul_f32 v143, v143, v103
    v_mfma_f32_16x16x32_bf16 v[204:207], a[160:163], a[224:227], v[204:207]
    ds_read_b128 v[120:123], v24 offset:8352
    v_mfma_f32_16x16x32_bf16 v[204:207], a[164:167], a[228:231], v[204:207]
    v_mfma_f32_16x16x32_bf16 v[204:207], a[120:123], a[192:195], v[204:207]
    ds_read_b128 a[56:59], v40 offset:43008
    v_mfma_f32_16x16x32_bf16 v[204:207], a[124:127], a[196:199], v[204:207]
    v_mul_f32 v172, v172, v104
    v_cvt_pk_bf16_f32 v112, v140, v172
    v_mfma_f32_16x16x32_bf16 v[204:207], a[16:19], a[48:51], v[204:207]
    s_waitcnt lgkmcnt(3)
    v_mul_f32 v173, v173, v105
    v_mfma_f32_16x16x32_bf16 v[204:207], a[20:23], a[52:55], v[204:207]
    buffer_store_dwordx4 v[84:87], v25, s[16:19], s66 offen sc1
    v_mfma_f32_16x16x32_bf16 v[204:207], a[24:27], a[72:75], v[204:207]
    s_mov_b32 s66, 344064
    v_add_f32 v236, v236, v116
    v_mul_f32 v236, v236, v96
    v_mfma_f32_16x16x32_bf16 v[204:207], a[28:31], a[76:79], v[204:207]
    v_add_f32 v237, v237, v117
    v_mul_f32 v237, v237, v97
    v_mfma_f32_16x16x32_bf16 v[240:243], a[248:251], a[34:37], v[240:243]
    s_waitcnt lgkmcnt(1)
    ds_read_b128 a[60:63], v41 offset:43008
    v_mfma_f32_16x16x32_bf16 v[240:243], a[252:255], a[82:85], v[240:243]
    buffer_store_dwordx4 v[120:123], v25, s[16:19], s67 offen sc1
    v_mfma_f32_16x16x32_bf16 v[240:243], a[144:147], a[242:245], v[240:243]
    s_mov_b32 s67, 358400
    v_cvt_pk_bf16_f32 v116, v236, v237
    v_mul_f32 v174, v174, v106
    v_mfma_f32_16x16x32_bf16 v[240:243], a[148:151], a[178:181], v[240:243]
    ds_write_b32 v28, v116 offset:14848
    v_cvt_pk_bf16_f32 v115, v142, v174
    v_mfma_f32_16x16x32_bf16 v[144:147], a[216:219], a[32:35], v[144:147]
    v_mul_f32 v175, v175, v107
    v_mul_f32 v204, v204, v108
    v_mfma_f32_16x16x32_bf16 v[144:147], a[220:223], a[36:39], v[144:147]
    v_mul_f32 v205, v205, v109
    v_mul_f32 v206, v206, v110
    v_mfma_f32_16x16x32_bf16 v[144:147], a[8:11], a[80:83], v[144:147]
    ds_read_b128 a[128:131], v40 offset:59392
    v_mul_f32 v207, v207, v111
    v_mfma_f32_16x16x32_bf16 v[144:147], a[12:15], a[84:87], v[144:147]
    v_cvt_pk_bf16_f32 v113, v204, v141
    v_cvt_pk_bf16_f32 v114, v173, v205
    v_mfma_f32_16x16x32_bf16 v[144:147], a[168:171], a[240:243], v[144:147]
    ds_write_b64 v26, v[112:113] offset:14848
    v_cvt_pk_bf16_f32 v124, v206, v143
    v_mfma_f32_16x16x32_bf16 v[144:147], a[172:175], a[244:247], v[144:147]
    ds_read_b128 a[132:135], v41 offset:59392
    v_cvt_pk_bf16_f32 v125, v175, v207
    v_mfma_f32_16x16x32_bf16 v[144:147], a[40:43], a[176:179], v[144:147]
    ds_write_b64 v26, v[114:115] offset:14856
    v_mfma_f32_16x16x32_bf16 v[144:147], a[44:47], a[180:183], v[144:147]
    ds_write_b64 v26, v[124:125] offset:14864
    v_mfma_f32_16x16x32_bf16 v[176:179], a[96:99], a[32:35], v[176:179]
    ds_write_b64 v29, v[242:243] offset:2048
    v_mfma_f32_16x16x32_bf16 v[176:179], a[100:103], a[36:39], v[176:179]
    ds_read_b128 a[184:187], v42 offset:10240
    v_mfma_f32_16x16x32_bf16 v[176:179], a[0:3], a[80:83], v[176:179]
    ds_read_b128 a[188:191], v43 offset:10240
    v_mfma_f32_16x16x32_bf16 v[176:179], a[4:7], a[84:87], v[176:179]
    ds_read_b128 a[224:227], v42 offset:26624
    v_mul_f32 v144, v144, v100
    v_mfma_f32_16x16x32_bf16 v[176:179], a[152:155], a[240:243], v[176:179]
    v_mul_f32 v145, v145, v101
    v_mul_f32 v146, v146, v102
    v_mfma_f32_16x16x32_bf16 v[176:179], a[156:159], a[244:247], v[176:179]
    s_waitcnt lgkmcnt(3)
    s_barrier
    v_mfma_f32_16x16x32_bf16 v[176:179], a[208:211], a[176:179], v[176:179]
    ds_read_b128 v[92:95], v24 offset:14848
    ds_read_b64 v[88:89], v30 offset:2048
    v_mfma_f32_16x16x32_bf16 v[176:179], a[212:215], a[180:183], v[176:179]
    ds_read_b128 a[228:231], v43 offset:26624
    v_mul_f32 v147, v147, v103
    v_mfma_f32_16x16x32_bf16 v[208:211], a[160:163], a[32:35], v[208:211]
    ds_read_b128 v[48:51], v24 offset:15776
    v_mfma_f32_16x16x32_bf16 v[208:211], a[164:167], a[36:39], v[208:211]
    v_mfma_f32_16x16x32_bf16 v[208:211], a[120:123], a[80:83], v[208:211]
    ds_read_b128 a[192:195], v40 offset:45056
    v_mfma_f32_16x16x32_bf16 v[208:211], a[124:127], a[84:87], v[208:211]
    v_mul_f32 v176, v176, v104
    v_cvt_pk_bf16_f32 v52, v144, v176
    v_mfma_f32_16x16x32_bf16 v[208:211], a[16:19], a[240:243], v[208:211]
    s_waitcnt lgkmcnt(3)
    v_mul_f32 v177, v177, v105
    v_mfma_f32_16x16x32_bf16 v[208:211], a[20:23], a[244:247], v[208:211]
    buffer_store_dwordx4 v[92:95], v25, s[16:19], s66 offen sc1
    v_mfma_f32_16x16x32_bf16 v[208:211], a[24:27], a[176:179], v[208:211]
    s_mov_b32 s66, 458752
    v_add_f32 v240, v240, v88
    v_mul_f32 v240, v240, v96
    v_mfma_f32_16x16x32_bf16 v[208:211], a[28:31], a[180:183], v[208:211]
    v_add_f32 v241, v241, v89
    v_mul_f32 v241, v241, v97
    v_mfma_f32_16x16x32_bf16 v[244:247], a[248:251], a[58:61], v[244:247]
    s_waitcnt lgkmcnt(1)
    ds_read_b128 a[196:199], v41 offset:45056
    v_mfma_f32_16x16x32_bf16 v[244:247], a[252:255], a[130:133], v[244:247]
    buffer_store_dwordx4 v[48:51], v25, s[16:19], s67 offen sc1
    v_mfma_f32_16x16x32_bf16 v[244:247], a[144:147], a[186:189], v[244:247]
    s_mov_b32 s67, 473088
    v_cvt_pk_bf16_f32 v88, v240, v241
    v_mul_f32 v178, v178, v106
    v_mfma_f32_16x16x32_bf16 v[244:247], a[148:151], a[226:229], v[244:247]
    ds_write_b32 v28, v88 offset:22272
    v_cvt_pk_bf16_f32 v55, v146, v178
    v_mfma_f32_16x16x32_bf16 v[148:151], a[216:219], a[56:59], v[148:151]
    v_mul_f32 v179, v179, v107
    v_mul_f32 v208, v208, v108
    v_mfma_f32_16x16x32_bf16 v[148:151], a[220:223], a[60:63], v[148:151]
    v_mul_f32 v209, v209, v109
    v_mul_f32 v210, v210, v110
    v_mfma_f32_16x16x32_bf16 v[148:151], a[8:11], a[128:131], v[148:151]
    ds_read_b128 a[48:51], v40 offset:61440
    v_mul_f32 v211, v211, v111
    v_mfma_f32_16x16x32_bf16 v[148:151], a[12:15], a[132:135], v[148:151]
    v_cvt_pk_bf16_f32 v53, v208, v145
    v_cvt_pk_bf16_f32 v54, v177, v209
    v_mfma_f32_16x16x32_bf16 v[148:151], a[168:171], a[184:187], v[148:151]
    ds_write_b64 v26, v[52:53] offset:22272
    v_cvt_pk_bf16_f32 v68, v210, v147
    v_mfma_f32_16x16x32_bf16 v[148:151], a[172:175], a[188:191], v[148:151]
    ds_read_b128 a[52:55], v41 offset:61440
    v_cvt_pk_bf16_f32 v69, v179, v211
    v_mfma_f32_16x16x32_bf16 v[148:151], a[40:43], a[224:227], v[148:151]
    ds_write_b64 v26, v[54:55] offset:22280
    v_mfma_f32_16x16x32_bf16 v[148:151], a[44:47], a[228:231], v[148:151]
    ds_write_b64 v26, v[68:69] offset:22288
    v_mfma_f32_16x16x32_bf16 v[180:183], a[96:99], a[56:59], v[180:183]
    ds_write_b64 v29, v[246:247] offset:4096
    v_mfma_f32_16x16x32_bf16 v[180:183], a[100:103], a[60:63], v[180:183]
    ds_read_b128 a[72:75], v42 offset:12288
    v_mfma_f32_16x16x32_bf16 v[180:183], a[0:3], a[128:131], v[180:183]
    ds_read_b128 a[76:79], v43 offset:12288
    v_mfma_f32_16x16x32_bf16 v[180:183], a[4:7], a[132:135], v[180:183]
    ds_read_b128 a[32:35], v42 offset:28672
    v_mul_f32 v148, v148, v100
    v_mfma_f32_16x16x32_bf16 v[180:183], a[152:155], a[184:187], v[180:183]
    v_mul_f32 v149, v149, v101
    v_mul_f32 v150, v150, v102
    v_mfma_f32_16x16x32_bf16 v[180:183], a[156:159], a[188:191], v[180:183]
    s_waitcnt lgkmcnt(3)
    s_barrier
    v_mfma_f32_16x16x32_bf16 v[180:183], a[208:211], a[224:227], v[180:183]
    ds_read_b128 v[76:79], v24 offset:22272
    ds_read_b64 v[72:73], v30 offset:4096
    v_mfma_f32_16x16x32_bf16 v[180:183], a[212:215], a[228:231], v[180:183]
    ds_read_b128 a[36:39], v43 offset:28672
    v_mul_f32 v151, v151, v103
    v_mfma_f32_16x16x32_bf16 v[212:215], a[160:163], a[56:59], v[212:215]
    ds_read_b128 v[80:83], v24 offset:23200
    v_mfma_f32_16x16x32_bf16 v[212:215], a[164:167], a[60:63], v[212:215]
    v_mfma_f32_16x16x32_bf16 v[212:215], a[120:123], a[128:131], v[212:215]
    ds_read_b128 a[80:83], v40 offset:14336
    v_mfma_f32_16x16x32_bf16 v[212:215], a[124:127], a[132:135], v[212:215]
    v_mul_f32 v180, v180, v104
    v_cvt_pk_bf16_f32 v64, v148, v180
    v_mfma_f32_16x16x32_bf16 v[212:215], a[16:19], a[184:187], v[212:215]
    s_waitcnt lgkmcnt(3)
    v_mul_f32 v181, v181, v105
    v_mfma_f32_16x16x32_bf16 v[212:215], a[20:23], a[188:191], v[212:215]
    buffer_store_dwordx4 v[76:79], v25, s[16:19], s66 offen sc1
    v_mfma_f32_16x16x32_bf16 v[212:215], a[24:27], a[224:227], v[212:215]
    s_mov_b32 s66, 573440
    v_add_f32 v244, v244, v72
    v_mul_f32 v244, v244, v96
    v_mfma_f32_16x16x32_bf16 v[212:215], a[28:31], a[228:231], v[212:215]
    v_add_f32 v245, v245, v73
    v_mul_f32 v245, v245, v97
    v_mfma_f32_16x16x32_bf16 v[248:251], a[248:251], a[194:197], v[248:251]
    s_waitcnt lgkmcnt(1)
    ds_read_b128 a[84:87], v41 offset:14336
    v_mfma_f32_16x16x32_bf16 v[248:251], a[252:255], a[50:53], v[248:251]
    buffer_store_dwordx4 v[80:83], v25, s[16:19], s67 offen sc1
    v_mfma_f32_16x16x32_bf16 v[248:251], a[144:147], a[74:77], v[248:251]
    s_mov_b32 s67, 587776
    v_cvt_pk_bf16_f32 v72, v244, v245
    v_mul_f32 v182, v182, v106
    v_mfma_f32_16x16x32_bf16 v[248:251], a[148:151], a[34:37], v[248:251]
    ds_write_b32 v28, v72 offset:29696
    v_cvt_pk_bf16_f32 v67, v150, v182
    v_mfma_f32_16x16x32_bf16 v[152:155], a[216:219], a[192:195], v[152:155]
    v_mul_f32 v183, v183, v107
    v_mul_f32 v212, v212, v108
    v_mfma_f32_16x16x32_bf16 v[152:155], a[220:223], a[196:199], v[152:155]
    v_mul_f32 v213, v213, v109
    v_mul_f32 v214, v214, v110
    v_mfma_f32_16x16x32_bf16 v[152:155], a[8:11], a[48:51], v[152:155]
    ds_read_b128 a[240:243], v40 offset:30720
    v_mul_f32 v215, v215, v111
    v_mfma_f32_16x16x32_bf16 v[152:155], a[12:15], a[52:55], v[152:155]
    v_cvt_pk_bf16_f32 v65, v212, v149
    v_cvt_pk_bf16_f32 v66, v181, v213
    v_mfma_f32_16x16x32_bf16 v[152:155], a[168:171], a[72:75], v[152:155]
    ds_write_b64 v26, v[64:65] offset:29696
    v_cvt_pk_bf16_f32 v84, v214, v151
    v_mfma_f32_16x16x32_bf16 v[152:155], a[172:175], a[76:79], v[152:155]
    ds_read_b128 a[244:247], v41 offset:30720
    v_cvt_pk_bf16_f32 v85, v183, v215
    v_mfma_f32_16x16x32_bf16 v[152:155], a[40:43], a[32:35], v[152:155]
    ds_write_b64 v26, v[66:67] offset:29704
    v_mfma_f32_16x16x32_bf16 v[152:155], a[44:47], a[36:39], v[152:155]
    ds_write_b64 v26, v[84:85] offset:29712
    v_mfma_f32_16x16x32_bf16 v[184:187], a[96:99], a[192:195], v[184:187]
    ds_write_b64 v29, v[250:251] offset:6144
    v_mfma_f32_16x16x32_bf16 v[184:187], a[100:103], a[196:199], v[184:187]
    ds_read_b128 a[176:179], v40 offset:47104
    v_mfma_f32_16x16x32_bf16 v[184:187], a[0:3], a[48:51], v[184:187]
    ds_read_b128 a[180:183], v41 offset:47104
    v_mfma_f32_16x16x32_bf16 v[184:187], a[4:7], a[52:55], v[184:187]
    ds_read_b128 a[56:59], v40 offset:63488
    v_mul_f32 v152, v152, v100
    v_mfma_f32_16x16x32_bf16 v[184:187], a[152:155], a[72:75], v[184:187]
    v_mul_f32 v153, v153, v101
    v_mul_f32 v154, v154, v102
    v_mfma_f32_16x16x32_bf16 v[184:187], a[156:159], a[76:79], v[184:187]
    s_waitcnt lgkmcnt(3)
    s_barrier
    v_mfma_f32_16x16x32_bf16 v[184:187], a[208:211], a[32:35], v[184:187]
    ds_read_b128 v[120:123], v24 offset:29696
    ds_read_b64 v[116:117], v30 offset:6144
    v_mfma_f32_16x16x32_bf16 v[184:187], a[212:215], a[36:39], v[184:187]
    ds_read_b128 a[60:63], v41 offset:63488
    v_mul_f32 v155, v155, v103
    v_mfma_f32_16x16x32_bf16 v[216:219], a[160:163], a[192:195], v[216:219]
    ds_read_b128 a[128:131], v42 offset:14336
    v_mfma_f32_16x16x32_bf16 v[216:219], a[164:167], a[196:199], v[216:219]
    ds_read_b128 a[132:135], v43 offset:14336
    v_mfma_f32_16x16x32_bf16 v[216:219], a[120:123], a[48:51], v[216:219]
    ds_read_b128 a[184:187], v42 offset:30720
    v_mfma_f32_16x16x32_bf16 v[216:219], a[124:127], a[52:55], v[216:219]
    v_mul_f32 v184, v184, v104
    v_cvt_pk_bf16_f32 v112, v152, v184
    v_mfma_f32_16x16x32_bf16 v[216:219], a[16:19], a[72:75], v[216:219]
    s_waitcnt lgkmcnt(4)
    ds_read_b128 a[188:191], v43 offset:30720
    v_mfma_f32_16x16x32_bf16 v[216:219], a[20:23], a[76:79], v[216:219]
    buffer_store_dwordx4 v[120:123], v25, s[16:19], s66 offen sc1
    v_mfma_f32_16x16x32_bf16 v[216:219], a[24:27], a[32:35], v[216:219]
    s_mov_b32 s66, 688128
    ds_read_b128 v[124:127], v24 offset:30624
    v_add_f32 v248, v248, v116
    v_mfma_f32_16x16x32_bf16 v[216:219], a[28:31], a[36:39], v[216:219]
    v_mul_f32 v248, v248, v96
    v_add_f32 v249, v249, v117
    v_mfma_f32_16x16x32_bf16 v[252:255], a[88:91], a[82:85], v[252:255]
    v_mul_f32 v249, v249, v97
    v_cvt_pk_bf16_f32 v116, v248, v249
    v_mfma_f32_16x16x32_bf16 v[252:255], a[92:95], a[242:245], v[252:255]
    ds_write_b32 v28, v116 offset:37120
    v_mul_f32 v185, v185, v105
    v_mfma_f32_16x16x32_bf16 v[252:255], a[248:251], a[178:181], v[252:255]
    s_waitcnt lgkmcnt(4)
    v_mul_f32 v186, v186, v106
    v_cvt_pk_bf16_f32 v115, v154, v186
    v_mfma_f32_16x16x32_bf16 v[252:255], a[252:255], a[58:61], v[252:255]
    v_mul_f32 v187, v187, v107
    v_mul_f32 v216, v216, v108
    v_mfma_f32_16x16x32_bf16 v[252:255], a[144:147], a[130:133], v[252:255]
    s_waitcnt lgkmcnt(1)
    v_mul_f32 v217, v217, v109
    v_mfma_f32_16x16x32_bf16 v[252:255], a[148:151], a[186:189], v[252:255]
    buffer_store_dwordx4 v[124:127], v25, s[16:19], s67 offen sc1
    v_mfma_f32_16x16x32_bf16 v[156:159], a[136:139], a[80:83], v[156:159]
    s_mov_b32 s67, 702464
    v_mul_f32 v218, v218, v110
    v_mul_f32 v219, v219, v111
    v_mfma_f32_16x16x32_bf16 v[156:159], a[140:143], a[84:87], v[156:159]
    v_cvt_pk_bf16_f32 v113, v216, v153
    v_cvt_pk_bf16_f32 v114, v185, v217
    v_mfma_f32_16x16x32_bf16 v[156:159], a[64:67], a[240:243], v[156:159]
    ds_write_b64 v26, v[112:113] offset:37120
    v_cvt_pk_bf16_f32 v92, v218, v155
    v_mfma_f32_16x16x32_bf16 v[156:159], a[68:71], a[244:247], v[156:159]
    ds_write_b64 v26, v[114:115] offset:37128
    v_cvt_pk_bf16_f32 v93, v187, v219
    v_mfma_f32_16x16x32_bf16 v[156:159], a[216:219], a[176:179], v[156:159]
    ds_write_b64 v26, v[92:93] offset:37136
    v_mfma_f32_16x16x32_bf16 v[156:159], a[220:223], a[180:183], v[156:159]
    ds_write_b64 v29, v[254:255] offset:8192
    v_mfma_f32_16x16x32_bf16 v[156:159], a[8:11], a[56:59], v[156:159]
    v_mfma_f32_16x16x32_bf16 v[156:159], a[12:15], a[60:63], v[156:159]
    v_mfma_f32_16x16x32_bf16 v[156:159], a[168:171], a[128:131], v[156:159]
    v_mfma_f32_16x16x32_bf16 v[156:159], a[172:175], a[132:135], v[156:159]
    v_mfma_f32_16x16x32_bf16 v[156:159], a[40:43], a[184:187], v[156:159]
    s_waitcnt lgkmcnt(0)
    s_barrier
    v_mfma_f32_16x16x32_bf16 v[156:159], a[44:47], a[188:191], v[156:159]
    ds_read_b128 v[48:51], v24 offset:37120
    ds_read_b64 v[88:89], v30 offset:8192
    v_mfma_f32_16x16x32_bf16 v[188:191], a[104:107], a[80:83], v[188:191]
    ds_read_b128 v[52:55], v24 offset:38048
    v_mfma_f32_16x16x32_bf16 v[188:191], a[108:111], a[84:87], v[188:191]
    v_mfma_f32_16x16x32_bf16 v[188:191], a[200:203], a[240:243], v[188:191]
    s_waitcnt vmcnt(12)
    v_xor_b32 v8, 15, v8
    v_or_b32 v8, v8, v0
    v_mfma_f32_16x16x32_bf16 v[188:191], a[204:207], a[244:247], v[188:191]
    v_mul_f32 v156, v156, v100
    v_mul_f32 v157, v157, v101
    v_mfma_f32_16x16x32_bf16 v[188:191], a[96:99], a[176:179], v[188:191]
    v_mul_f32 v158, v158, v102
    v_mul_f32 v159, v159, v103
    v_mfma_f32_16x16x32_bf16 v[188:191], a[100:103], a[180:183], v[188:191]
    s_waitcnt lgkmcnt(1)
    v_min_u32 v8, 1, v8
    v_mfma_f32_16x16x32_bf16 v[188:191], a[0:3], a[56:59], v[188:191]
    buffer_store_dwordx4 v[48:51], v25, s[16:19], s66 offen sc1
    v_mfma_f32_16x16x32_bf16 v[188:191], a[4:7], a[60:63], v[188:191]
    s_mov_b32 s66, 802816
    v_add_f32 v252, v252, v88
    v_mul_f32 v252, v252, v96
    v_mfma_f32_16x16x32_bf16 v[188:191], a[152:155], a[128:131], v[188:191]
    v_add_f32 v253, v253, v89
    v_mul_f32 v253, v253, v97
    v_mfma_f32_16x16x32_bf16 v[188:191], a[156:159], a[132:135], v[188:191]
    s_waitcnt lgkmcnt(0)
    v_cvt_pk_bf16_f32 v88, v252, v253
    v_mfma_f32_16x16x32_bf16 v[188:191], a[208:211], a[184:187], v[188:191]
    buffer_store_dwordx4 v[52:55], v25, s[16:19], s67 offen sc1
    v_mfma_f32_16x16x32_bf16 v[188:191], a[212:215], a[188:191], v[188:191]
    s_mov_b32 s67, 817152
    ds_write_b32 v28, v88 offset:44544
    v_lshlrev_b32 v8, 30, v8
    v_mfma_f32_16x16x32_bf16 v[220:223], a[112:115], a[80:83], v[220:223]
    v_mov_b32 v9, s76
    v_mfma_f32_16x16x32_bf16 v[220:223], a[116:119], a[84:87], v[220:223]
    v_mfma_f32_16x16x32_bf16 v[220:223], a[232:235], a[240:243], v[220:223]
    buffer_store_dword v9, v8, s[12:15], s78 offen sc1
    v_mfma_f32_16x16x32_bf16 v[220:223], a[236:239], a[244:247], v[220:223]
    v_mul_f32 v188, v188, v104
    v_cvt_pk_bf16_f32 v68, v156, v188
    v_mfma_f32_16x16x32_bf16 v[220:223], a[160:163], a[176:179], v[220:223]
    v_mul_f32 v189, v189, v105
    v_mul_f32 v190, v190, v106
    v_mfma_f32_16x16x32_bf16 v[220:223], a[164:167], a[180:183], v[220:223]
    v_cvt_pk_bf16_f32 v71, v158, v190
    v_mul_f32 v191, v191, v107
    v_mfma_f32_16x16x32_bf16 v[220:223], a[120:123], a[56:59], v[220:223]
    v_mfma_f32_16x16x32_bf16 v[220:223], a[124:127], a[60:63], v[220:223]
    v_mfma_f32_16x16x32_bf16 v[220:223], a[16:19], a[128:131], v[220:223]
    v_mfma_f32_16x16x32_bf16 v[220:223], a[20:23], a[132:135], v[220:223]
    v_mfma_f32_16x16x32_bf16 v[220:223], a[24:27], a[184:187], v[220:223]
    v_mfma_f32_16x16x32_bf16 v[220:223], a[28:31], a[188:191], v[220:223]
    s_nop 7
    v_mul_f32 v220, v220, v108
    v_mul_f32 v221, v221, v109
    v_mul_f32 v222, v222, v110
    v_mul_f32 v223, v223, v111
    v_cvt_pk_bf16_f32 v69, v220, v157
    v_cvt_pk_bf16_f32 v70, v189, v221
    v_cvt_pk_bf16_f32 v76, v222, v159
    v_cvt_pk_bf16_f32 v77, v191, v223
    ds_write_b64 v26, v[68:69] offset:44544
    ds_write_b64 v26, v[70:71] offset:44552
    ds_write_b64 v26, v[76:77] offset:44560
    s_waitcnt lgkmcnt(0)
    s_barrier
    ds_read_b128 v[80:83], v24 offset:44544
    ds_read_b128 v[72:75], v24 offset:45472
    s_waitcnt lgkmcnt(1)
    buffer_store_dwordx4 v[80:83], v25, s[16:19], s66 offen sc1
    s_waitcnt lgkmcnt(0)
    buffer_store_dwordx4 v[72:75], v25, s[16:19], s67 offen sc1
L_end:
    s_endpgm
L_slow0_1:
    s_mov_b32 s22, 0
    s_call_b64 s[20:21], L_tick
    buffer_load_dwordx4 v[72:75], v34, s[12:15], 0 offen sc1
    buffer_load_dwordx4 v[76:79], v44, s[12:15], 0 offen sc1
    s_waitcnt vmcnt(0)
    v_bitop3_b32 v12, v75, v79, s76 bitop3:0x7e
    v_cmp_lt_u32 vcc, 0xffff, v12
    s_cbranch_vccnz L_slow0_1
    s_branch L_back0_1
L_slow1_0:
    s_mov_b32 s22, 1
    s_call_b64 s[20:21], L_tick
    buffer_load_dwordx4 v[80:83], v32, s[12:15], s40 offen sc1
    buffer_load_dwordx4 v[84:87], v33, s[12:15], s40 offen sc1
    s_waitcnt vmcnt(0)
    v_bitop3_b32 v12, v83, v87, s76 bitop3:0x7e
    v_cmp_lt_u32 vcc, 0xffff, v12
    s_cbranch_vccnz L_slow1_0
    s_branch L_back1_0
L_slow1_1:
    s_mov_b32 s22, 1
    s_call_b64 s[20:21], L_tick
    buffer_load_dwordx4 v[88:91], v34, s[12:15], s40 offen sc1
    buffer_load_dwordx4 v[92:95], v44, s[12:15], s40 offen sc1
    s_waitcnt vmcnt(0)
    v_bitop3_b32 v12, v91, v95, s76 bitop3:0x7e
    v_cmp_lt_u32 vcc, 0xffff, v12
    s_cbranch_vccnz L_slow1_1
    s_branch L_back1_1
L_slow2_0:
    s_mov_b32 s22, 2
    s_call_b64 s[20:21], L_tick
    buffer_load_dwordx4 v[48:51], v32, s[12:15], s41 offen sc1
    buffer_load_dwordx4 v[52:55], v33, s[12:15], s41 offen sc1
    s_waitcnt vmcnt(0)
    v_bitop3_b32 v12, v51, v55, s76 bitop3:0x7e
    v_cmp_lt_u32 vcc, 0xffff, v12
    s_cbranch_vccnz L_slow2_0
    s_branch L_back2_0
L_slow2_1:
    s_mov_b32 s22, 2
    s_call_b64 s[20:21], L_tick
    buffer_load_dwordx4 v[64:67], v34, s[12:15], s41 offen sc1
    buffer_load_dwordx4 v[68:71], v44, s[12:15], s41 offen sc1
    s_waitcnt vmcnt(0)
    v_bitop3_b32 v12, v67, v71, s76 bitop3:0x7e
    v_cmp_lt_u32 vcc, 0xffff, v12
    s_cbranch_vccnz L_slow2_1
    s_branch L_back2_1
L_slow3_0:
    s_mov_b32 s22, 3
    s_call_b64 s[20:21], L_tick
    buffer_load_dwordx4 v[72:75], v32, s[12:15], s42 offen sc1
    buffer_load_dwordx4 v[76:79], v33, s[12:15], s42 offen sc1
    s_waitcnt vmcnt(0)
    v_bitop3_b32 v12, v75, v79, s76 bitop3:0x7e
    v_cmp_lt_u32 vcc, 0xffff, v12
    s_cbranch_vccnz L_slow3_0
    s_branch L_back3_0
L_slow3_1:
    s_mov_b32 s22, 3
    s_call_b64 s[20:21], L_tick
    buffer_load_dwordx4 v[80:83], v34, s[12:15], s42 offen sc1
    buffer_load_dwordx4 v[84:87], v44, s[12:15], s42 offen sc1
    s_waitcnt vmcnt(0)
    v_bitop3_b32 v12, v83, v87, s76 bitop3:0x7e
    v_cmp_lt_u32 vcc, 0xffff, v12
    s_cbranch_vccnz L_slow3_1
    s_branch L_back3_1
L_slow4_0:
    s_mov_b32 s22, 4
    s_call_b64 s[20:21], L_tick
    buffer_load_dwordx4 v[96:99], v32, s[12:15], s43 offen sc1
    buffer_load_dwordx4 v[100:103], v33, s[12:15], s43 offen sc1
    s_waitcnt vmcnt(0)
    v_bitop3_b32 v12, v99, v103, s76 bitop3:0x7e
    v_cmp_lt_u32 vcc, 0xffff, v12
    s_cbranch_vccnz L_slow4_0
    s_branch L_back4_0
L_slow4_1:
    s_mov_b32 s22, 4
    s_call_b64 s[20:21], L_tick
    buffer_load_dwordx4 v[104:107], v34, s[12:15], s43 offen sc1
    buffer_load_dwordx4 v[108:111], v44, s[12:15], s43 offen sc1
    s_waitcnt vmcnt(0)
    v_bitop3_b32 v12, v107, v111, s76 bitop3:0x7e
    v_cmp_lt_u32 vcc, 0xffff, v12
    s_cbranch_vccnz L_slow4_1
    s_branch L_back4_1
L_slow5_0:
    s_mov_b32 s22, 5
    s_call_b64 s[20:21], L_tick
    buffer_load_dwordx4 v[112:115], v32, s[12:15], s44 offen sc1
    buffer_load_dwordx4 v[116:119], v33, s[12:15], s44 offen sc1
    s_waitcnt vmcnt(0)
    v_bitop3_b32 v12, v115, v119, s76 bitop3:0x7e
    v_cmp_lt_u32 vcc, 0xffff, v12
    s_cbranch_vccnz L_slow5_0
    s_branch L_back5_0
L_slow5_1:
    s_mov_b32 s22, 5
    s_call_b64 s[20:21], L_tick
    buffer_load_dwordx4 v[120:123], v34, s[12:15], s44 offen sc1
    buffer_load_dwordx4 v[124:127], v44, s[12:15], s44 offen sc1
    s_waitcnt vmcnt(0)
    v_bitop3_b32 v12, v123, v127, s76 bitop3:0x7e
    v_cmp_lt_u32 vcc, 0xffff, v12
    s_cbranch_vccnz L_slow5_1
    s_branch L_back5_1
L_slow6_0:
    s_mov_b32 s22, 6
    s_call_b64 s[20:21], L_tick
    buffer_load_dwordx4 v[88:91], v32, s[12:15], s45 offen sc1
    buffer_load_dwordx4 v[92:95], v33, s[12:15], s45 offen sc1
    s_waitcnt vmcnt(0)
    v_bitop3_b32 v12, v91, v95, s76 bitop3:0x7e
    v_cmp_lt_u32 vcc, 0xffff, v12
    s_cbranch_vccnz L_slow6_0
    s_branch L_back6_0
L_slow6_1:
    s_mov_b32 s22, 6
    s_call_b64 s[20:21], L_tick
    buffer_load_dwordx4 v[48:51], v34, s[12:15], s45 offen sc1
    buffer_load_dwordx4 v[52:55], v44, s[12:15], s45 offen sc1
    s_waitcnt vmcnt(0)
    v_bitop3_b32 v12, v51, v55, s76 bitop3:0x7e
    v_cmp_lt_u32 vcc, 0xffff, v12
    s_cbranch_vccnz L_slow6_1
    s_branch L_back6_1
L_slow7_0:
    s_mov_b32 s22, 7
    s_call_b64 s[20:21], L_tick
    buffer_load_dwordx4 v[68:71], v32, s[12:15], s72 offen sc1
    buffer_load_dwordx4 v[72:75], v33, s[12:15], s72 offen sc1
    s_waitcnt vmcnt(0)
    v_bitop3_b32 v12, v71, v75, s76 bitop3:0x7e
    v_cmp_lt_u32 vcc, 0xffff, v12
    s_cbranch_vccnz L_slow7_0
    s_branch L_back7_0
L_slow7_1:
    s_mov_b32 s22, 7
    s_call_b64 s[20:21], L_tick
    buffer_load_dwordx4 v[76:79], v34, s[12:15], s72 offen sc1
    buffer_load_dwordx4 v[80:83], v44, s[12:15], s72 offen sc1
    s_waitcnt vmcnt(0)
    v_bitop3_b32 v12, v79, v83, s76 bitop3:0x7e
    v_cmp_lt_u32 vcc, 0xffff, v12
    s_cbranch_vccnz L_slow7_1
    s_branch L_back7_1
L_tick:
    s_add_u32 s52, s52, 1
    s_and_b32 s23, s52, 4095
    s_cbranch_scc1 L_tick_ret
L_help:
    s_mov_b32 s53, s61
    s_mov_b32 s54, s62
    s_mul_i32 s61, s22, 1835008
    s_add_u32 s61, s61, s79
    s_lshl_b32 s62, s22, 14
    s_add_u32 s62, s62, s68
    s_mov_b32 s22, 0
L_help_row:
    v_mov_b32 v21, v19
    s_xor_b32 s23, s22, s58
    s_bitcmp0_b32 s23, 2
    s_cbranch_scc1 L_help_same
    v_add_u32 v12, 57344, v19
    v_subrev_u32 v13, 57344, v19
    v_min_u32 v21, v12, v13
L_help_same:
    v_mov_b32 v8, 0
    v_mov_b32 v9, 0
    v_mov_b32 v10, 0
    v_mov_b32 v11, s47
    s_mov_b32 s23, 0
L_help_e:
    v_mov_b32 v15, 0
    buffer_load_dwordx3 v[12:14], v18, s[4:7], s61 offen nt
    s_cmp_ge_u32 s23, 16
    s_cbranch_scc1 L_help_own
    buffer_load_dword v15, v21, s[4:7], s61 offen nt
L_help_own:
    s_waitcnt vmcnt(0)
    v_lshl_or_b32 v8, v12, s23, v8
    v_lshl_or_b32 v9, v13, s23, v9
    v_lshl_or_b32 v10, v14, s23, v10
    v_lshl_or_b32 v11, v15, s23, v11
    s_add_u32 s61, s61, 14336
    s_add_u32 s23, s23, 4
    s_cmp_lt_u32 s23, 32
    s_cbranch_scc1 L_help_e
    buffer_store_dwordx4 v[8:11], v20, s[12:15], s62 offen sc1
    s_add_u32 s62, s62, 1024
    s_waitcnt vmcnt(0)
    s_add_u32 s22, s22, 1
    s_cmp_lt_u32 s22, 16
    s_cbranch_scc1 L_help_row
    s_mov_b32 s61, s53
    s_mov_b32 s62, s54
L_tick_ret:
    s_setpc_b64 s[20:21]
L_code_end:

.section .rodata,"a"
.p2align 6
.amdhsa_kernel standalone__normalfloat_lut_af4__prompt_kernel
  .amdhsa_next_free_vgpr 512
  .amdhsa_next_free_sgpr 102
  .amdhsa_accum_offset 256
  .amdhsa_group_segment_fixed_size 0
  .amdhsa_kernarg_size 56
  .amdhsa_user_sgpr_count 2
  .amdhsa_user_sgpr_kernarg_segment_ptr 1
  .amdhsa_system_sgpr_workgroup_id_x 1
.end_amdhsa_kernel
```

```asm
; @launch grid=(256,1,1) block=(256,1,1) lds=163840
.amdgcn_target "amdgcn-amd-amdhsa--gfx950"
.text
.globl standalone__normalfloat_lut_af4__prompt_kernel
.p2align 8
.type standalone__normalfloat_lut_af4__prompt_kernel,@function
standalone__normalfloat_lut_af4__prompt_kernel:
    s_cmp_ge_u32 s2, 256
    s_cbranch_scc1 L_end
    s_load_dwordx2 s[4:5], s[0:1], 8
    s_load_dwordx2 s[12:13], s[0:1], 48
    s_load_dwordx2 s[8:9], s[0:1], 0
    s_load_dwordx2 s[28:29], s[0:1], 16
    s_getpc_b64 s[48:49]
    s_mov_b32 s50, L_code_end-standalone__normalfloat_lut_af4__prompt_kernel-256
    s_mov_b32 s51, 0x20000
    s_lshr_b32 s61, s2, 3
    v_lshl_add_u32 v46, v0, 5, s61
    v_lshlrev_b32 v46, 7, v46
    buffer_load_dword v1, v46, s[48:51], 0 offen offset:256
    v_lshrrev_b32 v5, 6, v0
    v_and_b32 v2, 63, v0
    s_and_b32 s60, s2, 7
    v_readfirstlane_b32 s63, v5
    s_and_b32 s58, s60, 1
    s_lshl_b32 s58, s58, 3
    s_and_b32 s62, s61, 7
    s_add_u32 s58, s58, s62
    s_lshr_b32 s59, s60, 1
    s_lshl_b32 s59, s59, 2
    s_lshr_b32 s62, s61, 3
    s_add_u32 s59, s59, s62
    v_mul_u32_u24 v18, 12, v2
    s_lshl_b32 s60, s63, 4
    s_add_u32 s60, s60, s58
    s_mul_i32 s61, s60, 114688
    s_mul_i32 s79, s59, 896
    s_add_u32 s61, s61, s79
    s_mov_b32 s6, 14680064
    s_mov_b32 s7, 0x20000
    s_lshl_b32 s78, s59, 7
    s_add_u32 s78, s78, 2097164
    v_and_b32 v4, 15, v2
    v_lshrrev_b32 v3, 4, v2
    v_and_b32 v12, 1, v3
    v_lshlrev_b32 v13, 1, v12
    v_xor_b32 v13, v13, v4
    v_lshrrev_b32 v19, 1, v3
    v_lshl_add_u32 v19, v19, 4, v13
    s_bfe_u32 s70, s58, 0x10002
    s_xor_b32 s70, s70, 1
    v_xor_b32 v12, s70, v12
    v_mul_u32_u24 v12, 14336, v12
    v_add_lshl_u32 v19, v19, v12, 2
    v_add_u32 v19, 768, v19
    s_mov_b32 s46, 2
    s_cmp_lg_u32 s63, 0
    s_cbranch_scc1 L_role0
    s_mov_b32 s46, 0
L_role0:
    s_cmp_lg_u32 s63, 1
    s_cbranch_scc1 L_role1
    s_mov_b32 s46, 1
L_role1:
    v_lshlrev_b32 v16, 1, v4
    v_lshrrev_b32 v17, 4, v0
    v_lshlrev_b32 v17, 1, v17
    s_mov_b32 s30, 32
    s_mov_b32 s31, 0x20000
    v_lshrrev_b32 v6, 3, v2
    v_and_b32 v7, 7, v2
    v_xor_b32 v13, v7, v3
    s_lshl_b32 s70, s63, 5
    v_add_lshl_u32 v12, v6, s70, 11
    v_lshl_add_u32 v36, v13, 4, v12
    v_xor_b32 v37, 64, v36
    v_add_u32 v37, 15360, v37
    v_add_u32 v38, 30720, v36
    v_add_u32 v39, 30720, v37
    s_mov_b32 s10, 4194304
    s_mov_b32 s11, 0x20000
    s_lshl_b32 s55, s58, 18
    s_and_b32 s71, s58, 8
    s_lshl_b32 s70, s71, 4
    s_add_u32 s55, s55, s70
    s_lshl_b32 s57, s63, 12
    s_xor_b32 s69, s55, 128
    s_add_u32 s57, s57, 65536
    s_mov_b32 s14, 2099200
    s_mov_b32 s15, 0x20000
    s_lshl_b32 s68, s59, 17
    s_lshl_b32 s62, s60, 10
    s_add_u32 s62, s62, s68
    v_lshlrev_b32 v20, 4, v2
    s_waitcnt lgkmcnt(0)
    s_load_dword s76, s[12:13], s78
    s_cmp_eq_u32 s46, 1
    s_cbranch_scc1 L_L
    s_cmp_eq_u32 s46, 2
    s_cbranch_scc1 L_L
L_X:
    buffer_load_dwordx3 v[128:130], v18, s[4:7], s61 offen nt
    buffer_load_dword v131, v19, s[4:7], s61 offen nt
    s_add_u32 s61, s61, 14336
    buffer_load_dwordx3 v[132:134], v18, s[4:7], s61 offen nt
    buffer_load_dword v135, v19, s[4:7], s61 offen nt
    s_add_u32 s61, s61, 14336
    buffer_load_dwordx3 v[136:138], v18, s[4:7], s61 offen nt
    buffer_load_dword v139, v19, s[4:7], s61 offen nt
    s_add_u32 s61, s61, 14336
    buffer_load_dwordx3 v[140:142], v18, s[4:7], s61 offen nt
    buffer_load_dword v143, v19, s[4:7], s61 offen nt
    s_add_u32 s61, s61, 14336
    buffer_load_dwordx3 v[144:146], v18, s[4:7], s61 offen nt
    s_add_u32 s61, s61, 14336
    buffer_load_dwordx3 v[148:150], v18, s[4:7], s61 offen nt
    s_add_u32 s61, s61, 14336
    buffer_load_dwordx3 v[152:154], v18, s[4:7], s61 offen nt
    s_add_u32 s61, s61, 14336
    buffer_load_dwordx3 v[156:158], v18, s[4:7], s61 offen nt
    s_add_u32 s61, s61, 7239680
    s_cmp_eq_u32 s46, 1
    s_cbranch_scc1 L_D
    s_cmp_eq_u32 s46, 2
    s_cbranch_scc1 L_B
L_L:
    buffer_load_ushort v16, v16, s[28:31], 0 offen
    buffer_load_ushort v17, v17, s[28:31], 0 offen
    s_cmp_eq_u32 s46, 1
    s_cbranch_scc1 L_S
    s_cmp_eq_u32 s46, 2
    s_cbranch_scc1 L_S
L_D:
    s_add_u32 m0, s57, 32768
    s_add_u32 s56, s55, 0
    buffer_load_dwordx4 v36, s[8:11], s56 offen offset:0  lds
    buffer_load_dwordx4 v37, s[8:11], s56 offen offset:1024  lds
    buffer_load_dwordx4 v38, s[8:11], s56 offen offset:2048  lds
    buffer_load_dwordx4 v39, s[8:11], s56 offen offset:3072  lds
    s_cmp_eq_u32 s46, 1
    s_cbranch_scc1 L_G
    s_cmp_eq_u32 s46, 2
    s_cbranch_scc1 L_G
L_S:
    s_load_dwordx2 s[32:33], s[0:1], 24
    s_load_dwordx2 s[16:17], s[0:1], 32
    s_load_dwordx2 s[24:25], s[0:1], 40
    s_and_b32 s64, s63, 1
    s_lshr_b32 s65, s63, 1
    s_and_b32 s70, s58, 8
    s_lshl_b32 s70, s70, 10
    s_lshl_b32 s71, s64, 12
    s_add_u32 s70, s70, s71
    s_lshl_b32 s71, s63, 8
    s_add_u32 s70, s70, s71
    s_add_u32 s70, s70, s68
    v_lshl_add_u32 v32, v4, 4, s70
    v_lshl_add_u32 v32, v3, 10, v32
    v_xor_b32 v33, 4096, v32
    v_xor_b32 v34, 8192, v32
    v_xor_b32 v44, 12288, v32
    s_mov_b32 s36, 202114048
    s_mov_b32 s37, 202114304
    s_mov_b32 s38, 202114560
    s_mov_b32 s39, 202114816
    v_and_b32 v35, 31, v2
    v_lshlrev_b32 v35, 2, v35
    s_lshl_b32 s70, s64, 6
    s_add_u32 s70, s70, 65536
    v_lshrrev_b32 v12, 1, v4
    v_xor_b32 v12, v12, v3
    v_lshlrev_b32 v12, 4, v12
    v_lshl_add_u32 v12, v4, 7, v12
    v_xor_b32 v40, s70, v12
    v_xor_b32 v41, 64, v40
    v_add_u32 v42, 65536, v40
    v_add_u32 v43, 65536, v41
    s_mov_b32 s52, 0
    v_lshlrev_b32 v8, 4, v7
    v_lshl_add_u32 v8, v0, 8, v8
    v_xor_b32 v9, 16, v8
    v_xor_b32 v10, 32, v8
    v_xor_b32 v11, 48, v8
    v_xor_b32 v12, 64, v8
    v_xor_b32 v13, 80, v8
    v_xor_b32 v14, 96, v8
    v_xor_b32 v15, 112, v8
    s_cmp_eq_u32 s46, 1
    s_cbranch_scc1 L_X
    s_cmp_eq_u32 s46, 2
    s_cbranch_scc1 L_D
L_G:
    s_waitcnt lgkmcnt(0)
    s_add_u32 s76, s76, 2654435769
    s_and_b32 s47, s76, 0xffff0000
    s_cmp_eq_u32 s46, 1
    s_cbranch_scc1 L_T
    s_cmp_eq_u32 s46, 2
    s_cbranch_scc1 L_T
L_K:
    s_waitcnt vmcnt(16)
    v_or_b32 v131, s47, v131
    s_waitcnt vmcnt(15)
    v_lshl_or_b32 v128, v132, 4, v128
    v_lshl_or_b32 v129, v133, 4, v129
    v_lshl_or_b32 v130, v134, 4, v130
    s_waitcnt vmcnt(14)
    v_lshl_or_b32 v131, v135, 4, v131
    s_waitcnt vmcnt(13)
    v_lshl_or_b32 v128, v136, 8, v128
    v_lshl_or_b32 v129, v137, 8, v129
    v_lshl_or_b32 v130, v138, 8, v130
    s_waitcnt vmcnt(12)
    v_lshl_or_b32 v131, v139, 8, v131
    s_waitcnt vmcnt(11)
    v_lshl_or_b32 v128, v140, 12, v128
    v_lshl_or_b32 v129, v141, 12, v129
    v_lshl_or_b32 v130, v142, 12, v130
    s_waitcnt vmcnt(10)
    v_lshl_or_b32 v131, v143, 12, v131
    s_waitcnt vmcnt(9)
    v_lshl_or_b32 v128, v144, 16, v128
    v_lshl_or_b32 v129, v145, 16, v129
    v_lshl_or_b32 v130, v146, 16, v130
    s_waitcnt vmcnt(8)
    v_lshl_or_b32 v128, v148, 20, v128
    v_lshl_or_b32 v129, v149, 20, v129
    v_lshl_or_b32 v130, v150, 20, v130
    s_waitcnt vmcnt(7)
    v_lshl_or_b32 v128, v152, 24, v128
    v_lshl_or_b32 v129, v153, 24, v129
    v_lshl_or_b32 v130, v154, 24, v130
    s_waitcnt vmcnt(6)
    v_lshl_or_b32 v128, v156, 28, v128
    v_lshl_or_b32 v129, v157, 28, v129
    v_lshl_or_b32 v130, v158, 28, v130
    buffer_store_dwordx4 v[128:131], v20, s[12:15], s62 offen sc1
    s_add_u32 s62, s62, 65536
    s_cmp_eq_u32 s46, 1
    s_cbranch_scc1 L_B
    s_cmp_eq_u32 s46, 2
    s_cbranch_scc1 L_E
L_T:
    s_waitcnt vmcnt(16)
    s_cmp_eq_u32 s46, 1
    s_cbranch_scc1 L_rw1
    s_waitcnt vmcnt(5)
    s_cmp_eq_u32 s46, 0
    s_cbranch_scc1 L_rw1
    s_waitcnt vmcnt(4)
L_rw1:
    v_lshl_or_b32 v56, v17, 16, v16
    v_lshl_or_b32 v57, v17, 16, v16
    v_lshl_or_b32 v58, v17, 16, v16
    v_lshl_or_b32 v59, v17, 16, v16
    ds_write_b128 v8, v[56:59]
    ds_write_b128 v9, v[56:59]
    ds_write_b128 v10, v[56:59]
    ds_write_b128 v11, v[56:59]
    ds_write_b128 v12, v[56:59]
    ds_write_b128 v13, v[56:59]
    ds_write_b128 v14, v[56:59]
    ds_write_b128 v15, v[56:59]
    s_cmp_lg_u32 s46, 1
    s_cbranch_scc1 L_ed2
    s_waitcnt vmcnt(4)
    s_branch L_K
L_ed2:
    s_cmp_eq_u32 s46, 2
    s_cbranch_scc1 L_X
L_W:
    s_mov_b64 exec, 0
    s_cmp_eq_u32 s63, 0
    s_cbranch_scc1 L_pad0
L_warmed:
    s_mov_b64 exec, -1
L_B:
    s_waitcnt vmcnt(12) lgkmcnt(0)
    s_cmp_eq_u32 s46, 2
    s_cbranch_scc1 L_rw3
    s_waitcnt vmcnt(1)
L_rw3:
    s_barrier
L_Q:
    ds_read_b128 a[0:3], v40 offset:32768
    ds_read_b128 a[4:7], v41 offset:32768
    ds_read_b128 a[8:11], v40 offset:34816
    ds_read_b128 a[12:15], v41 offset:34816
    ds_read_b128 a[16:19], v40 offset:36864
    ds_read_b128 a[20:23], v41 offset:36864
    ds_read_b128 a[24:27], v40 offset:38912
    ds_read_b128 a[28:31], v41 offset:38912
    ds_read_b128 a[40:43], v40 offset:40960
    ds_read_b128 a[44:47], v41 offset:40960
    ds_read_b128 a[48:51], v40 offset:43008
    ds_read_b128 a[52:55], v41 offset:43008
    ds_read_b128 a[56:59], v40 offset:45056
    ds_read_b128 a[60:63], v41 offset:45056
    ds_read_b128 a[72:75], v40 offset:47104
    ds_read_b128 a[76:79], v41 offset:47104
L_P:
    buffer_load_dwordx4 v[64:67], v32, s[12:15], 0 offen sc1
    buffer_load_dwordx4 v[68:71], v33, s[12:15], 0 offen sc1
L_d:
    s_add_u32 m0, s57, 49152
    s_add_u32 s3, s69, 0
    buffer_load_dwordx4 v36, s[8:11], s3 offen offset:0  lds
    buffer_load_dwordx4 v37, s[8:11], s3 offen offset:1024  lds
    buffer_load_dwordx4 v38, s[8:11], s3 offen offset:2048  lds
    buffer_load_dwordx4 v39, s[8:11], s3 offen offset:3072  lds
    s_cmp_lg_u32 s46, 2
    s_cbranch_scc1 L_ed4
    s_waitcnt vmcnt(6)
    s_branch L_K
L_ed4:
L_E:
L_chk0:
    s_waitcnt vmcnt(5)
    s_cmp_eq_u32 s46, 2
    s_cbranch_scc1 L_rw5
    s_waitcnt vmcnt(4)
L_rw5:
    v_bitop3_b32 v12, v67, v71, s76 bitop3:0x7e
    v_cmp_lt_u32 vcc, 0xffff, v12
    s_cbranch_vccnz L_retry0
    buffer_load_dwordx4 v[72:75], v34, s[12:15], 0 offen sc1
    buffer_load_dwordx4 v[76:79], v44, s[12:15], 0 offen sc1
    v_perm_b32 v56, v64, v35, s36
    v_perm_b32 v57, v64, v35, s37
    v_perm_b32 v58, v64, v35, s38
    v_perm_b32 v59, v64, v35, s39
    v_perm_b32 v60, v68, v35, s36
    v_perm_b32 v61, v68, v35, s37
    v_perm_b32 v62, v68, v35, s38
    v_perm_b32 v63, v68, v35, s39
    ds_read_b32 a32, v56
    ds_read_b32 a33, v57
    ds_read_b32 a34, v58
    ds_read_b32 a35, v59
    ds_read_b32 a36, v60
    ds_read_b32 a37, v61
    ds_read_b32 a38, v62
    ds_read_b32 a39, v63
    v_perm_b32 v56, v65, v35, s36
    v_perm_b32 v57, v65, v35, s37
    v_perm_b32 v58, v65, v35, s38
    v_perm_b32 v59, v65, v35, s39
    v_perm_b32 v60, v69, v35, s36
    v_perm_b32 v61, v69, v35, s37
    ds_read_b32 a64, v56
    ds_read_b32 a65, v57
    ds_read_b32 a66, v58
    ds_read_b32 a67, v59
    s_cbranch_vccz L_main
L_retry0:
    s_add_u32 s52, s52, 1
    s_and_b32 s23, s52, 4095
    s_cbranch_scc1 L_retry0b
    s_mov_b32 s22, 0
    s_call_b64 s[20:21], L_help
L_retry0b:
    buffer_load_dwordx4 v[64:67], v32, s[12:15], 0 offen sc1
    buffer_load_dwordx4 v[68:71], v33, s[12:15], 0 offen sc1
    s_waitcnt vmcnt(0) lgkmcnt(0)
    s_branch L_chk0
L_tick:
    s_add_u32 s52, s52, 1
    s_and_b32 s23, s52, 4095
    s_cbranch_scc0 L_help
    s_setpc_b64 s[20:21]
L_slow0_1:
    s_mov_b32 s22, 0
    s_call_b64 s[20:21], L_tick
    buffer_load_dwordx4 v[72:75], v34, s[12:15], 0 offen sc1
    buffer_load_dwordx4 v[76:79], v44, s[12:15], 0 offen sc1
    s_waitcnt vmcnt(0)
    v_bitop3_b32 v12, v75, v79, s76 bitop3:0x7e
    v_cmp_lt_u32 vcc, 0xffff, v12
    s_cbranch_vccnz L_slow0_1
    s_branch L_back0_1
L_slow4_0:
    s_mov_b32 s22, 4
    s_call_b64 s[20:21], L_tick
    buffer_load_dwordx4 v[96:99], v32, s[12:15], s43 offen sc1
    buffer_load_dwordx4 v[100:103], v33, s[12:15], s43 offen sc1
    s_waitcnt vmcnt(0)
    v_bitop3_b32 v12, v99, v103, s76 bitop3:0x7e
    v_cmp_lt_u32 vcc, 0xffff, v12
    s_cbranch_vccnz L_slow4_0
    s_branch L_back4_0
L_slow4_1:
    s_mov_b32 s22, 4
    s_call_b64 s[20:21], L_tick
    buffer_load_dwordx4 v[104:107], v34, s[12:15], s43 offen sc1
    buffer_load_dwordx4 v[108:111], v44, s[12:15], s43 offen sc1
    s_waitcnt vmcnt(0)
    v_bitop3_b32 v12, v107, v111, s76 bitop3:0x7e
    v_cmp_lt_u32 vcc, 0xffff, v12
    s_cbranch_vccnz L_slow4_1
    s_branch L_back4_1
L_slow1_0:
    s_mov_b32 s22, 1
    s_call_b64 s[20:21], L_tick
    buffer_load_dwordx4 v[80:83], v32, s[12:15], s40 offen sc1
    buffer_load_dwordx4 v[84:87], v33, s[12:15], s40 offen sc1
    s_waitcnt vmcnt(0)
    v_bitop3_b32 v12, v83, v87, s76 bitop3:0x7e
    v_cmp_lt_u32 vcc, 0xffff, v12
    s_cbranch_vccnz L_slow1_0
    s_branch L_back1_0
L_slow1_1:
    s_mov_b32 s22, 1
    s_call_b64 s[20:21], L_tick
    buffer_load_dwordx4 v[88:91], v34, s[12:15], s40 offen sc1
    buffer_load_dwordx4 v[92:95], v44, s[12:15], s40 offen sc1
    s_waitcnt vmcnt(0)
    v_bitop3_b32 v12, v91, v95, s76 bitop3:0x7e
    v_cmp_lt_u32 vcc, 0xffff, v12
    s_cbranch_vccnz L_slow1_1
    s_branch L_back1_1
L_slow5_0:
    s_mov_b32 s22, 5
    s_call_b64 s[20:21], L_tick
    buffer_load_dwordx4 v[112:115], v32, s[12:15], s44 offen sc1
    buffer_load_dwordx4 v[116:119], v33, s[12:15], s44 offen sc1
    s_waitcnt vmcnt(0)
    v_bitop3_b32 v12, v115, v119, s76 bitop3:0x7e
    v_cmp_lt_u32 vcc, 0xffff, v12
    s_cbranch_vccnz L_slow5_0
    s_branch L_back5_0
L_slow5_1:
    s_mov_b32 s22, 5
    s_call_b64 s[20:21], L_tick
    buffer_load_dwordx4 v[120:123], v34, s[12:15], s44 offen sc1
    buffer_load_dwordx4 v[124:127], v44, s[12:15], s44 offen sc1
    s_waitcnt vmcnt(0)
    v_bitop3_b32 v12, v123, v127, s76 bitop3:0x7e
    v_cmp_lt_u32 vcc, 0xffff, v12
    s_cbranch_vccnz L_slow5_1
    s_branch L_back5_1
L_slow2_0:
    s_mov_b32 s22, 2
    s_call_b64 s[20:21], L_tick
    buffer_load_dwordx4 v[48:51], v32, s[12:15], s41 offen sc1
    buffer_load_dwordx4 v[52:55], v33, s[12:15], s41 offen sc1
    s_waitcnt vmcnt(0)
    v_bitop3_b32 v12, v51, v55, s76 bitop3:0x7e
    v_cmp_lt_u32 vcc, 0xffff, v12
    s_cbranch_vccnz L_slow2_0
    s_branch L_back2_0
L_slow2_1:
    s_mov_b32 s22, 2
    s_call_b64 s[20:21], L_tick
    buffer_load_dwordx4 v[64:67], v34, s[12:15], s41 offen sc1
    buffer_load_dwordx4 v[68:71], v44, s[12:15], s41 offen sc1
    s_waitcnt vmcnt(0)
    v_bitop3_b32 v12, v67, v71, s76 bitop3:0x7e
    v_cmp_lt_u32 vcc, 0xffff, v12
    s_cbranch_vccnz L_slow2_1
    s_branch L_back2_1
L_slow6_0:
    s_mov_b32 s22, 6
    s_call_b64 s[20:21], L_tick
    buffer_load_dwordx4 v[88:91], v32, s[12:15], s45 offen sc1
    buffer_load_dwordx4 v[92:95], v33, s[12:15], s45 offen sc1
    s_waitcnt vmcnt(0)
    v_bitop3_b32 v12, v91, v95, s76 bitop3:0x7e
    v_cmp_lt_u32 vcc, 0xffff, v12
    s_cbranch_vccnz L_slow6_0
    s_branch L_back6_0
L_slow6_1:
    s_mov_b32 s22, 6
    s_call_b64 s[20:21], L_tick
    buffer_load_dwordx4 v[48:51], v34, s[12:15], s45 offen sc1
    buffer_load_dwordx4 v[52:55], v44, s[12:15], s45 offen sc1
    s_waitcnt vmcnt(0)
    v_bitop3_b32 v12, v51, v55, s76 bitop3:0x7e
    v_cmp_lt_u32 vcc, 0xffff, v12
    s_cbranch_vccnz L_slow6_1
    s_branch L_back6_1
L_slow3_0:
    s_mov_b32 s22, 3
    s_call_b64 s[20:21], L_tick
    buffer_load_dwordx4 v[72:75], v32, s[12:15], s42 offen sc1
    buffer_load_dwordx4 v[76:79], v33, s[12:15], s42 offen sc1
    s_waitcnt vmcnt(0)
    v_bitop3_b32 v12, v75, v79, s76 bitop3:0x7e
    v_cmp_lt_u32 vcc, 0xffff, v12
    s_cbranch_vccnz L_slow3_0
    s_branch L_back3_0
L_slow3_1:
    s_mov_b32 s22, 3
    s_call_b64 s[20:21], L_tick
    buffer_load_dwordx4 v[80:83], v34, s[12:15], s42 offen sc1
    buffer_load_dwordx4 v[84:87], v44, s[12:15], s42 offen sc1
    s_waitcnt vmcnt(0)
    v_bitop3_b32 v12, v83, v87, s76 bitop3:0x7e
    v_cmp_lt_u32 vcc, 0xffff, v12
    s_cbranch_vccnz L_slow3_1
    s_branch L_back3_1
L_slow7_0:
    s_mov_b32 s22, 7
    s_call_b64 s[20:21], L_tick
    buffer_load_dwordx4 v[68:71], v32, s[12:15], s72 offen sc1
    buffer_load_dwordx4 v[72:75], v33, s[12:15], s72 offen sc1
    s_waitcnt vmcnt(0)
    v_bitop3_b32 v12, v71, v75, s76 bitop3:0x7e
    v_cmp_lt_u32 vcc, 0xffff, v12
    s_cbranch_vccnz L_slow7_0
    s_branch L_back7_0
L_slow7_1:
    s_mov_b32 s22, 7
    s_call_b64 s[20:21], L_tick
    buffer_load_dwordx4 v[76:79], v34, s[12:15], s72 offen sc1
    buffer_load_dwordx4 v[80:83], v44, s[12:15], s72 offen sc1
    s_waitcnt vmcnt(0)
    v_bitop3_b32 v12, v79, v83, s76 bitop3:0x7e
    v_cmp_lt_u32 vcc, 0xffff, v12
    s_cbranch_vccnz L_slow7_1
    s_branch L_back7_1
.p2align 12
L_main:
L_pad0:
    s_cbranch_execz L_pad1
    s_waitcnt lgkmcnt(8)
    v_mfma_f32_16x16x32_bf16 v[128:131], a[32:35], a[0:3], 0
    s_waitcnt lgkmcnt(4)
    s_mov_b32 s40, 16384
    ds_read_b32 a68, v60
    v_mfma_f32_16x16x32_bf16 v[128:131], a[36:39], a[4:7], v[128:131]
    buffer_load_dwordx4 v[80:83], v32, s[12:15], s40 offen sc1
    v_mfma_f32_16x16x32_bf16 v[132:135], a[36:39], a[12:15], 0
    s_add_u32 m0, s57, 65536
    ds_read_b32 a69, v61
    v_perm_b32 v62, v69, v35, s38
    v_mfma_f32_16x16x32_bf16 v[132:135], a[32:35], a[8:11], v[132:135]
    s_add_u32 s56, s55, 256
    ds_read_b32 a70, v62
    v_perm_b32 v63, v69, v35, s39
    v_mfma_f32_16x16x32_bf16 v[136:139], a[32:35], a[16:19], 0
    s_add_u32 s3, s69, 256
    ds_read_b32 a71, v63
    v_mfma_f32_16x16x32_bf16 v[136:139], a[36:39], a[20:23], v[136:139]
    buffer_load_dwordx4 v[84:87], v33, s[12:15], s40 offen sc1
    v_mfma_f32_16x16x32_bf16 v[140:143], a[36:39], a[28:31], 0
    v_perm_b32 v56, v66, v35, s36
    v_perm_b32 v57, v66, v35, s37
    v_mfma_f32_16x16x32_bf16 v[140:143], a[32:35], a[24:27], v[140:143]
    ds_read_b32 a80, v56
    v_perm_b32 v58, v66, v35, s38
    v_mfma_f32_16x16x32_bf16 v[144:147], a[32:35], a[40:43], 0
    ds_read_b32 a81, v57
    v_mfma_f32_16x16x32_bf16 v[144:147], a[36:39], a[44:47], v[144:147]
    buffer_load_dwordx4 v36, s[8:11], s56 offen offset:0  lds
    v_mfma_f32_16x16x32_bf16 v[148:151], a[36:39], a[52:55], 0
    ds_read_b32 a82, v58
    v_perm_b32 v59, v66, v35, s39
    v_mfma_f32_16x16x32_bf16 v[148:151], a[32:35], a[48:51], v[148:151]
    v_perm_b32 v60, v70, v35, s36
    v_perm_b32 v61, v70, v35, s37
    v_mfma_f32_16x16x32_bf16 v[152:155], a[32:35], a[56:59], 0
    s_mov_b32 s41, 32768
    ds_read_b32 a83, v59
    ds_read_b32 a84, v60
    v_mfma_f32_16x16x32_bf16 v[152:155], a[36:39], a[60:63], v[152:155]
    buffer_load_dwordx4 v37, s[8:11], s56 offen offset:1024  lds
    v_mfma_f32_16x16x32_bf16 v[156:159], a[36:39], a[76:79], 0
    ds_read_b32 a85, v61
    v_perm_b32 v62, v70, v35, s38
    v_mfma_f32_16x16x32_bf16 v[156:159], a[32:35], a[72:75], v[156:159]
    s_waitcnt lgkmcnt(6)
    ds_read_b32 a86, v62
    v_perm_b32 v63, v70, v35, s39
    v_mfma_f32_16x16x32_bf16 v[160:163], a[64:67], a[0:3], 0
    ds_read_b32 a87, v63
    v_mfma_f32_16x16x32_bf16 v[160:163], a[68:71], a[4:7], v[160:163]
    buffer_load_dwordx4 v38, s[8:11], s56 offen offset:2048  lds
    v_mfma_f32_16x16x32_bf16 v[164:167], a[68:71], a[12:15], 0
    v_perm_b32 v56, v67, v35, s36
    v_perm_b32 v57, v67, v35, s37
    v_mfma_f32_16x16x32_bf16 v[164:167], a[64:67], a[8:11], v[164:167]
    ds_read_b32 a88, v56
    v_perm_b32 v58, v71, v35, s36
    v_mfma_f32_16x16x32_bf16 v[168:171], a[64:67], a[16:19], 0
    ds_read_b32 a89, v57
    v_mfma_f32_16x16x32_bf16 v[168:171], a[68:71], a[20:23], v[168:171]
    buffer_load_dwordx4 v39, s[8:11], s56 offen offset:3072  lds
    v_mfma_f32_16x16x32_bf16 v[172:175], a[68:71], a[28:31], 0
    s_add_u32 m0, s57, 81920
    ds_read_b32 a90, v58
    v_perm_b32 v59, v71, v35, s37
    v_mfma_f32_16x16x32_bf16 v[172:175], a[64:67], a[24:27], v[172:175]
    s_add_u32 s56, s55, 512
    ds_read_b32 a91, v59
    v_mfma_f32_16x16x32_bf16 v[176:179], a[64:67], a[40:43], 0
    s_waitcnt vmcnt(6)
    s_mov_b32 s42, 49152
    v_bitop3_b32 v60, v75, v79, s76 bitop3:0x7e
    v_mfma_f32_16x16x32_bf16 v[176:179], a[68:71], a[44:47], v[176:179]
    buffer_load_dwordx4 v[88:91], v34, s[12:15], s40 offen sc1
    v_mfma_f32_16x16x32_bf16 v[180:183], a[68:71], a[52:55], 0
    v_cmp_lt_u32 vcc, 0xffff, v60
    v_mfma_f32_16x16x32_bf16 v[180:183], a[64:67], a[48:51], v[180:183]
    v_mfma_f32_16x16x32_bf16 v[184:187], a[64:67], a[56:59], 0
    s_cbranch_vccnz L_slow0_1
L_back0_1:
    v_mfma_f32_16x16x32_bf16 v[184:187], a[68:71], a[60:63], v[184:187]
    buffer_load_dwordx4 v[92:95], v44, s[12:15], s40 offen sc1
    v_mfma_f32_16x16x32_bf16 v[188:191], a[68:71], a[76:79], 0
    v_perm_b32 v61, v72, v35, s36
    v_perm_b32 v62, v72, v35, s37
    v_mfma_f32_16x16x32_bf16 v[188:191], a[64:67], a[72:75], v[188:191]
    s_waitcnt lgkmcnt(1)
    ds_read_b32 a96, v61
    v_perm_b32 v63, v72, v35, s38
    v_mfma_f32_16x16x32_bf16 v[192:195], a[80:83], a[0:3], 0
    s_barrier
    v_mfma_f32_16x16x32_bf16 v[192:195], a[84:87], a[4:7], v[192:195]
    buffer_load_dwordx4 v36, s[8:11], s3 offen offset:0  lds
    v_mfma_f32_16x16x32_bf16 v[196:199], a[84:87], a[12:15], 0
    ds_read_b32 a97, v62
    ds_read_b32 a98, v63
    v_mfma_f32_16x16x32_bf16 v[196:199], a[80:83], a[8:11], v[196:199]
    ds_read_b128 a[104:107], v40 offset:49152
    v_perm_b32 v56, v72, v35, s39
    v_mfma_f32_16x16x32_bf16 v[200:203], a[80:83], a[16:19], 0
    s_mov_b32 s43, 65536
    ds_read_b32 a99, v56
    ds_read_b128 a[108:111], v41 offset:49152
    v_mfma_f32_16x16x32_bf16 v[200:203], a[84:87], a[20:23], v[200:203]
    buffer_load_dwordx4 v37, s[8:11], s3 offen offset:1024  lds
    v_mfma_f32_16x16x32_bf16 v[204:207], a[84:87], a[28:31], 0
    ds_read_b128 a[112:115], v40 offset:51200
    v_perm_b32 v57, v76, v35, s36
    v_mfma_f32_16x16x32_bf16 v[204:207], a[80:83], a[24:27], v[204:207]
    ds_read_b32 a100, v57
    v_perm_b32 v58, v76, v35, s37
    v_mfma_f32_16x16x32_bf16 v[208:211], a[80:83], a[40:43], 0
    ds_read_b32 a101, v58
    ds_read_b128 a[116:119], v41 offset:51200
    v_mfma_f32_16x16x32_bf16 v[208:211], a[84:87], a[44:47], v[208:211]
    buffer_load_dwordx4 v38, s[8:11], s3 offen offset:2048  lds
    v_mfma_f32_16x16x32_bf16 v[212:215], a[84:87], a[52:55], 0
    ds_read_b128 a[120:123], v40 offset:53248
    v_perm_b32 v59, v76, v35, s38
    v_mfma_f32_16x16x32_bf16 v[212:215], a[80:83], a[48:51], v[212:215]
    ds_read_b32 a102, v59
    v_perm_b32 v60, v76, v35, s39
    v_mfma_f32_16x16x32_bf16 v[216:219], a[80:83], a[56:59], 0
    ds_read_b32 a103, v60
    ds_read_b128 a[124:127], v41 offset:53248
    v_mfma_f32_16x16x32_bf16 v[216:219], a[84:87], a[60:63], v[216:219]
    ds_read_b128 a[128:131], v40 offset:55296
    v_perm_b32 v61, v73, v35, s36
    v_mfma_f32_16x16x32_bf16 v[220:223], a[84:87], a[76:79], 0
    ds_read_b32 a136, v61
    v_perm_b32 v62, v73, v35, s37
    v_mfma_f32_16x16x32_bf16 v[220:223], a[80:83], a[72:75], v[220:223]
    s_waitcnt lgkmcnt(9)
    ds_read_b32 a137, v62
    ds_read_b128 a[132:135], v41 offset:55296
    v_mfma_f32_16x16x32_bf16 v[224:227], a[88:91], a[2:5], 0
    buffer_load_dwordx4 v39, s[8:11], s3 offen offset:3072  lds
    v_mfma_f32_16x16x32_bf16 v[228:231], a[88:91], a[10:13], 0
    s_add_u32 m0, s57, 0
    ds_read_b128 a[144:147], v40 offset:57344
    v_perm_b32 v63, v73, v35, s38
    v_mfma_f32_16x16x32_bf16 v[232:235], a[88:91], a[18:21], 0
    s_add_u32 s3, s69, 512
    ds_read_b32 a138, v63
    v_perm_b32 v56, v73, v35, s39
    v_mfma_f32_16x16x32_bf16 v[236:239], a[88:91], a[26:29], 0
    s_mov_b32 s44, 81920
    ds_read_b32 a139, v56
    v_perm_b32 v57, v77, v35, s36
    v_mfma_f32_16x16x32_bf16 v[240:243], a[88:91], a[42:45], 0
    ds_read_b32 a140, v57
    ds_read_b128 a[148:151], v41 offset:57344
    v_mfma_f32_16x16x32_bf16 v[244:247], a[88:91], a[50:53], 0
    buffer_load_dwordx3 v[96:98], v18, s[4:7], s61 offen nt
    v_mfma_f32_16x16x32_bf16 v[248:251], a[88:91], a[58:61], 0
    ds_read_b128 a[152:155], v40 offset:59392
    v_perm_b32 v58, v77, v35, s37
    v_mfma_f32_16x16x32_bf16 v[252:255], a[88:91], a[74:77], 0
    ds_read_b128 a[156:159], v41 offset:59392
    v_perm_b32 v59, v77, v35, s38
    v_mfma_f32_16x16x32_bf16 v[128:131], a[96:99], a[104:107], v[128:131]
    s_waitcnt lgkmcnt(7)
    ds_read_b32 a141, v58
    ds_read_b32 a142, v59
    v_mfma_f32_16x16x32_bf16 v[128:131], a[100:103], a[108:111], v[128:131]
    buffer_load_dword v99, v19, s[4:7], s61 offen nt
    v_mfma_f32_16x16x32_bf16 v[132:135], a[100:103], a[116:119], v[132:135]
    s_add_u32 s61, s61, 14336
    ds_read_b128 a[160:163], v40 offset:61440
    v_perm_b32 v60, v77, v35, s39
    v_mfma_f32_16x16x32_bf16 v[132:135], a[96:99], a[112:115], v[132:135]
    s_waitcnt vmcnt(12)
    v_bitop3_b32 v61, v83, v87, s76 bitop3:0x7e
    v_perm_b32 v62, v74, v35, s36
    v_mfma_f32_16x16x32_bf16 v[136:139], a[96:99], a[120:123], v[136:139]
    s_mov_b32 s45, 98304
    ds_read_b128 a[164:167], v41 offset:61440
    ds_read_b32 a143, v60
    v_mfma_f32_16x16x32_bf16 v[136:139], a[100:103], a[124:127], v[136:139]
    buffer_load_dwordx3 v[100:102], v18, s[4:7], s61 offen nt
    v_mfma_f32_16x16x32_bf16 v[140:143], a[100:103], a[132:135], v[140:143]
    ds_read_b128 a[168:171], v40 offset:63488
    ds_read_b32 a176, v62
    v_mfma_f32_16x16x32_bf16 v[140:143], a[96:99], a[128:131], v[140:143]
    s_waitcnt lgkmcnt(8)
    ds_read_b128 a[172:175], v41 offset:63488
    v_cmp_lt_u32 vcc, 0xffff, v61
    v_mfma_f32_16x16x32_bf16 v[144:147], a[96:99], a[144:147], v[144:147]
    s_waitcnt lgkmcnt(8)
    v_perm_b32 v63, v74, v35, s37
    v_mfma_f32_16x16x32_bf16 v[144:147], a[100:103], a[148:151], v[144:147]
    buffer_load_dword v103, v19, s[4:7], s61 offen nt
    v_mfma_f32_16x16x32_bf16 v[148:151], a[100:103], a[156:159], v[148:151]
    s_add_u32 s61, s61, 14336
    ds_read_b32 a177, v63
    v_perm_b32 v56, v74, v35, s38
    v_mfma_f32_16x16x32_bf16 v[148:151], a[96:99], a[152:155], v[148:151]
    s_waitcnt lgkmcnt(6)
    v_perm_b32 v57, v74, v35, s39
    s_cbranch_vccnz L_slow1_0
L_back1_0:
    v_mfma_f32_16x16x32_bf16 v[152:155], a[96:99], a[160:163], v[152:155]
    s_waitcnt lgkmcnt(5)
    ds_read_b32 a178, v56
    ds_read_b32 a179, v57
    v_mfma_f32_16x16x32_bf16 v[152:155], a[100:103], a[164:167], v[152:155]
    s_waitcnt lgkmcnt(3)
    buffer_load_dwordx3 v[104:106], v18, s[4:7], s61 offen nt
    v_mfma_f32_16x16x32_bf16 v[156:159], a[100:103], a[172:175], v[156:159]
    v_perm_b32 v58, v78, v35, s36
    v_perm_b32 v59, v78, v35, s37
    v_mfma_f32_16x16x32_bf16 v[156:159], a[96:99], a[168:171], v[156:159]
    ds_read_b32 a180, v58
    ds_read_b32 a181, v59
    v_perm_b32 v60, v78, v35, s38
    v_mfma_f32_16x16x32_bf16 v[160:163], a[136:139], a[104:107], v[160:163]
    s_mov_b32 s72, 114688
    ds_read_b32 a182, v60
    v_mfma_f32_16x16x32_bf16 v[160:163], a[140:143], a[108:111], v[160:163]
    buffer_load_dword v107, v19, s[4:7], s61 offen nt
    v_mfma_f32_16x16x32_bf16 v[164:167], a[140:143], a[116:119], v[164:167]
    s_add_u32 s61, s61, 14336
    v_perm_b32 v62, v78, v35, s39
    v_perm_b32 v61, v75, v35, s36
    v_mfma_f32_16x16x32_bf16 v[164:167], a[136:139], a[112:115], v[164:167]
    ds_read_b32 a183, v62
    v_perm_b32 v63, v75, v35, s37
    v_mfma_f32_16x16x32_bf16 v[168:171], a[136:139], a[120:123], v[168:171]
    ds_read_b32 a92, v61
    ds_read_b32 a93, v63
    v_mfma_f32_16x16x32_bf16 v[168:171], a[140:143], a[124:127], v[168:171]
    buffer_load_dwordx3 v[108:110], v18, s[4:7], s61 offen nt
    v_mfma_f32_16x16x32_bf16 v[172:175], a[140:143], a[132:135], v[172:175]
    v_perm_b32 v56, v79, v35, s36
    v_perm_b32 v57, v79, v35, s37
    v_mfma_f32_16x16x32_bf16 v[172:175], a[136:139], a[128:131], v[172:175]
    ds_read_b32 a94, v56
    v_perm_b32 v58, v80, v35, s36
    v_mfma_f32_16x16x32_bf16 v[176:179], a[136:139], a[144:147], v[176:179]
    ds_read_b32 a95, v57
    ds_read_b32 a184, v58
    v_mfma_f32_16x16x32_bf16 v[176:179], a[140:143], a[148:151], v[176:179]
    buffer_load_dword v111, v19, s[4:7], s61 offen nt
    v_mfma_f32_16x16x32_bf16 v[180:183], a[140:143], a[156:159], v[180:183]
    s_add_u32 s61, s61, 14336
    v_perm_b32 v59, v80, v35, s37
    v_perm_b32 v60, v80, v35, s38
    v_mfma_f32_16x16x32_bf16 v[180:183], a[136:139], a[152:155], v[180:183]
    ds_read_b32 a185, v59
    v_perm_b32 v62, v80, v35, s39
    v_mfma_f32_16x16x32_bf16 v[184:187], a[136:139], a[160:163], v[184:187]
    ds_read_b32 a186, v60
    ds_read_b32 a187, v62
    v_mfma_f32_16x16x32_bf16 v[184:187], a[140:143], a[164:167], v[184:187]
    buffer_load_dwordx3 v[112:114], v18, s[4:7], s61 offen nt
    v_mfma_f32_16x16x32_bf16 v[188:191], a[140:143], a[172:175], v[188:191]
    s_add_u32 s61, s61, 14336
    v_perm_b32 v61, v84, v35, s36
    v_perm_b32 v63, v84, v35, s37
    v_mfma_f32_16x16x32_bf16 v[188:191], a[136:139], a[168:171], v[188:191]
    s_waitcnt vmcnt(15) lgkmcnt(6)
    ds_read_b32 a188, v61
    v_perm_b32 v56, v84, v35, s38
    v_mfma_f32_16x16x32_bf16 v[192:195], a[176:179], a[104:107], v[192:195]
    s_barrier
    v_mfma_f32_16x16x32_bf16 v[192:195], a[180:183], a[108:111], v[192:195]
    buffer_load_dwordx3 v[116:118], v18, s[4:7], s61 offen nt
    v_mfma_f32_16x16x32_bf16 v[196:199], a[180:183], a[116:119], v[196:199]
    s_add_u32 s61, s61, 14336
    ds_read_b32 a189, v63
    ds_read_b128 a[192:195], v42 offset:0
    v_mfma_f32_16x16x32_bf16 v[196:199], a[176:179], a[112:115], v[196:199]
    ds_read_b32 a190, v56
    ds_read_b128 a[196:199], v43 offset:0
    v_mfma_f32_16x16x32_bf16 v[200:203], a[176:179], a[120:123], v[200:203]
    ds_read_b128 a[204:207], v43 offset:2048
    v_perm_b32 v57, v84, v35, s39
    v_mfma_f32_16x16x32_bf16 v[200:203], a[180:183], a[124:127], v[200:203]
    ds_read_b32 a191, v57
    ds_read_b128 a[200:203], v42 offset:2048
    v_mfma_f32_16x16x32_bf16 v[204:207], a[180:183], a[132:135], v[204:207]
    buffer_load_dwordx3 v[120:122], v18, s[4:7], s61 offen nt
    v_mfma_f32_16x16x32_bf16 v[204:207], a[176:179], a[128:131], v[204:207]
    s_add_u32 s61, s61, 14336
    ds_read_b128 a[208:211], v42 offset:4096
    v_perm_b32 v58, v81, v35, s36
    v_mfma_f32_16x16x32_bf16 v[208:211], a[176:179], a[144:147], v[208:211]
    ds_read_b128 a[212:215], v43 offset:4096
    ds_read_b32 a216, v58
    v_mfma_f32_16x16x32_bf16 v[208:211], a[180:183], a[148:151], v[208:211]
    s_waitcnt vmcnt(15)
    ds_read_b128 a[228:231], v43 offset:6144
    v_bitop3_b32 v59, v91, v95, s76 bitop3:0x7e
    v_mfma_f32_16x16x32_bf16 v[212:215], a[180:183], a[156:159], v[212:215]
    ds_read_b128 a[224:227], v42 offset:6144
    v_mfma_f32_16x16x32_bf16 v[212:215], a[176:179], a[152:155], v[212:215]
    buffer_load_dwordx3 v[124:126], v18, s[4:7], s61 offen nt
    v_mfma_f32_16x16x32_bf16 v[216:219], a[176:179], a[160:163], v[216:219]
    ds_read_b128 a[232:235], v42 offset:8192
    v_cmp_lt_u32 vcc, 0xffff, v59
    v_mfma_f32_16x16x32_bf16 v[216:219], a[180:183], a[164:167], v[216:219]
    ds_read_b128 a[236:239], v43 offset:8192
    v_perm_b32 v60, v81, v35, s37
    v_mfma_f32_16x16x32_bf16 v[220:223], a[180:183], a[172:175], v[220:223]
    ds_read_b128 a[240:243], v42 offset:10240
    ds_read_b32 a217, v60
    v_mfma_f32_16x16x32_bf16 v[220:223], a[176:179], a[168:171], v[220:223]
    s_waitcnt lgkmcnt(9)
    ds_read_b128 a[244:247], v43 offset:10240
    s_cbranch_vccnz L_slow1_1
L_back1_1:
    v_mfma_f32_16x16x32_bf16 v[224:227], a[92:95], a[106:109], v[224:227]
    buffer_load_dwordx4 v[48:51], v32, s[12:15], s41 offen sc1
    v_mfma_f32_16x16x32_bf16 v[228:231], a[92:95], a[114:117], v[228:231]
    ds_read_b128 a[248:251], v42 offset:12288
    v_perm_b32 v62, v81, v35, s38
    v_mfma_f32_16x16x32_bf16 v[232:235], a[92:95], a[122:125], v[232:235]
    ds_read_b32 a218, v62
    ds_read_b128 a[252:255], v43 offset:12288
    v_mfma_f32_16x16x32_bf16 v[236:239], a[92:95], a[130:133], v[236:239]
    v_perm_b32 v61, v81, v35, s39
    v_perm_b32 v63, v85, v35, s36
    v_mfma_f32_16x16x32_bf16 v[240:243], a[92:95], a[146:149], v[240:243]
    ds_read_b32 a219, v61
    ds_read_b32 a220, v63
    v_mfma_f32_16x16x32_bf16 v[244:247], a[92:95], a[154:157], v[244:247]
    buffer_load_dwordx4 v[52:55], v33, s[12:15], s41 offen sc1
    v_mfma_f32_16x16x32_bf16 v[248:251], a[92:95], a[162:165], v[248:251]
    ds_read_b128 a[32:35], v42 offset:14336
    v_perm_b32 v56, v85, v35, s37
    v_mfma_f32_16x16x32_bf16 v[252:255], a[92:95], a[170:173], v[252:255]
    ds_read_b32 a221, v56
    ds_read_b128 a[36:39], v43 offset:14336
    v_mfma_f32_16x16x32_bf16 v[128:131], a[184:187], a[192:195], v[128:131]
    v_perm_b32 v57, v85, v35, s38
    v_perm_b32 v58, v85, v35, s39
    v_mfma_f32_16x16x32_bf16 v[128:131], a[188:191], a[196:199], v[128:131]
    ds_read_b32 a222, v57
    ds_read_b32 a223, v58
    v_mfma_f32_16x16x32_bf16 v[132:135], a[188:191], a[204:207], v[132:135]
    v_perm_b32 v59, v82, v35, s36
    v_perm_b32 v60, v82, v35, s37
    v_mfma_f32_16x16x32_bf16 v[132:135], a[184:187], a[200:203], v[132:135]
    s_mul_i32 s66, s63, 96
    s_lshl_b32 s67, s65, 5
    s_lshl_b32 s70, s64, 2
    s_add_u32 s67, s67, s70
    s_add_u32 s67, s67, 384
    s_mul_i32 s71, s59, 448
    s_add_u32 s70, s66, s71
    v_mad_u32_u24 v22, v3, 24, s70
    s_add_u32 s70, s67, s71
    v_lshl_add_u32 v23, v3, 3, s70
    s_mov_b32 s34, 7168
    s_mov_b32 s35, 0x20000
    s_mov_b32 s26, 256
    s_mov_b32 s27, 0x20000
    s_lshl_b32 s77, s59, 4
    s_mov_b32 s18, 14680064
    s_mov_b32 s19, 0x20000
    s_sub_u32 s70, 1024, s71
    v_mul_u32_u24 v16, 464, v4
    v_add3_u32 v26, v22, v16, s70
    v_add3_u32 v28, v23, v16, s70
    v_lshlrev_b32 v29, 3, v0
    v_xor_b32 v30, 512, v29
    v_add_u32 v29, 52992, v29
    v_add_u32 v30, 52992, v30
    v_mul_u32_u24 v16, 2341, v2
    v_lshrrev_b32 v16, 16, v16
    s_mul_i32 s73, s63, 1856
    s_add_u32 s73, s73, 1024
    v_add_lshl_u32 v24, v2, v16, 4
    v_add_u32 v24, s73, v24
    s_lshl_b32 s74, s58, 7
    s_lshl_b32 s75, s63, 2
    s_add_u32 s74, s74, s75
    s_mul_i32 s74, s74, 7168
    s_add_u32 s74, s74, s71
    v_mul_u32_u24 v17, 6720, v16
    v_lshl_add_u32 v25, v2, 4, v17
    v_lshrrev_b32 v16, 1, v16
    v_lshlrev_b32 v16, 30, v16
    v_add3_u32 v25, v25, v16, s74
    s_waitcnt lgkmcnt(7)
    v_mfma_f32_16x16x32_bf16 v[136:139], a[184:187], a[208:211], v[136:139]
    buffer_load_dwordx4 v36, s[8:11], s56 offen offset:0  lds
    v_mfma_f32_16x16x32_bf16 v[136:139], a[188:191], a[212:215], v[136:139]
    ds_read_b32 a64, v59
    ds_read_b32 a65, v60
    v_mfma_f32_16x16x32_bf16 v[140:143], a[188:191], a[228:231], v[140:143]
    v_perm_b32 v62, v82, v35, s38
    v_perm_b32 v61, v82, v35, s39
    v_mfma_f32_16x16x32_bf16 v[140:143], a[184:187], a[224:227], v[140:143]
    ds_read_b32 a66, v62
    ds_read_b32 a67, v61
    v_mfma_f32_16x16x32_bf16 v[144:147], a[184:187], a[232:235], v[144:147]
    buffer_load_dwordx4 v37, s[8:11], s56 offen offset:1024  lds
    v_mfma_f32_16x16x32_bf16 v[144:147], a[188:191], a[236:239], v[144:147]
    v_perm_b32 v63, v86, v35, s36
    v_perm_b32 v56, v86, v35, s37
    v_mfma_f32_16x16x32_bf16 v[148:151], a[188:191], a[244:247], v[148:151]
    ds_read_b32 a68, v63
    ds_read_b32 a69, v56
    v_perm_b32 v57, v86, v35, s38
    v_mfma_f32_16x16x32_bf16 v[148:151], a[184:187], a[240:243], v[148:151]
    ds_read_b32 a70, v57
    v_mfma_f32_16x16x32_bf16 v[152:155], a[184:187], a[248:251], v[152:155]
    buffer_load_dwordx4 v38, s[8:11], s56 offen offset:2048  lds
    v_mfma_f32_16x16x32_bf16 v[152:155], a[188:191], a[252:255], v[152:155]
    s_waitcnt lgkmcnt(7)
    v_perm_b32 v58, v86, v35, s39
    v_perm_b32 v59, v83, v35, s36
    v_mfma_f32_16x16x32_bf16 v[156:159], a[188:191], a[36:39], v[156:159]
    ds_read_b32 a71, v58
    ds_read_b32 a80, v59
    v_perm_b32 v60, v83, v35, s37
    v_mfma_f32_16x16x32_bf16 v[156:159], a[184:187], a[32:35], v[156:159]
    ds_read_b32 a81, v60
    v_mfma_f32_16x16x32_bf16 v[160:163], a[216:219], a[192:195], v[160:163]
    buffer_load_dwordx4 v39, s[8:11], s56 offen offset:3072  lds
    v_mfma_f32_16x16x32_bf16 v[160:163], a[220:223], a[196:199], v[160:163]
    s_add_u32 m0, s57, 16384
    v_perm_b32 v62, v87, v35, s36
    v_perm_b32 v61, v87, v35, s37
    v_mfma_f32_16x16x32_bf16 v[164:167], a[220:223], a[204:207], v[164:167]
    s_add_u32 s56, s55, 768
    ds_read_b32 a82, v62
    v_perm_b32 v63, v88, v35, s36
    v_mfma_f32_16x16x32_bf16 v[164:167], a[216:219], a[200:203], v[164:167]
    ds_read_b32 a83, v61
    ds_read_b32 a0, v63
    v_mfma_f32_16x16x32_bf16 v[168:171], a[216:219], a[208:211], v[168:171]
    buffer_load_dwordx4 v[64:67], v34, s[12:15], s41 offen sc1
    v_mfma_f32_16x16x32_bf16 v[168:171], a[220:223], a[212:215], v[168:171]
    v_perm_b32 v56, v88, v35, s37
    v_perm_b32 v57, v88, v35, s38
    v_mfma_f32_16x16x32_bf16 v[172:175], a[220:223], a[228:231], v[172:175]
    ds_read_b32 a1, v56
    ds_read_b32 a2, v57
    v_perm_b32 v58, v88, v35, s39
    v_mfma_f32_16x16x32_bf16 v[172:175], a[216:219], a[224:227], v[172:175]
    ds_read_b32 a3, v58
    v_mfma_f32_16x16x32_bf16 v[176:179], a[216:219], a[232:235], v[176:179]
    buffer_load_dwordx4 v[68:71], v44, s[12:15], s41 offen sc1
    v_mfma_f32_16x16x32_bf16 v[176:179], a[220:223], a[236:239], v[176:179]
    v_perm_b32 v59, v92, v35, s36
    v_perm_b32 v60, v92, v35, s37
    v_mfma_f32_16x16x32_bf16 v[180:183], a[220:223], a[244:247], v[180:183]
    ds_read_b32 a4, v59
    ds_read_b32 a5, v60
    v_perm_b32 v62, v92, v35, s38
    v_mfma_f32_16x16x32_bf16 v[180:183], a[216:219], a[240:243], v[180:183]
    ds_read_b32 a6, v62
    v_mfma_f32_16x16x32_bf16 v[184:187], a[216:219], a[248:251], v[184:187]
    buffer_load_dwordx4 v[72:75], v32, s[12:15], s42 offen sc1
    v_mfma_f32_16x16x32_bf16 v[184:187], a[220:223], a[252:255], v[184:187]
    v_perm_b32 v61, v92, v35, s39
    v_perm_b32 v63, v89, v35, s36
    v_mfma_f32_16x16x32_bf16 v[188:191], a[220:223], a[36:39], v[188:191]
    ds_read_b32 a7, v61
    ds_read_b32 a8, v63
    v_perm_b32 v56, v89, v35, s37
    v_mfma_f32_16x16x32_bf16 v[188:191], a[216:219], a[32:35], v[188:191]
    s_waitcnt vmcnt(21) lgkmcnt(6)
    ds_read_b32 a9, v56
    v_mfma_f32_16x16x32_bf16 v[192:195], a[64:67], a[192:195], v[192:195]
    buffer_load_dwordx4 v[76:79], v33, s[12:15], s42 offen sc1
    v_mfma_f32_16x16x32_bf16 v[192:195], a[68:71], a[196:199], v[192:195]
    s_barrier
    v_mfma_f32_16x16x32_bf16 v[196:199], a[68:71], a[204:207], v[196:199]
    ds_read_b128 a[16:19], v42 offset:16384
    v_perm_b32 v57, v89, v35, s38
    v_mfma_f32_16x16x32_bf16 v[196:199], a[64:67], a[200:203], v[196:199]
    ds_read_b32 a10, v57
    ds_read_b128 a[20:23], v43 offset:16384
    v_mfma_f32_16x16x32_bf16 v[200:203], a[64:67], a[208:211], v[200:203]
    v_perm_b32 v58, v89, v35, s39
    v_perm_b32 v59, v93, v35, s36
    v_mfma_f32_16x16x32_bf16 v[200:203], a[68:71], a[212:215], v[200:203]
    ds_read_b32 a11, v58
    ds_read_b32 a12, v59
    v_mfma_f32_16x16x32_bf16 v[204:207], a[68:71], a[228:231], v[204:207]
    ds_read_b128 a[24:27], v42 offset:18432
    v_perm_b32 v60, v93, v35, s37
    v_mfma_f32_16x16x32_bf16 v[204:207], a[64:67], a[224:227], v[204:207]
    ds_read_b32 a13, v60
    ds_read_b128 a[28:31], v43 offset:18432
    v_mfma_f32_16x16x32_bf16 v[208:211], a[64:67], a[232:235], v[208:211]
    buffer_load_dwordx4 v36, s[8:11], s3 offen offset:0  lds
    v_mfma_f32_16x16x32_bf16 v[208:211], a[68:71], a[236:239], v[208:211]
    ds_read_b128 a[40:43], v42 offset:20480
    v_perm_b32 v62, v93, v35, s38
    v_mfma_f32_16x16x32_bf16 v[212:215], a[68:71], a[244:247], v[212:215]
    ds_read_b32 a14, v62
    v_perm_b32 v61, v93, v35, s39
    v_mfma_f32_16x16x32_bf16 v[212:215], a[64:67], a[240:243], v[212:215]
    ds_read_b32 a15, v61
    ds_read_b128 a[44:47], v43 offset:20480
    v_mfma_f32_16x16x32_bf16 v[216:219], a[64:67], a[248:251], v[216:219]
    v_perm_b32 v63, v90, v35, s36
    v_perm_b32 v56, v90, v35, s37
    v_mfma_f32_16x16x32_bf16 v[216:219], a[68:71], a[252:255], v[216:219]
    ds_read_b32 a48, v63
    ds_read_b32 a49, v56
    v_perm_b32 v57, v90, v35, s38
    v_mfma_f32_16x16x32_bf16 v[220:223], a[68:71], a[36:39], v[220:223]
    s_waitcnt vmcnt(19)
    ds_read_b32 a50, v57
    ds_read_b128 a[56:59], v42 offset:22528
    v_mfma_f32_16x16x32_bf16 v[220:223], a[64:67], a[32:35], v[220:223]
    buffer_load_dwordx4 v37, s[8:11], s3 offen offset:1024  lds
    v_mfma_f32_16x16x32_bf16 v[224:227], a[80:83], a[194:197], v[224:227]
    v_or_b32 v99, s47, v99
    v_lshl_or_b32 v96, v100, 4, v96
    v_lshl_or_b32 v97, v101, 4, v97
    v_lshl_or_b32 v98, v102, 4, v98
    v_lshl_or_b32 v99, v103, 4, v99
    s_waitcnt vmcnt(19)
    v_lshl_or_b32 v96, v104, 8, v96
    v_lshl_or_b32 v97, v105, 8, v97
    v_lshl_or_b32 v98, v106, 8, v98
    s_waitcnt vmcnt(18)
    v_lshl_or_b32 v99, v107, 8, v99
    s_waitcnt vmcnt(17)
    v_lshl_or_b32 v96, v108, 12, v96
    v_lshl_or_b32 v97, v109, 12, v97
    v_lshl_or_b32 v98, v110, 12, v98
    s_waitcnt vmcnt(16)
    v_lshl_or_b32 v99, v111, 12, v99
    s_waitcnt vmcnt(15)
    v_lshl_or_b32 v96, v112, 16, v96
    v_lshl_or_b32 v97, v113, 16, v97
    v_lshl_or_b32 v98, v114, 16, v98
    s_waitcnt vmcnt(14)
    v_lshl_or_b32 v96, v116, 20, v96
    v_lshl_or_b32 v97, v117, 20, v97
L_pad1:
    s_cbranch_execz L_pad2
    v_lshl_or_b32 v98, v118, 20, v98
    s_waitcnt vmcnt(13)
    v_lshl_or_b32 v96, v120, 24, v96
    v_lshl_or_b32 v97, v121, 24, v97
    v_lshl_or_b32 v98, v122, 24, v98
    s_waitcnt vmcnt(12)
    v_lshl_or_b32 v96, v124, 28, v96
    v_lshl_or_b32 v97, v125, 28, v97
    v_lshl_or_b32 v98, v126, 28, v98
    buffer_store_dwordx4 v[96:99], v20, s[12:15], s62 offen sc1
    v_mfma_f32_16x16x32_bf16 v[228:231], a[80:83], a[202:205], v[228:231]
    ds_read_b128 a[60:63], v43 offset:22528
    v_perm_b32 v58, v90, v35, s39
    v_mfma_f32_16x16x32_bf16 v[232:235], a[80:83], a[210:213], v[232:235]
    ds_read_b32 a51, v58
    ds_read_b128 a[72:75], v42 offset:24576
    v_mfma_f32_16x16x32_bf16 v[236:239], a[80:83], a[226:229], v[236:239]
    buffer_load_dwordx4 v38, s[8:11], s3 offen offset:2048  lds
    v_mfma_f32_16x16x32_bf16 v[240:243], a[80:83], a[234:237], v[240:243]
    s_waitcnt vmcnt(12)
    ds_read_b128 a[76:79], v43 offset:24576
    v_perm_b32 v59, v94, v35, s36
    v_mfma_f32_16x16x32_bf16 v[244:247], a[80:83], a[242:245], v[244:247]
    ds_read_b32 a52, v59
    v_bitop3_b32 v60, v51, v55, s76 bitop3:0x7e
    v_perm_b32 v62, v94, v35, s37
    v_mfma_f32_16x16x32_bf16 v[248:251], a[80:83], a[250:253], v[248:251]
    s_waitcnt lgkmcnt(7)
    ds_read_b32 a53, v62
    ds_read_b128 a[96:99], v42 offset:26624
    v_mfma_f32_16x16x32_bf16 v[252:255], a[80:83], a[34:37], v[252:255]
    buffer_load_dwordx4 v39, s[8:11], s3 offen offset:3072  lds
    v_mfma_f32_16x16x32_bf16 v[128:131], a[0:3], a[16:19], v[128:131]
    s_add_u32 m0, s57, 32768
    ds_read_b128 a[100:103], v43 offset:26624
    v_cmp_lt_u32 vcc, 0xffff, v60
    v_mfma_f32_16x16x32_bf16 v[128:131], a[4:7], a[20:23], v[128:131]
    s_add_u32 s3, s69, 768
    ds_read_b128 a[136:139], v42 offset:28672
    v_perm_b32 v61, v94, v35, s38
    v_mfma_f32_16x16x32_bf16 v[132:135], a[4:7], a[28:31], v[132:135]
    v_perm_b32 v63, v94, v35, s39
    s_cbranch_vccnz L_slow2_0
L_back2_0:
    v_mfma_f32_16x16x32_bf16 v[132:135], a[0:3], a[24:27], v[132:135]
    ds_read_b128 a[140:143], v43 offset:28672
    ds_read_b32 a54, v61
    v_mfma_f32_16x16x32_bf16 v[136:139], a[0:3], a[40:43], v[136:139]
    buffer_load_dwordx4 v36, s[8:11], s56 offen offset:0  lds
    v_mfma_f32_16x16x32_bf16 v[136:139], a[4:7], a[44:47], v[136:139]
    s_waitcnt lgkmcnt(7)
    ds_read_b128 a[176:179], v42 offset:30720
    ds_read_b32 a55, v63
    v_mfma_f32_16x16x32_bf16 v[140:143], a[4:7], a[60:63], v[140:143]
    v_perm_b32 v56, v91, v35, s36
    v_perm_b32 v57, v91, v35, s37
    v_mfma_f32_16x16x32_bf16 v[140:143], a[0:3], a[56:59], v[140:143]
    ds_read_b128 a[180:183], v43 offset:30720
    ds_read_b32 a84, v56
    v_mfma_f32_16x16x32_bf16 v[144:147], a[0:3], a[72:75], v[144:147]
    s_waitcnt lgkmcnt(7)
    ds_read_b32 a85, v57
    v_perm_b32 v58, v95, v35, s36
    v_mfma_f32_16x16x32_bf16 v[144:147], a[4:7], a[76:79], v[144:147]
    ds_read_b32 a86, v58
    v_perm_b32 v59, v95, v35, s37
    v_perm_b32 v62, v48, v35, s36
    v_mfma_f32_16x16x32_bf16 v[148:151], a[4:7], a[100:103], v[148:151]
    s_waitcnt lgkmcnt(8)
    ds_read_b32 a87, v59
    ds_read_b32 a104, v62
    v_mfma_f32_16x16x32_bf16 v[148:151], a[0:3], a[96:99], v[148:151]
    buffer_load_dwordx4 v37, s[8:11], s56 offen offset:1024  lds
    v_mfma_f32_16x16x32_bf16 v[152:155], a[0:3], a[136:139], v[152:155]
    s_waitcnt lgkmcnt(8)
    v_perm_b32 v60, v48, v35, s37
    v_perm_b32 v61, v48, v35, s38
    v_mfma_f32_16x16x32_bf16 v[152:155], a[4:7], a[140:143], v[152:155]
    s_waitcnt lgkmcnt(5)
    ds_read_b32 a105, v60
    ds_read_b32 a106, v61
    v_mfma_f32_16x16x32_bf16 v[156:159], a[4:7], a[180:183], v[156:159]
    v_perm_b32 v63, v48, v35, s39
    v_perm_b32 v56, v52, v35, s36
    v_mfma_f32_16x16x32_bf16 v[156:159], a[0:3], a[176:179], v[156:159]
    ds_read_b32 a107, v63
    ds_read_b32 a108, v56
    v_mfma_f32_16x16x32_bf16 v[160:163], a[8:11], a[16:19], v[160:163]
    v_perm_b32 v57, v52, v35, s37
    v_perm_b32 v58, v52, v35, s38
    v_mfma_f32_16x16x32_bf16 v[160:163], a[12:15], a[20:23], v[160:163]
    ds_read_b32 a109, v57
    ds_read_b32 a110, v58
    v_mfma_f32_16x16x32_bf16 v[164:167], a[12:15], a[28:31], v[164:167]
    buffer_load_dwordx4 v38, s[8:11], s56 offen offset:2048  lds
    v_mfma_f32_16x16x32_bf16 v[164:167], a[8:11], a[24:27], v[164:167]
    v_perm_b32 v59, v52, v35, s39
    v_perm_b32 v62, v49, v35, s36
    v_mfma_f32_16x16x32_bf16 v[168:171], a[8:11], a[40:43], v[168:171]
    ds_read_b32 a111, v59
    ds_read_b32 a112, v62
    v_mfma_f32_16x16x32_bf16 v[168:171], a[12:15], a[44:47], v[168:171]
    v_perm_b32 v60, v49, v35, s37
    v_perm_b32 v61, v49, v35, s38
    v_mfma_f32_16x16x32_bf16 v[172:175], a[12:15], a[60:63], v[172:175]
    ds_read_b32 a113, v60
    ds_read_b32 a114, v61
    v_mfma_f32_16x16x32_bf16 v[172:175], a[8:11], a[56:59], v[172:175]
    v_perm_b32 v63, v49, v35, s39
    v_perm_b32 v56, v53, v35, s36
    v_mfma_f32_16x16x32_bf16 v[176:179], a[8:11], a[72:75], v[176:179]
    ds_read_b32 a115, v63
    ds_read_b32 a116, v56
    v_perm_b32 v57, v53, v35, s37
    v_mfma_f32_16x16x32_bf16 v[176:179], a[12:15], a[76:79], v[176:179]
    s_waitcnt vmcnt(12)
    ds_read_b32 a117, v57
    v_mfma_f32_16x16x32_bf16 v[180:183], a[12:15], a[100:103], v[180:183]
    buffer_load_dwordx4 v39, s[8:11], s56 offen offset:3072  lds
    v_mfma_f32_16x16x32_bf16 v[180:183], a[8:11], a[96:99], v[180:183]
    s_barrier
    v_mfma_f32_16x16x32_bf16 v[184:187], a[8:11], a[136:139], v[184:187]
    s_add_u32 m0, s57, 49152
    ds_read_b128 a[120:123], v40 offset:0
    v_perm_b32 v58, v53, v35, s38
    v_mfma_f32_16x16x32_bf16 v[184:187], a[12:15], a[140:143], v[184:187]
    s_add_u32 s56, s55, 1024
    ds_read_b128 a[124:127], v41 offset:0
    ds_read_b32 a118, v58
    v_mfma_f32_16x16x32_bf16 v[188:191], a[12:15], a[180:183], v[188:191]
    ds_read_b128 a[132:135], v41 offset:2048
    v_perm_b32 v59, v53, v35, s39
    v_mfma_f32_16x16x32_bf16 v[188:191], a[8:11], a[176:179], v[188:191]
    ds_read_b128 a[128:131], v40 offset:2048
    ds_read_b32 a119, v59
    v_mfma_f32_16x16x32_bf16 v[192:195], a[48:51], a[16:19], v[192:195]
    ds_read_b128 a[144:147], v40 offset:4096
    v_mfma_f32_16x16x32_bf16 v[192:195], a[52:55], a[20:23], v[192:195]
    buffer_load_dwordx4 v36, s[8:11], s3 offen offset:0  lds
    v_mfma_f32_16x16x32_bf16 v[196:199], a[52:55], a[28:31], v[196:199]
    ds_read_b128 a[148:151], v41 offset:4096
    v_perm_b32 v62, v50, v35, s36
    v_mfma_f32_16x16x32_bf16 v[196:199], a[48:51], a[24:27], v[196:199]
    ds_read_b128 a[156:159], v41 offset:6144
    ds_read_b32 a160, v62
    v_mfma_f32_16x16x32_bf16 v[200:203], a[48:51], a[40:43], v[200:203]
    s_waitcnt vmcnt(12)
    ds_read_b128 a[152:155], v40 offset:6144
    v_bitop3_b32 v60, v67, v71, s76 bitop3:0x7e
    v_mfma_f32_16x16x32_bf16 v[200:203], a[52:55], a[44:47], v[200:203]
    ds_read_b128 a[88:91], v40 offset:8192
    v_cmp_lt_u32 vcc, 0xffff, v60
    v_mfma_f32_16x16x32_bf16 v[204:207], a[52:55], a[60:63], v[204:207]
    v_perm_b32 v61, v50, v35, s37
    v_perm_b32 v63, v50, v35, s38
    v_mfma_f32_16x16x32_bf16 v[204:207], a[48:51], a[56:59], v[204:207]
    ds_read_b32 a161, v61
    ds_read_b32 a162, v63
    v_mfma_f32_16x16x32_bf16 v[208:211], a[48:51], a[72:75], v[208:211]
    buffer_load_dwordx4 v37, s[8:11], s3 offen offset:1024  lds
    v_mfma_f32_16x16x32_bf16 v[208:211], a[52:55], a[76:79], v[208:211]
    ds_read_b128 a[92:95], v41 offset:8192
    s_cbranch_vccnz L_slow2_1
L_back2_1:
    v_mfma_f32_16x16x32_bf16 v[212:215], a[52:55], a[100:103], v[212:215]
    v_perm_b32 v56, v50, v35, s39
    v_perm_b32 v57, v54, v35, s36
    v_mfma_f32_16x16x32_bf16 v[212:215], a[48:51], a[96:99], v[212:215]
    ds_read_b32 a163, v56
    ds_read_b32 a164, v57
    v_mfma_f32_16x16x32_bf16 v[216:219], a[48:51], a[136:139], v[216:219]
    ds_read_b128 a[168:171], v40 offset:10240
    v_perm_b32 v58, v54, v35, s37
    v_mfma_f32_16x16x32_bf16 v[216:219], a[52:55], a[140:143], v[216:219]
    ds_read_b32 a165, v58
    v_perm_b32 v59, v54, v35, s38
    v_mfma_f32_16x16x32_bf16 v[220:223], a[52:55], a[180:183], v[220:223]
    ds_read_b32 a166, v59
    v_perm_b32 v62, v54, v35, s39
    v_mfma_f32_16x16x32_bf16 v[220:223], a[48:51], a[176:179], v[220:223]
    s_waitcnt lgkmcnt(8)
    ds_read_b128 a[172:175], v41 offset:10240
    ds_read_b32 a167, v62
    v_mfma_f32_16x16x32_bf16 v[224:227], a[84:87], a[18:21], v[224:227]
    buffer_load_dwordx4 v38, s[8:11], s3 offen offset:2048  lds
    v_mfma_f32_16x16x32_bf16 v[228:231], a[84:87], a[26:29], v[228:231]
    ds_read_b128 a[184:187], v40 offset:12288
    v_perm_b32 v60, v51, v35, s36
    v_mfma_f32_16x16x32_bf16 v[232:235], a[84:87], a[42:45], v[232:235]
    ds_read_b32 a216, v60
    v_perm_b32 v61, v51, v35, s37
    v_mfma_f32_16x16x32_bf16 v[236:239], a[84:87], a[58:61], v[236:239]
    ds_read_b32 a217, v61
    v_perm_b32 v63, v55, v35, s36
    v_mfma_f32_16x16x32_bf16 v[240:243], a[84:87], a[74:77], v[240:243]
    ds_read_b32 a218, v63
    ds_read_b128 a[188:191], v41 offset:12288
    v_mfma_f32_16x16x32_bf16 v[244:247], a[84:87], a[98:101], v[244:247]
    v_perm_b32 v56, v55, v35, s37
    v_perm_b32 v57, v64, v35, s36
    v_mfma_f32_16x16x32_bf16 v[248:251], a[84:87], a[138:141], v[248:251]
    ds_read_b32 a219, v56
    ds_read_b32 a64, v57
    v_mfma_f32_16x16x32_bf16 v[252:255], a[84:87], a[178:181], v[252:255]
    buffer_load_dwordx4 v39, s[8:11], s3 offen offset:3072  lds
    v_mfma_f32_16x16x32_bf16 v[128:131], a[104:107], a[120:123], v[128:131]
    s_add_u32 m0, s57, 65536
    ds_read_b128 a[192:195], v40 offset:14336
    v_perm_b32 v58, v64, v35, s37
    v_mfma_f32_16x16x32_bf16 v[128:131], a[108:111], a[124:127], v[128:131]
    s_add_u32 s3, s69, 1024
    ds_read_b32 a65, v58
    v_perm_b32 v59, v64, v35, s38
    v_mfma_f32_16x16x32_bf16 v[132:135], a[108:111], a[132:135], v[132:135]
    ds_read_b128 a[196:199], v41 offset:14336
    ds_read_b32 a66, v59
    v_perm_b32 v62, v64, v35, s39
    v_mfma_f32_16x16x32_bf16 v[132:135], a[104:107], a[128:131], v[132:135]
    ds_read_b32 a67, v62
    v_mfma_f32_16x16x32_bf16 v[136:139], a[104:107], a[144:147], v[136:139]
    buffer_load_dwordx4 v[80:83], v34, s[12:15], s42 offen sc1
    v_mfma_f32_16x16x32_bf16 v[136:139], a[108:111], a[148:151], v[136:139]
    s_waitcnt vmcnt(14)
    v_bitop3_b32 v60, v75, v79, s76 bitop3:0x7e
    v_perm_b32 v61, v68, v35, s36
    v_mfma_f32_16x16x32_bf16 v[140:143], a[108:111], a[156:159], v[140:143]
    ds_read_b32 a68, v61
    v_cmp_lt_u32 vcc, 0xffff, v60
    v_mfma_f32_16x16x32_bf16 v[140:143], a[104:107], a[152:155], v[140:143]
    v_perm_b32 v63, v68, v35, s37
    v_perm_b32 v56, v68, v35, s38
    v_mfma_f32_16x16x32_bf16 v[144:147], a[104:107], a[88:91], v[144:147]
    s_waitcnt lgkmcnt(6)
    ds_read_b32 a69, v63
    ds_read_b32 a70, v56
    v_mfma_f32_16x16x32_bf16 v[144:147], a[108:111], a[92:95], v[144:147]
    buffer_load_dwordx4 v[84:87], v44, s[12:15], s42 offen sc1
    v_mfma_f32_16x16x32_bf16 v[148:151], a[108:111], a[172:175], v[148:151]
    v_perm_b32 v57, v68, v35, s39
    s_cbranch_vccnz L_slow3_0
L_back3_0:
    v_mfma_f32_16x16x32_bf16 v[148:151], a[104:107], a[168:171], v[148:151]
    ds_read_b32 a71, v57
    v_perm_b32 v58, v65, v35, s36
    v_mfma_f32_16x16x32_bf16 v[152:155], a[104:107], a[184:187], v[152:155]
    ds_read_b32 a200, v58
    v_perm_b32 v59, v65, v35, s37
    v_mfma_f32_16x16x32_bf16 v[152:155], a[108:111], a[188:191], v[152:155]
    s_waitcnt lgkmcnt(5)
    ds_read_b32 a201, v59
    v_perm_b32 v62, v65, v35, s38
    v_mfma_f32_16x16x32_bf16 v[156:159], a[108:111], a[196:199], v[156:159]
    ds_read_b32 a202, v62
    v_perm_b32 v60, v65, v35, s39
    v_perm_b32 v61, v69, v35, s36
    v_mfma_f32_16x16x32_bf16 v[156:159], a[104:107], a[192:195], v[156:159]
    ds_read_b32 a203, v60
    ds_read_b32 a204, v61
    v_mfma_f32_16x16x32_bf16 v[160:163], a[112:115], a[120:123], v[160:163]
    buffer_load_dwordx4 v36, s[8:11], s56 offen offset:0  lds
    v_mfma_f32_16x16x32_bf16 v[160:163], a[116:119], a[124:127], v[160:163]
    v_perm_b32 v63, v69, v35, s37
    v_perm_b32 v56, v69, v35, s38
    v_mfma_f32_16x16x32_bf16 v[164:167], a[116:119], a[132:135], v[164:167]
    ds_read_b32 a205, v63
    ds_read_b32 a206, v56
    v_mfma_f32_16x16x32_bf16 v[164:167], a[112:115], a[128:131], v[164:167]
    v_perm_b32 v57, v69, v35, s39
    v_perm_b32 v58, v66, v35, s36
    v_mfma_f32_16x16x32_bf16 v[168:171], a[112:115], a[144:147], v[168:171]
    ds_read_b32 a207, v57
    ds_read_b32 a208, v58
    v_mfma_f32_16x16x32_bf16 v[168:171], a[116:119], a[148:151], v[168:171]
    buffer_load_dwordx4 v[96:99], v32, s[12:15], s43 offen sc1
    v_mfma_f32_16x16x32_bf16 v[172:175], a[116:119], a[156:159], v[172:175]
    v_perm_b32 v59, v66, v35, s37
    v_perm_b32 v62, v66, v35, s38
    v_mfma_f32_16x16x32_bf16 v[172:175], a[112:115], a[152:155], v[172:175]
    ds_read_b32 a209, v59
    ds_read_b32 a210, v62
    v_mfma_f32_16x16x32_bf16 v[176:179], a[112:115], a[88:91], v[176:179]
    v_perm_b32 v60, v66, v35, s39
    v_perm_b32 v61, v70, v35, s36
    v_mfma_f32_16x16x32_bf16 v[176:179], a[116:119], a[92:95], v[176:179]
    ds_read_b32 a211, v60
    ds_read_b32 a212, v61
    v_mfma_f32_16x16x32_bf16 v[180:183], a[116:119], a[172:175], v[180:183]
    buffer_load_dwordx4 v[100:103], v33, s[12:15], s43 offen sc1
    v_mfma_f32_16x16x32_bf16 v[180:183], a[112:115], a[168:171], v[180:183]
    v_perm_b32 v63, v70, v35, s37
    v_perm_b32 v56, v70, v35, s38
    v_mfma_f32_16x16x32_bf16 v[184:187], a[112:115], a[184:187], v[184:187]
    ds_read_b32 a213, v63
    ds_read_b32 a214, v56
    v_mfma_f32_16x16x32_bf16 v[184:187], a[116:119], a[188:191], v[184:187]
    v_perm_b32 v57, v70, v35, s39
    v_perm_b32 v58, v67, v35, s36
    v_mfma_f32_16x16x32_bf16 v[188:191], a[116:119], a[196:199], v[188:191]
    ds_read_b32 a215, v57
    ds_read_b32 a220, v58
    v_mfma_f32_16x16x32_bf16 v[188:191], a[112:115], a[192:195], v[188:191]
    s_waitcnt vmcnt(13)
    v_perm_b32 v59, v67, v35, s37
    v_perm_b32 v62, v71, v35, s36
    v_mfma_f32_16x16x32_bf16 v[192:195], a[160:163], a[120:123], v[192:195]
    s_barrier
    v_mfma_f32_16x16x32_bf16 v[192:195], a[164:167], a[124:127], v[192:195]
    buffer_load_dwordx4 v37, s[8:11], s56 offen offset:1024  lds
    v_mfma_f32_16x16x32_bf16 v[196:199], a[164:167], a[132:135], v[196:199]
    ds_read_b32 a221, v59
    ds_read_b32 a222, v62
    v_mfma_f32_16x16x32_bf16 v[196:199], a[160:163], a[128:131], v[196:199]
    ds_read_b128 a[224:227], v40 offset:16384
    v_perm_b32 v60, v71, v35, s37
    v_mfma_f32_16x16x32_bf16 v[200:203], a[160:163], a[144:147], v[200:203]
    ds_read_b32 a223, v60
    ds_read_b128 a[228:231], v41 offset:16384
    v_mfma_f32_16x16x32_bf16 v[200:203], a[164:167], a[148:151], v[200:203]
    ds_read_b128 a[232:235], v40 offset:18432
    v_perm_b32 v61, v72, v35, s36
    v_mfma_f32_16x16x32_bf16 v[204:207], a[164:167], a[156:159], v[204:207]
    ds_read_b32 a240, v61
    v_perm_b32 v63, v72, v35, s37
    v_mfma_f32_16x16x32_bf16 v[204:207], a[160:163], a[152:155], v[204:207]
    ds_read_b32 a241, v63
    ds_read_b128 a[236:239], v41 offset:18432
    v_mfma_f32_16x16x32_bf16 v[208:211], a[160:163], a[88:91], v[208:211]
    buffer_load_dwordx4 v38, s[8:11], s56 offen offset:2048  lds
    v_mfma_f32_16x16x32_bf16 v[208:211], a[164:167], a[92:95], v[208:211]
    ds_read_b128 a[248:251], v40 offset:20480
    v_perm_b32 v56, v72, v35, s38
    v_mfma_f32_16x16x32_bf16 v[212:215], a[164:167], a[172:175], v[212:215]
    ds_read_b32 a242, v56
    v_perm_b32 v57, v72, v35, s39
    v_mfma_f32_16x16x32_bf16 v[212:215], a[160:163], a[168:171], v[212:215]
    ds_read_b32 a243, v57
    ds_read_b128 a[252:255], v41 offset:20480
    v_mfma_f32_16x16x32_bf16 v[216:219], a[160:163], a[184:187], v[216:219]
    v_perm_b32 v58, v76, v35, s36
    v_perm_b32 v59, v76, v35, s37
    v_mfma_f32_16x16x32_bf16 v[216:219], a[164:167], a[188:191], v[216:219]
    ds_read_b32 a244, v58
    ds_read_b32 a245, v59
    v_mfma_f32_16x16x32_bf16 v[220:223], a[164:167], a[196:199], v[220:223]
    ds_read_b128 a[32:35], v40 offset:22528
    v_perm_b32 v62, v76, v35, s38
    v_mfma_f32_16x16x32_bf16 v[220:223], a[160:163], a[192:195], v[220:223]
    ds_read_b32 a246, v62
    ds_read_b128 a[36:39], v41 offset:22528
    v_mfma_f32_16x16x32_bf16 v[224:227], a[216:219], a[122:125], v[224:227]
    buffer_load_dwordx4 v39, s[8:11], s56 offen offset:3072  lds
    v_mfma_f32_16x16x32_bf16 v[228:231], a[216:219], a[130:133], v[228:231]
    s_add_u32 m0, s57, 81920
    ds_read_b128 a[0:3], v40 offset:24576
    v_perm_b32 v60, v76, v35, s39
    v_mfma_f32_16x16x32_bf16 v[232:235], a[216:219], a[146:149], v[232:235]
    ds_read_b32 a247, v60
    v_perm_b32 v61, v73, v35, s36
    v_mfma_f32_16x16x32_bf16 v[236:239], a[216:219], a[154:157], v[236:239]
    ds_read_b32 a8, v61
    ds_read_b128 a[4:7], v41 offset:24576
    v_mfma_f32_16x16x32_bf16 v[240:243], a[216:219], a[90:93], v[240:243]
    v_perm_b32 v63, v73, v35, s37
    v_perm_b32 v56, v73, v35, s38
    v_mfma_f32_16x16x32_bf16 v[244:247], a[216:219], a[170:173], v[244:247]
    ds_read_b32 a9, v63
    ds_read_b32 a10, v56
    v_perm_b32 v57, v73, v35, s39
    v_mfma_f32_16x16x32_bf16 v[248:251], a[216:219], a[186:189], v[248:251]
    s_waitcnt lgkmcnt(9)
    ds_read_b32 a11, v57
    ds_read_b128 a[48:51], v40 offset:26624
    v_mfma_f32_16x16x32_bf16 v[252:255], a[216:219], a[194:197], v[252:255]
    buffer_load_dwordx4 v36, s[8:11], s3 offen offset:0  lds
    v_mfma_f32_16x16x32_bf16 v[128:131], a[64:67], a[224:227], v[128:131]
    ds_read_b128 a[52:55], v41 offset:26624
    v_perm_b32 v58, v77, v35, s36
    v_mfma_f32_16x16x32_bf16 v[128:131], a[68:71], a[228:231], v[128:131]
    ds_read_b128 a[16:19], v40 offset:28672
    ds_read_b32 a12, v58
    v_mfma_f32_16x16x32_bf16 v[132:135], a[68:71], a[236:239], v[132:135]
    s_add_u32 s56, s55, 1280
    v_perm_b32 v59, v77, v35, s37
    v_perm_b32 v62, v77, v35, s38
    v_mfma_f32_16x16x32_bf16 v[132:135], a[64:67], a[232:235], v[132:135]
    ds_read_b128 a[20:23], v41 offset:28672
    ds_read_b32 a13, v59
    v_mfma_f32_16x16x32_bf16 v[136:139], a[64:67], a[248:251], v[136:139]
    ds_read_b32 a14, v62
    v_perm_b32 v60, v77, v35, s39
    v_mfma_f32_16x16x32_bf16 v[136:139], a[68:71], a[252:255], v[136:139]
    s_waitcnt lgkmcnt(10)
    ds_read_b128 a[24:27], v40 offset:30720
    ds_read_b32 a15, v60
    v_mfma_f32_16x16x32_bf16 v[140:143], a[68:71], a[36:39], v[140:143]
    buffer_load_dwordx4 v37, s[8:11], s3 offen offset:1024  lds
    v_mfma_f32_16x16x32_bf16 v[140:143], a[64:67], a[32:35], v[140:143]
    ds_read_b128 a[28:31], v41 offset:30720
    v_perm_b32 v61, v74, v35, s36
    v_mfma_f32_16x16x32_bf16 v[144:147], a[64:67], a[0:3], v[144:147]
    ds_read_b32 a40, v61
    v_perm_b32 v63, v74, v35, s37
    v_mfma_f32_16x16x32_bf16 v[144:147], a[68:71], a[4:7], v[144:147]
    s_waitcnt lgkmcnt(9)
    ds_read_b32 a41, v63
    v_perm_b32 v56, v74, v35, s38
    v_mfma_f32_16x16x32_bf16 v[148:151], a[68:71], a[52:55], v[148:151]
    ds_read_b32 a42, v56
    v_perm_b32 v57, v74, v35, s39
    v_mfma_f32_16x16x32_bf16 v[148:151], a[64:67], a[48:51], v[148:151]
    s_waitcnt lgkmcnt(8)
    ds_read_b32 a43, v57
    v_perm_b32 v58, v78, v35, s36
    v_mfma_f32_16x16x32_bf16 v[152:155], a[64:67], a[16:19], v[152:155]
    ds_read_b32 a44, v58
    v_perm_b32 v59, v78, v35, s37
    v_perm_b32 v62, v78, v35, s38
    v_mfma_f32_16x16x32_bf16 v[152:155], a[68:71], a[20:23], v[152:155]
    s_waitcnt lgkmcnt(5)
    ds_read_b32 a45, v59
    ds_read_b32 a46, v62
    v_mfma_f32_16x16x32_bf16 v[156:159], a[68:71], a[28:31], v[156:159]
    buffer_load_dwordx4 v38, s[8:11], s3 offen offset:2048  lds
    v_mfma_f32_16x16x32_bf16 v[156:159], a[64:67], a[24:27], v[156:159]
    v_perm_b32 v60, v78, v35, s39
    v_perm_b32 v61, v75, v35, s36
    v_mfma_f32_16x16x32_bf16 v[160:163], a[200:203], a[224:227], v[160:163]
    ds_read_b32 a47, v60
    ds_read_b32 a56, v61
    v_mfma_f32_16x16x32_bf16 v[160:163], a[204:207], a[228:231], v[160:163]
    v_perm_b32 v63, v75, v35, s37
    v_perm_b32 v56, v79, v35, s36
    v_mfma_f32_16x16x32_bf16 v[164:167], a[204:207], a[236:239], v[164:167]
    ds_read_b32 a57, v63
    ds_read_b32 a58, v56
    v_perm_b32 v57, v79, v35, s37
    v_mfma_f32_16x16x32_bf16 v[164:167], a[200:203], a[232:235], v[164:167]
    ds_read_b32 a59, v57
    v_mfma_f32_16x16x32_bf16 v[168:171], a[200:203], a[248:251], v[168:171]
    buffer_load_dwordx4 v[104:107], v34, s[12:15], s43 offen sc1
    v_mfma_f32_16x16x32_bf16 v[168:171], a[204:207], a[252:255], v[168:171]
    s_waitcnt vmcnt(12)
    v_mfma_f32_16x16x32_bf16 v[172:175], a[204:207], a[36:39], v[172:175]
    s_barrier
    v_mfma_f32_16x16x32_bf16 v[172:175], a[200:203], a[32:35], v[172:175]
    ds_read_b128 a[72:75], v40 offset:32768
    v_mfma_f32_16x16x32_bf16 v[176:179], a[200:203], a[0:3], v[176:179]
    buffer_load_dwordx4 v[108:111], v44, s[12:15], s43 offen sc1
    v_mfma_f32_16x16x32_bf16 v[176:179], a[204:207], a[4:7], v[176:179]
    ds_read_b128 a[76:79], v41 offset:32768
    v_mfma_f32_16x16x32_bf16 v[180:183], a[204:207], a[52:55], v[180:183]
    ds_read_b128 a[100:103], v41 offset:34816
    v_mfma_f32_16x16x32_bf16 v[180:183], a[200:203], a[48:51], v[180:183]
    ds_read_b128 a[96:99], v40 offset:34816
    v_mfma_f32_16x16x32_bf16 v[184:187], a[200:203], a[16:19], v[184:187]
    ds_read_b128 a[136:139], v40 offset:36864
    v_mfma_f32_16x16x32_bf16 v[184:187], a[204:207], a[20:23], v[184:187]
    ds_read_b128 a[140:143], v41 offset:36864
    v_mfma_f32_16x16x32_bf16 v[188:191], a[204:207], a[28:31], v[188:191]
    s_waitcnt vmcnt(11)
    ds_read_b128 a[80:83], v40 offset:38912
    v_mfma_f32_16x16x32_bf16 v[188:191], a[200:203], a[24:27], v[188:191]
    buffer_load_dwordx4 v39, s[8:11], s3 offen offset:3072  lds
    v_mfma_f32_16x16x32_bf16 v[192:195], a[208:211], a[224:227], v[192:195]
    s_add_u32 m0, s57, 0
    ds_read_b128 a[84:87], v41 offset:38912
    v_bitop3_b32 v58, v83, v87, s76 bitop3:0x7e
    v_mfma_f32_16x16x32_bf16 v[192:195], a[212:215], a[228:231], v[192:195]
    s_add_u32 s3, s69, 1280
    ds_read_b128 a[176:179], v40 offset:40960
    v_cmp_lt_u32 vcc, 0xffff, v58
    v_mfma_f32_16x16x32_bf16 v[196:199], a[212:215], a[236:239], v[196:199]
    v_mfma_f32_16x16x32_bf16 v[196:199], a[208:211], a[232:235], v[196:199]
    s_cbranch_vccnz L_slow3_1
L_back3_1:
    v_mfma_f32_16x16x32_bf16 v[200:203], a[208:211], a[248:251], v[200:203]
    buffer_load_dwordx4 v[112:115], v32, s[12:15], s44 offen sc1
    v_mfma_f32_16x16x32_bf16 v[200:203], a[212:215], a[252:255], v[200:203]
    v_perm_b32 v59, v83, v35, s36
    v_perm_b32 v62, v83, v35, s37
    v_mfma_f32_16x16x32_bf16 v[204:207], a[212:215], a[36:39], v[204:207]
    ds_read_b32 a60, v59
    ds_read_b32 a61, v62
    v_mfma_f32_16x16x32_bf16 v[204:207], a[208:211], a[32:35], v[204:207]
    ds_read_b128 a[180:183], v41 offset:40960
    v_mfma_f32_16x16x32_bf16 v[208:211], a[208:211], a[0:3], v[208:211]
    buffer_load_dwordx4 v[116:119], v33, s[12:15], s44 offen sc1
    v_mfma_f32_16x16x32_bf16 v[208:211], a[212:215], a[4:7], v[208:211]
    v_perm_b32 v60, v87, v35, s36
    v_perm_b32 v61, v87, v35, s37
    v_mfma_f32_16x16x32_bf16 v[212:215], a[212:215], a[52:55], v[212:215]
    ds_read_b32 a62, v60
    ds_read_b32 a63, v61
    v_mfma_f32_16x16x32_bf16 v[212:215], a[208:211], a[48:51], v[212:215]
    v_perm_b32 v63, v80, v35, s36
    v_perm_b32 v56, v80, v35, s37
    v_mfma_f32_16x16x32_bf16 v[216:219], a[208:211], a[16:19], v[216:219]
    ds_read_b128 a[104:107], v40 offset:43008
    ds_read_b32 a112, v63
    v_mfma_f32_16x16x32_bf16 v[216:219], a[212:215], a[20:23], v[216:219]
    ds_read_b32 a113, v56
    v_perm_b32 v57, v80, v35, s38
    v_mfma_f32_16x16x32_bf16 v[220:223], a[212:215], a[28:31], v[220:223]
    ds_read_b32 a114, v57
    v_perm_b32 v58, v80, v35, s39
    v_mfma_f32_16x16x32_bf16 v[220:223], a[208:211], a[24:27], v[220:223]
    ds_read_b128 a[108:111], v41 offset:43008
    ds_read_b32 a115, v58
    v_mfma_f32_16x16x32_bf16 v[224:227], a[220:223], a[226:229], v[224:227]
    buffer_load_dwordx4 v36, s[8:11], s56 offen offset:0  lds
    v_mfma_f32_16x16x32_bf16 v[228:231], a[220:223], a[234:237], v[228:231]
    s_waitcnt vmcnt(12)
    v_bitop3_b32 v59, v99, v103, s76 bitop3:0x7e
    v_perm_b32 v62, v84, v35, s36
    v_mfma_f32_16x16x32_bf16 v[232:235], a[220:223], a[250:253], v[232:235]
    ds_read_b128 a[160:163], v40 offset:45056
    ds_read_b32 a116, v62
    v_cmp_lt_u32 vcc, 0xffff, v59
    v_mfma_f32_16x16x32_bf16 v[236:239], a[220:223], a[34:37], v[236:239]
    v_perm_b32 v60, v84, v35, s37
    v_perm_b32 v61, v84, v35, s38
    v_mfma_f32_16x16x32_bf16 v[240:243], a[220:223], a[2:5], v[240:243]
    ds_read_b32 a117, v60
    ds_read_b32 a118, v61
    v_mfma_f32_16x16x32_bf16 v[244:247], a[220:223], a[50:53], v[244:247]
    ds_read_b128 a[164:167], v41 offset:45056
    s_cbranch_vccnz L_slow4_0
L_back4_0:
    v_mfma_f32_16x16x32_bf16 v[248:251], a[220:223], a[18:21], v[248:251]
    s_waitcnt lgkmcnt(8)
    ds_read_b128 a[120:123], v40 offset:47104
    v_mfma_f32_16x16x32_bf16 v[252:255], a[220:223], a[26:29], v[252:255]
    buffer_load_dwordx4 v37, s[8:11], s56 offen offset:1024  lds
    v_mfma_f32_16x16x32_bf16 v[128:131], a[240:243], a[72:75], v[128:131]
    v_perm_b32 v63, v84, v35, s39
    v_perm_b32 v56, v81, v35, s36
L_pad2:
    s_cbranch_execz L_pad3
    v_mfma_f32_16x16x32_bf16 v[128:131], a[244:247], a[76:79], v[128:131]
    ds_read_b32 a119, v63
    ds_read_b32 a128, v56
    v_mfma_f32_16x16x32_bf16 v[132:135], a[244:247], a[100:103], v[132:135]
    ds_read_b128 a[124:127], v41 offset:47104
    v_perm_b32 v57, v81, v35, s37
    v_mfma_f32_16x16x32_bf16 v[132:135], a[240:243], a[96:99], v[132:135]
    ds_read_b32 a129, v57
    v_perm_b32 v58, v81, v35, s38
    v_mfma_f32_16x16x32_bf16 v[136:139], a[240:243], a[136:139], v[136:139]
    ds_read_b32 a130, v58
    v_perm_b32 v59, v81, v35, s39
    v_mfma_f32_16x16x32_bf16 v[136:139], a[244:247], a[140:143], v[136:139]
    ds_read_b32 a131, v59
    v_perm_b32 v62, v85, v35, s36
    v_mfma_f32_16x16x32_bf16 v[140:143], a[244:247], a[84:87], v[140:143]
    ds_read_b32 a132, v62
    v_perm_b32 v60, v85, v35, s37
    v_mfma_f32_16x16x32_bf16 v[140:143], a[240:243], a[80:83], v[140:143]
    ds_read_b32 a133, v60
    v_perm_b32 v61, v85, v35, s38
    v_mfma_f32_16x16x32_bf16 v[144:147], a[240:243], a[176:179], v[144:147]
    s_waitcnt lgkmcnt(8)
    ds_read_b32 a134, v61
    ds_read_b128 a[144:147], v40 offset:49152
    v_mfma_f32_16x16x32_bf16 v[144:147], a[244:247], a[180:183], v[144:147]
    buffer_load_dwordx4 v[120:123], v34, s[12:15], s44 offen sc1
    v_mfma_f32_16x16x32_bf16 v[148:151], a[244:247], a[108:111], v[148:151]
    v_perm_b32 v63, v85, v35, s39
    v_perm_b32 v56, v82, v35, s36
    v_mfma_f32_16x16x32_bf16 v[148:151], a[240:243], a[104:107], v[148:151]
    ds_read_b32 a135, v63
    ds_read_b32 a152, v56
    v_mfma_f32_16x16x32_bf16 v[152:155], a[240:243], a[160:163], v[152:155]
    s_waitcnt lgkmcnt(8)
    ds_read_b128 a[148:151], v41 offset:49152
    v_mfma_f32_16x16x32_bf16 v[152:155], a[244:247], a[164:167], v[152:155]
    buffer_load_dwordx4 v[124:127], v44, s[12:15], s44 offen sc1
    v_mfma_f32_16x16x32_bf16 v[156:159], a[244:247], a[124:127], v[156:159]
    ds_read_b128 a[88:91], v40 offset:51200
    v_perm_b32 v57, v82, v35, s37
    v_mfma_f32_16x16x32_bf16 v[156:159], a[240:243], a[120:123], v[156:159]
    ds_read_b128 a[92:95], v41 offset:51200
    ds_read_b32 a153, v57
    v_mfma_f32_16x16x32_bf16 v[160:163], a[8:11], a[72:75], v[160:163]
    ds_read_b128 a[168:171], v40 offset:53248
    v_mfma_f32_16x16x32_bf16 v[160:163], a[12:15], a[76:79], v[160:163]
    buffer_load_dwordx4 v38, s[8:11], s56 offen offset:2048  lds
    v_mfma_f32_16x16x32_bf16 v[164:167], a[12:15], a[100:103], v[164:167]
    v_perm_b32 v58, v82, v35, s38
    v_perm_b32 v59, v82, v35, s39
    v_mfma_f32_16x16x32_bf16 v[164:167], a[8:11], a[96:99], v[164:167]
    ds_read_b32 a154, v58
    ds_read_b32 a155, v59
    v_mfma_f32_16x16x32_bf16 v[168:171], a[8:11], a[136:139], v[168:171]
    v_perm_b32 v62, v86, v35, s36
    v_perm_b32 v60, v86, v35, s37
    v_mfma_f32_16x16x32_bf16 v[168:171], a[12:15], a[140:143], v[168:171]
    ds_read_b128 a[172:175], v41 offset:53248
    ds_read_b32 a156, v62
    v_mfma_f32_16x16x32_bf16 v[172:175], a[12:15], a[84:87], v[172:175]
    ds_read_b32 a157, v60
    ds_read_b128 a[184:187], v40 offset:55296
    v_mfma_f32_16x16x32_bf16 v[172:175], a[8:11], a[80:83], v[172:175]
    buffer_load_dwordx4 v39, s[8:11], s56 offen offset:3072  lds
    v_mfma_f32_16x16x32_bf16 v[176:179], a[8:11], a[176:179], v[176:179]
    s_add_u32 m0, s57, 16384
    v_perm_b32 v61, v86, v35, s38
    v_perm_b32 v63, v86, v35, s39
    v_mfma_f32_16x16x32_bf16 v[176:179], a[12:15], a[180:183], v[176:179]
    ds_read_b32 a158, v61
    ds_read_b32 a159, v63
    v_mfma_f32_16x16x32_bf16 v[180:183], a[12:15], a[108:111], v[180:183]
    v_perm_b32 v56, v96, v35, s36
    v_perm_b32 v57, v96, v35, s37
    v_mfma_f32_16x16x32_bf16 v[180:183], a[8:11], a[104:107], v[180:183]
    ds_read_b128 a[188:191], v41 offset:55296
    ds_read_b32 a192, v56
    v_mfma_f32_16x16x32_bf16 v[184:187], a[8:11], a[160:163], v[184:187]
    ds_read_b32 a193, v57
    v_perm_b32 v58, v96, v35, s38
    v_mfma_f32_16x16x32_bf16 v[184:187], a[12:15], a[164:167], v[184:187]
    ds_read_b32 a194, v58
    v_perm_b32 v59, v96, v35, s39
    v_mfma_f32_16x16x32_bf16 v[188:191], a[12:15], a[124:127], v[188:191]
    ds_read_b128 a[64:67], v40 offset:57344
    ds_read_b32 a195, v59
    v_mfma_f32_16x16x32_bf16 v[188:191], a[8:11], a[120:123], v[188:191]
    buffer_load_dwordx4 v36, s[8:11], s3 offen offset:0  lds
    v_mfma_f32_16x16x32_bf16 v[192:195], a[40:43], a[72:75], v[192:195]
    v_perm_b32 v62, v100, v35, s36
    v_perm_b32 v60, v100, v35, s37
    v_mfma_f32_16x16x32_bf16 v[192:195], a[44:47], a[76:79], v[192:195]
    ds_read_b128 a[68:71], v41 offset:57344
    ds_read_b32 a196, v62
    v_mfma_f32_16x16x32_bf16 v[196:199], a[44:47], a[100:103], v[196:199]
    ds_read_b32 a197, v60
    v_perm_b32 v61, v100, v35, s38
    v_mfma_f32_16x16x32_bf16 v[196:199], a[40:43], a[96:99], v[196:199]
    ds_read_b32 a198, v61
    v_perm_b32 v63, v100, v35, s39
    v_mfma_f32_16x16x32_bf16 v[200:203], a[40:43], a[136:139], v[200:203]
    ds_read_b128 a[200:203], v40 offset:59392
    ds_read_b32 a199, v63
    v_mfma_f32_16x16x32_bf16 v[200:203], a[44:47], a[140:143], v[200:203]
    ds_read_b128 a[204:207], v41 offset:59392
    v_mfma_f32_16x16x32_bf16 v[204:207], a[44:47], a[84:87], v[204:207]
    buffer_load_dwordx4 v37, s[8:11], s3 offen offset:1024  lds
    v_mfma_f32_16x16x32_bf16 v[204:207], a[40:43], a[80:83], v[204:207]
    v_perm_b32 v56, v97, v35, s36
    v_perm_b32 v57, v97, v35, s37
    v_mfma_f32_16x16x32_bf16 v[208:211], a[40:43], a[176:179], v[208:211]
    ds_read_b32 a208, v56
    ds_read_b32 a209, v57
    v_mfma_f32_16x16x32_bf16 v[208:211], a[44:47], a[180:183], v[208:211]
    v_perm_b32 v58, v97, v35, s38
    v_perm_b32 v59, v97, v35, s39
    v_mfma_f32_16x16x32_bf16 v[212:215], a[44:47], a[108:111], v[212:215]
    ds_read_b128 a[224:227], v40 offset:61440
    ds_read_b32 a210, v58
    v_mfma_f32_16x16x32_bf16 v[212:215], a[40:43], a[104:107], v[212:215]
    ds_read_b32 a211, v59
    v_perm_b32 v62, v101, v35, s36
    v_mfma_f32_16x16x32_bf16 v[216:219], a[40:43], a[160:163], v[216:219]
    ds_read_b32 a212, v62
    ds_read_b128 a[228:231], v41 offset:61440
    v_mfma_f32_16x16x32_bf16 v[216:219], a[44:47], a[164:167], v[216:219]
    buffer_load_dwordx4 v38, s[8:11], s3 offen offset:2048  lds
    v_mfma_f32_16x16x32_bf16 v[220:223], a[44:47], a[124:127], v[220:223]
    s_waitcnt vmcnt(12)
    v_bitop3_b32 v60, v107, v111, s76 bitop3:0x7e
    v_perm_b32 v61, v101, v35, s37
    v_mfma_f32_16x16x32_bf16 v[220:223], a[40:43], a[120:123], v[220:223]
    ds_read_b32 a213, v61
    v_cmp_lt_u32 vcc, 0xffff, v60
    v_mfma_f32_16x16x32_bf16 v[224:227], a[56:59], a[74:77], v[224:227]
    s_waitcnt lgkmcnt(8)
    ds_read_b128 a[232:235], v40 offset:63488
    v_perm_b32 v63, v101, v35, s38
    v_mfma_f32_16x16x32_bf16 v[224:227], a[60:63], a[146:149], v[224:227]
    ds_read_b32 a214, v63
    s_cbranch_vccnz L_slow4_1
L_back4_1:
    v_mfma_f32_16x16x32_bf16 v[228:231], a[60:63], a[90:93], v[228:231]
    v_perm_b32 v56, v101, v35, s39
    v_perm_b32 v57, v98, v35, s36
    v_mfma_f32_16x16x32_bf16 v[228:231], a[56:59], a[98:101], v[228:231]
    ds_read_b128 a[236:239], v41 offset:63488
    ds_read_b32 a215, v56
    v_mfma_f32_16x16x32_bf16 v[232:235], a[56:59], a[138:141], v[232:235]
    buffer_load_dwordx4 v[88:91], v32, s[12:15], s45 offen sc1
    v_mfma_f32_16x16x32_bf16 v[232:235], a[60:63], a[170:173], v[232:235]
    ds_read_b32 a248, v57
    v_perm_b32 v58, v98, v35, s37
    v_mfma_f32_16x16x32_bf16 v[236:239], a[60:63], a[186:189], v[236:239]
    ds_read_b32 a249, v58
    v_perm_b32 v59, v98, v35, s38
    v_perm_b32 v62, v98, v35, s39
    v_mfma_f32_16x16x32_bf16 v[236:239], a[56:59], a[82:85], v[236:239]
    ds_read_b32 a250, v59
    ds_read_b32 a251, v62
    v_mfma_f32_16x16x32_bf16 v[240:243], a[56:59], a[178:181], v[240:243]
    buffer_load_dwordx4 v[92:95], v33, s[12:15], s45 offen sc1
    v_mfma_f32_16x16x32_bf16 v[240:243], a[60:63], a[66:69], v[240:243]
    v_perm_b32 v60, v102, v35, s36
    v_perm_b32 v61, v102, v35, s37
    v_mfma_f32_16x16x32_bf16 v[244:247], a[60:63], a[202:205], v[244:247]
    ds_read_b32 a252, v60
    ds_read_b32 a253, v61
    v_mfma_f32_16x16x32_bf16 v[244:247], a[56:59], a[106:109], v[244:247]
    s_waitcnt vmcnt(13) lgkmcnt(7)
    v_perm_b32 v63, v102, v35, s38
    v_perm_b32 v56, v102, v35, s39
    v_mfma_f32_16x16x32_bf16 v[248:251], a[56:59], a[162:165], v[248:251]
    s_barrier
    v_mfma_f32_16x16x32_bf16 v[248:251], a[60:63], a[226:229], v[248:251]
    ds_read_b32 a254, v63
    ds_read_b32 a255, v56
    v_mfma_f32_16x16x32_bf16 v[252:255], a[60:63], a[234:237], v[252:255]
    buffer_load_dwordx4 v39, s[8:11], s3 offen offset:3072  lds
    v_mfma_f32_16x16x32_bf16 v[252:255], a[56:59], a[122:125], v[252:255]
    s_add_u32 s56, s55, 1536
    v_perm_b32 v57, v99, v35, s36
    v_perm_b32 v58, v99, v35, s37
    v_mfma_f32_16x16x32_bf16 v[128:131], a[112:115], a[144:147], v[128:131]
    ds_read_b32 a32, v57
    ds_read_b32 a33, v58
    v_mfma_f32_16x16x32_bf16 v[128:131], a[116:119], a[148:151], v[128:131]
    s_add_u32 m0, s57, 32768
    v_perm_b32 v59, v103, v35, s36
    v_perm_b32 v62, v103, v35, s37
    v_mfma_f32_16x16x32_bf16 v[132:135], a[116:119], a[92:95], v[132:135]
    ds_read_b32 a34, v59
    ds_read_b32 a35, v62
    v_mfma_f32_16x16x32_bf16 v[132:135], a[112:115], a[88:91], v[132:135]
    buffer_load_dwordx4 v[48:51], v34, s[12:15], s45 offen sc1
    v_mfma_f32_16x16x32_bf16 v[136:139], a[112:115], a[168:171], v[136:139]
    v_perm_b32 v60, v107, v35, s36
    v_perm_b32 v61, v107, v35, s37
    v_mfma_f32_16x16x32_bf16 v[136:139], a[116:119], a[172:175], v[136:139]
    ds_read_b32 a36, v60
    ds_read_b32 a37, v61
    v_mfma_f32_16x16x32_bf16 v[140:143], a[116:119], a[188:191], v[140:143]
    v_perm_b32 v63, v111, v35, s36
    v_perm_b32 v56, v111, v35, s37
    v_mfma_f32_16x16x32_bf16 v[140:143], a[112:115], a[184:187], v[140:143]
    ds_read_b32 a38, v63
    ds_read_b32 a39, v56
    v_mfma_f32_16x16x32_bf16 v[144:147], a[112:115], a[64:67], v[144:147]
    buffer_load_dwordx4 v[52:55], v44, s[12:15], s45 offen sc1
    v_mfma_f32_16x16x32_bf16 v[144:147], a[116:119], a[68:71], v[144:147]
    s_waitcnt vmcnt(14)
    v_bitop3_b32 v57, v115, v119, s76 bitop3:0x7e
    v_perm_b32 v58, v104, v35, s36
    v_mfma_f32_16x16x32_bf16 v[148:151], a[116:119], a[204:207], v[148:151]
    ds_read_b32 a0, v58
    v_cmp_lt_u32 vcc, 0xffff, v57
    v_mfma_f32_16x16x32_bf16 v[148:151], a[112:115], a[200:203], v[148:151]
    ds_read_b128 a[48:51], v42 offset:0
    v_perm_b32 v59, v104, v35, s37
    v_mfma_f32_16x16x32_bf16 v[152:155], a[112:115], a[224:227], v[152:155]
    ds_read_b128 a[52:55], v43 offset:0
    ds_read_b32 a1, v59
    v_mfma_f32_16x16x32_bf16 v[152:155], a[116:119], a[228:231], v[152:155]
    v_perm_b32 v62, v104, v35, s38
    s_cbranch_vccnz L_slow5_0
L_back5_0:
    v_mfma_f32_16x16x32_bf16 v[156:159], a[116:119], a[236:239], v[156:159]
    s_add_u32 s3, s69, 1536
    ds_read_b128 a[16:19], v42 offset:2048
    ds_read_b32 a2, v62
    v_mfma_f32_16x16x32_bf16 v[156:159], a[112:115], a[232:235], v[156:159]
    buffer_load_dwordx4 v36, s[8:11], s56 offen offset:0  lds
    v_mfma_f32_16x16x32_bf16 v[160:163], a[128:131], a[144:147], v[160:163]
    ds_read_b128 a[20:23], v43 offset:2048
    v_perm_b32 v60, v104, v35, s39
    v_mfma_f32_16x16x32_bf16 v[160:163], a[132:135], a[148:151], v[160:163]
    ds_read_b32 a3, v60
    v_perm_b32 v61, v108, v35, s36
    v_mfma_f32_16x16x32_bf16 v[164:167], a[132:135], a[92:95], v[164:167]
    ds_read_b128 a[216:219], v42 offset:4096
    ds_read_b32 a4, v61
    v_mfma_f32_16x16x32_bf16 v[164:167], a[128:131], a[88:91], v[164:167]
    v_perm_b32 v63, v108, v35, s37
    v_perm_b32 v56, v108, v35, s38
    v_mfma_f32_16x16x32_bf16 v[168:171], a[128:131], a[168:171], v[168:171]
    ds_read_b32 a5, v63
    ds_read_b32 a6, v56
    v_mfma_f32_16x16x32_bf16 v[168:171], a[132:135], a[172:175], v[168:171]
    ds_read_b128 a[220:223], v43 offset:4096
    v_perm_b32 v57, v108, v35, s39
    v_mfma_f32_16x16x32_bf16 v[172:175], a[132:135], a[188:191], v[172:175]
    ds_read_b32 a7, v57
    ds_read_b128 a[24:27], v42 offset:6144
    v_mfma_f32_16x16x32_bf16 v[172:175], a[128:131], a[184:187], v[172:175]
    buffer_load_dwordx4 v37, s[8:11], s56 offen offset:1024  lds
    v_mfma_f32_16x16x32_bf16 v[176:179], a[128:131], a[64:67], v[176:179]
    v_perm_b32 v58, v105, v35, s36
    v_perm_b32 v59, v105, v35, s37
    v_mfma_f32_16x16x32_bf16 v[176:179], a[132:135], a[68:71], v[176:179]
    ds_read_b32 a240, v58
    ds_read_b32 a241, v59
    v_mfma_f32_16x16x32_bf16 v[180:183], a[132:135], a[204:207], v[180:183]
    v_perm_b32 v62, v105, v35, s38
    v_perm_b32 v60, v105, v35, s39
    v_mfma_f32_16x16x32_bf16 v[180:183], a[128:131], a[200:203], v[180:183]
    ds_read_b128 a[28:31], v43 offset:6144
    ds_read_b32 a242, v62
    v_mfma_f32_16x16x32_bf16 v[184:187], a[128:131], a[224:227], v[184:187]
    ds_read_b32 a243, v60
    v_perm_b32 v61, v109, v35, s36
    v_mfma_f32_16x16x32_bf16 v[184:187], a[132:135], a[228:231], v[184:187]
    ds_read_b32 a244, v61
    ds_read_b128 a[8:11], v42 offset:8192
    v_mfma_f32_16x16x32_bf16 v[188:191], a[132:135], a[236:239], v[188:191]
    buffer_load_dwordx4 v38, s[8:11], s56 offen offset:2048  lds
    v_mfma_f32_16x16x32_bf16 v[188:191], a[128:131], a[232:235], v[188:191]
    v_perm_b32 v63, v109, v35, s37
    v_perm_b32 v56, v109, v35, s38
    v_mfma_f32_16x16x32_bf16 v[192:195], a[152:155], a[144:147], v[192:195]
    ds_read_b32 a245, v63
    ds_read_b32 a246, v56
    v_mfma_f32_16x16x32_bf16 v[192:195], a[156:159], a[148:151], v[192:195]
    ds_read_b128 a[12:15], v43 offset:8192
    v_perm_b32 v57, v109, v35, s39
    v_mfma_f32_16x16x32_bf16 v[196:199], a[156:159], a[92:95], v[196:199]
    ds_read_b32 a247, v57
    v_perm_b32 v58, v106, v35, s36
    v_mfma_f32_16x16x32_bf16 v[196:199], a[152:155], a[88:91], v[196:199]
    ds_read_b32 a40, v58
    v_perm_b32 v59, v106, v35, s37
    v_mfma_f32_16x16x32_bf16 v[200:203], a[152:155], a[168:171], v[200:203]
    ds_read_b128 a[72:75], v42 offset:10240
    ds_read_b32 a41, v59
    v_mfma_f32_16x16x32_bf16 v[200:203], a[156:159], a[172:175], v[200:203]
    buffer_load_dwordx4 v39, s[8:11], s56 offen offset:3072  lds
    v_mfma_f32_16x16x32_bf16 v[204:207], a[156:159], a[188:191], v[204:207]
    s_add_u32 m0, s57, 49152
    v_perm_b32 v62, v106, v35, s38
    v_perm_b32 v60, v106, v35, s39
    v_mfma_f32_16x16x32_bf16 v[204:207], a[152:155], a[184:187], v[204:207]
    s_add_u32 s56, s55, 1792
    ds_read_b128 a[76:79], v43 offset:10240
    ds_read_b32 a42, v62
    v_mfma_f32_16x16x32_bf16 v[208:211], a[152:155], a[64:67], v[208:211]
    ds_read_b32 a43, v60
    v_perm_b32 v61, v110, v35, s36
    v_mfma_f32_16x16x32_bf16 v[208:211], a[156:159], a[68:71], v[208:211]
    ds_read_b32 a44, v61
    v_perm_b32 v63, v110, v35, s37
    v_mfma_f32_16x16x32_bf16 v[212:215], a[156:159], a[204:207], v[212:215]
    ds_read_b128 a[96:99], v42 offset:12288
    ds_read_b32 a45, v63
    v_mfma_f32_16x16x32_bf16 v[212:215], a[152:155], a[200:203], v[212:215]
    v_perm_b32 v56, v110, v35, s38
    v_perm_b32 v57, v110, v35, s39
    v_mfma_f32_16x16x32_bf16 v[216:219], a[152:155], a[224:227], v[216:219]
    ds_read_b32 a46, v56
    ds_read_b32 a47, v57
    v_mfma_f32_16x16x32_bf16 v[216:219], a[156:159], a[228:231], v[216:219]
    buffer_load_dwordx4 v36, s[8:11], s3 offen offset:0  lds
    v_mfma_f32_16x16x32_bf16 v[220:223], a[156:159], a[236:239], v[220:223]
    ds_read_b128 a[100:103], v43 offset:12288
    v_perm_b32 v58, v112, v35, s36
    v_mfma_f32_16x16x32_bf16 v[220:223], a[152:155], a[232:235], v[220:223]
    s_waitcnt lgkmcnt(9)
    ds_read_b32 a136, v58
    v_perm_b32 v59, v112, v35, s37
    v_mfma_f32_16x16x32_bf16 v[128:131], a[192:195], a[48:51], v[128:131]
    ds_read_b128 a[80:83], v42 offset:14336
    ds_read_b32 a137, v59
    v_mfma_f32_16x16x32_bf16 v[128:131], a[196:199], a[52:55], v[128:131]
    v_perm_b32 v62, v112, v35, s38
    v_perm_b32 v60, v112, v35, s39
    v_mfma_f32_16x16x32_bf16 v[132:135], a[196:199], a[20:23], v[132:135]
    ds_read_b128 a[84:87], v43 offset:14336
    ds_read_b32 a138, v62
    v_mfma_f32_16x16x32_bf16 v[132:135], a[192:195], a[16:19], v[132:135]
    ds_read_b32 a139, v60
    ds_read_b128 a[176:179], v42 offset:16384
    v_mfma_f32_16x16x32_bf16 v[136:139], a[192:195], a[216:219], v[136:139]
    buffer_load_dwordx4 v37, s[8:11], s3 offen offset:1024  lds
    v_mfma_f32_16x16x32_bf16 v[136:139], a[196:199], a[220:223], v[136:139]
    s_waitcnt vmcnt(16)
    v_bitop3_b32 v61, v123, v127, s76 bitop3:0x7e
    v_perm_b32 v63, v116, v35, s36
    v_mfma_f32_16x16x32_bf16 v[140:143], a[196:199], a[28:31], v[140:143]
    ds_read_b32 a140, v63
    v_cmp_lt_u32 vcc, 0xffff, v61
    v_mfma_f32_16x16x32_bf16 v[140:143], a[192:195], a[24:27], v[140:143]
    v_perm_b32 v56, v116, v35, s37
    v_perm_b32 v57, v116, v35, s38
    v_mfma_f32_16x16x32_bf16 v[144:147], a[192:195], a[8:11], v[144:147]
    ds_read_b32 a141, v56
    ds_read_b32 a142, v57
    v_mfma_f32_16x16x32_bf16 v[144:147], a[196:199], a[12:15], v[144:147]
    s_waitcnt lgkmcnt(7)
    v_perm_b32 v58, v116, v35, s39
    s_cbranch_vccnz L_slow5_1
L_back5_1:
    v_mfma_f32_16x16x32_bf16 v[148:151], a[196:199], a[76:79], v[148:151]
    ds_read_b32 a143, v58
    v_perm_b32 v59, v113, v35, s36
    v_mfma_f32_16x16x32_bf16 v[148:151], a[192:195], a[72:75], v[148:151]
    ds_read_b32 a104, v59
    ds_read_b128 a[180:183], v43 offset:16384
    v_mfma_f32_16x16x32_bf16 v[152:155], a[192:195], a[96:99], v[152:155]
    buffer_load_dwordx4 v38, s[8:11], s3 offen offset:2048  lds
    v_mfma_f32_16x16x32_bf16 v[152:155], a[196:199], a[100:103], v[152:155]
    s_waitcnt lgkmcnt(6)
    ds_read_b128 a[160:163], v42 offset:18432
    v_perm_b32 v62, v113, v35, s37
    v_mfma_f32_16x16x32_bf16 v[156:159], a[196:199], a[84:87], v[156:159]
    ds_read_b32 a105, v62
    v_perm_b32 v60, v113, v35, s38
    v_mfma_f32_16x16x32_bf16 v[156:159], a[192:195], a[80:83], v[156:159]
    ds_read_b128 a[164:167], v43 offset:18432
    ds_read_b32 a106, v60
    v_mfma_f32_16x16x32_bf16 v[160:163], a[208:211], a[48:51], v[160:163]
    v_perm_b32 v61, v113, v35, s39
    v_perm_b32 v63, v117, v35, s36
    v_mfma_f32_16x16x32_bf16 v[160:163], a[212:215], a[52:55], v[160:163]
    ds_read_b32 a107, v61
    ds_read_b32 a108, v63
    v_mfma_f32_16x16x32_bf16 v[164:167], a[212:215], a[20:23], v[164:167]
    ds_read_b128 a[56:59], v42 offset:20480
    v_mfma_f32_16x16x32_bf16 v[164:167], a[208:211], a[16:19], v[164:167]
    buffer_load_dwordx4 v39, s[8:11], s3 offen offset:3072  lds
    v_mfma_f32_16x16x32_bf16 v[168:171], a[208:211], a[216:219], v[168:171]
    s_add_u32 m0, s57, 65536
    v_perm_b32 v56, v117, v35, s37
    v_perm_b32 v57, v117, v35, s38
    v_mfma_f32_16x16x32_bf16 v[168:171], a[212:215], a[220:223], v[168:171]
    s_add_u32 s3, s69, 1792
    ds_read_b128 a[60:63], v43 offset:20480
    ds_read_b32 a109, v56
    v_mfma_f32_16x16x32_bf16 v[172:175], a[212:215], a[28:31], v[172:175]
    ds_read_b32 a110, v57
    ds_read_b128 a[120:123], v42 offset:22528
    v_mfma_f32_16x16x32_bf16 v[172:175], a[208:211], a[24:27], v[172:175]
    buffer_load_dwordx4 v[64:67], v22, s[32:35], 0 offen
    v_mfma_f32_16x16x32_bf16 v[176:179], a[208:211], a[8:11], v[176:179]
    v_perm_b32 v58, v117, v35, s39
    v_perm_b32 v59, v114, v35, s36
    v_mfma_f32_16x16x32_bf16 v[176:179], a[212:215], a[12:15], v[176:179]
    ds_read_b32 a111, v58
    ds_read_b32 a112, v59
    v_mfma_f32_16x16x32_bf16 v[180:183], a[212:215], a[76:79], v[180:183]
    ds_read_b128 a[124:127], v43 offset:22528
    v_mfma_f32_16x16x32_bf16 v[180:183], a[208:211], a[72:75], v[180:183]
    buffer_load_dwordx4 v[68:71], v32, s[12:15], s72 offen sc1
    v_mfma_f32_16x16x32_bf16 v[184:187], a[208:211], a[96:99], v[184:187]
    v_perm_b32 v62, v114, v35, s37
    v_perm_b32 v60, v114, v35, s38
    v_mfma_f32_16x16x32_bf16 v[184:187], a[212:215], a[100:103], v[184:187]
    ds_read_b32 a113, v62
    ds_read_b32 a114, v60
    v_mfma_f32_16x16x32_bf16 v[188:191], a[212:215], a[84:87], v[188:191]
    ds_read_b128 a[128:131], v42 offset:24576
    v_mfma_f32_16x16x32_bf16 v[188:191], a[208:211], a[80:83], v[188:191]
    buffer_load_dwordx4 v[72:75], v33, s[12:15], s72 offen sc1
    v_mfma_f32_16x16x32_bf16 v[192:195], a[248:251], a[48:51], v[192:195]
    v_perm_b32 v61, v114, v35, s39
    v_perm_b32 v63, v118, v35, s36
    v_mfma_f32_16x16x32_bf16 v[192:195], a[252:255], a[52:55], v[192:195]
    ds_read_b128 a[132:135], v43 offset:24576
    ds_read_b32 a115, v61
    v_mfma_f32_16x16x32_bf16 v[196:199], a[252:255], a[20:23], v[196:199]
    ds_read_b32 a116, v63
    ds_read_b128 a[144:147], v42 offset:26624
    v_mfma_f32_16x16x32_bf16 v[196:199], a[248:251], a[16:19], v[196:199]
    buffer_load_dwordx4 v[76:79], v34, s[12:15], s72 offen sc1
    v_mfma_f32_16x16x32_bf16 v[200:203], a[248:251], a[216:219], v[200:203]
    v_perm_b32 v56, v118, v35, s37
    v_perm_b32 v57, v118, v35, s38
    v_mfma_f32_16x16x32_bf16 v[200:203], a[252:255], a[220:223], v[200:203]
    ds_read_b32 a117, v56
    ds_read_b32 a118, v57
    v_mfma_f32_16x16x32_bf16 v[204:207], a[252:255], a[28:31], v[204:207]
    ds_read_b128 a[148:151], v43 offset:26624
    v_mfma_f32_16x16x32_bf16 v[204:207], a[248:251], a[24:27], v[204:207]
    buffer_load_dwordx4 v[80:83], v44, s[12:15], s72 offen sc1
    v_mfma_f32_16x16x32_bf16 v[208:211], a[248:251], a[8:11], v[208:211]
    v_perm_b32 v58, v118, v35, s39
    v_perm_b32 v59, v115, v35, s36
    v_mfma_f32_16x16x32_bf16 v[208:211], a[252:255], a[12:15], v[208:211]
    ds_read_b32 a119, v58
    ds_read_b32 a88, v59
    v_mfma_f32_16x16x32_bf16 v[212:215], a[252:255], a[76:79], v[212:215]
    ds_read_b128 a[168:171], v42 offset:28672
    v_mfma_f32_16x16x32_bf16 v[212:215], a[248:251], a[72:75], v[212:215]
    buffer_load_dwordx2 v[84:85], v22, s[32:35], 0 offen offset:16
    v_mfma_f32_16x16x32_bf16 v[216:219], a[248:251], a[96:99], v[216:219]
    v_perm_b32 v62, v115, v35, s37
    v_perm_b32 v60, v119, v35, s36
    v_mfma_f32_16x16x32_bf16 v[216:219], a[252:255], a[100:103], v[216:219]
    ds_read_b128 a[172:175], v43 offset:28672
    ds_read_b32 a89, v62
    v_perm_b32 v61, v119, v35, s37
    v_mfma_f32_16x16x32_bf16 v[220:223], a[252:255], a[84:87], v[220:223]
    s_waitcnt lgkmcnt(6)
    ds_read_b32 a90, v60
    ds_read_b32 a91, v61
    v_mfma_f32_16x16x32_bf16 v[220:223], a[248:251], a[80:83], v[220:223]
    buffer_load_dword v86, v23, s[32:35], 0 offen
    v_mfma_f32_16x16x32_bf16 v[224:227], a[32:35], a[50:53], v[224:227]
    ds_read_b128 a[184:187], v42 offset:30720
    v_perm_b32 v63, v123, v35, s36
    v_perm_b32 v56, v123, v35, s37
    v_mfma_f32_16x16x32_bf16 v[224:227], a[36:39], a[178:181], v[224:227]
    ds_read_b32 a92, v63
    ds_read_b32 a93, v56
    v_mfma_f32_16x16x32_bf16 v[228:231], a[36:39], a[162:165], v[228:231]
    ds_read_b128 a[188:191], v43 offset:30720
    v_perm_b32 v57, v127, v35, s36
    v_mfma_f32_16x16x32_bf16 v[228:231], a[32:35], a[18:21], v[228:231]
    ds_read_b32 a94, v57
    v_perm_b32 v58, v127, v35, s37
    v_mfma_f32_16x16x32_bf16 v[232:235], a[32:35], a[218:221], v[232:235]
    s_waitcnt vmcnt(18)
    ds_read_b32 a95, v58
    v_bitop3_b32 v59, v91, v95, s76 bitop3:0x7e
    v_mfma_f32_16x16x32_bf16 v[232:235], a[36:39], a[58:61], v[232:235]
    v_cmp_lt_u32 vcc, 0xffff, v59
    v_perm_b32 v62, v120, v35, s36
    v_mfma_f32_16x16x32_bf16 v[236:239], a[36:39], a[122:125], v[236:239]
    ds_read_b32 a64, v62
    v_perm_b32 v60, v120, v35, s37
    v_mfma_f32_16x16x32_bf16 v[236:239], a[32:35], a[26:29], v[236:239]
    ds_read_b32 a65, v60
    s_cbranch_vccnz L_slow6_0
L_back6_0:
    v_mfma_f32_16x16x32_bf16 v[240:243], a[32:35], a[10:13], v[240:243]
    v_perm_b32 v61, v120, v35, s38
    v_perm_b32 v63, v120, v35, s39
    v_mfma_f32_16x16x32_bf16 v[240:243], a[36:39], a[130:133], v[240:243]
    s_waitcnt lgkmcnt(7)
    ds_read_b32 a66, v61
    ds_read_b32 a67, v63
    v_mfma_f32_16x16x32_bf16 v[244:247], a[36:39], a[146:149], v[244:247]
    s_waitcnt vmcnt(15)
    v_bitop3_b32 v56, v51, v55, s76 bitop3:0x7e
    v_perm_b32 v57, v124, v35, s36
    v_mfma_f32_16x16x32_bf16 v[244:247], a[32:35], a[74:77], v[244:247]
    s_waitcnt lgkmcnt(6)
    ds_read_b32 a68, v57
    v_cmp_lt_u32 vcc, 0xffff, v56
    v_mfma_f32_16x16x32_bf16 v[248:251], a[32:35], a[98:101], v[248:251]
    s_barrier
    v_mfma_f32_16x16x32_bf16 v[248:251], a[36:39], a[170:173], v[248:251]
    buffer_load_dwordx4 v36, s[8:11], s56 offen offset:0  lds
    v_mfma_f32_16x16x32_bf16 v[252:255], a[36:39], a[186:189], v[252:255]
    v_perm_b32 v58, v124, v35, s37
    s_cbranch_vccnz L_slow6_1
L_back6_1:
    v_mfma_f32_16x16x32_bf16 v[252:255], a[32:35], a[82:85], v[252:255]
    ds_read_b32 a69, v58
    v_perm_b32 v59, v124, v35, s38
    v_perm_b32 v62, v124, v35, s39
    v_mfma_f32_16x16x32_bf16 v[128:131], a[0:3], a[176:179], v[128:131]
    ds_read_b32 a70, v59
    ds_read_b32 a71, v62
    v_mfma_f32_16x16x32_bf16 v[128:131], a[4:7], a[180:183], v[128:131]
    buffer_load_dwordx4 v37, s[8:11], s56 offen offset:1024  lds
    v_mfma_f32_16x16x32_bf16 v[132:135], a[4:7], a[164:167], v[132:135]
    v_perm_b32 v60, v121, v35, s36
    v_perm_b32 v61, v121, v35, s37
    v_mfma_f32_16x16x32_bf16 v[132:135], a[0:3], a[160:163], v[132:135]
    ds_read_b32 a200, v60
    ds_read_b32 a201, v61
    v_mfma_f32_16x16x32_bf16 v[136:139], a[0:3], a[56:59], v[136:139]
    ds_read_b128 a[224:227], v40 offset:0
L_pad3:
    s_cbranch_execz L_pad4
    v_mfma_f32_16x16x32_bf16 v[136:139], a[4:7], a[60:63], v[136:139]
    buffer_load_dwordx4 v38, s[8:11], s56 offen offset:2048  lds
    v_mfma_f32_16x16x32_bf16 v[140:143], a[4:7], a[124:127], v[140:143]
    v_perm_b32 v63, v121, v35, s38
    v_perm_b32 v56, v121, v35, s39
    v_mfma_f32_16x16x32_bf16 v[140:143], a[0:3], a[120:123], v[140:143]
    ds_read_b32 a202, v63
    ds_read_b32 a203, v56
    v_perm_b32 v57, v125, v35, s36
    v_mfma_f32_16x16x32_bf16 v[144:147], a[0:3], a[128:131], v[144:147]
    ds_read_b32 a204, v57
    ds_read_b128 a[228:231], v41 offset:0
    v_mfma_f32_16x16x32_bf16 v[144:147], a[4:7], a[132:135], v[144:147]
    buffer_load_dwordx4 v39, s[8:11], s56 offen offset:3072  lds
    v_mfma_f32_16x16x32_bf16 v[148:151], a[4:7], a[148:151], v[148:151]
    s_add_u32 m0, s57, 81920
    v_perm_b32 v58, v125, v35, s37
    v_perm_b32 v59, v125, v35, s38
    v_mfma_f32_16x16x32_bf16 v[148:151], a[0:3], a[144:147], v[148:151]
    ds_read_b32 a205, v58
    ds_read_b32 a206, v59
    v_mfma_f32_16x16x32_bf16 v[152:155], a[0:3], a[168:171], v[152:155]
    ds_read_b128 a[152:155], v40 offset:2048
    v_mfma_f32_16x16x32_bf16 v[152:155], a[4:7], a[172:175], v[152:155]
    buffer_load_dwordx4 v36, s[8:11], s3 offen offset:0  lds
    v_mfma_f32_16x16x32_bf16 v[156:159], a[4:7], a[188:191], v[156:159]
    v_perm_b32 v62, v125, v35, s39
    v_perm_b32 v60, v122, v35, s36
    v_mfma_f32_16x16x32_bf16 v[156:159], a[0:3], a[184:187], v[156:159]
    ds_read_b128 a[156:159], v41 offset:2048
    ds_read_b32 a207, v62
    v_perm_b32 v61, v122, v35, s37
    v_mfma_f32_16x16x32_bf16 v[160:163], a[240:243], a[176:179], v[160:163]
    ds_read_b32 a232, v60
    ds_read_b32 a233, v61
    v_mfma_f32_16x16x32_bf16 v[160:163], a[244:247], a[180:183], v[160:163]
    ds_read_b128 a[192:195], v40 offset:4096
    v_mfma_f32_16x16x32_bf16 v[164:167], a[244:247], a[164:167], v[164:167]
    buffer_load_dwordx4 v37, s[8:11], s3 offen offset:1024  lds
    v_mfma_f32_16x16x32_bf16 v[164:167], a[240:243], a[160:163], v[164:167]
    v_perm_b32 v63, v122, v35, s38
    v_perm_b32 v56, v122, v35, s39
    v_mfma_f32_16x16x32_bf16 v[168:171], a[240:243], a[56:59], v[168:171]
    ds_read_b32 a234, v63
    ds_read_b32 a235, v56
    v_perm_b32 v57, v126, v35, s36
    v_mfma_f32_16x16x32_bf16 v[168:171], a[244:247], a[60:63], v[168:171]
    ds_read_b128 a[196:199], v41 offset:4096
    ds_read_b32 a236, v57
    v_perm_b32 v58, v126, v35, s37
    v_mfma_f32_16x16x32_bf16 v[172:175], a[244:247], a[124:127], v[172:175]
    ds_read_b32 a237, v58
    v_perm_b32 v59, v126, v35, s38
    v_mfma_f32_16x16x32_bf16 v[172:175], a[240:243], a[120:123], v[172:175]
    ds_read_b32 a238, v59
    v_perm_b32 v62, v126, v35, s39
    v_mfma_f32_16x16x32_bf16 v[176:179], a[240:243], a[128:131], v[176:179]
    ds_read_b128 a[208:211], v40 offset:6144
    ds_read_b32 a239, v62
    v_mfma_f32_16x16x32_bf16 v[176:179], a[244:247], a[132:135], v[176:179]
    ds_read_b128 a[212:215], v41 offset:6144
    v_mfma_f32_16x16x32_bf16 v[180:183], a[244:247], a[148:151], v[180:183]
    buffer_load_dwordx4 v38, s[8:11], s3 offen offset:2048  lds
    v_mfma_f32_16x16x32_bf16 v[180:183], a[240:243], a[144:147], v[180:183]
    v_perm_b32 v60, v91, v35, s36
    v_perm_b32 v61, v91, v35, s37
    v_mfma_f32_16x16x32_bf16 v[184:187], a[240:243], a[168:171], v[184:187]
    ds_read_b32 a248, v60
    ds_read_b32 a249, v61
    v_mfma_f32_16x16x32_bf16 v[184:187], a[244:247], a[172:175], v[184:187]
    v_perm_b32 v63, v95, v35, s36
    v_perm_b32 v56, v95, v35, s37
    v_mfma_f32_16x16x32_bf16 v[188:191], a[244:247], a[188:191], v[188:191]
    ds_read_b128 a[48:51], v40 offset:8192
    ds_read_b32 a250, v63
    v_mfma_f32_16x16x32_bf16 v[188:191], a[240:243], a[184:187], v[188:191]
    ds_read_b32 a251, v56
    v_perm_b32 v57, v51, v35, s36
    v_mfma_f32_16x16x32_bf16 v[192:195], a[40:43], a[176:179], v[192:195]
    ds_read_b32 a252, v57
    ds_read_b128 a[52:55], v41 offset:8192
    v_mfma_f32_16x16x32_bf16 v[192:195], a[44:47], a[180:183], v[192:195]
    buffer_load_dwordx4 v39, s[8:11], s3 offen offset:3072  lds
    v_mfma_f32_16x16x32_bf16 v[196:199], a[44:47], a[164:167], v[196:199]
    v_perm_b32 v58, v51, v35, s37
    v_perm_b32 v59, v55, v35, s36
    v_mfma_f32_16x16x32_bf16 v[196:199], a[40:43], a[160:163], v[196:199]
    ds_read_b32 a253, v58
    ds_read_b32 a254, v59
    v_mfma_f32_16x16x32_bf16 v[200:203], a[40:43], a[56:59], v[200:203]
    ds_read_b128 a[16:19], v40 offset:10240
    v_perm_b32 v62, v55, v35, s37
    v_mfma_f32_16x16x32_bf16 v[200:203], a[44:47], a[60:63], v[200:203]
    ds_read_b32 a255, v62
    v_perm_b32 v60, v88, v35, s36
    v_mfma_f32_16x16x32_bf16 v[204:207], a[44:47], a[124:127], v[204:207]
    ds_read_b32 a216, v60
    v_perm_b32 v61, v88, v35, s37
    v_mfma_f32_16x16x32_bf16 v[204:207], a[40:43], a[120:123], v[204:207]
    ds_read_b128 a[20:23], v41 offset:10240
    ds_read_b32 a217, v61
    v_mfma_f32_16x16x32_bf16 v[208:211], a[40:43], a[128:131], v[208:211]
    v_perm_b32 v63, v88, v35, s38
    v_perm_b32 v56, v88, v35, s39
    v_mfma_f32_16x16x32_bf16 v[208:211], a[44:47], a[132:135], v[208:211]
    ds_read_b32 a218, v63
    ds_read_b32 a219, v56
    v_mfma_f32_16x16x32_bf16 v[212:215], a[44:47], a[148:151], v[212:215]
    ds_read_b128 a[24:27], v40 offset:12288
    v_perm_b32 v57, v92, v35, s36
    v_mfma_f32_16x16x32_bf16 v[212:215], a[40:43], a[144:147], v[212:215]
    ds_read_b32 a220, v57
    v_perm_b32 v58, v92, v35, s37
    v_mfma_f32_16x16x32_bf16 v[216:219], a[40:43], a[168:171], v[216:219]
    ds_read_b32 a221, v58
    v_perm_b32 v59, v92, v35, s38
    v_mfma_f32_16x16x32_bf16 v[216:219], a[44:47], a[172:175], v[216:219]
    ds_read_b128 a[28:31], v41 offset:12288
    ds_read_b32 a222, v59
    v_mfma_f32_16x16x32_bf16 v[220:223], a[44:47], a[188:191], v[220:223]
    v_perm_b32 v62, v92, v35, s39
    v_perm_b32 v60, v48, v35, s36
    v_mfma_f32_16x16x32_bf16 v[220:223], a[40:43], a[184:187], v[220:223]
    s_waitcnt lgkmcnt(9)
    ds_read_b32 a223, v62
    ds_read_b32 a8, v60
    v_mfma_f32_16x16x32_bf16 v[128:131], a[136:139], a[224:227], v[128:131]
    v_perm_b32 v61, v48, v35, s37
    v_perm_b32 v63, v48, v35, s38
    v_mfma_f32_16x16x32_bf16 v[128:131], a[140:143], a[228:231], v[128:131]
    ds_read_b32 a9, v61
    ds_read_b32 a10, v63
    v_mfma_f32_16x16x32_bf16 v[132:135], a[140:143], a[156:159], v[132:135]
    v_perm_b32 v56, v48, v35, s39
    v_perm_b32 v57, v52, v35, s36
    v_mfma_f32_16x16x32_bf16 v[132:135], a[136:139], a[152:155], v[132:135]
    ds_read_b32 a11, v56
    ds_read_b32 a12, v57
    v_mfma_f32_16x16x32_bf16 v[136:139], a[136:139], a[192:195], v[136:139]
    v_perm_b32 v58, v52, v35, s37
    v_perm_b32 v59, v52, v35, s38
    v_mfma_f32_16x16x32_bf16 v[136:139], a[140:143], a[196:199], v[136:139]
    ds_read_b32 a13, v58
    ds_read_b32 a14, v59
    v_mfma_f32_16x16x32_bf16 v[140:143], a[140:143], a[212:215], v[140:143]
    ds_read_b128 a[72:75], v40 offset:16384
    v_perm_b32 v62, v52, v35, s39
    v_mfma_f32_16x16x32_bf16 v[140:143], a[136:139], a[208:211], v[140:143]
    ds_read_b32 a15, v62
    v_perm_b32 v60, v89, v35, s36
    v_mfma_f32_16x16x32_bf16 v[144:147], a[136:139], a[48:51], v[144:147]
    ds_read_b32 a96, v60
    v_perm_b32 v61, v89, v35, s37
    v_mfma_f32_16x16x32_bf16 v[144:147], a[140:143], a[52:55], v[144:147]
    s_waitcnt lgkmcnt(9)
    ds_read_b128 a[76:79], v41 offset:16384
    ds_read_b32 a97, v61
    v_mfma_f32_16x16x32_bf16 v[148:151], a[140:143], a[20:23], v[148:151]
    v_perm_b32 v63, v89, v35, s38
    v_perm_b32 v56, v89, v35, s39
    v_mfma_f32_16x16x32_bf16 v[148:151], a[136:139], a[16:19], v[148:151]
    ds_read_b32 a98, v63
    ds_read_b32 a99, v56
    v_mfma_f32_16x16x32_bf16 v[152:155], a[136:139], a[24:27], v[152:155]
    ds_read_b128 a[32:35], v40 offset:18432
    v_perm_b32 v57, v93, v35, s36
    v_mfma_f32_16x16x32_bf16 v[152:155], a[140:143], a[28:31], v[152:155]
    ds_read_b32 a100, v57
    v_perm_b32 v58, v93, v35, s37
    v_mfma_f32_16x16x32_bf16 v[160:163], a[104:107], a[224:227], v[160:163]
    ds_read_b32 a101, v58
    v_perm_b32 v59, v93, v35, s38
    v_mfma_f32_16x16x32_bf16 v[160:163], a[108:111], a[228:231], v[160:163]
    ds_read_b128 a[36:39], v41 offset:18432
    ds_read_b32 a102, v59
    v_mfma_f32_16x16x32_bf16 v[164:167], a[108:111], a[156:159], v[164:167]
    s_waitcnt vmcnt(12)
    v_perm_b32 v60, v93, v35, s39
    v_bitop3_b32 v62, v71, v75, s76 bitop3:0x7e
    v_mfma_f32_16x16x32_bf16 v[164:167], a[104:107], a[152:155], v[164:167]
    ds_read_b32 a103, v60
    v_cmp_lt_u32 vcc, 0xffff, v62
    v_mfma_f32_16x16x32_bf16 v[168:171], a[104:107], a[192:195], v[168:171]
    ds_read_b128 a[80:83], v40 offset:20480
    v_perm_b32 v61, v49, v35, s36
    v_mfma_f32_16x16x32_bf16 v[168:171], a[108:111], a[196:199], v[168:171]
    ds_read_b32 a0, v61
    s_cbranch_vccnz L_slow7_0
L_back7_0:
    v_mfma_f32_16x16x32_bf16 v[172:175], a[108:111], a[212:215], v[172:175]
    v_perm_b32 v63, v49, v35, s37
    v_perm_b32 v56, v49, v35, s38
    v_mfma_f32_16x16x32_bf16 v[172:175], a[104:107], a[208:211], v[172:175]
    ds_read_b128 a[84:87], v41 offset:20480
    ds_read_b32 a1, v63
    v_mfma_f32_16x16x32_bf16 v[176:179], a[104:107], a[48:51], v[176:179]
    ds_read_b32 a2, v56
    v_perm_b32 v57, v49, v35, s39
    v_mfma_f32_16x16x32_bf16 v[176:179], a[108:111], a[52:55], v[176:179]
    s_waitcnt vmcnt(10)
    ds_read_b32 a3, v57
    v_bitop3_b32 v58, v79, v83, s76 bitop3:0x7e
    v_mfma_f32_16x16x32_bf16 v[180:183], a[108:111], a[20:23], v[180:183]
    ds_read_b128 a[240:243], v40 offset:22528
    v_cmp_lt_u32 vcc, 0xffff, v58
    v_mfma_f32_16x16x32_bf16 v[180:183], a[104:107], a[16:19], v[180:183]
    v_perm_b32 v59, v53, v35, s36
    v_perm_b32 v62, v53, v35, s37
    v_mfma_f32_16x16x32_bf16 v[184:187], a[104:107], a[24:27], v[184:187]
    ds_read_b32 a4, v59
    ds_read_b32 a5, v62
    v_mfma_f32_16x16x32_bf16 v[184:187], a[108:111], a[28:31], v[184:187]
    ds_read_b128 a[244:247], v41 offset:22528
    s_cbranch_vccnz L_slow7_1
L_back7_1:
    v_mfma_f32_16x16x32_bf16 v[192:195], a[112:115], a[224:227], v[192:195]
    v_perm_b32 v60, v53, v35, s38
    v_perm_b32 v61, v53, v35, s39
    v_mfma_f32_16x16x32_bf16 v[192:195], a[116:119], a[228:231], v[192:195]
    ds_read_b32 a6, v60
    ds_read_b32 a7, v61
    v_mfma_f32_16x16x32_bf16 v[196:199], a[116:119], a[156:159], v[196:199]
    ds_read_b128 a[176:179], v40 offset:24576
    v_perm_b32 v63, v90, v35, s36
    v_mfma_f32_16x16x32_bf16 v[196:199], a[112:115], a[152:155], v[196:199]
    ds_read_b32 a160, v63
    v_perm_b32 v56, v90, v35, s37
    v_mfma_f32_16x16x32_bf16 v[200:203], a[112:115], a[192:195], v[200:203]
    ds_read_b32 a161, v56
    v_perm_b32 v57, v90, v35, s38
    v_mfma_f32_16x16x32_bf16 v[200:203], a[116:119], a[196:199], v[200:203]
    ds_read_b128 a[180:183], v41 offset:24576
    ds_read_b32 a162, v57
    v_mfma_f32_16x16x32_bf16 v[204:207], a[116:119], a[212:215], v[204:207]
    v_perm_b32 v58, v90, v35, s39
    v_perm_b32 v59, v94, v35, s36
    v_mfma_f32_16x16x32_bf16 v[204:207], a[112:115], a[208:211], v[204:207]
    ds_read_b32 a163, v58
    ds_read_b32 a164, v59
    v_mfma_f32_16x16x32_bf16 v[208:211], a[112:115], a[48:51], v[208:211]
    ds_read_b128 a[56:59], v40 offset:26624
    v_perm_b32 v62, v94, v35, s37
    v_mfma_f32_16x16x32_bf16 v[208:211], a[116:119], a[52:55], v[208:211]
    ds_read_b32 a165, v62
    v_perm_b32 v60, v94, v35, s38
    v_mfma_f32_16x16x32_bf16 v[212:215], a[116:119], a[20:23], v[212:215]
    ds_read_b32 a166, v60
    v_perm_b32 v61, v94, v35, s39
    v_mfma_f32_16x16x32_bf16 v[212:215], a[112:115], a[16:19], v[212:215]
    ds_read_b128 a[60:63], v41 offset:26624
    ds_read_b32 a167, v61
    v_mfma_f32_16x16x32_bf16 v[216:219], a[112:115], a[24:27], v[216:219]
    v_perm_b32 v63, v50, v35, s36
    v_perm_b32 v56, v50, v35, s37
    v_mfma_f32_16x16x32_bf16 v[216:219], a[116:119], a[28:31], v[216:219]
    ds_read_b32 a120, v63
    ds_read_b32 a121, v56
    v_mfma_f32_16x16x32_bf16 v[224:227], a[88:91], a[226:229], v[224:227]
    s_waitcnt lgkmcnt(9)
    ds_read_b128 a[128:131], v40 offset:28672
    v_perm_b32 v57, v50, v35, s38
    v_mfma_f32_16x16x32_bf16 v[224:227], a[92:95], a[74:77], v[224:227]
    ds_read_b128 a[132:135], v41 offset:28672
    ds_read_b32 a122, v57
    v_mfma_f32_16x16x32_bf16 v[228:231], a[92:95], a[34:37], v[228:231]
    v_perm_b32 v58, v50, v35, s39
    v_perm_b32 v59, v54, v35, s36
    v_mfma_f32_16x16x32_bf16 v[228:231], a[88:91], a[154:157], v[228:231]
    ds_read_b32 a123, v58
    ds_read_b32 a124, v59
    v_mfma_f32_16x16x32_bf16 v[232:235], a[88:91], a[194:197], v[232:235]
    v_perm_b32 v62, v54, v35, s37
    v_perm_b32 v60, v54, v35, s38
    v_mfma_f32_16x16x32_bf16 v[232:235], a[92:95], a[82:85], v[232:235]
    ds_read_b32 a125, v62
    ds_read_b32 a126, v60
    v_mfma_f32_16x16x32_bf16 v[236:239], a[92:95], a[242:245], v[236:239]
    v_perm_b32 v61, v54, v35, s39
    v_perm_b32 v63, v71, v35, s36
    v_mfma_f32_16x16x32_bf16 v[236:239], a[88:91], a[210:213], v[236:239]
    ds_read_b32 a127, v61
    ds_read_b32 a144, v63
    v_mfma_f32_16x16x32_bf16 v[240:243], a[88:91], a[50:53], v[240:243]
    v_perm_b32 v56, v71, v35, s37
    v_perm_b32 v57, v75, v35, s36
    v_mfma_f32_16x16x32_bf16 v[240:243], a[92:95], a[178:181], v[240:243]
    s_waitcnt lgkmcnt(8)
    ds_read_b32 a145, v56
    ds_read_b32 a146, v57
    v_mfma_f32_16x16x32_bf16 v[244:247], a[92:95], a[58:61], v[244:247]
    v_perm_b32 v58, v75, v35, s37
    v_perm_b32 v59, v79, v35, s36
    v_mfma_f32_16x16x32_bf16 v[244:247], a[88:91], a[18:21], v[244:247]
    ds_read_b32 a147, v58
    ds_read_b32 a148, v59
    v_mfma_f32_16x16x32_bf16 v[248:251], a[88:91], a[26:29], v[248:251]
    s_waitcnt lgkmcnt(8)
    v_perm_b32 v62, v79, v35, s37
    v_perm_b32 v60, v83, v35, s36
    v_mfma_f32_16x16x32_bf16 v[248:251], a[92:95], a[130:133], v[248:251]
    ds_read_b32 a149, v62
    ds_read_b32 a150, v60
    v_mfma_f32_16x16x32_bf16 v[128:131], a[64:67], a[72:75], v[128:131]
    v_perm_b32 v61, v83, v35, s37
    v_perm_b32 v63, v68, v35, s36
    v_mfma_f32_16x16x32_bf16 v[128:131], a[68:71], a[76:79], v[128:131]
    ds_read_b32 a151, v61
    ds_read_b32 a168, v63
    v_mfma_f32_16x16x32_bf16 v[132:135], a[68:71], a[36:39], v[132:135]
    v_perm_b32 v56, v68, v35, s37
    v_perm_b32 v57, v68, v35, s38
    v_mfma_f32_16x16x32_bf16 v[132:135], a[64:67], a[32:35], v[132:135]
    ds_read_b32 a169, v56
    ds_read_b32 a170, v57
    v_mfma_f32_16x16x32_bf16 v[136:139], a[64:67], a[80:83], v[136:139]
    v_perm_b32 v58, v68, v35, s39
    v_perm_b32 v59, v72, v35, s36
    v_mfma_f32_16x16x32_bf16 v[136:139], a[68:71], a[84:87], v[136:139]
    ds_read_b32 a171, v58
    ds_read_b32 a172, v59
    v_mfma_f32_16x16x32_bf16 v[140:143], a[68:71], a[244:247], v[140:143]
    v_perm_b32 v62, v72, v35, s37
    v_perm_b32 v60, v72, v35, s38
    v_mfma_f32_16x16x32_bf16 v[140:143], a[64:67], a[240:243], v[140:143]
    s_waitcnt vmcnt(0)
    ds_read_b32 a173, v62
    ds_read_b32 a174, v60
    v_mfma_f32_16x16x32_bf16 v[144:147], a[64:67], a[176:179], v[144:147]
    s_barrier
    v_mfma_f32_16x16x32_bf16 v[144:147], a[68:71], a[180:183], v[144:147]
    v_perm_b32 v61, v72, v35, s39
    v_perm_b32 v63, v76, v35, s36
    v_mfma_f32_16x16x32_bf16 v[148:151], a[68:71], a[60:63], v[148:151]
    ds_read_b32 a175, v61
    ds_read_b32 a40, v63
    v_mfma_f32_16x16x32_bf16 v[148:151], a[64:67], a[56:59], v[148:151]
    v_perm_b32 v56, v76, v35, s37
    v_perm_b32 v57, v76, v35, s38
    v_mfma_f32_16x16x32_bf16 v[152:155], a[64:67], a[128:131], v[152:155]
    ds_read_b32 a41, v56
    ds_read_b32 a42, v57
    v_mfma_f32_16x16x32_bf16 v[152:155], a[68:71], a[132:135], v[152:155]
    ds_read_b128 a[184:187], v40 offset:32768
    v_perm_b32 v58, v76, v35, s39
    v_mfma_f32_16x16x32_bf16 v[160:163], a[200:203], a[72:75], v[160:163]
    ds_read_b32 a43, v58
    v_perm_b32 v59, v80, v35, s36
    v_mfma_f32_16x16x32_bf16 v[160:163], a[204:207], a[76:79], v[160:163]
    ds_read_b32 a44, v59
    v_perm_b32 v62, v80, v35, s37
    v_mfma_f32_16x16x32_bf16 v[164:167], a[204:207], a[36:39], v[164:167]
    ds_read_b128 a[188:191], v41 offset:32768
    ds_read_b32 a45, v62
    v_mfma_f32_16x16x32_bf16 v[164:167], a[200:203], a[32:35], v[164:167]
    v_perm_b32 v60, v80, v35, s38
    v_perm_b32 v61, v80, v35, s39
    v_mfma_f32_16x16x32_bf16 v[168:171], a[200:203], a[80:83], v[168:171]
    ds_read_b32 a46, v60
    ds_read_b32 a47, v61
    v_mfma_f32_16x16x32_bf16 v[168:171], a[204:207], a[84:87], v[168:171]
    v_perm_b32 v63, v69, v35, s36
    v_perm_b32 v56, v69, v35, s37
    v_mfma_f32_16x16x32_bf16 v[172:175], a[204:207], a[244:247], v[172:175]
    ds_read_b128 a[224:227], v40 offset:49152
    ds_read_b32 a152, v63
    v_mfma_f32_16x16x32_bf16 v[172:175], a[200:203], a[240:243], v[172:175]
    ds_read_b32 a153, v56
    v_perm_b32 v57, v69, v35, s38
    v_mfma_f32_16x16x32_bf16 v[176:179], a[200:203], a[176:179], v[176:179]
    ds_read_b32 a154, v57
    v_perm_b32 v58, v73, v35, s36
    v_mfma_f32_16x16x32_bf16 v[176:179], a[204:207], a[180:183], v[176:179]
    ds_read_b128 a[228:231], v41 offset:49152
    ds_read_b32 a156, v58
    v_mfma_f32_16x16x32_bf16 v[180:183], a[204:207], a[60:63], v[180:183]
    v_perm_b32 v62, v73, v35, s37
    v_perm_b32 v59, v69, v35, s39
    v_mfma_f32_16x16x32_bf16 v[180:183], a[200:203], a[56:59], v[180:183]
    ds_read_b32 a157, v62
    ds_read_b32 a155, v59
    v_perm_b32 v60, v73, v35, s38
    v_mfma_f32_16x16x32_bf16 v[184:187], a[200:203], a[128:131], v[184:187]
    ds_read_b32 a158, v60
    v_perm_b32 v61, v77, v35, s36
    v_mfma_f32_16x16x32_bf16 v[184:187], a[204:207], a[132:135], v[184:187]
    ds_read_b128 a[192:195], v42 offset:0
    ds_read_b32 a208, v61
    v_mfma_f32_16x16x32_bf16 v[192:195], a[232:235], a[72:75], v[192:195]
    v_perm_b32 v56, v77, v35, s37
    v_perm_b32 v63, v73, v35, s39
    v_mfma_f32_16x16x32_bf16 v[192:195], a[236:239], a[76:79], v[192:195]
    ds_read_b32 a209, v56
    v_perm_b32 v57, v77, v35, s38
    v_mfma_f32_16x16x32_bf16 v[196:199], a[236:239], a[36:39], v[196:199]
    ds_read_b128 a[196:199], v43 offset:0
    v_perm_b32 v58, v81, v35, s36
    v_mfma_f32_16x16x32_bf16 v[196:199], a[232:235], a[32:35], v[196:199]
    ds_read_b32 a212, v58
    ds_read_b32 a159, v63
    v_perm_b32 v59, v81, v35, s37
    v_mfma_f32_16x16x32_bf16 v[200:203], a[232:235], a[80:83], v[200:203]
    ds_read_b32 a210, v57
    v_perm_b32 v62, v77, v35, s39
    v_mfma_f32_16x16x32_bf16 v[200:203], a[236:239], a[84:87], v[200:203]
    ds_read_b32 a213, v59
    v_perm_b32 v60, v81, v35, s38
    v_mfma_f32_16x16x32_bf16 v[204:207], a[236:239], a[244:247], v[204:207]
    ds_read_b128 a[48:51], v42 offset:16384
    v_perm_b32 v61, v70, v35, s36
    v_mfma_f32_16x16x32_bf16 v[204:207], a[232:235], a[240:243], v[204:207]
    ds_read_b32 a16, v61
    v_perm_b32 v56, v70, v35, s37
    v_mfma_f32_16x16x32_bf16 v[208:211], a[232:235], a[176:179], v[208:211]
    ds_read_b32 a211, v62
    ds_read_b32 a214, v60
    v_mfma_f32_16x16x32_bf16 v[208:211], a[236:239], a[180:183], v[208:211]
    ds_read_b128 a[52:55], v43 offset:16384
    v_perm_b32 v63, v81, v35, s39
    v_mfma_f32_16x16x32_bf16 v[212:215], a[236:239], a[60:63], v[212:215]
    ds_read_b32 a17, v56
    v_perm_b32 v58, v74, v35, s36
    v_mfma_f32_16x16x32_bf16 v[212:215], a[232:235], a[56:59], v[212:215]
    ds_read_b32 a20, v58
    v_perm_b32 v57, v70, v35, s38
    v_mfma_f32_16x16x32_bf16 v[216:219], a[232:235], a[128:131], v[216:219]
    ds_read_b32 a215, v63
    v_perm_b32 v59, v74, v35, s37
    v_mfma_f32_16x16x32_bf16 v[216:219], a[236:239], a[132:135], v[216:219]
    s_waitcnt lgkmcnt(9)
    ds_read_b32 a18, v57
    v_perm_b32 v61, v70, v35, s39
    v_mfma_f32_16x16x32_bf16 v[224:227], a[248:251], a[186:189], v[224:227]
    s_mov_b32 s66, 0
    ds_read_b32 a21, v59
    v_perm_b32 v62, v78, v35, s36
    v_mfma_f32_16x16x32_bf16 v[224:227], a[252:255], a[226:229], v[224:227]
    s_mov_b32 s67, 14336
    v_perm_b32 v60, v74, v35, s38
    v_perm_b32 v56, v78, v35, s37
    v_mfma_f32_16x16x32_bf16 v[128:131], a[216:219], a[184:187], v[128:131]
    ds_read_b32 a24, v62
    ds_read_b32 a19, v61
    v_mfma_f32_16x16x32_bf16 v[128:131], a[220:223], a[188:191], v[128:131]
    ds_read_b32 a22, v60
    v_perm_b32 v58, v74, v35, s39
    v_mfma_f32_16x16x32_bf16 v[128:131], a[8:11], a[224:227], v[128:131]
    ds_read_b32 a25, v56
    v_perm_b32 v63, v78, v35, s38
    v_mfma_f32_16x16x32_bf16 v[128:131], a[12:15], a[228:231], v[128:131]
    ds_read_b32 a23, v58
    ds_read_b32 a26, v63
    v_mfma_f32_16x16x32_bf16 v[160:163], a[96:99], a[184:187], v[160:163]
    v_perm_b32 v59, v82, v35, s36
    v_perm_b32 v57, v78, v35, s39
    v_mfma_f32_16x16x32_bf16 v[160:163], a[100:103], a[188:191], v[160:163]
    ds_read_b32 a27, v57
    v_perm_b32 v61, v82, v35, s37
    v_mfma_f32_16x16x32_bf16 v[160:163], a[0:3], a[224:227], v[160:163]
    ds_read_b32 a28, v59
    ds_read_b128 a[72:75], v40 offset:34816
    v_mfma_f32_16x16x32_bf16 v[160:163], a[4:7], a[228:231], v[160:163]
    ds_read_b32 a29, v61
    v_perm_b32 v62, v82, v35, s38
    v_mfma_f32_16x16x32_bf16 v[192:195], a[160:163], a[184:187], v[192:195]
    ds_read_b128 a[76:79], v41 offset:34816
    ds_read_b32 a30, v62
    v_mfma_f32_16x16x32_bf16 v[192:195], a[164:167], a[188:191], v[192:195]
    ds_read_b128 a[32:35], v40 offset:51200
    v_perm_b32 v60, v82, v35, s39
    v_mfma_f32_16x16x32_bf16 v[192:195], a[120:123], a[224:227], v[192:195]
    ds_read_b128 a[36:39], v41 offset:51200
    ds_read_b32 a31, v60
    v_mfma_f32_16x16x32_bf16 v[192:195], a[124:127], a[228:231], v[192:195]
    v_lshlrev_b32 v96, 16, v86
    v_and_b32 v97, 0xffff0000, v86
    v_mfma_f32_16x16x32_bf16 v[224:227], a[144:147], a[194:197], v[224:227]
    s_waitcnt lgkmcnt(9)
    ds_read_b128 a[80:83], v42 offset:2048
    v_lshlrev_b32 v100, 16, v64
    v_mfma_f32_16x16x32_bf16 v[224:227], a[148:151], a[50:53], v[224:227]
    ds_read_b128 a[84:87], v43 offset:2048
    v_and_b32 v101, 0xffff0000, v65
    v_mfma_f32_16x16x32_bf16 v[128:131], a[168:171], a[192:195], v[128:131]
    v_lshlrev_b32 v102, 16, v67
    v_and_b32 v103, 0xffff0000, v84
    v_mfma_f32_16x16x32_bf16 v[128:131], a[172:175], a[196:199], v[128:131]
    ds_read_b128 a[240:243], v42 offset:18432
    v_and_b32 v104, 0xffff0000, v64
    v_mfma_f32_16x16x32_bf16 v[128:131], a[40:43], a[48:51], v[128:131]
    v_lshlrev_b32 v105, 16, v66
    v_and_b32 v106, 0xffff0000, v67
    v_mfma_f32_16x16x32_bf16 v[128:131], a[44:47], a[52:55], v[128:131]
    ds_read_b128 a[244:247], v43 offset:18432
    v_lshlrev_b32 v107, 16, v85
    v_mfma_f32_16x16x32_bf16 v[160:163], a[152:155], a[192:195], v[160:163]
    ds_write_b64 v29, v[226:227] offset:28928
    v_lshlrev_b32 v108, 16, v65
    v_mfma_f32_16x16x32_bf16 v[160:163], a[156:159], a[196:199], v[160:163]
    v_and_b32 v109, 0xffff0000, v66
    v_lshlrev_b32 v110, 16, v84
    v_mfma_f32_16x16x32_bf16 v[160:163], a[208:211], a[48:51], v[160:163]
    ds_read_b128 a[176:179], v40 offset:36864
    v_and_b32 v111, 0xffff0000, v85
    v_mfma_f32_16x16x32_bf16 v[160:163], a[212:215], a[52:55], v[160:163]
    v_mul_f32 v128, v128, v100
    v_mul_f32 v129, v129, v101
    v_mfma_f32_16x16x32_bf16 v[192:195], a[16:19], a[192:195], v[192:195]
    v_mul_f32 v130, v130, v102
    v_mul_f32 v131, v131, v103
    v_mfma_f32_16x16x32_bf16 v[192:195], a[20:23], a[196:199], v[192:195]
    s_waitcnt lgkmcnt(1)
    s_barrier
    v_mfma_f32_16x16x32_bf16 v[192:195], a[24:27], a[48:51], v[192:195]
    ds_read_b64 v[112:113], v30 offset:28928
    ds_read_b128 a[180:183], v41 offset:36864
    v_mfma_f32_16x16x32_bf16 v[192:195], a[28:31], a[52:55], v[192:195]
    v_mul_f32 v160, v160, v104
    v_cvt_pk_bf16_f32 v116, v128, v160
    v_mfma_f32_16x16x32_bf16 v[228:231], a[248:251], a[74:77], v[228:231]
    v_mul_f32 v161, v161, v105
    v_mul_f32 v162, v162, v106
    v_mfma_f32_16x16x32_bf16 v[228:231], a[252:255], a[34:37], v[228:231]
    ds_read_b128 a[56:59], v40 offset:53248
    v_cvt_pk_bf16_f32 v119, v130, v162
L_pad4:
    s_cbranch_execz L_warmed
    v_mfma_f32_16x16x32_bf16 v[228:231], a[144:147], a[82:85], v[228:231]
    v_mul_f32 v163, v163, v107
    v_mov_b32 v8, 1
    v_mfma_f32_16x16x32_bf16 v[228:231], a[148:151], a[242:245], v[228:231]
    v_mul_f32 v192, v192, v108
    v_mul_f32 v193, v193, v109
    v_mfma_f32_16x16x32_bf16 v[132:135], a[216:219], a[72:75], v[132:135]
    v_mul_f32 v194, v194, v110
    v_mul_f32 v195, v195, v111
    v_mfma_f32_16x16x32_bf16 v[132:135], a[220:223], a[76:79], v[132:135]
    v_cvt_pk_bf16_f32 v117, v192, v129
    v_cvt_pk_bf16_f32 v118, v161, v193
    v_mfma_f32_16x16x32_bf16 v[132:135], a[8:11], a[32:35], v[132:135]
    ds_write_b64 v26, v[116:117] offset:64512
    v_cvt_pk_bf16_f32 v120, v194, v131
    v_mfma_f32_16x16x32_bf16 v[132:135], a[12:15], a[36:39], v[132:135]
    ds_write_b64 v26, v[118:119] offset:64520
    v_cvt_pk_bf16_f32 v121, v163, v195
    v_mfma_f32_16x16x32_bf16 v[132:135], a[168:171], a[80:83], v[132:135]
    s_waitcnt lgkmcnt(3)
    ds_write_b64 v26, v[120:121] offset:64528
    v_add_f32 v224, v224, v112
    v_mfma_f32_16x16x32_bf16 v[132:135], a[172:175], a[84:87], v[132:135]
    ds_read_b128 a[60:63], v41 offset:53248
    v_mul_f32 v224, v224, v96
    v_mfma_f32_16x16x32_bf16 v[132:135], a[40:43], a[240:243], v[132:135]
    v_add_f32 v225, v225, v113
    v_mul_f32 v225, v225, v97
    v_mfma_f32_16x16x32_bf16 v[132:135], a[44:47], a[244:247], v[132:135]
    ds_write_b64 v29, v[230:231] offset:30976
    v_cvt_pk_bf16_f32 v112, v224, v225
    v_mfma_f32_16x16x32_bf16 v[164:167], a[96:99], a[72:75], v[164:167]
    ds_write_b32 v28, v112 offset:64512
    v_min_u32 v9, 1, v0
    v_mfma_f32_16x16x32_bf16 v[164:167], a[100:103], a[76:79], v[164:167]
    ds_read_b128 a[128:131], v42 offset:4096
    v_lshlrev_b32 v9, 30, v9
    v_mfma_f32_16x16x32_bf16 v[164:167], a[0:3], a[32:35], v[164:167]
    ds_read_b128 a[132:135], v43 offset:4096
    v_mfma_f32_16x16x32_bf16 v[164:167], a[4:7], a[36:39], v[164:167]
    buffer_atomic_add v8, v9, s[24:27], s77 offen sc0 sc1
    v_mfma_f32_16x16x32_bf16 v[164:167], a[152:155], a[80:83], v[164:167]
    ds_read_b128 a[184:187], v42 offset:20480
    v_mul_f32 v132, v132, v100
    v_mfma_f32_16x16x32_bf16 v[164:167], a[156:159], a[84:87], v[164:167]
    s_waitcnt lgkmcnt(3)
    s_barrier
    v_mfma_f32_16x16x32_bf16 v[164:167], a[208:211], a[240:243], v[164:167]
    ds_read_b128 v[124:127], v24 offset:64512
    ds_read_b64 v[88:89], v30 offset:30976
    v_mfma_f32_16x16x32_bf16 v[164:167], a[212:215], a[244:247], v[164:167]
    ds_read_b128 a[188:191], v43 offset:20480
    v_mul_f32 v133, v133, v101
    v_mfma_f32_16x16x32_bf16 v[196:199], a[160:163], a[72:75], v[196:199]
    ds_read_b128 v[92:95], v24 offset:65440
    v_mul_f32 v134, v134, v102
    v_mfma_f32_16x16x32_bf16 v[196:199], a[164:167], a[76:79], v[196:199]
    v_mul_f32 v135, v135, v103
    v_mfma_f32_16x16x32_bf16 v[196:199], a[120:123], a[32:35], v[196:199]
    ds_read_b128 a[224:227], v40 offset:38912
    v_mfma_f32_16x16x32_bf16 v[196:199], a[124:127], a[36:39], v[196:199]
    v_mul_f32 v164, v164, v104
    v_cvt_pk_bf16_f32 v48, v132, v164
    v_mfma_f32_16x16x32_bf16 v[196:199], a[16:19], a[80:83], v[196:199]
    s_waitcnt lgkmcnt(3)
    v_mul_f32 v165, v165, v105
    v_mfma_f32_16x16x32_bf16 v[196:199], a[20:23], a[84:87], v[196:199]
    buffer_store_dwordx4 v[124:127], v25, s[16:19], s66 offen sc1
    v_mfma_f32_16x16x32_bf16 v[196:199], a[24:27], a[240:243], v[196:199]
    s_mov_b32 s66, 114688
    v_add_f32 v228, v228, v88
    v_mul_f32 v228, v228, v96
    v_mfma_f32_16x16x32_bf16 v[196:199], a[28:31], a[244:247], v[196:199]
    v_add_f32 v229, v229, v89
    v_mul_f32 v229, v229, v97
    v_mfma_f32_16x16x32_bf16 v[232:235], a[248:251], a[178:181], v[232:235]
    s_waitcnt lgkmcnt(1)
    ds_read_b128 a[228:231], v41 offset:38912
    v_mfma_f32_16x16x32_bf16 v[232:235], a[252:255], a[58:61], v[232:235]
    buffer_store_dwordx4 v[92:95], v25, s[16:19], s67 offen sc1
    v_mfma_f32_16x16x32_bf16 v[232:235], a[144:147], a[130:133], v[232:235]
    s_mov_b32 s67, 129024
    v_cvt_pk_bf16_f32 v88, v228, v229
    v_mul_f32 v166, v166, v106
    v_mfma_f32_16x16x32_bf16 v[232:235], a[148:151], a[186:189], v[232:235]
    ds_write_b32 v28, v88 offset:0
    v_cvt_pk_bf16_f32 v51, v134, v166
    v_mfma_f32_16x16x32_bf16 v[136:139], a[216:219], a[176:179], v[136:139]
    v_mul_f32 v167, v167, v107
    v_mul_f32 v196, v196, v108
    v_mfma_f32_16x16x32_bf16 v[136:139], a[220:223], a[180:183], v[136:139]
    v_mul_f32 v197, v197, v109
    v_mul_f32 v198, v198, v110
    v_mfma_f32_16x16x32_bf16 v[136:139], a[8:11], a[56:59], v[136:139]
    ds_read_b128 a[192:195], v40 offset:55296
    v_mul_f32 v199, v199, v111
    v_mfma_f32_16x16x32_bf16 v[136:139], a[12:15], a[60:63], v[136:139]
    v_cvt_pk_bf16_f32 v49, v196, v133
    v_cvt_pk_bf16_f32 v50, v165, v197
    v_mfma_f32_16x16x32_bf16 v[136:139], a[168:171], a[128:131], v[136:139]
    ds_write_b64 v26, v[48:49] offset:0
    v_cvt_pk_bf16_f32 v52, v198, v135
    v_mfma_f32_16x16x32_bf16 v[136:139], a[172:175], a[132:135], v[136:139]
    ds_read_b128 a[196:199], v41 offset:55296
    v_cvt_pk_bf16_f32 v53, v167, v199
    v_mfma_f32_16x16x32_bf16 v[136:139], a[40:43], a[184:187], v[136:139]
    ds_write_b64 v26, v[50:51] offset:8
    v_mfma_f32_16x16x32_bf16 v[136:139], a[44:47], a[188:191], v[136:139]
    ds_write_b64 v26, v[52:53] offset:16
    v_mfma_f32_16x16x32_bf16 v[168:171], a[96:99], a[176:179], v[168:171]
    ds_write_b64 v29, v[234:235] offset:33024
    v_mfma_f32_16x16x32_bf16 v[168:171], a[100:103], a[180:183], v[168:171]
    ds_read_b128 a[48:51], v42 offset:6144
    v_mfma_f32_16x16x32_bf16 v[168:171], a[0:3], a[56:59], v[168:171]
    ds_read_b128 a[52:55], v43 offset:6144
    v_mfma_f32_16x16x32_bf16 v[168:171], a[4:7], a[60:63], v[168:171]
    ds_read_b128 a[72:75], v42 offset:22528
    v_mul_f32 v136, v136, v100
    v_mfma_f32_16x16x32_bf16 v[168:171], a[152:155], a[128:131], v[168:171]
    v_mul_f32 v137, v137, v101
    v_mul_f32 v138, v138, v102
    v_mfma_f32_16x16x32_bf16 v[168:171], a[156:159], a[132:135], v[168:171]
    s_waitcnt lgkmcnt(3)
    s_barrier
    v_mfma_f32_16x16x32_bf16 v[168:171], a[208:211], a[184:187], v[168:171]
    ds_read_b128 v[68:71], v24 offset:0
    ds_read_b64 v[72:73], v30 offset:33024
    v_mfma_f32_16x16x32_bf16 v[168:171], a[212:215], a[188:191], v[168:171]
    ds_read_b128 a[76:79], v43 offset:22528
    v_mul_f32 v139, v139, v103
    v_mfma_f32_16x16x32_bf16 v[200:203], a[160:163], a[176:179], v[200:203]
    ds_read_b128 v[76:79], v24 offset:928
    v_mfma_f32_16x16x32_bf16 v[200:203], a[164:167], a[180:183], v[200:203]
    v_mfma_f32_16x16x32_bf16 v[200:203], a[120:123], a[56:59], v[200:203]
    ds_read_b128 a[32:35], v40 offset:40960
    v_mfma_f32_16x16x32_bf16 v[200:203], a[124:127], a[60:63], v[200:203]
    v_mul_f32 v168, v168, v104
    v_cvt_pk_bf16_f32 v80, v136, v168
    v_mfma_f32_16x16x32_bf16 v[200:203], a[16:19], a[128:131], v[200:203]
    s_waitcnt lgkmcnt(3)
    v_mul_f32 v169, v169, v105
    v_mfma_f32_16x16x32_bf16 v[200:203], a[20:23], a[132:135], v[200:203]
    buffer_store_dwordx4 v[68:71], v25, s[16:19], s66 offen sc1
    v_mfma_f32_16x16x32_bf16 v[200:203], a[24:27], a[184:187], v[200:203]
    s_mov_b32 s66, 229376
    v_add_f32 v232, v232, v72
    v_mul_f32 v232, v232, v96
    v_mfma_f32_16x16x32_bf16 v[200:203], a[28:31], a[188:191], v[200:203]
    v_add_f32 v233, v233, v73
    v_mul_f32 v233, v233, v97
    v_mfma_f32_16x16x32_bf16 v[236:239], a[248:251], a[226:229], v[236:239]
    s_waitcnt lgkmcnt(1)
    ds_read_b128 a[36:39], v41 offset:40960
    v_mfma_f32_16x16x32_bf16 v[236:239], a[252:255], a[194:197], v[236:239]
    buffer_store_dwordx4 v[76:79], v25, s[16:19], s67 offen sc1
    v_mfma_f32_16x16x32_bf16 v[236:239], a[144:147], a[50:53], v[236:239]
    s_mov_b32 s67, 243712
    v_cvt_pk_bf16_f32 v72, v232, v233
    v_mul_f32 v170, v170, v106
    v_mfma_f32_16x16x32_bf16 v[236:239], a[148:151], a[74:77], v[236:239]
    ds_write_b32 v28, v72 offset:7424
    v_cvt_pk_bf16_f32 v83, v138, v170
    v_mfma_f32_16x16x32_bf16 v[140:143], a[216:219], a[224:227], v[140:143]
    v_mul_f32 v171, v171, v107
    v_mul_f32 v200, v200, v108
    v_mfma_f32_16x16x32_bf16 v[140:143], a[220:223], a[228:231], v[140:143]
    v_mul_f32 v201, v201, v109
    v_mul_f32 v202, v202, v110
    v_mfma_f32_16x16x32_bf16 v[140:143], a[8:11], a[192:195], v[140:143]
    ds_read_b128 a[80:83], v40 offset:57344
    v_mul_f32 v203, v203, v111
    v_mfma_f32_16x16x32_bf16 v[140:143], a[12:15], a[196:199], v[140:143]
    v_cvt_pk_bf16_f32 v81, v200, v137
    v_cvt_pk_bf16_f32 v82, v169, v201
    v_mfma_f32_16x16x32_bf16 v[140:143], a[168:171], a[48:51], v[140:143]
    ds_write_b64 v26, v[80:81] offset:7424
    v_cvt_pk_bf16_f32 v64, v202, v139
    v_mfma_f32_16x16x32_bf16 v[140:143], a[172:175], a[52:55], v[140:143]
    ds_read_b128 a[84:87], v41 offset:57344
    v_cvt_pk_bf16_f32 v65, v171, v203
    v_mfma_f32_16x16x32_bf16 v[140:143], a[40:43], a[72:75], v[140:143]
    ds_write_b64 v26, v[82:83] offset:7432
    v_mfma_f32_16x16x32_bf16 v[140:143], a[44:47], a[76:79], v[140:143]
    ds_write_b64 v26, v[64:65] offset:7440
    v_mfma_f32_16x16x32_bf16 v[172:175], a[96:99], a[224:227], v[172:175]
    ds_write_b64 v29, v[238:239] offset:0
    v_mfma_f32_16x16x32_bf16 v[172:175], a[100:103], a[228:231], v[172:175]
    ds_read_b128 a[240:243], v42 offset:8192
    v_mfma_f32_16x16x32_bf16 v[172:175], a[0:3], a[192:195], v[172:175]
    ds_read_b128 a[244:247], v43 offset:8192
    v_mfma_f32_16x16x32_bf16 v[172:175], a[4:7], a[196:199], v[172:175]
    ds_read_b128 a[176:179], v42 offset:24576
    v_mul_f32 v140, v140, v100
    v_mfma_f32_16x16x32_bf16 v[172:175], a[152:155], a[48:51], v[172:175]
    v_mul_f32 v141, v141, v101
    v_mul_f32 v142, v142, v102
    v_mfma_f32_16x16x32_bf16 v[172:175], a[156:159], a[52:55], v[172:175]
    s_waitcnt lgkmcnt(3)
    s_barrier
    v_mfma_f32_16x16x32_bf16 v[172:175], a[208:211], a[72:75], v[172:175]
    ds_read_b128 v[84:87], v24 offset:7424
    ds_read_b64 v[116:117], v30 offset:0
    v_mfma_f32_16x16x32_bf16 v[172:175], a[212:215], a[76:79], v[172:175]
    ds_read_b128 a[180:183], v43 offset:24576
    v_mul_f32 v143, v143, v103
    v_mfma_f32_16x16x32_bf16 v[204:207], a[160:163], a[224:227], v[204:207]
    ds_read_b128 v[120:123], v24 offset:8352
    v_mfma_f32_16x16x32_bf16 v[204:207], a[164:167], a[228:231], v[204:207]
    v_mfma_f32_16x16x32_bf16 v[204:207], a[120:123], a[192:195], v[204:207]
    ds_read_b128 a[56:59], v40 offset:43008
    v_mfma_f32_16x16x32_bf16 v[204:207], a[124:127], a[196:199], v[204:207]
    v_mul_f32 v172, v172, v104
    v_cvt_pk_bf16_f32 v112, v140, v172
    v_mfma_f32_16x16x32_bf16 v[204:207], a[16:19], a[48:51], v[204:207]
    s_waitcnt lgkmcnt(3)
    v_mul_f32 v173, v173, v105
    v_mfma_f32_16x16x32_bf16 v[204:207], a[20:23], a[52:55], v[204:207]
    buffer_store_dwordx4 v[84:87], v25, s[16:19], s66 offen sc1
    v_mfma_f32_16x16x32_bf16 v[204:207], a[24:27], a[72:75], v[204:207]
    s_mov_b32 s66, 344064
    v_add_f32 v236, v236, v116
    v_mul_f32 v236, v236, v96
    v_mfma_f32_16x16x32_bf16 v[204:207], a[28:31], a[76:79], v[204:207]
    v_add_f32 v237, v237, v117
    v_mul_f32 v237, v237, v97
    v_mfma_f32_16x16x32_bf16 v[240:243], a[248:251], a[34:37], v[240:243]
    s_waitcnt lgkmcnt(1)
    ds_read_b128 a[60:63], v41 offset:43008
    v_mfma_f32_16x16x32_bf16 v[240:243], a[252:255], a[82:85], v[240:243]
    buffer_store_dwordx4 v[120:123], v25, s[16:19], s67 offen sc1
    v_mfma_f32_16x16x32_bf16 v[240:243], a[144:147], a[242:245], v[240:243]
    s_mov_b32 s67, 358400
    v_cvt_pk_bf16_f32 v116, v236, v237
    v_mul_f32 v174, v174, v106
    v_mfma_f32_16x16x32_bf16 v[240:243], a[148:151], a[178:181], v[240:243]
    ds_write_b32 v28, v116 offset:14848
    v_cvt_pk_bf16_f32 v115, v142, v174
    v_mfma_f32_16x16x32_bf16 v[144:147], a[216:219], a[32:35], v[144:147]
    v_mul_f32 v175, v175, v107
    v_mul_f32 v204, v204, v108
    v_mfma_f32_16x16x32_bf16 v[144:147], a[220:223], a[36:39], v[144:147]
    v_mul_f32 v205, v205, v109
    v_mul_f32 v206, v206, v110
    v_mfma_f32_16x16x32_bf16 v[144:147], a[8:11], a[80:83], v[144:147]
    ds_read_b128 a[128:131], v40 offset:59392
    v_mul_f32 v207, v207, v111
    v_mfma_f32_16x16x32_bf16 v[144:147], a[12:15], a[84:87], v[144:147]
    v_cvt_pk_bf16_f32 v113, v204, v141
    v_cvt_pk_bf16_f32 v114, v173, v205
    v_mfma_f32_16x16x32_bf16 v[144:147], a[168:171], a[240:243], v[144:147]
    ds_write_b64 v26, v[112:113] offset:14848
    v_cvt_pk_bf16_f32 v124, v206, v143
    v_mfma_f32_16x16x32_bf16 v[144:147], a[172:175], a[244:247], v[144:147]
    ds_read_b128 a[132:135], v41 offset:59392
    v_cvt_pk_bf16_f32 v125, v175, v207
    v_mfma_f32_16x16x32_bf16 v[144:147], a[40:43], a[176:179], v[144:147]
    ds_write_b64 v26, v[114:115] offset:14856
    v_mfma_f32_16x16x32_bf16 v[144:147], a[44:47], a[180:183], v[144:147]
    ds_write_b64 v26, v[124:125] offset:14864
    v_mfma_f32_16x16x32_bf16 v[176:179], a[96:99], a[32:35], v[176:179]
    ds_write_b64 v29, v[242:243] offset:2048
    v_mfma_f32_16x16x32_bf16 v[176:179], a[100:103], a[36:39], v[176:179]
    ds_read_b128 a[184:187], v42 offset:10240
    v_mfma_f32_16x16x32_bf16 v[176:179], a[0:3], a[80:83], v[176:179]
    ds_read_b128 a[188:191], v43 offset:10240
    v_mfma_f32_16x16x32_bf16 v[176:179], a[4:7], a[84:87], v[176:179]
    ds_read_b128 a[224:227], v42 offset:26624
    v_mul_f32 v144, v144, v100
    v_mfma_f32_16x16x32_bf16 v[176:179], a[152:155], a[240:243], v[176:179]
    v_mul_f32 v145, v145, v101
    v_mul_f32 v146, v146, v102
    v_mfma_f32_16x16x32_bf16 v[176:179], a[156:159], a[244:247], v[176:179]
    s_waitcnt lgkmcnt(3)
    s_barrier
    v_mfma_f32_16x16x32_bf16 v[176:179], a[208:211], a[176:179], v[176:179]
    ds_read_b128 v[92:95], v24 offset:14848
    ds_read_b64 v[88:89], v30 offset:2048
    v_mfma_f32_16x16x32_bf16 v[176:179], a[212:215], a[180:183], v[176:179]
    ds_read_b128 a[228:231], v43 offset:26624
    v_mul_f32 v147, v147, v103
    v_mfma_f32_16x16x32_bf16 v[208:211], a[160:163], a[32:35], v[208:211]
    ds_read_b128 v[48:51], v24 offset:15776
    v_mfma_f32_16x16x32_bf16 v[208:211], a[164:167], a[36:39], v[208:211]
    v_mfma_f32_16x16x32_bf16 v[208:211], a[120:123], a[80:83], v[208:211]
    ds_read_b128 a[192:195], v40 offset:45056
    v_mfma_f32_16x16x32_bf16 v[208:211], a[124:127], a[84:87], v[208:211]
    v_mul_f32 v176, v176, v104
    v_cvt_pk_bf16_f32 v52, v144, v176
    v_mfma_f32_16x16x32_bf16 v[208:211], a[16:19], a[240:243], v[208:211]
    s_waitcnt lgkmcnt(3)
    v_mul_f32 v177, v177, v105
    v_mfma_f32_16x16x32_bf16 v[208:211], a[20:23], a[244:247], v[208:211]
    buffer_store_dwordx4 v[92:95], v25, s[16:19], s66 offen sc1
    v_mfma_f32_16x16x32_bf16 v[208:211], a[24:27], a[176:179], v[208:211]
    s_mov_b32 s66, 458752
    v_add_f32 v240, v240, v88
    v_mul_f32 v240, v240, v96
    v_mfma_f32_16x16x32_bf16 v[208:211], a[28:31], a[180:183], v[208:211]
    v_add_f32 v241, v241, v89
    v_mul_f32 v241, v241, v97
    v_mfma_f32_16x16x32_bf16 v[244:247], a[248:251], a[58:61], v[244:247]
    s_waitcnt lgkmcnt(1)
    ds_read_b128 a[196:199], v41 offset:45056
    v_mfma_f32_16x16x32_bf16 v[244:247], a[252:255], a[130:133], v[244:247]
    buffer_store_dwordx4 v[48:51], v25, s[16:19], s67 offen sc1
    v_mfma_f32_16x16x32_bf16 v[244:247], a[144:147], a[186:189], v[244:247]
    s_mov_b32 s67, 473088
    v_cvt_pk_bf16_f32 v88, v240, v241
    v_mul_f32 v178, v178, v106
    v_mfma_f32_16x16x32_bf16 v[244:247], a[148:151], a[226:229], v[244:247]
    ds_write_b32 v28, v88 offset:22272
    v_cvt_pk_bf16_f32 v55, v146, v178
    v_mfma_f32_16x16x32_bf16 v[148:151], a[216:219], a[56:59], v[148:151]
    v_mul_f32 v179, v179, v107
    v_mul_f32 v208, v208, v108
    v_mfma_f32_16x16x32_bf16 v[148:151], a[220:223], a[60:63], v[148:151]
    v_mul_f32 v209, v209, v109
    v_mul_f32 v210, v210, v110
    v_mfma_f32_16x16x32_bf16 v[148:151], a[8:11], a[128:131], v[148:151]
    ds_read_b128 a[48:51], v40 offset:61440
    v_mul_f32 v211, v211, v111
    v_mfma_f32_16x16x32_bf16 v[148:151], a[12:15], a[132:135], v[148:151]
    v_cvt_pk_bf16_f32 v53, v208, v145
    v_cvt_pk_bf16_f32 v54, v177, v209
    v_mfma_f32_16x16x32_bf16 v[148:151], a[168:171], a[184:187], v[148:151]
    ds_write_b64 v26, v[52:53] offset:22272
    v_cvt_pk_bf16_f32 v68, v210, v147
    v_mfma_f32_16x16x32_bf16 v[148:151], a[172:175], a[188:191], v[148:151]
    ds_read_b128 a[52:55], v41 offset:61440
    v_cvt_pk_bf16_f32 v69, v179, v211
    v_mfma_f32_16x16x32_bf16 v[148:151], a[40:43], a[224:227], v[148:151]
    ds_write_b64 v26, v[54:55] offset:22280
    v_mfma_f32_16x16x32_bf16 v[148:151], a[44:47], a[228:231], v[148:151]
    ds_write_b64 v26, v[68:69] offset:22288
    v_mfma_f32_16x16x32_bf16 v[180:183], a[96:99], a[56:59], v[180:183]
    ds_write_b64 v29, v[246:247] offset:4096
    v_mfma_f32_16x16x32_bf16 v[180:183], a[100:103], a[60:63], v[180:183]
    ds_read_b128 a[72:75], v42 offset:12288
    v_mfma_f32_16x16x32_bf16 v[180:183], a[0:3], a[128:131], v[180:183]
    ds_read_b128 a[76:79], v43 offset:12288
    v_mfma_f32_16x16x32_bf16 v[180:183], a[4:7], a[132:135], v[180:183]
    ds_read_b128 a[32:35], v42 offset:28672
    v_mul_f32 v148, v148, v100
    v_mfma_f32_16x16x32_bf16 v[180:183], a[152:155], a[184:187], v[180:183]
    v_mul_f32 v149, v149, v101
    v_mul_f32 v150, v150, v102
    v_mfma_f32_16x16x32_bf16 v[180:183], a[156:159], a[188:191], v[180:183]
    s_waitcnt lgkmcnt(3)
    s_barrier
    v_mfma_f32_16x16x32_bf16 v[180:183], a[208:211], a[224:227], v[180:183]
    ds_read_b128 v[76:79], v24 offset:22272
    ds_read_b64 v[72:73], v30 offset:4096
    v_mfma_f32_16x16x32_bf16 v[180:183], a[212:215], a[228:231], v[180:183]
    ds_read_b128 a[36:39], v43 offset:28672
    v_mul_f32 v151, v151, v103
    v_mfma_f32_16x16x32_bf16 v[212:215], a[160:163], a[56:59], v[212:215]
    ds_read_b128 v[80:83], v24 offset:23200
    v_mfma_f32_16x16x32_bf16 v[212:215], a[164:167], a[60:63], v[212:215]
    v_mfma_f32_16x16x32_bf16 v[212:215], a[120:123], a[128:131], v[212:215]
    ds_read_b128 a[80:83], v40 offset:14336
    v_mfma_f32_16x16x32_bf16 v[212:215], a[124:127], a[132:135], v[212:215]
    v_mul_f32 v180, v180, v104
    v_cvt_pk_bf16_f32 v64, v148, v180
    v_mfma_f32_16x16x32_bf16 v[212:215], a[16:19], a[184:187], v[212:215]
    s_waitcnt lgkmcnt(3)
    v_mul_f32 v181, v181, v105
    v_mfma_f32_16x16x32_bf16 v[212:215], a[20:23], a[188:191], v[212:215]
    buffer_store_dwordx4 v[76:79], v25, s[16:19], s66 offen sc1
    v_mfma_f32_16x16x32_bf16 v[212:215], a[24:27], a[224:227], v[212:215]
    s_mov_b32 s66, 573440
    v_add_f32 v244, v244, v72
    v_mul_f32 v244, v244, v96
    v_mfma_f32_16x16x32_bf16 v[212:215], a[28:31], a[228:231], v[212:215]
    v_add_f32 v245, v245, v73
    v_mul_f32 v245, v245, v97
    v_mfma_f32_16x16x32_bf16 v[248:251], a[248:251], a[194:197], v[248:251]
    s_waitcnt lgkmcnt(1)
    ds_read_b128 a[84:87], v41 offset:14336
    v_mfma_f32_16x16x32_bf16 v[248:251], a[252:255], a[50:53], v[248:251]
    buffer_store_dwordx4 v[80:83], v25, s[16:19], s67 offen sc1
    v_mfma_f32_16x16x32_bf16 v[248:251], a[144:147], a[74:77], v[248:251]
    s_mov_b32 s67, 587776
    v_cvt_pk_bf16_f32 v72, v244, v245
    v_mul_f32 v182, v182, v106
    v_mfma_f32_16x16x32_bf16 v[248:251], a[148:151], a[34:37], v[248:251]
    ds_write_b32 v28, v72 offset:29696
    v_cvt_pk_bf16_f32 v67, v150, v182
    v_mfma_f32_16x16x32_bf16 v[152:155], a[216:219], a[192:195], v[152:155]
    v_mul_f32 v183, v183, v107
    v_mul_f32 v212, v212, v108
    v_mfma_f32_16x16x32_bf16 v[152:155], a[220:223], a[196:199], v[152:155]
    v_mul_f32 v213, v213, v109
    v_mul_f32 v214, v214, v110
    v_mfma_f32_16x16x32_bf16 v[152:155], a[8:11], a[48:51], v[152:155]
    ds_read_b128 a[240:243], v40 offset:30720
    v_mul_f32 v215, v215, v111
    v_mfma_f32_16x16x32_bf16 v[152:155], a[12:15], a[52:55], v[152:155]
    v_cvt_pk_bf16_f32 v65, v212, v149
    v_cvt_pk_bf16_f32 v66, v181, v213
    v_mfma_f32_16x16x32_bf16 v[152:155], a[168:171], a[72:75], v[152:155]
    ds_write_b64 v26, v[64:65] offset:29696
    v_cvt_pk_bf16_f32 v84, v214, v151
    v_mfma_f32_16x16x32_bf16 v[152:155], a[172:175], a[76:79], v[152:155]
    ds_read_b128 a[244:247], v41 offset:30720
    v_cvt_pk_bf16_f32 v85, v183, v215
    v_mfma_f32_16x16x32_bf16 v[152:155], a[40:43], a[32:35], v[152:155]
    ds_write_b64 v26, v[66:67] offset:29704
    v_mfma_f32_16x16x32_bf16 v[152:155], a[44:47], a[36:39], v[152:155]
    ds_write_b64 v26, v[84:85] offset:29712
    v_mfma_f32_16x16x32_bf16 v[184:187], a[96:99], a[192:195], v[184:187]
    ds_write_b64 v29, v[250:251] offset:6144
    v_mfma_f32_16x16x32_bf16 v[184:187], a[100:103], a[196:199], v[184:187]
    ds_read_b128 a[176:179], v40 offset:47104
    v_mfma_f32_16x16x32_bf16 v[184:187], a[0:3], a[48:51], v[184:187]
    ds_read_b128 a[180:183], v41 offset:47104
    v_mfma_f32_16x16x32_bf16 v[184:187], a[4:7], a[52:55], v[184:187]
    ds_read_b128 a[56:59], v40 offset:63488
    v_mul_f32 v152, v152, v100
    v_mfma_f32_16x16x32_bf16 v[184:187], a[152:155], a[72:75], v[184:187]
    v_mul_f32 v153, v153, v101
    v_mul_f32 v154, v154, v102
    v_mfma_f32_16x16x32_bf16 v[184:187], a[156:159], a[76:79], v[184:187]
    s_waitcnt lgkmcnt(3)
    s_barrier
    v_mfma_f32_16x16x32_bf16 v[184:187], a[208:211], a[32:35], v[184:187]
    ds_read_b128 v[120:123], v24 offset:29696
    ds_read_b64 v[116:117], v30 offset:6144
    v_mfma_f32_16x16x32_bf16 v[184:187], a[212:215], a[36:39], v[184:187]
    ds_read_b128 a[60:63], v41 offset:63488
    v_mul_f32 v155, v155, v103
    v_mfma_f32_16x16x32_bf16 v[216:219], a[160:163], a[192:195], v[216:219]
    ds_read_b128 a[128:131], v42 offset:14336
    v_mfma_f32_16x16x32_bf16 v[216:219], a[164:167], a[196:199], v[216:219]
    ds_read_b128 a[132:135], v43 offset:14336
    v_mfma_f32_16x16x32_bf16 v[216:219], a[120:123], a[48:51], v[216:219]
    ds_read_b128 a[184:187], v42 offset:30720
    v_mfma_f32_16x16x32_bf16 v[216:219], a[124:127], a[52:55], v[216:219]
    v_mul_f32 v184, v184, v104
    v_cvt_pk_bf16_f32 v112, v152, v184
    v_mfma_f32_16x16x32_bf16 v[216:219], a[16:19], a[72:75], v[216:219]
    s_waitcnt lgkmcnt(4)
    ds_read_b128 a[188:191], v43 offset:30720
    v_mfma_f32_16x16x32_bf16 v[216:219], a[20:23], a[76:79], v[216:219]
    buffer_store_dwordx4 v[120:123], v25, s[16:19], s66 offen sc1
    v_mfma_f32_16x16x32_bf16 v[216:219], a[24:27], a[32:35], v[216:219]
    s_mov_b32 s66, 688128
    ds_read_b128 v[124:127], v24 offset:30624
    v_add_f32 v248, v248, v116
    v_mfma_f32_16x16x32_bf16 v[216:219], a[28:31], a[36:39], v[216:219]
    v_mul_f32 v248, v248, v96
    v_add_f32 v249, v249, v117
    v_mfma_f32_16x16x32_bf16 v[252:255], a[88:91], a[82:85], v[252:255]
    v_mul_f32 v249, v249, v97
    v_cvt_pk_bf16_f32 v116, v248, v249
    v_mfma_f32_16x16x32_bf16 v[252:255], a[92:95], a[242:245], v[252:255]
    ds_write_b32 v28, v116 offset:37120
    v_mul_f32 v185, v185, v105
    v_mfma_f32_16x16x32_bf16 v[252:255], a[248:251], a[178:181], v[252:255]
    s_waitcnt lgkmcnt(4)
    v_mul_f32 v186, v186, v106
    v_cvt_pk_bf16_f32 v115, v154, v186
    v_mfma_f32_16x16x32_bf16 v[252:255], a[252:255], a[58:61], v[252:255]
    v_mul_f32 v187, v187, v107
    v_mul_f32 v216, v216, v108
    v_mfma_f32_16x16x32_bf16 v[252:255], a[144:147], a[130:133], v[252:255]
    s_waitcnt lgkmcnt(1)
    v_mul_f32 v217, v217, v109
    v_mfma_f32_16x16x32_bf16 v[252:255], a[148:151], a[186:189], v[252:255]
    buffer_store_dwordx4 v[124:127], v25, s[16:19], s67 offen sc1
    v_mfma_f32_16x16x32_bf16 v[156:159], a[136:139], a[80:83], v[156:159]
    s_mov_b32 s67, 702464
    v_mul_f32 v218, v218, v110
    v_mul_f32 v219, v219, v111
    v_mfma_f32_16x16x32_bf16 v[156:159], a[140:143], a[84:87], v[156:159]
    v_cvt_pk_bf16_f32 v113, v216, v153
    v_cvt_pk_bf16_f32 v114, v185, v217
    v_mfma_f32_16x16x32_bf16 v[156:159], a[64:67], a[240:243], v[156:159]
    ds_write_b64 v26, v[112:113] offset:37120
    v_cvt_pk_bf16_f32 v92, v218, v155
    v_mfma_f32_16x16x32_bf16 v[156:159], a[68:71], a[244:247], v[156:159]
    ds_write_b64 v26, v[114:115] offset:37128
    v_cvt_pk_bf16_f32 v93, v187, v219
    v_mfma_f32_16x16x32_bf16 v[156:159], a[216:219], a[176:179], v[156:159]
    ds_write_b64 v26, v[92:93] offset:37136
    v_mfma_f32_16x16x32_bf16 v[156:159], a[220:223], a[180:183], v[156:159]
    ds_write_b64 v29, v[254:255] offset:8192
    v_mfma_f32_16x16x32_bf16 v[156:159], a[8:11], a[56:59], v[156:159]
    v_mfma_f32_16x16x32_bf16 v[156:159], a[12:15], a[60:63], v[156:159]
    v_mfma_f32_16x16x32_bf16 v[156:159], a[168:171], a[128:131], v[156:159]
    v_mfma_f32_16x16x32_bf16 v[156:159], a[172:175], a[132:135], v[156:159]
    v_mfma_f32_16x16x32_bf16 v[156:159], a[40:43], a[184:187], v[156:159]
    s_waitcnt lgkmcnt(0)
    s_barrier
    v_mfma_f32_16x16x32_bf16 v[156:159], a[44:47], a[188:191], v[156:159]
    ds_read_b128 v[48:51], v24 offset:37120
    ds_read_b64 v[88:89], v30 offset:8192
    v_mfma_f32_16x16x32_bf16 v[188:191], a[104:107], a[80:83], v[188:191]
    ds_read_b128 v[52:55], v24 offset:38048
    v_mfma_f32_16x16x32_bf16 v[188:191], a[108:111], a[84:87], v[188:191]
    v_mfma_f32_16x16x32_bf16 v[188:191], a[200:203], a[240:243], v[188:191]
    s_waitcnt vmcnt(12)
    v_xor_b32 v8, 15, v8
    v_or_b32 v8, v8, v0
    v_mfma_f32_16x16x32_bf16 v[188:191], a[204:207], a[244:247], v[188:191]
    v_mul_f32 v156, v156, v100
    v_mul_f32 v157, v157, v101
    v_mfma_f32_16x16x32_bf16 v[188:191], a[96:99], a[176:179], v[188:191]
    v_mul_f32 v158, v158, v102
    v_mul_f32 v159, v159, v103
    v_mfma_f32_16x16x32_bf16 v[188:191], a[100:103], a[180:183], v[188:191]
    s_waitcnt lgkmcnt(1)
    v_min_u32 v8, 1, v8
    v_mfma_f32_16x16x32_bf16 v[188:191], a[0:3], a[56:59], v[188:191]
    buffer_store_dwordx4 v[48:51], v25, s[16:19], s66 offen sc1
    v_mfma_f32_16x16x32_bf16 v[188:191], a[4:7], a[60:63], v[188:191]
    s_mov_b32 s66, 802816
    v_add_f32 v252, v252, v88
    v_mul_f32 v252, v252, v96
    v_mfma_f32_16x16x32_bf16 v[188:191], a[152:155], a[128:131], v[188:191]
    v_add_f32 v253, v253, v89
    v_mul_f32 v253, v253, v97
    v_mfma_f32_16x16x32_bf16 v[188:191], a[156:159], a[132:135], v[188:191]
    s_waitcnt lgkmcnt(0)
    v_cvt_pk_bf16_f32 v88, v252, v253
    v_mfma_f32_16x16x32_bf16 v[188:191], a[208:211], a[184:187], v[188:191]
    buffer_store_dwordx4 v[52:55], v25, s[16:19], s67 offen sc1
    v_mfma_f32_16x16x32_bf16 v[188:191], a[212:215], a[188:191], v[188:191]
    s_mov_b32 s67, 817152
    ds_write_b32 v28, v88 offset:44544
    v_lshlrev_b32 v8, 30, v8
    v_mfma_f32_16x16x32_bf16 v[220:223], a[112:115], a[80:83], v[220:223]
    v_mov_b32 v9, s76
    v_mfma_f32_16x16x32_bf16 v[220:223], a[116:119], a[84:87], v[220:223]
    v_mfma_f32_16x16x32_bf16 v[220:223], a[232:235], a[240:243], v[220:223]
    buffer_store_dword v9, v8, s[12:15], s78 offen sc1
    v_mfma_f32_16x16x32_bf16 v[220:223], a[236:239], a[244:247], v[220:223]
    v_mul_f32 v188, v188, v104
    v_cvt_pk_bf16_f32 v68, v156, v188
    v_mfma_f32_16x16x32_bf16 v[220:223], a[160:163], a[176:179], v[220:223]
    v_mul_f32 v189, v189, v105
    v_mul_f32 v190, v190, v106
    v_mfma_f32_16x16x32_bf16 v[220:223], a[164:167], a[180:183], v[220:223]
    v_cvt_pk_bf16_f32 v71, v158, v190
    v_mul_f32 v191, v191, v107
    v_mfma_f32_16x16x32_bf16 v[220:223], a[120:123], a[56:59], v[220:223]
    v_mfma_f32_16x16x32_bf16 v[220:223], a[124:127], a[60:63], v[220:223]
    v_mfma_f32_16x16x32_bf16 v[220:223], a[16:19], a[128:131], v[220:223]
    v_mfma_f32_16x16x32_bf16 v[220:223], a[20:23], a[132:135], v[220:223]
    v_mfma_f32_16x16x32_bf16 v[220:223], a[24:27], a[184:187], v[220:223]
    v_mfma_f32_16x16x32_bf16 v[220:223], a[28:31], a[188:191], v[220:223]
    s_nop 7
    v_mul_f32 v220, v220, v108
    v_mul_f32 v221, v221, v109
    v_mul_f32 v222, v222, v110
    v_mul_f32 v223, v223, v111
    v_cvt_pk_bf16_f32 v69, v220, v157
    v_cvt_pk_bf16_f32 v70, v189, v221
    v_cvt_pk_bf16_f32 v76, v222, v159
    v_cvt_pk_bf16_f32 v77, v191, v223
    ds_write_b64 v26, v[68:69] offset:44544
    ds_write_b64 v26, v[70:71] offset:44552
    ds_write_b64 v26, v[76:77] offset:44560
    s_waitcnt lgkmcnt(0)
    s_barrier
    ds_read_b128 v[80:83], v24 offset:44544
    ds_read_b128 v[72:75], v24 offset:45472
    s_waitcnt lgkmcnt(1)
    buffer_store_dwordx4 v[80:83], v25, s[16:19], s66 offen sc1
    s_waitcnt lgkmcnt(0)
    buffer_store_dwordx4 v[72:75], v25, s[16:19], s67 offen sc1
L_end:
    s_endpgm
L_help:
    s_mov_b32 s53, s61
    s_mov_b32 s54, s62
    s_mul_i32 s61, s22, 1835008
    s_add_u32 s61, s61, s79
    s_lshl_b32 s62, s22, 14
    s_add_u32 s62, s62, s68
    s_mov_b32 s22, 0
L_help_row:
    v_mov_b32 v21, v19
    s_xor_b32 s23, s22, s58
    s_bitcmp0_b32 s23, 2
    s_cbranch_scc1 L_help_same
    v_add_u32 v12, 57344, v19
    v_subrev_u32 v13, 57344, v19
    v_min_u32 v21, v12, v13
L_help_same:
    v_mov_b32 v8, 0
    v_mov_b32 v9, 0
    v_mov_b32 v10, 0
    v_mov_b32 v11, s47
    s_mov_b32 s23, 0
L_help_e:
    v_mov_b32 v15, 0
    buffer_load_dwordx3 v[12:14], v18, s[4:7], s61 offen nt
    s_cmp_ge_u32 s23, 16
    s_cbranch_scc1 L_help_own
    buffer_load_dword v15, v21, s[4:7], s61 offen nt
L_help_own:
    s_waitcnt vmcnt(0)
    v_lshl_or_b32 v8, v12, s23, v8
    v_lshl_or_b32 v9, v13, s23, v9
    v_lshl_or_b32 v10, v14, s23, v10
    v_lshl_or_b32 v11, v15, s23, v11
    s_add_u32 s61, s61, 14336
    s_add_u32 s23, s23, 4
    s_cmp_lt_u32 s23, 32
    s_cbranch_scc1 L_help_e
    buffer_store_dwordx4 v[8:11], v20, s[12:15], s62 offen sc1
    s_add_u32 s62, s62, 1024
    s_waitcnt vmcnt(0)
    s_add_u32 s22, s22, 1
    s_cmp_lt_u32 s22, 16
    s_cbranch_scc1 L_help_row
    s_mov_b32 s61, s53
    s_mov_b32 s62, s54
    s_setpc_b64 s[20:21]
L_code_end:

.section .rodata,"a"
.p2align 6
.amdhsa_kernel standalone__normalfloat_lut_af4__prompt_kernel
  .amdhsa_next_free_vgpr 512
  .amdhsa_next_free_sgpr 102
  .amdhsa_accum_offset 256
  .amdhsa_group_segment_fixed_size 0
  .amdhsa_kernarg_size 56
  .amdhsa_user_sgpr_count 2
  .amdhsa_user_sgpr_kernarg_segment_ptr 1
  .amdhsa_system_sgpr_workgroup_id_x 1
.end_amdhsa_kernel
```

```asm
; @launch grid=(256,1,1) block=(256,1,1) lds=163840
.amdgcn_target "amdgcn-amd-amdhsa--gfx950"
.text
.globl standalone__normalfloat_lut_af4__prompt_kernel
.p2align 8
.type standalone__normalfloat_lut_af4__prompt_kernel,@function
standalone__normalfloat_lut_af4__prompt_kernel:
    s_cmp_ge_u32 s2, 256
    s_cbranch_scc1 L_end
    s_load_dwordx2 s[4:5], s[0:1], 8
    s_load_dwordx2 s[12:13], s[0:1], 48
    s_load_dwordx2 s[8:9], s[0:1], 0
    s_load_dwordx2 s[28:29], s[0:1], 16
    s_getpc_b64 s[48:49]
    s_mov_b32 s50, L_code_end-standalone__normalfloat_lut_af4__prompt_kernel-256
    s_mov_b32 s51, 0x20000
    s_lshr_b32 s61, s2, 3
    v_lshl_add_u32 v46, v0, 5, s61
    v_lshlrev_b32 v46, 7, v46
    buffer_load_dword v1, v46, s[48:51], 0 offen offset:256
    v_lshrrev_b32 v5, 6, v0
    v_and_b32 v2, 63, v0
    s_and_b32 s60, s2, 7
    v_readfirstlane_b32 s63, v5
    s_and_b32 s58, s60, 1
    s_lshl_b32 s58, s58, 3
    s_and_b32 s62, s61, 7
    s_add_u32 s58, s58, s62
    s_lshr_b32 s59, s60, 1
    s_lshl_b32 s59, s59, 2
    s_lshr_b32 s62, s61, 3
    s_add_u32 s59, s59, s62
    v_mul_u32_u24 v18, 12, v2
    s_lshl_b32 s60, s63, 4
    s_add_u32 s60, s60, s58
    s_mul_i32 s61, s60, 114688
    s_mul_i32 s79, s59, 896
    s_add_u32 s61, s61, s79
    s_mov_b32 s6, 14680064
    s_mov_b32 s7, 0x20000
    s_lshl_b32 s78, s59, 7
    s_add_u32 s78, s78, 2097164
    v_and_b32 v4, 15, v2
    v_lshrrev_b32 v3, 4, v2
    v_and_b32 v12, 1, v3
    v_lshlrev_b32 v13, 1, v12
    v_xor_b32 v13, v13, v4
    v_lshrrev_b32 v19, 1, v3
    v_lshl_add_u32 v19, v19, 4, v13
    s_bfe_u32 s70, s58, 0x10002
    s_xor_b32 s70, s70, 1
    v_xor_b32 v12, s70, v12
    v_mul_u32_u24 v12, 14336, v12
    v_add_lshl_u32 v19, v19, v12, 2
    v_add_u32 v19, 768, v19
    s_mov_b32 s46, 2
    s_cmp_lg_u32 s63, 0
    s_cbranch_scc1 L_role0
    s_mov_b32 s46, 0
L_role0:
    s_cmp_lg_u32 s63, 1
    s_cbranch_scc1 L_role1
    s_mov_b32 s46, 1
L_role1:
    v_lshlrev_b32 v16, 1, v4
    v_lshrrev_b32 v17, 4, v0
    v_lshlrev_b32 v17, 1, v17
    s_mov_b32 s30, 32
    s_mov_b32 s31, 0x20000
    v_lshrrev_b32 v6, 3, v2
    v_and_b32 v7, 7, v2
    v_xor_b32 v13, v7, v3
    s_lshl_b32 s70, s63, 5
    v_add_lshl_u32 v12, v6, s70, 11
    v_lshl_add_u32 v36, v13, 4, v12
    v_xor_b32 v37, 64, v36
    v_add_u32 v37, 15360, v37
    v_add_u32 v38, 30720, v36
    v_add_u32 v39, 30720, v37
    s_mov_b32 s10, 4194304
    s_mov_b32 s11, 0x20000
    s_lshl_b32 s55, s58, 18
    s_and_b32 s71, s58, 8
    s_lshl_b32 s70, s71, 4
    s_add_u32 s55, s55, s70
    s_lshl_b32 s57, s63, 12
    s_xor_b32 s69, s55, 128
    s_add_u32 s57, s57, 65536
    s_mov_b32 s14, 2099200
    s_mov_b32 s15, 0x20000
    s_lshl_b32 s68, s59, 17
    s_lshl_b32 s62, s60, 10
    s_add_u32 s62, s62, s68
    v_lshlrev_b32 v20, 4, v2
    s_waitcnt lgkmcnt(0)
    s_load_dword s76, s[12:13], s78
    s_cmp_eq_u32 s46, 1
    s_cbranch_scc1 L_L
    s_cmp_eq_u32 s46, 2
    s_cbranch_scc1 L_L
L_X:
    buffer_load_dwordx3 v[128:130], v18, s[4:7], s61 offen nt
    buffer_load_dword v131, v19, s[4:7], s61 offen nt
    s_add_u32 s61, s61, 14336
    buffer_load_dwordx3 v[132:134], v18, s[4:7], s61 offen nt
    buffer_load_dword v135, v19, s[4:7], s61 offen nt
    s_add_u32 s61, s61, 14336
    buffer_load_dwordx3 v[136:138], v18, s[4:7], s61 offen nt
    buffer_load_dword v139, v19, s[4:7], s61 offen nt
    s_add_u32 s61, s61, 14336
    buffer_load_dwordx3 v[140:142], v18, s[4:7], s61 offen nt
    buffer_load_dword v143, v19, s[4:7], s61 offen nt
    s_add_u32 s61, s61, 14336
    buffer_load_dwordx3 v[144:146], v18, s[4:7], s61 offen nt
    s_add_u32 s61, s61, 14336
    buffer_load_dwordx3 v[148:150], v18, s[4:7], s61 offen nt
    s_add_u32 s61, s61, 14336
    buffer_load_dwordx3 v[152:154], v18, s[4:7], s61 offen nt
    s_add_u32 s61, s61, 14336
    buffer_load_dwordx3 v[156:158], v18, s[4:7], s61 offen nt
    s_add_u32 s61, s61, 7239680
    s_cmp_eq_u32 s46, 1
    s_cbranch_scc1 L_D
    s_cmp_eq_u32 s46, 2
    s_cbranch_scc1 L_B
L_L:
    buffer_load_ushort v16, v16, s[28:31], 0 offen
    buffer_load_ushort v17, v17, s[28:31], 0 offen
    s_cmp_eq_u32 s46, 1
    s_cbranch_scc1 L_S
    s_cmp_eq_u32 s46, 2
    s_cbranch_scc1 L_S
L_D:
    s_add_u32 m0, s57, 32768
    s_add_u32 s56, s55, 0
    buffer_load_dwordx4 v36, s[8:11], s56 offen offset:0  lds
    buffer_load_dwordx4 v37, s[8:11], s56 offen offset:1024  lds
    buffer_load_dwordx4 v38, s[8:11], s56 offen offset:2048  lds
    buffer_load_dwordx4 v39, s[8:11], s56 offen offset:3072  lds
    s_cmp_eq_u32 s46, 1
    s_cbranch_scc1 L_G
    s_cmp_eq_u32 s46, 2
    s_cbranch_scc1 L_G
L_S:
    s_load_dwordx2 s[32:33], s[0:1], 24
    s_load_dwordx2 s[16:17], s[0:1], 32
    s_load_dwordx2 s[24:25], s[0:1], 40
    s_and_b32 s64, s63, 1
    s_lshr_b32 s65, s63, 1
    s_and_b32 s70, s58, 8
    s_lshl_b32 s70, s70, 10
    s_lshl_b32 s71, s64, 12
    s_add_u32 s70, s70, s71
    s_lshl_b32 s71, s63, 8
    s_add_u32 s70, s70, s71
    s_add_u32 s70, s70, s68
    v_lshl_add_u32 v32, v4, 4, s70
    v_lshl_add_u32 v32, v3, 10, v32
    v_xor_b32 v33, 4096, v32
    v_xor_b32 v34, 8192, v32
    v_xor_b32 v44, 12288, v32
    s_mov_b32 s36, 202114048
    s_mov_b32 s37, 202114304
    s_mov_b32 s38, 202114560
    s_mov_b32 s39, 202114816
    v_and_b32 v35, 31, v2
    v_lshlrev_b32 v35, 2, v35
    s_lshl_b32 s70, s64, 6
    s_add_u32 s70, s70, 65536
    v_lshrrev_b32 v12, 1, v4
    v_xor_b32 v12, v12, v3
    v_lshlrev_b32 v12, 4, v12
    v_lshl_add_u32 v12, v4, 7, v12
    v_xor_b32 v40, s70, v12
    v_xor_b32 v41, 64, v40
    v_add_u32 v42, 65536, v40
    v_add_u32 v43, 65536, v41
    s_mov_b32 s52, 0
    v_lshlrev_b32 v8, 4, v7
    v_lshl_add_u32 v8, v0, 8, v8
    v_xor_b32 v9, 16, v8
    v_xor_b32 v10, 32, v8
    v_xor_b32 v11, 48, v8
    v_xor_b32 v12, 64, v8
    v_xor_b32 v13, 80, v8
    v_xor_b32 v14, 96, v8
    v_xor_b32 v15, 112, v8
    s_cmp_eq_u32 s46, 1
    s_cbranch_scc1 L_X
    s_cmp_eq_u32 s46, 2
    s_cbranch_scc1 L_D
L_G:
    s_waitcnt lgkmcnt(0)
    s_add_u32 s76, s76, 2654435769
    s_and_b32 s47, s76, 0xffff0000
    s_cmp_eq_u32 s46, 1
    s_cbranch_scc1 L_T
    s_cmp_eq_u32 s46, 2
    s_cbranch_scc1 L_T
L_K:
    s_waitcnt vmcnt(16)
    v_or_b32 v131, s47, v131
    s_waitcnt vmcnt(15)
    v_lshl_or_b32 v128, v132, 4, v128
    v_lshl_or_b32 v129, v133, 4, v129
    v_lshl_or_b32 v130, v134, 4, v130
    s_waitcnt vmcnt(14)
    v_lshl_or_b32 v131, v135, 4, v131
    s_waitcnt vmcnt(13)
    v_lshl_or_b32 v128, v136, 8, v128
    v_lshl_or_b32 v129, v137, 8, v129
    v_lshl_or_b32 v130, v138, 8, v130
    s_waitcnt vmcnt(12)
    v_lshl_or_b32 v131, v139, 8, v131
    s_waitcnt vmcnt(11)
    v_lshl_or_b32 v128, v140, 12, v128
    v_lshl_or_b32 v129, v141, 12, v129
    v_lshl_or_b32 v130, v142, 12, v130
    s_waitcnt vmcnt(10)
    v_lshl_or_b32 v131, v143, 12, v131
    s_waitcnt vmcnt(9)
    v_lshl_or_b32 v128, v144, 16, v128
    v_lshl_or_b32 v129, v145, 16, v129
    v_lshl_or_b32 v130, v146, 16, v130
    s_waitcnt vmcnt(8)
    v_lshl_or_b32 v128, v148, 20, v128
    v_lshl_or_b32 v129, v149, 20, v129
    v_lshl_or_b32 v130, v150, 20, v130
    s_waitcnt vmcnt(7)
    v_lshl_or_b32 v128, v152, 24, v128
    v_lshl_or_b32 v129, v153, 24, v129
    v_lshl_or_b32 v130, v154, 24, v130
    s_waitcnt vmcnt(6)
    v_lshl_or_b32 v128, v156, 28, v128
    v_lshl_or_b32 v129, v157, 28, v129
    v_lshl_or_b32 v130, v158, 28, v130
    buffer_store_dwordx4 v[128:131], v20, s[12:15], s62 offen sc1
    s_add_u32 s62, s62, 65536
    s_cmp_eq_u32 s46, 1
    s_cbranch_scc1 L_B
    s_cmp_eq_u32 s46, 2
    s_cbranch_scc1 L_E
L_T:
    s_waitcnt vmcnt(16)
    s_cmp_eq_u32 s46, 1
    s_cbranch_scc1 L_rw1
    s_waitcnt vmcnt(5)
    s_cmp_eq_u32 s46, 0
    s_cbranch_scc1 L_rw1
    s_waitcnt vmcnt(4)
L_rw1:
    v_lshl_or_b32 v56, v17, 16, v16
    v_lshl_or_b32 v57, v17, 16, v16
    v_lshl_or_b32 v58, v17, 16, v16
    v_lshl_or_b32 v59, v17, 16, v16
    ds_write_b128 v8, v[56:59]
    ds_write_b128 v9, v[56:59]
    ds_write_b128 v10, v[56:59]
    ds_write_b128 v11, v[56:59]
    ds_write_b128 v12, v[56:59]
    ds_write_b128 v13, v[56:59]
    ds_write_b128 v14, v[56:59]
    ds_write_b128 v15, v[56:59]
    s_cmp_lg_u32 s46, 1
    s_cbranch_scc1 L_ed2
    s_waitcnt vmcnt(4)
    s_branch L_K
L_ed2:
    s_cmp_eq_u32 s46, 2
    s_cbranch_scc1 L_X
L_W:
    s_mov_b64 exec, 0
    s_cmp_eq_u32 s63, 0
    s_cbranch_scc1 L_pad0
L_warmed:
    s_mov_b64 exec, -1
L_B:
    s_waitcnt vmcnt(12) lgkmcnt(0)
    s_cmp_eq_u32 s46, 2
    s_cbranch_scc1 L_rw3
    s_waitcnt vmcnt(1)
L_rw3:
    s_barrier
L_Q:
    ds_read_b128 a[0:3], v40 offset:32768
    ds_read_b128 a[4:7], v41 offset:32768
    ds_read_b128 a[8:11], v40 offset:34816
    ds_read_b128 a[12:15], v41 offset:34816
    ds_read_b128 a[16:19], v40 offset:36864
    ds_read_b128 a[20:23], v41 offset:36864
    ds_read_b128 a[24:27], v40 offset:38912
    ds_read_b128 a[28:31], v41 offset:38912
    ds_read_b128 a[40:43], v40 offset:40960
    ds_read_b128 a[44:47], v41 offset:40960
    ds_read_b128 a[48:51], v40 offset:43008
    ds_read_b128 a[52:55], v41 offset:43008
    ds_read_b128 a[56:59], v40 offset:45056
    ds_read_b128 a[60:63], v41 offset:45056
    ds_read_b128 a[72:75], v40 offset:47104
    ds_read_b128 a[76:79], v41 offset:47104
L_P:
    buffer_load_dwordx4 v[64:67], v32, s[12:15], 0 offen sc1
    buffer_load_dwordx4 v[68:71], v33, s[12:15], 0 offen sc1
L_d:
    s_add_u32 m0, s57, 49152
    s_add_u32 s3, s69, 0
    buffer_load_dwordx4 v36, s[8:11], s3 offen offset:0  lds
    buffer_load_dwordx4 v37, s[8:11], s3 offen offset:1024  lds
    buffer_load_dwordx4 v38, s[8:11], s3 offen offset:2048  lds
    buffer_load_dwordx4 v39, s[8:11], s3 offen offset:3072  lds
    s_cmp_lg_u32 s46, 2
    s_cbranch_scc1 L_ed4
    s_waitcnt vmcnt(6)
    s_branch L_K
L_ed4:
L_E:
L_chk0:
    s_waitcnt vmcnt(5)
    s_cmp_eq_u32 s46, 2
    s_cbranch_scc1 L_rw5
    s_waitcnt vmcnt(4)
L_rw5:
    v_bitop3_b32 v12, v67, v71, s76 bitop3:0x7e
    v_cmp_lt_u32 vcc, 0xffff, v12
    s_cbranch_vccnz L_retry0
    buffer_load_dwordx4 v[72:75], v34, s[12:15], 0 offen sc1
    buffer_load_dwordx4 v[76:79], v44, s[12:15], 0 offen sc1
    v_perm_b32 v56, v64, v35, s36
    v_perm_b32 v57, v64, v35, s37
    v_perm_b32 v58, v64, v35, s38
    v_perm_b32 v59, v64, v35, s39
    v_perm_b32 v60, v68, v35, s36
    v_perm_b32 v61, v68, v35, s37
    v_perm_b32 v62, v68, v35, s38
    v_perm_b32 v63, v68, v35, s39
    ds_read_b32 a32, v56
    ds_read_b32 a33, v57
    ds_read_b32 a34, v58
    ds_read_b32 a35, v59
    ds_read_b32 a36, v60
    ds_read_b32 a37, v61
    ds_read_b32 a38, v62
    ds_read_b32 a39, v63
    v_perm_b32 v56, v65, v35, s36
    v_perm_b32 v57, v65, v35, s37
    v_perm_b32 v58, v65, v35, s38
    v_perm_b32 v59, v65, v35, s39
    v_perm_b32 v60, v69, v35, s36
    v_perm_b32 v61, v69, v35, s37
    ds_read_b32 a64, v56
    ds_read_b32 a65, v57
    ds_read_b32 a66, v58
    ds_read_b32 a67, v59
    s_cbranch_vccz L_main
L_retry0:
    s_add_u32 s52, s52, 1
    s_and_b32 s23, s52, 4095
    s_cbranch_scc1 L_retry0b
    s_mov_b32 s22, 0
    s_call_b64 s[20:21], L_help
L_retry0b:
    buffer_load_dwordx4 v[64:67], v32, s[12:15], 0 offen sc1
    buffer_load_dwordx4 v[68:71], v33, s[12:15], 0 offen sc1
    s_waitcnt vmcnt(0) lgkmcnt(0)
    s_branch L_chk0
L_tick:
    s_add_u32 s52, s52, 1
    s_and_b32 s23, s52, 4095
    s_cbranch_scc0 L_help
    s_setpc_b64 s[20:21]
L_slow0_1:
    s_mov_b32 s22, 0
    s_call_b64 s[20:21], L_tick
    buffer_load_dwordx4 v[72:75], v34, s[12:15], 0 offen sc1
    buffer_load_dwordx4 v[76:79], v44, s[12:15], 0 offen sc1
    s_waitcnt vmcnt(0)
    v_bitop3_b32 v12, v75, v79, s76 bitop3:0x7e
    v_cmp_lt_u32 vcc, 0xffff, v12
    s_cbranch_vccnz L_slow0_1
    s_branch L_back0_1
L_slow4_0:
    s_mov_b32 s22, 4
    s_call_b64 s[20:21], L_tick
    buffer_load_dwordx4 v[96:99], v32, s[12:15], s43 offen sc1
    buffer_load_dwordx4 v[100:103], v33, s[12:15], s43 offen sc1
    s_waitcnt vmcnt(0)
    v_bitop3_b32 v12, v99, v103, s76 bitop3:0x7e
    v_cmp_lt_u32 vcc, 0xffff, v12
    s_cbranch_vccnz L_slow4_0
    s_branch L_back4_0
L_slow4_1:
    s_mov_b32 s22, 4
    s_call_b64 s[20:21], L_tick
    buffer_load_dwordx4 v[104:107], v34, s[12:15], s43 offen sc1
    buffer_load_dwordx4 v[108:111], v44, s[12:15], s43 offen sc1
    s_waitcnt vmcnt(0)
    v_bitop3_b32 v12, v107, v111, s76 bitop3:0x7e
    v_cmp_lt_u32 vcc, 0xffff, v12
    s_cbranch_vccnz L_slow4_1
    s_branch L_back4_1
L_slow1_0:
    s_mov_b32 s22, 1
    s_call_b64 s[20:21], L_tick
    buffer_load_dwordx4 v[80:83], v32, s[12:15], s40 offen sc1
    buffer_load_dwordx4 v[84:87], v33, s[12:15], s40 offen sc1
    s_waitcnt vmcnt(0)
    v_bitop3_b32 v12, v83, v87, s76 bitop3:0x7e
    v_cmp_lt_u32 vcc, 0xffff, v12
    s_cbranch_vccnz L_slow1_0
    s_branch L_back1_0
L_slow1_1:
    s_mov_b32 s22, 1
    s_call_b64 s[20:21], L_tick
    buffer_load_dwordx4 v[88:91], v34, s[12:15], s40 offen sc1
    buffer_load_dwordx4 v[92:95], v44, s[12:15], s40 offen sc1
    s_waitcnt vmcnt(0)
    v_bitop3_b32 v12, v91, v95, s76 bitop3:0x7e
    v_cmp_lt_u32 vcc, 0xffff, v12
    s_cbranch_vccnz L_slow1_1
    s_branch L_back1_1
L_slow5_0:
    s_mov_b32 s22, 5
    s_call_b64 s[20:21], L_tick
    buffer_load_dwordx4 v[112:115], v32, s[12:15], s44 offen sc1
    buffer_load_dwordx4 v[116:119], v33, s[12:15], s44 offen sc1
    s_waitcnt vmcnt(0)
    v_bitop3_b32 v12, v115, v119, s76 bitop3:0x7e
    v_cmp_lt_u32 vcc, 0xffff, v12
    s_cbranch_vccnz L_slow5_0
    s_branch L_back5_0
L_slow5_1:
    s_mov_b32 s22, 5
    s_call_b64 s[20:21], L_tick
    buffer_load_dwordx4 v[120:123], v34, s[12:15], s44 offen sc1
    buffer_load_dwordx4 v[124:127], v44, s[12:15], s44 offen sc1
    s_waitcnt vmcnt(0)
    v_bitop3_b32 v12, v123, v127, s76 bitop3:0x7e
    v_cmp_lt_u32 vcc, 0xffff, v12
    s_cbranch_vccnz L_slow5_1
    s_branch L_back5_1
L_slow2_0:
    s_mov_b32 s22, 2
    s_call_b64 s[20:21], L_tick
    buffer_load_dwordx4 v[48:51], v32, s[12:15], s41 offen sc1
    buffer_load_dwordx4 v[52:55], v33, s[12:15], s41 offen sc1
    s_waitcnt vmcnt(0)
    v_bitop3_b32 v12, v51, v55, s76 bitop3:0x7e
    v_cmp_lt_u32 vcc, 0xffff, v12
    s_cbranch_vccnz L_slow2_0
    s_branch L_back2_0
L_slow2_1:
    s_mov_b32 s22, 2
    s_call_b64 s[20:21], L_tick
    buffer_load_dwordx4 v[64:67], v34, s[12:15], s41 offen sc1
    buffer_load_dwordx4 v[68:71], v44, s[12:15], s41 offen sc1
    s_waitcnt vmcnt(0)
    v_bitop3_b32 v12, v67, v71, s76 bitop3:0x7e
    v_cmp_lt_u32 vcc, 0xffff, v12
    s_cbranch_vccnz L_slow2_1
    s_branch L_back2_1
L_slow6_0:
    s_mov_b32 s22, 6
    s_call_b64 s[20:21], L_tick
    buffer_load_dwordx4 v[88:91], v32, s[12:15], s45 offen sc1
    buffer_load_dwordx4 v[92:95], v33, s[12:15], s45 offen sc1
    s_waitcnt vmcnt(0)
    v_bitop3_b32 v12, v91, v95, s76 bitop3:0x7e
    v_cmp_lt_u32 vcc, 0xffff, v12
    s_cbranch_vccnz L_slow6_0
    s_branch L_back6_0
L_slow6_1:
    s_mov_b32 s22, 6
    s_call_b64 s[20:21], L_tick
    buffer_load_dwordx4 v[48:51], v34, s[12:15], s45 offen sc1
    buffer_load_dwordx4 v[52:55], v44, s[12:15], s45 offen sc1
    s_waitcnt vmcnt(0)
    v_bitop3_b32 v12, v51, v55, s76 bitop3:0x7e
    v_cmp_lt_u32 vcc, 0xffff, v12
    s_cbranch_vccnz L_slow6_1
    s_branch L_back6_1
L_slow3_0:
    s_mov_b32 s22, 3
    s_call_b64 s[20:21], L_tick
    buffer_load_dwordx4 v[72:75], v32, s[12:15], s42 offen sc1
    buffer_load_dwordx4 v[76:79], v33, s[12:15], s42 offen sc1
    s_waitcnt vmcnt(0)
    v_bitop3_b32 v12, v75, v79, s76 bitop3:0x7e
    v_cmp_lt_u32 vcc, 0xffff, v12
    s_cbranch_vccnz L_slow3_0
    s_branch L_back3_0
L_slow3_1:
    s_mov_b32 s22, 3
    s_call_b64 s[20:21], L_tick
    buffer_load_dwordx4 v[80:83], v34, s[12:15], s42 offen sc1
    buffer_load_dwordx4 v[84:87], v44, s[12:15], s42 offen sc1
    s_waitcnt vmcnt(0)
    v_bitop3_b32 v12, v83, v87, s76 bitop3:0x7e
    v_cmp_lt_u32 vcc, 0xffff, v12
    s_cbranch_vccnz L_slow3_1
    s_branch L_back3_1
L_slow7_0:
    s_mov_b32 s22, 7
    s_call_b64 s[20:21], L_tick
    buffer_load_dwordx4 v[68:71], v32, s[12:15], s72 offen sc1
    buffer_load_dwordx4 v[72:75], v33, s[12:15], s72 offen sc1
    s_waitcnt vmcnt(0)
    v_bitop3_b32 v12, v71, v75, s76 bitop3:0x7e
    v_cmp_lt_u32 vcc, 0xffff, v12
    s_cbranch_vccnz L_slow7_0
    s_branch L_back7_0
L_slow7_1:
    s_mov_b32 s22, 7
    s_call_b64 s[20:21], L_tick
    buffer_load_dwordx4 v[76:79], v34, s[12:15], s72 offen sc1
    buffer_load_dwordx4 v[80:83], v44, s[12:15], s72 offen sc1
    s_waitcnt vmcnt(0)
    v_bitop3_b32 v12, v79, v83, s76 bitop3:0x7e
    v_cmp_lt_u32 vcc, 0xffff, v12
    s_cbranch_vccnz L_slow7_1
    s_branch L_back7_1
.p2align 12
L_main:
L_pad0:
    s_cbranch_execz L_pad1
    s_waitcnt lgkmcnt(8)
    v_mfma_f32_16x16x32_bf16 v[128:131], a[32:35], a[0:3], 0
    s_waitcnt lgkmcnt(4)
    s_mov_b32 s40, 16384
    ds_read_b32 a68, v60
    v_mfma_f32_16x16x32_bf16 v[128:131], a[36:39], a[4:7], v[128:131]
    buffer_load_dwordx4 v[80:83], v32, s[12:15], s40 offen sc1
    v_mfma_f32_16x16x32_bf16 v[132:135], a[36:39], a[12:15], 0
    s_add_u32 m0, s57, 65536
    ds_read_b32 a69, v61
    v_perm_b32 v62, v69, v35, s38
    v_mfma_f32_16x16x32_bf16 v[132:135], a[32:35], a[8:11], v[132:135]
    s_add_u32 s56, s55, 256
    ds_read_b32 a70, v62
    v_perm_b32 v63, v69, v35, s39
    v_mfma_f32_16x16x32_bf16 v[136:139], a[32:35], a[16:19], 0
    s_add_u32 s3, s69, 256
    ds_read_b32 a71, v63
    v_mfma_f32_16x16x32_bf16 v[136:139], a[36:39], a[20:23], v[136:139]
    buffer_load_dwordx4 v[84:87], v33, s[12:15], s40 offen sc1
    v_mfma_f32_16x16x32_bf16 v[140:143], a[36:39], a[28:31], 0
    v_perm_b32 v56, v66, v35, s36
    v_perm_b32 v57, v66, v35, s37
    v_mfma_f32_16x16x32_bf16 v[140:143], a[32:35], a[24:27], v[140:143]
    ds_read_b32 a80, v56
    v_perm_b32 v58, v66, v35, s38
    v_mfma_f32_16x16x32_bf16 v[144:147], a[32:35], a[40:43], 0
    ds_read_b32 a81, v57
    v_mfma_f32_16x16x32_bf16 v[144:147], a[36:39], a[44:47], v[144:147]
    buffer_load_dwordx4 v36, s[8:11], s56 offen offset:0  lds
    v_mfma_f32_16x16x32_bf16 v[148:151], a[36:39], a[52:55], 0
    ds_read_b32 a82, v58
    v_perm_b32 v59, v66, v35, s39
    v_mfma_f32_16x16x32_bf16 v[148:151], a[32:35], a[48:51], v[148:151]
    v_perm_b32 v60, v70, v35, s36
    v_perm_b32 v61, v70, v35, s37
    v_mfma_f32_16x16x32_bf16 v[152:155], a[32:35], a[56:59], 0
    s_mov_b32 s41, 32768
    ds_read_b32 a83, v59
    ds_read_b32 a84, v60
    v_mfma_f32_16x16x32_bf16 v[152:155], a[36:39], a[60:63], v[152:155]
    buffer_load_dwordx4 v37, s[8:11], s56 offen offset:1024  lds
    v_mfma_f32_16x16x32_bf16 v[156:159], a[36:39], a[76:79], 0
    ds_read_b32 a85, v61
    v_perm_b32 v62, v70, v35, s38
    v_mfma_f32_16x16x32_bf16 v[156:159], a[32:35], a[72:75], v[156:159]
    s_waitcnt lgkmcnt(6)
    ds_read_b32 a86, v62
    v_perm_b32 v63, v70, v35, s39
    v_mfma_f32_16x16x32_bf16 v[160:163], a[64:67], a[0:3], 0
    ds_read_b32 a87, v63
    v_mfma_f32_16x16x32_bf16 v[160:163], a[68:71], a[4:7], v[160:163]
    buffer_load_dwordx4 v38, s[8:11], s56 offen offset:2048  lds
    v_mfma_f32_16x16x32_bf16 v[164:167], a[68:71], a[12:15], 0
    v_perm_b32 v56, v67, v35, s36
    v_perm_b32 v57, v67, v35, s37
    v_mfma_f32_16x16x32_bf16 v[164:167], a[64:67], a[8:11], v[164:167]
    ds_read_b32 a88, v56
    v_perm_b32 v58, v71, v35, s36
    v_mfma_f32_16x16x32_bf16 v[168:171], a[64:67], a[16:19], 0
    ds_read_b32 a89, v57
    v_mfma_f32_16x16x32_bf16 v[168:171], a[68:71], a[20:23], v[168:171]
    buffer_load_dwordx4 v39, s[8:11], s56 offen offset:3072  lds
    v_mfma_f32_16x16x32_bf16 v[172:175], a[68:71], a[28:31], 0
    s_add_u32 m0, s57, 81920
    ds_read_b32 a90, v58
    v_perm_b32 v59, v71, v35, s37
    v_mfma_f32_16x16x32_bf16 v[172:175], a[64:67], a[24:27], v[172:175]
    s_add_u32 s56, s55, 512
    ds_read_b32 a91, v59
    v_mfma_f32_16x16x32_bf16 v[176:179], a[64:67], a[40:43], 0
    s_waitcnt vmcnt(6)
    s_mov_b32 s42, 49152
    v_bitop3_b32 v60, v75, v79, s76 bitop3:0x7e
    v_mfma_f32_16x16x32_bf16 v[176:179], a[68:71], a[44:47], v[176:179]
    buffer_load_dwordx4 v[88:91], v34, s[12:15], s40 offen sc1
    v_mfma_f32_16x16x32_bf16 v[180:183], a[68:71], a[52:55], 0
    v_cmp_lt_u32 vcc, 0xffff, v60
    v_mfma_f32_16x16x32_bf16 v[180:183], a[64:67], a[48:51], v[180:183]
    v_mfma_f32_16x16x32_bf16 v[184:187], a[64:67], a[56:59], 0
    s_cbranch_vccnz L_slow0_1
L_back0_1:
    v_mfma_f32_16x16x32_bf16 v[184:187], a[68:71], a[60:63], v[184:187]
    buffer_load_dwordx4 v[92:95], v44, s[12:15], s40 offen sc1
    v_mfma_f32_16x16x32_bf16 v[188:191], a[68:71], a[76:79], 0
    v_perm_b32 v61, v72, v35, s36
    v_perm_b32 v62, v72, v35, s37
    v_mfma_f32_16x16x32_bf16 v[188:191], a[64:67], a[72:75], v[188:191]
    s_waitcnt lgkmcnt(1)
    ds_read_b32 a96, v61
    v_perm_b32 v63, v72, v35, s38
    v_mfma_f32_16x16x32_bf16 v[192:195], a[80:83], a[0:3], 0
    s_barrier
    v_mfma_f32_16x16x32_bf16 v[192:195], a[84:87], a[4:7], v[192:195]
    buffer_load_dwordx4 v36, s[8:11], s3 offen offset:0  lds
    v_mfma_f32_16x16x32_bf16 v[196:199], a[84:87], a[12:15], 0
    ds_read_b32 a97, v62
    ds_read_b32 a98, v63
    v_mfma_f32_16x16x32_bf16 v[196:199], a[80:83], a[8:11], v[196:199]
    ds_read_b128 a[104:107], v40 offset:49152
    v_perm_b32 v56, v72, v35, s39
    v_mfma_f32_16x16x32_bf16 v[200:203], a[80:83], a[16:19], 0
    s_mov_b32 s43, 65536
    ds_read_b32 a99, v56
    ds_read_b128 a[108:111], v41 offset:49152
    v_mfma_f32_16x16x32_bf16 v[200:203], a[84:87], a[20:23], v[200:203]
    buffer_load_dwordx4 v37, s[8:11], s3 offen offset:1024  lds
    v_mfma_f32_16x16x32_bf16 v[204:207], a[84:87], a[28:31], 0
    ds_read_b128 a[112:115], v40 offset:51200
    v_perm_b32 v57, v76, v35, s36
    v_mfma_f32_16x16x32_bf16 v[204:207], a[80:83], a[24:27], v[204:207]
    ds_read_b32 a100, v57
    v_perm_b32 v58, v76, v35, s37
    v_mfma_f32_16x16x32_bf16 v[208:211], a[80:83], a[40:43], 0
    ds_read_b32 a101, v58
    ds_read_b128 a[116:119], v41 offset:51200
    v_mfma_f32_16x16x32_bf16 v[208:211], a[84:87], a[44:47], v[208:211]
    buffer_load_dwordx4 v38, s[8:11], s3 offen offset:2048  lds
    v_mfma_f32_16x16x32_bf16 v[212:215], a[84:87], a[52:55], 0
    ds_read_b128 a[120:123], v40 offset:53248
    v_perm_b32 v59, v76, v35, s38
    v_mfma_f32_16x16x32_bf16 v[212:215], a[80:83], a[48:51], v[212:215]
    ds_read_b32 a102, v59
    v_perm_b32 v60, v76, v35, s39
    v_mfma_f32_16x16x32_bf16 v[216:219], a[80:83], a[56:59], 0
    ds_read_b32 a103, v60
    ds_read_b128 a[124:127], v41 offset:53248
    v_mfma_f32_16x16x32_bf16 v[216:219], a[84:87], a[60:63], v[216:219]
    ds_read_b128 a[128:131], v40 offset:55296
    v_perm_b32 v61, v73, v35, s36
    v_mfma_f32_16x16x32_bf16 v[220:223], a[84:87], a[76:79], 0
    ds_read_b32 a136, v61
    v_perm_b32 v62, v73, v35, s37
    v_mfma_f32_16x16x32_bf16 v[220:223], a[80:83], a[72:75], v[220:223]
    s_waitcnt lgkmcnt(9)
    ds_read_b32 a137, v62
    ds_read_b128 a[132:135], v41 offset:55296
    v_mfma_f32_16x16x32_bf16 v[224:227], a[88:91], a[2:5], 0
    buffer_load_dwordx4 v39, s[8:11], s3 offen offset:3072  lds
    v_mfma_f32_16x16x32_bf16 v[228:231], a[88:91], a[10:13], 0
    s_add_u32 m0, s57, 0
    ds_read_b128 a[144:147], v40 offset:57344
    v_perm_b32 v63, v73, v35, s38
    v_mfma_f32_16x16x32_bf16 v[232:235], a[88:91], a[18:21], 0
    s_add_u32 s3, s69, 512
    ds_read_b32 a138, v63
    v_perm_b32 v56, v73, v35, s39
    v_mfma_f32_16x16x32_bf16 v[236:239], a[88:91], a[26:29], 0
    s_mov_b32 s44, 81920
    ds_read_b32 a139, v56
    v_perm_b32 v57, v77, v35, s36
    v_mfma_f32_16x16x32_bf16 v[240:243], a[88:91], a[42:45], 0
    ds_read_b32 a140, v57
    ds_read_b128 a[148:151], v41 offset:57344
    v_mfma_f32_16x16x32_bf16 v[244:247], a[88:91], a[50:53], 0
    buffer_load_dwordx3 v[96:98], v18, s[4:7], s61 offen nt
    v_mfma_f32_16x16x32_bf16 v[248:251], a[88:91], a[58:61], 0
    ds_read_b128 a[152:155], v40 offset:59392
    v_perm_b32 v58, v77, v35, s37
    v_mfma_f32_16x16x32_bf16 v[252:255], a[88:91], a[74:77], 0
    ds_read_b128 a[156:159], v41 offset:59392
    v_perm_b32 v59, v77, v35, s38
    v_mfma_f32_16x16x32_bf16 v[128:131], a[96:99], a[104:107], v[128:131]
    s_waitcnt lgkmcnt(7)
    ds_read_b32 a141, v58
    ds_read_b32 a142, v59
    v_mfma_f32_16x16x32_bf16 v[128:131], a[100:103], a[108:111], v[128:131]
    buffer_load_dword v99, v19, s[4:7], s61 offen nt
    v_mfma_f32_16x16x32_bf16 v[132:135], a[100:103], a[116:119], v[132:135]
    s_add_u32 s61, s61, 14336
    ds_read_b128 a[160:163], v40 offset:61440
    v_perm_b32 v60, v77, v35, s39
    v_mfma_f32_16x16x32_bf16 v[132:135], a[96:99], a[112:115], v[132:135]
    s_waitcnt vmcnt(12)
    v_bitop3_b32 v61, v83, v87, s76 bitop3:0x7e
    v_perm_b32 v62, v74, v35, s36
    v_mfma_f32_16x16x32_bf16 v[136:139], a[96:99], a[120:123], v[136:139]
    s_mov_b32 s45, 98304
    ds_read_b128 a[164:167], v41 offset:61440
    ds_read_b32 a143, v60
    v_mfma_f32_16x16x32_bf16 v[136:139], a[100:103], a[124:127], v[136:139]
    buffer_load_dwordx3 v[100:102], v18, s[4:7], s61 offen nt
    v_mfma_f32_16x16x32_bf16 v[140:143], a[100:103], a[132:135], v[140:143]
    ds_read_b128 a[168:171], v40 offset:63488
    ds_read_b32 a176, v62
    v_mfma_f32_16x16x32_bf16 v[140:143], a[96:99], a[128:131], v[140:143]
    s_waitcnt lgkmcnt(8)
    ds_read_b128 a[172:175], v41 offset:63488
    v_cmp_lt_u32 vcc, 0xffff, v61
    v_mfma_f32_16x16x32_bf16 v[144:147], a[96:99], a[144:147], v[144:147]
    s_waitcnt lgkmcnt(8)
    v_perm_b32 v63, v74, v35, s37
    v_mfma_f32_16x16x32_bf16 v[144:147], a[100:103], a[148:151], v[144:147]
    buffer_load_dword v103, v19, s[4:7], s61 offen nt
    v_mfma_f32_16x16x32_bf16 v[148:151], a[100:103], a[156:159], v[148:151]
    s_add_u32 s61, s61, 14336
    ds_read_b32 a177, v63
    v_perm_b32 v56, v74, v35, s38
    v_mfma_f32_16x16x32_bf16 v[148:151], a[96:99], a[152:155], v[148:151]
    s_waitcnt lgkmcnt(6)
    v_perm_b32 v57, v74, v35, s39
    s_cbranch_vccnz L_slow1_0
L_back1_0:
    v_mfma_f32_16x16x32_bf16 v[152:155], a[96:99], a[160:163], v[152:155]
    s_waitcnt lgkmcnt(5)
    ds_read_b32 a178, v56
    ds_read_b32 a179, v57
    v_mfma_f32_16x16x32_bf16 v[152:155], a[100:103], a[164:167], v[152:155]
    s_waitcnt lgkmcnt(3)
    buffer_load_dwordx3 v[104:106], v18, s[4:7], s61 offen nt
    v_mfma_f32_16x16x32_bf16 v[156:159], a[100:103], a[172:175], v[156:159]
    v_perm_b32 v58, v78, v35, s36
    v_perm_b32 v59, v78, v35, s37
    v_mfma_f32_16x16x32_bf16 v[156:159], a[96:99], a[168:171], v[156:159]
    ds_read_b32 a180, v58
    ds_read_b32 a181, v59
    v_perm_b32 v60, v78, v35, s38
    v_mfma_f32_16x16x32_bf16 v[160:163], a[136:139], a[104:107], v[160:163]
    s_mov_b32 s72, 114688
    ds_read_b32 a182, v60
    v_mfma_f32_16x16x32_bf16 v[160:163], a[140:143], a[108:111], v[160:163]
    buffer_load_dword v107, v19, s[4:7], s61 offen nt
    v_mfma_f32_16x16x32_bf16 v[164:167], a[140:143], a[116:119], v[164:167]
    s_add_u32 s61, s61, 14336
    v_perm_b32 v62, v78, v35, s39
    v_perm_b32 v61, v75, v35, s36
    v_mfma_f32_16x16x32_bf16 v[164:167], a[136:139], a[112:115], v[164:167]
    ds_read_b32 a183, v62
    ds_read_b32 a92, v61
    v_perm_b32 v63, v75, v35, s37
    v_mfma_f32_16x16x32_bf16 v[168:171], a[136:139], a[120:123], v[168:171]
    ds_read_b32 a93, v63
    v_mfma_f32_16x16x32_bf16 v[168:171], a[140:143], a[124:127], v[168:171]
    buffer_load_dwordx3 v[108:110], v18, s[4:7], s61 offen nt
    v_mfma_f32_16x16x32_bf16 v[172:175], a[140:143], a[132:135], v[172:175]
    v_perm_b32 v56, v79, v35, s36
    v_perm_b32 v57, v79, v35, s37
    v_mfma_f32_16x16x32_bf16 v[172:175], a[136:139], a[128:131], v[172:175]
    ds_read_b32 a94, v56
    ds_read_b32 a95, v57
    v_perm_b32 v58, v80, v35, s36
    v_mfma_f32_16x16x32_bf16 v[176:179], a[136:139], a[144:147], v[176:179]
    ds_read_b32 a184, v58
    v_mfma_f32_16x16x32_bf16 v[176:179], a[140:143], a[148:151], v[176:179]
    buffer_load_dword v111, v19, s[4:7], s61 offen nt
    v_mfma_f32_16x16x32_bf16 v[180:183], a[140:143], a[156:159], v[180:183]
    s_add_u32 s61, s61, 14336
    v_perm_b32 v59, v80, v35, s37
    v_perm_b32 v60, v80, v35, s38
    v_mfma_f32_16x16x32_bf16 v[180:183], a[136:139], a[152:155], v[180:183]
    ds_read_b32 a185, v59
    v_perm_b32 v62, v80, v35, s39
    v_mfma_f32_16x16x32_bf16 v[184:187], a[136:139], a[160:163], v[184:187]
    ds_read_b32 a186, v60
    ds_read_b32 a187, v62
    v_mfma_f32_16x16x32_bf16 v[184:187], a[140:143], a[164:167], v[184:187]
    buffer_load_dwordx3 v[112:114], v18, s[4:7], s61 offen nt
    v_mfma_f32_16x16x32_bf16 v[188:191], a[140:143], a[172:175], v[188:191]
    s_add_u32 s61, s61, 14336
    v_perm_b32 v61, v84, v35, s36
    v_perm_b32 v63, v84, v35, s37
    v_mfma_f32_16x16x32_bf16 v[188:191], a[136:139], a[168:171], v[188:191]
    s_waitcnt vmcnt(15) lgkmcnt(6)
    ds_read_b32 a188, v61
    v_perm_b32 v56, v84, v35, s38
    v_mfma_f32_16x16x32_bf16 v[192:195], a[176:179], a[104:107], v[192:195]
    s_barrier
    v_mfma_f32_16x16x32_bf16 v[192:195], a[180:183], a[108:111], v[192:195]
    buffer_load_dwordx3 v[116:118], v18, s[4:7], s61 offen nt
    v_mfma_f32_16x16x32_bf16 v[196:199], a[180:183], a[116:119], v[196:199]
    s_add_u32 s61, s61, 14336
    ds_read_b32 a189, v63
    ds_read_b128 a[192:195], v42 offset:0
    v_mfma_f32_16x16x32_bf16 v[196:199], a[176:179], a[112:115], v[196:199]
    ds_read_b32 a190, v56
    ds_read_b128 a[196:199], v43 offset:0
    v_mfma_f32_16x16x32_bf16 v[200:203], a[176:179], a[120:123], v[200:203]
    ds_read_b128 a[204:207], v43 offset:2048
    v_perm_b32 v57, v84, v35, s39
    v_mfma_f32_16x16x32_bf16 v[200:203], a[180:183], a[124:127], v[200:203]
    ds_read_b32 a191, v57
    ds_read_b128 a[200:203], v42 offset:2048
    v_mfma_f32_16x16x32_bf16 v[204:207], a[180:183], a[132:135], v[204:207]
    buffer_load_dwordx3 v[120:122], v18, s[4:7], s61 offen nt
    v_mfma_f32_16x16x32_bf16 v[204:207], a[176:179], a[128:131], v[204:207]
    s_add_u32 s61, s61, 14336
    ds_read_b128 a[208:211], v42 offset:4096
    v_perm_b32 v58, v81, v35, s36
    v_mfma_f32_16x16x32_bf16 v[208:211], a[176:179], a[144:147], v[208:211]
    ds_read_b128 a[212:215], v43 offset:4096
    ds_read_b32 a216, v58
    v_mfma_f32_16x16x32_bf16 v[208:211], a[180:183], a[148:151], v[208:211]
    s_waitcnt vmcnt(15)
    ds_read_b128 a[228:231], v43 offset:6144
    v_bitop3_b32 v59, v91, v95, s76 bitop3:0x7e
    v_mfma_f32_16x16x32_bf16 v[212:215], a[180:183], a[156:159], v[212:215]
    ds_read_b128 a[224:227], v42 offset:6144
    v_mfma_f32_16x16x32_bf16 v[212:215], a[176:179], a[152:155], v[212:215]
    buffer_load_dwordx3 v[124:126], v18, s[4:7], s61 offen nt
    v_mfma_f32_16x16x32_bf16 v[216:219], a[176:179], a[160:163], v[216:219]
    ds_read_b128 a[232:235], v42 offset:8192
    v_cmp_lt_u32 vcc, 0xffff, v59
    v_mfma_f32_16x16x32_bf16 v[216:219], a[180:183], a[164:167], v[216:219]
    ds_read_b128 a[236:239], v43 offset:8192
    v_perm_b32 v60, v81, v35, s37
    v_mfma_f32_16x16x32_bf16 v[220:223], a[180:183], a[172:175], v[220:223]
    ds_read_b128 a[240:243], v42 offset:10240
    ds_read_b32 a217, v60
    v_mfma_f32_16x16x32_bf16 v[220:223], a[176:179], a[168:171], v[220:223]
    s_waitcnt lgkmcnt(9)
    ds_read_b128 a[244:247], v43 offset:10240
    s_cbranch_vccnz L_slow1_1
L_back1_1:
    v_mfma_f32_16x16x32_bf16 v[224:227], a[92:95], a[106:109], v[224:227]
    buffer_load_dwordx4 v[48:51], v32, s[12:15], s41 offen sc1
    v_mfma_f32_16x16x32_bf16 v[228:231], a[92:95], a[114:117], v[228:231]
    ds_read_b128 a[248:251], v42 offset:12288
    v_perm_b32 v62, v81, v35, s38
    v_mfma_f32_16x16x32_bf16 v[232:235], a[92:95], a[122:125], v[232:235]
    ds_read_b32 a218, v62
    ds_read_b128 a[252:255], v43 offset:12288
    v_mfma_f32_16x16x32_bf16 v[236:239], a[92:95], a[130:133], v[236:239]
    v_perm_b32 v61, v81, v35, s39
    v_perm_b32 v63, v85, v35, s36
    v_mfma_f32_16x16x32_bf16 v[240:243], a[92:95], a[146:149], v[240:243]
    ds_read_b32 a219, v61
    ds_read_b32 a220, v63
    v_mfma_f32_16x16x32_bf16 v[244:247], a[92:95], a[154:157], v[244:247]
    buffer_load_dwordx4 v[52:55], v33, s[12:15], s41 offen sc1
    v_mfma_f32_16x16x32_bf16 v[248:251], a[92:95], a[162:165], v[248:251]
    ds_read_b128 a[32:35], v42 offset:14336
    v_perm_b32 v56, v85, v35, s37
    v_mfma_f32_16x16x32_bf16 v[252:255], a[92:95], a[170:173], v[252:255]
    ds_read_b32 a221, v56
    v_perm_b32 v57, v85, v35, s38
    v_mfma_f32_16x16x32_bf16 v[128:131], a[184:187], a[192:195], v[128:131]
    ds_read_b32 a222, v57
    ds_read_b128 a[36:39], v43 offset:14336
    v_mfma_f32_16x16x32_bf16 v[128:131], a[188:191], a[196:199], v[128:131]
    v_perm_b32 v58, v85, v35, s39
    v_perm_b32 v59, v82, v35, s36
    v_mfma_f32_16x16x32_bf16 v[132:135], a[188:191], a[204:207], v[132:135]
    ds_read_b32 a223, v58
    ds_read_b32 a64, v59
    v_perm_b32 v60, v82, v35, s37
    v_mfma_f32_16x16x32_bf16 v[132:135], a[184:187], a[200:203], v[132:135]
    s_mul_i32 s66, s63, 96
    s_lshl_b32 s67, s65, 5
    s_lshl_b32 s70, s64, 2
    s_add_u32 s67, s67, s70
    s_add_u32 s67, s67, 384
    s_mul_i32 s71, s59, 448
    s_add_u32 s70, s66, s71
    v_mad_u32_u24 v22, v3, 24, s70
    s_add_u32 s70, s67, s71
    v_lshl_add_u32 v23, v3, 3, s70
    s_mov_b32 s34, 7168
    s_mov_b32 s35, 0x20000
    s_mov_b32 s26, 256
    s_mov_b32 s27, 0x20000
    s_lshl_b32 s77, s59, 4
    s_mov_b32 s18, 14680064
    s_mov_b32 s19, 0x20000
    s_sub_u32 s70, 1024, s71
    v_mul_u32_u24 v16, 464, v4
    v_add3_u32 v26, v22, v16, s70
    v_add3_u32 v28, v23, v16, s70
    v_lshlrev_b32 v29, 3, v0
    v_xor_b32 v30, 512, v29
    v_add_u32 v29, 52992, v29
    v_add_u32 v30, 52992, v30
    v_mul_u32_u24 v16, 2341, v2
    v_lshrrev_b32 v16, 16, v16
    s_mul_i32 s73, s63, 1856
    s_add_u32 s73, s73, 1024
    v_add_lshl_u32 v24, v2, v16, 4
    v_add_u32 v24, s73, v24
    s_lshl_b32 s74, s58, 7
    s_lshl_b32 s75, s63, 2
    s_add_u32 s74, s74, s75
    s_mul_i32 s74, s74, 7168
    s_add_u32 s74, s74, s71
    v_mul_u32_u24 v17, 6720, v16
    v_lshl_add_u32 v25, v2, 4, v17
    v_lshrrev_b32 v16, 1, v16
    v_lshlrev_b32 v16, 30, v16
    v_add3_u32 v25, v25, v16, s74
    s_waitcnt lgkmcnt(8)
    v_mfma_f32_16x16x32_bf16 v[136:139], a[184:187], a[208:211], v[136:139]
    buffer_load_dwordx4 v36, s[8:11], s56 offen offset:0  lds
    v_mfma_f32_16x16x32_bf16 v[136:139], a[188:191], a[212:215], v[136:139]
    ds_read_b32 a65, v60
    v_perm_b32 v62, v82, v35, s38
    v_mfma_f32_16x16x32_bf16 v[140:143], a[188:191], a[228:231], v[140:143]
    ds_read_b32 a66, v62
    v_perm_b32 v61, v82, v35, s39
    v_perm_b32 v63, v86, v35, s36
    v_mfma_f32_16x16x32_bf16 v[140:143], a[184:187], a[224:227], v[140:143]
    ds_read_b32 a67, v61
    ds_read_b32 a68, v63
    v_mfma_f32_16x16x32_bf16 v[144:147], a[184:187], a[232:235], v[144:147]
    buffer_load_dwordx4 v37, s[8:11], s56 offen offset:1024  lds
    v_mfma_f32_16x16x32_bf16 v[144:147], a[188:191], a[236:239], v[144:147]
    v_perm_b32 v56, v86, v35, s37
    v_perm_b32 v57, v86, v35, s38
    v_mfma_f32_16x16x32_bf16 v[148:151], a[188:191], a[244:247], v[148:151]
    ds_read_b32 a69, v56
    ds_read_b32 a70, v57
    v_perm_b32 v58, v86, v35, s39
    v_mfma_f32_16x16x32_bf16 v[148:151], a[184:187], a[240:243], v[148:151]
    ds_read_b32 a71, v58
    v_mfma_f32_16x16x32_bf16 v[152:155], a[184:187], a[248:251], v[152:155]
    buffer_load_dwordx4 v38, s[8:11], s56 offen offset:2048  lds
    v_mfma_f32_16x16x32_bf16 v[152:155], a[188:191], a[252:255], v[152:155]
    s_waitcnt lgkmcnt(7)
    v_perm_b32 v59, v83, v35, s36
    v_perm_b32 v60, v83, v35, s37
    v_mfma_f32_16x16x32_bf16 v[156:159], a[188:191], a[36:39], v[156:159]
    ds_read_b32 a80, v59
    ds_read_b32 a81, v60
    v_perm_b32 v62, v87, v35, s36
    v_mfma_f32_16x16x32_bf16 v[156:159], a[184:187], a[32:35], v[156:159]
    ds_read_b32 a82, v62
    v_mfma_f32_16x16x32_bf16 v[160:163], a[216:219], a[192:195], v[160:163]
    buffer_load_dwordx4 v39, s[8:11], s56 offen offset:3072  lds
    v_mfma_f32_16x16x32_bf16 v[160:163], a[220:223], a[196:199], v[160:163]
    s_add_u32 m0, s57, 16384
    v_perm_b32 v61, v87, v35, s37
    v_perm_b32 v63, v88, v35, s36
    v_mfma_f32_16x16x32_bf16 v[164:167], a[220:223], a[204:207], v[164:167]
    s_add_u32 s56, s55, 768
    ds_read_b32 a83, v61
    v_perm_b32 v56, v88, v35, s37
    v_mfma_f32_16x16x32_bf16 v[164:167], a[216:219], a[200:203], v[164:167]
    ds_read_b32 a0, v63
    ds_read_b32 a1, v56
    v_mfma_f32_16x16x32_bf16 v[168:171], a[216:219], a[208:211], v[168:171]
    buffer_load_dwordx4 v[64:67], v34, s[12:15], s41 offen sc1
    v_mfma_f32_16x16x32_bf16 v[168:171], a[220:223], a[212:215], v[168:171]
    v_perm_b32 v57, v88, v35, s38
    v_perm_b32 v58, v88, v35, s39
    v_mfma_f32_16x16x32_bf16 v[172:175], a[220:223], a[228:231], v[172:175]
    ds_read_b32 a2, v57
    ds_read_b32 a3, v58
    v_perm_b32 v59, v92, v35, s36
    v_mfma_f32_16x16x32_bf16 v[172:175], a[216:219], a[224:227], v[172:175]
    ds_read_b32 a4, v59
    v_mfma_f32_16x16x32_bf16 v[176:179], a[216:219], a[232:235], v[176:179]
    buffer_load_dwordx4 v[68:71], v44, s[12:15], s41 offen sc1
    v_mfma_f32_16x16x32_bf16 v[176:179], a[220:223], a[236:239], v[176:179]
    v_perm_b32 v60, v92, v35, s37
    v_perm_b32 v62, v92, v35, s38
    v_mfma_f32_16x16x32_bf16 v[180:183], a[220:223], a[244:247], v[180:183]
    ds_read_b32 a5, v60
    ds_read_b32 a6, v62
    v_perm_b32 v61, v92, v35, s39
    v_mfma_f32_16x16x32_bf16 v[180:183], a[216:219], a[240:243], v[180:183]
    ds_read_b32 a7, v61
    v_mfma_f32_16x16x32_bf16 v[184:187], a[216:219], a[248:251], v[184:187]
    buffer_load_dwordx4 v[72:75], v32, s[12:15], s42 offen sc1
    v_mfma_f32_16x16x32_bf16 v[184:187], a[220:223], a[252:255], v[184:187]
    v_perm_b32 v63, v89, v35, s36
    v_perm_b32 v56, v89, v35, s37
    v_mfma_f32_16x16x32_bf16 v[188:191], a[220:223], a[36:39], v[188:191]
    ds_read_b32 a8, v63
    ds_read_b32 a9, v56
    v_perm_b32 v57, v89, v35, s38
    v_mfma_f32_16x16x32_bf16 v[188:191], a[216:219], a[32:35], v[188:191]
    s_waitcnt vmcnt(21) lgkmcnt(6)
    ds_read_b32 a10, v57
    v_mfma_f32_16x16x32_bf16 v[192:195], a[64:67], a[192:195], v[192:195]
    buffer_load_dwordx4 v[76:79], v33, s[12:15], s42 offen sc1
    v_mfma_f32_16x16x32_bf16 v[192:195], a[68:71], a[196:199], v[192:195]
    s_barrier
    v_mfma_f32_16x16x32_bf16 v[196:199], a[68:71], a[204:207], v[196:199]
    ds_read_b128 a[16:19], v42 offset:16384
    v_perm_b32 v58, v89, v35, s39
    v_mfma_f32_16x16x32_bf16 v[196:199], a[64:67], a[200:203], v[196:199]
    ds_read_b32 a11, v58
    ds_read_b128 a[20:23], v43 offset:16384
    v_mfma_f32_16x16x32_bf16 v[200:203], a[64:67], a[208:211], v[200:203]
    v_perm_b32 v59, v93, v35, s36
    v_perm_b32 v60, v93, v35, s37
    v_mfma_f32_16x16x32_bf16 v[200:203], a[68:71], a[212:215], v[200:203]
    ds_read_b32 a12, v59
    ds_read_b32 a13, v60
    v_mfma_f32_16x16x32_bf16 v[204:207], a[68:71], a[228:231], v[204:207]
    ds_read_b128 a[24:27], v42 offset:18432
    v_perm_b32 v62, v93, v35, s38
    v_mfma_f32_16x16x32_bf16 v[204:207], a[64:67], a[224:227], v[204:207]
    ds_read_b32 a14, v62
    ds_read_b128 a[28:31], v43 offset:18432
    v_mfma_f32_16x16x32_bf16 v[208:211], a[64:67], a[232:235], v[208:211]
    buffer_load_dwordx4 v36, s[8:11], s3 offen offset:0  lds
    v_mfma_f32_16x16x32_bf16 v[208:211], a[68:71], a[236:239], v[208:211]
    ds_read_b128 a[40:43], v42 offset:20480
    v_perm_b32 v61, v93, v35, s39
    v_mfma_f32_16x16x32_bf16 v[212:215], a[68:71], a[244:247], v[212:215]
    ds_read_b32 a15, v61
    v_perm_b32 v63, v90, v35, s36
    v_mfma_f32_16x16x32_bf16 v[212:215], a[64:67], a[240:243], v[212:215]
    ds_read_b32 a48, v63
    ds_read_b128 a[44:47], v43 offset:20480
    v_mfma_f32_16x16x32_bf16 v[216:219], a[64:67], a[248:251], v[216:219]
    v_perm_b32 v56, v90, v35, s37
    v_perm_b32 v57, v90, v35, s38
    v_mfma_f32_16x16x32_bf16 v[216:219], a[68:71], a[252:255], v[216:219]
    ds_read_b32 a49, v56
    ds_read_b32 a50, v57
    v_perm_b32 v58, v90, v35, s39
    v_mfma_f32_16x16x32_bf16 v[220:223], a[68:71], a[36:39], v[220:223]
    s_waitcnt vmcnt(19)
    ds_read_b32 a51, v58
    ds_read_b128 a[56:59], v42 offset:22528
    v_mfma_f32_16x16x32_bf16 v[220:223], a[64:67], a[32:35], v[220:223]
    buffer_load_dwordx4 v37, s[8:11], s3 offen offset:1024  lds
    v_mfma_f32_16x16x32_bf16 v[224:227], a[80:83], a[194:197], v[224:227]
    v_or_b32 v99, s47, v99
    v_lshl_or_b32 v96, v100, 4, v96
    v_lshl_or_b32 v97, v101, 4, v97
    v_lshl_or_b32 v98, v102, 4, v98
    v_lshl_or_b32 v99, v103, 4, v99
    s_waitcnt vmcnt(19)
    v_lshl_or_b32 v96, v104, 8, v96
    v_lshl_or_b32 v97, v105, 8, v97
    v_lshl_or_b32 v98, v106, 8, v98
    s_waitcnt vmcnt(18)
    v_lshl_or_b32 v99, v107, 8, v99
    s_waitcnt vmcnt(17)
    v_lshl_or_b32 v96, v108, 12, v96
    v_lshl_or_b32 v97, v109, 12, v97
    v_lshl_or_b32 v98, v110, 12, v98
    s_waitcnt vmcnt(16)
    v_lshl_or_b32 v99, v111, 12, v99
    s_waitcnt vmcnt(15)
    v_lshl_or_b32 v96, v112, 16, v96
    v_lshl_or_b32 v97, v113, 16, v97
    v_lshl_or_b32 v98, v114, 16, v98
    s_waitcnt vmcnt(14)
L_pad1:
    s_cbranch_execz L_pad2
    v_lshl_or_b32 v96, v116, 20, v96
    v_lshl_or_b32 v97, v117, 20, v97
    v_lshl_or_b32 v98, v118, 20, v98
    s_waitcnt vmcnt(13)
    v_lshl_or_b32 v96, v120, 24, v96
    v_lshl_or_b32 v97, v121, 24, v97
    v_lshl_or_b32 v98, v122, 24, v98
    s_waitcnt vmcnt(12)
    v_lshl_or_b32 v96, v124, 28, v96
    v_lshl_or_b32 v97, v125, 28, v97
    v_lshl_or_b32 v98, v126, 28, v98
    buffer_store_dwordx4 v[96:99], v20, s[12:15], s62 offen sc1
    v_mfma_f32_16x16x32_bf16 v[228:231], a[80:83], a[202:205], v[228:231]
    ds_read_b128 a[60:63], v43 offset:22528
    v_perm_b32 v59, v94, v35, s36
    v_mfma_f32_16x16x32_bf16 v[232:235], a[80:83], a[210:213], v[232:235]
    ds_read_b32 a52, v59
    ds_read_b128 a[72:75], v42 offset:24576
    v_mfma_f32_16x16x32_bf16 v[236:239], a[80:83], a[226:229], v[236:239]
    buffer_load_dwordx4 v38, s[8:11], s3 offen offset:2048  lds
    v_mfma_f32_16x16x32_bf16 v[240:243], a[80:83], a[234:237], v[240:243]
    s_waitcnt vmcnt(12)
    ds_read_b128 a[76:79], v43 offset:24576
    v_perm_b32 v60, v94, v35, s37
    v_mfma_f32_16x16x32_bf16 v[244:247], a[80:83], a[242:245], v[244:247]
    ds_read_b32 a53, v60
    v_bitop3_b32 v62, v51, v55, s76 bitop3:0x7e
    v_perm_b32 v61, v94, v35, s38
    v_mfma_f32_16x16x32_bf16 v[248:251], a[80:83], a[250:253], v[248:251]
    s_waitcnt lgkmcnt(7)
    ds_read_b32 a54, v61
    ds_read_b128 a[96:99], v42 offset:26624
    v_mfma_f32_16x16x32_bf16 v[252:255], a[80:83], a[34:37], v[252:255]
    buffer_load_dwordx4 v39, s[8:11], s3 offen offset:3072  lds
    v_mfma_f32_16x16x32_bf16 v[128:131], a[0:3], a[16:19], v[128:131]
    s_add_u32 m0, s57, 32768
    ds_read_b128 a[100:103], v43 offset:26624
    v_cmp_lt_u32 vcc, 0xffff, v62
    v_mfma_f32_16x16x32_bf16 v[128:131], a[4:7], a[20:23], v[128:131]
    s_add_u32 s3, s69, 768
    v_perm_b32 v63, v94, v35, s39
    v_perm_b32 v56, v91, v35, s36
    v_mfma_f32_16x16x32_bf16 v[132:135], a[4:7], a[28:31], v[132:135]
    ds_read_b128 a[136:139], v42 offset:28672
    ds_read_b32 a55, v63
    v_mfma_f32_16x16x32_bf16 v[132:135], a[0:3], a[24:27], v[132:135]
    buffer_load_dwordx4 v[80:83], v34, s[12:15], s42 offen sc1
    v_mfma_f32_16x16x32_bf16 v[136:139], a[0:3], a[40:43], v[136:139]
    s_waitcnt lgkmcnt(7)
    ds_read_b128 a[140:143], v43 offset:28672
    s_cbranch_vccnz L_slow2_0
L_back2_0:
    v_mfma_f32_16x16x32_bf16 v[136:139], a[4:7], a[44:47], v[136:139]
    ds_read_b128 a[176:179], v42 offset:30720
    ds_read_b32 a84, v56
    v_perm_b32 v57, v91, v35, s37
    v_mfma_f32_16x16x32_bf16 v[140:143], a[4:7], a[60:63], v[140:143]
    ds_read_b32 a85, v57
    v_mfma_f32_16x16x32_bf16 v[140:143], a[0:3], a[56:59], v[140:143]
    buffer_load_dwordx4 v[84:87], v44, s[12:15], s42 offen sc1
    v_mfma_f32_16x16x32_bf16 v[144:147], a[0:3], a[72:75], v[144:147]
    s_waitcnt lgkmcnt(7)
    ds_read_b128 a[180:183], v43 offset:30720
    v_perm_b32 v58, v95, v35, s36
    v_mfma_f32_16x16x32_bf16 v[144:147], a[4:7], a[76:79], v[144:147]
    s_waitcnt lgkmcnt(7)
    ds_read_b32 a86, v58
    v_perm_b32 v59, v95, v35, s37
    v_mfma_f32_16x16x32_bf16 v[148:151], a[4:7], a[100:103], v[148:151]
    s_waitcnt lgkmcnt(7)
    ds_read_b32 a87, v59
    v_perm_b32 v60, v48, v35, s36
    v_mfma_f32_16x16x32_bf16 v[148:151], a[0:3], a[96:99], v[148:151]
    ds_read_b32 a104, v60
    v_perm_b32 v61, v48, v35, s37
    v_perm_b32 v62, v48, v35, s38
    v_mfma_f32_16x16x32_bf16 v[152:155], a[0:3], a[136:139], v[152:155]
    s_waitcnt lgkmcnt(7)
    ds_read_b32 a105, v61
    ds_read_b32 a106, v62
    v_mfma_f32_16x16x32_bf16 v[152:155], a[4:7], a[140:143], v[152:155]
    s_waitcnt lgkmcnt(5)
    buffer_load_dwordx4 v36, s[8:11], s56 offen offset:0  lds
    v_mfma_f32_16x16x32_bf16 v[156:159], a[4:7], a[180:183], v[156:159]
    v_perm_b32 v63, v48, v35, s39
    v_perm_b32 v56, v52, v35, s36
    v_mfma_f32_16x16x32_bf16 v[156:159], a[0:3], a[176:179], v[156:159]
    ds_read_b32 a107, v63
    ds_read_b32 a108, v56
    v_mfma_f32_16x16x32_bf16 v[160:163], a[8:11], a[16:19], v[160:163]
    v_perm_b32 v57, v52, v35, s37
    v_perm_b32 v58, v52, v35, s38
    v_mfma_f32_16x16x32_bf16 v[160:163], a[12:15], a[20:23], v[160:163]
    ds_read_b32 a109, v57
    ds_read_b32 a110, v58
    v_mfma_f32_16x16x32_bf16 v[164:167], a[12:15], a[28:31], v[164:167]
    v_perm_b32 v59, v52, v35, s39
    v_perm_b32 v60, v49, v35, s36
    v_mfma_f32_16x16x32_bf16 v[164:167], a[8:11], a[24:27], v[164:167]
    ds_read_b32 a111, v59
    ds_read_b32 a112, v60
    v_perm_b32 v61, v49, v35, s37
    v_mfma_f32_16x16x32_bf16 v[168:171], a[8:11], a[40:43], v[168:171]
    ds_read_b32 a113, v61
    v_mfma_f32_16x16x32_bf16 v[168:171], a[12:15], a[44:47], v[168:171]
    buffer_load_dwordx4 v37, s[8:11], s56 offen offset:1024  lds
    v_mfma_f32_16x16x32_bf16 v[172:175], a[12:15], a[60:63], v[172:175]
    v_perm_b32 v62, v49, v35, s38
    v_perm_b32 v63, v49, v35, s39
    v_mfma_f32_16x16x32_bf16 v[172:175], a[8:11], a[56:59], v[172:175]
    ds_read_b32 a114, v62
    ds_read_b32 a115, v63
    v_mfma_f32_16x16x32_bf16 v[176:179], a[8:11], a[72:75], v[176:179]
    v_perm_b32 v56, v53, v35, s36
    v_perm_b32 v57, v53, v35, s37
    v_mfma_f32_16x16x32_bf16 v[176:179], a[12:15], a[76:79], v[176:179]
    ds_read_b32 a116, v56
    ds_read_b32 a117, v57
    v_mfma_f32_16x16x32_bf16 v[180:183], a[12:15], a[100:103], v[180:183]
    s_waitcnt vmcnt(13)
    v_perm_b32 v58, v53, v35, s38
    v_perm_b32 v59, v53, v35, s39
    v_mfma_f32_16x16x32_bf16 v[180:183], a[8:11], a[96:99], v[180:183]
    s_barrier
    v_mfma_f32_16x16x32_bf16 v[184:187], a[8:11], a[136:139], v[184:187]
    buffer_load_dwordx4 v38, s[8:11], s56 offen offset:2048  lds
    v_mfma_f32_16x16x32_bf16 v[184:187], a[12:15], a[140:143], v[184:187]
    ds_read_b128 a[120:123], v40 offset:0
    ds_read_b32 a118, v58
    v_mfma_f32_16x16x32_bf16 v[188:191], a[12:15], a[180:183], v[188:191]
    ds_read_b128 a[124:127], v41 offset:0
    ds_read_b32 a119, v59
    v_mfma_f32_16x16x32_bf16 v[188:191], a[8:11], a[176:179], v[188:191]
    ds_read_b128 a[132:135], v41 offset:2048
    v_perm_b32 v60, v50, v35, s36
    v_mfma_f32_16x16x32_bf16 v[192:195], a[48:51], a[16:19], v[192:195]
    ds_read_b128 a[128:131], v40 offset:2048
    ds_read_b32 a144, v60
    v_mfma_f32_16x16x32_bf16 v[192:195], a[52:55], a[20:23], v[192:195]
    ds_read_b128 a[152:155], v40 offset:4096
    v_perm_b32 v61, v50, v35, s37
    v_mfma_f32_16x16x32_bf16 v[196:199], a[52:55], a[28:31], v[196:199]
    s_waitcnt vmcnt(12)
    ds_read_b128 a[156:159], v41 offset:4096
    ds_read_b32 a145, v61
    v_mfma_f32_16x16x32_bf16 v[196:199], a[48:51], a[24:27], v[196:199]
    buffer_load_dwordx4 v39, s[8:11], s56 offen offset:3072  lds
    v_mfma_f32_16x16x32_bf16 v[200:203], a[48:51], a[40:43], v[200:203]
    s_add_u32 m0, s57, 49152
    ds_read_b128 a[164:167], v41 offset:6144
    v_bitop3_b32 v62, v67, v71, s76 bitop3:0x7e
    v_mfma_f32_16x16x32_bf16 v[200:203], a[52:55], a[44:47], v[200:203]
    s_add_u32 s56, s55, 1024
    ds_read_b128 a[160:163], v40 offset:6144
    v_cmp_lt_u32 vcc, 0xffff, v62
    v_mfma_f32_16x16x32_bf16 v[204:207], a[52:55], a[60:63], v[204:207]
    ds_read_b128 a[88:91], v40 offset:8192
    v_perm_b32 v63, v50, v35, s38
    v_mfma_f32_16x16x32_bf16 v[204:207], a[48:51], a[56:59], v[204:207]
    ds_read_b32 a146, v63
    s_cbranch_vccnz L_slow2_1
L_back2_1:
    v_mfma_f32_16x16x32_bf16 v[208:211], a[48:51], a[72:75], v[208:211]
    v_perm_b32 v56, v50, v35, s39
    v_perm_b32 v57, v54, v35, s36
    v_mfma_f32_16x16x32_bf16 v[208:211], a[52:55], a[76:79], v[208:211]
    ds_read_b128 a[92:95], v41 offset:8192
    ds_read_b32 a147, v56
    v_mfma_f32_16x16x32_bf16 v[212:215], a[52:55], a[100:103], v[212:215]
    ds_read_b32 a148, v57
    ds_read_b128 a[168:171], v40 offset:10240
    v_mfma_f32_16x16x32_bf16 v[212:215], a[48:51], a[96:99], v[212:215]
    buffer_load_dwordx4 v36, s[8:11], s3 offen offset:0  lds
    v_mfma_f32_16x16x32_bf16 v[216:219], a[48:51], a[136:139], v[216:219]
    v_perm_b32 v58, v54, v35, s37
    v_perm_b32 v59, v54, v35, s38
    v_mfma_f32_16x16x32_bf16 v[216:219], a[52:55], a[140:143], v[216:219]
    ds_read_b32 a149, v58
    ds_read_b32 a150, v59
    v_mfma_f32_16x16x32_bf16 v[220:223], a[52:55], a[180:183], v[220:223]
    v_perm_b32 v60, v54, v35, s39
    v_perm_b32 v61, v51, v35, s36
    v_mfma_f32_16x16x32_bf16 v[220:223], a[48:51], a[176:179], v[220:223]
    s_waitcnt lgkmcnt(7)
    ds_read_b128 a[172:175], v41 offset:10240
    ds_read_b32 a151, v60
    v_mfma_f32_16x16x32_bf16 v[224:227], a[84:87], a[18:21], v[224:227]
    ds_read_b32 a184, v61
    v_perm_b32 v62, v51, v35, s37
    v_mfma_f32_16x16x32_bf16 v[228:231], a[84:87], a[26:29], v[228:231]
    ds_read_b32 a185, v62
    ds_read_b128 a[216:219], v40 offset:12288
    v_mfma_f32_16x16x32_bf16 v[232:235], a[84:87], a[42:45], v[232:235]
    buffer_load_dwordx4 v37, s[8:11], s3 offen offset:1024  lds
    v_mfma_f32_16x16x32_bf16 v[236:239], a[84:87], a[58:61], v[236:239]
    v_perm_b32 v63, v55, v35, s36
    v_perm_b32 v56, v55, v35, s37
    v_mfma_f32_16x16x32_bf16 v[240:243], a[84:87], a[74:77], v[240:243]
    ds_read_b32 a186, v63
    ds_read_b32 a187, v56
    v_mfma_f32_16x16x32_bf16 v[244:247], a[84:87], a[98:101], v[244:247]
    ds_read_b128 a[220:223], v41 offset:12288
    v_perm_b32 v57, v64, v35, s36
    v_mfma_f32_16x16x32_bf16 v[248:251], a[84:87], a[138:141], v[248:251]
    ds_read_b32 a64, v57
    v_perm_b32 v58, v64, v35, s37
    v_mfma_f32_16x16x32_bf16 v[252:255], a[84:87], a[178:181], v[252:255]
    ds_read_b32 a65, v58
    v_perm_b32 v59, v64, v35, s38
    v_mfma_f32_16x16x32_bf16 v[128:131], a[104:107], a[120:123], v[128:131]
    ds_read_b128 a[192:195], v40 offset:14336
    ds_read_b32 a66, v59
    v_mfma_f32_16x16x32_bf16 v[128:131], a[108:111], a[124:127], v[128:131]
    buffer_load_dwordx4 v38, s[8:11], s3 offen offset:2048  lds
    v_mfma_f32_16x16x32_bf16 v[132:135], a[108:111], a[132:135], v[132:135]
    s_waitcnt vmcnt(14)
    ds_read_b128 a[196:199], v41 offset:14336
    v_bitop3_b32 v60, v75, v79, s76 bitop3:0x7e
    v_mfma_f32_16x16x32_bf16 v[132:135], a[104:107], a[128:131], v[132:135]
    v_cmp_lt_u32 vcc, 0xffff, v60
    v_perm_b32 v61, v64, v35, s39
    v_mfma_f32_16x16x32_bf16 v[136:139], a[104:107], a[152:155], v[136:139]
    ds_read_b32 a67, v61
    v_perm_b32 v62, v68, v35, s36
    v_mfma_f32_16x16x32_bf16 v[136:139], a[108:111], a[156:159], v[136:139]
    ds_read_b32 a68, v62
    s_cbranch_vccnz L_slow3_0
L_back3_0:
    v_mfma_f32_16x16x32_bf16 v[140:143], a[108:111], a[164:167], v[140:143]
    v_perm_b32 v63, v68, v35, s37
    v_perm_b32 v56, v68, v35, s38
    v_mfma_f32_16x16x32_bf16 v[140:143], a[104:107], a[160:163], v[140:143]
    ds_read_b32 a69, v63
    ds_read_b32 a70, v56
    v_perm_b32 v57, v68, v35, s39
    v_mfma_f32_16x16x32_bf16 v[144:147], a[104:107], a[88:91], v[144:147]
    s_waitcnt lgkmcnt(7)
    ds_read_b32 a71, v57
    v_mfma_f32_16x16x32_bf16 v[144:147], a[108:111], a[92:95], v[144:147]
    buffer_load_dwordx4 v39, s[8:11], s3 offen offset:3072  lds
    v_mfma_f32_16x16x32_bf16 v[148:151], a[108:111], a[172:175], v[148:151]
    s_add_u32 m0, s57, 65536
    v_perm_b32 v58, v65, v35, s36
    v_perm_b32 v59, v65, v35, s37
    v_mfma_f32_16x16x32_bf16 v[148:151], a[104:107], a[168:171], v[148:151]
    s_add_u32 s3, s69, 1024
    ds_read_b32 a200, v58
    ds_read_b32 a201, v59
    v_mfma_f32_16x16x32_bf16 v[152:155], a[104:107], a[216:219], v[152:155]
    v_perm_b32 v60, v65, v35, s38
    v_perm_b32 v61, v65, v35, s39
    v_mfma_f32_16x16x32_bf16 v[152:155], a[108:111], a[220:223], v[152:155]
    s_waitcnt lgkmcnt(6)
    ds_read_b32 a202, v60
    ds_read_b32 a203, v61
    v_mfma_f32_16x16x32_bf16 v[156:159], a[108:111], a[196:199], v[156:159]
    v_perm_b32 v62, v69, v35, s36
    v_perm_b32 v63, v69, v35, s37
    v_mfma_f32_16x16x32_bf16 v[156:159], a[104:107], a[192:195], v[156:159]
    ds_read_b32 a204, v62
    ds_read_b32 a205, v63
    v_mfma_f32_16x16x32_bf16 v[160:163], a[112:115], a[120:123], v[160:163]
    buffer_load_dwordx4 v36, s[8:11], s56 offen offset:0  lds
    v_mfma_f32_16x16x32_bf16 v[160:163], a[116:119], a[124:127], v[160:163]
    v_perm_b32 v56, v69, v35, s38
    v_perm_b32 v57, v69, v35, s39
    v_mfma_f32_16x16x32_bf16 v[164:167], a[116:119], a[132:135], v[164:167]
    ds_read_b32 a206, v56
    ds_read_b32 a207, v57
    v_mfma_f32_16x16x32_bf16 v[164:167], a[112:115], a[128:131], v[164:167]
    v_perm_b32 v58, v66, v35, s36
    v_perm_b32 v59, v66, v35, s37
    v_mfma_f32_16x16x32_bf16 v[168:171], a[112:115], a[152:155], v[168:171]
    ds_read_b32 a208, v58
    ds_read_b32 a209, v59
    v_mfma_f32_16x16x32_bf16 v[168:171], a[116:119], a[156:159], v[168:171]
    buffer_load_dwordx4 v[96:99], v32, s[12:15], s43 offen sc1
    v_mfma_f32_16x16x32_bf16 v[172:175], a[116:119], a[164:167], v[172:175]
    v_perm_b32 v60, v66, v35, s38
    v_perm_b32 v61, v66, v35, s39
    v_mfma_f32_16x16x32_bf16 v[172:175], a[112:115], a[160:163], v[172:175]
    ds_read_b32 a210, v60
    ds_read_b32 a211, v61
    v_mfma_f32_16x16x32_bf16 v[176:179], a[112:115], a[88:91], v[176:179]
    v_perm_b32 v62, v70, v35, s36
    v_perm_b32 v63, v70, v35, s37
    v_mfma_f32_16x16x32_bf16 v[176:179], a[116:119], a[92:95], v[176:179]
    ds_read_b32 a212, v62
    ds_read_b32 a213, v63
    v_mfma_f32_16x16x32_bf16 v[180:183], a[116:119], a[172:175], v[180:183]
    buffer_load_dwordx4 v[100:103], v33, s[12:15], s43 offen sc1
    v_mfma_f32_16x16x32_bf16 v[180:183], a[112:115], a[168:171], v[180:183]
    v_perm_b32 v56, v70, v35, s38
    v_perm_b32 v57, v70, v35, s39
    v_mfma_f32_16x16x32_bf16 v[184:187], a[112:115], a[216:219], v[184:187]
    ds_read_b32 a214, v56
    ds_read_b32 a215, v57
    v_mfma_f32_16x16x32_bf16 v[184:187], a[116:119], a[220:223], v[184:187]
    v_perm_b32 v58, v67, v35, s36
    v_perm_b32 v59, v67, v35, s37
    v_mfma_f32_16x16x32_bf16 v[188:191], a[116:119], a[196:199], v[188:191]
    ds_read_b32 a188, v58
    ds_read_b32 a189, v59
    v_mfma_f32_16x16x32_bf16 v[188:191], a[112:115], a[192:195], v[188:191]
    s_waitcnt vmcnt(13)
    v_perm_b32 v60, v71, v35, s36
    v_perm_b32 v61, v71, v35, s37
    v_mfma_f32_16x16x32_bf16 v[192:195], a[144:147], a[120:123], v[192:195]
    s_barrier
    v_mfma_f32_16x16x32_bf16 v[192:195], a[148:151], a[124:127], v[192:195]
    buffer_load_dwordx4 v37, s[8:11], s56 offen offset:1024  lds
    v_mfma_f32_16x16x32_bf16 v[196:199], a[148:151], a[132:135], v[196:199]
    ds_read_b32 a190, v60
    ds_read_b32 a191, v61
    v_mfma_f32_16x16x32_bf16 v[196:199], a[144:147], a[128:131], v[196:199]
    ds_read_b128 a[224:227], v40 offset:16384
    v_perm_b32 v62, v72, v35, s36
    v_mfma_f32_16x16x32_bf16 v[200:203], a[144:147], a[152:155], v[200:203]
    ds_read_b32 a232, v62
    v_perm_b32 v63, v72, v35, s37
    v_mfma_f32_16x16x32_bf16 v[200:203], a[148:151], a[156:159], v[200:203]
    ds_read_b32 a233, v63
    ds_read_b128 a[228:231], v41 offset:16384
    v_mfma_f32_16x16x32_bf16 v[204:207], a[148:151], a[164:167], v[204:207]
    ds_read_b128 a[240:243], v40 offset:18432
    v_perm_b32 v56, v72, v35, s38
    v_mfma_f32_16x16x32_bf16 v[204:207], a[144:147], a[160:163], v[204:207]
    ds_read_b32 a234, v56
    ds_read_b128 a[244:247], v41 offset:18432
    v_mfma_f32_16x16x32_bf16 v[208:211], a[144:147], a[88:91], v[208:211]
    buffer_load_dwordx4 v38, s[8:11], s56 offen offset:2048  lds
    v_mfma_f32_16x16x32_bf16 v[208:211], a[148:151], a[92:95], v[208:211]
    s_waitcnt vmcnt(13)
    v_perm_b32 v58, v72, v35, s39
    v_bitop3_b32 v57, v83, v87, s76 bitop3:0x7e
    v_mfma_f32_16x16x32_bf16 v[212:215], a[148:151], a[172:175], v[212:215]
    ds_read_b32 a235, v58
    v_cmp_lt_u32 vcc, 0xffff, v57
    v_mfma_f32_16x16x32_bf16 v[212:215], a[144:147], a[168:171], v[212:215]
    v_perm_b32 v59, v76, v35, s36
    v_perm_b32 v60, v76, v35, s37
    v_mfma_f32_16x16x32_bf16 v[216:219], a[144:147], a[216:219], v[216:219]
    ds_read_b32 a236, v59
    ds_read_b32 a237, v60
    v_mfma_f32_16x16x32_bf16 v[216:219], a[148:151], a[220:223], v[216:219]
    ds_read_b128 a[248:251], v40 offset:20480
    s_cbranch_vccnz L_slow3_1
L_back3_1:
    v_mfma_f32_16x16x32_bf16 v[220:223], a[148:151], a[196:199], v[220:223]
    ds_read_b128 a[252:255], v41 offset:20480
    v_perm_b32 v61, v76, v35, s38
    v_mfma_f32_16x16x32_bf16 v[220:223], a[144:147], a[192:195], v[220:223]
    ds_read_b32 a238, v61
    ds_read_b128 a[32:35], v40 offset:22528
    v_mfma_f32_16x16x32_bf16 v[224:227], a[184:187], a[122:125], v[224:227]
    buffer_load_dwordx4 v39, s[8:11], s56 offen offset:3072  lds
    v_mfma_f32_16x16x32_bf16 v[228:231], a[184:187], a[130:133], v[228:231]
    s_add_u32 m0, s57, 81920
    v_perm_b32 v62, v76, v35, s39
    v_perm_b32 v63, v73, v35, s36
    v_mfma_f32_16x16x32_bf16 v[232:235], a[184:187], a[154:157], v[232:235]
    ds_read_b128 a[36:39], v41 offset:22528
    ds_read_b32 a239, v62
    v_mfma_f32_16x16x32_bf16 v[236:239], a[184:187], a[162:165], v[236:239]
    ds_read_b32 a0, v63
    v_perm_b32 v56, v73, v35, s37
    v_mfma_f32_16x16x32_bf16 v[240:243], a[184:187], a[90:93], v[240:243]
    ds_read_b128 a[8:11], v40 offset:24576
    ds_read_b32 a1, v56
    v_mfma_f32_16x16x32_bf16 v[244:247], a[184:187], a[170:173], v[244:247]
    ds_read_b128 a[12:15], v41 offset:24576
    v_perm_b32 v57, v73, v35, s38
    v_mfma_f32_16x16x32_bf16 v[248:251], a[184:187], a[218:221], v[248:251]
    s_waitcnt lgkmcnt(9)
    ds_read_b32 a2, v57
    ds_read_b128 a[48:51], v40 offset:26624
    v_mfma_f32_16x16x32_bf16 v[252:255], a[184:187], a[194:197], v[252:255]
    buffer_load_dwordx4 v36, s[8:11], s3 offen offset:0  lds
    v_mfma_f32_16x16x32_bf16 v[128:131], a[64:67], a[224:227], v[128:131]
    ds_read_b128 a[52:55], v41 offset:26624
    v_perm_b32 v58, v73, v35, s39
    v_mfma_f32_16x16x32_bf16 v[128:131], a[68:71], a[228:231], v[128:131]
    ds_read_b128 a[16:19], v40 offset:28672
    ds_read_b32 a3, v58
    v_mfma_f32_16x16x32_bf16 v[132:135], a[68:71], a[244:247], v[132:135]
    s_add_u32 s56, s55, 1280
    v_perm_b32 v59, v77, v35, s36
    v_perm_b32 v60, v77, v35, s37
    v_mfma_f32_16x16x32_bf16 v[132:135], a[64:67], a[240:243], v[132:135]
    ds_read_b128 a[20:23], v41 offset:28672
    ds_read_b32 a4, v59
    v_mfma_f32_16x16x32_bf16 v[136:139], a[64:67], a[248:251], v[136:139]
    s_waitcnt lgkmcnt(10)
    ds_read_b32 a5, v60
    v_perm_b32 v61, v77, v35, s38
    v_mfma_f32_16x16x32_bf16 v[136:139], a[68:71], a[252:255], v[136:139]
    ds_read_b128 a[24:27], v40 offset:30720
    ds_read_b32 a6, v61
    v_mfma_f32_16x16x32_bf16 v[140:143], a[68:71], a[36:39], v[140:143]
    buffer_load_dwordx4 v37, s[8:11], s3 offen offset:1024  lds
    v_mfma_f32_16x16x32_bf16 v[140:143], a[64:67], a[32:35], v[140:143]
    s_waitcnt lgkmcnt(8)
    ds_read_b128 a[28:31], v41 offset:30720
    v_perm_b32 v62, v77, v35, s39
    v_mfma_f32_16x16x32_bf16 v[144:147], a[64:67], a[8:11], v[144:147]
    ds_read_b32 a7, v62
    v_perm_b32 v63, v74, v35, s36
    v_mfma_f32_16x16x32_bf16 v[144:147], a[68:71], a[12:15], v[144:147]
    s_waitcnt lgkmcnt(9)
    ds_read_b32 a40, v63
    v_perm_b32 v56, v74, v35, s37
    v_mfma_f32_16x16x32_bf16 v[148:151], a[68:71], a[52:55], v[148:151]
    ds_read_b32 a41, v56
    v_perm_b32 v57, v74, v35, s38
    v_mfma_f32_16x16x32_bf16 v[148:151], a[64:67], a[48:51], v[148:151]
    s_waitcnt lgkmcnt(8)
    ds_read_b32 a42, v57
    v_perm_b32 v58, v74, v35, s39
    v_mfma_f32_16x16x32_bf16 v[152:155], a[64:67], a[16:19], v[152:155]
    ds_read_b32 a43, v58
    v_perm_b32 v59, v78, v35, s36
    v_perm_b32 v60, v78, v35, s37
    v_mfma_f32_16x16x32_bf16 v[152:155], a[68:71], a[20:23], v[152:155]
    s_waitcnt lgkmcnt(5)
    ds_read_b32 a44, v59
    ds_read_b32 a45, v60
    v_mfma_f32_16x16x32_bf16 v[156:159], a[68:71], a[28:31], v[156:159]
    buffer_load_dwordx4 v38, s[8:11], s3 offen offset:2048  lds
    v_mfma_f32_16x16x32_bf16 v[156:159], a[64:67], a[24:27], v[156:159]
    v_perm_b32 v61, v78, v35, s38
    v_perm_b32 v62, v78, v35, s39
    v_mfma_f32_16x16x32_bf16 v[160:163], a[200:203], a[224:227], v[160:163]
    ds_read_b32 a46, v61
    ds_read_b32 a47, v62
    v_mfma_f32_16x16x32_bf16 v[160:163], a[204:207], a[228:231], v[160:163]
    v_perm_b32 v63, v75, v35, s36
    v_perm_b32 v56, v75, v35, s37
    v_mfma_f32_16x16x32_bf16 v[164:167], a[204:207], a[244:247], v[164:167]
    ds_read_b32 a56, v63
    ds_read_b32 a57, v56
    v_perm_b32 v57, v79, v35, s36
    v_mfma_f32_16x16x32_bf16 v[164:167], a[200:203], a[240:243], v[164:167]
    ds_read_b32 a58, v57
    v_mfma_f32_16x16x32_bf16 v[168:171], a[200:203], a[248:251], v[168:171]
    buffer_load_dwordx4 v[104:107], v34, s[12:15], s43 offen sc1
    v_mfma_f32_16x16x32_bf16 v[168:171], a[204:207], a[252:255], v[168:171]
    v_perm_b32 v58, v79, v35, s37
    v_perm_b32 v59, v83, v35, s36
    v_mfma_f32_16x16x32_bf16 v[172:175], a[204:207], a[36:39], v[172:175]
    ds_read_b32 a59, v58
    ds_read_b32 a60, v59
    v_perm_b32 v60, v83, v35, s37
    v_mfma_f32_16x16x32_bf16 v[172:175], a[200:203], a[32:35], v[172:175]
    ds_read_b32 a61, v60
    v_mfma_f32_16x16x32_bf16 v[176:179], a[200:203], a[8:11], v[176:179]
    buffer_load_dwordx4 v[108:111], v44, s[12:15], s43 offen sc1
    v_mfma_f32_16x16x32_bf16 v[176:179], a[204:207], a[12:15], v[176:179]
    v_perm_b32 v61, v87, v35, s36
    v_perm_b32 v62, v87, v35, s37
    v_mfma_f32_16x16x32_bf16 v[180:183], a[204:207], a[52:55], v[180:183]
    ds_read_b32 a62, v61
    ds_read_b32 a63, v62
    v_mfma_f32_16x16x32_bf16 v[180:183], a[200:203], a[48:51], v[180:183]
    v_perm_b32 v63, v80, v35, s36
    v_perm_b32 v56, v80, v35, s37
    v_mfma_f32_16x16x32_bf16 v[184:187], a[200:203], a[16:19], v[184:187]
    ds_read_b32 a72, v63
    ds_read_b32 a73, v56
    v_mfma_f32_16x16x32_bf16 v[184:187], a[204:207], a[20:23], v[184:187]
    v_perm_b32 v57, v80, v35, s38
    v_perm_b32 v58, v80, v35, s39
    v_mfma_f32_16x16x32_bf16 v[188:191], a[204:207], a[28:31], v[188:191]
    s_waitcnt vmcnt(11)
    ds_read_b32 a74, v57
    ds_read_b32 a75, v58
    v_mfma_f32_16x16x32_bf16 v[188:191], a[200:203], a[24:27], v[188:191]
    buffer_load_dwordx4 v39, s[8:11], s3 offen offset:3072  lds
    v_mfma_f32_16x16x32_bf16 v[192:195], a[208:211], a[224:227], v[192:195]
    s_barrier
    v_mfma_f32_16x16x32_bf16 v[192:195], a[212:215], a[228:231], v[192:195]
    s_add_u32 m0, s57, 0
    ds_read_b128 a[96:99], v40 offset:32768
    v_perm_b32 v59, v84, v35, s36
    v_mfma_f32_16x16x32_bf16 v[196:199], a[212:215], a[244:247], v[196:199]
    s_add_u32 s3, s69, 1280
    ds_read_b128 a[100:103], v41 offset:32768
    ds_read_b32 a76, v59
    v_mfma_f32_16x16x32_bf16 v[196:199], a[208:211], a[240:243], v[196:199]
    ds_read_b128 a[140:143], v41 offset:34816
    v_perm_b32 v60, v84, v35, s37
    v_mfma_f32_16x16x32_bf16 v[200:203], a[208:211], a[248:251], v[200:203]
    ds_read_b128 a[136:139], v40 offset:34816
    ds_read_b32 a77, v60
    v_mfma_f32_16x16x32_bf16 v[200:203], a[212:215], a[252:255], v[200:203]
    buffer_load_dwordx4 v[112:115], v32, s[12:15], s44 offen sc1
    v_mfma_f32_16x16x32_bf16 v[204:207], a[212:215], a[36:39], v[204:207]
    ds_read_b128 a[80:83], v40 offset:36864
    v_perm_b32 v61, v84, v35, s38
    v_mfma_f32_16x16x32_bf16 v[204:207], a[208:211], a[32:35], v[204:207]
    ds_read_b128 a[84:87], v41 offset:36864
    ds_read_b32 a78, v61
    v_mfma_f32_16x16x32_bf16 v[208:211], a[208:211], a[8:11], v[208:211]
    ds_read_b128 a[180:183], v41 offset:38912
    v_perm_b32 v62, v84, v35, s39
    v_mfma_f32_16x16x32_bf16 v[208:211], a[212:215], a[12:15], v[208:211]
    ds_read_b128 a[176:179], v40 offset:38912
    ds_read_b32 a79, v62
    v_mfma_f32_16x16x32_bf16 v[212:215], a[212:215], a[52:55], v[212:215]
    buffer_load_dwordx4 v[116:119], v33, s[12:15], s44 offen sc1
    v_mfma_f32_16x16x32_bf16 v[212:215], a[208:211], a[48:51], v[212:215]
    ds_read_b128 a[104:107], v40 offset:40960
    v_perm_b32 v63, v81, v35, s36
    v_mfma_f32_16x16x32_bf16 v[216:219], a[208:211], a[16:19], v[216:219]
    ds_read_b128 a[108:111], v41 offset:40960
    ds_read_b32 a112, v63
    v_mfma_f32_16x16x32_bf16 v[216:219], a[212:215], a[20:23], v[216:219]
    ds_read_b128 a[144:147], v40 offset:43008
    v_perm_b32 v56, v81, v35, s37
    v_mfma_f32_16x16x32_bf16 v[220:223], a[212:215], a[28:31], v[220:223]
    ds_read_b32 a113, v56
    v_perm_b32 v57, v81, v35, s38
    v_mfma_f32_16x16x32_bf16 v[220:223], a[208:211], a[24:27], v[220:223]
    ds_read_b128 a[148:151], v41 offset:43008
    ds_read_b32 a114, v57
    v_mfma_f32_16x16x32_bf16 v[224:227], a[188:191], a[226:229], v[224:227]
    buffer_load_dwordx4 v36, s[8:11], s56 offen offset:0  lds
    v_mfma_f32_16x16x32_bf16 v[228:231], a[188:191], a[242:245], v[228:231]
    s_waitcnt vmcnt(12)
    v_bitop3_b32 v58, v99, v103, s76 bitop3:0x7e
    v_perm_b32 v59, v81, v35, s39
    v_mfma_f32_16x16x32_bf16 v[232:235], a[188:191], a[250:253], v[232:235]
    ds_read_b128 a[120:123], v40 offset:45056
    ds_read_b32 a115, v59
    v_cmp_lt_u32 vcc, 0xffff, v58
    v_mfma_f32_16x16x32_bf16 v[236:239], a[188:191], a[34:37], v[236:239]
    v_perm_b32 v60, v85, v35, s36
    v_perm_b32 v61, v85, v35, s37
L_pad2:
    s_cbranch_execz L_pad3
    v_mfma_f32_16x16x32_bf16 v[240:243], a[188:191], a[10:13], v[240:243]
    ds_read_b32 a116, v60
    ds_read_b32 a117, v61
    v_mfma_f32_16x16x32_bf16 v[244:247], a[188:191], a[50:53], v[244:247]
    ds_read_b128 a[124:127], v41 offset:45056
    s_cbranch_vccnz L_slow4_0
L_back4_0:
    v_mfma_f32_16x16x32_bf16 v[248:251], a[188:191], a[18:21], v[248:251]
    s_waitcnt lgkmcnt(8)
    ds_read_b128 a[128:131], v40 offset:47104
    v_mfma_f32_16x16x32_bf16 v[252:255], a[188:191], a[26:29], v[252:255]
    buffer_load_dwordx4 v[120:123], v34, s[12:15], s44 offen sc1
    v_mfma_f32_16x16x32_bf16 v[128:131], a[232:235], a[96:99], v[128:131]
    v_perm_b32 v62, v85, v35, s38
    v_perm_b32 v63, v85, v35, s39
    v_mfma_f32_16x16x32_bf16 v[128:131], a[236:239], a[100:103], v[128:131]
    ds_read_b32 a118, v62
    ds_read_b32 a119, v63
    v_mfma_f32_16x16x32_bf16 v[132:135], a[236:239], a[140:143], v[132:135]
    ds_read_b128 a[132:135], v41 offset:47104
    v_mfma_f32_16x16x32_bf16 v[132:135], a[232:235], a[136:139], v[132:135]
    buffer_load_dwordx4 v[124:127], v44, s[12:15], s44 offen sc1
    v_mfma_f32_16x16x32_bf16 v[136:139], a[232:235], a[80:83], v[136:139]
    v_perm_b32 v56, v82, v35, s36
    v_perm_b32 v57, v82, v35, s37
    v_mfma_f32_16x16x32_bf16 v[136:139], a[236:239], a[84:87], v[136:139]
    ds_read_b32 a152, v56
    ds_read_b32 a153, v57
    v_mfma_f32_16x16x32_bf16 v[140:143], a[236:239], a[180:183], v[140:143]
    v_perm_b32 v58, v82, v35, s38
    v_perm_b32 v59, v82, v35, s39
    v_mfma_f32_16x16x32_bf16 v[140:143], a[232:235], a[176:179], v[140:143]
    ds_read_b32 a154, v58
    ds_read_b32 a155, v59
    v_mfma_f32_16x16x32_bf16 v[144:147], a[232:235], a[104:107], v[144:147]
    s_waitcnt lgkmcnt(7)
    ds_read_b128 a[160:163], v40 offset:49152
    v_mfma_f32_16x16x32_bf16 v[144:147], a[236:239], a[108:111], v[144:147]
    buffer_load_dwordx4 v37, s[8:11], s56 offen offset:1024  lds
    v_mfma_f32_16x16x32_bf16 v[148:151], a[236:239], a[148:151], v[148:151]
    v_perm_b32 v60, v86, v35, s36
    v_perm_b32 v61, v86, v35, s37
    v_mfma_f32_16x16x32_bf16 v[148:151], a[232:235], a[144:147], v[148:151]
    ds_read_b32 a156, v60
    ds_read_b32 a157, v61
    v_mfma_f32_16x16x32_bf16 v[152:155], a[232:235], a[120:123], v[152:155]
    ds_read_b128 a[164:167], v41 offset:49152
    v_perm_b32 v62, v86, v35, s38
    v_mfma_f32_16x16x32_bf16 v[152:155], a[236:239], a[124:127], v[152:155]
    s_waitcnt lgkmcnt(8)
    ds_read_b128 a[88:91], v40 offset:51200
    ds_read_b32 a158, v62
    v_mfma_f32_16x16x32_bf16 v[156:159], a[236:239], a[132:135], v[156:159]
    v_perm_b32 v63, v86, v35, s39
    v_perm_b32 v56, v96, v35, s36
    v_mfma_f32_16x16x32_bf16 v[156:159], a[232:235], a[128:131], v[156:159]
    ds_read_b128 a[92:95], v41 offset:51200
    ds_read_b32 a159, v63
    v_mfma_f32_16x16x32_bf16 v[160:163], a[0:3], a[96:99], v[160:163]
    buffer_load_dwordx4 v38, s[8:11], s56 offen offset:2048  lds
    v_mfma_f32_16x16x32_bf16 v[160:163], a[4:7], a[100:103], v[160:163]
    ds_read_b32 a168, v56
    v_perm_b32 v57, v96, v35, s37
    v_mfma_f32_16x16x32_bf16 v[164:167], a[4:7], a[140:143], v[164:167]
    ds_read_b128 a[216:219], v40 offset:53248
    ds_read_b32 a169, v57
    v_mfma_f32_16x16x32_bf16 v[164:167], a[0:3], a[136:139], v[164:167]
    v_perm_b32 v58, v96, v35, s38
    v_perm_b32 v59, v96, v35, s39
    v_mfma_f32_16x16x32_bf16 v[168:171], a[0:3], a[80:83], v[168:171]
    ds_read_b32 a170, v58
    ds_read_b32 a171, v59
    v_mfma_f32_16x16x32_bf16 v[168:171], a[4:7], a[84:87], v[168:171]
    ds_read_b128 a[220:223], v41 offset:53248
    v_perm_b32 v60, v100, v35, s36
    v_mfma_f32_16x16x32_bf16 v[172:175], a[4:7], a[180:183], v[172:175]
    ds_read_b32 a172, v60
    ds_read_b128 a[192:195], v40 offset:55296
    v_mfma_f32_16x16x32_bf16 v[172:175], a[0:3], a[176:179], v[172:175]
    buffer_load_dwordx4 v39, s[8:11], s56 offen offset:3072  lds
    v_mfma_f32_16x16x32_bf16 v[176:179], a[0:3], a[104:107], v[176:179]
    s_add_u32 m0, s57, 16384
    v_perm_b32 v61, v100, v35, s37
    v_perm_b32 v62, v100, v35, s38
    v_mfma_f32_16x16x32_bf16 v[176:179], a[4:7], a[108:111], v[176:179]
    ds_read_b32 a173, v61
    ds_read_b32 a174, v62
    v_mfma_f32_16x16x32_bf16 v[180:183], a[4:7], a[148:151], v[180:183]
    v_perm_b32 v63, v100, v35, s39
    v_perm_b32 v56, v97, v35, s36
    v_mfma_f32_16x16x32_bf16 v[180:183], a[0:3], a[144:147], v[180:183]
    ds_read_b128 a[196:199], v41 offset:55296
    ds_read_b32 a175, v63
    v_mfma_f32_16x16x32_bf16 v[184:187], a[0:3], a[120:123], v[184:187]
    ds_read_b32 a64, v56
    v_perm_b32 v57, v97, v35, s37
    v_mfma_f32_16x16x32_bf16 v[184:187], a[4:7], a[124:127], v[184:187]
    ds_read_b32 a65, v57
    v_perm_b32 v58, v97, v35, s38
    v_mfma_f32_16x16x32_bf16 v[188:191], a[4:7], a[132:135], v[188:191]
    ds_read_b128 a[200:203], v40 offset:57344
    ds_read_b32 a66, v58
    v_mfma_f32_16x16x32_bf16 v[188:191], a[0:3], a[128:131], v[188:191]
    buffer_load_dwordx4 v36, s[8:11], s3 offen offset:0  lds
    v_mfma_f32_16x16x32_bf16 v[192:195], a[40:43], a[96:99], v[192:195]
    v_perm_b32 v59, v97, v35, s39
    v_perm_b32 v60, v101, v35, s36
    v_mfma_f32_16x16x32_bf16 v[192:195], a[44:47], a[100:103], v[192:195]
    ds_read_b128 a[204:207], v41 offset:57344
    ds_read_b32 a67, v59
    v_mfma_f32_16x16x32_bf16 v[196:199], a[44:47], a[140:143], v[196:199]
    ds_read_b32 a68, v60
    v_perm_b32 v61, v101, v35, s37
    v_mfma_f32_16x16x32_bf16 v[196:199], a[40:43], a[136:139], v[196:199]
    ds_read_b32 a69, v61
    v_perm_b32 v62, v101, v35, s38
    v_mfma_f32_16x16x32_bf16 v[200:203], a[40:43], a[80:83], v[200:203]
    ds_read_b128 a[208:211], v40 offset:59392
    ds_read_b32 a70, v62
    v_mfma_f32_16x16x32_bf16 v[200:203], a[44:47], a[84:87], v[200:203]
    v_perm_b32 v63, v101, v35, s39
    v_perm_b32 v56, v98, v35, s36
    v_mfma_f32_16x16x32_bf16 v[204:207], a[44:47], a[180:183], v[204:207]
    ds_read_b32 a71, v63
    ds_read_b32 a224, v56
    v_mfma_f32_16x16x32_bf16 v[204:207], a[40:43], a[176:179], v[204:207]
    ds_read_b128 a[212:215], v41 offset:59392
    v_perm_b32 v57, v98, v35, s37
    v_mfma_f32_16x16x32_bf16 v[208:211], a[40:43], a[104:107], v[208:211]
    ds_read_b32 a225, v57
    ds_read_b128 a[240:243], v40 offset:61440
    v_mfma_f32_16x16x32_bf16 v[208:211], a[44:47], a[108:111], v[208:211]
    buffer_load_dwordx4 v[88:91], v32, s[12:15], s45 offen sc1
    v_mfma_f32_16x16x32_bf16 v[212:215], a[44:47], a[148:151], v[212:215]
    v_perm_b32 v58, v98, v35, s38
    v_perm_b32 v59, v98, v35, s39
    v_mfma_f32_16x16x32_bf16 v[212:215], a[40:43], a[144:147], v[212:215]
    ds_read_b32 a226, v58
    ds_read_b32 a227, v59
    v_mfma_f32_16x16x32_bf16 v[216:219], a[40:43], a[120:123], v[216:219]
    ds_read_b128 a[244:247], v41 offset:61440
    v_mfma_f32_16x16x32_bf16 v[216:219], a[44:47], a[124:127], v[216:219]
    buffer_load_dwordx4 v[92:95], v33, s[12:15], s45 offen sc1
    v_mfma_f32_16x16x32_bf16 v[220:223], a[44:47], a[132:135], v[220:223]
    s_waitcnt vmcnt(12)
    v_bitop3_b32 v60, v107, v111, s76 bitop3:0x7e
    v_perm_b32 v61, v102, v35, s36
    v_mfma_f32_16x16x32_bf16 v[220:223], a[40:43], a[128:131], v[220:223]
    ds_read_b32 a228, v61
    v_cmp_lt_u32 vcc, 0xffff, v60
    v_mfma_f32_16x16x32_bf16 v[224:227], a[56:59], a[98:101], v[224:227]
    s_waitcnt lgkmcnt(6)
    ds_read_b128 a[248:251], v40 offset:63488
    v_mfma_f32_16x16x32_bf16 v[224:227], a[60:63], a[162:165], v[224:227]
    buffer_load_dwordx4 v[48:51], v34, s[12:15], s45 offen sc1
    v_mfma_f32_16x16x32_bf16 v[228:231], a[60:63], a[90:93], v[228:231]
    ds_read_b128 a[252:255], v41 offset:63488
    s_cbranch_vccnz L_slow4_1
L_back4_1:
    v_mfma_f32_16x16x32_bf16 v[228:231], a[56:59], a[138:141], v[228:231]
    v_perm_b32 v62, v102, v35, s37
    v_perm_b32 v63, v102, v35, s38
    v_mfma_f32_16x16x32_bf16 v[232:235], a[56:59], a[82:85], v[232:235]
    ds_read_b32 a229, v62
    ds_read_b32 a230, v63
    v_mfma_f32_16x16x32_bf16 v[232:235], a[60:63], a[218:221], v[232:235]
    buffer_load_dwordx4 v[52:55], v44, s[12:15], s45 offen sc1
    v_mfma_f32_16x16x32_bf16 v[236:239], a[60:63], a[194:197], v[236:239]
    v_perm_b32 v56, v102, v35, s39
    v_perm_b32 v57, v99, v35, s36
    v_mfma_f32_16x16x32_bf16 v[236:239], a[56:59], a[178:181], v[236:239]
    s_add_u32 s56, s55, 1536
    ds_read_b32 a231, v56
    v_perm_b32 v58, v99, v35, s37
    v_mfma_f32_16x16x32_bf16 v[240:243], a[56:59], a[106:109], v[240:243]
    ds_read_b32 a32, v57
    ds_read_b32 a33, v58
    v_mfma_f32_16x16x32_bf16 v[240:243], a[60:63], a[202:205], v[240:243]
    buffer_load_dwordx4 v37, s[8:11], s3 offen offset:1024  lds
    v_mfma_f32_16x16x32_bf16 v[244:247], a[60:63], a[210:213], v[244:247]
    v_perm_b32 v59, v103, v35, s36
    v_perm_b32 v60, v103, v35, s37
    v_mfma_f32_16x16x32_bf16 v[244:247], a[56:59], a[146:149], v[244:247]
    s_waitcnt vmcnt(14) lgkmcnt(5)
    ds_read_b32 a34, v59
    ds_read_b32 a35, v60
    v_mfma_f32_16x16x32_bf16 v[248:251], a[56:59], a[122:125], v[248:251]
    s_barrier
    v_mfma_f32_16x16x32_bf16 v[248:251], a[60:63], a[242:245], v[248:251]
    v_perm_b32 v61, v107, v35, s36
    v_perm_b32 v62, v107, v35, s37
    v_mfma_f32_16x16x32_bf16 v[252:255], a[60:63], a[250:253], v[252:255]
    ds_read_b32 a36, v61
    ds_read_b32 a37, v62
    v_mfma_f32_16x16x32_bf16 v[252:255], a[56:59], a[130:133], v[252:255]
    v_perm_b32 v63, v111, v35, s36
    v_perm_b32 v56, v111, v35, s37
    v_mfma_f32_16x16x32_bf16 v[128:131], a[72:75], a[160:163], v[128:131]
    ds_read_b32 a38, v63
    ds_read_b32 a39, v56
    v_mfma_f32_16x16x32_bf16 v[128:131], a[76:79], a[164:167], v[128:131]
    buffer_load_dwordx4 v38, s[8:11], s3 offen offset:2048  lds
    v_mfma_f32_16x16x32_bf16 v[132:135], a[76:79], a[92:95], v[132:135]
    s_waitcnt vmcnt(13)
    v_bitop3_b32 v57, v115, v119, s76 bitop3:0x7e
    v_perm_b32 v58, v104, v35, s36
    v_mfma_f32_16x16x32_bf16 v[132:135], a[72:75], a[88:91], v[132:135]
    ds_read_b32 a8, v58
    v_cmp_lt_u32 vcc, 0xffff, v57
    v_mfma_f32_16x16x32_bf16 v[136:139], a[72:75], a[216:219], v[136:139]
    v_perm_b32 v59, v104, v35, s37
    v_perm_b32 v60, v104, v35, s38
    v_mfma_f32_16x16x32_bf16 v[136:139], a[76:79], a[220:223], v[136:139]
    ds_read_b32 a9, v59
    ds_read_b32 a10, v60
    v_mfma_f32_16x16x32_bf16 v[140:143], a[76:79], a[196:199], v[140:143]
    v_perm_b32 v61, v104, v35, s39
    s_cbranch_vccnz L_slow5_0
L_back5_0:
    v_mfma_f32_16x16x32_bf16 v[140:143], a[72:75], a[192:195], v[140:143]
    ds_read_b32 a11, v61
    ds_read_b128 a[48:51], v42 offset:0
    v_mfma_f32_16x16x32_bf16 v[144:147], a[72:75], a[200:203], v[144:147]
    buffer_load_dwordx4 v39, s[8:11], s3 offen offset:3072  lds
    v_mfma_f32_16x16x32_bf16 v[144:147], a[76:79], a[204:207], v[144:147]
    s_add_u32 m0, s57, 32768
    v_perm_b32 v62, v108, v35, s36
    v_perm_b32 v63, v108, v35, s37
    v_mfma_f32_16x16x32_bf16 v[148:151], a[76:79], a[212:215], v[148:151]
    s_add_u32 s3, s69, 1536
    ds_read_b32 a12, v62
    ds_read_b32 a13, v63
    v_mfma_f32_16x16x32_bf16 v[148:151], a[72:75], a[208:211], v[148:151]
    v_perm_b32 v56, v108, v35, s38
    v_perm_b32 v57, v108, v35, s39
    v_mfma_f32_16x16x32_bf16 v[152:155], a[72:75], a[240:243], v[152:155]
    ds_read_b128 a[52:55], v43 offset:0
    ds_read_b32 a14, v56
    v_mfma_f32_16x16x32_bf16 v[152:155], a[76:79], a[244:247], v[152:155]
    ds_read_b32 a15, v57
    v_perm_b32 v58, v105, v35, s36
    v_mfma_f32_16x16x32_bf16 v[156:159], a[76:79], a[252:255], v[156:159]
    ds_read_b128 a[16:19], v42 offset:2048
    ds_read_b32 a184, v58
    v_mfma_f32_16x16x32_bf16 v[156:159], a[72:75], a[248:251], v[156:159]
    buffer_load_dwordx4 v36, s[8:11], s56 offen offset:0  lds
    v_mfma_f32_16x16x32_bf16 v[160:163], a[112:115], a[160:163], v[160:163]
    ds_read_b128 a[20:23], v43 offset:2048
    v_perm_b32 v59, v105, v35, s37
    v_mfma_f32_16x16x32_bf16 v[160:163], a[116:119], a[164:167], v[160:163]
    ds_read_b32 a185, v59
    v_perm_b32 v60, v105, v35, s38
    v_mfma_f32_16x16x32_bf16 v[164:167], a[116:119], a[92:95], v[164:167]
    ds_read_b128 a[24:27], v42 offset:4096
    ds_read_b32 a186, v60
    v_mfma_f32_16x16x32_bf16 v[164:167], a[112:115], a[88:91], v[164:167]
    v_perm_b32 v61, v105, v35, s39
    v_perm_b32 v62, v109, v35, s36
    v_mfma_f32_16x16x32_bf16 v[168:171], a[112:115], a[216:219], v[168:171]
    ds_read_b32 a187, v61
    ds_read_b32 a188, v62
    v_mfma_f32_16x16x32_bf16 v[168:171], a[116:119], a[220:223], v[168:171]
    ds_read_b128 a[28:31], v43 offset:4096
    v_perm_b32 v63, v109, v35, s37
    v_mfma_f32_16x16x32_bf16 v[172:175], a[116:119], a[196:199], v[172:175]
    ds_read_b32 a189, v63
    ds_read_b128 a[232:235], v42 offset:6144
    v_mfma_f32_16x16x32_bf16 v[172:175], a[112:115], a[192:195], v[172:175]
    buffer_load_dwordx4 v37, s[8:11], s56 offen offset:1024  lds
    v_mfma_f32_16x16x32_bf16 v[176:179], a[112:115], a[200:203], v[176:179]
    v_perm_b32 v56, v109, v35, s38
    v_perm_b32 v57, v109, v35, s39
    v_mfma_f32_16x16x32_bf16 v[176:179], a[116:119], a[204:207], v[176:179]
    ds_read_b32 a190, v56
    ds_read_b32 a191, v57
    v_mfma_f32_16x16x32_bf16 v[180:183], a[116:119], a[212:215], v[180:183]
    v_perm_b32 v58, v106, v35, s36
    v_perm_b32 v59, v106, v35, s37
    v_mfma_f32_16x16x32_bf16 v[180:183], a[112:115], a[208:211], v[180:183]
    ds_read_b128 a[236:239], v43 offset:6144
    ds_read_b32 a0, v58
    v_mfma_f32_16x16x32_bf16 v[184:187], a[112:115], a[240:243], v[184:187]
    ds_read_b32 a1, v59
    v_perm_b32 v60, v106, v35, s38
    v_mfma_f32_16x16x32_bf16 v[184:187], a[116:119], a[244:247], v[184:187]
    ds_read_b32 a2, v60
    ds_read_b128 a[40:43], v42 offset:8192
    v_mfma_f32_16x16x32_bf16 v[188:191], a[116:119], a[252:255], v[188:191]
    buffer_load_dwordx4 v38, s[8:11], s56 offen offset:2048  lds
    v_mfma_f32_16x16x32_bf16 v[188:191], a[112:115], a[248:251], v[188:191]
    v_perm_b32 v61, v106, v35, s39
    v_perm_b32 v62, v110, v35, s36
    v_mfma_f32_16x16x32_bf16 v[192:195], a[152:155], a[160:163], v[192:195]
    ds_read_b32 a3, v61
    ds_read_b32 a4, v62
    v_mfma_f32_16x16x32_bf16 v[192:195], a[156:159], a[164:167], v[192:195]
    ds_read_b128 a[44:47], v43 offset:8192
    v_perm_b32 v63, v110, v35, s37
    v_mfma_f32_16x16x32_bf16 v[196:199], a[156:159], a[92:95], v[196:199]
    ds_read_b32 a5, v63
    v_perm_b32 v56, v110, v35, s38
    v_mfma_f32_16x16x32_bf16 v[196:199], a[152:155], a[88:91], v[196:199]
    ds_read_b32 a6, v56
    v_perm_b32 v57, v110, v35, s39
    v_mfma_f32_16x16x32_bf16 v[200:203], a[152:155], a[216:219], v[200:203]
    ds_read_b128 a[96:99], v42 offset:10240
    ds_read_b32 a7, v57
    v_mfma_f32_16x16x32_bf16 v[200:203], a[156:159], a[220:223], v[200:203]
    buffer_load_dwordx4 v39, s[8:11], s56 offen offset:3072  lds
    v_mfma_f32_16x16x32_bf16 v[204:207], a[156:159], a[196:199], v[204:207]
    s_add_u32 m0, s57, 49152
    v_perm_b32 v58, v112, v35, s36
    v_perm_b32 v59, v112, v35, s37
    v_mfma_f32_16x16x32_bf16 v[204:207], a[152:155], a[192:195], v[204:207]
    s_add_u32 s56, s55, 1792
    ds_read_b128 a[100:103], v43 offset:10240
    ds_read_b32 a136, v58
    v_mfma_f32_16x16x32_bf16 v[208:211], a[152:155], a[200:203], v[208:211]
    ds_read_b32 a137, v59
    v_perm_b32 v60, v112, v35, s38
    v_mfma_f32_16x16x32_bf16 v[208:211], a[156:159], a[204:207], v[208:211]
    s_waitcnt vmcnt(15)
    ds_read_b32 a138, v60
    v_bitop3_b32 v61, v123, v127, s76 bitop3:0x7e
    v_mfma_f32_16x16x32_bf16 v[212:215], a[156:159], a[212:215], v[212:215]
    ds_read_b128 a[80:83], v42 offset:12288
    v_cmp_lt_u32 vcc, 0xffff, v61
    v_mfma_f32_16x16x32_bf16 v[212:215], a[152:155], a[208:211], v[212:215]
    v_perm_b32 v62, v112, v35, s39
    v_perm_b32 v63, v116, v35, s36
    v_mfma_f32_16x16x32_bf16 v[216:219], a[152:155], a[240:243], v[216:219]
    ds_read_b32 a139, v62
    ds_read_b32 a140, v63
    v_mfma_f32_16x16x32_bf16 v[216:219], a[156:159], a[244:247], v[216:219]
    buffer_load_dwordx4 v36, s[8:11], s3 offen offset:0  lds
    v_mfma_f32_16x16x32_bf16 v[220:223], a[156:159], a[252:255], v[220:223]
    ds_read_b128 a[84:87], v43 offset:12288
    s_cbranch_vccnz L_slow5_1
L_back5_1:
    v_mfma_f32_16x16x32_bf16 v[220:223], a[152:155], a[248:251], v[220:223]
    s_waitcnt lgkmcnt(8)
    v_perm_b32 v56, v116, v35, s37
    v_perm_b32 v57, v116, v35, s38
    v_mfma_f32_16x16x32_bf16 v[128:131], a[168:171], a[48:51], v[128:131]
    ds_read_b128 a[176:179], v42 offset:14336
    ds_read_b32 a141, v56
    v_mfma_f32_16x16x32_bf16 v[128:131], a[172:175], a[52:55], v[128:131]
    ds_read_b32 a142, v57
    v_perm_b32 v58, v116, v35, s39
    v_mfma_f32_16x16x32_bf16 v[132:135], a[172:175], a[20:23], v[132:135]
    ds_read_b128 a[180:183], v43 offset:14336
    ds_read_b32 a143, v58
    v_perm_b32 v59, v113, v35, s36
    v_mfma_f32_16x16x32_bf16 v[132:135], a[168:171], a[16:19], v[132:135]
    ds_read_b32 a144, v59
    ds_read_b128 a[104:107], v42 offset:16384
    v_mfma_f32_16x16x32_bf16 v[136:139], a[168:171], a[24:27], v[136:139]
    buffer_load_dwordx4 v37, s[8:11], s3 offen offset:1024  lds
    v_mfma_f32_16x16x32_bf16 v[136:139], a[172:175], a[28:31], v[136:139]
    v_perm_b32 v60, v113, v35, s37
    v_perm_b32 v61, v113, v35, s38
    v_mfma_f32_16x16x32_bf16 v[140:143], a[172:175], a[236:239], v[140:143]
    ds_read_b32 a145, v60
    ds_read_b32 a146, v61
    v_mfma_f32_16x16x32_bf16 v[140:143], a[168:171], a[232:235], v[140:143]
    v_perm_b32 v62, v113, v35, s39
    v_perm_b32 v63, v117, v35, s36
    v_mfma_f32_16x16x32_bf16 v[144:147], a[168:171], a[40:43], v[144:147]
    ds_read_b32 a147, v62
    ds_read_b32 a148, v63
    v_mfma_f32_16x16x32_bf16 v[144:147], a[172:175], a[44:47], v[144:147]
    s_waitcnt lgkmcnt(9)
    v_perm_b32 v56, v117, v35, s37
    v_perm_b32 v57, v117, v35, s38
    v_mfma_f32_16x16x32_bf16 v[148:151], a[172:175], a[100:103], v[148:151]
    ds_read_b32 a149, v56
    ds_read_b32 a150, v57
    v_mfma_f32_16x16x32_bf16 v[148:151], a[168:171], a[96:99], v[148:151]
    ds_read_b128 a[108:111], v43 offset:16384
    v_mfma_f32_16x16x32_bf16 v[152:155], a[168:171], a[80:83], v[152:155]
    buffer_load_dwordx4 v38, s[8:11], s3 offen offset:2048  lds
    v_mfma_f32_16x16x32_bf16 v[152:155], a[172:175], a[84:87], v[152:155]
    s_waitcnt lgkmcnt(7)
    ds_read_b128 a[120:123], v42 offset:18432
    v_perm_b32 v58, v117, v35, s39
    v_mfma_f32_16x16x32_bf16 v[156:159], a[172:175], a[180:183], v[156:159]
    ds_read_b32 a151, v58
    v_perm_b32 v59, v114, v35, s36
    v_mfma_f32_16x16x32_bf16 v[156:159], a[168:171], a[176:179], v[156:159]
    ds_read_b128 a[124:127], v43 offset:18432
    ds_read_b32 a56, v59
    v_mfma_f32_16x16x32_bf16 v[160:163], a[64:67], a[48:51], v[160:163]
    v_perm_b32 v60, v114, v35, s37
    v_perm_b32 v61, v114, v35, s38
    v_mfma_f32_16x16x32_bf16 v[160:163], a[68:71], a[52:55], v[160:163]
    ds_read_b32 a57, v60
    ds_read_b32 a58, v61
    v_mfma_f32_16x16x32_bf16 v[164:167], a[68:71], a[20:23], v[164:167]
    ds_read_b128 a[128:131], v42 offset:20480
    v_mfma_f32_16x16x32_bf16 v[164:167], a[64:67], a[16:19], v[164:167]
    buffer_load_dwordx4 v39, s[8:11], s3 offen offset:3072  lds
    v_mfma_f32_16x16x32_bf16 v[168:171], a[64:67], a[24:27], v[168:171]
    s_add_u32 m0, s57, 65536
    v_perm_b32 v62, v114, v35, s39
    v_perm_b32 v63, v118, v35, s36
    v_mfma_f32_16x16x32_bf16 v[168:171], a[68:71], a[28:31], v[168:171]
    s_add_u32 s3, s69, 1792
    ds_read_b128 a[132:135], v43 offset:20480
    ds_read_b32 a59, v62
    v_mfma_f32_16x16x32_bf16 v[172:175], a[68:71], a[236:239], v[172:175]
    ds_read_b32 a60, v63
    ds_read_b128 a[72:75], v42 offset:22528
    v_mfma_f32_16x16x32_bf16 v[172:175], a[64:67], a[232:235], v[172:175]
    buffer_load_dwordx4 v[64:67], v22, s[32:35], 0 offen
    v_mfma_f32_16x16x32_bf16 v[176:179], a[64:67], a[40:43], v[176:179]
    v_perm_b32 v56, v118, v35, s37
    v_perm_b32 v57, v118, v35, s38
    v_mfma_f32_16x16x32_bf16 v[176:179], a[68:71], a[44:47], v[176:179]
    ds_read_b32 a61, v56
    ds_read_b32 a62, v57
    v_mfma_f32_16x16x32_bf16 v[180:183], a[68:71], a[100:103], v[180:183]
    ds_read_b128 a[76:79], v43 offset:22528
    v_mfma_f32_16x16x32_bf16 v[180:183], a[64:67], a[96:99], v[180:183]
    buffer_load_dwordx4 v[68:71], v32, s[12:15], s72 offen sc1
    v_mfma_f32_16x16x32_bf16 v[184:187], a[64:67], a[80:83], v[184:187]
    v_perm_b32 v58, v118, v35, s39
    v_perm_b32 v59, v115, v35, s36
    v_mfma_f32_16x16x32_bf16 v[184:187], a[68:71], a[84:87], v[184:187]
    ds_read_b32 a63, v58
    ds_read_b32 a112, v59
    v_mfma_f32_16x16x32_bf16 v[188:191], a[68:71], a[180:183], v[188:191]
    ds_read_b128 a[160:163], v42 offset:24576
    v_mfma_f32_16x16x32_bf16 v[188:191], a[64:67], a[176:179], v[188:191]
    buffer_load_dwordx4 v[72:75], v33, s[12:15], s72 offen sc1
    v_mfma_f32_16x16x32_bf16 v[192:195], a[224:227], a[48:51], v[192:195]
    v_perm_b32 v60, v115, v35, s37
    v_perm_b32 v61, v119, v35, s36
    v_mfma_f32_16x16x32_bf16 v[192:195], a[228:231], a[52:55], v[192:195]
    ds_read_b128 a[164:167], v43 offset:24576
    ds_read_b32 a113, v60
    v_mfma_f32_16x16x32_bf16 v[196:199], a[228:231], a[20:23], v[196:199]
    ds_read_b32 a114, v61
    ds_read_b128 a[88:91], v42 offset:26624
    v_mfma_f32_16x16x32_bf16 v[196:199], a[224:227], a[16:19], v[196:199]
    buffer_load_dwordx4 v[76:79], v34, s[12:15], s72 offen sc1
    v_mfma_f32_16x16x32_bf16 v[200:203], a[224:227], a[24:27], v[200:203]
    v_perm_b32 v62, v119, v35, s37
    v_perm_b32 v63, v123, v35, s36
    v_mfma_f32_16x16x32_bf16 v[200:203], a[228:231], a[28:31], v[200:203]
    ds_read_b32 a115, v62
    ds_read_b32 a116, v63
    v_mfma_f32_16x16x32_bf16 v[204:207], a[228:231], a[236:239], v[204:207]
    ds_read_b128 a[92:95], v43 offset:26624
    v_mfma_f32_16x16x32_bf16 v[204:207], a[224:227], a[232:235], v[204:207]
    buffer_load_dwordx4 v[80:83], v44, s[12:15], s72 offen sc1
    v_mfma_f32_16x16x32_bf16 v[208:211], a[224:227], a[40:43], v[208:211]
    v_perm_b32 v56, v123, v35, s37
    v_perm_b32 v57, v127, v35, s36
    v_mfma_f32_16x16x32_bf16 v[208:211], a[228:231], a[44:47], v[208:211]
    ds_read_b32 a117, v56
    ds_read_b32 a118, v57
    v_mfma_f32_16x16x32_bf16 v[212:215], a[228:231], a[100:103], v[212:215]
    ds_read_b128 a[216:219], v42 offset:28672
    v_mfma_f32_16x16x32_bf16 v[212:215], a[224:227], a[96:99], v[212:215]
    buffer_load_dwordx2 v[84:85], v22, s[32:35], 0 offen offset:16
    v_mfma_f32_16x16x32_bf16 v[216:219], a[224:227], a[80:83], v[216:219]
    s_waitcnt vmcnt(19)
    v_bitop3_b32 v58, v91, v95, s76 bitop3:0x7e
    v_perm_b32 v59, v127, v35, s37
    v_mfma_f32_16x16x32_bf16 v[216:219], a[228:231], a[84:87], v[216:219]
    ds_read_b128 a[220:223], v43 offset:28672
    ds_read_b32 a119, v59
    v_cmp_lt_u32 vcc, 0xffff, v58
    v_mfma_f32_16x16x32_bf16 v[220:223], a[228:231], a[180:183], v[220:223]
    ds_read_b128 a[192:195], v42 offset:30720
    v_mfma_f32_16x16x32_bf16 v[220:223], a[224:227], a[176:179], v[220:223]
    buffer_load_dword v86, v23, s[32:35], 0 offen
    v_mfma_f32_16x16x32_bf16 v[224:227], a[32:35], a[50:53], v[224:227]
    s_waitcnt vmcnt(18) lgkmcnt(6)
    v_perm_b32 v60, v120, v35, s36
    s_cbranch_vccnz L_slow6_0
L_back6_0:
    v_mfma_f32_16x16x32_bf16 v[224:227], a[36:39], a[106:109], v[224:227]
    ds_read_b32 a200, v60
    v_perm_b32 v61, v120, v35, s37
    v_perm_b32 v62, v120, v35, s38
    v_mfma_f32_16x16x32_bf16 v[228:231], a[36:39], a[122:125], v[228:231]
    ds_read_b128 a[196:199], v43 offset:30720
    ds_read_b32 a201, v61
    v_bitop3_b32 v63, v51, v55, s76 bitop3:0x7e
    v_mfma_f32_16x16x32_bf16 v[228:231], a[32:35], a[18:21], v[228:231]
    ds_read_b32 a202, v62
    v_cmp_lt_u32 vcc, 0xffff, v63
    v_perm_b32 v56, v120, v35, s39
    v_mfma_f32_16x16x32_bf16 v[232:235], a[32:35], a[26:29], v[232:235]
    ds_read_b32 a203, v56
    v_perm_b32 v57, v124, v35, s36
    v_perm_b32 v58, v124, v35, s37
    v_mfma_f32_16x16x32_bf16 v[232:235], a[36:39], a[130:133], v[232:235]
    ds_read_b32 a204, v57
    ds_read_b32 a205, v58
    v_perm_b32 v59, v124, v35, s38
    v_mfma_f32_16x16x32_bf16 v[236:239], a[36:39], a[74:77], v[236:239]
    ds_read_b32 a206, v59
    s_cbranch_vccnz L_slow6_1
L_back6_1:
    v_mfma_f32_16x16x32_bf16 v[236:239], a[32:35], a[234:237], v[236:239]
    v_perm_b32 v60, v124, v35, s39
    v_perm_b32 v61, v121, v35, s36
    v_mfma_f32_16x16x32_bf16 v[240:243], a[32:35], a[42:45], v[240:243]
    ds_read_b32 a207, v60
    ds_read_b32 a208, v61
    v_mfma_f32_16x16x32_bf16 v[240:243], a[36:39], a[162:165], v[240:243]
    v_perm_b32 v62, v121, v35, s37
    v_perm_b32 v63, v121, v35, s38
    v_mfma_f32_16x16x32_bf16 v[244:247], a[36:39], a[90:93], v[244:247]
    ds_read_b32 a209, v62
    ds_read_b32 a210, v63
    v_mfma_f32_16x16x32_bf16 v[244:247], a[32:35], a[98:101], v[244:247]
    s_waitcnt vmcnt(15) lgkmcnt(9)
    v_perm_b32 v56, v121, v35, s39
    v_perm_b32 v57, v125, v35, s36
    v_mfma_f32_16x16x32_bf16 v[248:251], a[32:35], a[82:85], v[248:251]
    s_barrier
L_pad3:
    s_cbranch_execz L_pad4
    v_mfma_f32_16x16x32_bf16 v[248:251], a[36:39], a[218:221], v[248:251]
    buffer_load_dwordx4 v36, s[8:11], s56 offen offset:0  lds
    v_mfma_f32_16x16x32_bf16 v[252:255], a[36:39], a[194:197], v[252:255]
    ds_read_b32 a211, v56
    ds_read_b32 a212, v57
    v_mfma_f32_16x16x32_bf16 v[252:255], a[32:35], a[178:181], v[252:255]
    v_perm_b32 v58, v125, v35, s37
    v_perm_b32 v59, v125, v35, s38
    v_mfma_f32_16x16x32_bf16 v[128:131], a[8:11], a[104:107], v[128:131]
    ds_read_b32 a213, v58
    ds_read_b32 a214, v59
    v_mfma_f32_16x16x32_bf16 v[128:131], a[12:15], a[108:111], v[128:131]
    buffer_load_dwordx4 v37, s[8:11], s56 offen offset:1024  lds
    v_mfma_f32_16x16x32_bf16 v[132:135], a[12:15], a[124:127], v[132:135]
    v_perm_b32 v60, v125, v35, s39
    v_perm_b32 v61, v122, v35, s36
    v_mfma_f32_16x16x32_bf16 v[132:135], a[8:11], a[120:123], v[132:135]
    ds_read_b32 a215, v60
    ds_read_b32 a240, v61
    v_mfma_f32_16x16x32_bf16 v[136:139], a[8:11], a[128:131], v[136:139]
    ds_read_b128 a[152:155], v40 offset:0
    v_mfma_f32_16x16x32_bf16 v[136:139], a[12:15], a[132:135], v[136:139]
    buffer_load_dwordx4 v38, s[8:11], s56 offen offset:2048  lds
    v_mfma_f32_16x16x32_bf16 v[140:143], a[12:15], a[76:79], v[140:143]
    v_perm_b32 v62, v122, v35, s37
    v_perm_b32 v63, v122, v35, s38
    v_mfma_f32_16x16x32_bf16 v[140:143], a[8:11], a[72:75], v[140:143]
    ds_read_b32 a241, v62
    ds_read_b32 a242, v63
    v_mfma_f32_16x16x32_bf16 v[144:147], a[8:11], a[160:163], v[144:147]
    ds_read_b128 a[156:159], v41 offset:0
    v_mfma_f32_16x16x32_bf16 v[144:147], a[12:15], a[164:167], v[144:147]
    buffer_load_dwordx4 v39, s[8:11], s56 offen offset:3072  lds
    v_mfma_f32_16x16x32_bf16 v[148:151], a[12:15], a[92:95], v[148:151]
    s_add_u32 m0, s57, 81920
    v_perm_b32 v56, v122, v35, s39
    v_perm_b32 v57, v126, v35, s36
    v_mfma_f32_16x16x32_bf16 v[148:151], a[8:11], a[88:91], v[148:151]
    ds_read_b32 a243, v56
    ds_read_b32 a244, v57
    v_perm_b32 v58, v126, v35, s37
    v_mfma_f32_16x16x32_bf16 v[152:155], a[8:11], a[216:219], v[152:155]
    ds_read_b32 a245, v58
    ds_read_b128 a[248:251], v40 offset:2048
    v_mfma_f32_16x16x32_bf16 v[152:155], a[12:15], a[220:223], v[152:155]
    buffer_load_dwordx4 v36, s[8:11], s3 offen offset:0  lds
    v_mfma_f32_16x16x32_bf16 v[156:159], a[12:15], a[196:199], v[156:159]
    v_perm_b32 v59, v126, v35, s38
    v_perm_b32 v60, v126, v35, s39
    v_mfma_f32_16x16x32_bf16 v[156:159], a[8:11], a[192:195], v[156:159]
    ds_read_b128 a[252:255], v41 offset:2048
    ds_read_b32 a246, v59
    v_perm_b32 v61, v91, v35, s36
    v_mfma_f32_16x16x32_bf16 v[160:163], a[184:187], a[104:107], v[160:163]
    ds_read_b32 a247, v60
    ds_read_b32 a168, v61
    v_mfma_f32_16x16x32_bf16 v[160:163], a[188:191], a[108:111], v[160:163]
    ds_read_b128 a[64:67], v40 offset:4096
    v_mfma_f32_16x16x32_bf16 v[164:167], a[188:191], a[124:127], v[164:167]
    buffer_load_dwordx4 v37, s[8:11], s3 offen offset:1024  lds
    v_mfma_f32_16x16x32_bf16 v[164:167], a[184:187], a[120:123], v[164:167]
    v_perm_b32 v62, v91, v35, s37
    v_perm_b32 v63, v95, v35, s36
    v_mfma_f32_16x16x32_bf16 v[168:171], a[184:187], a[128:131], v[168:171]
    ds_read_b32 a169, v62
    ds_read_b32 a170, v63
    v_perm_b32 v56, v95, v35, s37
    v_mfma_f32_16x16x32_bf16 v[168:171], a[188:191], a[132:135], v[168:171]
    ds_read_b128 a[68:71], v41 offset:4096
    ds_read_b32 a171, v56
    v_perm_b32 v57, v51, v35, s36
    v_mfma_f32_16x16x32_bf16 v[172:175], a[188:191], a[76:79], v[172:175]
    ds_read_b32 a172, v57
    v_perm_b32 v58, v51, v35, s37
    v_mfma_f32_16x16x32_bf16 v[172:175], a[184:187], a[72:75], v[172:175]
    ds_read_b32 a173, v58
    v_perm_b32 v59, v55, v35, s36
    v_mfma_f32_16x16x32_bf16 v[176:179], a[184:187], a[160:163], v[176:179]
    ds_read_b128 a[224:227], v40 offset:6144
    ds_read_b32 a174, v59
    v_mfma_f32_16x16x32_bf16 v[176:179], a[188:191], a[164:167], v[176:179]
    ds_read_b128 a[228:231], v41 offset:6144
    v_mfma_f32_16x16x32_bf16 v[180:183], a[188:191], a[92:95], v[180:183]
    buffer_load_dwordx4 v38, s[8:11], s3 offen offset:2048  lds
    v_mfma_f32_16x16x32_bf16 v[180:183], a[184:187], a[88:91], v[180:183]
    v_perm_b32 v60, v55, v35, s37
    v_perm_b32 v61, v88, v35, s36
    v_mfma_f32_16x16x32_bf16 v[184:187], a[184:187], a[216:219], v[184:187]
    ds_read_b32 a175, v60
    ds_read_b32 a48, v61
    v_mfma_f32_16x16x32_bf16 v[184:187], a[188:191], a[220:223], v[184:187]
    v_perm_b32 v62, v88, v35, s37
    v_perm_b32 v63, v88, v35, s38
    v_mfma_f32_16x16x32_bf16 v[188:191], a[188:191], a[196:199], v[188:191]
    ds_read_b128 a[16:19], v40 offset:8192
    ds_read_b32 a49, v62
    v_mfma_f32_16x16x32_bf16 v[188:191], a[184:187], a[192:195], v[188:191]
    ds_read_b32 a50, v63
    v_perm_b32 v56, v88, v35, s39
    v_mfma_f32_16x16x32_bf16 v[192:195], a[0:3], a[104:107], v[192:195]
    ds_read_b32 a51, v56
    ds_read_b128 a[20:23], v41 offset:8192
    v_mfma_f32_16x16x32_bf16 v[192:195], a[4:7], a[108:111], v[192:195]
    buffer_load_dwordx4 v39, s[8:11], s3 offen offset:3072  lds
    v_mfma_f32_16x16x32_bf16 v[196:199], a[4:7], a[124:127], v[196:199]
    v_perm_b32 v57, v92, v35, s36
    v_perm_b32 v58, v92, v35, s37
    v_mfma_f32_16x16x32_bf16 v[196:199], a[0:3], a[120:123], v[196:199]
    ds_read_b32 a52, v57
    ds_read_b32 a53, v58
    v_mfma_f32_16x16x32_bf16 v[200:203], a[0:3], a[128:131], v[200:203]
    ds_read_b128 a[24:27], v40 offset:10240
    v_perm_b32 v59, v92, v35, s38
    v_mfma_f32_16x16x32_bf16 v[200:203], a[4:7], a[132:135], v[200:203]
    ds_read_b32 a54, v59
    v_perm_b32 v60, v92, v35, s39
    v_mfma_f32_16x16x32_bf16 v[204:207], a[4:7], a[76:79], v[204:207]
    ds_read_b32 a55, v60
    v_perm_b32 v61, v48, v35, s36
    v_mfma_f32_16x16x32_bf16 v[204:207], a[0:3], a[72:75], v[204:207]
    ds_read_b128 a[28:31], v41 offset:10240
    ds_read_b32 a232, v61
    v_mfma_f32_16x16x32_bf16 v[208:211], a[0:3], a[160:163], v[208:211]
    v_perm_b32 v62, v48, v35, s37
    v_perm_b32 v63, v48, v35, s38
    v_mfma_f32_16x16x32_bf16 v[208:211], a[4:7], a[164:167], v[208:211]
    ds_read_b32 a233, v62
    ds_read_b32 a234, v63
    v_mfma_f32_16x16x32_bf16 v[212:215], a[4:7], a[92:95], v[212:215]
    v_perm_b32 v56, v48, v35, s39
    v_perm_b32 v57, v52, v35, s36
    v_mfma_f32_16x16x32_bf16 v[212:215], a[0:3], a[88:91], v[212:215]
    ds_read_b32 a235, v56
    ds_read_b32 a236, v57
    v_mfma_f32_16x16x32_bf16 v[216:219], a[0:3], a[216:219], v[216:219]
    v_perm_b32 v58, v52, v35, s37
    v_perm_b32 v59, v52, v35, s38
    v_mfma_f32_16x16x32_bf16 v[216:219], a[4:7], a[220:223], v[216:219]
    ds_read_b32 a237, v58
    ds_read_b32 a238, v59
    v_mfma_f32_16x16x32_bf16 v[220:223], a[4:7], a[196:199], v[220:223]
    v_perm_b32 v60, v52, v35, s39
    v_perm_b32 v61, v89, v35, s36
    v_mfma_f32_16x16x32_bf16 v[220:223], a[0:3], a[192:195], v[220:223]
    s_waitcnt lgkmcnt(8)
    ds_read_b32 a239, v60
    ds_read_b32 a40, v61
    v_mfma_f32_16x16x32_bf16 v[128:131], a[136:139], a[152:155], v[128:131]
    v_perm_b32 v62, v89, v35, s37
    v_perm_b32 v63, v89, v35, s38
    v_mfma_f32_16x16x32_bf16 v[128:131], a[140:143], a[156:159], v[128:131]
    ds_read_b32 a41, v62
    ds_read_b32 a42, v63
    v_mfma_f32_16x16x32_bf16 v[132:135], a[140:143], a[252:255], v[132:135]
    v_perm_b32 v56, v89, v35, s39
    v_perm_b32 v57, v93, v35, s36
    v_mfma_f32_16x16x32_bf16 v[132:135], a[136:139], a[248:251], v[132:135]
    ds_read_b32 a43, v56
    ds_read_b32 a44, v57
    v_mfma_f32_16x16x32_bf16 v[136:139], a[136:139], a[64:67], v[136:139]
    v_perm_b32 v58, v93, v35, s37
    v_perm_b32 v59, v93, v35, s38
    v_mfma_f32_16x16x32_bf16 v[136:139], a[140:143], a[68:71], v[136:139]
    ds_read_b32 a45, v58
    ds_read_b32 a46, v59
    v_mfma_f32_16x16x32_bf16 v[140:143], a[140:143], a[228:231], v[140:143]
    ds_read_b128 a[96:99], v40 offset:16384
    v_perm_b32 v60, v93, v35, s39
    v_mfma_f32_16x16x32_bf16 v[140:143], a[136:139], a[224:227], v[140:143]
    s_waitcnt vmcnt(12)
    ds_read_b32 a47, v60
    v_bitop3_b32 v61, v71, v75, s76 bitop3:0x7e
    v_mfma_f32_16x16x32_bf16 v[144:147], a[136:139], a[16:19], v[144:147]
    v_cmp_lt_u32 vcc, 0xffff, v61
    v_perm_b32 v62, v49, v35, s36
    v_mfma_f32_16x16x32_bf16 v[144:147], a[140:143], a[20:23], v[144:147]
    s_waitcnt lgkmcnt(8)
    ds_read_b128 a[100:103], v41 offset:16384
    ds_read_b32 a80, v62
    v_mfma_f32_16x16x32_bf16 v[148:151], a[140:143], a[28:31], v[148:151]
    v_perm_b32 v63, v49, v35, s37
    s_cbranch_vccnz L_slow7_0
L_back7_0:
    v_mfma_f32_16x16x32_bf16 v[148:151], a[136:139], a[24:27], v[148:151]
    ds_read_b32 a81, v63
    v_perm_b32 v56, v49, v35, s38
    v_mfma_f32_16x16x32_bf16 v[160:163], a[144:147], a[152:155], v[160:163]
    ds_read_b128 a[32:35], v40 offset:18432
    ds_read_b32 a82, v56
    v_mfma_f32_16x16x32_bf16 v[160:163], a[148:151], a[156:159], v[160:163]
    s_waitcnt vmcnt(10)
    v_perm_b32 v58, v49, v35, s39
    v_bitop3_b32 v57, v79, v83, s76 bitop3:0x7e
    v_mfma_f32_16x16x32_bf16 v[164:167], a[148:151], a[252:255], v[164:167]
    ds_read_b32 a83, v58
    v_cmp_lt_u32 vcc, 0xffff, v57
    v_mfma_f32_16x16x32_bf16 v[164:167], a[144:147], a[248:251], v[164:167]
    ds_read_b128 a[36:39], v41 offset:18432
    v_perm_b32 v59, v53, v35, s36
    v_mfma_f32_16x16x32_bf16 v[168:171], a[144:147], a[64:67], v[168:171]
    ds_read_b32 a84, v59
    s_cbranch_vccnz L_slow7_1
L_back7_1:
    v_mfma_f32_16x16x32_bf16 v[168:171], a[148:151], a[68:71], v[168:171]
    v_perm_b32 v60, v53, v35, s37
    v_perm_b32 v61, v53, v35, s38
    v_mfma_f32_16x16x32_bf16 v[172:175], a[148:151], a[228:231], v[172:175]
    ds_read_b128 a[176:179], v40 offset:20480
    ds_read_b32 a85, v60
    v_mfma_f32_16x16x32_bf16 v[172:175], a[144:147], a[224:227], v[172:175]
    ds_read_b32 a86, v61
    v_perm_b32 v62, v53, v35, s39
    v_mfma_f32_16x16x32_bf16 v[176:179], a[144:147], a[16:19], v[176:179]
    ds_read_b32 a87, v62
    v_perm_b32 v63, v90, v35, s36
    v_mfma_f32_16x16x32_bf16 v[176:179], a[148:151], a[20:23], v[176:179]
    ds_read_b128 a[180:183], v41 offset:20480
    ds_read_b32 a8, v63
    v_mfma_f32_16x16x32_bf16 v[180:183], a[148:151], a[28:31], v[180:183]
    v_perm_b32 v56, v90, v35, s37
    v_perm_b32 v57, v90, v35, s38
    v_mfma_f32_16x16x32_bf16 v[180:183], a[144:147], a[24:27], v[180:183]
    ds_read_b32 a9, v56
    ds_read_b32 a10, v57
    v_mfma_f32_16x16x32_bf16 v[192:195], a[56:59], a[152:155], v[192:195]
    ds_read_b128 a[184:187], v40 offset:22528
    v_perm_b32 v58, v90, v35, s39
    v_mfma_f32_16x16x32_bf16 v[192:195], a[60:63], a[156:159], v[192:195]
    ds_read_b32 a11, v58
    v_perm_b32 v59, v94, v35, s36
    v_mfma_f32_16x16x32_bf16 v[196:199], a[60:63], a[252:255], v[196:199]
    ds_read_b32 a12, v59
    v_perm_b32 v60, v94, v35, s37
    v_mfma_f32_16x16x32_bf16 v[196:199], a[56:59], a[248:251], v[196:199]
    ds_read_b128 a[188:191], v41 offset:22528
    ds_read_b32 a13, v60
    v_mfma_f32_16x16x32_bf16 v[200:203], a[56:59], a[64:67], v[200:203]
    v_perm_b32 v61, v94, v35, s38
    v_perm_b32 v62, v94, v35, s39
    v_mfma_f32_16x16x32_bf16 v[200:203], a[60:63], a[68:71], v[200:203]
    ds_read_b32 a14, v61
    ds_read_b32 a15, v62
    v_mfma_f32_16x16x32_bf16 v[204:207], a[60:63], a[228:231], v[204:207]
    ds_read_b128 a[104:107], v40 offset:24576
    v_perm_b32 v63, v50, v35, s36
    v_mfma_f32_16x16x32_bf16 v[204:207], a[56:59], a[224:227], v[204:207]
    ds_read_b32 a120, v63
    v_perm_b32 v56, v50, v35, s37
    v_mfma_f32_16x16x32_bf16 v[208:211], a[56:59], a[16:19], v[208:211]
    ds_read_b32 a121, v56
    v_perm_b32 v57, v50, v35, s38
    v_mfma_f32_16x16x32_bf16 v[208:211], a[60:63], a[20:23], v[208:211]
    ds_read_b128 a[108:111], v41 offset:24576
    ds_read_b32 a122, v57
    v_mfma_f32_16x16x32_bf16 v[212:215], a[60:63], a[28:31], v[212:215]
    ds_read_b128 a[128:131], v40 offset:26624
    v_perm_b32 v58, v50, v35, s39
    v_mfma_f32_16x16x32_bf16 v[212:215], a[56:59], a[24:27], v[212:215]
    ds_read_b128 a[132:135], v41 offset:26624
    ds_read_b32 a123, v58
    v_mfma_f32_16x16x32_bf16 v[224:227], a[112:115], a[154:157], v[224:227]
    s_waitcnt lgkmcnt(10)
    v_perm_b32 v59, v54, v35, s36
    v_perm_b32 v60, v54, v35, s37
    v_mfma_f32_16x16x32_bf16 v[224:227], a[116:119], a[98:101], v[224:227]
    ds_read_b32 a124, v59
    ds_read_b32 a125, v60
    v_mfma_f32_16x16x32_bf16 v[228:231], a[116:119], a[34:37], v[228:231]
    v_perm_b32 v61, v54, v35, s38
    v_perm_b32 v62, v54, v35, s39
    v_mfma_f32_16x16x32_bf16 v[228:231], a[112:115], a[250:253], v[228:231]
    ds_read_b32 a126, v61
    ds_read_b32 a127, v62
    v_mfma_f32_16x16x32_bf16 v[232:235], a[112:115], a[66:69], v[232:235]
    v_perm_b32 v63, v71, v35, s36
    v_perm_b32 v56, v71, v35, s37
    v_mfma_f32_16x16x32_bf16 v[232:235], a[116:119], a[178:181], v[232:235]
    ds_read_b32 a72, v63
    ds_read_b32 a73, v56
    v_mfma_f32_16x16x32_bf16 v[236:239], a[116:119], a[186:189], v[236:239]
    v_perm_b32 v57, v75, v35, s36
    v_perm_b32 v58, v75, v35, s37
    v_mfma_f32_16x16x32_bf16 v[236:239], a[112:115], a[226:229], v[236:239]
    ds_read_b32 a74, v57
    ds_read_b32 a75, v58
    v_mfma_f32_16x16x32_bf16 v[240:243], a[112:115], a[18:21], v[240:243]
    s_waitcnt lgkmcnt(8)
    v_perm_b32 v59, v79, v35, s36
    v_perm_b32 v60, v79, v35, s37
    v_mfma_f32_16x16x32_bf16 v[240:243], a[116:119], a[106:109], v[240:243]
    ds_read_b32 a76, v59
    ds_read_b32 a77, v60
    v_mfma_f32_16x16x32_bf16 v[244:247], a[116:119], a[130:133], v[244:247]
    v_perm_b32 v61, v83, v35, s36
    v_perm_b32 v62, v83, v35, s37
    v_mfma_f32_16x16x32_bf16 v[244:247], a[112:115], a[26:29], v[244:247]
    ds_read_b32 a78, v61
    ds_read_b32 a79, v62
    v_mfma_f32_16x16x32_bf16 v[128:131], a[200:203], a[96:99], v[128:131]
    v_perm_b32 v63, v68, v35, s36
    v_perm_b32 v56, v68, v35, s37
    v_mfma_f32_16x16x32_bf16 v[128:131], a[204:207], a[100:103], v[128:131]
    ds_read_b32 a160, v63
    ds_read_b32 a161, v56
    v_mfma_f32_16x16x32_bf16 v[132:135], a[204:207], a[36:39], v[132:135]
    v_perm_b32 v57, v68, v35, s38
    v_perm_b32 v58, v68, v35, s39
    v_mfma_f32_16x16x32_bf16 v[132:135], a[200:203], a[32:35], v[132:135]
    ds_read_b32 a162, v57
    ds_read_b32 a163, v58
    v_mfma_f32_16x16x32_bf16 v[136:139], a[200:203], a[176:179], v[136:139]
    v_perm_b32 v59, v72, v35, s36
    v_perm_b32 v60, v72, v35, s37
    v_mfma_f32_16x16x32_bf16 v[136:139], a[204:207], a[180:183], v[136:139]
    ds_read_b32 a164, v59
    ds_read_b32 a165, v60
    v_mfma_f32_16x16x32_bf16 v[140:143], a[204:207], a[188:191], v[140:143]
    v_perm_b32 v61, v72, v35, s38
    v_perm_b32 v62, v72, v35, s39
    v_mfma_f32_16x16x32_bf16 v[140:143], a[200:203], a[184:187], v[140:143]
    ds_read_b32 a166, v61
    ds_read_b32 a167, v62
    v_mfma_f32_16x16x32_bf16 v[144:147], a[200:203], a[104:107], v[144:147]
    v_perm_b32 v63, v76, v35, s36
    v_perm_b32 v56, v76, v35, s37
    v_mfma_f32_16x16x32_bf16 v[144:147], a[204:207], a[108:111], v[144:147]
    ds_read_b32 a88, v63
    ds_read_b32 a89, v56
    v_mfma_f32_16x16x32_bf16 v[148:151], a[204:207], a[132:135], v[148:151]
    v_perm_b32 v57, v76, v35, s38
    v_perm_b32 v58, v76, v35, s39
    v_mfma_f32_16x16x32_bf16 v[148:151], a[200:203], a[128:131], v[148:151]
    ds_read_b32 a90, v57
    ds_read_b32 a91, v58
    v_mfma_f32_16x16x32_bf16 v[160:163], a[208:211], a[96:99], v[160:163]
    v_perm_b32 v59, v80, v35, s36
    v_perm_b32 v60, v80, v35, s37
    v_mfma_f32_16x16x32_bf16 v[160:163], a[212:215], a[100:103], v[160:163]
    ds_read_b32 a92, v59
    ds_read_b32 a93, v60
    v_mfma_f32_16x16x32_bf16 v[164:167], a[212:215], a[36:39], v[164:167]
    s_waitcnt vmcnt(0)
    v_perm_b32 v61, v80, v35, s38
    v_perm_b32 v62, v80, v35, s39
    v_mfma_f32_16x16x32_bf16 v[164:167], a[208:211], a[32:35], v[164:167]
    ds_read_b32 a94, v61
    ds_read_b32 a95, v62
    v_perm_b32 v63, v69, v35, s36
    v_mfma_f32_16x16x32_bf16 v[168:171], a[208:211], a[176:179], v[168:171]
    s_barrier
    v_mfma_f32_16x16x32_bf16 v[168:171], a[212:215], a[180:183], v[168:171]
    ds_read_b128 a[216:219], v40 offset:32768
    ds_read_b32 a0, v63
    v_mfma_f32_16x16x32_bf16 v[172:175], a[212:215], a[188:191], v[172:175]
    ds_read_b128 a[220:223], v41 offset:32768
    v_perm_b32 v56, v69, v35, s37
    v_mfma_f32_16x16x32_bf16 v[172:175], a[208:211], a[184:187], v[172:175]
    ds_read_b128 a[192:195], v40 offset:49152
    ds_read_b32 a1, v56
    v_perm_b32 v57, v73, v35, s36
    v_mfma_f32_16x16x32_bf16 v[176:179], a[208:211], a[104:107], v[176:179]
    ds_read_b128 a[196:199], v41 offset:49152
    v_perm_b32 v58, v69, v35, s38
    v_mfma_f32_16x16x32_bf16 v[176:179], a[212:215], a[108:111], v[176:179]
    ds_read_b128 a[152:155], v42 offset:0
    ds_read_b32 a4, v57
    v_mfma_f32_16x16x32_bf16 v[180:183], a[212:215], a[132:135], v[180:183]
    ds_read_b32 a2, v58
    v_perm_b32 v59, v73, v35, s37
    v_perm_b32 v60, v77, v35, s36
    v_mfma_f32_16x16x32_bf16 v[180:183], a[208:211], a[128:131], v[180:183]
    ds_read_b32 a5, v59
    v_perm_b32 v61, v69, v35, s39
    v_mfma_f32_16x16x32_bf16 v[192:195], a[240:243], a[96:99], v[192:195]
    ds_read_b128 a[156:159], v43 offset:0
    ds_read_b32 a3, v61
    v_perm_b32 v62, v73, v35, s38
    v_mfma_f32_16x16x32_bf16 v[192:195], a[244:247], a[100:103], v[192:195]
    ds_read_b32 a248, v60
    ds_read_b32 a6, v62
    v_perm_b32 v63, v77, v35, s37
    v_mfma_f32_16x16x32_bf16 v[196:199], a[244:247], a[36:39], v[196:199]
    v_perm_b32 v57, v81, v35, s36
    v_perm_b32 v56, v73, v35, s39
    v_mfma_f32_16x16x32_bf16 v[196:199], a[240:243], a[32:35], v[196:199]
    ds_read_b32 a249, v63
    ds_read_b32 a7, v56
    v_perm_b32 v58, v77, v35, s38
    v_mfma_f32_16x16x32_bf16 v[200:203], a[240:243], a[176:179], v[200:203]
    ds_read_b128 a[64:67], v42 offset:16384
    ds_read_b32 a252, v57
    v_mfma_f32_16x16x32_bf16 v[200:203], a[244:247], a[180:183], v[200:203]
    v_perm_b32 v59, v81, v35, s37
    v_perm_b32 v61, v70, v35, s36
    v_mfma_f32_16x16x32_bf16 v[204:207], a[244:247], a[188:191], v[204:207]
    ds_read_b32 a250, v58
    v_perm_b32 v60, v77, v35, s39
    v_mfma_f32_16x16x32_bf16 v[204:207], a[240:243], a[184:187], v[204:207]
    ds_read_b128 a[68:71], v43 offset:16384
    ds_read_b32 a253, v59
    v_mfma_f32_16x16x32_bf16 v[208:211], a[240:243], a[104:107], v[208:211]
    ds_read_b32 a224, v61
    ds_read_b32 a251, v60
    v_perm_b32 v62, v81, v35, s38
    v_mfma_f32_16x16x32_bf16 v[208:211], a[244:247], a[108:111], v[208:211]
    v_perm_b32 v63, v70, v35, s37
    v_perm_b32 v56, v74, v35, s36
    v_mfma_f32_16x16x32_bf16 v[212:215], a[244:247], a[132:135], v[212:215]
    ds_read_b32 a254, v62
    v_perm_b32 v57, v81, v35, s39
    v_mfma_f32_16x16x32_bf16 v[212:215], a[240:243], a[128:131], v[212:215]
    s_waitcnt lgkmcnt(10)
    ds_read_b32 a225, v63
    v_perm_b32 v58, v70, v35, s38
    v_mfma_f32_16x16x32_bf16 v[224:227], a[168:171], a[218:221], v[224:227]
    s_mov_b32 s66, 0
    ds_read_b32 a228, v56
    v_perm_b32 v59, v74, v35, s37
    v_mfma_f32_16x16x32_bf16 v[224:227], a[172:175], a[194:197], v[224:227]
    s_mov_b32 s67, 14336
    ds_read_b32 a255, v57
    v_perm_b32 v61, v78, v35, s36
    v_mfma_f32_16x16x32_bf16 v[128:131], a[48:51], a[216:219], v[128:131]
    ds_read_b32 a226, v58
    v_perm_b32 v60, v70, v35, s39
    v_mfma_f32_16x16x32_bf16 v[128:131], a[52:55], a[220:223], v[128:131]
    ds_read_b32 a229, v59
    v_perm_b32 v62, v74, v35, s38
    v_mfma_f32_16x16x32_bf16 v[128:131], a[232:235], a[192:195], v[128:131]
    ds_read_b32 a16, v61
    v_perm_b32 v63, v78, v35, s37
    v_mfma_f32_16x16x32_bf16 v[128:131], a[236:239], a[196:199], v[128:131]
    ds_read_b32 a227, v60
    ds_read_b32 a230, v62
    v_mfma_f32_16x16x32_bf16 v[160:163], a[40:43], a[216:219], v[160:163]
    v_perm_b32 v57, v82, v35, s36
    v_perm_b32 v56, v74, v35, s39
    v_mfma_f32_16x16x32_bf16 v[160:163], a[44:47], a[220:223], v[160:163]
    ds_read_b32 a17, v63
    v_perm_b32 v58, v78, v35, s38
    v_mfma_f32_16x16x32_bf16 v[160:163], a[80:83], a[192:195], v[160:163]
    ds_read_b32 a20, v57
    v_perm_b32 v59, v82, v35, s37
    v_mfma_f32_16x16x32_bf16 v[160:163], a[84:87], a[196:199], v[160:163]
    ds_read_b32 a231, v56
    ds_read_b32 a18, v58
    v_mfma_f32_16x16x32_bf16 v[192:195], a[8:11], a[216:219], v[192:195]
    ds_read_b32 a21, v59
    v_perm_b32 v61, v78, v35, s39
    v_mfma_f32_16x16x32_bf16 v[192:195], a[12:15], a[220:223], v[192:195]
    ds_read_b32 a19, v61
    v_perm_b32 v60, v82, v35, s38
    v_mfma_f32_16x16x32_bf16 v[192:195], a[120:123], a[192:195], v[192:195]
    ds_read_b32 a22, v60
    ds_read_b128 a[24:27], v40 offset:34816
    v_perm_b32 v62, v82, v35, s39
    v_mfma_f32_16x16x32_bf16 v[192:195], a[124:127], a[196:199], v[192:195]
    v_lshlrev_b32 v96, 16, v86
    v_and_b32 v97, 0xffff0000, v86
    v_mfma_f32_16x16x32_bf16 v[224:227], a[72:75], a[154:157], v[224:227]
    s_waitcnt lgkmcnt(8)
    ds_read_b32 a23, v62
    ds_read_b128 a[28:31], v41 offset:34816
    v_mfma_f32_16x16x32_bf16 v[224:227], a[76:79], a[66:69], v[224:227]
    ds_read_b128 a[96:99], v40 offset:51200
    v_lshlrev_b32 v100, 16, v64
    v_mfma_f32_16x16x32_bf16 v[128:131], a[160:163], a[152:155], v[128:131]
    ds_read_b128 a[100:103], v41 offset:51200
    v_and_b32 v101, 0xffff0000, v65
    v_mfma_f32_16x16x32_bf16 v[128:131], a[164:167], a[156:159], v[128:131]
    v_lshlrev_b32 v102, 16, v67
    v_and_b32 v103, 0xffff0000, v84
    v_mfma_f32_16x16x32_bf16 v[128:131], a[88:91], a[64:67], v[128:131]
    ds_read_b128 a[32:35], v42 offset:2048
    v_and_b32 v104, 0xffff0000, v64
    v_mfma_f32_16x16x32_bf16 v[128:131], a[92:95], a[68:71], v[128:131]
    ds_read_b128 a[36:39], v43 offset:2048
    v_lshlrev_b32 v105, 16, v66
    v_mfma_f32_16x16x32_bf16 v[160:163], a[0:3], a[152:155], v[160:163]
    ds_read_b128 a[176:179], v42 offset:18432
    v_and_b32 v106, 0xffff0000, v67
    v_mfma_f32_16x16x32_bf16 v[160:163], a[4:7], a[156:159], v[160:163]
    ds_read_b128 a[180:183], v43 offset:18432
    v_lshlrev_b32 v107, 16, v85
    v_mfma_f32_16x16x32_bf16 v[160:163], a[248:251], a[64:67], v[160:163]
    ds_write_b64 v29, v[226:227] offset:28928
    v_lshlrev_b32 v108, 16, v65
    v_mfma_f32_16x16x32_bf16 v[160:163], a[252:255], a[68:71], v[160:163]
    v_and_b32 v109, 0xffff0000, v66
    v_lshlrev_b32 v110, 16, v84
    v_mfma_f32_16x16x32_bf16 v[192:195], a[224:227], a[152:155], v[192:195]
    s_waitcnt lgkmcnt(6)
    ds_read_b128 a[184:187], v40 offset:36864
    v_and_b32 v111, 0xffff0000, v85
    v_mfma_f32_16x16x32_bf16 v[192:195], a[228:231], a[156:159], v[192:195]
    ds_read_b128 a[188:191], v41 offset:36864
    v_mul_f32 v128, v128, v100
    v_mfma_f32_16x16x32_bf16 v[192:195], a[16:19], a[64:67], v[192:195]
    v_mul_f32 v129, v129, v101
    v_mul_f32 v130, v130, v102
    v_mfma_f32_16x16x32_bf16 v[192:195], a[20:23], a[68:71], v[192:195]
    s_waitcnt lgkmcnt(2)
    s_barrier
    v_mfma_f32_16x16x32_bf16 v[228:231], a[168:171], a[26:29], v[228:231]
    ds_read_b64 v[112:113], v30 offset:28928
    v_mul_f32 v131, v131, v103
    v_mfma_f32_16x16x32_bf16 v[228:231], a[172:175], a[98:101], v[228:231]
    ds_read_b128 a[104:107], v40 offset:53248
    v_mul_f32 v160, v160, v104
    v_mfma_f32_16x16x32_bf16 v[228:231], a[72:75], a[34:37], v[228:231]
    v_cvt_pk_bf16_f32 v116, v128, v160
    v_mul_f32 v161, v161, v105
    v_mfma_f32_16x16x32_bf16 v[228:231], a[76:79], a[178:181], v[228:231]
    v_mul_f32 v192, v192, v108
    v_mul_f32 v193, v193, v109
    v_mfma_f32_16x16x32_bf16 v[132:135], a[48:51], a[24:27], v[132:135]
    v_mul_f32 v194, v194, v110
    v_mul_f32 v195, v195, v111
    v_mfma_f32_16x16x32_bf16 v[132:135], a[52:55], a[28:31], v[132:135]
    v_cvt_pk_bf16_f32 v117, v192, v129
    v_mul_f32 v162, v162, v106
    v_mfma_f32_16x16x32_bf16 v[132:135], a[232:235], a[96:99], v[132:135]
    ds_write_b64 v26, v[116:117] offset:64512
    v_cvt_pk_bf16_f32 v119, v130, v162
    v_mfma_f32_16x16x32_bf16 v[132:135], a[236:239], a[100:103], v[132:135]
    v_mul_f32 v163, v163, v107
    v_cvt_pk_bf16_f32 v118, v161, v193
    v_mfma_f32_16x16x32_bf16 v[132:135], a[160:163], a[32:35], v[132:135]
    ds_write_b64 v26, v[118:119] offset:64520
    v_cvt_pk_bf16_f32 v120, v194, v131
    v_mfma_f32_16x16x32_bf16 v[132:135], a[164:167], a[36:39], v[132:135]
    ds_read_b128 a[108:111], v41 offset:53248
    v_cvt_pk_bf16_f32 v121, v163, v195
L_pad4:
    s_cbranch_execz L_warmed
    v_mfma_f32_16x16x32_bf16 v[132:135], a[88:91], a[176:179], v[132:135]
    s_waitcnt lgkmcnt(3)
    ds_write_b64 v26, v[120:121] offset:64528
    v_add_f32 v224, v224, v112
    v_mfma_f32_16x16x32_bf16 v[132:135], a[92:95], a[180:183], v[132:135]
    v_mul_f32 v224, v224, v96
    v_add_f32 v225, v225, v113
    v_mfma_f32_16x16x32_bf16 v[164:167], a[40:43], a[24:27], v[164:167]
    v_mul_f32 v225, v225, v97
    v_cvt_pk_bf16_f32 v112, v224, v225
    v_mfma_f32_16x16x32_bf16 v[164:167], a[44:47], a[28:31], v[164:167]
    ds_read_b128 a[128:131], v42 offset:4096
    v_mov_b32 v8, 1
    v_mfma_f32_16x16x32_bf16 v[164:167], a[80:83], a[96:99], v[164:167]
    ds_write_b32 v28, v112 offset:64512
    v_min_u32 v9, 1, v0
    v_mfma_f32_16x16x32_bf16 v[164:167], a[84:87], a[100:103], v[164:167]
    ds_write_b64 v29, v[230:231] offset:30976
    v_lshlrev_b32 v9, 30, v9
    v_mfma_f32_16x16x32_bf16 v[164:167], a[0:3], a[32:35], v[164:167]
    ds_read_b128 a[132:135], v43 offset:4096
    v_mfma_f32_16x16x32_bf16 v[164:167], a[4:7], a[36:39], v[164:167]
    buffer_atomic_add v8, v9, s[24:27], s77 offen sc0 sc1
    v_mfma_f32_16x16x32_bf16 v[164:167], a[248:251], a[176:179], v[164:167]
    ds_read_b128 a[216:219], v42 offset:20480
    v_mul_f32 v132, v132, v100
    v_mfma_f32_16x16x32_bf16 v[164:167], a[252:255], a[180:183], v[164:167]
    ds_read_b128 a[220:223], v43 offset:20480
    v_mul_f32 v133, v133, v101
    v_mfma_f32_16x16x32_bf16 v[196:199], a[8:11], a[24:27], v[196:199]
    s_waitcnt lgkmcnt(3)
    s_barrier
    v_mfma_f32_16x16x32_bf16 v[196:199], a[12:15], a[28:31], v[196:199]
    ds_read_b128 v[124:127], v24 offset:64512
    ds_read_b64 v[88:89], v30 offset:30976
    v_mfma_f32_16x16x32_bf16 v[196:199], a[120:123], a[96:99], v[196:199]
    ds_read_b128 v[92:95], v24 offset:65440
    v_mul_f32 v134, v134, v102
    v_mfma_f32_16x16x32_bf16 v[196:199], a[124:127], a[100:103], v[196:199]
    ds_read_b128 a[192:195], v40 offset:38912
    v_mul_f32 v135, v135, v103
    v_mfma_f32_16x16x32_bf16 v[196:199], a[224:227], a[32:35], v[196:199]
    v_mul_f32 v164, v164, v104
    v_cvt_pk_bf16_f32 v48, v132, v164
    v_mfma_f32_16x16x32_bf16 v[196:199], a[228:231], a[36:39], v[196:199]
    ds_read_b128 a[196:199], v41 offset:38912
    v_mul_f32 v165, v165, v105
    v_mfma_f32_16x16x32_bf16 v[196:199], a[16:19], a[176:179], v[196:199]
    v_mul_f32 v166, v166, v106
    v_cvt_pk_bf16_f32 v51, v134, v166
    v_mfma_f32_16x16x32_bf16 v[196:199], a[20:23], a[180:183], v[196:199]
    s_waitcnt lgkmcnt(3)
    v_mul_f32 v167, v167, v107
    v_mfma_f32_16x16x32_bf16 v[232:235], a[168:171], a[186:189], v[232:235]
    buffer_store_dwordx4 v[124:127], v25, s[16:19], s66 offen sc1
    v_mfma_f32_16x16x32_bf16 v[232:235], a[172:175], a[106:109], v[232:235]
    s_mov_b32 s66, 114688
    v_add_f32 v228, v228, v88
    v_mul_f32 v228, v228, v96
    v_mfma_f32_16x16x32_bf16 v[232:235], a[72:75], a[130:133], v[232:235]
    v_add_f32 v229, v229, v89
    v_mul_f32 v229, v229, v97
    v_mfma_f32_16x16x32_bf16 v[232:235], a[76:79], a[218:221], v[232:235]
    s_waitcnt lgkmcnt(2)
    ds_read_b128 a[152:155], v40 offset:55296
    v_mfma_f32_16x16x32_bf16 v[136:139], a[48:51], a[184:187], v[136:139]
    buffer_store_dwordx4 v[92:95], v25, s[16:19], s67 offen sc1
    v_mfma_f32_16x16x32_bf16 v[136:139], a[52:55], a[188:191], v[136:139]
    s_mov_b32 s67, 129024
    v_cvt_pk_bf16_f32 v88, v228, v229
    v_mul_f32 v196, v196, v108
    v_mfma_f32_16x16x32_bf16 v[136:139], a[232:235], a[104:107], v[136:139]
    ds_write_b32 v28, v88 offset:0
    v_mul_f32 v197, v197, v109
    v_mfma_f32_16x16x32_bf16 v[136:139], a[236:239], a[108:111], v[136:139]
    v_mul_f32 v198, v198, v110
    v_mul_f32 v199, v199, v111
    v_mfma_f32_16x16x32_bf16 v[136:139], a[160:163], a[128:131], v[136:139]
    v_cvt_pk_bf16_f32 v49, v196, v133
    v_cvt_pk_bf16_f32 v50, v165, v197
    v_mfma_f32_16x16x32_bf16 v[136:139], a[164:167], a[132:135], v[136:139]
    ds_read_b128 a[156:159], v41 offset:55296
    v_cvt_pk_bf16_f32 v52, v198, v135
    v_mfma_f32_16x16x32_bf16 v[136:139], a[88:91], a[216:219], v[136:139]
    ds_write_b64 v26, v[48:49] offset:0
    v_cvt_pk_bf16_f32 v53, v167, v199
    v_mfma_f32_16x16x32_bf16 v[136:139], a[92:95], a[220:223], v[136:139]
    ds_write_b64 v26, v[50:51] offset:8
    v_mfma_f32_16x16x32_bf16 v[168:171], a[40:43], a[184:187], v[168:171]
    ds_write_b64 v26, v[52:53] offset:16
    v_mfma_f32_16x16x32_bf16 v[168:171], a[44:47], a[188:191], v[168:171]
    ds_read_b128 a[64:67], v42 offset:6144
    v_mfma_f32_16x16x32_bf16 v[168:171], a[80:83], a[104:107], v[168:171]
    ds_write_b64 v29, v[234:235] offset:33024
    v_mfma_f32_16x16x32_bf16 v[168:171], a[84:87], a[108:111], v[168:171]
    ds_read_b128 a[68:71], v43 offset:6144
    v_mul_f32 v136, v136, v100
    v_mfma_f32_16x16x32_bf16 v[168:171], a[0:3], a[128:131], v[168:171]
    ds_read_b128 a[24:27], v42 offset:22528
    v_mul_f32 v137, v137, v101
    v_mfma_f32_16x16x32_bf16 v[168:171], a[4:7], a[132:135], v[168:171]
    v_mul_f32 v138, v138, v102
    v_mul_f32 v139, v139, v103
    v_mfma_f32_16x16x32_bf16 v[168:171], a[248:251], a[216:219], v[168:171]
    ds_read_b128 a[28:31], v43 offset:22528
    v_mfma_f32_16x16x32_bf16 v[168:171], a[252:255], a[220:223], v[168:171]
    s_waitcnt lgkmcnt(3)
    s_barrier
    v_mfma_f32_16x16x32_bf16 v[200:203], a[8:11], a[184:187], v[200:203]
    ds_read_b128 v[68:71], v24 offset:0
    ds_read_b64 v[72:73], v30 offset:33024
    v_mfma_f32_16x16x32_bf16 v[200:203], a[12:15], a[188:191], v[200:203]
    ds_read_b128 v[76:79], v24 offset:928
    v_mfma_f32_16x16x32_bf16 v[200:203], a[120:123], a[104:107], v[200:203]
    ds_read_b128 a[96:99], v40 offset:40960
    v_mfma_f32_16x16x32_bf16 v[200:203], a[124:127], a[108:111], v[200:203]
    v_mul_f32 v168, v168, v104
    v_cvt_pk_bf16_f32 v80, v136, v168
    v_mfma_f32_16x16x32_bf16 v[200:203], a[224:227], a[128:131], v[200:203]
    v_mul_f32 v169, v169, v105
    v_mul_f32 v170, v170, v106
    v_mfma_f32_16x16x32_bf16 v[200:203], a[228:231], a[132:135], v[200:203]
    v_cvt_pk_bf16_f32 v83, v138, v170
    v_mul_f32 v171, v171, v107
    v_mfma_f32_16x16x32_bf16 v[200:203], a[16:19], a[216:219], v[200:203]
    s_waitcnt lgkmcnt(2)
    ds_read_b128 a[100:103], v41 offset:40960
    v_mfma_f32_16x16x32_bf16 v[200:203], a[20:23], a[220:223], v[200:203]
    buffer_store_dwordx4 v[68:71], v25, s[16:19], s66 offen sc1
    v_mfma_f32_16x16x32_bf16 v[236:239], a[168:171], a[194:197], v[236:239]
    s_mov_b32 s66, 229376
    v_add_f32 v232, v232, v72
    v_mul_f32 v232, v232, v96
    v_mfma_f32_16x16x32_bf16 v[236:239], a[172:175], a[154:157], v[236:239]
    v_add_f32 v233, v233, v73
    v_mul_f32 v233, v233, v97
    v_mfma_f32_16x16x32_bf16 v[236:239], a[72:75], a[66:69], v[236:239]
    s_waitcnt lgkmcnt(2)
    ds_read_b128 a[32:35], v40 offset:57344
    v_mfma_f32_16x16x32_bf16 v[236:239], a[76:79], a[26:29], v[236:239]
    buffer_store_dwordx4 v[76:79], v25, s[16:19], s67 offen sc1
    v_mfma_f32_16x16x32_bf16 v[140:143], a[48:51], a[192:195], v[140:143]
    s_mov_b32 s67, 243712
    v_cvt_pk_bf16_f32 v72, v232, v233
    v_mul_f32 v200, v200, v108
    v_mfma_f32_16x16x32_bf16 v[140:143], a[52:55], a[196:199], v[140:143]
    ds_write_b32 v28, v72 offset:7424
    v_mul_f32 v201, v201, v109
    v_mfma_f32_16x16x32_bf16 v[140:143], a[232:235], a[152:155], v[140:143]
    v_mul_f32 v202, v202, v110
    v_mul_f32 v203, v203, v111
    v_mfma_f32_16x16x32_bf16 v[140:143], a[236:239], a[156:159], v[140:143]
    v_cvt_pk_bf16_f32 v81, v200, v137
    v_cvt_pk_bf16_f32 v82, v169, v201
    v_mfma_f32_16x16x32_bf16 v[140:143], a[160:163], a[64:67], v[140:143]
    ds_write_b64 v26, v[80:81] offset:7424
    v_cvt_pk_bf16_f32 v64, v202, v139
    v_mfma_f32_16x16x32_bf16 v[140:143], a[164:167], a[68:71], v[140:143]
    ds_read_b128 a[36:39], v41 offset:57344
    v_cvt_pk_bf16_f32 v65, v171, v203
    v_mfma_f32_16x16x32_bf16 v[140:143], a[88:91], a[24:27], v[140:143]
    ds_write_b64 v26, v[82:83] offset:7432
    v_mfma_f32_16x16x32_bf16 v[140:143], a[92:95], a[28:31], v[140:143]
    ds_write_b64 v26, v[64:65] offset:7440
    v_mfma_f32_16x16x32_bf16 v[172:175], a[40:43], a[192:195], v[172:175]
    ds_write_b64 v29, v[238:239] offset:0
    v_mfma_f32_16x16x32_bf16 v[172:175], a[44:47], a[196:199], v[172:175]
    ds_read_b128 a[176:179], v42 offset:8192
    v_mfma_f32_16x16x32_bf16 v[172:175], a[80:83], a[152:155], v[172:175]
    ds_read_b128 a[180:183], v43 offset:8192
    v_mfma_f32_16x16x32_bf16 v[172:175], a[84:87], a[156:159], v[172:175]
    ds_read_b128 a[184:187], v42 offset:24576
    v_mul_f32 v140, v140, v100
    v_mfma_f32_16x16x32_bf16 v[172:175], a[0:3], a[64:67], v[172:175]
    v_mul_f32 v141, v141, v101
    v_mul_f32 v142, v142, v102
    v_mfma_f32_16x16x32_bf16 v[172:175], a[4:7], a[68:71], v[172:175]
    s_waitcnt lgkmcnt(3)
    s_barrier
    v_mfma_f32_16x16x32_bf16 v[172:175], a[248:251], a[24:27], v[172:175]
    ds_read_b128 v[84:87], v24 offset:7424
    ds_read_b64 v[116:117], v30 offset:0
    v_mfma_f32_16x16x32_bf16 v[172:175], a[252:255], a[28:31], v[172:175]
    ds_read_b128 a[188:191], v43 offset:24576
    v_mul_f32 v143, v143, v103
    v_mfma_f32_16x16x32_bf16 v[204:207], a[8:11], a[192:195], v[204:207]
    ds_read_b128 v[120:123], v24 offset:8352
    v_mfma_f32_16x16x32_bf16 v[204:207], a[12:15], a[196:199], v[204:207]
    v_mfma_f32_16x16x32_bf16 v[204:207], a[120:123], a[152:155], v[204:207]
    ds_read_b128 a[104:107], v40 offset:43008
    v_mfma_f32_16x16x32_bf16 v[204:207], a[124:127], a[156:159], v[204:207]
    v_mul_f32 v172, v172, v104
    v_cvt_pk_bf16_f32 v112, v140, v172
    v_mfma_f32_16x16x32_bf16 v[204:207], a[224:227], a[64:67], v[204:207]
    s_waitcnt lgkmcnt(3)
    v_mul_f32 v173, v173, v105
    v_mfma_f32_16x16x32_bf16 v[204:207], a[228:231], a[68:71], v[204:207]
    buffer_store_dwordx4 v[84:87], v25, s[16:19], s66 offen sc1
    v_mfma_f32_16x16x32_bf16 v[204:207], a[16:19], a[24:27], v[204:207]
    s_mov_b32 s66, 344064
    v_add_f32 v236, v236, v116
    v_mul_f32 v236, v236, v96
    v_mfma_f32_16x16x32_bf16 v[204:207], a[20:23], a[28:31], v[204:207]
    v_add_f32 v237, v237, v117
    v_mul_f32 v237, v237, v97
    v_mfma_f32_16x16x32_bf16 v[240:243], a[168:171], a[98:101], v[240:243]
    s_waitcnt lgkmcnt(1)
    ds_read_b128 a[108:111], v41 offset:43008
    v_mfma_f32_16x16x32_bf16 v[240:243], a[172:175], a[34:37], v[240:243]
    buffer_store_dwordx4 v[120:123], v25, s[16:19], s67 offen sc1
    v_mfma_f32_16x16x32_bf16 v[240:243], a[72:75], a[178:181], v[240:243]
    s_mov_b32 s67, 358400
    v_cvt_pk_bf16_f32 v116, v236, v237
    v_mul_f32 v174, v174, v106
    v_mfma_f32_16x16x32_bf16 v[240:243], a[76:79], a[186:189], v[240:243]
    ds_write_b32 v28, v116 offset:14848
    v_cvt_pk_bf16_f32 v115, v142, v174
    v_mfma_f32_16x16x32_bf16 v[144:147], a[48:51], a[96:99], v[144:147]
    v_mul_f32 v175, v175, v107
    v_mul_f32 v204, v204, v108
    v_mfma_f32_16x16x32_bf16 v[144:147], a[52:55], a[100:103], v[144:147]
    v_mul_f32 v205, v205, v109
    v_mul_f32 v206, v206, v110
    v_mfma_f32_16x16x32_bf16 v[144:147], a[232:235], a[32:35], v[144:147]
    ds_read_b128 a[128:131], v40 offset:59392
    v_mul_f32 v207, v207, v111
    v_mfma_f32_16x16x32_bf16 v[144:147], a[236:239], a[36:39], v[144:147]
    v_cvt_pk_bf16_f32 v113, v204, v141
    v_cvt_pk_bf16_f32 v114, v173, v205
    v_mfma_f32_16x16x32_bf16 v[144:147], a[160:163], a[176:179], v[144:147]
    ds_write_b64 v26, v[112:113] offset:14848
    v_cvt_pk_bf16_f32 v124, v206, v143
    v_mfma_f32_16x16x32_bf16 v[144:147], a[164:167], a[180:183], v[144:147]
    ds_read_b128 a[132:135], v41 offset:59392
    v_cvt_pk_bf16_f32 v125, v175, v207
    v_mfma_f32_16x16x32_bf16 v[144:147], a[88:91], a[184:187], v[144:147]
    ds_write_b64 v26, v[114:115] offset:14856
    v_mfma_f32_16x16x32_bf16 v[144:147], a[92:95], a[188:191], v[144:147]
    ds_write_b64 v26, v[124:125] offset:14864
    v_mfma_f32_16x16x32_bf16 v[176:179], a[40:43], a[96:99], v[176:179]
    ds_write_b64 v29, v[242:243] offset:2048
    v_mfma_f32_16x16x32_bf16 v[176:179], a[44:47], a[100:103], v[176:179]
    ds_read_b128 a[216:219], v42 offset:10240
    v_mfma_f32_16x16x32_bf16 v[176:179], a[80:83], a[32:35], v[176:179]
    ds_read_b128 a[220:223], v43 offset:10240
    v_mfma_f32_16x16x32_bf16 v[176:179], a[84:87], a[36:39], v[176:179]
    ds_read_b128 a[192:195], v42 offset:26624
    v_mul_f32 v144, v144, v100
    v_mfma_f32_16x16x32_bf16 v[176:179], a[0:3], a[176:179], v[176:179]
    v_mul_f32 v145, v145, v101
    v_mul_f32 v146, v146, v102
    v_mfma_f32_16x16x32_bf16 v[176:179], a[4:7], a[180:183], v[176:179]
    s_waitcnt lgkmcnt(3)
    s_barrier
    v_mfma_f32_16x16x32_bf16 v[176:179], a[248:251], a[184:187], v[176:179]
    ds_read_b128 v[92:95], v24 offset:14848
    ds_read_b64 v[88:89], v30 offset:2048
    v_mfma_f32_16x16x32_bf16 v[176:179], a[252:255], a[188:191], v[176:179]
    ds_read_b128 a[196:199], v43 offset:26624
    v_mul_f32 v147, v147, v103
    v_mfma_f32_16x16x32_bf16 v[208:211], a[8:11], a[96:99], v[208:211]
    ds_read_b128 v[48:51], v24 offset:15776
    v_mfma_f32_16x16x32_bf16 v[208:211], a[12:15], a[100:103], v[208:211]
    v_mfma_f32_16x16x32_bf16 v[208:211], a[120:123], a[32:35], v[208:211]
    ds_read_b128 a[152:155], v40 offset:12288
    v_mfma_f32_16x16x32_bf16 v[208:211], a[124:127], a[36:39], v[208:211]
    v_mul_f32 v176, v176, v104
    v_cvt_pk_bf16_f32 v52, v144, v176
    v_mfma_f32_16x16x32_bf16 v[208:211], a[224:227], a[176:179], v[208:211]
    s_waitcnt lgkmcnt(3)
    v_mul_f32 v177, v177, v105
    v_mfma_f32_16x16x32_bf16 v[208:211], a[228:231], a[180:183], v[208:211]
    buffer_store_dwordx4 v[92:95], v25, s[16:19], s66 offen sc1
    v_mfma_f32_16x16x32_bf16 v[208:211], a[16:19], a[184:187], v[208:211]
    s_mov_b32 s66, 458752
    v_add_f32 v240, v240, v88
    v_mul_f32 v240, v240, v96
    v_mfma_f32_16x16x32_bf16 v[208:211], a[20:23], a[188:191], v[208:211]
    v_add_f32 v241, v241, v89
    v_mul_f32 v241, v241, v97
    v_mfma_f32_16x16x32_bf16 v[244:247], a[168:171], a[106:109], v[244:247]
    s_waitcnt lgkmcnt(1)
    ds_read_b128 a[156:159], v41 offset:12288
    v_mfma_f32_16x16x32_bf16 v[244:247], a[172:175], a[130:133], v[244:247]
    buffer_store_dwordx4 v[48:51], v25, s[16:19], s67 offen sc1
    v_mfma_f32_16x16x32_bf16 v[244:247], a[72:75], a[218:221], v[244:247]
    s_mov_b32 s67, 473088
    v_cvt_pk_bf16_f32 v88, v240, v241
    v_mul_f32 v178, v178, v106
    v_mfma_f32_16x16x32_bf16 v[244:247], a[76:79], a[194:197], v[244:247]
    ds_write_b32 v28, v88 offset:22272
    v_cvt_pk_bf16_f32 v55, v146, v178
    v_mfma_f32_16x16x32_bf16 v[148:151], a[48:51], a[104:107], v[148:151]
    v_mul_f32 v179, v179, v107
    v_mul_f32 v208, v208, v108
    v_mfma_f32_16x16x32_bf16 v[148:151], a[52:55], a[108:111], v[148:151]
    v_mul_f32 v209, v209, v109
    v_mul_f32 v210, v210, v110
    v_mfma_f32_16x16x32_bf16 v[148:151], a[232:235], a[128:131], v[148:151]
    ds_read_b128 a[64:67], v40 offset:28672
    v_mul_f32 v211, v211, v111
    v_mfma_f32_16x16x32_bf16 v[148:151], a[236:239], a[132:135], v[148:151]
    v_cvt_pk_bf16_f32 v53, v208, v145
    v_cvt_pk_bf16_f32 v54, v177, v209
    v_mfma_f32_16x16x32_bf16 v[148:151], a[160:163], a[216:219], v[148:151]
    ds_write_b64 v26, v[52:53] offset:22272
    v_cvt_pk_bf16_f32 v68, v210, v147
    v_mfma_f32_16x16x32_bf16 v[148:151], a[164:167], a[220:223], v[148:151]
    ds_read_b128 a[68:71], v41 offset:28672
    v_cvt_pk_bf16_f32 v69, v179, v211
    v_mfma_f32_16x16x32_bf16 v[148:151], a[88:91], a[192:195], v[148:151]
    ds_write_b64 v26, v[54:55] offset:22280
    v_mfma_f32_16x16x32_bf16 v[148:151], a[92:95], a[196:199], v[148:151]
    ds_write_b64 v26, v[68:69] offset:22288
    v_mfma_f32_16x16x32_bf16 v[180:183], a[40:43], a[104:107], v[180:183]
    ds_write_b64 v29, v[246:247] offset:4096
    v_mfma_f32_16x16x32_bf16 v[180:183], a[44:47], a[108:111], v[180:183]
    ds_read_b128 a[24:27], v40 offset:45056
    v_mfma_f32_16x16x32_bf16 v[180:183], a[80:83], a[128:131], v[180:183]
    ds_read_b128 a[28:31], v41 offset:45056
    v_mfma_f32_16x16x32_bf16 v[180:183], a[84:87], a[132:135], v[180:183]
    ds_read_b128 a[96:99], v40 offset:61440
    v_mul_f32 v148, v148, v100
    v_mfma_f32_16x16x32_bf16 v[180:183], a[0:3], a[216:219], v[180:183]
    v_mul_f32 v149, v149, v101
    v_mul_f32 v150, v150, v102
    v_mfma_f32_16x16x32_bf16 v[180:183], a[4:7], a[220:223], v[180:183]
    s_waitcnt lgkmcnt(3)
    s_barrier
    v_mfma_f32_16x16x32_bf16 v[180:183], a[248:251], a[192:195], v[180:183]
    ds_read_b128 v[76:79], v24 offset:22272
    ds_read_b64 v[72:73], v30 offset:4096
    v_mfma_f32_16x16x32_bf16 v[180:183], a[252:255], a[196:199], v[180:183]
    ds_read_b128 a[100:103], v41 offset:61440
    v_mul_f32 v151, v151, v103
    v_mfma_f32_16x16x32_bf16 v[212:215], a[8:11], a[104:107], v[212:215]
    ds_read_b128 a[32:35], v42 offset:12288
    v_mfma_f32_16x16x32_bf16 v[212:215], a[12:15], a[108:111], v[212:215]
    ds_read_b128 a[36:39], v43 offset:12288
    v_mfma_f32_16x16x32_bf16 v[212:215], a[120:123], a[128:131], v[212:215]
    ds_read_b128 a[176:179], v42 offset:28672
    v_mfma_f32_16x16x32_bf16 v[212:215], a[124:127], a[132:135], v[212:215]
    v_mul_f32 v180, v180, v104
    v_cvt_pk_bf16_f32 v80, v148, v180
    v_mfma_f32_16x16x32_bf16 v[212:215], a[224:227], a[216:219], v[212:215]
    s_waitcnt lgkmcnt(4)
    ds_read_b128 a[180:183], v43 offset:28672
    v_mfma_f32_16x16x32_bf16 v[212:215], a[228:231], a[220:223], v[212:215]
    buffer_store_dwordx4 v[76:79], v25, s[16:19], s66 offen sc1
    v_mfma_f32_16x16x32_bf16 v[212:215], a[16:19], a[192:195], v[212:215]
    s_mov_b32 s66, 573440
    ds_read_b128 v[64:67], v24 offset:23200
    v_add_f32 v244, v244, v72
    v_mfma_f32_16x16x32_bf16 v[212:215], a[20:23], a[196:199], v[212:215]
    v_mul_f32 v244, v244, v96
    v_add_f32 v245, v245, v73
    v_mfma_f32_16x16x32_bf16 v[248:251], a[112:115], a[154:157], v[248:251]
    v_mul_f32 v245, v245, v97
    v_cvt_pk_bf16_f32 v72, v244, v245
    v_mfma_f32_16x16x32_bf16 v[248:251], a[116:119], a[66:69], v[248:251]
    ds_write_b32 v28, v72 offset:29696
    v_mul_f32 v181, v181, v105
    v_mfma_f32_16x16x32_bf16 v[248:251], a[168:171], a[26:29], v[248:251]
    s_waitcnt lgkmcnt(4)
    v_mul_f32 v182, v182, v106
    v_cvt_pk_bf16_f32 v83, v150, v182
    v_mfma_f32_16x16x32_bf16 v[248:251], a[172:175], a[98:101], v[248:251]
    v_mul_f32 v183, v183, v107
    v_mul_f32 v212, v212, v108
    v_mfma_f32_16x16x32_bf16 v[248:251], a[72:75], a[34:37], v[248:251]
    s_waitcnt lgkmcnt(1)
    v_mul_f32 v213, v213, v109
    v_mfma_f32_16x16x32_bf16 v[248:251], a[76:79], a[178:181], v[248:251]
    buffer_store_dwordx4 v[64:67], v25, s[16:19], s67 offen sc1
    v_mfma_f32_16x16x32_bf16 v[152:155], a[136:139], a[152:155], v[152:155]
    s_mov_b32 s67, 587776
    v_mul_f32 v214, v214, v110
    v_mul_f32 v215, v215, v111
    v_mfma_f32_16x16x32_bf16 v[152:155], a[140:143], a[156:159], v[152:155]
    v_cvt_pk_bf16_f32 v81, v212, v149
    v_cvt_pk_bf16_f32 v82, v181, v213
    v_mfma_f32_16x16x32_bf16 v[152:155], a[200:203], a[64:67], v[152:155]
    ds_write_b64 v26, v[80:81] offset:29696
    v_cvt_pk_bf16_f32 v84, v214, v151
    v_mfma_f32_16x16x32_bf16 v[152:155], a[204:207], a[68:71], v[152:155]
    ds_write_b64 v26, v[82:83] offset:29704
    v_cvt_pk_bf16_f32 v85, v183, v215
    v_mfma_f32_16x16x32_bf16 v[152:155], a[48:51], a[24:27], v[152:155]
    ds_write_b64 v26, v[84:85] offset:29712
    v_mfma_f32_16x16x32_bf16 v[152:155], a[52:55], a[28:31], v[152:155]
    ds_write_b64 v29, v[250:251] offset:6144
    v_mfma_f32_16x16x32_bf16 v[152:155], a[232:235], a[96:99], v[152:155]
    ds_read_b128 a[184:187], v40 offset:14336
    v_mfma_f32_16x16x32_bf16 v[152:155], a[236:239], a[100:103], v[152:155]
    ds_read_b128 a[188:191], v41 offset:14336
    v_mfma_f32_16x16x32_bf16 v[152:155], a[160:163], a[32:35], v[152:155]
    v_mfma_f32_16x16x32_bf16 v[152:155], a[164:167], a[36:39], v[152:155]
    ds_read_b128 a[104:107], v40 offset:30720
    v_mfma_f32_16x16x32_bf16 v[152:155], a[88:91], a[176:179], v[152:155]
    s_waitcnt lgkmcnt(3)
    s_barrier
    v_mfma_f32_16x16x32_bf16 v[152:155], a[92:95], a[180:183], v[152:155]
    ds_read_b128 v[120:123], v24 offset:29696
    ds_read_b64 v[116:117], v30 offset:6144
    v_mfma_f32_16x16x32_bf16 v[184:187], a[144:147], a[152:155], v[184:187]
    ds_read_b128 v[112:115], v24 offset:30624
    v_mfma_f32_16x16x32_bf16 v[184:187], a[148:151], a[156:159], v[184:187]
    ds_read_b128 a[108:111], v41 offset:30720
    v_mfma_f32_16x16x32_bf16 v[184:187], a[208:211], a[64:67], v[184:187]
    v_mfma_f32_16x16x32_bf16 v[184:187], a[212:215], a[68:71], v[184:187]
    v_mul_f32 v152, v152, v100
    v_mul_f32 v153, v153, v101
    v_mfma_f32_16x16x32_bf16 v[184:187], a[40:43], a[24:27], v[184:187]
    v_mul_f32 v154, v154, v102
    v_mul_f32 v155, v155, v103
    v_mfma_f32_16x16x32_bf16 v[184:187], a[44:47], a[28:31], v[184:187]
    s_waitcnt lgkmcnt(2)
    ds_read_b128 a[128:131], v40 offset:47104
    v_mfma_f32_16x16x32_bf16 v[184:187], a[80:83], a[96:99], v[184:187]
    buffer_store_dwordx4 v[120:123], v25, s[16:19], s66 offen sc1
    v_mfma_f32_16x16x32_bf16 v[184:187], a[84:87], a[100:103], v[184:187]
    s_mov_b32 s66, 688128
    v_add_f32 v248, v248, v116
    v_mul_f32 v248, v248, v96
    v_mfma_f32_16x16x32_bf16 v[184:187], a[0:3], a[32:35], v[184:187]
    v_add_f32 v249, v249, v117
    v_mul_f32 v249, v249, v97
    v_mfma_f32_16x16x32_bf16 v[184:187], a[4:7], a[36:39], v[184:187]
    s_waitcnt lgkmcnt(2)
    ds_read_b128 a[132:135], v41 offset:47104
    v_mfma_f32_16x16x32_bf16 v[184:187], a[248:251], a[176:179], v[184:187]
    buffer_store_dwordx4 v[112:115], v25, s[16:19], s67 offen sc1
    v_mfma_f32_16x16x32_bf16 v[184:187], a[252:255], a[180:183], v[184:187]
    s_mov_b32 s67, 702464
    ds_read_b128 a[216:219], v40 offset:63488
    v_cvt_pk_bf16_f32 v116, v248, v249
    v_mfma_f32_16x16x32_bf16 v[216:219], a[56:59], a[152:155], v[216:219]
    ds_write_b32 v28, v116 offset:37120
    v_mfma_f32_16x16x32_bf16 v[216:219], a[60:63], a[156:159], v[216:219]
    v_mfma_f32_16x16x32_bf16 v[216:219], a[240:243], a[64:67], v[216:219]
    ds_read_b128 a[220:223], v41 offset:63488
    v_mfma_f32_16x16x32_bf16 v[216:219], a[244:247], a[68:71], v[216:219]
    v_mul_f32 v184, v184, v104
    v_cvt_pk_bf16_f32 v124, v152, v184
    v_mfma_f32_16x16x32_bf16 v[216:219], a[8:11], a[24:27], v[216:219]
    ds_read_b128 a[192:195], v42 offset:14336
    v_mul_f32 v185, v185, v105
    v_mfma_f32_16x16x32_bf16 v[216:219], a[12:15], a[28:31], v[216:219]
    ds_read_b128 a[196:199], v43 offset:14336
    v_mul_f32 v186, v186, v106
    v_mfma_f32_16x16x32_bf16 v[216:219], a[120:123], a[96:99], v[216:219]
    ds_read_b128 a[152:155], v42 offset:30720
    v_cvt_pk_bf16_f32 v127, v154, v186
    v_mfma_f32_16x16x32_bf16 v[216:219], a[124:127], a[100:103], v[216:219]
    ds_read_b128 a[156:159], v43 offset:30720
    v_mul_f32 v187, v187, v107
    v_mfma_f32_16x16x32_bf16 v[216:219], a[224:227], a[32:35], v[216:219]
    v_mfma_f32_16x16x32_bf16 v[216:219], a[228:231], a[36:39], v[216:219]
    v_mfma_f32_16x16x32_bf16 v[216:219], a[16:19], a[176:179], v[216:219]
    v_mfma_f32_16x16x32_bf16 v[216:219], a[20:23], a[180:183], v[216:219]
    v_mfma_f32_16x16x32_bf16 v[252:255], a[112:115], a[186:189], v[252:255]
    s_waitcnt lgkmcnt(4)
    v_mfma_f32_16x16x32_bf16 v[252:255], a[116:119], a[106:109], v[252:255]
    v_mfma_f32_16x16x32_bf16 v[252:255], a[168:171], a[130:133], v[252:255]
    v_mfma_f32_16x16x32_bf16 v[252:255], a[172:175], a[218:221], v[252:255]
    s_waitcnt lgkmcnt(1)
    s_nop 1
    v_mul_f32 v216, v216, v108
    v_mul_f32 v217, v217, v109
    v_mfma_f32_16x16x32_bf16 v[252:255], a[72:75], a[194:197], v[252:255]
    s_waitcnt lgkmcnt(0)
    v_mul_f32 v218, v218, v110
    v_mul_f32 v219, v219, v111
    v_mfma_f32_16x16x32_bf16 v[252:255], a[76:79], a[154:157], v[252:255]
    v_cvt_pk_bf16_f32 v125, v216, v153
    v_cvt_pk_bf16_f32 v126, v185, v217
    v_mfma_f32_16x16x32_bf16 v[156:159], a[136:139], a[184:187], v[156:159]
    ds_write_b64 v26, v[124:125] offset:37120
    v_cvt_pk_bf16_f32 v92, v218, v155
    v_mfma_f32_16x16x32_bf16 v[156:159], a[140:143], a[188:191], v[156:159]
    ds_write_b64 v26, v[126:127] offset:37128
    v_cvt_pk_bf16_f32 v93, v187, v219
    v_mfma_f32_16x16x32_bf16 v[156:159], a[200:203], a[104:107], v[156:159]
    ds_write_b64 v26, v[92:93] offset:37136
    v_mfma_f32_16x16x32_bf16 v[156:159], a[204:207], a[108:111], v[156:159]
    ds_write_b64 v29, v[254:255] offset:8192
    v_mfma_f32_16x16x32_bf16 v[156:159], a[48:51], a[128:131], v[156:159]
    v_mfma_f32_16x16x32_bf16 v[156:159], a[52:55], a[132:135], v[156:159]
    v_mfma_f32_16x16x32_bf16 v[156:159], a[232:235], a[216:219], v[156:159]
    v_mfma_f32_16x16x32_bf16 v[156:159], a[236:239], a[220:223], v[156:159]
    v_mfma_f32_16x16x32_bf16 v[156:159], a[160:163], a[192:195], v[156:159]
    s_waitcnt lgkmcnt(0)
    s_barrier
    v_mfma_f32_16x16x32_bf16 v[156:159], a[164:167], a[196:199], v[156:159]
    ds_read_b128 v[48:51], v24 offset:37120
    ds_read_b64 v[88:89], v30 offset:8192
    v_mfma_f32_16x16x32_bf16 v[156:159], a[88:91], a[152:155], v[156:159]
    ds_read_b128 v[52:55], v24 offset:38048
    v_mfma_f32_16x16x32_bf16 v[156:159], a[92:95], a[156:159], v[156:159]
    v_mfma_f32_16x16x32_bf16 v[188:191], a[144:147], a[184:187], v[188:191]
    v_mfma_f32_16x16x32_bf16 v[188:191], a[148:151], a[188:191], v[188:191]
    v_mfma_f32_16x16x32_bf16 v[188:191], a[208:211], a[104:107], v[188:191]
    s_waitcnt vmcnt(12)
    v_xor_b32 v8, 15, v8
    v_or_b32 v8, v8, v0
    v_mfma_f32_16x16x32_bf16 v[188:191], a[212:215], a[108:111], v[188:191]
    s_waitcnt lgkmcnt(1)
    v_mul_f32 v156, v156, v100
    v_mfma_f32_16x16x32_bf16 v[188:191], a[40:43], a[128:131], v[188:191]
    buffer_store_dwordx4 v[48:51], v25, s[16:19], s66 offen sc1
    v_mfma_f32_16x16x32_bf16 v[188:191], a[44:47], a[132:135], v[188:191]
    s_mov_b32 s66, 802816
    v_add_f32 v252, v252, v88
    v_mul_f32 v252, v252, v96
    v_mfma_f32_16x16x32_bf16 v[188:191], a[80:83], a[216:219], v[188:191]
    v_add_f32 v253, v253, v89
    v_mul_f32 v253, v253, v97
    v_mfma_f32_16x16x32_bf16 v[188:191], a[84:87], a[220:223], v[188:191]
    s_waitcnt lgkmcnt(0)
    v_cvt_pk_bf16_f32 v88, v252, v253
    v_mfma_f32_16x16x32_bf16 v[188:191], a[0:3], a[192:195], v[188:191]
    buffer_store_dwordx4 v[52:55], v25, s[16:19], s67 offen sc1
    v_mfma_f32_16x16x32_bf16 v[188:191], a[4:7], a[196:199], v[188:191]
    s_mov_b32 s67, 817152
    ds_write_b32 v28, v88 offset:44544
    v_mul_f32 v157, v157, v101
    v_mfma_f32_16x16x32_bf16 v[188:191], a[248:251], a[152:155], v[188:191]
    v_mul_f32 v158, v158, v102
    v_mul_f32 v159, v159, v103
    v_mfma_f32_16x16x32_bf16 v[188:191], a[252:255], a[156:159], v[188:191]
    v_min_u32 v8, 1, v8
    v_lshlrev_b32 v8, 30, v8
    v_mfma_f32_16x16x32_bf16 v[220:223], a[56:59], a[184:187], v[220:223]
    v_mov_b32 v9, s76
    v_mfma_f32_16x16x32_bf16 v[220:223], a[60:63], a[188:191], v[220:223]
    buffer_store_dword v9, v8, s[12:15], s78 offen sc1
    v_mfma_f32_16x16x32_bf16 v[220:223], a[240:243], a[104:107], v[220:223]
    v_mfma_f32_16x16x32_bf16 v[220:223], a[244:247], a[108:111], v[220:223]
    v_mul_f32 v188, v188, v104
    v_cvt_pk_bf16_f32 v68, v156, v188
    v_mfma_f32_16x16x32_bf16 v[220:223], a[8:11], a[128:131], v[220:223]
    v_mul_f32 v189, v189, v105
    v_mul_f32 v190, v190, v106
    v_mfma_f32_16x16x32_bf16 v[220:223], a[12:15], a[132:135], v[220:223]
    v_cvt_pk_bf16_f32 v71, v158, v190
    v_mul_f32 v191, v191, v107
    v_mfma_f32_16x16x32_bf16 v[220:223], a[120:123], a[216:219], v[220:223]
    v_mfma_f32_16x16x32_bf16 v[220:223], a[124:127], a[220:223], v[220:223]
    v_mfma_f32_16x16x32_bf16 v[220:223], a[224:227], a[192:195], v[220:223]
    v_mfma_f32_16x16x32_bf16 v[220:223], a[228:231], a[196:199], v[220:223]
    v_mfma_f32_16x16x32_bf16 v[220:223], a[16:19], a[152:155], v[220:223]
    v_mfma_f32_16x16x32_bf16 v[220:223], a[20:23], a[156:159], v[220:223]
    s_nop 7
    v_mul_f32 v220, v220, v108
    v_mul_f32 v221, v221, v109
    v_mul_f32 v222, v222, v110
    v_mul_f32 v223, v223, v111
    v_cvt_pk_bf16_f32 v69, v220, v157
    v_cvt_pk_bf16_f32 v70, v189, v221
    v_cvt_pk_bf16_f32 v76, v222, v159
    v_cvt_pk_bf16_f32 v77, v191, v223
    ds_write_b64 v26, v[68:69] offset:44544
    ds_write_b64 v26, v[70:71] offset:44552
    ds_write_b64 v26, v[76:77] offset:44560
    s_waitcnt lgkmcnt(0)
    s_barrier
    ds_read_b128 v[72:75], v24 offset:44544
    ds_read_b128 v[64:67], v24 offset:45472
    s_waitcnt lgkmcnt(1)
    buffer_store_dwordx4 v[72:75], v25, s[16:19], s66 offen sc1
    s_waitcnt lgkmcnt(0)
    buffer_store_dwordx4 v[64:67], v25, s[16:19], s67 offen sc1
L_end:
    s_endpgm
L_help:
    s_mov_b32 s53, s61
    s_mov_b32 s54, s62
    s_mul_i32 s61, s22, 1835008
    s_add_u32 s61, s61, s79
    s_lshl_b32 s62, s22, 14
    s_add_u32 s62, s62, s68
    s_mov_b32 s22, 0
L_help_row:
    v_mov_b32 v21, v19
    s_xor_b32 s23, s22, s58
    s_bitcmp0_b32 s23, 2
    s_cbranch_scc1 L_help_same
    v_add_u32 v12, 57344, v19
    v_subrev_u32 v13, 57344, v19
    v_min_u32 v21, v12, v13
L_help_same:
    v_mov_b32 v8, 0
    v_mov_b32 v9, 0
    v_mov_b32 v10, 0
    v_mov_b32 v11, s47
    s_mov_b32 s23, 0
L_help_e:
    v_mov_b32 v15, 0
    buffer_load_dwordx3 v[12:14], v18, s[4:7], s61 offen nt
    s_cmp_ge_u32 s23, 16
    s_cbranch_scc1 L_help_own
    buffer_load_dword v15, v21, s[4:7], s61 offen nt
L_help_own:
    s_waitcnt vmcnt(0)
    v_lshl_or_b32 v8, v12, s23, v8
    v_lshl_or_b32 v9, v13, s23, v9
    v_lshl_or_b32 v10, v14, s23, v10
    v_lshl_or_b32 v11, v15, s23, v11
    s_add_u32 s61, s61, 14336
    s_add_u32 s23, s23, 4
    s_cmp_lt_u32 s23, 32
    s_cbranch_scc1 L_help_e
    buffer_store_dwordx4 v[8:11], v20, s[12:15], s62 offen sc1
    s_add_u32 s62, s62, 1024
    s_waitcnt vmcnt(0)
    s_add_u32 s22, s22, 1
    s_cmp_lt_u32 s22, 16
    s_cbranch_scc1 L_help_row
    s_mov_b32 s61, s53
    s_mov_b32 s62, s54
    s_setpc_b64 s[20:21]
L_code_end:

.section .rodata,"a"
.p2align 6
.amdhsa_kernel standalone__normalfloat_lut_af4__prompt_kernel
  .amdhsa_next_free_vgpr 512
  .amdhsa_next_free_sgpr 102
  .amdhsa_accum_offset 256
  .amdhsa_group_segment_fixed_size 0
  .amdhsa_kernarg_size 56
  .amdhsa_user_sgpr_count 2
  .amdhsa_user_sgpr_kernarg_segment_ptr 1
  .amdhsa_system_sgpr_workgroup_id_x 1
.end_amdhsa_kernel
```

```asm
; @launch grid=(256,1,1) block=(256,1,1) lds=163840
.amdgcn_target "amdgcn-amd-amdhsa--gfx950"
.text
.globl standalone__normalfloat_lut_af4__prompt_kernel
.p2align 8
.type standalone__normalfloat_lut_af4__prompt_kernel,@function
standalone__normalfloat_lut_af4__prompt_kernel:
    s_cmp_ge_u32 s2, 256
    s_cbranch_scc1 L_end
    s_load_dwordx2 s[4:5], s[0:1], 8
    s_load_dwordx2 s[12:13], s[0:1], 48
    s_load_dwordx2 s[8:9], s[0:1], 0
    s_load_dwordx2 s[28:29], s[0:1], 16
    s_getpc_b64 s[48:49]
L_pc:
    s_mov_b32 s50, L_code_end-L_pc
    s_mov_b32 s51, 0x20000
    s_lshr_b32 s61, s2, 3
    v_lshl_add_u32 v46, v0, 5, s61
    v_lshlrev_b32 v46, 7, v46
    buffer_load_dword v1, v46, s[48:51], 0 offen offset:256
    v_lshrrev_b32 v5, 6, v0
    v_and_b32 v2, 63, v0
    s_and_b32 s60, s2, 7
    v_readfirstlane_b32 s63, v5
    s_and_b32 s58, s60, 1
    s_lshl_b32 s58, s58, 3
    s_and_b32 s62, s61, 7
    s_add_u32 s58, s58, s62
    s_lshr_b32 s59, s60, 1
    s_lshl_b32 s59, s59, 2
    s_lshr_b32 s62, s61, 3
    s_add_u32 s59, s59, s62
    v_mul_u32_u24 v18, 12, v2
    s_lshl_b32 s60, s63, 4
    s_add_u32 s60, s60, s58
    s_mul_i32 s61, s60, 114688
    s_mul_i32 s79, s59, 896
    s_add_u32 s61, s61, s79
    s_mov_b32 s6, 14680064
    s_mov_b32 s7, 0x20000
    s_lshl_b32 s78, s59, 7
    s_add_u32 s78, s78, 2097164
    v_and_b32 v4, 15, v2
    v_lshrrev_b32 v3, 4, v2
    v_and_b32 v12, 1, v3
    v_lshlrev_b32 v13, 1, v12
    v_xor_b32 v13, v13, v4
    v_lshrrev_b32 v19, 1, v3
    v_lshl_add_u32 v19, v19, 4, v13
    s_bfe_u32 s70, s58, 0x10002
    s_xor_b32 s70, s70, 1
    v_xor_b32 v12, s70, v12
    v_mul_u32_u24 v12, 14336, v12
    v_add_lshl_u32 v19, v19, v12, 2
    v_add_u32 v19, 768, v19
    s_mov_b32 s46, 2
    s_cmp_lg_u32 s63, 0
    s_cbranch_scc1 L_role0
    s_mov_b32 s46, 0
L_role0:
    s_cmp_lg_u32 s63, 1
    s_cbranch_scc1 L_role1
    s_mov_b32 s46, 1
L_role1:
    v_lshlrev_b32 v16, 1, v4
    v_lshrrev_b32 v17, 4, v0
    v_lshlrev_b32 v17, 1, v17
    s_mov_b32 s30, 32
    s_mov_b32 s31, 0x20000
    v_lshrrev_b32 v6, 3, v2
    v_and_b32 v7, 7, v2
    v_xor_b32 v13, v7, v3
    s_lshl_b32 s70, s63, 5
    v_add_lshl_u32 v12, v6, s70, 11
    v_lshl_add_u32 v36, v13, 4, v12
    v_xor_b32 v37, 64, v36
    v_add_u32 v37, 15360, v37
    v_add_u32 v38, 30720, v36
    v_add_u32 v39, 30720, v37
    s_mov_b32 s10, 4194304
    s_mov_b32 s11, 0x20000
    s_lshl_b32 s55, s58, 18
    s_and_b32 s71, s58, 8
    s_lshl_b32 s70, s71, 4
    s_add_u32 s55, s55, s70
    s_lshl_b32 s57, s63, 12
    s_xor_b32 s69, s55, 128
    s_add_u32 s57, s57, 65536
    s_mov_b32 s14, 2099200
    s_mov_b32 s15, 0x20000
    s_lshl_b32 s68, s59, 17
    s_lshl_b32 s62, s60, 10
    s_add_u32 s62, s62, s68
    v_lshlrev_b32 v20, 4, v2
    s_waitcnt lgkmcnt(0)
    s_load_dword s76, s[12:13], s78
    s_cmp_eq_u32 s46, 1
    s_cbranch_scc1 L_L
    s_cmp_eq_u32 s46, 2
    s_cbranch_scc1 L_L
L_X:
    buffer_load_dwordx3 v[128:130], v18, s[4:7], s61 offen nt
    buffer_load_dword v131, v19, s[4:7], s61 offen nt
    s_add_u32 s61, s61, 14336
    buffer_load_dwordx3 v[132:134], v18, s[4:7], s61 offen nt
    buffer_load_dword v135, v19, s[4:7], s61 offen nt
    s_add_u32 s61, s61, 14336
    buffer_load_dwordx3 v[136:138], v18, s[4:7], s61 offen nt
    buffer_load_dword v139, v19, s[4:7], s61 offen nt
    s_add_u32 s61, s61, 14336
    buffer_load_dwordx3 v[140:142], v18, s[4:7], s61 offen nt
    buffer_load_dword v143, v19, s[4:7], s61 offen nt
    s_add_u32 s61, s61, 14336
    buffer_load_dwordx3 v[144:146], v18, s[4:7], s61 offen nt
    s_add_u32 s61, s61, 14336
    buffer_load_dwordx3 v[148:150], v18, s[4:7], s61 offen nt
    s_add_u32 s61, s61, 14336
    buffer_load_dwordx3 v[152:154], v18, s[4:7], s61 offen nt
    s_add_u32 s61, s61, 14336
    buffer_load_dwordx3 v[156:158], v18, s[4:7], s61 offen nt
    s_add_u32 s61, s61, 7239680
    s_cmp_eq_u32 s46, 1
    s_cbranch_scc1 L_D
    s_cmp_eq_u32 s46, 2
    s_cbranch_scc1 L_B
L_L:
    buffer_load_ushort v16, v16, s[28:31], 0 offen
    buffer_load_ushort v17, v17, s[28:31], 0 offen
    s_cmp_eq_u32 s46, 1
    s_cbranch_scc1 L_S
    s_cmp_eq_u32 s46, 2
    s_cbranch_scc1 L_S
L_D:
    s_add_u32 m0, s57, 32768
    s_add_u32 s56, s55, 0
    buffer_load_dwordx4 v36, s[8:11], s56 offen offset:0  lds
    buffer_load_dwordx4 v37, s[8:11], s56 offen offset:1024  lds
    buffer_load_dwordx4 v38, s[8:11], s56 offen offset:2048  lds
    buffer_load_dwordx4 v39, s[8:11], s56 offen offset:3072  lds
    s_cmp_eq_u32 s46, 1
    s_cbranch_scc1 L_G
    s_cmp_eq_u32 s46, 2
    s_cbranch_scc1 L_G
L_S:
    s_load_dwordx2 s[32:33], s[0:1], 24
    s_load_dwordx2 s[16:17], s[0:1], 32
    s_load_dwordx2 s[24:25], s[0:1], 40
    s_and_b32 s64, s63, 1
    s_lshr_b32 s65, s63, 1
    s_and_b32 s70, s58, 8
    s_lshl_b32 s70, s70, 10
    s_lshl_b32 s71, s64, 12
    s_add_u32 s70, s70, s71
    s_lshl_b32 s71, s63, 8
    s_add_u32 s70, s70, s71
    s_add_u32 s70, s70, s68
    v_lshl_add_u32 v32, v4, 4, s70
    v_lshl_add_u32 v32, v3, 10, v32
    v_xor_b32 v33, 4096, v32
    v_xor_b32 v34, 8192, v32
    v_xor_b32 v44, 12288, v32
    s_mov_b32 s36, 202114048
    s_mov_b32 s37, 202114304
    s_mov_b32 s38, 202114560
    s_mov_b32 s39, 202114816
    v_and_b32 v35, 31, v2
    v_lshlrev_b32 v35, 2, v35
    s_lshl_b32 s70, s64, 6
    s_add_u32 s70, s70, 65536
    v_lshrrev_b32 v12, 1, v4
    v_xor_b32 v12, v12, v3
    v_lshlrev_b32 v12, 4, v12
    v_lshl_add_u32 v12, v4, 7, v12
    v_xor_b32 v40, s70, v12
    v_xor_b32 v41, 64, v40
    v_add_u32 v42, 65536, v40
    v_add_u32 v43, 65536, v41
    s_mov_b32 s52, 0
    v_lshlrev_b32 v8, 4, v7
    v_lshl_add_u32 v8, v0, 8, v8
    v_xor_b32 v9, 16, v8
    v_xor_b32 v10, 32, v8
    v_xor_b32 v11, 48, v8
    v_xor_b32 v12, 64, v8
    v_xor_b32 v13, 80, v8
    v_xor_b32 v14, 96, v8
    v_xor_b32 v15, 112, v8
    s_cmp_eq_u32 s46, 1
    s_cbranch_scc1 L_X
    s_cmp_eq_u32 s46, 2
    s_cbranch_scc1 L_D
L_G:
    s_waitcnt lgkmcnt(0)
    s_add_u32 s76, s76, 2654435769
    s_and_b32 s47, s76, 0xffff0000
    s_cmp_eq_u32 s46, 1
    s_cbranch_scc1 L_T
    s_cmp_eq_u32 s46, 2
    s_cbranch_scc1 L_T
L_K:
    s_waitcnt vmcnt(16)
    v_or_b32 v131, s47, v131
    s_waitcnt vmcnt(15)
    v_lshl_or_b32 v128, v132, 4, v128
    v_lshl_or_b32 v129, v133, 4, v129
    v_lshl_or_b32 v130, v134, 4, v130
    s_waitcnt vmcnt(14)
    v_lshl_or_b32 v131, v135, 4, v131
    s_waitcnt vmcnt(13)
    v_lshl_or_b32 v128, v136, 8, v128
    v_lshl_or_b32 v129, v137, 8, v129
    v_lshl_or_b32 v130, v138, 8, v130
    s_waitcnt vmcnt(12)
    v_lshl_or_b32 v131, v139, 8, v131
    s_waitcnt vmcnt(11)
    v_lshl_or_b32 v128, v140, 12, v128
    v_lshl_or_b32 v129, v141, 12, v129
    v_lshl_or_b32 v130, v142, 12, v130
    s_waitcnt vmcnt(10)
    v_lshl_or_b32 v131, v143, 12, v131
    s_waitcnt vmcnt(9)
    v_lshl_or_b32 v128, v144, 16, v128
    v_lshl_or_b32 v129, v145, 16, v129
    v_lshl_or_b32 v130, v146, 16, v130
    s_waitcnt vmcnt(8)
    v_lshl_or_b32 v128, v148, 20, v128
    v_lshl_or_b32 v129, v149, 20, v129
    v_lshl_or_b32 v130, v150, 20, v130
    s_waitcnt vmcnt(7)
    v_lshl_or_b32 v128, v152, 24, v128
    v_lshl_or_b32 v129, v153, 24, v129
    v_lshl_or_b32 v130, v154, 24, v130
    s_waitcnt vmcnt(6)
    v_lshl_or_b32 v128, v156, 28, v128
    v_lshl_or_b32 v129, v157, 28, v129
    v_lshl_or_b32 v130, v158, 28, v130
    buffer_store_dwordx4 v[128:131], v20, s[12:15], s62 offen sc1
    s_add_u32 s62, s62, 65536
    s_cmp_eq_u32 s46, 1
    s_cbranch_scc1 L_B
    s_cmp_eq_u32 s46, 2
    s_cbranch_scc1 L_E
L_T:
    s_waitcnt vmcnt(16)
    s_cmp_eq_u32 s46, 1
    s_cbranch_scc1 L_rw1
    s_waitcnt vmcnt(5)
    s_cmp_eq_u32 s46, 0
    s_cbranch_scc1 L_rw1
    s_waitcnt vmcnt(4)
L_rw1:
    v_lshl_or_b32 v56, v17, 16, v16
    v_lshl_or_b32 v57, v17, 16, v16
    v_lshl_or_b32 v58, v17, 16, v16
    v_lshl_or_b32 v59, v17, 16, v16
    ds_write_b128 v8, v[56:59]
    ds_write_b128 v9, v[56:59]
    ds_write_b128 v10, v[56:59]
    ds_write_b128 v11, v[56:59]
    ds_write_b128 v12, v[56:59]
    ds_write_b128 v13, v[56:59]
    ds_write_b128 v14, v[56:59]
    ds_write_b128 v15, v[56:59]
    s_cmp_lg_u32 s46, 1
    s_cbranch_scc1 L_ed2
    s_waitcnt vmcnt(4)
    s_branch L_K
L_ed2:
    s_cmp_eq_u32 s46, 2
    s_cbranch_scc1 L_X
L_W:
    s_mov_b64 exec, 0
    s_cmp_eq_u32 s63, 0
    s_cbranch_scc1 L_pad0
L_warmed:
    s_mov_b64 exec, -1
L_B:
    s_waitcnt vmcnt(12) lgkmcnt(0)
    s_cmp_eq_u32 s46, 2
    s_cbranch_scc1 L_rw3
    s_waitcnt vmcnt(1)
L_rw3:
    s_barrier
L_Q:
    ds_read_b128 a[0:3], v40 offset:32768
    ds_read_b128 a[4:7], v41 offset:32768
    ds_read_b128 a[8:11], v40 offset:34816
    ds_read_b128 a[12:15], v41 offset:34816
    ds_read_b128 a[16:19], v40 offset:36864
    ds_read_b128 a[20:23], v41 offset:36864
    ds_read_b128 a[24:27], v40 offset:38912
    ds_read_b128 a[28:31], v41 offset:38912
    ds_read_b128 a[40:43], v40 offset:40960
    ds_read_b128 a[44:47], v41 offset:40960
    ds_read_b128 a[48:51], v40 offset:43008
    ds_read_b128 a[52:55], v41 offset:43008
    ds_read_b128 a[56:59], v40 offset:45056
    ds_read_b128 a[60:63], v41 offset:45056
    ds_read_b128 a[72:75], v40 offset:47104
    ds_read_b128 a[76:79], v41 offset:47104
L_P:
    buffer_load_dwordx4 v[64:67], v32, s[12:15], 0 offen sc1
    buffer_load_dwordx4 v[68:71], v33, s[12:15], 0 offen sc1
L_d:
    s_add_u32 m0, s57, 49152
    s_add_u32 s3, s69, 0
    buffer_load_dwordx4 v36, s[8:11], s3 offen offset:0  lds
    buffer_load_dwordx4 v37, s[8:11], s3 offen offset:1024  lds
    buffer_load_dwordx4 v38, s[8:11], s3 offen offset:2048  lds
    buffer_load_dwordx4 v39, s[8:11], s3 offen offset:3072  lds
    s_cmp_lg_u32 s46, 2
    s_cbranch_scc1 L_ed4
    s_waitcnt vmcnt(6)
    s_branch L_K
L_ed4:
L_E:
L_chk0:
    s_waitcnt vmcnt(5)
    s_cmp_eq_u32 s46, 2
    s_cbranch_scc1 L_rw5
    s_waitcnt vmcnt(4)
L_rw5:
    v_bitop3_b32 v12, v67, v71, s76 bitop3:0x7e
    v_cmp_lt_u32 vcc, 0xffff, v12
    s_cbranch_vccnz L_retry0
    buffer_load_dwordx4 v[72:75], v34, s[12:15], 0 offen sc1
    buffer_load_dwordx4 v[76:79], v44, s[12:15], 0 offen sc1
    v_perm_b32 v56, v64, v35, s36
    v_perm_b32 v57, v64, v35, s37
    v_perm_b32 v58, v64, v35, s38
    v_perm_b32 v59, v64, v35, s39
    v_perm_b32 v60, v68, v35, s36
    v_perm_b32 v61, v68, v35, s37
    v_perm_b32 v62, v68, v35, s38
    v_perm_b32 v63, v68, v35, s39
    ds_read_b32 a32, v56
    ds_read_b32 a33, v57
    ds_read_b32 a34, v58
    ds_read_b32 a35, v59
    ds_read_b32 a36, v60
    ds_read_b32 a37, v61
    ds_read_b32 a38, v62
    ds_read_b32 a39, v63
    v_perm_b32 v5, v65, v35, s36
    v_perm_b32 v6, v65, v35, s37
    v_perm_b32 v7, v65, v35, s38
    v_perm_b32 v27, v65, v35, s39
    v_perm_b32 v29, v69, v35, s36
    v_perm_b32 v31, v69, v35, s37
    ds_read_b32 a64, v5
    ds_read_b32 a65, v6
    ds_read_b32 a66, v7
    ds_read_b32 a67, v27
    s_cbranch_vccz L_main
L_retry0:
    s_add_u32 s52, s52, 1
    s_and_b32 s23, s52, 4095
    s_cbranch_scc1 L_retry0b
    s_mov_b32 s22, 0
    s_call_b64 s[20:21], L_help
L_retry0b:
    buffer_load_dwordx4 v[64:67], v32, s[12:15], 0 offen sc1
    buffer_load_dwordx4 v[68:71], v33, s[12:15], 0 offen sc1
    s_waitcnt vmcnt(0) lgkmcnt(0)
    s_branch L_chk0
L_tick:
    s_add_u32 s52, s52, 1
    s_and_b32 s23, s52, 4095
    s_cbranch_scc0 L_help
    s_setpc_b64 s[20:21]
L_slow0_1:
    s_mov_b32 s22, 0
    s_call_b64 s[20:21], L_tick
    buffer_load_dwordx4 v[72:75], v34, s[12:15], 0 offen sc1
    buffer_load_dwordx4 v[76:79], v44, s[12:15], 0 offen sc1
    s_waitcnt vmcnt(0)
    v_bitop3_b32 v12, v75, v79, s76 bitop3:0x7e
    v_cmp_lt_u32 vcc, 0xffff, v12
    s_cbranch_vccnz L_slow0_1
    s_branch L_back0_1
L_slow4_0:
    s_mov_b32 s22, 4
    s_call_b64 s[20:21], L_tick
    buffer_load_dwordx4 v[96:99], v32, s[12:15], s43 offen sc1
    buffer_load_dwordx4 v[100:103], v33, s[12:15], s43 offen sc1
    s_waitcnt vmcnt(0)
    v_bitop3_b32 v12, v99, v103, s76 bitop3:0x7e
    v_cmp_lt_u32 vcc, 0xffff, v12
    s_cbranch_vccnz L_slow4_0
    s_branch L_back4_0
L_slow4_1:
    s_mov_b32 s22, 4
    s_call_b64 s[20:21], L_tick
    buffer_load_dwordx4 v[104:107], v34, s[12:15], s43 offen sc1
    buffer_load_dwordx4 v[108:111], v44, s[12:15], s43 offen sc1
    s_waitcnt vmcnt(0)
    v_bitop3_b32 v12, v107, v111, s76 bitop3:0x7e
    v_cmp_lt_u32 vcc, 0xffff, v12
    s_cbranch_vccnz L_slow4_1
    s_branch L_back4_1
L_slow1_0:
    s_mov_b32 s22, 1
    s_call_b64 s[20:21], L_tick
    buffer_load_dwordx4 v[80:83], v32, s[12:15], s40 offen sc1
    buffer_load_dwordx4 v[84:87], v33, s[12:15], s40 offen sc1
    s_waitcnt vmcnt(0)
    v_bitop3_b32 v12, v83, v87, s76 bitop3:0x7e
    v_cmp_lt_u32 vcc, 0xffff, v12
    s_cbranch_vccnz L_slow1_0
    s_branch L_back1_0
L_slow1_1:
    s_mov_b32 s22, 1
    s_call_b64 s[20:21], L_tick
    buffer_load_dwordx4 v[88:91], v34, s[12:15], s40 offen sc1
    buffer_load_dwordx4 v[92:95], v44, s[12:15], s40 offen sc1
    s_waitcnt vmcnt(0)
    v_bitop3_b32 v12, v91, v95, s76 bitop3:0x7e
    v_cmp_lt_u32 vcc, 0xffff, v12
    s_cbranch_vccnz L_slow1_1
    s_branch L_back1_1
L_slow5_0:
    s_mov_b32 s22, 5
    s_call_b64 s[20:21], L_tick
    buffer_load_dwordx4 v[112:115], v32, s[12:15], s44 offen sc1
    buffer_load_dwordx4 v[116:119], v33, s[12:15], s44 offen sc1
    s_waitcnt vmcnt(0)
    v_bitop3_b32 v12, v115, v119, s76 bitop3:0x7e
    v_cmp_lt_u32 vcc, 0xffff, v12
    s_cbranch_vccnz L_slow5_0
    s_branch L_back5_0
L_slow5_1:
    s_mov_b32 s22, 5
    s_call_b64 s[20:21], L_tick
    buffer_load_dwordx4 v[120:123], v34, s[12:15], s44 offen sc1
    buffer_load_dwordx4 v[124:127], v44, s[12:15], s44 offen sc1
    s_waitcnt vmcnt(0)
    v_bitop3_b32 v12, v123, v127, s76 bitop3:0x7e
    v_cmp_lt_u32 vcc, 0xffff, v12
    s_cbranch_vccnz L_slow5_1
    s_branch L_back5_1
L_slow2_0:
    s_mov_b32 s22, 2
    s_call_b64 s[20:21], L_tick
    buffer_load_dwordx4 v[48:51], v32, s[12:15], s41 offen sc1
    buffer_load_dwordx4 v[52:55], v33, s[12:15], s41 offen sc1
    s_waitcnt vmcnt(0)
    v_bitop3_b32 v12, v51, v55, s76 bitop3:0x7e
    v_cmp_lt_u32 vcc, 0xffff, v12
    s_cbranch_vccnz L_slow2_0
    s_branch L_back2_0
L_slow2_1:
    s_mov_b32 s22, 2
    s_call_b64 s[20:21], L_tick
    buffer_load_dwordx4 v[64:67], v34, s[12:15], s41 offen sc1
    buffer_load_dwordx4 v[68:71], v44, s[12:15], s41 offen sc1
    s_waitcnt vmcnt(0)
    v_bitop3_b32 v12, v67, v71, s76 bitop3:0x7e
    v_cmp_lt_u32 vcc, 0xffff, v12
    s_cbranch_vccnz L_slow2_1
    s_branch L_back2_1
L_slow6_0:
    s_mov_b32 s22, 6
    s_call_b64 s[20:21], L_tick
    buffer_load_dwordx4 v[88:91], v32, s[12:15], s45 offen sc1
    buffer_load_dwordx4 v[92:95], v33, s[12:15], s45 offen sc1
    s_waitcnt vmcnt(0)
    v_bitop3_b32 v12, v91, v95, s76 bitop3:0x7e
    v_cmp_lt_u32 vcc, 0xffff, v12
    s_cbranch_vccnz L_slow6_0
    s_branch L_back6_0
L_slow6_1:
    s_mov_b32 s22, 6
    s_call_b64 s[20:21], L_tick
    buffer_load_dwordx4 v[48:51], v34, s[12:15], s45 offen sc1
    buffer_load_dwordx4 v[52:55], v44, s[12:15], s45 offen sc1
    s_waitcnt vmcnt(0)
    v_bitop3_b32 v12, v51, v55, s76 bitop3:0x7e
    v_cmp_lt_u32 vcc, 0xffff, v12
    s_cbranch_vccnz L_slow6_1
    s_branch L_back6_1
L_slow3_0:
    s_mov_b32 s22, 3
    s_call_b64 s[20:21], L_tick
    buffer_load_dwordx4 v[72:75], v32, s[12:15], s42 offen sc1
    buffer_load_dwordx4 v[76:79], v33, s[12:15], s42 offen sc1
    s_waitcnt vmcnt(0)
    v_bitop3_b32 v12, v75, v79, s76 bitop3:0x7e
    v_cmp_lt_u32 vcc, 0xffff, v12
    s_cbranch_vccnz L_slow3_0
    s_branch L_back3_0
L_slow3_1:
    s_mov_b32 s22, 3
    s_call_b64 s[20:21], L_tick
    buffer_load_dwordx4 v[80:83], v34, s[12:15], s42 offen sc1
    buffer_load_dwordx4 v[84:87], v44, s[12:15], s42 offen sc1
    s_waitcnt vmcnt(0)
    v_bitop3_b32 v12, v83, v87, s76 bitop3:0x7e
    v_cmp_lt_u32 vcc, 0xffff, v12
    s_cbranch_vccnz L_slow3_1
    s_branch L_back3_1
L_slow7_0:
    s_mov_b32 s22, 7
    s_call_b64 s[20:21], L_tick
    buffer_load_dwordx4 v[68:71], v32, s[12:15], s72 offen sc1
    buffer_load_dwordx4 v[72:75], v33, s[12:15], s72 offen sc1
    s_waitcnt vmcnt(0)
    v_bitop3_b32 v12, v71, v75, s76 bitop3:0x7e
    v_cmp_lt_u32 vcc, 0xffff, v12
    s_cbranch_vccnz L_slow7_0
    s_branch L_back7_0
L_slow7_1:
    s_mov_b32 s22, 7
    s_call_b64 s[20:21], L_tick
    buffer_load_dwordx4 v[76:79], v34, s[12:15], s72 offen sc1
    buffer_load_dwordx4 v[80:83], v44, s[12:15], s72 offen sc1
    s_waitcnt vmcnt(0)
    v_bitop3_b32 v12, v79, v83, s76 bitop3:0x7e
    v_cmp_lt_u32 vcc, 0xffff, v12
    s_cbranch_vccnz L_slow7_1
    s_branch L_back7_1
.p2align 12
L_main:
L_pad0:
    s_cbranch_execz L_pad1
    s_waitcnt lgkmcnt(8)
    v_mfma_f32_16x16x32_bf16 v[128:131], a[32:35], a[0:3], 0
    s_waitcnt lgkmcnt(4)
    s_mov_b32 s40, 16384
    ds_read_b32 a68, v29
    v_mfma_f32_16x16x32_bf16 v[128:131], a[36:39], a[4:7], v[128:131]
    buffer_load_dwordx4 v[80:83], v32, s[12:15], s40 offen sc1
    v_mfma_f32_16x16x32_bf16 v[132:135], a[36:39], a[12:15], 0
    s_add_u32 m0, s57, 65536
    ds_read_b32 a69, v31
    v_perm_b32 v46, v69, v35, s38
    v_mfma_f32_16x16x32_bf16 v[132:135], a[32:35], a[8:11], v[132:135]
    s_add_u32 s56, s55, 256
    ds_read_b32 a70, v46
    v_perm_b32 v47, v69, v35, s39
    v_mfma_f32_16x16x32_bf16 v[136:139], a[32:35], a[16:19], 0
    s_add_u32 s3, s69, 256
    ds_read_b32 a71, v47
    v_mfma_f32_16x16x32_bf16 v[136:139], a[36:39], a[20:23], v[136:139]
    buffer_load_dwordx4 v[84:87], v33, s[12:15], s40 offen sc1
    v_mfma_f32_16x16x32_bf16 v[140:143], a[36:39], a[28:31], 0
    v_perm_b32 v56, v66, v35, s36
    v_perm_b32 v57, v66, v35, s37
    v_mfma_f32_16x16x32_bf16 v[140:143], a[32:35], a[24:27], v[140:143]
    ds_read_b32 a80, v56
    v_perm_b32 v58, v66, v35, s38
    v_mfma_f32_16x16x32_bf16 v[144:147], a[32:35], a[40:43], 0
    ds_read_b32 a81, v57
    v_mfma_f32_16x16x32_bf16 v[144:147], a[36:39], a[44:47], v[144:147]
    buffer_load_dwordx4 v36, s[8:11], s56 offen offset:0  lds
    v_mfma_f32_16x16x32_bf16 v[148:151], a[36:39], a[52:55], 0
    ds_read_b32 a82, v58
    v_perm_b32 v59, v66, v35, s39
    v_mfma_f32_16x16x32_bf16 v[148:151], a[32:35], a[48:51], v[148:151]
    v_perm_b32 v60, v70, v35, s36
    v_perm_b32 v61, v70, v35, s37
    v_mfma_f32_16x16x32_bf16 v[152:155], a[32:35], a[56:59], 0
    s_mov_b32 s41, 32768
    ds_read_b32 a83, v59
    ds_read_b32 a84, v60
    v_mfma_f32_16x16x32_bf16 v[152:155], a[36:39], a[60:63], v[152:155]
    buffer_load_dwordx4 v37, s[8:11], s56 offen offset:1024  lds
    v_mfma_f32_16x16x32_bf16 v[156:159], a[36:39], a[76:79], 0
    ds_read_b32 a85, v61
    v_perm_b32 v62, v70, v35, s38
    v_mfma_f32_16x16x32_bf16 v[156:159], a[32:35], a[72:75], v[156:159]
    s_waitcnt lgkmcnt(6)
    ds_read_b32 a86, v62
    v_perm_b32 v63, v70, v35, s39
    v_mfma_f32_16x16x32_bf16 v[160:163], a[64:67], a[0:3], 0
    ds_read_b32 a87, v63
    v_mfma_f32_16x16x32_bf16 v[160:163], a[68:71], a[4:7], v[160:163]
    buffer_load_dwordx4 v38, s[8:11], s56 offen offset:2048  lds
    v_mfma_f32_16x16x32_bf16 v[164:167], a[68:71], a[12:15], 0
    v_perm_b32 v5, v67, v35, s36
    v_perm_b32 v6, v67, v35, s37
    v_mfma_f32_16x16x32_bf16 v[164:167], a[64:67], a[8:11], v[164:167]
    ds_read_b32 a88, v5
    v_perm_b32 v7, v71, v35, s36
    v_mfma_f32_16x16x32_bf16 v[168:171], a[64:67], a[16:19], 0
    ds_read_b32 a89, v6
    v_mfma_f32_16x16x32_bf16 v[168:171], a[68:71], a[20:23], v[168:171]
    buffer_load_dwordx4 v39, s[8:11], s56 offen offset:3072  lds
    v_mfma_f32_16x16x32_bf16 v[172:175], a[68:71], a[28:31], 0
    s_add_u32 m0, s57, 81920
    ds_read_b32 a90, v7
    v_perm_b32 v27, v71, v35, s37
    v_mfma_f32_16x16x32_bf16 v[172:175], a[64:67], a[24:27], v[172:175]
    s_add_u32 s56, s55, 512
    ds_read_b32 a91, v27
    v_mfma_f32_16x16x32_bf16 v[176:179], a[64:67], a[40:43], 0
    s_waitcnt vmcnt(6)
    s_mov_b32 s42, 49152
    v_bitop3_b32 v29, v75, v79, s76 bitop3:0x7e
    v_mfma_f32_16x16x32_bf16 v[176:179], a[68:71], a[44:47], v[176:179]
    buffer_load_dwordx4 v[88:91], v34, s[12:15], s40 offen sc1
    v_mfma_f32_16x16x32_bf16 v[180:183], a[68:71], a[52:55], 0
    v_cmp_lt_u32 vcc, 0xffff, v29
    v_mfma_f32_16x16x32_bf16 v[180:183], a[64:67], a[48:51], v[180:183]
    v_mfma_f32_16x16x32_bf16 v[184:187], a[64:67], a[56:59], 0
    s_cbranch_vccnz L_slow0_1
L_back0_1:
    v_mfma_f32_16x16x32_bf16 v[184:187], a[68:71], a[60:63], v[184:187]
    buffer_load_dwordx4 v[92:95], v44, s[12:15], s40 offen sc1
    v_mfma_f32_16x16x32_bf16 v[188:191], a[68:71], a[76:79], 0
    v_perm_b32 v31, v72, v35, s36
    v_perm_b32 v46, v72, v35, s37
    v_mfma_f32_16x16x32_bf16 v[188:191], a[64:67], a[72:75], v[188:191]
    s_waitcnt lgkmcnt(1)
    ds_read_b32 a96, v31
    v_perm_b32 v47, v72, v35, s38
    v_mfma_f32_16x16x32_bf16 v[192:195], a[80:83], a[0:3], 0
    s_barrier
    v_mfma_f32_16x16x32_bf16 v[192:195], a[84:87], a[4:7], v[192:195]
    buffer_load_dwordx4 v36, s[8:11], s3 offen offset:0  lds
    v_mfma_f32_16x16x32_bf16 v[196:199], a[84:87], a[12:15], 0
    ds_read_b32 a97, v46
    v_perm_b32 v56, v72, v35, s39
    v_mfma_f32_16x16x32_bf16 v[196:199], a[80:83], a[8:11], v[196:199]
    ds_read_b32 a98, v47
    ds_read_b32 a99, v56
    v_mfma_f32_16x16x32_bf16 v[200:203], a[80:83], a[16:19], 0
    s_mov_b32 s43, 65536
    ds_read_b128 a[104:107], v40 offset:49152
    v_mfma_f32_16x16x32_bf16 v[200:203], a[84:87], a[20:23], v[200:203]
    buffer_load_dwordx4 v37, s[8:11], s3 offen offset:1024  lds
    v_mfma_f32_16x16x32_bf16 v[204:207], a[84:87], a[28:31], 0
    ds_read_b128 a[108:111], v41 offset:49152
    v_perm_b32 v57, v76, v35, s36
    v_mfma_f32_16x16x32_bf16 v[204:207], a[80:83], a[24:27], v[204:207]
    ds_read_b32 a100, v57
    v_perm_b32 v58, v76, v35, s37
    v_mfma_f32_16x16x32_bf16 v[208:211], a[80:83], a[40:43], 0
    ds_read_b32 a101, v58
    ds_read_b128 a[112:115], v40 offset:51200
    v_mfma_f32_16x16x32_bf16 v[208:211], a[84:87], a[44:47], v[208:211]
    buffer_load_dwordx4 v38, s[8:11], s3 offen offset:2048  lds
    v_mfma_f32_16x16x32_bf16 v[212:215], a[84:87], a[52:55], 0
    ds_read_b128 a[116:119], v41 offset:51200
    v_perm_b32 v59, v76, v35, s38
    v_mfma_f32_16x16x32_bf16 v[212:215], a[80:83], a[48:51], v[212:215]
    ds_read_b32 a102, v59
    v_perm_b32 v60, v76, v35, s39
    v_mfma_f32_16x16x32_bf16 v[216:219], a[80:83], a[56:59], 0
    ds_read_b32 a103, v60
    v_perm_b32 v61, v73, v35, s36
    v_mfma_f32_16x16x32_bf16 v[216:219], a[84:87], a[60:63], v[216:219]
    ds_read_b32 a120, v61
    v_perm_b32 v62, v73, v35, s37
    v_mfma_f32_16x16x32_bf16 v[220:223], a[84:87], a[76:79], 0
    ds_read_b128 a[128:131], v40 offset:53248
    ds_read_b32 a121, v62
    v_mfma_f32_16x16x32_bf16 v[220:223], a[80:83], a[72:75], v[220:223]
    s_waitcnt lgkmcnt(9)
    ds_read_b128 a[132:135], v41 offset:53248
    v_mfma_f32_16x16x32_bf16 v[224:227], a[88:91], a[2:5], 0
    buffer_load_dwordx4 v39, s[8:11], s3 offen offset:3072  lds
    v_mfma_f32_16x16x32_bf16 v[228:231], a[88:91], a[10:13], 0
    s_add_u32 m0, s57, 0
    ds_read_b128 a[136:139], v40 offset:55296
    v_perm_b32 v63, v73, v35, s38
    v_mfma_f32_16x16x32_bf16 v[232:235], a[88:91], a[18:21], 0
    s_add_u32 s3, s69, 512
    ds_read_b128 a[140:143], v41 offset:55296
    v_perm_b32 v5, v73, v35, s39
    v_mfma_f32_16x16x32_bf16 v[236:239], a[88:91], a[26:29], 0
    s_mov_b32 s44, 81920
    ds_read_b32 a122, v63
    ds_read_b32 a123, v5
    v_mfma_f32_16x16x32_bf16 v[240:243], a[88:91], a[42:45], 0
    ds_read_b128 a[144:147], v40 offset:57344
    v_mfma_f32_16x16x32_bf16 v[244:247], a[88:91], a[50:53], 0
    buffer_load_dwordx3 v[96:98], v18, s[4:7], s61 offen nt
    v_mfma_f32_16x16x32_bf16 v[248:251], a[88:91], a[58:61], 0
    ds_read_b128 a[148:151], v41 offset:57344
    v_perm_b32 v6, v77, v35, s36
    v_mfma_f32_16x16x32_bf16 v[252:255], a[88:91], a[74:77], 0
    ds_read_b128 a[156:159], v41 offset:59392
    v_perm_b32 v7, v77, v35, s37
    v_mfma_f32_16x16x32_bf16 v[128:131], a[96:99], a[104:107], v[128:131]
    s_waitcnt lgkmcnt(7)
    ds_read_b128 a[152:155], v40 offset:59392
    ds_read_b32 a124, v6
    v_mfma_f32_16x16x32_bf16 v[128:131], a[100:103], a[108:111], v[128:131]
    buffer_load_dword v99, v19, s[4:7], s61 offen nt
    v_mfma_f32_16x16x32_bf16 v[132:135], a[100:103], a[116:119], v[132:135]
    s_add_u32 s61, s61, 14336
    ds_read_b128 a[160:163], v40 offset:61440
    v_perm_b32 v27, v77, v35, s38
    v_mfma_f32_16x16x32_bf16 v[132:135], a[96:99], a[112:115], v[132:135]
    s_waitcnt lgkmcnt(8)
    ds_read_b128 a[164:167], v41 offset:61440
    v_perm_b32 v29, v77, v35, s39
    v_mfma_f32_16x16x32_bf16 v[136:139], a[96:99], a[128:131], v[136:139]
    s_mov_b32 s45, 98304
    ds_read_b32 a125, v7
    ds_read_b32 a126, v27
    v_mfma_f32_16x16x32_bf16 v[136:139], a[100:103], a[132:135], v[136:139]
    buffer_load_dwordx3 v[100:102], v18, s[4:7], s61 offen nt
    v_mfma_f32_16x16x32_bf16 v[140:143], a[100:103], a[140:143], v[140:143]
    s_waitcnt vmcnt(13)
    ds_read_b128 a[168:171], v40 offset:63488
    v_bitop3_b32 v31, v83, v87, s76 bitop3:0x7e
    v_mfma_f32_16x16x32_bf16 v[140:143], a[96:99], a[136:139], v[140:143]
    s_waitcnt lgkmcnt(8)
    ds_read_b128 a[172:175], v41 offset:63488
    ds_read_b32 a127, v29
    v_mfma_f32_16x16x32_bf16 v[144:147], a[96:99], a[144:147], v[144:147]
    s_waitcnt lgkmcnt(8)
    v_perm_b32 v46, v74, v35, s36
    v_mfma_f32_16x16x32_bf16 v[144:147], a[100:103], a[148:151], v[144:147]
    buffer_load_dword v103, v19, s[4:7], s61 offen nt
    v_mfma_f32_16x16x32_bf16 v[148:151], a[100:103], a[156:159], v[148:151]
    s_add_u32 s61, s61, 14336
    ds_read_b32 a176, v46
    v_perm_b32 v47, v74, v35, s37
    v_mfma_f32_16x16x32_bf16 v[148:151], a[96:99], a[152:155], v[148:151]
    s_waitcnt lgkmcnt(7)
    v_cmp_lt_u32 vcc, 0xffff, v31
    v_perm_b32 v56, v74, v35, s38
    v_mfma_f32_16x16x32_bf16 v[152:155], a[96:99], a[160:163], v[152:155]
    s_waitcnt lgkmcnt(6)
    ds_read_b32 a177, v47
    ds_read_b32 a178, v56
    v_mfma_f32_16x16x32_bf16 v[152:155], a[100:103], a[164:167], v[152:155]
    s_waitcnt lgkmcnt(4)
    buffer_load_dwordx3 v[104:106], v18, s[4:7], s61 offen nt
    v_mfma_f32_16x16x32_bf16 v[156:159], a[100:103], a[172:175], v[156:159]
    v_perm_b32 v57, v74, v35, s39
    s_cbranch_vccnz L_slow1_0
L_back1_0:
    v_mfma_f32_16x16x32_bf16 v[156:159], a[96:99], a[168:171], v[156:159]
    s_waitcnt lgkmcnt(3)
    v_perm_b32 v58, v78, v35, s36
    v_perm_b32 v59, v78, v35, s37
    v_mfma_f32_16x16x32_bf16 v[160:163], a[120:123], a[104:107], v[160:163]
    s_mov_b32 s72, 114688
    ds_read_b32 a179, v57
    ds_read_b32 a180, v58
    v_mfma_f32_16x16x32_bf16 v[160:163], a[124:127], a[108:111], v[160:163]
    buffer_load_dword v107, v19, s[4:7], s61 offen nt
    v_mfma_f32_16x16x32_bf16 v[164:167], a[124:127], a[116:119], v[164:167]
    s_add_u32 s61, s61, 14336
    ds_read_b32 a181, v59
    v_perm_b32 v60, v78, v35, s38
    v_mfma_f32_16x16x32_bf16 v[164:167], a[120:123], a[112:115], v[164:167]
    v_perm_b32 v61, v78, v35, s39
    v_perm_b32 v62, v75, v35, s36
    v_mfma_f32_16x16x32_bf16 v[168:171], a[120:123], a[128:131], v[168:171]
    ds_read_b32 a182, v60
    ds_read_b32 a183, v61
    v_mfma_f32_16x16x32_bf16 v[168:171], a[124:127], a[132:135], v[168:171]
    buffer_load_dwordx3 v[108:110], v18, s[4:7], s61 offen nt
    v_mfma_f32_16x16x32_bf16 v[172:175], a[124:127], a[140:143], v[172:175]
    ds_read_b32 a92, v62
    v_perm_b32 v63, v75, v35, s37
    v_mfma_f32_16x16x32_bf16 v[172:175], a[120:123], a[136:139], v[172:175]
    v_perm_b32 v5, v79, v35, s36
    v_perm_b32 v6, v79, v35, s37
    v_mfma_f32_16x16x32_bf16 v[176:179], a[120:123], a[144:147], v[176:179]
    ds_read_b32 a93, v63
    ds_read_b32 a94, v5
    v_mfma_f32_16x16x32_bf16 v[176:179], a[124:127], a[148:151], v[176:179]
    buffer_load_dword v111, v19, s[4:7], s61 offen nt
    v_mfma_f32_16x16x32_bf16 v[180:183], a[124:127], a[156:159], v[180:183]
    s_add_u32 s61, s61, 14336
    ds_read_b32 a95, v6
    v_perm_b32 v7, v80, v35, s36
    v_mfma_f32_16x16x32_bf16 v[180:183], a[120:123], a[152:155], v[180:183]
    v_perm_b32 v27, v80, v35, s37
    v_perm_b32 v29, v80, v35, s38
    v_mfma_f32_16x16x32_bf16 v[184:187], a[120:123], a[160:163], v[184:187]
    ds_read_b32 a184, v7
    ds_read_b32 a185, v27
    v_mfma_f32_16x16x32_bf16 v[184:187], a[124:127], a[164:167], v[184:187]
    buffer_load_dwordx3 v[112:114], v18, s[4:7], s61 offen nt
    v_mfma_f32_16x16x32_bf16 v[188:191], a[124:127], a[172:175], v[188:191]
    s_add_u32 s61, s61, 14336
    ds_read_b32 a186, v29
    v_perm_b32 v46, v80, v35, s39
    v_mfma_f32_16x16x32_bf16 v[188:191], a[120:123], a[168:171], v[188:191]
    s_waitcnt vmcnt(15) lgkmcnt(6)
    v_perm_b32 v31, v84, v35, s36
    v_perm_b32 v47, v84, v35, s37
    v_mfma_f32_16x16x32_bf16 v[192:195], a[176:179], a[104:107], v[192:195]
    s_barrier
    v_mfma_f32_16x16x32_bf16 v[192:195], a[180:183], a[108:111], v[192:195]
    buffer_load_dwordx3 v[116:118], v18, s[4:7], s61 offen nt
    v_mfma_f32_16x16x32_bf16 v[196:199], a[180:183], a[116:119], v[196:199]
    s_add_u32 s61, s61, 14336
    ds_read_b32 a187, v46
    ds_read_b32 a188, v31
    v_mfma_f32_16x16x32_bf16 v[196:199], a[176:179], a[112:115], v[196:199]
    ds_read_b32 a189, v47
    ds_read_b128 a[192:195], v42 offset:0
    v_mfma_f32_16x16x32_bf16 v[200:203], a[176:179], a[128:131], v[200:203]
    ds_read_b128 a[196:199], v43 offset:0
    v_perm_b32 v56, v84, v35, s38
    v_mfma_f32_16x16x32_bf16 v[200:203], a[180:183], a[132:135], v[200:203]
    ds_read_b32 a190, v56
    ds_read_b128 a[204:207], v43 offset:2048
    v_mfma_f32_16x16x32_bf16 v[204:207], a[180:183], a[140:143], v[204:207]
    buffer_load_dwordx3 v[120:122], v18, s[4:7], s61 offen nt
    v_mfma_f32_16x16x32_bf16 v[204:207], a[176:179], a[136:139], v[204:207]
    s_add_u32 s61, s61, 14336
    ds_read_b128 a[200:203], v42 offset:2048
    v_perm_b32 v57, v84, v35, s39
    v_mfma_f32_16x16x32_bf16 v[208:211], a[176:179], a[144:147], v[208:211]
    ds_read_b32 a191, v57
    ds_read_b128 a[208:211], v42 offset:4096
    v_mfma_f32_16x16x32_bf16 v[208:211], a[180:183], a[148:151], v[208:211]
    ds_read_b128 a[212:215], v43 offset:4096
    v_perm_b32 v58, v81, v35, s36
    v_mfma_f32_16x16x32_bf16 v[212:215], a[180:183], a[156:159], v[212:215]
    ds_read_b128 a[220:223], v43 offset:6144
    ds_read_b32 a224, v58
    v_mfma_f32_16x16x32_bf16 v[212:215], a[176:179], a[152:155], v[212:215]
    buffer_load_dwordx3 v[124:126], v18, s[4:7], s61 offen nt
    v_mfma_f32_16x16x32_bf16 v[216:219], a[176:179], a[160:163], v[216:219]
    ds_read_b128 a[216:219], v42 offset:6144
    v_perm_b32 v59, v81, v35, s37
    v_mfma_f32_16x16x32_bf16 v[216:219], a[180:183], a[164:167], v[216:219]
    ds_read_b128 a[232:235], v42 offset:8192
    v_perm_b32 v60, v81, v35, s38
    v_mfma_f32_16x16x32_bf16 v[220:223], a[180:183], a[172:175], v[220:223]
    ds_read_b128 a[236:239], v43 offset:8192
    ds_read_b32 a225, v59
    v_mfma_f32_16x16x32_bf16 v[220:223], a[176:179], a[168:171], v[220:223]
    s_waitcnt lgkmcnt(10)
    ds_read_b128 a[244:247], v43 offset:10240
    ds_read_b32 a226, v60
    v_mfma_f32_16x16x32_bf16 v[224:227], a[92:95], a[106:109], v[224:227]
    buffer_load_dwordx4 v[48:51], v32, s[12:15], s41 offen sc1
    v_mfma_f32_16x16x32_bf16 v[228:231], a[92:95], a[114:117], v[228:231]
    ds_read_b128 a[240:243], v42 offset:10240
    v_perm_b32 v61, v81, v35, s39
    v_mfma_f32_16x16x32_bf16 v[232:235], a[92:95], a[130:133], v[232:235]
    ds_read_b128 a[248:251], v42 offset:12288
    v_perm_b32 v62, v85, v35, s36
    v_mfma_f32_16x16x32_bf16 v[236:239], a[92:95], a[138:141], v[236:239]
    ds_read_b32 a227, v61
    ds_read_b32 a228, v62
    v_mfma_f32_16x16x32_bf16 v[240:243], a[92:95], a[146:149], v[240:243]
    ds_read_b128 a[252:255], v43 offset:12288
    v_mfma_f32_16x16x32_bf16 v[244:247], a[92:95], a[154:157], v[244:247]
    buffer_load_dwordx4 v[52:55], v33, s[12:15], s41 offen sc1
    v_mfma_f32_16x16x32_bf16 v[248:251], a[92:95], a[162:165], v[248:251]
    v_perm_b32 v63, v85, v35, s37
    v_perm_b32 v5, v85, v35, s38
    v_mfma_f32_16x16x32_bf16 v[252:255], a[92:95], a[170:173], v[252:255]
    ds_read_b32 a229, v63
    v_perm_b32 v6, v85, v35, s39
    v_mfma_f32_16x16x32_bf16 v[128:131], a[184:187], a[192:195], v[128:131]
    s_waitcnt vmcnt(18) lgkmcnt(6)
    ds_read_b128 a[32:35], v42 offset:14336
    v_perm_b32 v7, v82, v35, s36
    v_mfma_f32_16x16x32_bf16 v[128:131], a[188:191], a[196:199], v[128:131]
    ds_read_b32 a230, v5
    v_perm_b32 v29, v82, v35, s37
    v_bitop3_b32 v27, v91, v95, s76 bitop3:0x7e
    v_mfma_f32_16x16x32_bf16 v[132:135], a[188:191], a[204:207], v[132:135]
    ds_read_b128 a[36:39], v43 offset:14336
    ds_read_b32 a231, v6
    v_cmp_lt_u32 vcc, 0xffff, v27
    v_mfma_f32_16x16x32_bf16 v[132:135], a[184:187], a[200:203], v[132:135]
    s_mul_i32 s66, s63, 96
    s_lshl_b32 s67, s65, 5
    s_lshl_b32 s70, s64, 2
    s_add_u32 s67, s67, s70
    s_add_u32 s67, s67, 384
    s_mul_i32 s71, s59, 448
    s_add_u32 s70, s66, s71
    v_mad_u32_u24 v22, v3, 24, s70
    s_add_u32 s70, s67, s71
    v_lshl_add_u32 v23, v3, 3, s70
    s_mov_b32 s34, 7168
    s_mov_b32 s35, 0x20000
    s_mov_b32 s26, 256
    s_mov_b32 s27, 0x20000
    s_lshl_b32 s77, s59, 4
    s_mov_b32 s18, 14680064
    s_mov_b32 s19, 0x20000
    s_sub_u32 s70, 1024, s71
    v_mul_u32_u24 v16, 464, v4
    v_add3_u32 v26, v22, v16, s70
    v_add3_u32 v28, v23, v16, s70
    s_lshl_b32 s70, s63, 9
    s_add_u32 s60, s70, 52992
    s_xor_b32 s70, s70, 512
    s_add_u32 s70, s70, 52992
    v_lshl_add_u32 v30, v2, 2, s70
    v_mul_u32_u24 v16, 2341, v2
    v_lshrrev_b32 v16, 16, v16
    s_mul_i32 s73, s63, 1856
    s_add_u32 s73, s73, 1024
    v_add_lshl_u32 v24, v2, v16, 4
    v_add_u32 v24, s73, v24
    s_lshl_b32 s74, s58, 7
    s_lshl_b32 s75, s63, 2
    s_add_u32 s74, s74, s75
    s_mul_i32 s74, s74, 7168
    s_add_u32 s74, s74, s71
    v_mul_u32_u24 v17, 6720, v16
    v_lshl_add_u32 v25, v2, 4, v17
    v_lshrrev_b32 v16, 1, v16
    v_lshlrev_b32 v16, 30, v16
    v_add3_u32 v25, v25, v16, s74
    v_mfma_f32_16x16x32_bf16 v[136:139], a[184:187], a[208:211], v[136:139]
    buffer_load_dwordx4 v36, s[8:11], s56 offen offset:0  lds
    v_mfma_f32_16x16x32_bf16 v[136:139], a[188:191], a[212:215], v[136:139]
    ds_read_b32 a64, v7
    ds_read_b32 a65, v29
    v_mfma_f32_16x16x32_bf16 v[140:143], a[188:191], a[220:223], v[140:143]
    v_perm_b32 v46, v82, v35, s38
    v_perm_b32 v31, v82, v35, s39
    v_mfma_f32_16x16x32_bf16 v[140:143], a[184:187], a[216:219], v[140:143]
    ds_read_b32 a66, v46
    v_perm_b32 v47, v86, v35, s36
    v_mfma_f32_16x16x32_bf16 v[144:147], a[184:187], a[232:235], v[144:147]
    ds_read_b32 a67, v31
    ds_read_b32 a68, v47
    v_mfma_f32_16x16x32_bf16 v[144:147], a[188:191], a[236:239], v[144:147]
    buffer_load_dwordx4 v37, s[8:11], s56 offen offset:1024  lds
    v_mfma_f32_16x16x32_bf16 v[148:151], a[188:191], a[244:247], v[148:151]
    s_waitcnt lgkmcnt(7)
    v_perm_b32 v56, v86, v35, s37
    v_perm_b32 v57, v86, v35, s38
    v_mfma_f32_16x16x32_bf16 v[148:151], a[184:187], a[240:243], v[148:151]
    ds_read_b32 a69, v56
    v_perm_b32 v58, v86, v35, s39
    v_mfma_f32_16x16x32_bf16 v[152:155], a[184:187], a[248:251], v[152:155]
    s_waitcnt lgkmcnt(6)
    ds_read_b32 a70, v57
    ds_read_b32 a71, v58
    v_mfma_f32_16x16x32_bf16 v[152:155], a[188:191], a[252:255], v[152:155]
    buffer_load_dwordx4 v38, s[8:11], s56 offen offset:2048  lds
    v_mfma_f32_16x16x32_bf16 v[156:159], a[188:191], a[36:39], v[156:159]
    v_perm_b32 v59, v83, v35, s36
    v_perm_b32 v60, v83, v35, s37
    v_mfma_f32_16x16x32_bf16 v[156:159], a[184:187], a[32:35], v[156:159]
    ds_read_b32 a80, v59
    v_perm_b32 v61, v87, v35, s36
    v_mfma_f32_16x16x32_bf16 v[160:163], a[224:227], a[192:195], v[160:163]
    ds_read_b32 a81, v60
    ds_read_b32 a82, v61
    v_mfma_f32_16x16x32_bf16 v[160:163], a[228:231], a[196:199], v[160:163]
    buffer_load_dwordx4 v39, s[8:11], s56 offen offset:3072  lds
    v_mfma_f32_16x16x32_bf16 v[164:167], a[228:231], a[204:207], v[164:167]
    v_perm_b32 v62, v87, v35, s37
    s_cbranch_vccnz L_slow1_1
L_back1_1:
    v_mfma_f32_16x16x32_bf16 v[164:167], a[224:227], a[200:203], v[164:167]
    s_add_u32 m0, s57, 16384
    v_perm_b32 v63, v88, v35, s36
    v_perm_b32 v5, v88, v35, s37
    v_mfma_f32_16x16x32_bf16 v[168:171], a[224:227], a[208:211], v[168:171]
    s_add_u32 s56, s55, 768
    ds_read_b32 a83, v62
    v_perm_b32 v6, v88, v35, s38
    v_mfma_f32_16x16x32_bf16 v[168:171], a[228:231], a[212:215], v[168:171]
    ds_read_b32 a0, v63
    v_perm_b32 v27, v88, v35, s39
    v_mfma_f32_16x16x32_bf16 v[172:175], a[228:231], a[220:223], v[172:175]
    ds_read_b32 a1, v5
    v_perm_b32 v7, v92, v35, s36
    v_mfma_f32_16x16x32_bf16 v[172:175], a[224:227], a[216:219], v[172:175]
    ds_read_b32 a2, v6
    v_perm_b32 v29, v92, v35, s37
    v_mfma_f32_16x16x32_bf16 v[176:179], a[224:227], a[232:235], v[176:179]
    ds_read_b32 a3, v27
    v_perm_b32 v46, v92, v35, s38
    v_mfma_f32_16x16x32_bf16 v[176:179], a[228:231], a[236:239], v[176:179]
    ds_read_b32 a4, v7
    v_perm_b32 v31, v92, v35, s39
    v_mfma_f32_16x16x32_bf16 v[180:183], a[228:231], a[244:247], v[180:183]
    ds_read_b32 a5, v29
    v_perm_b32 v47, v89, v35, s36
    v_mfma_f32_16x16x32_bf16 v[180:183], a[224:227], a[240:243], v[180:183]
    ds_read_b32 a6, v46
    ds_read_b32 a7, v31
    v_mfma_f32_16x16x32_bf16 v[184:187], a[224:227], a[248:251], v[184:187]
    buffer_load_dwordx4 v[64:67], v34, s[12:15], s41 offen sc1
    v_mfma_f32_16x16x32_bf16 v[184:187], a[228:231], a[252:255], v[184:187]
    ds_read_b32 a8, v47
    v_perm_b32 v56, v89, v35, s37
    v_mfma_f32_16x16x32_bf16 v[188:191], a[228:231], a[36:39], v[188:191]
    v_perm_b32 v57, v89, v35, s38
    v_perm_b32 v58, v89, v35, s39
    v_mfma_f32_16x16x32_bf16 v[188:191], a[224:227], a[32:35], v[188:191]
    s_waitcnt vmcnt(19) lgkmcnt(7)
    ds_read_b32 a9, v56
    ds_read_b32 a10, v57
    v_mfma_f32_16x16x32_bf16 v[192:195], a[64:67], a[192:195], v[192:195]
    buffer_load_dwordx4 v[68:71], v44, s[12:15], s41 offen sc1
    v_mfma_f32_16x16x32_bf16 v[192:195], a[68:71], a[196:199], v[192:195]
    s_barrier
    v_mfma_f32_16x16x32_bf16 v[196:199], a[68:71], a[204:207], v[196:199]
    ds_read_b32 a11, v58
    v_perm_b32 v59, v93, v35, s36
    v_mfma_f32_16x16x32_bf16 v[196:199], a[64:67], a[200:203], v[196:199]
    ds_read_b32 a12, v59
    ds_read_b128 a[16:19], v42 offset:16384
    v_mfma_f32_16x16x32_bf16 v[200:203], a[64:67], a[208:211], v[200:203]
    buffer_load_dwordx4 v[72:75], v32, s[12:15], s42 offen sc1
    v_mfma_f32_16x16x32_bf16 v[200:203], a[68:71], a[212:215], v[200:203]
    ds_read_b128 a[20:23], v43 offset:16384
    v_perm_b32 v60, v93, v35, s37
    v_mfma_f32_16x16x32_bf16 v[204:207], a[68:71], a[220:223], v[204:207]
    ds_read_b32 a13, v60
    v_perm_b32 v61, v93, v35, s38
    v_mfma_f32_16x16x32_bf16 v[204:207], a[64:67], a[216:219], v[204:207]
    ds_read_b32 a14, v61
    ds_read_b128 a[24:27], v42 offset:18432
    v_mfma_f32_16x16x32_bf16 v[208:211], a[64:67], a[232:235], v[208:211]
    buffer_load_dwordx4 v[76:79], v33, s[12:15], s42 offen sc1
    v_mfma_f32_16x16x32_bf16 v[208:211], a[68:71], a[236:239], v[208:211]
    ds_read_b128 a[28:31], v43 offset:18432
    v_perm_b32 v62, v93, v35, s39
    v_mfma_f32_16x16x32_bf16 v[212:215], a[68:71], a[244:247], v[212:215]
    ds_read_b32 a15, v62
    v_perm_b32 v63, v90, v35, s36
    v_mfma_f32_16x16x32_bf16 v[212:215], a[64:67], a[240:243], v[212:215]
    ds_read_b32 a48, v63
    ds_read_b128 a[40:43], v42 offset:20480
    v_mfma_f32_16x16x32_bf16 v[216:219], a[64:67], a[248:251], v[216:219]
    buffer_load_dwordx4 v36, s[8:11], s3 offen offset:0  lds
    v_mfma_f32_16x16x32_bf16 v[216:219], a[68:71], a[252:255], v[216:219]
    ds_read_b128 a[44:47], v43 offset:20480
    v_perm_b32 v5, v90, v35, s37
    v_mfma_f32_16x16x32_bf16 v[220:223], a[68:71], a[36:39], v[220:223]
    s_waitcnt vmcnt(19)
    ds_read_b32 a49, v5
    v_perm_b32 v6, v90, v35, s38
    v_mfma_f32_16x16x32_bf16 v[220:223], a[64:67], a[32:35], v[220:223]
    v_or_b32 v99, s47, v99
    v_lshl_or_b32 v96, v100, 4, v96
    v_lshl_or_b32 v97, v101, 4, v97
    v_lshl_or_b32 v98, v102, 4, v98
    v_lshl_or_b32 v99, v103, 4, v99
    s_waitcnt vmcnt(18)
    v_lshl_or_b32 v96, v104, 8, v96
    v_lshl_or_b32 v97, v105, 8, v97
    v_lshl_or_b32 v98, v106, 8, v98
    s_waitcnt vmcnt(17)
    v_lshl_or_b32 v99, v107, 8, v99
    s_waitcnt vmcnt(16)
    v_lshl_or_b32 v96, v108, 12, v96
    v_lshl_or_b32 v97, v109, 12, v97
    v_lshl_or_b32 v98, v110, 12, v98
    s_waitcnt vmcnt(15)
    v_lshl_or_b32 v99, v111, 12, v99
    s_waitcnt vmcnt(14)
    v_lshl_or_b32 v96, v112, 16, v96
    v_lshl_or_b32 v97, v113, 16, v97
    v_lshl_or_b32 v98, v114, 16, v98
    s_waitcnt vmcnt(13)
    v_lshl_or_b32 v96, v116, 20, v96
    v_lshl_or_b32 v97, v117, 20, v97
    v_lshl_or_b32 v98, v118, 20, v98
    s_waitcnt vmcnt(12)
    v_lshl_or_b32 v96, v120, 24, v96
L_pad1:
    s_cbranch_execz L_pad2
    v_lshl_or_b32 v97, v121, 24, v97
    v_lshl_or_b32 v98, v122, 24, v98
    s_waitcnt vmcnt(11)
    v_lshl_or_b32 v96, v124, 28, v96
    v_lshl_or_b32 v97, v125, 28, v97
    v_lshl_or_b32 v98, v126, 28, v98
    buffer_store_dwordx4 v[96:99], v20, s[12:15], s62 offen sc1
    v_mfma_f32_16x16x32_bf16 v[224:227], a[80:83], a[194:197], v[224:227]
    buffer_load_dwordx4 v37, s[8:11], s3 offen offset:1024  lds
    v_mfma_f32_16x16x32_bf16 v[228:231], a[80:83], a[202:205], v[228:231]
    ds_read_b32 a50, v6
    v_perm_b32 v27, v90, v35, s39
    v_mfma_f32_16x16x32_bf16 v[232:235], a[80:83], a[210:213], v[232:235]
    ds_read_b128 a[60:63], v43 offset:22528
    ds_read_b32 a51, v27
    v_mfma_f32_16x16x32_bf16 v[236:239], a[80:83], a[218:221], v[236:239]
    s_waitcnt vmcnt(11)
    ds_read_b128 a[56:59], v42 offset:22528
    v_perm_b32 v7, v94, v35, s36
    v_mfma_f32_16x16x32_bf16 v[240:243], a[80:83], a[234:237], v[240:243]
    ds_read_b128 a[72:75], v42 offset:24576
    ds_read_b32 a52, v7
    v_bitop3_b32 v29, v51, v55, s76 bitop3:0x7e
    v_mfma_f32_16x16x32_bf16 v[244:247], a[80:83], a[242:245], v[244:247]
    ds_read_b128 a[76:79], v43 offset:24576
    v_perm_b32 v46, v94, v35, s37
    v_cmp_lt_u32 vcc, 0xffff, v29
    v_mfma_f32_16x16x32_bf16 v[248:251], a[80:83], a[250:253], v[248:251]
    ds_read_b32 a53, v46
    v_perm_b32 v31, v94, v35, s38
    v_mfma_f32_16x16x32_bf16 v[252:255], a[80:83], a[34:37], v[252:255]
    s_waitcnt lgkmcnt(8)
    ds_read_b128 a[100:103], v43 offset:26624
    ds_read_b32 a54, v31
    v_mfma_f32_16x16x32_bf16 v[128:131], a[0:3], a[16:19], v[128:131]
    buffer_load_dwordx4 v38, s[8:11], s3 offen offset:2048  lds
    v_mfma_f32_16x16x32_bf16 v[128:131], a[4:7], a[20:23], v[128:131]
    ds_read_b128 a[96:99], v42 offset:26624
    s_cbranch_vccnz L_slow2_0
L_back2_0:
    v_mfma_f32_16x16x32_bf16 v[132:135], a[4:7], a[28:31], v[132:135]
    ds_read_b128 a[120:123], v42 offset:28672
    v_perm_b32 v47, v94, v35, s39
    v_mfma_f32_16x16x32_bf16 v[132:135], a[0:3], a[24:27], v[132:135]
    s_waitcnt lgkmcnt(8)
    ds_read_b128 a[124:127], v43 offset:28672
    ds_read_b32 a55, v47
    v_mfma_f32_16x16x32_bf16 v[136:139], a[0:3], a[40:43], v[136:139]
    buffer_load_dwordx4 v39, s[8:11], s3 offen offset:3072  lds
    v_mfma_f32_16x16x32_bf16 v[136:139], a[4:7], a[44:47], v[136:139]
    s_add_u32 m0, s57, 32768
    ds_read_b128 a[176:179], v42 offset:30720
    v_perm_b32 v56, v91, v35, s36
    v_mfma_f32_16x16x32_bf16 v[140:143], a[4:7], a[60:63], v[140:143]
    s_add_u32 s3, s69, 768
    v_perm_b32 v57, v91, v35, s37
    v_perm_b32 v58, v95, v35, s36
    v_mfma_f32_16x16x32_bf16 v[140:143], a[0:3], a[56:59], v[140:143]
    s_waitcnt lgkmcnt(7)
    ds_read_b128 a[180:183], v43 offset:30720
    ds_read_b32 a84, v56
    v_mfma_f32_16x16x32_bf16 v[144:147], a[0:3], a[72:75], v[144:147]
    buffer_load_dwordx4 v36, s[8:11], s56 offen offset:0  lds
    v_mfma_f32_16x16x32_bf16 v[144:147], a[4:7], a[76:79], v[144:147]
    s_waitcnt lgkmcnt(7)
    ds_read_b32 a85, v57
    v_perm_b32 v59, v95, v35, s37
    v_mfma_f32_16x16x32_bf16 v[148:151], a[4:7], a[100:103], v[148:151]
    s_waitcnt lgkmcnt(7)
    ds_read_b32 a86, v58
    v_perm_b32 v60, v48, v35, s36
    v_mfma_f32_16x16x32_bf16 v[148:151], a[0:3], a[96:99], v[148:151]
    s_waitcnt lgkmcnt(6)
    ds_read_b32 a87, v59
    ds_read_b32 a104, v60
    v_mfma_f32_16x16x32_bf16 v[152:155], a[0:3], a[120:123], v[152:155]
    buffer_load_dwordx4 v37, s[8:11], s56 offen offset:1024  lds
    v_mfma_f32_16x16x32_bf16 v[152:155], a[4:7], a[124:127], v[152:155]
    s_waitcnt lgkmcnt(5)
    v_perm_b32 v61, v48, v35, s37
    v_perm_b32 v62, v48, v35, s38
    v_mfma_f32_16x16x32_bf16 v[156:159], a[4:7], a[180:183], v[156:159]
    ds_read_b32 a105, v61
    v_perm_b32 v63, v48, v35, s39
    v_mfma_f32_16x16x32_bf16 v[156:159], a[0:3], a[176:179], v[156:159]
    ds_read_b32 a106, v62
    v_perm_b32 v5, v52, v35, s36
    v_mfma_f32_16x16x32_bf16 v[160:163], a[8:11], a[16:19], v[160:163]
    ds_read_b32 a107, v63
    ds_read_b32 a108, v5
    v_mfma_f32_16x16x32_bf16 v[160:163], a[12:15], a[20:23], v[160:163]
    buffer_load_dwordx4 v38, s[8:11], s56 offen offset:2048  lds
    v_mfma_f32_16x16x32_bf16 v[164:167], a[12:15], a[28:31], v[164:167]
    v_perm_b32 v6, v52, v35, s37
    v_perm_b32 v27, v52, v35, s38
    v_mfma_f32_16x16x32_bf16 v[164:167], a[8:11], a[24:27], v[164:167]
    ds_read_b32 a109, v6
    v_perm_b32 v7, v52, v35, s39
    v_mfma_f32_16x16x32_bf16 v[168:171], a[8:11], a[40:43], v[168:171]
    ds_read_b32 a110, v27
    v_perm_b32 v29, v49, v35, s36
    v_mfma_f32_16x16x32_bf16 v[168:171], a[12:15], a[44:47], v[168:171]
    ds_read_b32 a111, v7
    v_perm_b32 v46, v49, v35, s37
    v_mfma_f32_16x16x32_bf16 v[172:175], a[12:15], a[60:63], v[172:175]
    ds_read_b32 a112, v29
    v_perm_b32 v31, v49, v35, s38
    v_mfma_f32_16x16x32_bf16 v[172:175], a[8:11], a[56:59], v[172:175]
    ds_read_b32 a113, v46
    v_perm_b32 v47, v49, v35, s39
    v_mfma_f32_16x16x32_bf16 v[176:179], a[8:11], a[72:75], v[176:179]
    s_waitcnt vmcnt(12)
    ds_read_b32 a114, v31
    ds_read_b32 a115, v47
    v_mfma_f32_16x16x32_bf16 v[176:179], a[12:15], a[76:79], v[176:179]
    buffer_load_dwordx4 v39, s[8:11], s56 offen offset:3072  lds
    v_mfma_f32_16x16x32_bf16 v[180:183], a[12:15], a[100:103], v[180:183]
    s_barrier
    v_mfma_f32_16x16x32_bf16 v[180:183], a[8:11], a[96:99], v[180:183]
    s_add_u32 m0, s57, 49152
    ds_read_b128 a[128:131], v40 offset:0
    v_perm_b32 v56, v53, v35, s36
    v_mfma_f32_16x16x32_bf16 v[184:187], a[8:11], a[120:123], v[184:187]
    s_add_u32 s56, s55, 1024
    ds_read_b128 a[132:135], v41 offset:0
    v_perm_b32 v57, v53, v35, s37
    v_mfma_f32_16x16x32_bf16 v[184:187], a[12:15], a[124:127], v[184:187]
    ds_read_b128 a[140:143], v41 offset:2048
    v_perm_b32 v58, v53, v35, s38
    v_mfma_f32_16x16x32_bf16 v[188:191], a[12:15], a[180:183], v[188:191]
    ds_read_b128 a[136:139], v40 offset:2048
    v_perm_b32 v59, v53, v35, s39
    v_mfma_f32_16x16x32_bf16 v[188:191], a[8:11], a[176:179], v[188:191]
    ds_read_b128 a[144:147], v40 offset:4096
    ds_read_b32 a116, v56
    v_mfma_f32_16x16x32_bf16 v[192:195], a[48:51], a[16:19], v[192:195]
    buffer_load_dwordx4 v36, s[8:11], s3 offen offset:0  lds
    v_mfma_f32_16x16x32_bf16 v[192:195], a[52:55], a[20:23], v[192:195]
    ds_read_b128 a[148:151], v41 offset:4096
    ds_read_b32 a117, v57
    v_mfma_f32_16x16x32_bf16 v[196:199], a[52:55], a[28:31], v[196:199]
    s_waitcnt vmcnt(12)
    ds_read_b128 a[152:155], v40 offset:6144
    v_perm_b32 v60, v50, v35, s36
    v_mfma_f32_16x16x32_bf16 v[196:199], a[48:51], a[24:27], v[196:199]
    ds_read_b128 a[156:159], v41 offset:6144
    ds_read_b32 a118, v58
    v_bitop3_b32 v61, v67, v71, s76 bitop3:0x7e
    v_mfma_f32_16x16x32_bf16 v[200:203], a[48:51], a[40:43], v[200:203]
    ds_read_b32 a119, v59
    v_cmp_lt_u32 vcc, 0xffff, v61
    v_mfma_f32_16x16x32_bf16 v[200:203], a[52:55], a[44:47], v[200:203]
    v_perm_b32 v62, v50, v35, s37
    v_perm_b32 v63, v50, v35, s38
    v_mfma_f32_16x16x32_bf16 v[204:207], a[52:55], a[60:63], v[204:207]
    ds_read_b128 a[160:163], v40 offset:8192
    s_cbranch_vccnz L_slow2_1
L_back2_1:
    v_mfma_f32_16x16x32_bf16 v[204:207], a[48:51], a[56:59], v[204:207]
    buffer_load_dwordx4 v37, s[8:11], s3 offen offset:1024  lds
    v_mfma_f32_16x16x32_bf16 v[208:211], a[48:51], a[72:75], v[208:211]
    ds_read_b32 a88, v60
    v_perm_b32 v5, v50, v35, s39
    v_mfma_f32_16x16x32_bf16 v[208:211], a[52:55], a[76:79], v[208:211]
    ds_read_b128 a[164:167], v41 offset:8192
    v_perm_b32 v6, v54, v35, s36
    v_mfma_f32_16x16x32_bf16 v[212:215], a[52:55], a[100:103], v[212:215]
    ds_read_b32 a89, v62
    v_perm_b32 v27, v54, v35, s37
    v_mfma_f32_16x16x32_bf16 v[212:215], a[48:51], a[96:99], v[212:215]
    ds_read_b32 a90, v63
    v_perm_b32 v7, v54, v35, s38
    v_mfma_f32_16x16x32_bf16 v[216:219], a[48:51], a[120:123], v[216:219]
    ds_read_b128 a[168:171], v40 offset:10240
    v_perm_b32 v29, v54, v35, s39
    v_mfma_f32_16x16x32_bf16 v[216:219], a[52:55], a[124:127], v[216:219]
    ds_read_b32 a91, v5
    v_perm_b32 v46, v51, v35, s36
    v_mfma_f32_16x16x32_bf16 v[220:223], a[52:55], a[180:183], v[220:223]
    s_waitcnt lgkmcnt(7)
    ds_read_b32 a92, v6
    ds_read_b32 a93, v27
    v_mfma_f32_16x16x32_bf16 v[220:223], a[48:51], a[176:179], v[220:223]
    buffer_load_dwordx4 v38, s[8:11], s3 offen offset:2048  lds
    v_mfma_f32_16x16x32_bf16 v[224:227], a[84:87], a[18:21], v[224:227]
    ds_read_b128 a[172:175], v41 offset:10240
    v_perm_b32 v31, v51, v35, s37
    v_mfma_f32_16x16x32_bf16 v[228:231], a[84:87], a[26:29], v[228:231]
    ds_read_b32 a94, v7
    v_perm_b32 v47, v55, v35, s36
    v_mfma_f32_16x16x32_bf16 v[232:235], a[84:87], a[42:45], v[232:235]
    ds_read_b128 a[184:187], v40 offset:12288
    ds_read_b32 a95, v29
    v_mfma_f32_16x16x32_bf16 v[236:239], a[84:87], a[58:61], v[236:239]
    ds_read_b32 a224, v46
    v_perm_b32 v56, v55, v35, s37
    v_mfma_f32_16x16x32_bf16 v[240:243], a[84:87], a[74:77], v[240:243]
    ds_read_b32 a225, v31
    v_perm_b32 v57, v64, v35, s36
    v_mfma_f32_16x16x32_bf16 v[244:247], a[84:87], a[98:101], v[244:247]
    ds_read_b128 a[188:191], v41 offset:12288
    ds_read_b32 a226, v47
    v_mfma_f32_16x16x32_bf16 v[248:251], a[84:87], a[122:125], v[248:251]
    buffer_load_dwordx4 v39, s[8:11], s3 offen offset:3072  lds
    v_mfma_f32_16x16x32_bf16 v[252:255], a[84:87], a[178:181], v[252:255]
    s_add_u32 m0, s57, 65536
    v_perm_b32 v58, v64, v35, s37
    v_perm_b32 v59, v64, v35, s38
    v_mfma_f32_16x16x32_bf16 v[128:131], a[104:107], a[128:131], v[128:131]
    s_add_u32 s3, s69, 1024
    ds_read_b128 a[64:67], v40 offset:14336
    ds_read_b32 a227, v56
    v_mfma_f32_16x16x32_bf16 v[128:131], a[108:111], a[132:135], v[128:131]
    ds_read_b32 a192, v57
    v_perm_b32 v61, v64, v35, s39
    v_mfma_f32_16x16x32_bf16 v[132:135], a[108:111], a[140:143], v[132:135]
    ds_read_b128 a[68:71], v41 offset:14336
    ds_read_b32 a193, v58
    v_mfma_f32_16x16x32_bf16 v[132:135], a[104:107], a[136:139], v[132:135]
    buffer_load_dwordx4 v[80:83], v34, s[12:15], s42 offen sc1
    v_mfma_f32_16x16x32_bf16 v[136:139], a[104:107], a[144:147], v[136:139]
    v_perm_b32 v60, v68, v35, s36
    v_perm_b32 v62, v68, v35, s37
    v_mfma_f32_16x16x32_bf16 v[136:139], a[108:111], a[148:151], v[136:139]
    ds_read_b32 a194, v59
    v_perm_b32 v63, v68, v35, s38
    v_mfma_f32_16x16x32_bf16 v[140:143], a[108:111], a[156:159], v[140:143]
    ds_read_b32 a195, v61
    v_perm_b32 v5, v68, v35, s39
    v_mfma_f32_16x16x32_bf16 v[140:143], a[104:107], a[152:155], v[140:143]
    s_waitcnt lgkmcnt(7)
    ds_read_b32 a196, v60
    ds_read_b32 a197, v62
    v_mfma_f32_16x16x32_bf16 v[144:147], a[104:107], a[160:163], v[144:147]
    buffer_load_dwordx4 v[84:87], v44, s[12:15], s42 offen sc1
    v_mfma_f32_16x16x32_bf16 v[144:147], a[108:111], a[164:167], v[144:147]
    v_perm_b32 v6, v65, v35, s36
    v_perm_b32 v27, v65, v35, s37
    v_mfma_f32_16x16x32_bf16 v[148:151], a[108:111], a[172:175], v[148:151]
    s_waitcnt vmcnt(15)
    ds_read_b32 a198, v63
    v_bitop3_b32 v7, v75, v79, s76 bitop3:0x7e
    v_mfma_f32_16x16x32_bf16 v[148:151], a[104:107], a[168:171], v[148:151]
    ds_read_b32 a199, v5
    v_cmp_lt_u32 vcc, 0xffff, v7
    v_mfma_f32_16x16x32_bf16 v[152:155], a[104:107], a[184:187], v[152:155]
    v_perm_b32 v29, v65, v35, s38
    v_perm_b32 v46, v65, v35, s39
    v_mfma_f32_16x16x32_bf16 v[152:155], a[108:111], a[188:191], v[152:155]
    s_waitcnt lgkmcnt(6)
    ds_read_b32 a200, v6
    s_cbranch_vccnz L_slow3_0
L_back3_0:
    v_mfma_f32_16x16x32_bf16 v[156:159], a[108:111], a[68:71], v[156:159]
    ds_read_b32 a201, v27
    ds_read_b32 a202, v29
    v_mfma_f32_16x16x32_bf16 v[156:159], a[104:107], a[64:67], v[156:159]
    buffer_load_dwordx4 v36, s[8:11], s56 offen offset:0  lds
    v_mfma_f32_16x16x32_bf16 v[160:163], a[112:115], a[128:131], v[160:163]
    v_perm_b32 v31, v69, v35, s36
    v_perm_b32 v47, v69, v35, s37
    v_mfma_f32_16x16x32_bf16 v[160:163], a[116:119], a[132:135], v[160:163]
    ds_read_b32 a203, v46
    v_perm_b32 v56, v69, v35, s38
    v_mfma_f32_16x16x32_bf16 v[164:167], a[116:119], a[140:143], v[164:167]
    v_perm_b32 v57, v69, v35, s39
    v_perm_b32 v58, v66, v35, s36
    v_mfma_f32_16x16x32_bf16 v[164:167], a[112:115], a[136:139], v[164:167]
    ds_read_b32 a204, v31
    ds_read_b32 a205, v47
    v_mfma_f32_16x16x32_bf16 v[168:171], a[112:115], a[144:147], v[168:171]
    buffer_load_dwordx4 v[96:99], v32, s[12:15], s43 offen sc1
    v_mfma_f32_16x16x32_bf16 v[168:171], a[116:119], a[148:151], v[168:171]
    ds_read_b32 a206, v56
    v_perm_b32 v59, v66, v35, s37
    v_mfma_f32_16x16x32_bf16 v[172:175], a[116:119], a[156:159], v[172:175]
    ds_read_b32 a207, v57
    ds_read_b32 a208, v58
    v_mfma_f32_16x16x32_bf16 v[172:175], a[112:115], a[152:155], v[172:175]
    v_perm_b32 v61, v66, v35, s38
    v_perm_b32 v60, v66, v35, s39
    v_mfma_f32_16x16x32_bf16 v[176:179], a[112:115], a[160:163], v[176:179]
    ds_read_b32 a209, v59
    ds_read_b32 a210, v61
    v_mfma_f32_16x16x32_bf16 v[176:179], a[116:119], a[164:167], v[176:179]
    buffer_load_dwordx4 v[100:103], v33, s[12:15], s43 offen sc1
    v_mfma_f32_16x16x32_bf16 v[180:183], a[116:119], a[172:175], v[180:183]
    ds_read_b32 a211, v60
    v_perm_b32 v62, v70, v35, s36
    v_mfma_f32_16x16x32_bf16 v[180:183], a[112:115], a[168:171], v[180:183]
    ds_read_b32 a212, v62
    v_perm_b32 v63, v70, v35, s37
    v_mfma_f32_16x16x32_bf16 v[184:187], a[112:115], a[184:187], v[184:187]
    ds_read_b32 a213, v63
    v_perm_b32 v5, v70, v35, s38
    v_mfma_f32_16x16x32_bf16 v[184:187], a[116:119], a[188:191], v[184:187]
    ds_read_b32 a214, v5
    v_perm_b32 v7, v70, v35, s39
    v_mfma_f32_16x16x32_bf16 v[188:191], a[116:119], a[68:71], v[188:191]
    v_perm_b32 v6, v67, v35, s36
    v_perm_b32 v27, v67, v35, s37
    v_mfma_f32_16x16x32_bf16 v[188:191], a[112:115], a[64:67], v[188:191]
    s_waitcnt vmcnt(13)
    ds_read_b32 a215, v7
    ds_read_b32 a228, v6
    v_mfma_f32_16x16x32_bf16 v[192:195], a[88:91], a[128:131], v[192:195]
    buffer_load_dwordx4 v37, s[8:11], s56 offen offset:1024  lds
    v_mfma_f32_16x16x32_bf16 v[192:195], a[92:95], a[132:135], v[192:195]
    s_barrier
    v_mfma_f32_16x16x32_bf16 v[196:199], a[92:95], a[140:143], v[196:199]
    ds_read_b32 a229, v27
    v_perm_b32 v29, v71, v35, s36
    v_mfma_f32_16x16x32_bf16 v[196:199], a[88:91], a[136:139], v[196:199]
    ds_read_b32 a230, v29
    v_perm_b32 v46, v71, v35, s37
    v_mfma_f32_16x16x32_bf16 v[200:203], a[88:91], a[144:147], v[200:203]
    ds_read_b32 a231, v46
    v_perm_b32 v31, v72, v35, s36
    v_mfma_f32_16x16x32_bf16 v[200:203], a[92:95], a[148:151], v[200:203]
    ds_read_b32 a216, v31
    v_perm_b32 v47, v72, v35, s37
    v_mfma_f32_16x16x32_bf16 v[204:207], a[92:95], a[156:159], v[204:207]
    ds_read_b128 a[232:235], v40 offset:16384
    ds_read_b32 a217, v47
    v_mfma_f32_16x16x32_bf16 v[204:207], a[88:91], a[152:155], v[204:207]
    buffer_load_dwordx4 v38, s[8:11], s56 offen offset:2048  lds
    v_mfma_f32_16x16x32_bf16 v[208:211], a[88:91], a[160:163], v[208:211]
    ds_read_b128 a[236:239], v41 offset:16384
    v_perm_b32 v56, v72, v35, s38
    v_mfma_f32_16x16x32_bf16 v[208:211], a[92:95], a[164:167], v[208:211]
    ds_read_b32 a218, v56
    v_perm_b32 v57, v72, v35, s39
    v_mfma_f32_16x16x32_bf16 v[212:215], a[92:95], a[172:175], v[212:215]
    ds_read_b128 a[240:243], v40 offset:18432
    v_perm_b32 v58, v76, v35, s36
    v_mfma_f32_16x16x32_bf16 v[212:215], a[88:91], a[168:171], v[212:215]
    ds_read_b32 a219, v57
    v_perm_b32 v59, v76, v35, s37
    v_mfma_f32_16x16x32_bf16 v[216:219], a[88:91], a[184:187], v[216:219]
    ds_read_b128 a[244:247], v41 offset:18432
    v_perm_b32 v61, v76, v35, s38
    v_mfma_f32_16x16x32_bf16 v[216:219], a[92:95], a[188:191], v[216:219]
    ds_read_b32 a220, v58
    ds_read_b32 a221, v59
    v_mfma_f32_16x16x32_bf16 v[220:223], a[92:95], a[68:71], v[220:223]
    ds_read_b128 a[248:251], v40 offset:20480
    ds_read_b32 a222, v61
    v_mfma_f32_16x16x32_bf16 v[220:223], a[88:91], a[64:67], v[220:223]
    buffer_load_dwordx4 v39, s[8:11], s56 offen offset:3072  lds
    v_mfma_f32_16x16x32_bf16 v[224:227], a[224:227], a[130:133], v[224:227]
    s_add_u32 m0, s57, 81920
    ds_read_b128 a[252:255], v41 offset:20480
    v_perm_b32 v60, v76, v35, s39
    v_mfma_f32_16x16x32_bf16 v[228:231], a[224:227], a[138:141], v[228:231]
    ds_read_b32 a223, v60
    v_perm_b32 v62, v73, v35, s36
    v_mfma_f32_16x16x32_bf16 v[232:235], a[224:227], a[146:149], v[232:235]
    ds_read_b128 a[36:39], v41 offset:22528
    v_perm_b32 v63, v73, v35, s37
    v_mfma_f32_16x16x32_bf16 v[236:239], a[224:227], a[154:157], v[236:239]
    ds_read_b128 a[32:35], v40 offset:22528
    v_perm_b32 v5, v73, v35, s38
    v_mfma_f32_16x16x32_bf16 v[240:243], a[224:227], a[162:165], v[240:243]
    ds_read_b128 a[0:3], v40 offset:24576
    ds_read_b32 a8, v62
    v_mfma_f32_16x16x32_bf16 v[244:247], a[224:227], a[170:173], v[244:247]
    ds_read_b128 a[4:7], v41 offset:24576
    ds_read_b32 a9, v63
    v_mfma_f32_16x16x32_bf16 v[248:251], a[224:227], a[186:189], v[248:251]
    buffer_load_dwordx4 v36, s[8:11], s3 offen offset:0  lds
    v_mfma_f32_16x16x32_bf16 v[252:255], a[224:227], a[66:69], v[252:255]
    s_waitcnt lgkmcnt(8)
    ds_read_b128 a[52:55], v41 offset:26624
    v_perm_b32 v7, v73, v35, s39
    v_mfma_f32_16x16x32_bf16 v[128:131], a[192:195], a[232:235], v[128:131]
    ds_read_b128 a[48:51], v40 offset:26624
    ds_read_b32 a10, v5
    v_mfma_f32_16x16x32_bf16 v[128:131], a[196:199], a[236:239], v[128:131]
    ds_read_b128 a[16:19], v40 offset:28672
    v_perm_b32 v6, v77, v35, s36
    v_mfma_f32_16x16x32_bf16 v[132:135], a[196:199], a[244:247], v[132:135]
    s_add_u32 s56, s55, 1280
    ds_read_b32 a11, v7
    v_perm_b32 v27, v77, v35, s37
    v_mfma_f32_16x16x32_bf16 v[132:135], a[192:195], a[240:243], v[132:135]
    ds_read_b128 a[20:23], v41 offset:28672
    v_perm_b32 v29, v77, v35, s38
    v_mfma_f32_16x16x32_bf16 v[136:139], a[192:195], a[248:251], v[136:139]
    s_waitcnt lgkmcnt(10)
    ds_read_b32 a12, v6
    ds_read_b32 a13, v27
    v_mfma_f32_16x16x32_bf16 v[136:139], a[196:199], a[252:255], v[136:139]
    buffer_load_dwordx4 v37, s[8:11], s3 offen offset:1024  lds
    v_mfma_f32_16x16x32_bf16 v[140:143], a[196:199], a[36:39], v[140:143]
    ds_read_b128 a[24:27], v40 offset:30720
    v_perm_b32 v46, v77, v35, s39
    v_mfma_f32_16x16x32_bf16 v[140:143], a[192:195], a[32:35], v[140:143]
    s_waitcnt lgkmcnt(9)
    ds_read_b128 a[28:31], v41 offset:30720
    v_perm_b32 v31, v74, v35, s36
    v_mfma_f32_16x16x32_bf16 v[144:147], a[192:195], a[0:3], v[144:147]
    ds_read_b32 a14, v29
    v_perm_b32 v47, v74, v35, s37
    v_mfma_f32_16x16x32_bf16 v[144:147], a[196:199], a[4:7], v[144:147]
    s_waitcnt lgkmcnt(8)
    ds_read_b32 a15, v46
    v_perm_b32 v56, v74, v35, s38
    v_mfma_f32_16x16x32_bf16 v[148:151], a[196:199], a[52:55], v[148:151]
    ds_read_b32 a40, v31
    v_perm_b32 v57, v74, v35, s39
    v_mfma_f32_16x16x32_bf16 v[148:151], a[192:195], a[48:51], v[148:151]
    s_waitcnt lgkmcnt(8)
    ds_read_b32 a41, v47
    v_perm_b32 v58, v78, v35, s36
    v_mfma_f32_16x16x32_bf16 v[152:155], a[192:195], a[16:19], v[152:155]
    s_waitcnt lgkmcnt(8)
    ds_read_b32 a42, v56
    ds_read_b32 a43, v57
    v_mfma_f32_16x16x32_bf16 v[152:155], a[196:199], a[20:23], v[152:155]
    s_waitcnt lgkmcnt(6)
    buffer_load_dwordx4 v38, s[8:11], s3 offen offset:2048  lds
    v_mfma_f32_16x16x32_bf16 v[156:159], a[196:199], a[28:31], v[156:159]
    ds_read_b32 a44, v58
    v_perm_b32 v59, v78, v35, s37
    v_mfma_f32_16x16x32_bf16 v[156:159], a[192:195], a[24:27], v[156:159]
    ds_read_b32 a45, v59
    v_perm_b32 v61, v78, v35, s38
    v_mfma_f32_16x16x32_bf16 v[160:163], a[200:203], a[232:235], v[160:163]
    ds_read_b32 a46, v61
    v_perm_b32 v60, v78, v35, s39
    v_mfma_f32_16x16x32_bf16 v[160:163], a[204:207], a[236:239], v[160:163]
    v_perm_b32 v62, v75, v35, s36
    v_perm_b32 v63, v75, v35, s37
    v_mfma_f32_16x16x32_bf16 v[164:167], a[204:207], a[244:247], v[164:167]
    ds_read_b32 a47, v60
    ds_read_b32 a56, v62
    v_mfma_f32_16x16x32_bf16 v[164:167], a[200:203], a[240:243], v[164:167]
    buffer_load_dwordx4 v[104:107], v34, s[12:15], s43 offen sc1
    v_mfma_f32_16x16x32_bf16 v[168:171], a[200:203], a[248:251], v[168:171]
    s_waitcnt vmcnt(12)
    ds_read_b32 a57, v63
    v_perm_b32 v5, v79, v35, s36
    v_mfma_f32_16x16x32_bf16 v[168:171], a[204:207], a[252:255], v[168:171]
    s_barrier
    v_mfma_f32_16x16x32_bf16 v[172:175], a[204:207], a[36:39], v[172:175]
    ds_read_b128 a[72:75], v40 offset:32768
    v_perm_b32 v7, v79, v35, s37
    v_mfma_f32_16x16x32_bf16 v[172:175], a[200:203], a[32:35], v[172:175]
    ds_read_b128 a[76:79], v41 offset:32768
    ds_read_b32 a58, v5
    v_mfma_f32_16x16x32_bf16 v[176:179], a[200:203], a[0:3], v[176:179]
    buffer_load_dwordx4 v[108:111], v44, s[12:15], s43 offen sc1
    v_mfma_f32_16x16x32_bf16 v[176:179], a[204:207], a[4:7], v[176:179]
    ds_read_b128 a[100:103], v41 offset:34816
    ds_read_b32 a59, v7
    v_mfma_f32_16x16x32_bf16 v[180:183], a[204:207], a[52:55], v[180:183]
    ds_read_b128 a[96:99], v40 offset:34816
    v_mfma_f32_16x16x32_bf16 v[180:183], a[200:203], a[48:51], v[180:183]
    ds_read_b128 a[120:123], v40 offset:36864
    v_mfma_f32_16x16x32_bf16 v[184:187], a[200:203], a[16:19], v[184:187]
    ds_read_b128 a[124:127], v41 offset:36864
    v_mfma_f32_16x16x32_bf16 v[184:187], a[204:207], a[20:23], v[184:187]
    s_waitcnt vmcnt(11)
    ds_read_b128 a[80:83], v40 offset:38912
    v_mfma_f32_16x16x32_bf16 v[188:191], a[204:207], a[28:31], v[188:191]
    buffer_load_dwordx4 v39, s[8:11], s3 offen offset:3072  lds
    v_mfma_f32_16x16x32_bf16 v[188:191], a[200:203], a[24:27], v[188:191]
    s_add_u32 m0, s57, 0
    ds_read_b128 a[84:87], v41 offset:38912
    v_bitop3_b32 v6, v83, v87, s76 bitop3:0x7e
    v_mfma_f32_16x16x32_bf16 v[192:195], a[208:211], a[232:235], v[192:195]
    s_add_u32 s3, s69, 1280
    v_cmp_lt_u32 vcc, 0xffff, v6
    v_mfma_f32_16x16x32_bf16 v[192:195], a[212:215], a[236:239], v[192:195]
    ds_read_b128 a[176:179], v40 offset:40960
    v_mfma_f32_16x16x32_bf16 v[196:199], a[212:215], a[244:247], v[196:199]
    s_cbranch_vccnz L_slow3_1
L_back3_1:
    v_mfma_f32_16x16x32_bf16 v[196:199], a[208:211], a[240:243], v[196:199]
    buffer_load_dwordx4 v[112:115], v32, s[12:15], s44 offen sc1
    v_mfma_f32_16x16x32_bf16 v[200:203], a[208:211], a[248:251], v[200:203]
    v_perm_b32 v27, v83, v35, s36
    v_perm_b32 v29, v83, v35, s37
    v_mfma_f32_16x16x32_bf16 v[200:203], a[212:215], a[252:255], v[200:203]
    v_perm_b32 v46, v87, v35, s36
    v_perm_b32 v31, v87, v35, s37
    v_mfma_f32_16x16x32_bf16 v[204:207], a[212:215], a[36:39], v[204:207]
    ds_read_b32 a60, v27
    ds_read_b32 a61, v29
    v_mfma_f32_16x16x32_bf16 v[204:207], a[208:211], a[32:35], v[204:207]
    buffer_load_dwordx4 v[116:119], v33, s[12:15], s44 offen sc1
    v_mfma_f32_16x16x32_bf16 v[208:211], a[208:211], a[0:3], v[208:211]
    v_perm_b32 v47, v80, v35, s36
    v_perm_b32 v56, v80, v35, s37
    v_mfma_f32_16x16x32_bf16 v[208:211], a[212:215], a[4:7], v[208:211]
    ds_read_b128 a[180:183], v41 offset:40960
    v_perm_b32 v57, v80, v35, s38
    v_mfma_f32_16x16x32_bf16 v[212:215], a[212:215], a[52:55], v[212:215]
    v_perm_b32 v58, v80, v35, s39
    v_perm_b32 v59, v84, v35, s36
    v_mfma_f32_16x16x32_bf16 v[212:215], a[208:211], a[48:51], v[212:215]
    v_perm_b32 v61, v84, v35, s37
    v_perm_b32 v60, v84, v35, s38
    v_mfma_f32_16x16x32_bf16 v[216:219], a[208:211], a[16:19], v[216:219]
    ds_read_b128 a[104:107], v40 offset:43008
    ds_read_b32 a62, v46
    v_mfma_f32_16x16x32_bf16 v[216:219], a[212:215], a[20:23], v[216:219]
    ds_read_b32 a63, v31
    v_perm_b32 v62, v84, v35, s39
    v_mfma_f32_16x16x32_bf16 v[220:223], a[212:215], a[28:31], v[220:223]
    ds_read_b32 a112, v47
    ds_read_b32 a113, v56
    v_mfma_f32_16x16x32_bf16 v[220:223], a[208:211], a[24:27], v[220:223]
    buffer_load_dwordx4 v36, s[8:11], s56 offen offset:0  lds
    v_mfma_f32_16x16x32_bf16 v[224:227], a[228:231], a[234:237], v[224:227]
    s_waitcnt vmcnt(12)
    ds_read_b128 a[108:111], v41 offset:43008
    v_bitop3_b32 v63, v99, v103, s76 bitop3:0x7e
    v_mfma_f32_16x16x32_bf16 v[228:231], a[228:231], a[242:245], v[228:231]
    v_cmp_lt_u32 vcc, 0xffff, v63
    v_perm_b32 v5, v81, v35, s36
    v_mfma_f32_16x16x32_bf16 v[232:235], a[228:231], a[250:253], v[232:235]
    ds_read_b128 a[88:91], v40 offset:45056
    v_perm_b32 v7, v81, v35, s37
    v_mfma_f32_16x16x32_bf16 v[236:239], a[228:231], a[34:37], v[236:239]
    ds_read_b32 a114, v57
    s_cbranch_vccnz L_slow4_0
L_back4_0:
    v_mfma_f32_16x16x32_bf16 v[240:243], a[228:231], a[2:5], v[240:243]
    ds_read_b32 a115, v58
    ds_read_b32 a116, v59
    v_mfma_f32_16x16x32_bf16 v[244:247], a[228:231], a[50:53], v[244:247]
    ds_read_b128 a[92:95], v41 offset:45056
    ds_read_b32 a117, v61
    v_mfma_f32_16x16x32_bf16 v[248:251], a[228:231], a[18:21], v[248:251]
    buffer_load_dwordx4 v37, s[8:11], s56 offen offset:1024  lds
L_pad2:
    s_cbranch_execz L_pad3
    v_mfma_f32_16x16x32_bf16 v[252:255], a[228:231], a[26:29], v[252:255]
    s_waitcnt lgkmcnt(7)
    ds_read_b32 a118, v60
    v_perm_b32 v6, v81, v35, s38
    v_mfma_f32_16x16x32_bf16 v[128:131], a[216:219], a[72:75], v[128:131]
    ds_read_b128 a[128:131], v40 offset:47104
    v_perm_b32 v27, v81, v35, s39
    v_mfma_f32_16x16x32_bf16 v[128:131], a[220:223], a[76:79], v[128:131]
    ds_read_b32 a119, v62
    v_perm_b32 v29, v85, v35, s36
    v_mfma_f32_16x16x32_bf16 v[132:135], a[220:223], a[100:103], v[132:135]
    ds_read_b128 a[132:135], v41 offset:47104
    v_perm_b32 v46, v85, v35, s37
    v_mfma_f32_16x16x32_bf16 v[132:135], a[216:219], a[96:99], v[132:135]
    ds_read_b32 a136, v5
    v_perm_b32 v31, v85, v35, s38
    v_mfma_f32_16x16x32_bf16 v[136:139], a[216:219], a[120:123], v[136:139]
    ds_read_b32 a137, v7
    v_perm_b32 v47, v85, v35, s39
    v_mfma_f32_16x16x32_bf16 v[136:139], a[220:223], a[124:127], v[136:139]
    v_perm_b32 v56, v82, v35, s36
    v_perm_b32 v63, v82, v35, s37
    v_mfma_f32_16x16x32_bf16 v[140:143], a[220:223], a[84:87], v[140:143]
    ds_read_b32 a138, v6
    v_perm_b32 v57, v82, v35, s38
    v_mfma_f32_16x16x32_bf16 v[140:143], a[216:219], a[80:83], v[140:143]
    ds_read_b32 a139, v27
    v_perm_b32 v58, v82, v35, s39
    v_mfma_f32_16x16x32_bf16 v[144:147], a[216:219], a[176:179], v[144:147]
    s_waitcnt lgkmcnt(7)
    ds_read_b32 a140, v29
    ds_read_b32 a141, v46
    v_mfma_f32_16x16x32_bf16 v[144:147], a[220:223], a[180:183], v[144:147]
    buffer_load_dwordx4 v[120:123], v34, s[12:15], s44 offen sc1
    v_mfma_f32_16x16x32_bf16 v[148:151], a[220:223], a[108:111], v[148:151]
    ds_read_b32 a142, v31
    v_perm_b32 v59, v86, v35, s36
    v_mfma_f32_16x16x32_bf16 v[148:151], a[216:219], a[104:107], v[148:151]
    ds_read_b32 a143, v47
    v_perm_b32 v61, v86, v35, s37
    v_mfma_f32_16x16x32_bf16 v[152:155], a[216:219], a[88:91], v[152:155]
    s_waitcnt lgkmcnt(7)
    ds_read_b128 a[144:147], v40 offset:49152
    ds_read_b32 a152, v56
    v_mfma_f32_16x16x32_bf16 v[152:155], a[220:223], a[92:95], v[152:155]
    buffer_load_dwordx4 v[124:127], v44, s[12:15], s44 offen sc1
    v_mfma_f32_16x16x32_bf16 v[156:159], a[220:223], a[132:135], v[156:159]
    ds_read_b128 a[148:151], v41 offset:49152
    v_perm_b32 v60, v86, v35, s38
    v_mfma_f32_16x16x32_bf16 v[156:159], a[216:219], a[128:131], v[156:159]
    ds_read_b128 a[160:163], v40 offset:51200
    ds_read_b32 a153, v63
    v_mfma_f32_16x16x32_bf16 v[160:163], a[8:11], a[72:75], v[160:163]
    ds_read_b128 a[164:167], v41 offset:51200
    ds_read_b32 a154, v57
    v_mfma_f32_16x16x32_bf16 v[160:163], a[12:15], a[76:79], v[160:163]
    buffer_load_dwordx4 v38, s[8:11], s56 offen offset:2048  lds
    v_mfma_f32_16x16x32_bf16 v[164:167], a[12:15], a[100:103], v[164:167]
    ds_read_b128 a[168:171], v40 offset:53248
    v_perm_b32 v62, v86, v35, s39
    v_mfma_f32_16x16x32_bf16 v[164:167], a[8:11], a[96:99], v[164:167]
    ds_read_b32 a155, v58
    v_perm_b32 v5, v96, v35, s36
    v_mfma_f32_16x16x32_bf16 v[168:171], a[8:11], a[120:123], v[168:171]
    ds_read_b32 a156, v59
    v_perm_b32 v7, v96, v35, s37
    v_mfma_f32_16x16x32_bf16 v[168:171], a[12:15], a[124:127], v[168:171]
    ds_read_b128 a[172:175], v41 offset:53248
    ds_read_b32 a157, v61
    v_mfma_f32_16x16x32_bf16 v[172:175], a[12:15], a[84:87], v[172:175]
    buffer_load_dwordx4 v39, s[8:11], s56 offen offset:3072  lds
    v_mfma_f32_16x16x32_bf16 v[172:175], a[8:11], a[80:83], v[172:175]
    s_add_u32 m0, s57, 16384
    v_perm_b32 v6, v96, v35, s38
    v_perm_b32 v27, v96, v35, s39
    v_mfma_f32_16x16x32_bf16 v[176:179], a[8:11], a[176:179], v[176:179]
    ds_read_b128 a[184:187], v40 offset:55296
    ds_read_b32 a158, v60
    v_mfma_f32_16x16x32_bf16 v[176:179], a[12:15], a[180:183], v[176:179]
    v_perm_b32 v29, v100, v35, s36
    v_perm_b32 v46, v100, v35, s37
    v_mfma_f32_16x16x32_bf16 v[180:183], a[12:15], a[108:111], v[180:183]
    ds_read_b32 a159, v62
    v_perm_b32 v31, v100, v35, s38
    v_mfma_f32_16x16x32_bf16 v[180:183], a[8:11], a[104:107], v[180:183]
    ds_read_b128 a[188:191], v41 offset:55296
    v_perm_b32 v47, v100, v35, s39
    v_mfma_f32_16x16x32_bf16 v[184:187], a[8:11], a[88:91], v[184:187]
    ds_read_b32 a64, v5
    ds_read_b32 a65, v7
    v_mfma_f32_16x16x32_bf16 v[184:187], a[12:15], a[92:95], v[184:187]
    ds_read_b32 a66, v6
    ds_read_b32 a67, v27
    v_mfma_f32_16x16x32_bf16 v[188:191], a[12:15], a[132:135], v[188:191]
    buffer_load_dwordx4 v36, s[8:11], s3 offen offset:0  lds
    v_mfma_f32_16x16x32_bf16 v[188:191], a[8:11], a[128:131], v[188:191]
    ds_read_b128 a[192:195], v40 offset:57344
    v_perm_b32 v56, v97, v35, s36
    v_mfma_f32_16x16x32_bf16 v[192:195], a[40:43], a[72:75], v[192:195]
    v_perm_b32 v63, v97, v35, s37
    v_perm_b32 v57, v97, v35, s38
    v_mfma_f32_16x16x32_bf16 v[192:195], a[44:47], a[76:79], v[192:195]
    ds_read_b128 a[196:199], v41 offset:57344
    v_perm_b32 v58, v97, v35, s39
    v_mfma_f32_16x16x32_bf16 v[196:199], a[44:47], a[100:103], v[196:199]
    ds_read_b32 a68, v29
    ds_read_b32 a69, v46
    v_mfma_f32_16x16x32_bf16 v[196:199], a[40:43], a[96:99], v[196:199]
    ds_read_b32 a70, v31
    v_perm_b32 v59, v101, v35, s36
    v_mfma_f32_16x16x32_bf16 v[200:203], a[40:43], a[120:123], v[200:203]
    ds_read_b128 a[200:203], v40 offset:59392
    ds_read_b32 a71, v47
    v_mfma_f32_16x16x32_bf16 v[200:203], a[44:47], a[124:127], v[200:203]
    buffer_load_dwordx4 v37, s[8:11], s3 offen offset:1024  lds
    v_mfma_f32_16x16x32_bf16 v[204:207], a[44:47], a[84:87], v[204:207]
    v_perm_b32 v61, v101, v35, s37
    v_perm_b32 v60, v101, v35, s38
    v_mfma_f32_16x16x32_bf16 v[204:207], a[40:43], a[80:83], v[204:207]
    ds_read_b128 a[204:207], v41 offset:59392
    ds_read_b32 a208, v56
    v_mfma_f32_16x16x32_bf16 v[208:211], a[40:43], a[176:179], v[208:211]
    ds_read_b32 a209, v63
    v_perm_b32 v62, v101, v35, s39
    v_mfma_f32_16x16x32_bf16 v[208:211], a[44:47], a[180:183], v[208:211]
    ds_read_b32 a210, v57
    v_perm_b32 v5, v98, v35, s36
    v_mfma_f32_16x16x32_bf16 v[212:215], a[44:47], a[108:111], v[212:215]
    ds_read_b128 a[232:235], v40 offset:61440
    ds_read_b32 a211, v58
    v_mfma_f32_16x16x32_bf16 v[212:215], a[40:43], a[104:107], v[212:215]
    ds_read_b32 a212, v59
    ds_read_b32 a213, v61
    v_mfma_f32_16x16x32_bf16 v[216:219], a[40:43], a[88:91], v[216:219]
    buffer_load_dwordx4 v38, s[8:11], s3 offen offset:2048  lds
    v_mfma_f32_16x16x32_bf16 v[216:219], a[44:47], a[92:95], v[216:219]
    s_waitcnt vmcnt(12)
    ds_read_b128 a[236:239], v41 offset:61440
    v_bitop3_b32 v7, v107, v111, s76 bitop3:0x7e
    v_mfma_f32_16x16x32_bf16 v[220:223], a[44:47], a[132:135], v[220:223]
    v_cmp_lt_u32 vcc, 0xffff, v7
    v_perm_b32 v6, v98, v35, s37
    v_mfma_f32_16x16x32_bf16 v[220:223], a[40:43], a[128:131], v[220:223]
    v_perm_b32 v27, v98, v35, s38
    v_perm_b32 v29, v98, v35, s39
    v_mfma_f32_16x16x32_bf16 v[224:227], a[56:59], a[74:77], v[224:227]
    s_waitcnt lgkmcnt(7)
    ds_read_b128 a[240:243], v40 offset:63488
    s_cbranch_vccnz L_slow4_1
L_back4_1:
    v_mfma_f32_16x16x32_bf16 v[224:227], a[60:63], a[146:149], v[224:227]
    ds_read_b32 a214, v60
    v_perm_b32 v46, v102, v35, s36
    v_mfma_f32_16x16x32_bf16 v[228:231], a[60:63], a[162:165], v[228:231]
    ds_read_b128 a[244:247], v41 offset:63488
    ds_read_b32 a215, v62
    v_mfma_f32_16x16x32_bf16 v[228:231], a[56:59], a[98:101], v[228:231]
    ds_read_b32 a248, v5
    ds_read_b32 a249, v6
    v_mfma_f32_16x16x32_bf16 v[232:235], a[56:59], a[122:125], v[232:235]
    buffer_load_dwordx4 v[88:91], v32, s[12:15], s45 offen sc1
    v_mfma_f32_16x16x32_bf16 v[232:235], a[60:63], a[170:173], v[232:235]
    v_perm_b32 v31, v102, v35, s37
    v_perm_b32 v47, v102, v35, s38
    v_mfma_f32_16x16x32_bf16 v[236:239], a[60:63], a[186:189], v[236:239]
    v_perm_b32 v56, v102, v35, s39
    v_perm_b32 v63, v99, v35, s36
    v_mfma_f32_16x16x32_bf16 v[236:239], a[56:59], a[82:85], v[236:239]
    ds_read_b32 a250, v27
    ds_read_b32 a251, v29
    v_mfma_f32_16x16x32_bf16 v[240:243], a[56:59], a[178:181], v[240:243]
    buffer_load_dwordx4 v[92:95], v33, s[12:15], s45 offen sc1
    v_mfma_f32_16x16x32_bf16 v[240:243], a[60:63], a[194:197], v[240:243]
    v_perm_b32 v57, v99, v35, s37
    v_perm_b32 v58, v103, v35, s36
    v_mfma_f32_16x16x32_bf16 v[244:247], a[60:63], a[202:205], v[244:247]
    ds_read_b32 a252, v46
    v_perm_b32 v59, v103, v35, s37
    v_mfma_f32_16x16x32_bf16 v[244:247], a[56:59], a[106:109], v[244:247]
    s_waitcnt vmcnt(13) lgkmcnt(5)
    v_perm_b32 v61, v107, v35, s36
    v_perm_b32 v7, v107, v35, s37
    v_mfma_f32_16x16x32_bf16 v[248:251], a[56:59], a[90:93], v[248:251]
    s_barrier
    v_mfma_f32_16x16x32_bf16 v[248:251], a[60:63], a[234:237], v[248:251]
    buffer_load_dwordx4 v39, s[8:11], s3 offen offset:3072  lds
    v_mfma_f32_16x16x32_bf16 v[252:255], a[60:63], a[242:245], v[252:255]
    s_add_u32 s56, s55, 1536
    ds_read_b32 a253, v31
    ds_read_b32 a254, v47
    v_mfma_f32_16x16x32_bf16 v[252:255], a[56:59], a[130:133], v[252:255]
    ds_read_b32 a255, v56
    ds_read_b32 a32, v63
    v_mfma_f32_16x16x32_bf16 v[128:131], a[112:115], a[144:147], v[128:131]
    v_perm_b32 v60, v111, v35, s36
    v_perm_b32 v62, v111, v35, s37
    v_mfma_f32_16x16x32_bf16 v[128:131], a[116:119], a[148:151], v[128:131]
    s_add_u32 m0, s57, 32768
    ds_read_b32 a33, v57
    ds_read_b32 a34, v58
    v_mfma_f32_16x16x32_bf16 v[132:135], a[116:119], a[164:167], v[132:135]
    buffer_load_dwordx4 v[48:51], v34, s[12:15], s45 offen sc1
    v_mfma_f32_16x16x32_bf16 v[132:135], a[112:115], a[160:163], v[132:135]
    ds_read_b32 a35, v59
    v_perm_b32 v5, v104, v35, s36
    v_mfma_f32_16x16x32_bf16 v[136:139], a[112:115], a[168:171], v[136:139]
    ds_read_b32 a36, v61
    v_perm_b32 v6, v104, v35, s37
    v_mfma_f32_16x16x32_bf16 v[136:139], a[116:119], a[172:175], v[136:139]
    ds_read_b32 a37, v7
    v_perm_b32 v27, v104, v35, s38
    v_mfma_f32_16x16x32_bf16 v[140:143], a[116:119], a[188:191], v[140:143]
    ds_read_b32 a38, v60
    ds_read_b32 a39, v62
    v_mfma_f32_16x16x32_bf16 v[140:143], a[112:115], a[184:187], v[140:143]
    buffer_load_dwordx4 v[52:55], v44, s[12:15], s45 offen sc1
    v_mfma_f32_16x16x32_bf16 v[144:147], a[112:115], a[192:195], v[144:147]
    v_perm_b32 v29, v104, v35, s39
    v_perm_b32 v46, v108, v35, s36
    v_mfma_f32_16x16x32_bf16 v[144:147], a[116:119], a[196:199], v[144:147]
    v_perm_b32 v31, v108, v35, s37
    v_perm_b32 v47, v108, v35, s38
    v_mfma_f32_16x16x32_bf16 v[148:151], a[116:119], a[204:207], v[148:151]
    s_waitcnt vmcnt(14)
    ds_read_b32 a0, v5
    v_bitop3_b32 v56, v115, v119, s76 bitop3:0x7e
    v_mfma_f32_16x16x32_bf16 v[148:151], a[112:115], a[200:203], v[148:151]
    ds_read_b128 a[48:51], v42 offset:0
    v_cmp_lt_u32 vcc, 0xffff, v56
    v_mfma_f32_16x16x32_bf16 v[152:155], a[112:115], a[232:235], v[152:155]
    ds_read_b128 a[52:55], v43 offset:0
    ds_read_b32 a1, v6
    v_mfma_f32_16x16x32_bf16 v[152:155], a[116:119], a[236:239], v[152:155]
    ds_read_b32 a2, v27
    s_cbranch_vccnz L_slow5_0
L_back5_0:
    v_mfma_f32_16x16x32_bf16 v[156:159], a[116:119], a[244:247], v[156:159]
    buffer_load_dwordx4 v36, s[8:11], s56 offen offset:0  lds
    v_mfma_f32_16x16x32_bf16 v[156:159], a[112:115], a[240:243], v[156:159]
    s_add_u32 s3, s69, 1536
    ds_read_b128 a[20:23], v43 offset:2048
    v_perm_b32 v63, v108, v35, s39
    v_mfma_f32_16x16x32_bf16 v[160:163], a[136:139], a[144:147], v[160:163]
    ds_read_b128 a[16:19], v42 offset:2048
    v_perm_b32 v57, v105, v35, s36
    v_mfma_f32_16x16x32_bf16 v[160:163], a[140:143], a[148:151], v[160:163]
    ds_read_b32 a3, v29
    v_perm_b32 v58, v105, v35, s37
    v_mfma_f32_16x16x32_bf16 v[164:167], a[140:143], a[164:167], v[164:167]
    ds_read_b128 a[224:227], v42 offset:4096
    ds_read_b32 a4, v46
    v_mfma_f32_16x16x32_bf16 v[164:167], a[136:139], a[160:163], v[164:167]
    ds_read_b32 a5, v31
    v_perm_b32 v59, v105, v35, s38
    v_mfma_f32_16x16x32_bf16 v[168:171], a[136:139], a[168:171], v[168:171]
    ds_read_b32 a6, v47
    v_perm_b32 v61, v105, v35, s39
    v_mfma_f32_16x16x32_bf16 v[168:171], a[140:143], a[172:175], v[168:171]
    ds_read_b128 a[228:231], v43 offset:4096
    ds_read_b32 a7, v63
    v_mfma_f32_16x16x32_bf16 v[172:175], a[140:143], a[188:191], v[172:175]
    buffer_load_dwordx4 v37, s[8:11], s56 offen offset:1024  lds
    v_mfma_f32_16x16x32_bf16 v[172:175], a[136:139], a[184:187], v[172:175]
    v_perm_b32 v7, v109, v35, s36
    v_perm_b32 v60, v109, v35, s37
    v_mfma_f32_16x16x32_bf16 v[176:179], a[136:139], a[192:195], v[176:179]
    ds_read_b128 a[24:27], v42 offset:6144
    v_perm_b32 v62, v109, v35, s38
    v_mfma_f32_16x16x32_bf16 v[176:179], a[140:143], a[196:199], v[176:179]
    ds_read_b32 a216, v57
    v_perm_b32 v5, v109, v35, s39
    v_mfma_f32_16x16x32_bf16 v[180:183], a[140:143], a[204:207], v[180:183]
    ds_read_b32 a217, v58
    v_perm_b32 v56, v106, v35, s36
    v_mfma_f32_16x16x32_bf16 v[180:183], a[136:139], a[200:203], v[180:183]
    ds_read_b128 a[28:31], v43 offset:6144
    ds_read_b32 a218, v59
    v_mfma_f32_16x16x32_bf16 v[184:187], a[136:139], a[232:235], v[184:187]
    ds_read_b32 a219, v61
    ds_read_b32 a220, v7
    v_mfma_f32_16x16x32_bf16 v[184:187], a[140:143], a[236:239], v[184:187]
    buffer_load_dwordx4 v38, s[8:11], s56 offen offset:2048  lds
    v_mfma_f32_16x16x32_bf16 v[188:191], a[140:143], a[244:247], v[188:191]
    ds_read_b128 a[8:11], v42 offset:8192
    v_perm_b32 v6, v106, v35, s37
    v_mfma_f32_16x16x32_bf16 v[188:191], a[136:139], a[240:243], v[188:191]
    v_perm_b32 v27, v106, v35, s38
    v_perm_b32 v29, v106, v35, s39
    v_mfma_f32_16x16x32_bf16 v[192:195], a[152:155], a[144:147], v[192:195]
    ds_read_b32 a221, v60
    ds_read_b32 a222, v62
    v_mfma_f32_16x16x32_bf16 v[192:195], a[156:159], a[148:151], v[192:195]
    ds_read_b128 a[12:15], v43 offset:8192
    v_perm_b32 v46, v110, v35, s36
    v_mfma_f32_16x16x32_bf16 v[196:199], a[156:159], a[164:167], v[196:199]
    ds_read_b32 a223, v5
    v_perm_b32 v31, v110, v35, s37
    v_mfma_f32_16x16x32_bf16 v[196:199], a[152:155], a[160:163], v[196:199]
    ds_read_b32 a40, v56
    ds_read_b32 a41, v6
    v_mfma_f32_16x16x32_bf16 v[200:203], a[152:155], a[168:171], v[200:203]
    buffer_load_dwordx4 v39, s[8:11], s56 offen offset:3072  lds
    v_mfma_f32_16x16x32_bf16 v[200:203], a[156:159], a[172:175], v[200:203]
    s_add_u32 m0, s57, 49152
    ds_read_b128 a[72:75], v42 offset:10240
    v_perm_b32 v47, v110, v35, s38
    v_mfma_f32_16x16x32_bf16 v[204:207], a[156:159], a[188:191], v[204:207]
    s_add_u32 s56, s55, 1792
    v_perm_b32 v63, v110, v35, s39
    v_perm_b32 v57, v112, v35, s36
    v_mfma_f32_16x16x32_bf16 v[204:207], a[152:155], a[184:187], v[204:207]
    ds_read_b128 a[76:79], v43 offset:10240
    ds_read_b32 a42, v27
    v_mfma_f32_16x16x32_bf16 v[208:211], a[152:155], a[192:195], v[208:211]
    ds_read_b32 a43, v29
    v_perm_b32 v58, v112, v35, s37
    v_mfma_f32_16x16x32_bf16 v[208:211], a[156:159], a[196:199], v[208:211]
    ds_read_b32 a44, v46
    v_perm_b32 v59, v112, v35, s38
    v_mfma_f32_16x16x32_bf16 v[212:215], a[156:159], a[204:207], v[212:215]
    ds_read_b128 a[96:99], v42 offset:12288
    ds_read_b32 a45, v31
    v_mfma_f32_16x16x32_bf16 v[212:215], a[152:155], a[200:203], v[212:215]
    ds_read_b32 a46, v47
    ds_read_b32 a47, v63
    v_mfma_f32_16x16x32_bf16 v[216:219], a[152:155], a[232:235], v[216:219]
    buffer_load_dwordx4 v36, s[8:11], s3 offen offset:0  lds
    v_mfma_f32_16x16x32_bf16 v[216:219], a[156:159], a[236:239], v[216:219]
    ds_read_b128 a[100:103], v43 offset:12288
    v_perm_b32 v61, v112, v35, s39
    v_mfma_f32_16x16x32_bf16 v[220:223], a[156:159], a[244:247], v[220:223]
    v_perm_b32 v7, v116, v35, s36
    v_perm_b32 v60, v116, v35, s37
    v_mfma_f32_16x16x32_bf16 v[220:223], a[152:155], a[240:243], v[220:223]
    s_waitcnt lgkmcnt(9)
    ds_read_b32 a120, v57
    v_perm_b32 v62, v116, v35, s38
    v_mfma_f32_16x16x32_bf16 v[128:131], a[64:67], a[48:51], v[128:131]
    ds_read_b128 a[80:83], v42 offset:14336
    ds_read_b32 a121, v58
    v_mfma_f32_16x16x32_bf16 v[128:131], a[68:71], a[52:55], v[128:131]
    ds_read_b32 a122, v59
    v_perm_b32 v5, v116, v35, s39
    v_mfma_f32_16x16x32_bf16 v[132:135], a[68:71], a[20:23], v[132:135]
    ds_read_b128 a[84:87], v43 offset:14336
    ds_read_b32 a123, v61
    v_mfma_f32_16x16x32_bf16 v[132:135], a[64:67], a[16:19], v[132:135]
    buffer_load_dwordx4 v37, s[8:11], s3 offen offset:1024  lds
    v_mfma_f32_16x16x32_bf16 v[136:139], a[64:67], a[224:227], v[136:139]
    v_perm_b32 v56, v113, v35, s36
    v_perm_b32 v6, v113, v35, s37
    v_mfma_f32_16x16x32_bf16 v[136:139], a[68:71], a[228:231], v[136:139]
    s_waitcnt vmcnt(16)
    v_perm_b32 v29, v113, v35, s38
    v_bitop3_b32 v27, v123, v127, s76 bitop3:0x7e
    v_mfma_f32_16x16x32_bf16 v[140:143], a[68:71], a[28:31], v[140:143]
    ds_read_b32 a124, v7
    v_cmp_lt_u32 vcc, 0xffff, v27
    v_mfma_f32_16x16x32_bf16 v[140:143], a[64:67], a[24:27], v[140:143]
    ds_read_b32 a125, v60
    ds_read_b32 a126, v62
    v_mfma_f32_16x16x32_bf16 v[144:147], a[64:67], a[8:11], v[144:147]
    v_perm_b32 v46, v113, v35, s39
    s_cbranch_vccnz L_slow5_1
L_back5_1:
    v_mfma_f32_16x16x32_bf16 v[144:147], a[68:71], a[12:15], v[144:147]
    s_waitcnt lgkmcnt(6)
    ds_read_b32 a127, v5
    v_perm_b32 v31, v117, v35, s36
    v_mfma_f32_16x16x32_bf16 v[148:151], a[68:71], a[76:79], v[148:151]
    ds_read_b32 a176, v56
    ds_read_b32 a177, v6
    v_mfma_f32_16x16x32_bf16 v[148:151], a[64:67], a[72:75], v[148:151]
    buffer_load_dwordx4 v38, s[8:11], s3 offen offset:2048  lds
    v_mfma_f32_16x16x32_bf16 v[152:155], a[64:67], a[96:99], v[152:155]
    ds_read_b128 a[104:107], v42 offset:16384
    v_perm_b32 v47, v117, v35, s37
    v_mfma_f32_16x16x32_bf16 v[152:155], a[68:71], a[100:103], v[152:155]
    s_waitcnt lgkmcnt(7)
    ds_read_b128 a[108:111], v43 offset:16384
    v_perm_b32 v63, v117, v35, s38
    v_mfma_f32_16x16x32_bf16 v[156:159], a[68:71], a[84:87], v[156:159]
    ds_read_b128 a[88:91], v42 offset:18432
    ds_read_b32 a178, v29
    v_mfma_f32_16x16x32_bf16 v[156:159], a[64:67], a[80:83], v[156:159]
    ds_read_b128 a[92:95], v43 offset:18432
    v_perm_b32 v57, v117, v35, s39
    v_mfma_f32_16x16x32_bf16 v[160:163], a[208:211], a[48:51], v[160:163]
    ds_read_b32 a179, v46
    v_perm_b32 v58, v114, v35, s36
    v_mfma_f32_16x16x32_bf16 v[160:163], a[212:215], a[52:55], v[160:163]
    ds_read_b32 a180, v31
    ds_read_b32 a181, v47
    v_mfma_f32_16x16x32_bf16 v[164:167], a[212:215], a[20:23], v[164:167]
    buffer_load_dwordx4 v39, s[8:11], s3 offen offset:3072  lds
    v_mfma_f32_16x16x32_bf16 v[164:167], a[208:211], a[16:19], v[164:167]
    s_add_u32 m0, s57, 65536
    ds_read_b128 a[56:59], v42 offset:20480
    v_perm_b32 v59, v114, v35, s37
    v_mfma_f32_16x16x32_bf16 v[168:171], a[208:211], a[224:227], v[168:171]
    s_add_u32 s3, s69, 1792
    v_perm_b32 v61, v114, v35, s38
    v_perm_b32 v7, v114, v35, s39
    v_mfma_f32_16x16x32_bf16 v[168:171], a[212:215], a[228:231], v[168:171]
    ds_read_b128 a[60:63], v43 offset:20480
    ds_read_b32 a182, v63
    v_mfma_f32_16x16x32_bf16 v[172:175], a[212:215], a[28:31], v[172:175]
    buffer_load_dwordx4 v[64:67], v22, s[32:35], 0 offen
    v_mfma_f32_16x16x32_bf16 v[172:175], a[208:211], a[24:27], v[172:175]
    v_perm_b32 v27, v118, v35, s36
    v_perm_b32 v60, v118, v35, s37
    v_mfma_f32_16x16x32_bf16 v[176:179], a[208:211], a[8:11], v[176:179]
    ds_read_b128 a[128:131], v42 offset:22528
    ds_read_b32 a183, v57
    v_mfma_f32_16x16x32_bf16 v[176:179], a[212:215], a[12:15], v[176:179]
    ds_read_b32 a112, v58
    ds_read_b32 a113, v59
    v_mfma_f32_16x16x32_bf16 v[180:183], a[212:215], a[76:79], v[180:183]
    buffer_load_dwordx4 v[68:71], v32, s[12:15], s72 offen sc1
    v_mfma_f32_16x16x32_bf16 v[180:183], a[208:211], a[72:75], v[180:183]
    ds_read_b128 a[132:135], v43 offset:22528
    v_perm_b32 v62, v118, v35, s38
    v_mfma_f32_16x16x32_bf16 v[184:187], a[208:211], a[96:99], v[184:187]
    v_perm_b32 v5, v118, v35, s39
    v_perm_b32 v56, v115, v35, s36
    v_mfma_f32_16x16x32_bf16 v[184:187], a[212:215], a[100:103], v[184:187]
    ds_read_b32 a114, v61
    ds_read_b32 a115, v7
    v_mfma_f32_16x16x32_bf16 v[188:191], a[212:215], a[84:87], v[188:191]
    buffer_load_dwordx4 v[72:75], v33, s[12:15], s72 offen sc1
    v_mfma_f32_16x16x32_bf16 v[188:191], a[208:211], a[80:83], v[188:191]
    ds_read_b128 a[136:139], v42 offset:24576
    v_perm_b32 v6, v115, v35, s37
    v_mfma_f32_16x16x32_bf16 v[192:195], a[248:251], a[48:51], v[192:195]
    ds_read_b32 a116, v27
    v_perm_b32 v29, v119, v35, s36
    v_mfma_f32_16x16x32_bf16 v[192:195], a[252:255], a[52:55], v[192:195]
    ds_read_b128 a[140:143], v43 offset:24576
    ds_read_b32 a117, v60
    v_mfma_f32_16x16x32_bf16 v[196:199], a[252:255], a[20:23], v[196:199]
    buffer_load_dwordx4 v[76:79], v34, s[12:15], s72 offen sc1
    v_mfma_f32_16x16x32_bf16 v[196:199], a[248:251], a[16:19], v[196:199]
    v_perm_b32 v46, v119, v35, s37
    v_perm_b32 v31, v123, v35, s36
    v_mfma_f32_16x16x32_bf16 v[200:203], a[248:251], a[224:227], v[200:203]
    ds_read_b128 a[144:147], v42 offset:26624
    v_perm_b32 v47, v123, v35, s37
    v_mfma_f32_16x16x32_bf16 v[200:203], a[252:255], a[228:231], v[200:203]
    ds_read_b32 a118, v62
    ds_read_b32 a119, v5
    v_mfma_f32_16x16x32_bf16 v[204:207], a[252:255], a[28:31], v[204:207]
    buffer_load_dwordx4 v[80:83], v44, s[12:15], s72 offen sc1
    v_mfma_f32_16x16x32_bf16 v[204:207], a[248:251], a[24:27], v[204:207]
    ds_read_b128 a[148:151], v43 offset:26624
    ds_read_b32 a160, v56
    v_mfma_f32_16x16x32_bf16 v[208:211], a[248:251], a[8:11], v[208:211]
    v_perm_b32 v63, v127, v35, s36
    v_perm_b32 v57, v127, v35, s37
    v_mfma_f32_16x16x32_bf16 v[208:211], a[252:255], a[12:15], v[208:211]
    ds_read_b32 a161, v6
    ds_read_b32 a162, v29
    v_mfma_f32_16x16x32_bf16 v[212:215], a[252:255], a[76:79], v[212:215]
    buffer_load_dwordx2 v[84:85], v22, s[32:35], 0 offen offset:16
    v_mfma_f32_16x16x32_bf16 v[212:215], a[248:251], a[72:75], v[212:215]
    ds_read_b128 a[168:171], v42 offset:28672
    v_perm_b32 v58, v120, v35, s36
    v_mfma_f32_16x16x32_bf16 v[216:219], a[248:251], a[96:99], v[216:219]
    v_perm_b32 v59, v120, v35, s37
    v_perm_b32 v61, v120, v35, s38
    v_mfma_f32_16x16x32_bf16 v[216:219], a[252:255], a[100:103], v[216:219]
    ds_read_b128 a[172:175], v43 offset:28672
    ds_read_b32 a163, v46
    v_mfma_f32_16x16x32_bf16 v[220:223], a[252:255], a[84:87], v[220:223]
    buffer_load_dword v86, v23, s[32:35], 0 offen
    v_mfma_f32_16x16x32_bf16 v[220:223], a[248:251], a[80:83], v[220:223]
    ds_read_b32 a164, v31
    v_perm_b32 v7, v120, v35, s39
    v_mfma_f32_16x16x32_bf16 v[224:227], a[32:35], a[50:53], v[224:227]
    s_waitcnt lgkmcnt(6)
    ds_read_b128 a[184:187], v42 offset:30720
    ds_read_b32 a165, v47
    v_mfma_f32_16x16x32_bf16 v[224:227], a[36:39], a[106:109], v[224:227]
    v_perm_b32 v27, v124, v35, s36
    v_perm_b32 v60, v124, v35, s37
    v_mfma_f32_16x16x32_bf16 v[228:231], a[36:39], a[90:93], v[228:231]
    ds_read_b128 a[188:191], v43 offset:30720
    ds_read_b32 a166, v63
    v_mfma_f32_16x16x32_bf16 v[228:231], a[32:35], a[18:21], v[228:231]
    ds_read_b32 a167, v57
    v_perm_b32 v62, v124, v35, s38
    v_mfma_f32_16x16x32_bf16 v[232:235], a[32:35], a[226:229], v[232:235]
    s_waitcnt vmcnt(18)
    v_bitop3_b32 v5, v91, v95, s76 bitop3:0x7e
    v_perm_b32 v56, v124, v35, s39
    v_mfma_f32_16x16x32_bf16 v[232:235], a[36:39], a[58:61], v[232:235]
    ds_read_b32 a192, v58
    v_cmp_lt_u32 vcc, 0xffff, v5
    v_mfma_f32_16x16x32_bf16 v[236:239], a[36:39], a[130:133], v[236:239]
    ds_read_b32 a193, v59
    v_perm_b32 v6, v121, v35, s36
    v_mfma_f32_16x16x32_bf16 v[236:239], a[32:35], a[26:29], v[236:239]
    ds_read_b32 a194, v61
    s_cbranch_vccnz L_slow6_0
L_back6_0:
    v_mfma_f32_16x16x32_bf16 v[240:243], a[32:35], a[10:13], v[240:243]
    v_perm_b32 v29, v121, v35, s37
    v_perm_b32 v46, v121, v35, s38
    v_mfma_f32_16x16x32_bf16 v[240:243], a[36:39], a[138:141], v[240:243]
    s_waitcnt vmcnt(15)
    ds_read_b32 a195, v7
    v_bitop3_b32 v31, v51, v55, s76 bitop3:0x7e
    v_mfma_f32_16x16x32_bf16 v[244:247], a[36:39], a[146:149], v[244:247]
    v_cmp_lt_u32 vcc, 0xffff, v31
    v_perm_b32 v47, v121, v35, s39
    v_mfma_f32_16x16x32_bf16 v[244:247], a[32:35], a[74:77], v[244:247]
    s_waitcnt lgkmcnt(5)
    ds_read_b32 a196, v27
    ds_read_b32 a197, v60
    v_mfma_f32_16x16x32_bf16 v[248:251], a[32:35], a[98:101], v[248:251]
    s_barrier
    v_mfma_f32_16x16x32_bf16 v[248:251], a[36:39], a[170:173], v[248:251]
    buffer_load_dwordx4 v36, s[8:11], s56 offen offset:0  lds
    v_mfma_f32_16x16x32_bf16 v[252:255], a[36:39], a[186:189], v[252:255]
    v_perm_b32 v63, v125, v35, s36
    s_cbranch_vccnz L_slow6_1
L_back6_1:
L_pad3:
    s_cbranch_execz L_pad4
    v_mfma_f32_16x16x32_bf16 v[252:255], a[32:35], a[82:85], v[252:255]
    ds_read_b32 a198, v62
    v_perm_b32 v57, v125, v35, s37
    v_mfma_f32_16x16x32_bf16 v[128:131], a[0:3], a[104:107], v[128:131]
    ds_read_b32 a199, v56
    ds_read_b32 a200, v6
    v_mfma_f32_16x16x32_bf16 v[128:131], a[4:7], a[108:111], v[128:131]
    buffer_load_dwordx4 v37, s[8:11], s56 offen offset:1024  lds
    v_mfma_f32_16x16x32_bf16 v[132:135], a[4:7], a[92:95], v[132:135]
    v_perm_b32 v58, v125, v35, s38
    v_perm_b32 v5, v125, v35, s39
    v_mfma_f32_16x16x32_bf16 v[132:135], a[0:3], a[88:91], v[132:135]
    ds_read_b32 a201, v29
    v_perm_b32 v59, v122, v35, s36
    v_mfma_f32_16x16x32_bf16 v[136:139], a[0:3], a[56:59], v[136:139]
    ds_read_b32 a202, v46
    ds_read_b32 a203, v47
    v_mfma_f32_16x16x32_bf16 v[136:139], a[4:7], a[60:63], v[136:139]
    buffer_load_dwordx4 v38, s[8:11], s56 offen offset:2048  lds
    v_mfma_f32_16x16x32_bf16 v[140:143], a[4:7], a[132:135], v[140:143]
    v_perm_b32 v61, v122, v35, s37
    v_perm_b32 v7, v122, v35, s38
    v_mfma_f32_16x16x32_bf16 v[140:143], a[0:3], a[128:131], v[140:143]
    ds_read_b32 a204, v63
    v_perm_b32 v31, v122, v35, s39
    v_mfma_f32_16x16x32_bf16 v[144:147], a[0:3], a[136:139], v[144:147]
    ds_read_b32 a205, v57
    ds_read_b32 a206, v58
    v_mfma_f32_16x16x32_bf16 v[144:147], a[4:7], a[140:143], v[144:147]
    buffer_load_dwordx4 v39, s[8:11], s56 offen offset:3072  lds
    v_mfma_f32_16x16x32_bf16 v[148:151], a[4:7], a[148:151], v[148:151]
    s_add_u32 m0, s57, 81920
    v_perm_b32 v27, v126, v35, s36
    v_perm_b32 v60, v126, v35, s37
    v_mfma_f32_16x16x32_bf16 v[148:151], a[0:3], a[144:147], v[148:151]
    ds_read_b128 a[232:235], v40 offset:0
    v_perm_b32 v62, v126, v35, s38
    v_mfma_f32_16x16x32_bf16 v[152:155], a[0:3], a[168:171], v[152:155]
    ds_read_b128 a[236:239], v41 offset:0
    ds_read_b32 a207, v5
    v_mfma_f32_16x16x32_bf16 v[152:155], a[4:7], a[172:175], v[152:155]
    buffer_load_dwordx4 v36, s[8:11], s3 offen offset:0  lds
    v_mfma_f32_16x16x32_bf16 v[156:159], a[4:7], a[188:191], v[156:159]
    ds_read_b128 a[152:155], v40 offset:2048
    v_perm_b32 v56, v126, v35, s39
    v_mfma_f32_16x16x32_bf16 v[156:159], a[0:3], a[184:187], v[156:159]
    ds_read_b128 a[156:159], v41 offset:2048
    ds_read_b32 a240, v59
    v_mfma_f32_16x16x32_bf16 v[160:163], a[216:219], a[104:107], v[160:163]
    ds_read_b32 a241, v61
    ds_read_b32 a242, v7
    v_mfma_f32_16x16x32_bf16 v[160:163], a[220:223], a[108:111], v[160:163]
    buffer_load_dwordx4 v37, s[8:11], s3 offen offset:1024  lds
    v_mfma_f32_16x16x32_bf16 v[164:167], a[220:223], a[92:95], v[164:167]
    ds_read_b128 a[64:67], v40 offset:4096
    v_perm_b32 v6, v91, v35, s36
    v_perm_b32 v29, v91, v35, s37
    v_mfma_f32_16x16x32_bf16 v[164:167], a[216:219], a[88:91], v[164:167]
    ds_read_b32 a243, v31
    v_perm_b32 v46, v95, v35, s36
    v_mfma_f32_16x16x32_bf16 v[168:171], a[216:219], a[56:59], v[168:171]
    ds_read_b32 a244, v27
    v_perm_b32 v47, v95, v35, s37
    v_mfma_f32_16x16x32_bf16 v[168:171], a[220:223], a[60:63], v[168:171]
    ds_read_b128 a[68:71], v41 offset:4096
    ds_read_b32 a245, v60
    v_mfma_f32_16x16x32_bf16 v[172:175], a[220:223], a[132:135], v[172:175]
    ds_read_b32 a246, v62
    v_perm_b32 v63, v51, v35, s36
    v_mfma_f32_16x16x32_bf16 v[172:175], a[216:219], a[128:131], v[172:175]
    v_perm_b32 v57, v51, v35, s37
    v_perm_b32 v58, v55, v35, s36
    v_mfma_f32_16x16x32_bf16 v[176:179], a[216:219], a[136:139], v[176:179]
    ds_read_b128 a[208:211], v40 offset:6144
    ds_read_b32 a247, v56
    v_mfma_f32_16x16x32_bf16 v[176:179], a[220:223], a[140:143], v[176:179]
    buffer_load_dwordx4 v38, s[8:11], s3 offen offset:2048  lds
    v_mfma_f32_16x16x32_bf16 v[180:183], a[220:223], a[148:151], v[180:183]
    v_perm_b32 v5, v55, v35, s37
    v_perm_b32 v59, v88, v35, s36
    v_mfma_f32_16x16x32_bf16 v[180:183], a[216:219], a[144:147], v[180:183]
    ds_read_b128 a[212:215], v41 offset:6144
    ds_read_b32 a248, v6
    v_mfma_f32_16x16x32_bf16 v[184:187], a[216:219], a[168:171], v[184:187]
    ds_read_b32 a249, v29
    v_perm_b32 v61, v88, v35, s37
    v_mfma_f32_16x16x32_bf16 v[184:187], a[220:223], a[172:175], v[184:187]
    ds_read_b32 a250, v46
    v_perm_b32 v7, v88, v35, s38
    v_mfma_f32_16x16x32_bf16 v[188:191], a[220:223], a[188:191], v[188:191]
    ds_read_b128 a[48:51], v40 offset:8192
    ds_read_b32 a251, v47
    v_mfma_f32_16x16x32_bf16 v[188:191], a[216:219], a[184:187], v[188:191]
    ds_read_b32 a252, v63
    ds_read_b32 a253, v57
    v_mfma_f32_16x16x32_bf16 v[192:195], a[40:43], a[104:107], v[192:195]
    buffer_load_dwordx4 v39, s[8:11], s3 offen offset:3072  lds
    v_mfma_f32_16x16x32_bf16 v[192:195], a[44:47], a[108:111], v[192:195]
    ds_read_b128 a[52:55], v41 offset:8192
    v_perm_b32 v31, v88, v35, s39
    v_mfma_f32_16x16x32_bf16 v[196:199], a[44:47], a[92:95], v[196:199]
    ds_read_b32 a254, v58
    v_perm_b32 v27, v92, v35, s36
    v_mfma_f32_16x16x32_bf16 v[196:199], a[40:43], a[88:91], v[196:199]
    v_perm_b32 v60, v92, v35, s37
    v_perm_b32 v62, v92, v35, s38
    v_mfma_f32_16x16x32_bf16 v[200:203], a[40:43], a[56:59], v[200:203]
    ds_read_b128 a[16:19], v40 offset:10240
    ds_read_b32 a255, v5
    v_mfma_f32_16x16x32_bf16 v[200:203], a[44:47], a[60:63], v[200:203]
    ds_read_b32 a224, v59
    v_perm_b32 v56, v92, v35, s39
    v_mfma_f32_16x16x32_bf16 v[204:207], a[44:47], a[132:135], v[204:207]
    ds_read_b32 a225, v61
    v_perm_b32 v6, v48, v35, s36
    v_mfma_f32_16x16x32_bf16 v[204:207], a[40:43], a[128:131], v[204:207]
    ds_read_b128 a[20:23], v41 offset:10240
    ds_read_b32 a226, v7
    v_mfma_f32_16x16x32_bf16 v[208:211], a[40:43], a[136:139], v[208:211]
    v_perm_b32 v29, v48, v35, s37
    v_perm_b32 v46, v48, v35, s38
    v_mfma_f32_16x16x32_bf16 v[208:211], a[44:47], a[140:143], v[208:211]
    ds_read_b32 a227, v31
    v_perm_b32 v47, v48, v35, s39
    v_mfma_f32_16x16x32_bf16 v[212:215], a[44:47], a[148:151], v[212:215]
    ds_read_b128 a[24:27], v40 offset:12288
    ds_read_b32 a228, v27
    v_mfma_f32_16x16x32_bf16 v[212:215], a[40:43], a[144:147], v[212:215]
    ds_read_b32 a229, v60
    ds_read_b32 a230, v62
    v_mfma_f32_16x16x32_bf16 v[216:219], a[40:43], a[168:171], v[216:219]
    v_perm_b32 v63, v52, v35, s36
    v_perm_b32 v57, v52, v35, s37
    v_mfma_f32_16x16x32_bf16 v[216:219], a[44:47], a[172:175], v[216:219]
    ds_read_b128 a[28:31], v41 offset:12288
    ds_read_b32 a231, v56
    v_mfma_f32_16x16x32_bf16 v[220:223], a[44:47], a[188:191], v[220:223]
    ds_read_b32 a8, v6
    v_perm_b32 v58, v52, v35, s38
    v_mfma_f32_16x16x32_bf16 v[220:223], a[40:43], a[184:187], v[220:223]
    s_waitcnt lgkmcnt(10)
    ds_read_b32 a9, v29
    v_perm_b32 v5, v52, v35, s39
    v_mfma_f32_16x16x32_bf16 v[128:131], a[120:123], a[232:235], v[128:131]
    ds_read_b32 a10, v46
    ds_read_b32 a11, v47
    v_mfma_f32_16x16x32_bf16 v[128:131], a[124:127], a[236:239], v[128:131]
    v_perm_b32 v59, v89, v35, s36
    v_perm_b32 v61, v89, v35, s37
    v_mfma_f32_16x16x32_bf16 v[132:135], a[124:127], a[156:159], v[132:135]
    ds_read_b32 a12, v63
    ds_read_b32 a13, v57
    v_mfma_f32_16x16x32_bf16 v[132:135], a[120:123], a[152:155], v[132:135]
    v_perm_b32 v7, v89, v35, s38
    v_perm_b32 v31, v89, v35, s39
    v_mfma_f32_16x16x32_bf16 v[136:139], a[120:123], a[64:67], v[136:139]
    ds_read_b32 a14, v58
    ds_read_b32 a15, v5
    v_mfma_f32_16x16x32_bf16 v[136:139], a[124:127], a[68:71], v[136:139]
    v_perm_b32 v27, v93, v35, s36
    v_perm_b32 v60, v93, v35, s37
    v_mfma_f32_16x16x32_bf16 v[140:143], a[124:127], a[212:215], v[140:143]
    ds_read_b128 a[72:75], v40 offset:16384
    ds_read_b32 a96, v59
    v_mfma_f32_16x16x32_bf16 v[140:143], a[120:123], a[208:211], v[140:143]
    ds_read_b32 a97, v61
    v_perm_b32 v62, v93, v35, s38
    v_mfma_f32_16x16x32_bf16 v[144:147], a[120:123], a[48:51], v[144:147]
    ds_read_b32 a98, v7
    ds_read_b32 a99, v31
    v_mfma_f32_16x16x32_bf16 v[144:147], a[124:127], a[52:55], v[144:147]
    s_waitcnt lgkmcnt(9)
    ds_read_b128 a[76:79], v41 offset:16384
    v_perm_b32 v56, v93, v35, s39
    v_mfma_f32_16x16x32_bf16 v[148:151], a[124:127], a[20:23], v[148:151]
    ds_read_b32 a100, v27
    ds_read_b32 a101, v60
    v_mfma_f32_16x16x32_bf16 v[148:151], a[120:123], a[16:19], v[148:151]
    ds_read_b32 a102, v62
    v_perm_b32 v6, v49, v35, s36
    v_mfma_f32_16x16x32_bf16 v[152:155], a[120:123], a[24:27], v[152:155]
    ds_read_b128 a[32:35], v40 offset:18432
    v_perm_b32 v29, v49, v35, s37
    v_mfma_f32_16x16x32_bf16 v[152:155], a[124:127], a[28:31], v[152:155]
    ds_read_b32 a103, v56
    v_perm_b32 v46, v49, v35, s38
    v_mfma_f32_16x16x32_bf16 v[160:163], a[176:179], a[232:235], v[160:163]
    ds_read_b32 a80, v6
    v_perm_b32 v47, v49, v35, s39
    v_mfma_f32_16x16x32_bf16 v[160:163], a[180:183], a[236:239], v[160:163]
    ds_read_b128 a[36:39], v41 offset:18432
    v_perm_b32 v63, v53, v35, s36
    v_mfma_f32_16x16x32_bf16 v[164:167], a[180:183], a[156:159], v[164:167]
    ds_read_b32 a81, v29
    v_perm_b32 v57, v53, v35, s37
    v_mfma_f32_16x16x32_bf16 v[164:167], a[176:179], a[152:155], v[164:167]
    ds_read_b32 a82, v46
    v_perm_b32 v58, v53, v35, s38
    v_mfma_f32_16x16x32_bf16 v[168:171], a[176:179], a[64:67], v[168:171]
    ds_read_b128 a[0:3], v40 offset:20480
    ds_read_b32 a83, v47
    v_mfma_f32_16x16x32_bf16 v[168:171], a[180:183], a[68:71], v[168:171]
    s_waitcnt vmcnt(12)
    ds_read_b32 a84, v63
    v_bitop3_b32 v5, v71, v75, s76 bitop3:0x7e
    v_mfma_f32_16x16x32_bf16 v[172:175], a[180:183], a[212:215], v[172:175]
    ds_read_b32 a85, v57
    v_cmp_lt_u32 vcc, 0xffff, v5
    v_mfma_f32_16x16x32_bf16 v[172:175], a[176:179], a[208:211], v[172:175]
    ds_read_b128 a[4:7], v41 offset:20480
    v_perm_b32 v59, v53, v35, s39
    v_mfma_f32_16x16x32_bf16 v[176:179], a[176:179], a[48:51], v[176:179]
    ds_read_b32 a86, v58
    s_cbranch_vccnz L_slow7_0
L_back7_0:
    v_mfma_f32_16x16x32_bf16 v[176:179], a[180:183], a[52:55], v[176:179]
    v_perm_b32 v61, v90, v35, s36
    v_perm_b32 v7, v90, v35, s37
    v_mfma_f32_16x16x32_bf16 v[180:183], a[180:183], a[20:23], v[180:183]
    ds_read_b128 a[216:219], v40 offset:22528
    v_perm_b32 v31, v90, v35, s38
    v_mfma_f32_16x16x32_bf16 v[180:183], a[176:179], a[16:19], v[180:183]
    s_waitcnt vmcnt(10)
    ds_read_b32 a87, v59
    v_bitop3_b32 v27, v79, v83, s76 bitop3:0x7e
    v_mfma_f32_16x16x32_bf16 v[184:187], a[176:179], a[24:27], v[184:187]
    v_cmp_lt_u32 vcc, 0xffff, v27
    v_perm_b32 v60, v90, v35, s39
    v_mfma_f32_16x16x32_bf16 v[184:187], a[180:183], a[28:31], v[184:187]
    ds_read_b128 a[220:223], v41 offset:22528
    ds_read_b32 a104, v61
    v_mfma_f32_16x16x32_bf16 v[192:195], a[112:115], a[232:235], v[192:195]
    ds_read_b32 a105, v7
    s_cbranch_vccnz L_slow7_1
L_back7_1:
    v_mfma_f32_16x16x32_bf16 v[192:195], a[116:119], a[236:239], v[192:195]
    ds_read_b32 a106, v31
    v_perm_b32 v62, v94, v35, s36
    v_mfma_f32_16x16x32_bf16 v[196:199], a[116:119], a[156:159], v[196:199]
    ds_read_b128 a[88:91], v40 offset:24576
    v_perm_b32 v56, v94, v35, s37
    v_mfma_f32_16x16x32_bf16 v[196:199], a[112:115], a[152:155], v[196:199]
    ds_read_b32 a107, v60
    v_perm_b32 v6, v94, v35, s38
    v_mfma_f32_16x16x32_bf16 v[200:203], a[112:115], a[64:67], v[200:203]
    ds_read_b32 a108, v62
    v_perm_b32 v29, v94, v35, s39
    v_mfma_f32_16x16x32_bf16 v[200:203], a[116:119], a[68:71], v[200:203]
    ds_read_b128 a[92:95], v41 offset:24576
    v_perm_b32 v46, v50, v35, s36
    v_mfma_f32_16x16x32_bf16 v[204:207], a[116:119], a[212:215], v[204:207]
    ds_read_b32 a109, v56
    v_perm_b32 v47, v50, v35, s37
    v_mfma_f32_16x16x32_bf16 v[204:207], a[112:115], a[208:211], v[204:207]
    ds_read_b32 a110, v6
    v_perm_b32 v63, v50, v35, s38
    v_mfma_f32_16x16x32_bf16 v[208:211], a[112:115], a[48:51], v[208:211]
    ds_read_b128 a[56:59], v40 offset:26624
    ds_read_b32 a111, v29
    v_mfma_f32_16x16x32_bf16 v[208:211], a[116:119], a[52:55], v[208:211]
    ds_read_b32 a128, v46
    v_perm_b32 v57, v50, v35, s39
    v_mfma_f32_16x16x32_bf16 v[212:215], a[116:119], a[20:23], v[212:215]
    ds_read_b32 a129, v47
    v_perm_b32 v5, v54, v35, s36
    v_mfma_f32_16x16x32_bf16 v[212:215], a[112:115], a[16:19], v[212:215]
    ds_read_b128 a[60:63], v41 offset:26624
    ds_read_b32 a130, v63
    v_mfma_f32_16x16x32_bf16 v[216:219], a[112:115], a[24:27], v[216:219]
    ds_read_b32 a131, v57
    v_perm_b32 v58, v54, v35, s37
    v_mfma_f32_16x16x32_bf16 v[216:219], a[116:119], a[28:31], v[216:219]
    ds_read_b32 a132, v5
    v_perm_b32 v59, v54, v35, s38
    v_mfma_f32_16x16x32_bf16 v[224:227], a[160:163], a[234:237], v[224:227]
    s_waitcnt lgkmcnt(10)
    ds_read_b128 a[136:139], v40 offset:28672
    v_perm_b32 v27, v54, v35, s39
    v_mfma_f32_16x16x32_bf16 v[224:227], a[164:167], a[74:77], v[224:227]
    ds_read_b128 a[140:143], v41 offset:28672
    v_mov_b32 v8, 1
    v_mfma_f32_16x16x32_bf16 v[228:231], a[164:167], a[34:37], v[228:231]
    ds_read_b32 a133, v58
    v_min_u32 v9, 1, v0
    v_mfma_f32_16x16x32_bf16 v[228:231], a[160:163], a[154:157], v[228:231]
    ds_read_b32 a134, v59
    v_lshlrev_b32 v9, 30, v9
    v_mfma_f32_16x16x32_bf16 v[232:235], a[160:163], a[66:69], v[232:235]
    ds_read_b32 a135, v27
    v_perm_b32 v61, v71, v35, s36
    v_mfma_f32_16x16x32_bf16 v[232:235], a[164:167], a[2:5], v[232:235]
    ds_read_b32 a144, v61
    v_perm_b32 v7, v71, v35, s37
    v_mfma_f32_16x16x32_bf16 v[236:239], a[164:167], a[218:221], v[236:239]
    ds_read_b32 a145, v7
    v_perm_b32 v31, v75, v35, s36
    v_mfma_f32_16x16x32_bf16 v[236:239], a[160:163], a[210:213], v[236:239]
    ds_read_b32 a146, v31
    v_perm_b32 v60, v75, v35, s37
    v_mfma_f32_16x16x32_bf16 v[240:243], a[160:163], a[50:53], v[240:243]
    ds_read_b32 a147, v60
    v_perm_b32 v62, v79, v35, s36
    v_mfma_f32_16x16x32_bf16 v[240:243], a[164:167], a[90:93], v[240:243]
    s_waitcnt lgkmcnt(8)
    ds_read_b32 a148, v62
    v_perm_b32 v56, v79, v35, s37
    v_mfma_f32_16x16x32_bf16 v[244:247], a[164:167], a[58:61], v[244:247]
    ds_read_b32 a149, v56
    v_perm_b32 v6, v83, v35, s36
    v_mfma_f32_16x16x32_bf16 v[244:247], a[160:163], a[18:21], v[244:247]
    ds_read_b32 a150, v6
    v_perm_b32 v29, v83, v35, s37
    v_mfma_f32_16x16x32_bf16 v[248:251], a[160:163], a[26:29], v[248:251]
    s_waitcnt lgkmcnt(8)
    ds_read_b32 a151, v29
    v_perm_b32 v46, v68, v35, s36
    v_mfma_f32_16x16x32_bf16 v[248:251], a[164:167], a[138:141], v[248:251]
    ds_read_b32 a168, v46
    v_perm_b32 v47, v68, v35, s37
    v_mfma_f32_16x16x32_bf16 v[128:131], a[192:195], a[72:75], v[128:131]
    ds_read_b32 a169, v47
    v_perm_b32 v63, v68, v35, s38
    v_mfma_f32_16x16x32_bf16 v[128:131], a[196:199], a[76:79], v[128:131]
    ds_read_b32 a170, v63
    v_perm_b32 v57, v68, v35, s39
    v_mfma_f32_16x16x32_bf16 v[132:135], a[196:199], a[36:39], v[132:135]
    ds_read_b32 a171, v57
    v_perm_b32 v5, v72, v35, s36
    v_mfma_f32_16x16x32_bf16 v[132:135], a[192:195], a[32:35], v[132:135]
    ds_read_b32 a172, v5
    v_perm_b32 v58, v72, v35, s37
    v_mfma_f32_16x16x32_bf16 v[136:139], a[192:195], a[0:3], v[136:139]
    ds_read_b32 a173, v58
    v_perm_b32 v59, v72, v35, s38
    v_mfma_f32_16x16x32_bf16 v[136:139], a[196:199], a[4:7], v[136:139]
    ds_read_b32 a174, v59
    v_perm_b32 v27, v72, v35, s39
    v_mfma_f32_16x16x32_bf16 v[140:143], a[196:199], a[220:223], v[140:143]
    ds_read_b32 a175, v27
    v_perm_b32 v61, v76, v35, s36
    v_mfma_f32_16x16x32_bf16 v[140:143], a[192:195], a[216:219], v[140:143]
    s_waitcnt vmcnt(0)
    ds_read_b32 a40, v61
    v_perm_b32 v7, v76, v35, s37
    v_mfma_f32_16x16x32_bf16 v[144:147], a[192:195], a[88:91], v[144:147]
    s_barrier
    v_mfma_f32_16x16x32_bf16 v[144:147], a[196:199], a[92:95], v[144:147]
    buffer_atomic_add v8, v9, s[24:27], s77 offen sc0 sc1
    v_mfma_f32_16x16x32_bf16 v[148:151], a[196:199], a[60:63], v[148:151]
    ds_read_b32 a41, v7
    v_perm_b32 v31, v76, v35, s38
    v_mfma_f32_16x16x32_bf16 v[148:151], a[192:195], a[56:59], v[148:151]
    ds_read_b32 a42, v31
    v_perm_b32 v60, v76, v35, s39
    v_mfma_f32_16x16x32_bf16 v[152:155], a[192:195], a[136:139], v[152:155]
    ds_read_b32 a43, v60
    v_perm_b32 v62, v80, v35, s36
    v_mfma_f32_16x16x32_bf16 v[152:155], a[196:199], a[140:143], v[152:155]
    ds_read_b128 a[184:187], v40 offset:32768
    v_perm_b32 v56, v80, v35, s37
    v_mfma_f32_16x16x32_bf16 v[160:163], a[200:203], a[72:75], v[160:163]
    ds_read_b32 a44, v62
    v_perm_b32 v6, v80, v35, s38
    v_mfma_f32_16x16x32_bf16 v[160:163], a[204:207], a[76:79], v[160:163]
    ds_read_b32 a45, v56
    v_perm_b32 v29, v80, v35, s39
    v_mfma_f32_16x16x32_bf16 v[164:167], a[204:207], a[36:39], v[164:167]
    ds_read_b128 a[188:191], v41 offset:32768
    v_perm_b32 v46, v69, v35, s36
    v_mfma_f32_16x16x32_bf16 v[164:167], a[200:203], a[32:35], v[164:167]
    ds_read_b32 a46, v6
    v_perm_b32 v47, v69, v35, s37
    v_mfma_f32_16x16x32_bf16 v[168:171], a[200:203], a[0:3], v[168:171]
    ds_read_b32 a47, v29
    v_perm_b32 v63, v69, v35, s38
    v_mfma_f32_16x16x32_bf16 v[168:171], a[204:207], a[4:7], v[168:171]
    ds_read_b32 a232, v46
    v_perm_b32 v57, v69, v35, s39
    v_mfma_f32_16x16x32_bf16 v[172:175], a[204:207], a[220:223], v[172:175]
    ds_read_b128 a[152:155], v40 offset:49152
    v_perm_b32 v5, v73, v35, s36
    v_mfma_f32_16x16x32_bf16 v[172:175], a[200:203], a[216:219], v[172:175]
    ds_read_b32 a233, v47
    v_perm_b32 v58, v73, v35, s37
    v_mfma_f32_16x16x32_bf16 v[176:179], a[200:203], a[88:91], v[176:179]
    s_mov_b32 m0, s60
    ds_read_b32 a234, v63
    v_perm_b32 v59, v73, v35, s38
    v_mfma_f32_16x16x32_bf16 v[176:179], a[204:207], a[92:95], v[176:179]
    ds_read_b128 a[156:159], v41 offset:49152
    ds_read_b32 a236, v5
    v_mfma_f32_16x16x32_bf16 v[180:183], a[204:207], a[60:63], v[180:183]
    ds_read_b32 a237, v58
    ds_read_b32 a235, v57
    v_mfma_f32_16x16x32_bf16 v[180:183], a[200:203], a[56:59], v[180:183]
    ds_read_b32 a238, v59
    v_perm_b32 v27, v73, v35, s39
    v_mfma_f32_16x16x32_bf16 v[184:187], a[200:203], a[136:139], v[184:187]
    ds_read_b32 a239, v27
    v_perm_b32 v61, v77, v35, s36
    v_mfma_f32_16x16x32_bf16 v[184:187], a[204:207], a[140:143], v[184:187]
    ds_read_b128 a[64:67], v42 offset:0
    v_perm_b32 v7, v77, v35, s37
    v_mfma_f32_16x16x32_bf16 v[192:195], a[240:243], a[72:75], v[192:195]
    ds_read_b32 a208, v61
    v_perm_b32 v31, v77, v35, s38
    v_mfma_f32_16x16x32_bf16 v[192:195], a[244:247], a[76:79], v[192:195]
    ds_read_b32 a209, v7
    v_perm_b32 v60, v77, v35, s39
    v_mfma_f32_16x16x32_bf16 v[196:199], a[244:247], a[36:39], v[196:199]
    ds_read_b128 a[68:71], v43 offset:0
    v_perm_b32 v62, v81, v35, s36
    v_mfma_f32_16x16x32_bf16 v[196:199], a[240:243], a[32:35], v[196:199]
    ds_read_b32 a212, v62
    v_perm_b32 v56, v81, v35, s37
    v_mfma_f32_16x16x32_bf16 v[200:203], a[240:243], a[0:3], v[200:203]
    ds_read_b32 a210, v31
    v_perm_b32 v6, v81, v35, s38
    v_mfma_f32_16x16x32_bf16 v[200:203], a[244:247], a[4:7], v[200:203]
    ds_read_b32 a213, v56
    ds_read_b32 a211, v60
    v_mfma_f32_16x16x32_bf16 v[204:207], a[244:247], a[220:223], v[204:207]
    ds_read_b128 a[48:51], v42 offset:16384
    v_perm_b32 v29, v70, v35, s36
    v_mfma_f32_16x16x32_bf16 v[204:207], a[240:243], a[216:219], v[204:207]
    ds_read_b32 a16, v29
    v_perm_b32 v46, v70, v35, s37
    v_mfma_f32_16x16x32_bf16 v[208:211], a[240:243], a[88:91], v[208:211]
    ds_read_b32 a214, v6
    v_perm_b32 v47, v81, v35, s39
    v_mfma_f32_16x16x32_bf16 v[208:211], a[244:247], a[92:95], v[208:211]
    ds_read_b128 a[52:55], v43 offset:16384
    v_perm_b32 v63, v70, v35, s38
    v_mfma_f32_16x16x32_bf16 v[212:215], a[244:247], a[60:63], v[212:215]
    ds_read_b32 a17, v46
    v_perm_b32 v5, v74, v35, s36
    v_mfma_f32_16x16x32_bf16 v[212:215], a[240:243], a[56:59], v[212:215]
    ds_read_b32 a20, v5
    v_perm_b32 v57, v74, v35, s37
    v_mfma_f32_16x16x32_bf16 v[216:219], a[240:243], a[136:139], v[216:219]
    ds_read_b32 a215, v47
    v_perm_b32 v58, v70, v35, s39
    v_mfma_f32_16x16x32_bf16 v[216:219], a[244:247], a[140:143], v[216:219]
    s_waitcnt lgkmcnt(9)
    ds_read_b32 a18, v63
    v_perm_b32 v59, v74, v35, s38
    v_mfma_f32_16x16x32_bf16 v[224:227], a[248:251], a[186:189], v[224:227]
    s_mov_b32 s66, 0
    ds_read_b32 a21, v57
    v_perm_b32 v27, v78, v35, s36
    v_mfma_f32_16x16x32_bf16 v[224:227], a[252:255], a[154:157], v[224:227]
    s_mov_b32 s67, 14336
    ds_read_b32 a24, v27
    v_perm_b32 v61, v78, v35, s37
    v_mfma_f32_16x16x32_bf16 v[128:131], a[224:227], a[184:187], v[128:131]
    ds_read_b32 a19, v58
    v_perm_b32 v7, v74, v35, s39
    v_mfma_f32_16x16x32_bf16 v[128:131], a[228:231], a[188:191], v[128:131]
    ds_read_b32 a22, v59
    v_perm_b32 v62, v78, v35, s38
    v_mfma_f32_16x16x32_bf16 v[128:131], a[8:11], a[152:155], v[128:131]
    ds_read_b32 a25, v61
    ds_read_b32 a23, v7
    v_mfma_f32_16x16x32_bf16 v[128:131], a[12:15], a[156:159], v[128:131]
    ds_read_b32 a26, v62
    v_perm_b32 v31, v78, v35, s39
    v_mfma_f32_16x16x32_bf16 v[160:163], a[96:99], a[184:187], v[160:163]
    ds_read_b32 a27, v31
    v_perm_b32 v60, v82, v35, s36
    v_mfma_f32_16x16x32_bf16 v[160:163], a[100:103], a[188:191], v[160:163]
    ds_read_b32 a28, v60
    v_perm_b32 v56, v82, v35, s37
    v_mfma_f32_16x16x32_bf16 v[160:163], a[80:83], a[152:155], v[160:163]
    ds_read_b32 a29, v56
    ds_read_b128 a[72:75], v40 offset:34816
    v_mfma_f32_16x16x32_bf16 v[160:163], a[84:87], a[156:159], v[160:163]
    ds_read_b128 a[76:79], v41 offset:34816
    v_perm_b32 v29, v82, v35, s38
    v_mfma_f32_16x16x32_bf16 v[192:195], a[104:107], a[184:187], v[192:195]
    ds_read_b32 a30, v29
    v_perm_b32 v6, v82, v35, s39
    v_mfma_f32_16x16x32_bf16 v[192:195], a[108:111], a[188:191], v[192:195]
    ds_read_b32 a31, v6
    ds_read_b128 a[32:35], v40 offset:51200
    v_mfma_f32_16x16x32_bf16 v[192:195], a[128:131], a[152:155], v[192:195]
    ds_read_b128 a[36:39], v41 offset:51200
    v_lshlrev_b32 v96, 16, v86
    v_mfma_f32_16x16x32_bf16 v[192:195], a[132:135], a[156:159], v[192:195]
    ds_read_b128 a[0:3], v42 offset:2048
    v_and_b32 v97, 0xffff0000, v86
    v_mfma_f32_16x16x32_bf16 v[224:227], a[144:147], a[66:69], v[224:227]
    s_waitcnt lgkmcnt(10)
    ds_read_b128 a[4:7], v43 offset:2048
    v_lshlrev_b32 v100, 16, v64
    v_mfma_f32_16x16x32_bf16 v[224:227], a[148:151], a[50:53], v[224:227]
    ds_read_b128 a[216:219], v42 offset:18432
    v_and_b32 v101, 0xffff0000, v65
    v_mfma_f32_16x16x32_bf16 v[128:131], a[168:171], a[64:67], v[128:131]
    v_lshlrev_b32 v102, 16, v67
    v_and_b32 v103, 0xffff0000, v84
    v_mfma_f32_16x16x32_bf16 v[128:131], a[172:175], a[68:71], v[128:131]
    v_and_b32 v104, 0xffff0000, v64
    v_lshlrev_b32 v105, 16, v66
    v_mfma_f32_16x16x32_bf16 v[128:131], a[40:43], a[48:51], v[128:131]
    ds_read_b128 a[220:223], v43 offset:18432
    v_and_b32 v106, 0xffff0000, v67
    v_mfma_f32_16x16x32_bf16 v[128:131], a[44:47], a[52:55], v[128:131]
    ds_write_addtid_b32 v226 offset:28928
    v_lshlrev_b32 v107, 16, v85
    v_mfma_f32_16x16x32_bf16 v[160:163], a[232:235], a[64:67], v[160:163]
    ds_write_addtid_b32 v227 offset:29184
    v_lshlrev_b32 v108, 16, v65
    v_mfma_f32_16x16x32_bf16 v[160:163], a[236:239], a[68:71], v[160:163]
    v_and_b32 v109, 0xffff0000, v66
    v_lshlrev_b32 v110, 16, v84
    v_mfma_f32_16x16x32_bf16 v[160:163], a[208:211], a[48:51], v[160:163]
    ds_read_b128 a[88:91], v40 offset:36864
    v_and_b32 v111, 0xffff0000, v85
    v_mfma_f32_16x16x32_bf16 v[160:163], a[212:215], a[52:55], v[160:163]
    v_mul_f32 v128, v128, v100
    v_mul_f32 v129, v129, v101
    v_mfma_f32_16x16x32_bf16 v[192:195], a[16:19], a[64:67], v[192:195]
    v_mul_f32 v130, v130, v102
    v_mul_f32 v131, v131, v103
    v_mfma_f32_16x16x32_bf16 v[192:195], a[20:23], a[68:71], v[192:195]
    s_waitcnt lgkmcnt(1)
    s_barrier
    v_mfma_f32_16x16x32_bf16 v[192:195], a[24:27], a[48:51], v[192:195]
    ds_read2st64_b32 v[112:113], v30 offset0:113 offset1:114
    ds_read_b128 a[92:95], v41 offset:36864
L_pad4:
    s_cbranch_execz L_warmed
    v_mfma_f32_16x16x32_bf16 v[192:195], a[28:31], a[52:55], v[192:195]
    v_mul_f32 v160, v160, v104
    v_cvt_pk_bf16_f32 v116, v128, v160
    v_mfma_f32_16x16x32_bf16 v[228:231], a[248:251], a[74:77], v[228:231]
    v_mul_f32 v161, v161, v105
    v_mul_f32 v162, v162, v106
    v_mfma_f32_16x16x32_bf16 v[228:231], a[252:255], a[34:37], v[228:231]
    ds_read_b128 a[56:59], v40 offset:53248
    v_cvt_pk_bf16_f32 v119, v130, v162
    v_mfma_f32_16x16x32_bf16 v[228:231], a[144:147], a[2:5], v[228:231]
    v_mul_f32 v163, v163, v107
    v_mfma_f32_16x16x32_bf16 v[228:231], a[148:151], a[218:221], v[228:231]
    v_mul_f32 v192, v192, v108
    v_mul_f32 v193, v193, v109
    v_mfma_f32_16x16x32_bf16 v[132:135], a[224:227], a[72:75], v[132:135]
    ds_read_b128 a[60:63], v41 offset:53248
    v_mul_f32 v194, v194, v110
    v_mfma_f32_16x16x32_bf16 v[132:135], a[228:231], a[76:79], v[132:135]
    v_mul_f32 v195, v195, v111
    v_cvt_pk_bf16_f32 v117, v192, v129
    v_mfma_f32_16x16x32_bf16 v[132:135], a[8:11], a[32:35], v[132:135]
    ds_write_b64 v26, v[116:117] offset:64512
    v_mfma_f32_16x16x32_bf16 v[132:135], a[12:15], a[36:39], v[132:135]
    ds_write_addtid_b32 v230 offset:30976
    v_cvt_pk_bf16_f32 v118, v161, v193
    v_mfma_f32_16x16x32_bf16 v[132:135], a[168:171], a[0:3], v[132:135]
    ds_write_b64 v26, v[118:119] offset:64520
    v_mfma_f32_16x16x32_bf16 v[132:135], a[172:175], a[4:7], v[132:135]
    ds_write_addtid_b32 v231 offset:31232
    v_cvt_pk_bf16_f32 v120, v194, v131
    v_mfma_f32_16x16x32_bf16 v[132:135], a[40:43], a[216:219], v[132:135]
    ds_read_b128 a[136:139], v42 offset:4096
    v_cvt_pk_bf16_f32 v121, v163, v195
    v_mfma_f32_16x16x32_bf16 v[132:135], a[44:47], a[220:223], v[132:135]
    ds_write_b64 v26, v[120:121] offset:64528
    v_mfma_f32_16x16x32_bf16 v[164:167], a[96:99], a[72:75], v[164:167]
    s_waitcnt lgkmcnt(7)
    v_add_f32 v224, v224, v112
    v_mul_f32 v224, v224, v96
    v_mfma_f32_16x16x32_bf16 v[164:167], a[100:103], a[76:79], v[164:167]
    v_add_f32 v225, v225, v113
    v_mul_f32 v225, v225, v97
    v_mfma_f32_16x16x32_bf16 v[164:167], a[80:83], a[32:35], v[164:167]
    ds_read_b128 a[140:143], v43 offset:4096
    v_cvt_pk_bf16_f32 v112, v224, v225
    v_mfma_f32_16x16x32_bf16 v[164:167], a[84:87], a[36:39], v[164:167]
    ds_write_b32 v28, v112 offset:64512
    v_mfma_f32_16x16x32_bf16 v[164:167], a[232:235], a[0:3], v[164:167]
    ds_read_b128 a[184:187], v42 offset:20480
    v_mul_f32 v132, v132, v100
    v_mfma_f32_16x16x32_bf16 v[164:167], a[236:239], a[4:7], v[164:167]
    v_mul_f32 v133, v133, v101
    v_mul_f32 v134, v134, v102
    v_mfma_f32_16x16x32_bf16 v[164:167], a[208:211], a[216:219], v[164:167]
    ds_read_b128 a[188:191], v43 offset:20480
    v_mul_f32 v135, v135, v103
    v_mfma_f32_16x16x32_bf16 v[164:167], a[212:215], a[220:223], v[164:167]
    v_mfma_f32_16x16x32_bf16 v[196:199], a[104:107], a[72:75], v[196:199]
    s_waitcnt lgkmcnt(2)
    s_barrier
    v_mfma_f32_16x16x32_bf16 v[196:199], a[108:111], a[76:79], v[196:199]
    ds_read_b128 v[124:127], v24 offset:64512
    ds_read2st64_b32 v[88:89], v30 offset0:121 offset1:122
    v_mfma_f32_16x16x32_bf16 v[196:199], a[128:131], a[32:35], v[196:199]
    ds_read_b128 v[92:95], v24 offset:65440
    v_mfma_f32_16x16x32_bf16 v[196:199], a[132:135], a[36:39], v[196:199]
    ds_read_b128 a[152:155], v40 offset:38912
    v_mul_f32 v164, v164, v104
    v_mfma_f32_16x16x32_bf16 v[196:199], a[16:19], a[0:3], v[196:199]
    v_cvt_pk_bf16_f32 v48, v132, v164
    v_mul_f32 v165, v165, v105
    v_mfma_f32_16x16x32_bf16 v[196:199], a[20:23], a[4:7], v[196:199]
    ds_read_b128 a[156:159], v41 offset:38912
    v_mul_f32 v166, v166, v106
    v_mfma_f32_16x16x32_bf16 v[196:199], a[24:27], a[216:219], v[196:199]
    v_cvt_pk_bf16_f32 v51, v134, v166
    v_mul_f32 v167, v167, v107
    v_mfma_f32_16x16x32_bf16 v[196:199], a[28:31], a[220:223], v[196:199]
    s_waitcnt lgkmcnt(3)
    v_mfma_f32_16x16x32_bf16 v[232:235], a[248:251], a[90:93], v[232:235]
    buffer_store_dwordx4 v[124:127], v25, s[16:19], s66 offen sc1
    v_mfma_f32_16x16x32_bf16 v[232:235], a[252:255], a[58:61], v[232:235]
    s_mov_b32 s66, 114688
    v_add_f32 v228, v228, v88
    v_mul_f32 v228, v228, v96
    v_mfma_f32_16x16x32_bf16 v[232:235], a[144:147], a[138:141], v[232:235]
    v_add_f32 v229, v229, v89
    v_mul_f32 v229, v229, v97
    v_mfma_f32_16x16x32_bf16 v[232:235], a[148:151], a[186:189], v[232:235]
    s_waitcnt lgkmcnt(2)
    ds_read_b128 a[64:67], v40 offset:55296
    v_mfma_f32_16x16x32_bf16 v[136:139], a[224:227], a[88:91], v[136:139]
    buffer_store_dwordx4 v[92:95], v25, s[16:19], s67 offen sc1
    v_mfma_f32_16x16x32_bf16 v[136:139], a[228:231], a[92:95], v[136:139]
    s_mov_b32 s67, 129024
    ds_read_b128 a[68:71], v41 offset:55296
    v_cvt_pk_bf16_f32 v88, v228, v229
    v_mfma_f32_16x16x32_bf16 v[136:139], a[8:11], a[56:59], v[136:139]
    ds_write_b32 v28, v88 offset:0
    v_mfma_f32_16x16x32_bf16 v[136:139], a[12:15], a[60:63], v[136:139]
    ds_write_addtid_b32 v234 offset:33024
    v_mul_f32 v196, v196, v108
    v_mfma_f32_16x16x32_bf16 v[136:139], a[168:171], a[136:139], v[136:139]
    ds_write_addtid_b32 v235 offset:33280
    v_mul_f32 v197, v197, v109
    v_mfma_f32_16x16x32_bf16 v[136:139], a[172:175], a[140:143], v[136:139]
    v_mul_f32 v198, v198, v110
    v_mul_f32 v199, v199, v111
    v_mfma_f32_16x16x32_bf16 v[136:139], a[40:43], a[184:187], v[136:139]
    ds_read_b128 a[48:51], v42 offset:6144
    v_cvt_pk_bf16_f32 v49, v196, v133
    v_mfma_f32_16x16x32_bf16 v[136:139], a[44:47], a[188:191], v[136:139]
    ds_write_b64 v26, v[48:49] offset:0
    v_mfma_f32_16x16x32_bf16 v[168:171], a[96:99], a[88:91], v[168:171]
    v_cvt_pk_bf16_f32 v50, v165, v197
    v_cvt_pk_bf16_f32 v52, v198, v135
    v_mfma_f32_16x16x32_bf16 v[168:171], a[100:103], a[92:95], v[168:171]
    ds_write_b64 v26, v[50:51] offset:8
    v_mfma_f32_16x16x32_bf16 v[168:171], a[80:83], a[56:59], v[168:171]
    ds_read_b128 a[52:55], v43 offset:6144
    v_cvt_pk_bf16_f32 v53, v167, v199
    v_mfma_f32_16x16x32_bf16 v[168:171], a[84:87], a[60:63], v[168:171]
    ds_write_b64 v26, v[52:53] offset:16
    v_mfma_f32_16x16x32_bf16 v[168:171], a[232:235], a[136:139], v[168:171]
    ds_read_b128 a[72:75], v42 offset:22528
    v_mul_f32 v136, v136, v100
    v_mfma_f32_16x16x32_bf16 v[168:171], a[236:239], a[140:143], v[168:171]
    v_mul_f32 v137, v137, v101
    v_mul_f32 v138, v138, v102
    v_mfma_f32_16x16x32_bf16 v[168:171], a[208:211], a[184:187], v[168:171]
    ds_read_b128 a[76:79], v43 offset:22528
    v_mul_f32 v139, v139, v103
    v_mfma_f32_16x16x32_bf16 v[168:171], a[212:215], a[188:191], v[168:171]
    v_mfma_f32_16x16x32_bf16 v[200:203], a[104:107], a[88:91], v[200:203]
    s_waitcnt lgkmcnt(2)
    s_barrier
    v_mfma_f32_16x16x32_bf16 v[200:203], a[108:111], a[92:95], v[200:203]
    ds_read_b128 v[68:71], v24 offset:0
    ds_read2st64_b32 v[72:73], v30 offset0:129 offset1:130
    v_mfma_f32_16x16x32_bf16 v[200:203], a[128:131], a[56:59], v[200:203]
    ds_read_b128 v[76:79], v24 offset:928
    v_mfma_f32_16x16x32_bf16 v[200:203], a[132:135], a[60:63], v[200:203]
    ds_read_b128 a[32:35], v40 offset:40960
    v_mul_f32 v168, v168, v104
    v_mfma_f32_16x16x32_bf16 v[200:203], a[16:19], a[136:139], v[200:203]
    v_cvt_pk_bf16_f32 v80, v136, v168
    v_mul_f32 v169, v169, v105
    v_mfma_f32_16x16x32_bf16 v[200:203], a[20:23], a[140:143], v[200:203]
    ds_read_b128 a[36:39], v41 offset:40960
    v_mul_f32 v170, v170, v106
    v_mfma_f32_16x16x32_bf16 v[200:203], a[24:27], a[184:187], v[200:203]
    v_cvt_pk_bf16_f32 v83, v138, v170
    v_mul_f32 v171, v171, v107
    v_mfma_f32_16x16x32_bf16 v[200:203], a[28:31], a[188:191], v[200:203]
    s_waitcnt lgkmcnt(3)
    v_mfma_f32_16x16x32_bf16 v[236:239], a[248:251], a[154:157], v[236:239]
    buffer_store_dwordx4 v[68:71], v25, s[16:19], s66 offen sc1
    v_mfma_f32_16x16x32_bf16 v[236:239], a[252:255], a[66:69], v[236:239]
    s_mov_b32 s66, 229376
    v_add_f32 v232, v232, v72
    v_mul_f32 v232, v232, v96
    v_mfma_f32_16x16x32_bf16 v[236:239], a[144:147], a[50:53], v[236:239]
    v_add_f32 v233, v233, v73
    v_mul_f32 v233, v233, v97
    v_mfma_f32_16x16x32_bf16 v[236:239], a[148:151], a[74:77], v[236:239]
    s_waitcnt lgkmcnt(2)
    ds_read_b128 a[0:3], v40 offset:57344
    v_mfma_f32_16x16x32_bf16 v[140:143], a[224:227], a[152:155], v[140:143]
    buffer_store_dwordx4 v[76:79], v25, s[16:19], s67 offen sc1
    v_mfma_f32_16x16x32_bf16 v[140:143], a[228:231], a[156:159], v[140:143]
    s_mov_b32 s67, 243712
    ds_read_b128 a[4:7], v41 offset:57344
    v_cvt_pk_bf16_f32 v72, v232, v233
    v_mfma_f32_16x16x32_bf16 v[140:143], a[8:11], a[64:67], v[140:143]
    ds_write_b32 v28, v72 offset:7424
    v_mfma_f32_16x16x32_bf16 v[140:143], a[12:15], a[68:71], v[140:143]
    ds_write_addtid_b32 v238 offset:0
    v_mul_f32 v200, v200, v108
    v_mfma_f32_16x16x32_bf16 v[140:143], a[168:171], a[48:51], v[140:143]
    ds_write_addtid_b32 v239 offset:256
    v_mul_f32 v201, v201, v109
    v_mfma_f32_16x16x32_bf16 v[140:143], a[172:175], a[52:55], v[140:143]
    v_mul_f32 v202, v202, v110
    v_mul_f32 v203, v203, v111
    v_mfma_f32_16x16x32_bf16 v[140:143], a[40:43], a[72:75], v[140:143]
    ds_read_b128 a[216:219], v42 offset:8192
    v_cvt_pk_bf16_f32 v81, v200, v137
    v_mfma_f32_16x16x32_bf16 v[140:143], a[44:47], a[76:79], v[140:143]
    ds_write_b64 v26, v[80:81] offset:7424
    v_mfma_f32_16x16x32_bf16 v[172:175], a[96:99], a[152:155], v[172:175]
    v_cvt_pk_bf16_f32 v82, v169, v201
    v_cvt_pk_bf16_f32 v64, v202, v139
    v_mfma_f32_16x16x32_bf16 v[172:175], a[100:103], a[156:159], v[172:175]
    ds_write_b64 v26, v[82:83] offset:7432
    v_mfma_f32_16x16x32_bf16 v[172:175], a[80:83], a[64:67], v[172:175]
    ds_read_b128 a[220:223], v43 offset:8192
    v_cvt_pk_bf16_f32 v65, v171, v203
    v_mfma_f32_16x16x32_bf16 v[172:175], a[84:87], a[68:71], v[172:175]
    ds_write_b64 v26, v[64:65] offset:7440
    v_mfma_f32_16x16x32_bf16 v[172:175], a[232:235], a[48:51], v[172:175]
    ds_read_b128 a[88:91], v42 offset:24576
    v_mul_f32 v140, v140, v100
    v_mfma_f32_16x16x32_bf16 v[172:175], a[236:239], a[52:55], v[172:175]
    v_mul_f32 v141, v141, v101
    v_mul_f32 v142, v142, v102
    v_mfma_f32_16x16x32_bf16 v[172:175], a[208:211], a[72:75], v[172:175]
    ds_read_b128 a[92:95], v43 offset:24576
    v_mul_f32 v143, v143, v103
    v_mfma_f32_16x16x32_bf16 v[172:175], a[212:215], a[76:79], v[172:175]
    v_mfma_f32_16x16x32_bf16 v[204:207], a[104:107], a[152:155], v[204:207]
    s_waitcnt lgkmcnt(2)
    s_barrier
    v_mfma_f32_16x16x32_bf16 v[204:207], a[108:111], a[156:159], v[204:207]
    ds_read_b128 v[84:87], v24 offset:7424
    ds_read2st64_b32 v[116:117], v30 offset0:0 offset1:1
    v_mfma_f32_16x16x32_bf16 v[204:207], a[128:131], a[64:67], v[204:207]
    ds_read_b128 v[120:123], v24 offset:8352
    v_mfma_f32_16x16x32_bf16 v[204:207], a[132:135], a[68:71], v[204:207]
    ds_read_b128 a[56:59], v40 offset:43008
    v_mul_f32 v172, v172, v104
    v_mfma_f32_16x16x32_bf16 v[204:207], a[16:19], a[48:51], v[204:207]
    v_cvt_pk_bf16_f32 v112, v140, v172
    v_mul_f32 v173, v173, v105
    v_mfma_f32_16x16x32_bf16 v[204:207], a[20:23], a[52:55], v[204:207]
    ds_read_b128 a[60:63], v41 offset:43008
    v_mul_f32 v174, v174, v106
    v_mfma_f32_16x16x32_bf16 v[204:207], a[24:27], a[72:75], v[204:207]
    v_cvt_pk_bf16_f32 v115, v142, v174
    v_mul_f32 v175, v175, v107
    v_mfma_f32_16x16x32_bf16 v[204:207], a[28:31], a[76:79], v[204:207]
    s_waitcnt lgkmcnt(3)
    v_mfma_f32_16x16x32_bf16 v[240:243], a[248:251], a[34:37], v[240:243]
    buffer_store_dwordx4 v[84:87], v25, s[16:19], s66 offen sc1
    v_mfma_f32_16x16x32_bf16 v[240:243], a[252:255], a[2:5], v[240:243]
    s_mov_b32 s66, 344064
    v_add_f32 v236, v236, v116
    v_mul_f32 v236, v236, v96
    v_mfma_f32_16x16x32_bf16 v[240:243], a[144:147], a[218:221], v[240:243]
    v_add_f32 v237, v237, v117
    v_mul_f32 v237, v237, v97
    v_mfma_f32_16x16x32_bf16 v[240:243], a[148:151], a[90:93], v[240:243]
    s_waitcnt lgkmcnt(2)
    ds_read_b128 a[136:139], v40 offset:59392
    v_mfma_f32_16x16x32_bf16 v[144:147], a[224:227], a[32:35], v[144:147]
    buffer_store_dwordx4 v[120:123], v25, s[16:19], s67 offen sc1
    v_mfma_f32_16x16x32_bf16 v[144:147], a[228:231], a[36:39], v[144:147]
    s_mov_b32 s67, 358400
    ds_read_b128 a[140:143], v41 offset:59392
    v_cvt_pk_bf16_f32 v116, v236, v237
    v_mfma_f32_16x16x32_bf16 v[144:147], a[8:11], a[0:3], v[144:147]
    ds_write_b32 v28, v116 offset:14848
    v_mfma_f32_16x16x32_bf16 v[144:147], a[12:15], a[4:7], v[144:147]
    ds_write_addtid_b32 v242 offset:2048
    v_mul_f32 v204, v204, v108
    v_mfma_f32_16x16x32_bf16 v[144:147], a[168:171], a[216:219], v[144:147]
    ds_write_addtid_b32 v243 offset:2304
    v_mul_f32 v205, v205, v109
    v_mfma_f32_16x16x32_bf16 v[144:147], a[172:175], a[220:223], v[144:147]
    v_mul_f32 v206, v206, v110
    v_mul_f32 v207, v207, v111
    v_mfma_f32_16x16x32_bf16 v[144:147], a[40:43], a[88:91], v[144:147]
    ds_read_b128 a[184:187], v42 offset:10240
    v_cvt_pk_bf16_f32 v113, v204, v141
    v_mfma_f32_16x16x32_bf16 v[144:147], a[44:47], a[92:95], v[144:147]
    ds_write_b64 v26, v[112:113] offset:14848
    v_mfma_f32_16x16x32_bf16 v[176:179], a[96:99], a[32:35], v[176:179]
    v_cvt_pk_bf16_f32 v114, v173, v205
    v_cvt_pk_bf16_f32 v124, v206, v143
    v_mfma_f32_16x16x32_bf16 v[176:179], a[100:103], a[36:39], v[176:179]
    ds_write_b64 v26, v[114:115] offset:14856
    v_mfma_f32_16x16x32_bf16 v[176:179], a[80:83], a[0:3], v[176:179]
    ds_read_b128 a[188:191], v43 offset:10240
    v_cvt_pk_bf16_f32 v125, v175, v207
    v_mfma_f32_16x16x32_bf16 v[176:179], a[84:87], a[4:7], v[176:179]
    ds_write_b64 v26, v[124:125] offset:14864
    v_mfma_f32_16x16x32_bf16 v[176:179], a[232:235], a[216:219], v[176:179]
    ds_read_b128 a[152:155], v42 offset:26624
    v_mul_f32 v144, v144, v100
    v_mfma_f32_16x16x32_bf16 v[176:179], a[236:239], a[220:223], v[176:179]
    v_mul_f32 v145, v145, v101
    v_mul_f32 v146, v146, v102
    v_mfma_f32_16x16x32_bf16 v[176:179], a[208:211], a[88:91], v[176:179]
    ds_read_b128 a[156:159], v43 offset:26624
    v_mul_f32 v147, v147, v103
    v_mfma_f32_16x16x32_bf16 v[176:179], a[212:215], a[92:95], v[176:179]
    s_waitcnt vmcnt(6)
    v_xor_b32 v8, 15, v8
    v_or_b32 v8, v8, v0
    v_mfma_f32_16x16x32_bf16 v[208:211], a[104:107], a[32:35], v[208:211]
    s_waitcnt lgkmcnt(2)
    s_barrier
    v_mfma_f32_16x16x32_bf16 v[208:211], a[108:111], a[36:39], v[208:211]
    ds_read_b128 v[92:95], v24 offset:14848
    ds_read2st64_b32 v[88:89], v30 offset0:8 offset1:9
    v_mfma_f32_16x16x32_bf16 v[208:211], a[128:131], a[0:3], v[208:211]
    ds_read_b128 v[48:51], v24 offset:15776
    v_min_u32 v8, 1, v8
    v_mfma_f32_16x16x32_bf16 v[208:211], a[132:135], a[4:7], v[208:211]
    ds_read_b128 a[64:67], v40 offset:45056
    v_lshlrev_b32 v8, 30, v8
    v_mfma_f32_16x16x32_bf16 v[208:211], a[16:19], a[216:219], v[208:211]
    v_mov_b32 v9, s76
    v_mul_f32 v176, v176, v104
    v_mfma_f32_16x16x32_bf16 v[208:211], a[20:23], a[220:223], v[208:211]
    ds_read_b128 a[68:71], v41 offset:45056
    v_mfma_f32_16x16x32_bf16 v[208:211], a[24:27], a[88:91], v[208:211]
    buffer_store_dword v9, v8, s[12:15], s78 offen sc1
    v_mfma_f32_16x16x32_bf16 v[208:211], a[28:31], a[92:95], v[208:211]
    v_cvt_pk_bf16_f32 v52, v144, v176
    v_mul_f32 v177, v177, v105
    v_mfma_f32_16x16x32_bf16 v[244:247], a[248:251], a[58:61], v[244:247]
    s_waitcnt lgkmcnt(3)
    v_add_f32 v240, v240, v88
    v_mul_f32 v240, v240, v96
    v_mfma_f32_16x16x32_bf16 v[244:247], a[252:255], a[138:141], v[244:247]
    ds_read_b128 a[48:51], v40 offset:61440
    v_mfma_f32_16x16x32_bf16 v[244:247], a[144:147], a[186:189], v[244:247]
    buffer_store_dwordx4 v[92:95], v25, s[16:19], s66 offen sc1
    v_mfma_f32_16x16x32_bf16 v[244:247], a[148:151], a[154:157], v[244:247]
    s_mov_b32 s66, 458752
    v_add_f32 v241, v241, v89
    v_mul_f32 v241, v241, v97
    v_mfma_f32_16x16x32_bf16 v[148:151], a[224:227], a[56:59], v[148:151]
    v_cvt_pk_bf16_f32 v88, v240, v241
    v_mul_f32 v178, v178, v106
    v_mfma_f32_16x16x32_bf16 v[148:151], a[228:231], a[60:63], v[148:151]
    s_waitcnt lgkmcnt(2)
    ds_write_b32 v28, v88 offset:22272
    v_mfma_f32_16x16x32_bf16 v[148:151], a[8:11], a[136:139], v[148:151]
    buffer_store_dwordx4 v[48:51], v25, s[16:19], s67 offen sc1
    v_mfma_f32_16x16x32_bf16 v[148:151], a[12:15], a[140:143], v[148:151]
    s_mov_b32 s67, 473088
    v_cvt_pk_bf16_f32 v55, v146, v178
    v_mul_f32 v179, v179, v107
    v_mfma_f32_16x16x32_bf16 v[148:151], a[168:171], a[184:187], v[148:151]
    ds_read_b128 a[52:55], v41 offset:61440
    v_mul_f32 v208, v208, v108
    v_mfma_f32_16x16x32_bf16 v[148:151], a[172:175], a[188:191], v[148:151]
    v_mul_f32 v209, v209, v109
    v_mul_f32 v210, v210, v110
    v_mfma_f32_16x16x32_bf16 v[148:151], a[40:43], a[152:155], v[148:151]
    v_mul_f32 v211, v211, v111
    v_cvt_pk_bf16_f32 v53, v208, v145
    v_mfma_f32_16x16x32_bf16 v[148:151], a[44:47], a[156:159], v[148:151]
    ds_write_b64 v26, v[52:53] offset:22272
    v_mfma_f32_16x16x32_bf16 v[180:183], a[96:99], a[56:59], v[180:183]
    v_cvt_pk_bf16_f32 v54, v177, v209
    v_cvt_pk_bf16_f32 v68, v210, v147
    v_mfma_f32_16x16x32_bf16 v[180:183], a[100:103], a[60:63], v[180:183]
    ds_read_b128 a[72:75], v42 offset:12288
    v_cvt_pk_bf16_f32 v69, v179, v211
    v_mfma_f32_16x16x32_bf16 v[180:183], a[80:83], a[136:139], v[180:183]
    ds_write_b64 v26, v[54:55] offset:22280
    v_mfma_f32_16x16x32_bf16 v[180:183], a[84:87], a[140:143], v[180:183]
    ds_write_b64 v26, v[68:69] offset:22288
    v_mfma_f32_16x16x32_bf16 v[180:183], a[232:235], a[184:187], v[180:183]
    ds_read_b128 a[76:79], v43 offset:12288
    ds_write_addtid_b32 v246 offset:4096
    v_mfma_f32_16x16x32_bf16 v[180:183], a[236:239], a[188:191], v[180:183]
    ds_write_addtid_b32 v247 offset:4352
    v_mul_f32 v148, v148, v100
    v_mfma_f32_16x16x32_bf16 v[180:183], a[208:211], a[152:155], v[180:183]
    ds_read_b128 a[32:35], v42 offset:28672
    v_mul_f32 v149, v149, v101
    v_mfma_f32_16x16x32_bf16 v[180:183], a[212:215], a[156:159], v[180:183]
    ds_read_b128 a[36:39], v43 offset:28672
    v_mul_f32 v150, v150, v102
    v_mfma_f32_16x16x32_bf16 v[212:215], a[104:107], a[56:59], v[212:215]
    v_mul_f32 v151, v151, v103
    v_mfma_f32_16x16x32_bf16 v[212:215], a[108:111], a[60:63], v[212:215]
    v_mfma_f32_16x16x32_bf16 v[212:215], a[128:131], a[136:139], v[212:215]
    s_waitcnt lgkmcnt(2)
    s_barrier
    v_mfma_f32_16x16x32_bf16 v[212:215], a[132:135], a[140:143], v[212:215]
    ds_read_b128 v[76:79], v24 offset:22272
    ds_read2st64_b32 v[72:73], v30 offset0:16 offset1:17
    v_mfma_f32_16x16x32_bf16 v[212:215], a[16:19], a[184:187], v[212:215]
    ds_read_b128 v[80:83], v24 offset:23200
    v_mul_f32 v180, v180, v104
    v_mfma_f32_16x16x32_bf16 v[212:215], a[20:23], a[188:191], v[212:215]
    ds_read_b128 a[0:3], v40 offset:14336
    v_cvt_pk_bf16_f32 v64, v148, v180
    v_mfma_f32_16x16x32_bf16 v[212:215], a[24:27], a[152:155], v[212:215]
    ds_read_b128 a[4:7], v41 offset:14336
    v_mul_f32 v181, v181, v105
    v_mfma_f32_16x16x32_bf16 v[212:215], a[28:31], a[156:159], v[212:215]
    v_mul_f32 v182, v182, v106
    v_cvt_pk_bf16_f32 v67, v150, v182
    v_mfma_f32_16x16x32_bf16 v[248:251], a[248:251], a[66:69], v[248:251]
    v_mul_f32 v183, v183, v107
    v_mfma_f32_16x16x32_bf16 v[248:251], a[252:255], a[50:53], v[248:251]
    s_waitcnt lgkmcnt(3)
    ds_read_b128 a[216:219], v40 offset:30720
    v_mfma_f32_16x16x32_bf16 v[248:251], a[144:147], a[74:77], v[248:251]
    buffer_store_dwordx4 v[76:79], v25, s[16:19], s66 offen sc1
    v_mfma_f32_16x16x32_bf16 v[248:251], a[148:151], a[34:37], v[248:251]
    s_mov_b32 s66, 573440
    v_add_f32 v244, v244, v72
    v_mul_f32 v244, v244, v96
    v_mfma_f32_16x16x32_bf16 v[152:155], a[224:227], a[64:67], v[152:155]
    v_add_f32 v245, v245, v73
    v_mul_f32 v245, v245, v97
    v_mfma_f32_16x16x32_bf16 v[152:155], a[228:231], a[68:71], v[152:155]
    s_waitcnt lgkmcnt(3)
    ds_read_b128 a[220:223], v41 offset:30720
    v_mfma_f32_16x16x32_bf16 v[152:155], a[8:11], a[48:51], v[152:155]
    buffer_store_dwordx4 v[80:83], v25, s[16:19], s67 offen sc1
    v_mfma_f32_16x16x32_bf16 v[152:155], a[12:15], a[52:55], v[152:155]
    s_mov_b32 s67, 587776
    ds_write_addtid_b32 v250 offset:6144
    v_cvt_pk_bf16_f32 v72, v244, v245
    v_mfma_f32_16x16x32_bf16 v[152:155], a[168:171], a[72:75], v[152:155]
    ds_write_b32 v28, v72 offset:29696
    v_mfma_f32_16x16x32_bf16 v[152:155], a[172:175], a[76:79], v[152:155]
    v_mul_f32 v212, v212, v108
    v_mul_f32 v213, v213, v109
    v_mfma_f32_16x16x32_bf16 v[152:155], a[40:43], a[32:35], v[152:155]
    v_mul_f32 v214, v214, v110
    v_mul_f32 v215, v215, v111
    v_mfma_f32_16x16x32_bf16 v[152:155], a[44:47], a[36:39], v[152:155]
    v_cvt_pk_bf16_f32 v65, v212, v149
    v_cvt_pk_bf16_f32 v66, v181, v213
    v_mfma_f32_16x16x32_bf16 v[184:187], a[96:99], a[64:67], v[184:187]
    ds_write_b64 v26, v[64:65] offset:29696
    v_mfma_f32_16x16x32_bf16 v[184:187], a[100:103], a[68:71], v[184:187]
    ds_read_b128 a[88:91], v40 offset:47104
    v_cvt_pk_bf16_f32 v84, v214, v151
    v_mfma_f32_16x16x32_bf16 v[184:187], a[80:83], a[48:51], v[184:187]
    ds_write_b64 v26, v[66:67] offset:29704
    v_mfma_f32_16x16x32_bf16 v[184:187], a[84:87], a[52:55], v[184:187]
    ds_write_addtid_b32 v251 offset:6400
    v_cvt_pk_bf16_f32 v85, v183, v215
    v_mfma_f32_16x16x32_bf16 v[184:187], a[232:235], a[72:75], v[184:187]
    ds_read_b128 a[92:95], v41 offset:47104
    v_mul_f32 v152, v152, v100
    v_mfma_f32_16x16x32_bf16 v[184:187], a[236:239], a[76:79], v[184:187]
    ds_write_b64 v26, v[84:85] offset:29712
    v_mfma_f32_16x16x32_bf16 v[184:187], a[208:211], a[32:35], v[184:187]
    ds_read_b128 a[56:59], v40 offset:63488
    v_mul_f32 v153, v153, v101
    v_mfma_f32_16x16x32_bf16 v[184:187], a[212:215], a[36:39], v[184:187]
    ds_read_b128 a[60:63], v41 offset:63488
    v_mul_f32 v154, v154, v102
    v_mfma_f32_16x16x32_bf16 v[216:219], a[104:107], a[64:67], v[216:219]
    ds_read_b128 a[136:139], v42 offset:14336
    v_mul_f32 v155, v155, v103
    v_mfma_f32_16x16x32_bf16 v[216:219], a[108:111], a[68:71], v[216:219]
    ds_read_b128 a[140:143], v43 offset:14336
    v_mfma_f32_16x16x32_bf16 v[216:219], a[128:131], a[48:51], v[216:219]
    s_waitcnt lgkmcnt(4)
    s_barrier
    v_mfma_f32_16x16x32_bf16 v[216:219], a[132:135], a[52:55], v[216:219]
    ds_read_b128 a[184:187], v42 offset:30720
    ds_read2st64_b32 v[120:121], v30 offset0:24 offset1:25
    v_mfma_f32_16x16x32_bf16 v[216:219], a[16:19], a[72:75], v[216:219]
    ds_read_b128 a[188:191], v43 offset:30720
    v_mul_f32 v184, v184, v104
    v_mfma_f32_16x16x32_bf16 v[216:219], a[20:23], a[76:79], v[216:219]
    ds_read_b128 v[116:119], v24 offset:29696
    v_cvt_pk_bf16_f32 v112, v152, v184
    v_mfma_f32_16x16x32_bf16 v[216:219], a[24:27], a[32:35], v[216:219]
    ds_read_b128 v[124:127], v24 offset:30624
    v_mul_f32 v185, v185, v105
    v_mfma_f32_16x16x32_bf16 v[216:219], a[28:31], a[36:39], v[216:219]
    v_mul_f32 v186, v186, v106
    v_cvt_pk_bf16_f32 v115, v154, v186
    v_mfma_f32_16x16x32_bf16 v[252:255], a[160:163], a[2:5], v[252:255]
    v_mul_f32 v187, v187, v107
    v_mfma_f32_16x16x32_bf16 v[252:255], a[164:167], a[218:221], v[252:255]
    v_mfma_f32_16x16x32_bf16 v[252:255], a[248:251], a[90:93], v[252:255]
    s_waitcnt lgkmcnt(3)
    v_add_f32 v248, v248, v120
    v_mul_f32 v248, v248, v96
    v_mfma_f32_16x16x32_bf16 v[252:255], a[252:255], a[58:61], v[252:255]
    s_waitcnt lgkmcnt(1)
    v_add_f32 v249, v249, v121
    v_mfma_f32_16x16x32_bf16 v[252:255], a[144:147], a[138:141], v[252:255]
    buffer_store_dwordx4 v[116:119], v25, s[16:19], s66 offen sc1
    v_mfma_f32_16x16x32_bf16 v[252:255], a[148:151], a[186:189], v[252:255]
    s_mov_b32 s66, 688128
    v_mul_f32 v249, v249, v97
    v_cvt_pk_bf16_f32 v120, v248, v249
    v_mfma_f32_16x16x32_bf16 v[156:159], a[120:123], a[0:3], v[156:159]
    ds_write_b32 v28, v120 offset:37120
    v_mfma_f32_16x16x32_bf16 v[156:159], a[124:127], a[4:7], v[156:159]
    s_waitcnt lgkmcnt(1)
    v_mul_f32 v216, v216, v108
    v_mfma_f32_16x16x32_bf16 v[156:159], a[192:195], a[216:219], v[156:159]
    buffer_store_dwordx4 v[124:127], v25, s[16:19], s67 offen sc1
    v_mfma_f32_16x16x32_bf16 v[156:159], a[196:199], a[220:223], v[156:159]
    s_mov_b32 s67, 702464
    v_mul_f32 v217, v217, v109
    v_mul_f32 v218, v218, v110
    v_mfma_f32_16x16x32_bf16 v[156:159], a[224:227], a[88:91], v[156:159]
    v_mul_f32 v219, v219, v111
    v_cvt_pk_bf16_f32 v113, v216, v153
    v_mfma_f32_16x16x32_bf16 v[156:159], a[228:231], a[92:95], v[156:159]
    ds_write_b64 v26, v[112:113] offset:37120
    v_mfma_f32_16x16x32_bf16 v[156:159], a[8:11], a[56:59], v[156:159]
    v_cvt_pk_bf16_f32 v114, v185, v217
    v_cvt_pk_bf16_f32 v92, v218, v155
    v_mfma_f32_16x16x32_bf16 v[156:159], a[12:15], a[60:63], v[156:159]
    ds_write_b64 v26, v[114:115] offset:37128
    v_mfma_f32_16x16x32_bf16 v[156:159], a[168:171], a[136:139], v[156:159]
    ds_write_addtid_b32 v254 offset:8192
    v_cvt_pk_bf16_f32 v93, v187, v219
    v_mfma_f32_16x16x32_bf16 v[156:159], a[172:175], a[140:143], v[156:159]
    ds_write_b64 v26, v[92:93] offset:37136
    v_mfma_f32_16x16x32_bf16 v[156:159], a[40:43], a[184:187], v[156:159]
    ds_write_addtid_b32 v255 offset:8448
    v_mfma_f32_16x16x32_bf16 v[156:159], a[44:47], a[188:191], v[156:159]
    v_mfma_f32_16x16x32_bf16 v[188:191], a[176:179], a[0:3], v[188:191]
    v_mfma_f32_16x16x32_bf16 v[188:191], a[180:183], a[4:7], v[188:191]
    v_mfma_f32_16x16x32_bf16 v[188:191], a[200:203], a[216:219], v[188:191]
    v_mfma_f32_16x16x32_bf16 v[188:191], a[204:207], a[220:223], v[188:191]
    s_waitcnt lgkmcnt(0)
    s_barrier
    v_mfma_f32_16x16x32_bf16 v[188:191], a[96:99], a[88:91], v[188:191]
    ds_read_b128 v[88:91], v24 offset:37120
    ds_read2st64_b32 v[48:49], v30 offset0:32 offset1:33
    v_mfma_f32_16x16x32_bf16 v[188:191], a[100:103], a[92:95], v[188:191]
    ds_read_b128 v[52:55], v24 offset:38048
    v_mul_f32 v156, v156, v100
    v_mfma_f32_16x16x32_bf16 v[188:191], a[80:83], a[56:59], v[188:191]
    v_mul_f32 v157, v157, v101
    v_mul_f32 v158, v158, v102
    v_mfma_f32_16x16x32_bf16 v[188:191], a[84:87], a[60:63], v[188:191]
    v_mul_f32 v159, v159, v103
    v_mfma_f32_16x16x32_bf16 v[188:191], a[232:235], a[136:139], v[188:191]
    v_mfma_f32_16x16x32_bf16 v[188:191], a[236:239], a[140:143], v[188:191]
    v_mfma_f32_16x16x32_bf16 v[188:191], a[208:211], a[184:187], v[188:191]
    s_waitcnt lgkmcnt(1)
    v_mfma_f32_16x16x32_bf16 v[188:191], a[212:215], a[188:191], v[188:191]
    buffer_store_dwordx4 v[88:91], v25, s[16:19], s66 offen sc1
    v_mfma_f32_16x16x32_bf16 v[220:223], a[112:115], a[0:3], v[220:223]
    s_mov_b32 s66, 802816
    v_add_f32 v252, v252, v48
    v_mul_f32 v252, v252, v96
    v_mfma_f32_16x16x32_bf16 v[220:223], a[116:119], a[4:7], v[220:223]
    v_add_f32 v253, v253, v49
    v_mul_f32 v253, v253, v97
    v_mfma_f32_16x16x32_bf16 v[220:223], a[240:243], a[216:219], v[220:223]
    s_waitcnt lgkmcnt(0)
    v_cvt_pk_bf16_f32 v48, v252, v253
    v_mfma_f32_16x16x32_bf16 v[220:223], a[244:247], a[220:223], v[220:223]
    buffer_store_dwordx4 v[52:55], v25, s[16:19], s67 offen sc1
    v_mfma_f32_16x16x32_bf16 v[220:223], a[104:107], a[88:91], v[220:223]
    s_mov_b32 s67, 817152
    ds_write_b32 v28, v48 offset:44544
    v_mfma_f32_16x16x32_bf16 v[220:223], a[108:111], a[92:95], v[220:223]
    v_mul_f32 v188, v188, v104
    v_cvt_pk_bf16_f32 v68, v156, v188
    v_mfma_f32_16x16x32_bf16 v[220:223], a[128:131], a[56:59], v[220:223]
    v_mul_f32 v189, v189, v105
    v_mul_f32 v190, v190, v106
    v_mfma_f32_16x16x32_bf16 v[220:223], a[132:135], a[60:63], v[220:223]
    v_cvt_pk_bf16_f32 v71, v158, v190
    v_mul_f32 v191, v191, v107
    v_mfma_f32_16x16x32_bf16 v[220:223], a[16:19], a[136:139], v[220:223]
    v_mfma_f32_16x16x32_bf16 v[220:223], a[20:23], a[140:143], v[220:223]
    v_mfma_f32_16x16x32_bf16 v[220:223], a[24:27], a[184:187], v[220:223]
    v_mfma_f32_16x16x32_bf16 v[220:223], a[28:31], a[188:191], v[220:223]
    s_nop 7
    v_mul_f32 v220, v220, v108
    v_mul_f32 v221, v221, v109
    v_mul_f32 v222, v222, v110
    v_mul_f32 v223, v223, v111
    v_cvt_pk_bf16_f32 v69, v220, v157
    v_cvt_pk_bf16_f32 v70, v189, v221
    v_cvt_pk_bf16_f32 v76, v222, v159
    v_cvt_pk_bf16_f32 v77, v191, v223
    ds_write_b64 v26, v[68:69] offset:44544
    ds_write_b64 v26, v[70:71] offset:44552
    ds_write_b64 v26, v[76:77] offset:44560
    s_waitcnt lgkmcnt(0)
    s_barrier
    ds_read_b128 v[80:83], v24 offset:44544
    ds_read_b128 v[72:75], v24 offset:45472
    s_waitcnt lgkmcnt(1)
    buffer_store_dwordx4 v[80:83], v25, s[16:19], s66 offen sc1
    s_waitcnt lgkmcnt(0)
    buffer_store_dwordx4 v[72:75], v25, s[16:19], s67 offen sc1
L_end:
    s_endpgm
L_help:
    s_mov_b32 s53, s61
    s_mov_b32 s54, s62
    s_mul_i32 s61, s22, 1835008
    s_add_u32 s61, s61, s79
    s_lshl_b32 s62, s22, 14
    s_add_u32 s62, s62, s68
    s_mov_b32 s22, 0
L_help_row:
    v_mov_b32 v21, v19
    s_xor_b32 s23, s22, s58
    s_bitcmp0_b32 s23, 2
    s_cbranch_scc1 L_help_same
    v_add_u32 v12, 57344, v19
    v_subrev_u32 v13, 57344, v19
    v_min_u32 v21, v12, v13
L_help_same:
    v_mov_b32 v8, 0
    v_mov_b32 v9, 0
    v_mov_b32 v10, 0
    v_mov_b32 v11, s47
    s_mov_b32 s23, 0
L_help_e:
    v_mov_b32 v15, 0
    buffer_load_dwordx3 v[12:14], v18, s[4:7], s61 offen nt
    s_cmp_ge_u32 s23, 16
    s_cbranch_scc1 L_help_own
    buffer_load_dword v15, v21, s[4:7], s61 offen nt
L_help_own:
    s_waitcnt vmcnt(0)
    v_lshl_or_b32 v8, v12, s23, v8
    v_lshl_or_b32 v9, v13, s23, v9
    v_lshl_or_b32 v10, v14, s23, v10
    v_lshl_or_b32 v11, v15, s23, v11
    s_add_u32 s61, s61, 14336
    s_add_u32 s23, s23, 4
    s_cmp_lt_u32 s23, 32
    s_cbranch_scc1 L_help_e
    buffer_store_dwordx4 v[8:11], v20, s[12:15], s62 offen sc1
    s_add_u32 s62, s62, 1024
    s_waitcnt vmcnt(0)
    s_add_u32 s22, s22, 1
    s_cmp_lt_u32 s22, 16
    s_cbranch_scc1 L_help_row
    s_mov_b32 s61, s53
    s_mov_b32 s62, s54
    s_setpc_b64 s[20:21]
L_code_end:

.section .rodata,"a"
.p2align 6
.amdhsa_kernel standalone__normalfloat_lut_af4__prompt_kernel
  .amdhsa_next_free_vgpr 512
  .amdhsa_next_free_sgpr 102
  .amdhsa_accum_offset 256
  .amdhsa_group_segment_fixed_size 0
  .amdhsa_kernarg_size 56
  .amdhsa_user_sgpr_count 2
  .amdhsa_user_sgpr_kernarg_segment_ptr 1
  .amdhsa_system_sgpr_workgroup_id_x 1
.end_amdhsa_kernel
```

```asm
; @launch grid=(256,1,1) block=(256,1,1) lds=163840
.amdgcn_target "amdgcn-amd-amdhsa--gfx950"
.text
.globl standalone__normalfloat_lut_af4__prompt_kernel
.p2align 8
.type standalone__normalfloat_lut_af4__prompt_kernel,@function
standalone__normalfloat_lut_af4__prompt_kernel:
    s_cmp_ge_u32 s2, 256
    s_cbranch_scc1 L_end
    s_load_dwordx2 s[4:5], s[0:1], 8
    s_load_dwordx2 s[12:13], s[0:1], 48
    s_load_dwordx2 s[8:9], s[0:1], 0
    s_load_dwordx2 s[28:29], s[0:1], 16
    s_getpc_b64 s[48:49]
L_pc:
    s_mov_b32 s50, L_code_end-L_pc
    s_mov_b32 s51, 0x20000
    s_lshr_b32 s61, s2, 3
    v_lshl_add_u32 v46, v0, 5, s61
    v_lshlrev_b32 v46, 7, v46
    buffer_load_dword v1, v46, s[48:51], 0 offen offset:256
    v_lshrrev_b32 v5, 6, v0
    v_and_b32 v2, 63, v0
    s_and_b32 s60, s2, 7
    v_readfirstlane_b32 s63, v5
    s_and_b32 s58, s60, 1
    s_lshl_b32 s58, s58, 3
    s_and_b32 s62, s61, 7
    s_add_u32 s58, s58, s62
    s_lshr_b32 s59, s60, 1
    s_lshl_b32 s59, s59, 2
    s_lshr_b32 s62, s61, 3
    s_add_u32 s59, s59, s62
    v_mul_u32_u24 v18, 12, v2
    s_lshl_b32 s60, s63, 4
    s_add_u32 s60, s60, s58
    s_mul_i32 s61, s60, 114688
    s_mul_i32 s79, s59, 896
    s_add_u32 s61, s61, s79
    s_mov_b32 s6, 14680064
    s_mov_b32 s7, 0x20000
    s_lshl_b32 s78, s59, 7
    s_add_u32 s78, s78, 2097164
    v_and_b32 v4, 15, v2
    v_lshrrev_b32 v3, 4, v2
    v_and_b32 v12, 1, v3
    v_lshlrev_b32 v13, 1, v12
    v_xor_b32 v13, v13, v4
    v_lshrrev_b32 v19, 1, v3
    v_lshl_add_u32 v19, v19, 4, v13
    s_bfe_u32 s70, s58, 0x10002
    s_xor_b32 s70, s70, 1
    v_xor_b32 v12, s70, v12
    v_mul_u32_u24 v12, 14336, v12
    v_add_lshl_u32 v19, v19, v12, 2
    v_add_u32 v19, 768, v19
    s_mov_b32 s46, 2
    s_cmp_lg_u32 s63, 0
    s_cbranch_scc1 L_role0
    s_mov_b32 s46, 0
L_role0:
    s_cmp_lg_u32 s63, 1
    s_cbranch_scc1 L_role1
    s_mov_b32 s46, 1
L_role1:
    v_lshlrev_b32 v16, 1, v4
    v_lshrrev_b32 v17, 4, v0
    v_lshlrev_b32 v17, 1, v17
    s_mov_b32 s30, 32
    s_mov_b32 s31, 0x20000
    v_lshrrev_b32 v6, 3, v2
    v_and_b32 v7, 7, v2
    v_xor_b32 v13, v7, v3
    s_lshl_b32 s70, s63, 5
    v_add_lshl_u32 v12, v6, s70, 11
    v_lshl_add_u32 v36, v13, 4, v12
    v_xor_b32 v37, 64, v36
    v_add_u32 v37, 15360, v37
    v_add_u32 v38, 30720, v36
    v_add_u32 v39, 30720, v37
    s_mov_b32 s10, 4194304
    s_mov_b32 s11, 0x20000
    s_lshl_b32 s55, s58, 18
    s_and_b32 s71, s58, 8
    s_lshl_b32 s70, s71, 4
    s_add_u32 s55, s55, s70
    s_lshl_b32 s57, s63, 12
    s_xor_b32 s69, s55, 128
    s_add_u32 s57, s57, 65536
    s_mov_b32 s14, 2099200
    s_mov_b32 s15, 0x20000
    s_lshl_b32 s68, s59, 17
    s_lshl_b32 s62, s60, 10
    s_add_u32 s62, s62, s68
    v_lshlrev_b32 v20, 4, v2
    s_waitcnt lgkmcnt(0)
    s_load_dword s76, s[12:13], s78
    s_cmp_eq_u32 s46, 1
    s_cbranch_scc1 L_L
    s_cmp_eq_u32 s46, 2
    s_cbranch_scc1 L_L
L_X:
    buffer_load_dwordx3 v[128:130], v18, s[4:7], s61 offen nt
    buffer_load_dword v131, v19, s[4:7], s61 offen nt
    s_add_u32 s61, s61, 14336
    buffer_load_dwordx3 v[132:134], v18, s[4:7], s61 offen nt
    buffer_load_dword v135, v19, s[4:7], s61 offen nt
    s_add_u32 s61, s61, 14336
    buffer_load_dwordx3 v[136:138], v18, s[4:7], s61 offen nt
    buffer_load_dword v139, v19, s[4:7], s61 offen nt
    s_add_u32 s61, s61, 14336
    buffer_load_dwordx3 v[140:142], v18, s[4:7], s61 offen nt
    buffer_load_dword v143, v19, s[4:7], s61 offen nt
    s_add_u32 s61, s61, 14336
    buffer_load_dwordx3 v[144:146], v18, s[4:7], s61 offen nt
    s_add_u32 s61, s61, 14336
    buffer_load_dwordx3 v[148:150], v18, s[4:7], s61 offen nt
    s_add_u32 s61, s61, 14336
    buffer_load_dwordx3 v[152:154], v18, s[4:7], s61 offen nt
    s_add_u32 s61, s61, 14336
    buffer_load_dwordx3 v[156:158], v18, s[4:7], s61 offen nt
    s_add_u32 s61, s61, 7239680
    s_cmp_eq_u32 s46, 1
    s_cbranch_scc1 L_D
    s_cmp_eq_u32 s46, 2
    s_cbranch_scc1 L_B
L_L:
    buffer_load_ushort v16, v16, s[28:31], 0 offen
    buffer_load_ushort v17, v17, s[28:31], 0 offen
    s_cmp_eq_u32 s46, 1
    s_cbranch_scc1 L_S
    s_cmp_eq_u32 s46, 2
    s_cbranch_scc1 L_S
L_D:
    s_add_u32 m0, s57, 32768
    s_add_u32 s56, s55, 0
    buffer_load_dwordx4 v36, s[8:11], s56 offen offset:0  lds
    buffer_load_dwordx4 v37, s[8:11], s56 offen offset:1024  lds
    buffer_load_dwordx4 v38, s[8:11], s56 offen offset:2048  lds
    buffer_load_dwordx4 v39, s[8:11], s56 offen offset:3072  lds
    s_cmp_eq_u32 s46, 1
    s_cbranch_scc1 L_G
    s_cmp_eq_u32 s46, 2
    s_cbranch_scc1 L_G
L_S:
    s_load_dwordx2 s[32:33], s[0:1], 24
    s_load_dwordx2 s[16:17], s[0:1], 32
    s_load_dwordx2 s[24:25], s[0:1], 40
    s_and_b32 s64, s63, 1
    s_lshr_b32 s65, s63, 1
    s_and_b32 s70, s58, 8
    s_lshl_b32 s70, s70, 10
    s_lshl_b32 s71, s64, 12
    s_add_u32 s70, s70, s71
    s_lshl_b32 s71, s63, 8
    s_add_u32 s70, s70, s71
    s_add_u32 s70, s70, s68
    v_lshl_add_u32 v32, v4, 4, s70
    v_lshl_add_u32 v32, v3, 10, v32
    v_xor_b32 v33, 4096, v32
    v_xor_b32 v34, 8192, v32
    v_xor_b32 v44, 12288, v32
    s_mov_b32 s36, 202114048
    s_mov_b32 s37, 202114304
    s_mov_b32 s38, 202114560
    s_mov_b32 s39, 202114816
    v_and_b32 v35, 31, v2
    v_lshlrev_b32 v35, 2, v35
    s_lshl_b32 s70, s64, 6
    s_add_u32 s70, s70, 65536
    v_lshrrev_b32 v12, 1, v4
    v_xor_b32 v12, v12, v3
    v_lshlrev_b32 v12, 4, v12
    v_lshl_add_u32 v12, v4, 7, v12
    v_xor_b32 v40, s70, v12
    v_xor_b32 v41, 64, v40
    v_add_u32 v42, 65536, v40
    v_add_u32 v43, 65536, v41
    s_mov_b32 s52, 0
    v_lshlrev_b32 v8, 4, v7
    v_lshl_add_u32 v8, v0, 8, v8
    v_xor_b32 v9, 16, v8
    v_xor_b32 v10, 32, v8
    v_xor_b32 v11, 48, v8
    v_xor_b32 v12, 64, v8
    v_xor_b32 v13, 80, v8
    v_xor_b32 v14, 96, v8
    v_xor_b32 v15, 112, v8
    s_cmp_eq_u32 s46, 1
    s_cbranch_scc1 L_X
    s_cmp_eq_u32 s46, 2
    s_cbranch_scc1 L_D
L_G:
    s_waitcnt lgkmcnt(0)
    s_add_u32 s76, s76, 2654435769
    s_and_b32 s47, s76, 0xffff0000
    s_cmp_eq_u32 s46, 1
    s_cbranch_scc1 L_T
    s_cmp_eq_u32 s46, 2
    s_cbranch_scc1 L_T
L_K:
    s_waitcnt vmcnt(16)
    v_or_b32 v131, s47, v131
    s_waitcnt vmcnt(15)
    v_lshl_or_b32 v128, v132, 4, v128
    v_lshl_or_b32 v129, v133, 4, v129
    v_lshl_or_b32 v130, v134, 4, v130
    s_waitcnt vmcnt(14)
    v_lshl_or_b32 v131, v135, 4, v131
    s_waitcnt vmcnt(13)
    v_lshl_or_b32 v128, v136, 8, v128
    v_lshl_or_b32 v129, v137, 8, v129
    v_lshl_or_b32 v130, v138, 8, v130
    s_waitcnt vmcnt(12)
    v_lshl_or_b32 v131, v139, 8, v131
    s_waitcnt vmcnt(11)
    v_lshl_or_b32 v128, v140, 12, v128
    v_lshl_or_b32 v129, v141, 12, v129
    v_lshl_or_b32 v130, v142, 12, v130
    s_waitcnt vmcnt(10)
    v_lshl_or_b32 v131, v143, 12, v131
    s_waitcnt vmcnt(9)
    v_lshl_or_b32 v128, v144, 16, v128
    v_lshl_or_b32 v129, v145, 16, v129
    v_lshl_or_b32 v130, v146, 16, v130
    s_waitcnt vmcnt(8)
    v_lshl_or_b32 v128, v148, 20, v128
    v_lshl_or_b32 v129, v149, 20, v129
    v_lshl_or_b32 v130, v150, 20, v130
    s_waitcnt vmcnt(7)
    v_lshl_or_b32 v128, v152, 24, v128
    v_lshl_or_b32 v129, v153, 24, v129
    v_lshl_or_b32 v130, v154, 24, v130
    s_waitcnt vmcnt(6)
    v_lshl_or_b32 v128, v156, 28, v128
    v_lshl_or_b32 v129, v157, 28, v129
    v_lshl_or_b32 v130, v158, 28, v130
    buffer_store_dwordx4 v[128:131], v20, s[12:15], s62 offen sc1
    s_add_u32 s62, s62, 65536
    s_cmp_eq_u32 s46, 1
    s_cbranch_scc1 L_B
    s_cmp_eq_u32 s46, 2
    s_cbranch_scc1 L_E
L_T:
    s_waitcnt vmcnt(16)
    s_cmp_eq_u32 s46, 1
    s_cbranch_scc1 L_rw1
    s_waitcnt vmcnt(5)
    s_cmp_eq_u32 s46, 0
    s_cbranch_scc1 L_rw1
    s_waitcnt vmcnt(4)
L_rw1:
    v_lshl_or_b32 v56, v17, 16, v16
    v_lshl_or_b32 v57, v17, 16, v16
    v_lshl_or_b32 v58, v17, 16, v16
    v_lshl_or_b32 v59, v17, 16, v16
    ds_write_b128 v8, v[56:59]
    ds_write_b128 v9, v[56:59]
    ds_write_b128 v10, v[56:59]
    ds_write_b128 v11, v[56:59]
    ds_write_b128 v12, v[56:59]
    ds_write_b128 v13, v[56:59]
    ds_write_b128 v14, v[56:59]
    ds_write_b128 v15, v[56:59]
    s_cmp_lg_u32 s46, 1
    s_cbranch_scc1 L_ed2
    s_waitcnt vmcnt(4)
    s_branch L_K
L_ed2:
    s_cmp_eq_u32 s46, 2
    s_cbranch_scc1 L_X
L_W:
    s_mov_b64 exec, 0
    s_cmp_eq_u32 s63, 0
    s_cbranch_scc1 L_pad0
L_warmed:
    s_mov_b64 exec, -1
L_B:
    s_waitcnt vmcnt(12) lgkmcnt(0)
    s_cmp_eq_u32 s46, 2
    s_cbranch_scc1 L_rw3
    s_waitcnt vmcnt(1)
L_rw3:
    s_barrier
L_Q:
    ds_read_b128 a[0:3], v40 offset:32768
    ds_read_b128 a[4:7], v41 offset:32768
    ds_read_b128 a[8:11], v40 offset:34816
    ds_read_b128 a[12:15], v41 offset:34816
    ds_read_b128 a[16:19], v40 offset:36864
    ds_read_b128 a[20:23], v41 offset:36864
    ds_read_b128 a[24:27], v40 offset:38912
    ds_read_b128 a[28:31], v41 offset:38912
    ds_read_b128 a[40:43], v40 offset:40960
    ds_read_b128 a[44:47], v41 offset:40960
    ds_read_b128 a[48:51], v40 offset:43008
    ds_read_b128 a[52:55], v41 offset:43008
    ds_read_b128 a[56:59], v40 offset:45056
    ds_read_b128 a[60:63], v41 offset:45056
    ds_read_b128 a[72:75], v40 offset:47104
    ds_read_b128 a[76:79], v41 offset:47104
L_P:
    buffer_load_dwordx4 v[64:67], v32, s[12:15], 0 offen sc1
    buffer_load_dwordx4 v[68:71], v33, s[12:15], 0 offen sc1
L_d:
    s_add_u32 m0, s57, 49152
    s_add_u32 s3, s69, 0
    buffer_load_dwordx4 v36, s[8:11], s3 offen offset:0  lds
    buffer_load_dwordx4 v37, s[8:11], s3 offen offset:1024  lds
    buffer_load_dwordx4 v38, s[8:11], s3 offen offset:2048  lds
    buffer_load_dwordx4 v39, s[8:11], s3 offen offset:3072  lds
    s_cmp_lg_u32 s46, 2
    s_cbranch_scc1 L_ed4
    s_waitcnt vmcnt(6)
    s_branch L_K
L_ed4:
L_E:
L_chk0:
    s_waitcnt vmcnt(5)
    s_cmp_eq_u32 s46, 2
    s_cbranch_scc1 L_rw5
    s_waitcnt vmcnt(4)
L_rw5:
    v_bitop3_b32 v12, v67, v71, s76 bitop3:0x7e
    v_cmp_lt_u32 vcc, 0xffff, v12
    s_cbranch_vccnz L_retry0
    buffer_load_dwordx4 v[72:75], v34, s[12:15], 0 offen sc1
    buffer_load_dwordx4 v[76:79], v44, s[12:15], 0 offen sc1
    v_perm_b32 v56, v64, v35, s36
    v_perm_b32 v57, v64, v35, s37
    v_perm_b32 v58, v64, v35, s38
    v_perm_b32 v59, v64, v35, s39
    v_perm_b32 v60, v68, v35, s36
    v_perm_b32 v61, v68, v35, s37
    v_perm_b32 v62, v68, v35, s38
    v_perm_b32 v63, v68, v35, s39
    ds_read_b32 a32, v56
    ds_read_b32 a33, v57
    ds_read_b32 a34, v58
    ds_read_b32 a35, v59
    ds_read_b32 a36, v60
    ds_read_b32 a37, v61
    ds_read_b32 a38, v62
    ds_read_b32 a39, v63
    v_perm_b32 v5, v65, v35, s36
    v_perm_b32 v6, v65, v35, s37
    v_perm_b32 v7, v65, v35, s38
    v_perm_b32 v27, v65, v35, s39
    v_perm_b32 v29, v69, v35, s36
    v_perm_b32 v31, v69, v35, s37
    ds_read_b32 a64, v5
    ds_read_b32 a65, v6
    ds_read_b32 a66, v7
    ds_read_b32 a67, v27
    s_cbranch_vccz L_main
L_retry0:
    s_add_u32 s52, s52, 1
    s_and_b32 s23, s52, 4095
    s_cbranch_scc1 L_retry0b
    s_mov_b32 s22, 0
    s_call_b64 s[20:21], L_help
L_retry0b:
    buffer_load_dwordx4 v[64:67], v32, s[12:15], 0 offen sc1
    buffer_load_dwordx4 v[68:71], v33, s[12:15], 0 offen sc1
    s_waitcnt vmcnt(0) lgkmcnt(0)
    s_branch L_chk0
L_tick:
    s_add_u32 s52, s52, 1
    s_and_b32 s23, s52, 4095
    s_cbranch_scc0 L_help
    s_setpc_b64 s[20:21]
L_slow0_1:
    s_mov_b32 s22, 0
    s_call_b64 s[20:21], L_tick
    buffer_load_dwordx4 v[72:75], v34, s[12:15], 0 offen sc1
    buffer_load_dwordx4 v[76:79], v44, s[12:15], 0 offen sc1
    s_waitcnt vmcnt(0)
    v_bitop3_b32 v12, v75, v79, s76 bitop3:0x7e
    v_cmp_lt_u32 vcc, 0xffff, v12
    s_cbranch_vccnz L_slow0_1
    s_branch L_back0_1
L_slow4_0:
    s_mov_b32 s22, 4
    s_call_b64 s[20:21], L_tick
    buffer_load_dwordx4 v[96:99], v32, s[12:15], s43 offen sc1
    buffer_load_dwordx4 v[100:103], v33, s[12:15], s43 offen sc1
    s_waitcnt vmcnt(0)
    v_bitop3_b32 v12, v99, v103, s76 bitop3:0x7e
    v_cmp_lt_u32 vcc, 0xffff, v12
    s_cbranch_vccnz L_slow4_0
    s_branch L_back4_0
L_slow4_1:
    s_mov_b32 s22, 4
    s_call_b64 s[20:21], L_tick
    buffer_load_dwordx4 v[104:107], v34, s[12:15], s43 offen sc1
    buffer_load_dwordx4 v[108:111], v44, s[12:15], s43 offen sc1
    s_waitcnt vmcnt(0)
    v_bitop3_b32 v12, v107, v111, s76 bitop3:0x7e
    v_cmp_lt_u32 vcc, 0xffff, v12
    s_cbranch_vccnz L_slow4_1
    s_branch L_back4_1
L_slow1_0:
    s_mov_b32 s22, 1
    s_call_b64 s[20:21], L_tick
    buffer_load_dwordx4 v[80:83], v32, s[12:15], s40 offen sc1
    buffer_load_dwordx4 v[84:87], v33, s[12:15], s40 offen sc1
    s_waitcnt vmcnt(0)
    v_bitop3_b32 v12, v83, v87, s76 bitop3:0x7e
    v_cmp_lt_u32 vcc, 0xffff, v12
    s_cbranch_vccnz L_slow1_0
    s_branch L_back1_0
L_slow1_1:
    s_mov_b32 s22, 1
    s_call_b64 s[20:21], L_tick
    buffer_load_dwordx4 v[88:91], v34, s[12:15], s40 offen sc1
    buffer_load_dwordx4 v[92:95], v44, s[12:15], s40 offen sc1
    s_waitcnt vmcnt(0)
    v_bitop3_b32 v12, v91, v95, s76 bitop3:0x7e
    v_cmp_lt_u32 vcc, 0xffff, v12
    s_cbranch_vccnz L_slow1_1
    s_branch L_back1_1
L_slow5_0:
    s_mov_b32 s22, 5
    s_call_b64 s[20:21], L_tick
    buffer_load_dwordx4 v[112:115], v32, s[12:15], s44 offen sc1
    buffer_load_dwordx4 v[116:119], v33, s[12:15], s44 offen sc1
    s_waitcnt vmcnt(0)
    v_bitop3_b32 v12, v115, v119, s76 bitop3:0x7e
    v_cmp_lt_u32 vcc, 0xffff, v12
    s_cbranch_vccnz L_slow5_0
    s_branch L_back5_0
L_slow5_1:
    s_mov_b32 s22, 5
    s_call_b64 s[20:21], L_tick
    buffer_load_dwordx4 v[120:123], v34, s[12:15], s44 offen sc1
    buffer_load_dwordx4 v[124:127], v44, s[12:15], s44 offen sc1
    s_waitcnt vmcnt(0)
    v_bitop3_b32 v12, v123, v127, s76 bitop3:0x7e
    v_cmp_lt_u32 vcc, 0xffff, v12
    s_cbranch_vccnz L_slow5_1
    s_branch L_back5_1
L_slow2_0:
    s_mov_b32 s22, 2
    s_call_b64 s[20:21], L_tick
    buffer_load_dwordx4 v[48:51], v32, s[12:15], s41 offen sc1
    buffer_load_dwordx4 v[52:55], v33, s[12:15], s41 offen sc1
    s_waitcnt vmcnt(0)
    v_bitop3_b32 v12, v51, v55, s76 bitop3:0x7e
    v_cmp_lt_u32 vcc, 0xffff, v12
    s_cbranch_vccnz L_slow2_0
    s_branch L_back2_0
L_slow2_1:
    s_mov_b32 s22, 2
    s_call_b64 s[20:21], L_tick
    buffer_load_dwordx4 v[64:67], v34, s[12:15], s41 offen sc1
    buffer_load_dwordx4 v[68:71], v44, s[12:15], s41 offen sc1
    s_waitcnt vmcnt(0)
    v_bitop3_b32 v12, v67, v71, s76 bitop3:0x7e
    v_cmp_lt_u32 vcc, 0xffff, v12
    s_cbranch_vccnz L_slow2_1
    s_branch L_back2_1
L_slow6_0:
    s_mov_b32 s22, 6
    s_call_b64 s[20:21], L_tick
    buffer_load_dwordx4 v[88:91], v32, s[12:15], s45 offen sc1
    buffer_load_dwordx4 v[92:95], v33, s[12:15], s45 offen sc1
    s_waitcnt vmcnt(0)
    v_bitop3_b32 v12, v91, v95, s76 bitop3:0x7e
    v_cmp_lt_u32 vcc, 0xffff, v12
    s_cbranch_vccnz L_slow6_0
    s_branch L_back6_0
L_slow6_1:
    s_mov_b32 s22, 6
    s_call_b64 s[20:21], L_tick
    buffer_load_dwordx4 v[48:51], v34, s[12:15], s45 offen sc1
    buffer_load_dwordx4 v[52:55], v44, s[12:15], s45 offen sc1
    s_waitcnt vmcnt(0)
    v_bitop3_b32 v12, v51, v55, s76 bitop3:0x7e
    v_cmp_lt_u32 vcc, 0xffff, v12
    s_cbranch_vccnz L_slow6_1
    s_branch L_back6_1
L_slow3_0:
    s_mov_b32 s22, 3
    s_call_b64 s[20:21], L_tick
    buffer_load_dwordx4 v[72:75], v32, s[12:15], s42 offen sc1
    buffer_load_dwordx4 v[76:79], v33, s[12:15], s42 offen sc1
    s_waitcnt vmcnt(0)
    v_bitop3_b32 v12, v75, v79, s76 bitop3:0x7e
    v_cmp_lt_u32 vcc, 0xffff, v12
    s_cbranch_vccnz L_slow3_0
    s_branch L_back3_0
L_slow3_1:
    s_mov_b32 s22, 3
    s_call_b64 s[20:21], L_tick
    buffer_load_dwordx4 v[80:83], v34, s[12:15], s42 offen sc1
    buffer_load_dwordx4 v[84:87], v44, s[12:15], s42 offen sc1
    s_waitcnt vmcnt(0)
    v_bitop3_b32 v12, v83, v87, s76 bitop3:0x7e
    v_cmp_lt_u32 vcc, 0xffff, v12
    s_cbranch_vccnz L_slow3_1
    s_branch L_back3_1
L_slow7_0:
    s_mov_b32 s22, 7
    s_call_b64 s[20:21], L_tick
    buffer_load_dwordx4 v[68:71], v32, s[12:15], s72 offen sc1
    buffer_load_dwordx4 v[72:75], v33, s[12:15], s72 offen sc1
    s_waitcnt vmcnt(0)
    v_bitop3_b32 v12, v71, v75, s76 bitop3:0x7e
    v_cmp_lt_u32 vcc, 0xffff, v12
    s_cbranch_vccnz L_slow7_0
    s_branch L_back7_0
L_slow7_1:
    s_mov_b32 s22, 7
    s_call_b64 s[20:21], L_tick
    buffer_load_dwordx4 v[76:79], v34, s[12:15], s72 offen sc1
    buffer_load_dwordx4 v[80:83], v44, s[12:15], s72 offen sc1
    s_waitcnt vmcnt(0)
    v_bitop3_b32 v12, v79, v83, s76 bitop3:0x7e
    v_cmp_lt_u32 vcc, 0xffff, v12
    s_cbranch_vccnz L_slow7_1
    s_branch L_back7_1
.p2align 12
L_main:
L_pad0:
    s_cbranch_execz L_pad1
    s_waitcnt lgkmcnt(8)
    v_mfma_f32_16x16x32_bf16 v[128:131], a[32:35], a[0:3], 0
    s_waitcnt lgkmcnt(4)
    s_mov_b32 s40, 16384
    ds_read_b32 a68, v29
    v_mfma_f32_16x16x32_bf16 v[128:131], a[36:39], a[4:7], v[128:131]
    buffer_load_dwordx4 v[80:83], v32, s[12:15], s40 offen sc1
    v_mfma_f32_16x16x32_bf16 v[132:135], a[36:39], a[12:15], 0
    s_add_u32 m0, s57, 65536
    ds_read_b32 a69, v31
    v_perm_b32 v46, v69, v35, s38
    v_mfma_f32_16x16x32_bf16 v[132:135], a[32:35], a[8:11], v[132:135]
    s_add_u32 s56, s55, 256
    ds_read_b32 a70, v46
    v_perm_b32 v56, v69, v35, s39
    v_mfma_f32_16x16x32_bf16 v[136:139], a[32:35], a[16:19], 0
    s_add_u32 s3, s69, 256
    ds_read_b32 a71, v56
    v_mfma_f32_16x16x32_bf16 v[136:139], a[36:39], a[20:23], v[136:139]
    buffer_load_dwordx4 v[84:87], v33, s[12:15], s40 offen sc1
    v_mfma_f32_16x16x32_bf16 v[140:143], a[36:39], a[28:31], 0
    v_perm_b32 v57, v66, v35, s36
    v_perm_b32 v58, v66, v35, s37
    v_mfma_f32_16x16x32_bf16 v[140:143], a[32:35], a[24:27], v[140:143]
    ds_read_b32 a80, v57
    v_perm_b32 v59, v66, v35, s38
    v_mfma_f32_16x16x32_bf16 v[144:147], a[32:35], a[40:43], 0
    ds_read_b32 a81, v58
    v_mfma_f32_16x16x32_bf16 v[144:147], a[36:39], a[44:47], v[144:147]
    buffer_load_dwordx4 v36, s[8:11], s56 offen offset:0  lds
    v_mfma_f32_16x16x32_bf16 v[148:151], a[36:39], a[52:55], 0
    ds_read_b32 a82, v59
    v_perm_b32 v60, v66, v35, s39
    v_mfma_f32_16x16x32_bf16 v[148:151], a[32:35], a[48:51], v[148:151]
    v_perm_b32 v61, v70, v35, s36
    v_perm_b32 v62, v70, v35, s37
    v_mfma_f32_16x16x32_bf16 v[152:155], a[32:35], a[56:59], 0
    s_mov_b32 s41, 32768
    ds_read_b32 a83, v60
    ds_read_b32 a84, v61
    v_mfma_f32_16x16x32_bf16 v[152:155], a[36:39], a[60:63], v[152:155]
    buffer_load_dwordx4 v37, s[8:11], s56 offen offset:1024  lds
    v_mfma_f32_16x16x32_bf16 v[156:159], a[36:39], a[76:79], 0
    ds_read_b32 a85, v62
    v_perm_b32 v63, v70, v35, s38
    v_mfma_f32_16x16x32_bf16 v[156:159], a[32:35], a[72:75], v[156:159]
    s_waitcnt lgkmcnt(6)
    ds_read_b32 a86, v63
    v_perm_b32 v5, v70, v35, s39
    v_mfma_f32_16x16x32_bf16 v[160:163], a[64:67], a[0:3], 0
    ds_read_b32 a87, v5
    v_mfma_f32_16x16x32_bf16 v[160:163], a[68:71], a[4:7], v[160:163]
    buffer_load_dwordx4 v38, s[8:11], s56 offen offset:2048  lds
    v_mfma_f32_16x16x32_bf16 v[164:167], a[68:71], a[12:15], 0
    v_perm_b32 v6, v67, v35, s36
    v_perm_b32 v7, v67, v35, s37
    v_mfma_f32_16x16x32_bf16 v[164:167], a[64:67], a[8:11], v[164:167]
    ds_read_b32 a88, v6
    v_perm_b32 v27, v71, v35, s36
    v_mfma_f32_16x16x32_bf16 v[168:171], a[64:67], a[16:19], 0
    ds_read_b32 a89, v7
    v_mfma_f32_16x16x32_bf16 v[168:171], a[68:71], a[20:23], v[168:171]
    buffer_load_dwordx4 v39, s[8:11], s56 offen offset:3072  lds
    v_mfma_f32_16x16x32_bf16 v[172:175], a[68:71], a[28:31], 0
    s_add_u32 m0, s57, 81920
    ds_read_b32 a90, v27
    v_perm_b32 v29, v71, v35, s37
    v_mfma_f32_16x16x32_bf16 v[172:175], a[64:67], a[24:27], v[172:175]
    s_add_u32 s56, s55, 512
    ds_read_b32 a91, v29
    v_mfma_f32_16x16x32_bf16 v[176:179], a[64:67], a[40:43], 0
    s_waitcnt vmcnt(6)
    s_mov_b32 s42, 49152
    v_bitop3_b32 v31, v75, v79, s76 bitop3:0x7e
    v_mfma_f32_16x16x32_bf16 v[176:179], a[68:71], a[44:47], v[176:179]
    buffer_load_dwordx4 v[88:91], v34, s[12:15], s40 offen sc1
    v_mfma_f32_16x16x32_bf16 v[180:183], a[68:71], a[52:55], 0
    v_cmp_lt_u32 vcc, 0xffff, v31
    v_mfma_f32_16x16x32_bf16 v[180:183], a[64:67], a[48:51], v[180:183]
    v_mfma_f32_16x16x32_bf16 v[184:187], a[64:67], a[56:59], 0
    s_cbranch_vccnz L_slow0_1
L_back0_1:
    v_mfma_f32_16x16x32_bf16 v[184:187], a[68:71], a[60:63], v[184:187]
    buffer_load_dwordx4 v[92:95], v44, s[12:15], s40 offen sc1
    v_mfma_f32_16x16x32_bf16 v[188:191], a[68:71], a[76:79], 0
    v_perm_b32 v46, v72, v35, s36
    v_perm_b32 v56, v72, v35, s37
    v_mfma_f32_16x16x32_bf16 v[188:191], a[64:67], a[72:75], v[188:191]
    s_waitcnt lgkmcnt(1)
    ds_read_b32 a96, v46
    v_perm_b32 v57, v72, v35, s38
    v_mfma_f32_16x16x32_bf16 v[192:195], a[80:83], a[0:3], 0
    s_barrier
    v_mfma_f32_16x16x32_bf16 v[192:195], a[84:87], a[4:7], v[192:195]
    buffer_load_dwordx4 v36, s[8:11], s3 offen offset:0  lds
    v_mfma_f32_16x16x32_bf16 v[196:199], a[84:87], a[12:15], 0
    ds_read_b32 a97, v56
    v_perm_b32 v58, v72, v35, s39
    v_mfma_f32_16x16x32_bf16 v[196:199], a[80:83], a[8:11], v[196:199]
    ds_read_b32 a98, v57
    ds_read_b32 a99, v58
    v_mfma_f32_16x16x32_bf16 v[200:203], a[80:83], a[16:19], 0
    s_mov_b32 s43, 65536
    ds_read_b128 a[104:107], v40 offset:49152
    v_mfma_f32_16x16x32_bf16 v[200:203], a[84:87], a[20:23], v[200:203]
    buffer_load_dwordx4 v37, s[8:11], s3 offen offset:1024  lds
    v_mfma_f32_16x16x32_bf16 v[204:207], a[84:87], a[28:31], 0
    ds_read_b128 a[108:111], v41 offset:49152
    v_perm_b32 v59, v76, v35, s36
    v_mfma_f32_16x16x32_bf16 v[204:207], a[80:83], a[24:27], v[204:207]
    ds_read_b32 a100, v59
    v_perm_b32 v60, v76, v35, s37
    v_mfma_f32_16x16x32_bf16 v[208:211], a[80:83], a[40:43], 0
    ds_read_b32 a101, v60
    ds_read_b128 a[112:115], v40 offset:51200
    v_mfma_f32_16x16x32_bf16 v[208:211], a[84:87], a[44:47], v[208:211]
    buffer_load_dwordx4 v38, s[8:11], s3 offen offset:2048  lds
    v_mfma_f32_16x16x32_bf16 v[212:215], a[84:87], a[52:55], 0
    ds_read_b128 a[116:119], v41 offset:51200
    v_perm_b32 v61, v76, v35, s38
    v_mfma_f32_16x16x32_bf16 v[212:215], a[80:83], a[48:51], v[212:215]
    ds_read_b32 a102, v61
    v_perm_b32 v62, v76, v35, s39
    v_mfma_f32_16x16x32_bf16 v[216:219], a[80:83], a[56:59], 0
    ds_read_b32 a103, v62
    v_perm_b32 v63, v73, v35, s36
    v_mfma_f32_16x16x32_bf16 v[216:219], a[84:87], a[60:63], v[216:219]
    ds_read_b32 a120, v63
    v_perm_b32 v5, v73, v35, s37
    v_mfma_f32_16x16x32_bf16 v[220:223], a[84:87], a[76:79], 0
    ds_read_b128 a[128:131], v40 offset:53248
    ds_read_b32 a121, v5
    v_mfma_f32_16x16x32_bf16 v[220:223], a[80:83], a[72:75], v[220:223]
    s_waitcnt lgkmcnt(9)
    ds_read_b128 a[132:135], v41 offset:53248
    v_mfma_f32_16x16x32_bf16 v[224:227], a[88:91], a[2:5], 0
    buffer_load_dwordx4 v39, s[8:11], s3 offen offset:3072  lds
    v_mfma_f32_16x16x32_bf16 v[228:231], a[88:91], a[10:13], 0
    s_add_u32 m0, s57, 0
    ds_read_b128 a[136:139], v40 offset:55296
    v_perm_b32 v6, v73, v35, s38
    v_mfma_f32_16x16x32_bf16 v[232:235], a[88:91], a[18:21], 0
    s_add_u32 s3, s69, 512
    ds_read_b128 a[140:143], v41 offset:55296
    v_perm_b32 v7, v73, v35, s39
    v_mfma_f32_16x16x32_bf16 v[236:239], a[88:91], a[26:29], 0
    s_mov_b32 s44, 81920
    ds_read_b32 a122, v6
    ds_read_b32 a123, v7
    v_mfma_f32_16x16x32_bf16 v[240:243], a[88:91], a[42:45], 0
    ds_read_b128 a[144:147], v40 offset:57344
    v_mfma_f32_16x16x32_bf16 v[244:247], a[88:91], a[50:53], 0
    buffer_load_dwordx3 v[96:98], v18, s[4:7], s61 offen nt
    v_mfma_f32_16x16x32_bf16 v[248:251], a[88:91], a[58:61], 0
    ds_read_b128 a[148:151], v41 offset:57344
    v_perm_b32 v27, v77, v35, s36
    v_mfma_f32_16x16x32_bf16 v[252:255], a[88:91], a[74:77], 0
    ds_read_b128 a[156:159], v41 offset:59392
    v_perm_b32 v29, v77, v35, s37
    v_mfma_f32_16x16x32_bf16 v[128:131], a[96:99], a[104:107], v[128:131]
    s_waitcnt lgkmcnt(7)
    ds_read_b128 a[152:155], v40 offset:59392
    ds_read_b32 a124, v27
    v_mfma_f32_16x16x32_bf16 v[128:131], a[100:103], a[108:111], v[128:131]
    buffer_load_dword v99, v19, s[4:7], s61 offen nt
    v_mfma_f32_16x16x32_bf16 v[132:135], a[100:103], a[116:119], v[132:135]
    s_add_u32 s61, s61, 14336
    ds_read_b128 a[160:163], v40 offset:61440
    v_perm_b32 v31, v77, v35, s38
    v_mfma_f32_16x16x32_bf16 v[132:135], a[96:99], a[112:115], v[132:135]
    s_waitcnt lgkmcnt(8)
    ds_read_b128 a[164:167], v41 offset:61440
    v_perm_b32 v46, v77, v35, s39
    v_mfma_f32_16x16x32_bf16 v[136:139], a[96:99], a[128:131], v[136:139]
    s_mov_b32 s45, 98304
    ds_read_b32 a125, v29
    ds_read_b32 a126, v31
    v_mfma_f32_16x16x32_bf16 v[136:139], a[100:103], a[132:135], v[136:139]
    buffer_load_dwordx3 v[100:102], v18, s[4:7], s61 offen nt
    v_mfma_f32_16x16x32_bf16 v[140:143], a[100:103], a[140:143], v[140:143]
    s_waitcnt vmcnt(13)
    ds_read_b128 a[168:171], v40 offset:63488
    v_bitop3_b32 v56, v83, v87, s76 bitop3:0x7e
    v_mfma_f32_16x16x32_bf16 v[140:143], a[96:99], a[136:139], v[140:143]
    s_waitcnt lgkmcnt(8)
    ds_read_b128 a[172:175], v41 offset:63488
    ds_read_b32 a127, v46
    v_mfma_f32_16x16x32_bf16 v[144:147], a[96:99], a[144:147], v[144:147]
    s_waitcnt lgkmcnt(8)
    v_perm_b32 v57, v74, v35, s36
    v_mfma_f32_16x16x32_bf16 v[144:147], a[100:103], a[148:151], v[144:147]
    buffer_load_dword v103, v19, s[4:7], s61 offen nt
    v_mfma_f32_16x16x32_bf16 v[148:151], a[100:103], a[156:159], v[148:151]
    s_add_u32 s61, s61, 14336
    ds_read_b32 a176, v57
    v_perm_b32 v58, v74, v35, s37
    v_mfma_f32_16x16x32_bf16 v[148:151], a[96:99], a[152:155], v[148:151]
    s_waitcnt lgkmcnt(7)
    v_cmp_lt_u32 vcc, 0xffff, v56
    v_perm_b32 v59, v74, v35, s38
    v_mfma_f32_16x16x32_bf16 v[152:155], a[96:99], a[160:163], v[152:155]
    s_waitcnt lgkmcnt(6)
    ds_read_b32 a177, v58
    ds_read_b32 a178, v59
    v_mfma_f32_16x16x32_bf16 v[152:155], a[100:103], a[164:167], v[152:155]
    s_waitcnt lgkmcnt(4)
    buffer_load_dwordx3 v[104:106], v18, s[4:7], s61 offen nt
    v_mfma_f32_16x16x32_bf16 v[156:159], a[100:103], a[172:175], v[156:159]
    v_perm_b32 v60, v74, v35, s39
    s_cbranch_vccnz L_slow1_0
L_back1_0:
    v_mfma_f32_16x16x32_bf16 v[156:159], a[96:99], a[168:171], v[156:159]
    s_waitcnt lgkmcnt(3)
    v_perm_b32 v61, v78, v35, s36
    v_perm_b32 v62, v78, v35, s37
    v_mfma_f32_16x16x32_bf16 v[160:163], a[120:123], a[104:107], v[160:163]
    s_mov_b32 s72, 114688
    ds_read_b32 a179, v60
    ds_read_b32 a180, v61
    v_mfma_f32_16x16x32_bf16 v[160:163], a[124:127], a[108:111], v[160:163]
    buffer_load_dword v107, v19, s[4:7], s61 offen nt
    v_mfma_f32_16x16x32_bf16 v[164:167], a[124:127], a[116:119], v[164:167]
    s_add_u32 s61, s61, 14336
    ds_read_b32 a181, v62
    v_perm_b32 v63, v78, v35, s38
    v_mfma_f32_16x16x32_bf16 v[164:167], a[120:123], a[112:115], v[164:167]
    v_perm_b32 v5, v78, v35, s39
    v_perm_b32 v6, v75, v35, s36
    v_mfma_f32_16x16x32_bf16 v[168:171], a[120:123], a[128:131], v[168:171]
    ds_read_b32 a182, v63
    ds_read_b32 a183, v5
    v_mfma_f32_16x16x32_bf16 v[168:171], a[124:127], a[132:135], v[168:171]
    buffer_load_dwordx3 v[108:110], v18, s[4:7], s61 offen nt
    v_mfma_f32_16x16x32_bf16 v[172:175], a[124:127], a[140:143], v[172:175]
    ds_read_b32 a92, v6
    v_perm_b32 v7, v75, v35, s37
    v_mfma_f32_16x16x32_bf16 v[172:175], a[120:123], a[136:139], v[172:175]
    v_perm_b32 v27, v79, v35, s36
    v_perm_b32 v29, v79, v35, s37
    v_mfma_f32_16x16x32_bf16 v[176:179], a[120:123], a[144:147], v[176:179]
    ds_read_b32 a93, v7
    ds_read_b32 a94, v27
    v_mfma_f32_16x16x32_bf16 v[176:179], a[124:127], a[148:151], v[176:179]
    buffer_load_dword v111, v19, s[4:7], s61 offen nt
    v_mfma_f32_16x16x32_bf16 v[180:183], a[124:127], a[156:159], v[180:183]
    s_add_u32 s61, s61, 14336
    ds_read_b32 a95, v29
    v_perm_b32 v31, v80, v35, s36
    v_mfma_f32_16x16x32_bf16 v[180:183], a[120:123], a[152:155], v[180:183]
    v_perm_b32 v46, v80, v35, s37
    v_perm_b32 v57, v80, v35, s38
    v_mfma_f32_16x16x32_bf16 v[184:187], a[120:123], a[160:163], v[184:187]
    ds_read_b32 a184, v31
    ds_read_b32 a185, v46
    v_mfma_f32_16x16x32_bf16 v[184:187], a[124:127], a[164:167], v[184:187]
    buffer_load_dwordx3 v[112:114], v18, s[4:7], s61 offen nt
    v_mfma_f32_16x16x32_bf16 v[188:191], a[124:127], a[172:175], v[188:191]
    s_add_u32 s61, s61, 14336
    ds_read_b32 a186, v57
    v_perm_b32 v56, v80, v35, s39
    v_mfma_f32_16x16x32_bf16 v[188:191], a[120:123], a[168:171], v[188:191]
    s_waitcnt vmcnt(15) lgkmcnt(6)
    v_perm_b32 v58, v84, v35, s36
    v_perm_b32 v59, v84, v35, s37
    v_mfma_f32_16x16x32_bf16 v[192:195], a[176:179], a[104:107], v[192:195]
    s_barrier
    v_mfma_f32_16x16x32_bf16 v[192:195], a[180:183], a[108:111], v[192:195]
    buffer_load_dwordx3 v[116:118], v18, s[4:7], s61 offen nt
    v_mfma_f32_16x16x32_bf16 v[196:199], a[180:183], a[116:119], v[196:199]
    s_add_u32 s61, s61, 14336
    ds_read_b32 a187, v56
    ds_read_b32 a188, v58
    v_mfma_f32_16x16x32_bf16 v[196:199], a[176:179], a[112:115], v[196:199]
    ds_read_b32 a189, v59
    ds_read_b128 a[192:195], v42 offset:0
    v_mfma_f32_16x16x32_bf16 v[200:203], a[176:179], a[128:131], v[200:203]
    ds_read_b128 a[196:199], v43 offset:0
    v_perm_b32 v60, v84, v35, s38
    v_mfma_f32_16x16x32_bf16 v[200:203], a[180:183], a[132:135], v[200:203]
    ds_read_b32 a190, v60
    ds_read_b128 a[204:207], v43 offset:2048
    v_mfma_f32_16x16x32_bf16 v[204:207], a[180:183], a[140:143], v[204:207]
    buffer_load_dwordx3 v[120:122], v18, s[4:7], s61 offen nt
    v_mfma_f32_16x16x32_bf16 v[204:207], a[176:179], a[136:139], v[204:207]
    s_add_u32 s61, s61, 14336
    ds_read_b128 a[200:203], v42 offset:2048
    v_perm_b32 v61, v84, v35, s39
    v_mfma_f32_16x16x32_bf16 v[208:211], a[176:179], a[144:147], v[208:211]
    ds_read_b32 a191, v61
    ds_read_b128 a[208:211], v42 offset:4096
    v_mfma_f32_16x16x32_bf16 v[208:211], a[180:183], a[148:151], v[208:211]
    ds_read_b128 a[212:215], v43 offset:4096
    v_perm_b32 v62, v81, v35, s36
    v_mfma_f32_16x16x32_bf16 v[212:215], a[180:183], a[156:159], v[212:215]
    ds_read_b128 a[220:223], v43 offset:6144
    ds_read_b32 a224, v62
    v_mfma_f32_16x16x32_bf16 v[212:215], a[176:179], a[152:155], v[212:215]
    buffer_load_dwordx3 v[124:126], v18, s[4:7], s61 offen nt
    v_mfma_f32_16x16x32_bf16 v[216:219], a[176:179], a[160:163], v[216:219]
    ds_read_b128 a[216:219], v42 offset:6144
    v_perm_b32 v63, v81, v35, s37
    v_mfma_f32_16x16x32_bf16 v[216:219], a[180:183], a[164:167], v[216:219]
    ds_read_b128 a[232:235], v42 offset:8192
    v_perm_b32 v5, v81, v35, s38
    v_mfma_f32_16x16x32_bf16 v[220:223], a[180:183], a[172:175], v[220:223]
    ds_read_b128 a[236:239], v43 offset:8192
    ds_read_b32 a225, v63
    v_mfma_f32_16x16x32_bf16 v[220:223], a[176:179], a[168:171], v[220:223]
    s_waitcnt lgkmcnt(10)
    ds_read_b128 a[244:247], v43 offset:10240
    ds_read_b32 a226, v5
    v_mfma_f32_16x16x32_bf16 v[224:227], a[92:95], a[106:109], v[224:227]
    buffer_load_dwordx4 v[48:51], v32, s[12:15], s41 offen sc1
    v_mfma_f32_16x16x32_bf16 v[228:231], a[92:95], a[114:117], v[228:231]
    ds_read_b128 a[240:243], v42 offset:10240
    v_perm_b32 v6, v81, v35, s39
    v_mfma_f32_16x16x32_bf16 v[232:235], a[92:95], a[130:133], v[232:235]
    ds_read_b128 a[248:251], v42 offset:12288
    v_perm_b32 v7, v85, v35, s36
    v_mfma_f32_16x16x32_bf16 v[236:239], a[92:95], a[138:141], v[236:239]
    ds_read_b32 a227, v6
    ds_read_b32 a228, v7
    v_mfma_f32_16x16x32_bf16 v[240:243], a[92:95], a[146:149], v[240:243]
    ds_read_b128 a[252:255], v43 offset:12288
    v_mfma_f32_16x16x32_bf16 v[244:247], a[92:95], a[154:157], v[244:247]
    buffer_load_dwordx4 v[52:55], v33, s[12:15], s41 offen sc1
    v_mfma_f32_16x16x32_bf16 v[248:251], a[92:95], a[162:165], v[248:251]
    v_perm_b32 v27, v85, v35, s37
    v_perm_b32 v29, v85, v35, s38
    v_mfma_f32_16x16x32_bf16 v[252:255], a[92:95], a[170:173], v[252:255]
    ds_read_b32 a229, v27
    v_perm_b32 v31, v85, v35, s39
    v_mfma_f32_16x16x32_bf16 v[128:131], a[184:187], a[192:195], v[128:131]
    s_waitcnt vmcnt(18) lgkmcnt(6)
    ds_read_b128 a[32:35], v42 offset:14336
    v_perm_b32 v46, v82, v35, s36
    v_mfma_f32_16x16x32_bf16 v[128:131], a[188:191], a[196:199], v[128:131]
    ds_read_b32 a230, v29
    v_perm_b32 v56, v82, v35, s37
    v_bitop3_b32 v57, v91, v95, s76 bitop3:0x7e
    v_mfma_f32_16x16x32_bf16 v[132:135], a[188:191], a[204:207], v[132:135]
    ds_read_b128 a[36:39], v43 offset:14336
    ds_read_b32 a231, v31
    v_cmp_lt_u32 vcc, 0xffff, v57
    v_mfma_f32_16x16x32_bf16 v[132:135], a[184:187], a[200:203], v[132:135]
    s_mul_i32 s66, s63, 96
    s_lshl_b32 s67, s65, 5
    s_lshl_b32 s70, s64, 2
    s_add_u32 s67, s67, s70
    s_add_u32 s67, s67, 384
    s_mul_i32 s71, s59, 448
    s_add_u32 s70, s66, s71
    v_mad_u32_u24 v22, v3, 24, s70
    s_add_u32 s70, s67, s71
    v_lshl_add_u32 v23, v3, 3, s70
    s_mov_b32 s34, 7168
    s_mov_b32 s35, 0x20000
    s_mov_b32 s26, 256
    s_mov_b32 s27, 0x20000
    s_lshl_b32 s77, s59, 4
    s_mov_b32 s18, 14680064
    s_mov_b32 s19, 0x20000
    s_sub_u32 s70, 1024, s71
    v_mul_u32_u24 v16, 464, v4
    v_add3_u32 v26, v22, v16, s70
    v_add3_u32 v28, v23, v16, s70
    s_lshl_b32 s70, s63, 9
    s_add_u32 s60, s70, 52992
    s_xor_b32 s70, s70, 512
    s_add_u32 s70, s70, 52992
    v_lshl_add_u32 v30, v2, 2, s70
    v_mul_u32_u24 v16, 2341, v2
    v_lshrrev_b32 v16, 16, v16
    s_mul_i32 s73, s63, 1856
    s_add_u32 s73, s73, 1024
    v_add_lshl_u32 v24, v2, v16, 4
    v_add_u32 v24, s73, v24
    s_lshl_b32 s74, s58, 7
    s_lshl_b32 s75, s63, 2
    s_add_u32 s74, s74, s75
    s_mul_i32 s74, s74, 7168
    s_add_u32 s74, s74, s71
    v_mul_u32_u24 v17, 6720, v16
    v_lshl_add_u32 v25, v2, 4, v17
    v_lshrrev_b32 v16, 1, v16
    v_lshlrev_b32 v16, 30, v16
    v_add3_u32 v25, v25, v16, s74
    v_mov_b32 v45, 1
    v_lshlrev_b32 v1, 22, v0
    v_mov_b32 v47, s76
    v_mfma_f32_16x16x32_bf16 v[136:139], a[184:187], a[208:211], v[136:139]
    buffer_load_dwordx4 v36, s[8:11], s56 offen offset:0  lds
    v_mfma_f32_16x16x32_bf16 v[136:139], a[188:191], a[212:215], v[136:139]
    ds_read_b32 a64, v46
    ds_read_b32 a65, v56
    v_mfma_f32_16x16x32_bf16 v[140:143], a[188:191], a[220:223], v[140:143]
    v_perm_b32 v58, v82, v35, s38
    v_perm_b32 v59, v82, v35, s39
    v_mfma_f32_16x16x32_bf16 v[140:143], a[184:187], a[216:219], v[140:143]
    ds_read_b32 a66, v58
    v_perm_b32 v60, v86, v35, s36
    v_mfma_f32_16x16x32_bf16 v[144:147], a[184:187], a[232:235], v[144:147]
    ds_read_b32 a67, v59
    ds_read_b32 a68, v60
    v_mfma_f32_16x16x32_bf16 v[144:147], a[188:191], a[236:239], v[144:147]
    buffer_load_dwordx4 v37, s[8:11], s56 offen offset:1024  lds
    v_mfma_f32_16x16x32_bf16 v[148:151], a[188:191], a[244:247], v[148:151]
    s_waitcnt lgkmcnt(7)
    v_perm_b32 v61, v86, v35, s37
    v_perm_b32 v62, v86, v35, s38
    v_mfma_f32_16x16x32_bf16 v[148:151], a[184:187], a[240:243], v[148:151]
    ds_read_b32 a69, v61
    v_perm_b32 v63, v86, v35, s39
    v_mfma_f32_16x16x32_bf16 v[152:155], a[184:187], a[248:251], v[152:155]
    s_waitcnt lgkmcnt(6)
    ds_read_b32 a70, v62
    ds_read_b32 a71, v63
    v_mfma_f32_16x16x32_bf16 v[152:155], a[188:191], a[252:255], v[152:155]
    buffer_load_dwordx4 v38, s[8:11], s56 offen offset:2048  lds
    v_mfma_f32_16x16x32_bf16 v[156:159], a[188:191], a[36:39], v[156:159]
    v_perm_b32 v5, v83, v35, s36
    v_perm_b32 v6, v83, v35, s37
    v_mfma_f32_16x16x32_bf16 v[156:159], a[184:187], a[32:35], v[156:159]
    ds_read_b32 a80, v5
    v_perm_b32 v7, v87, v35, s36
    v_mfma_f32_16x16x32_bf16 v[160:163], a[224:227], a[192:195], v[160:163]
    ds_read_b32 a81, v6
    ds_read_b32 a82, v7
    v_mfma_f32_16x16x32_bf16 v[160:163], a[228:231], a[196:199], v[160:163]
    buffer_load_dwordx4 v39, s[8:11], s56 offen offset:3072  lds
    v_mfma_f32_16x16x32_bf16 v[164:167], a[228:231], a[204:207], v[164:167]
    v_perm_b32 v27, v87, v35, s37
    s_cbranch_vccnz L_slow1_1
L_back1_1:
    v_mfma_f32_16x16x32_bf16 v[164:167], a[224:227], a[200:203], v[164:167]
    s_add_u32 m0, s57, 16384
    v_perm_b32 v29, v88, v35, s36
    v_perm_b32 v31, v88, v35, s37
    v_mfma_f32_16x16x32_bf16 v[168:171], a[224:227], a[208:211], v[168:171]
    s_add_u32 s56, s55, 768
    ds_read_b32 a83, v27
    v_perm_b32 v57, v88, v35, s38
    v_mfma_f32_16x16x32_bf16 v[168:171], a[228:231], a[212:215], v[168:171]
    ds_read_b32 a0, v29
    v_perm_b32 v46, v88, v35, s39
    v_mfma_f32_16x16x32_bf16 v[172:175], a[228:231], a[220:223], v[172:175]
    ds_read_b32 a1, v31
    v_perm_b32 v56, v92, v35, s36
    v_mfma_f32_16x16x32_bf16 v[172:175], a[224:227], a[216:219], v[172:175]
    ds_read_b32 a2, v57
    v_perm_b32 v58, v92, v35, s37
    v_mfma_f32_16x16x32_bf16 v[176:179], a[224:227], a[232:235], v[176:179]
    ds_read_b32 a3, v46
    v_perm_b32 v59, v92, v35, s38
    v_mfma_f32_16x16x32_bf16 v[176:179], a[228:231], a[236:239], v[176:179]
    ds_read_b32 a4, v56
    v_perm_b32 v60, v92, v35, s39
    v_mfma_f32_16x16x32_bf16 v[180:183], a[228:231], a[244:247], v[180:183]
    ds_read_b32 a5, v58
    v_perm_b32 v61, v89, v35, s36
    v_mfma_f32_16x16x32_bf16 v[180:183], a[224:227], a[240:243], v[180:183]
    ds_read_b32 a6, v59
    ds_read_b32 a7, v60
    v_mfma_f32_16x16x32_bf16 v[184:187], a[224:227], a[248:251], v[184:187]
    buffer_load_dwordx4 v[64:67], v34, s[12:15], s41 offen sc1
    v_mfma_f32_16x16x32_bf16 v[184:187], a[228:231], a[252:255], v[184:187]
    ds_read_b32 a8, v61
    v_perm_b32 v62, v89, v35, s37
    v_mfma_f32_16x16x32_bf16 v[188:191], a[228:231], a[36:39], v[188:191]
    v_perm_b32 v63, v89, v35, s38
    v_perm_b32 v5, v89, v35, s39
    v_mfma_f32_16x16x32_bf16 v[188:191], a[224:227], a[32:35], v[188:191]
    s_waitcnt vmcnt(19) lgkmcnt(7)
    ds_read_b32 a9, v62
    ds_read_b32 a10, v63
    v_mfma_f32_16x16x32_bf16 v[192:195], a[64:67], a[192:195], v[192:195]
    buffer_load_dwordx4 v[68:71], v44, s[12:15], s41 offen sc1
    v_mfma_f32_16x16x32_bf16 v[192:195], a[68:71], a[196:199], v[192:195]
    s_barrier
    v_mfma_f32_16x16x32_bf16 v[196:199], a[68:71], a[204:207], v[196:199]
    ds_read_b32 a11, v5
    v_perm_b32 v6, v93, v35, s36
    v_mfma_f32_16x16x32_bf16 v[196:199], a[64:67], a[200:203], v[196:199]
    ds_read_b32 a12, v6
    ds_read_b128 a[16:19], v42 offset:16384
    v_mfma_f32_16x16x32_bf16 v[200:203], a[64:67], a[208:211], v[200:203]
    buffer_load_dwordx4 v[72:75], v32, s[12:15], s42 offen sc1
    v_mfma_f32_16x16x32_bf16 v[200:203], a[68:71], a[212:215], v[200:203]
    ds_read_b128 a[20:23], v43 offset:16384
    v_perm_b32 v7, v93, v35, s37
    v_mfma_f32_16x16x32_bf16 v[204:207], a[68:71], a[220:223], v[204:207]
    ds_read_b32 a13, v7
    v_perm_b32 v27, v93, v35, s38
    v_mfma_f32_16x16x32_bf16 v[204:207], a[64:67], a[216:219], v[204:207]
    ds_read_b32 a14, v27
    ds_read_b128 a[24:27], v42 offset:18432
    v_mfma_f32_16x16x32_bf16 v[208:211], a[64:67], a[232:235], v[208:211]
    buffer_load_dwordx4 v[76:79], v33, s[12:15], s42 offen sc1
    v_mfma_f32_16x16x32_bf16 v[208:211], a[68:71], a[236:239], v[208:211]
    ds_read_b128 a[28:31], v43 offset:18432
    v_perm_b32 v29, v93, v35, s39
    v_mfma_f32_16x16x32_bf16 v[212:215], a[68:71], a[244:247], v[212:215]
    ds_read_b32 a15, v29
    v_perm_b32 v31, v90, v35, s36
    v_mfma_f32_16x16x32_bf16 v[212:215], a[64:67], a[240:243], v[212:215]
    ds_read_b32 a48, v31
    ds_read_b128 a[40:43], v42 offset:20480
    v_mfma_f32_16x16x32_bf16 v[216:219], a[64:67], a[248:251], v[216:219]
    buffer_load_dwordx4 v36, s[8:11], s3 offen offset:0  lds
    v_mfma_f32_16x16x32_bf16 v[216:219], a[68:71], a[252:255], v[216:219]
    ds_read_b128 a[44:47], v43 offset:20480
    v_perm_b32 v57, v90, v35, s37
    v_mfma_f32_16x16x32_bf16 v[220:223], a[68:71], a[36:39], v[220:223]
    s_waitcnt vmcnt(19)
    ds_read_b32 a49, v57
    v_perm_b32 v46, v90, v35, s38
    v_mfma_f32_16x16x32_bf16 v[220:223], a[64:67], a[32:35], v[220:223]
    v_or_b32 v99, s47, v99
    v_lshl_or_b32 v96, v100, 4, v96
    v_lshl_or_b32 v97, v101, 4, v97
    v_lshl_or_b32 v98, v102, 4, v98
    v_lshl_or_b32 v99, v103, 4, v99
    s_waitcnt vmcnt(18)
    v_lshl_or_b32 v96, v104, 8, v96
    v_lshl_or_b32 v97, v105, 8, v97
    v_lshl_or_b32 v98, v106, 8, v98
    s_waitcnt vmcnt(17)
    v_lshl_or_b32 v99, v107, 8, v99
    s_waitcnt vmcnt(16)
    v_lshl_or_b32 v96, v108, 12, v96
    v_lshl_or_b32 v97, v109, 12, v97
    v_lshl_or_b32 v98, v110, 12, v98
    s_waitcnt vmcnt(15)
    v_lshl_or_b32 v99, v111, 12, v99
    s_waitcnt vmcnt(14)
    v_lshl_or_b32 v96, v112, 16, v96
    v_lshl_or_b32 v97, v113, 16, v97
    v_lshl_or_b32 v98, v114, 16, v98
    s_waitcnt vmcnt(13)
    v_lshl_or_b32 v96, v116, 20, v96
    v_lshl_or_b32 v97, v117, 20, v97
    v_lshl_or_b32 v98, v118, 20, v98
L_pad1:
    s_cbranch_execz L_pad2
    s_waitcnt vmcnt(12)
    v_lshl_or_b32 v96, v120, 24, v96
    v_lshl_or_b32 v97, v121, 24, v97
    v_lshl_or_b32 v98, v122, 24, v98
    s_waitcnt vmcnt(11)
    v_lshl_or_b32 v96, v124, 28, v96
    v_lshl_or_b32 v97, v125, 28, v97
    v_lshl_or_b32 v98, v126, 28, v98
    buffer_store_dwordx4 v[96:99], v20, s[12:15], s62 offen sc1
    v_mfma_f32_16x16x32_bf16 v[224:227], a[80:83], a[194:197], v[224:227]
    buffer_load_dwordx4 v37, s[8:11], s3 offen offset:1024  lds
    v_mfma_f32_16x16x32_bf16 v[228:231], a[80:83], a[202:205], v[228:231]
    ds_read_b32 a50, v46
    v_perm_b32 v56, v90, v35, s39
    v_mfma_f32_16x16x32_bf16 v[232:235], a[80:83], a[210:213], v[232:235]
    ds_read_b128 a[60:63], v43 offset:22528
    ds_read_b32 a51, v56
    v_mfma_f32_16x16x32_bf16 v[236:239], a[80:83], a[218:221], v[236:239]
    s_waitcnt vmcnt(11)
    ds_read_b128 a[56:59], v42 offset:22528
    v_perm_b32 v58, v94, v35, s36
    v_mfma_f32_16x16x32_bf16 v[240:243], a[80:83], a[234:237], v[240:243]
    ds_read_b128 a[72:75], v42 offset:24576
    ds_read_b32 a52, v58
    v_bitop3_b32 v59, v51, v55, s76 bitop3:0x7e
    v_mfma_f32_16x16x32_bf16 v[244:247], a[80:83], a[242:245], v[244:247]
    ds_read_b128 a[76:79], v43 offset:24576
    v_perm_b32 v60, v94, v35, s37
    v_cmp_lt_u32 vcc, 0xffff, v59
    v_mfma_f32_16x16x32_bf16 v[248:251], a[80:83], a[250:253], v[248:251]
    ds_read_b32 a53, v60
    v_perm_b32 v61, v94, v35, s38
    v_mfma_f32_16x16x32_bf16 v[252:255], a[80:83], a[34:37], v[252:255]
    s_waitcnt lgkmcnt(8)
    ds_read_b128 a[100:103], v43 offset:26624
    ds_read_b32 a54, v61
    v_mfma_f32_16x16x32_bf16 v[128:131], a[0:3], a[16:19], v[128:131]
    buffer_load_dwordx4 v38, s[8:11], s3 offen offset:2048  lds
    v_mfma_f32_16x16x32_bf16 v[128:131], a[4:7], a[20:23], v[128:131]
    ds_read_b128 a[96:99], v42 offset:26624
    s_cbranch_vccnz L_slow2_0
L_back2_0:
    v_mfma_f32_16x16x32_bf16 v[132:135], a[4:7], a[28:31], v[132:135]
    ds_read_b128 a[120:123], v42 offset:28672
    v_perm_b32 v62, v94, v35, s39
    v_mfma_f32_16x16x32_bf16 v[132:135], a[0:3], a[24:27], v[132:135]
    s_waitcnt lgkmcnt(8)
    ds_read_b128 a[124:127], v43 offset:28672
    ds_read_b32 a55, v62
    v_mfma_f32_16x16x32_bf16 v[136:139], a[0:3], a[40:43], v[136:139]
    buffer_load_dwordx4 v39, s[8:11], s3 offen offset:3072  lds
    v_mfma_f32_16x16x32_bf16 v[136:139], a[4:7], a[44:47], v[136:139]
    s_add_u32 m0, s57, 32768
    ds_read_b128 a[176:179], v42 offset:30720
    v_perm_b32 v63, v91, v35, s36
    v_mfma_f32_16x16x32_bf16 v[140:143], a[4:7], a[60:63], v[140:143]
    s_add_u32 s3, s69, 768
    v_perm_b32 v5, v91, v35, s37
    v_perm_b32 v6, v95, v35, s36
    v_mfma_f32_16x16x32_bf16 v[140:143], a[0:3], a[56:59], v[140:143]
    s_waitcnt lgkmcnt(7)
    ds_read_b128 a[180:183], v43 offset:30720
    ds_read_b32 a84, v63
    v_mfma_f32_16x16x32_bf16 v[144:147], a[0:3], a[72:75], v[144:147]
    buffer_load_dwordx4 v36, s[8:11], s56 offen offset:0  lds
    v_mfma_f32_16x16x32_bf16 v[144:147], a[4:7], a[76:79], v[144:147]
    s_waitcnt lgkmcnt(7)
    ds_read_b32 a85, v5
    v_perm_b32 v7, v95, v35, s37
    v_mfma_f32_16x16x32_bf16 v[148:151], a[4:7], a[100:103], v[148:151]
    s_waitcnt lgkmcnt(7)
    ds_read_b32 a86, v6
    v_perm_b32 v27, v48, v35, s36
    v_mfma_f32_16x16x32_bf16 v[148:151], a[0:3], a[96:99], v[148:151]
    s_waitcnt lgkmcnt(6)
    ds_read_b32 a87, v7
    ds_read_b32 a104, v27
    v_mfma_f32_16x16x32_bf16 v[152:155], a[0:3], a[120:123], v[152:155]
    buffer_load_dwordx4 v37, s[8:11], s56 offen offset:1024  lds
    v_mfma_f32_16x16x32_bf16 v[152:155], a[4:7], a[124:127], v[152:155]
    s_waitcnt lgkmcnt(5)
    v_perm_b32 v29, v48, v35, s37
    v_perm_b32 v31, v48, v35, s38
    v_mfma_f32_16x16x32_bf16 v[156:159], a[4:7], a[180:183], v[156:159]
    ds_read_b32 a105, v29
    v_perm_b32 v57, v48, v35, s39
    v_mfma_f32_16x16x32_bf16 v[156:159], a[0:3], a[176:179], v[156:159]
    ds_read_b32 a106, v31
    v_perm_b32 v46, v52, v35, s36
    v_mfma_f32_16x16x32_bf16 v[160:163], a[8:11], a[16:19], v[160:163]
    ds_read_b32 a107, v57
    ds_read_b32 a108, v46
    v_mfma_f32_16x16x32_bf16 v[160:163], a[12:15], a[20:23], v[160:163]
    buffer_load_dwordx4 v38, s[8:11], s56 offen offset:2048  lds
    v_mfma_f32_16x16x32_bf16 v[164:167], a[12:15], a[28:31], v[164:167]
    v_perm_b32 v56, v52, v35, s37
    v_perm_b32 v58, v52, v35, s38
    v_mfma_f32_16x16x32_bf16 v[164:167], a[8:11], a[24:27], v[164:167]
    ds_read_b32 a109, v56
    v_perm_b32 v59, v52, v35, s39
    v_mfma_f32_16x16x32_bf16 v[168:171], a[8:11], a[40:43], v[168:171]
    ds_read_b32 a110, v58
    v_perm_b32 v60, v49, v35, s36
    v_mfma_f32_16x16x32_bf16 v[168:171], a[12:15], a[44:47], v[168:171]
    ds_read_b32 a111, v59
    v_perm_b32 v61, v49, v35, s37
    v_mfma_f32_16x16x32_bf16 v[172:175], a[12:15], a[60:63], v[172:175]
    ds_read_b32 a112, v60
    v_perm_b32 v62, v49, v35, s38
    v_mfma_f32_16x16x32_bf16 v[172:175], a[8:11], a[56:59], v[172:175]
    ds_read_b32 a113, v61
    v_perm_b32 v63, v49, v35, s39
    v_mfma_f32_16x16x32_bf16 v[176:179], a[8:11], a[72:75], v[176:179]
    s_waitcnt vmcnt(12)
    ds_read_b32 a114, v62
    ds_read_b32 a115, v63
    v_mfma_f32_16x16x32_bf16 v[176:179], a[12:15], a[76:79], v[176:179]
    buffer_load_dwordx4 v39, s[8:11], s56 offen offset:3072  lds
    v_mfma_f32_16x16x32_bf16 v[180:183], a[12:15], a[100:103], v[180:183]
    s_barrier
    v_mfma_f32_16x16x32_bf16 v[180:183], a[8:11], a[96:99], v[180:183]
    s_add_u32 m0, s57, 49152
    ds_read_b128 a[128:131], v40 offset:0
    v_perm_b32 v5, v53, v35, s36
    v_mfma_f32_16x16x32_bf16 v[184:187], a[8:11], a[120:123], v[184:187]
    s_add_u32 s56, s55, 1024
    ds_read_b128 a[132:135], v41 offset:0
    v_perm_b32 v6, v53, v35, s37
    v_mfma_f32_16x16x32_bf16 v[184:187], a[12:15], a[124:127], v[184:187]
    ds_read_b128 a[140:143], v41 offset:2048
    v_perm_b32 v7, v53, v35, s38
    v_mfma_f32_16x16x32_bf16 v[188:191], a[12:15], a[180:183], v[188:191]
    ds_read_b128 a[136:139], v40 offset:2048
    v_perm_b32 v27, v53, v35, s39
    v_mfma_f32_16x16x32_bf16 v[188:191], a[8:11], a[176:179], v[188:191]
    ds_read_b128 a[144:147], v40 offset:4096
    ds_read_b32 a116, v5
    v_mfma_f32_16x16x32_bf16 v[192:195], a[48:51], a[16:19], v[192:195]
    buffer_load_dwordx4 v36, s[8:11], s3 offen offset:0  lds
    v_mfma_f32_16x16x32_bf16 v[192:195], a[52:55], a[20:23], v[192:195]
    ds_read_b128 a[148:151], v41 offset:4096
    ds_read_b32 a117, v6
    v_mfma_f32_16x16x32_bf16 v[196:199], a[52:55], a[28:31], v[196:199]
    s_waitcnt vmcnt(12)
    ds_read_b128 a[152:155], v40 offset:6144
    v_perm_b32 v29, v50, v35, s36
    v_mfma_f32_16x16x32_bf16 v[196:199], a[48:51], a[24:27], v[196:199]
    ds_read_b128 a[156:159], v41 offset:6144
    ds_read_b32 a118, v7
    v_bitop3_b32 v31, v67, v71, s76 bitop3:0x7e
    v_mfma_f32_16x16x32_bf16 v[200:203], a[48:51], a[40:43], v[200:203]
    ds_read_b32 a119, v27
    v_cmp_lt_u32 vcc, 0xffff, v31
    v_mfma_f32_16x16x32_bf16 v[200:203], a[52:55], a[44:47], v[200:203]
    v_perm_b32 v57, v50, v35, s37
    v_perm_b32 v46, v50, v35, s38
    v_mfma_f32_16x16x32_bf16 v[204:207], a[52:55], a[60:63], v[204:207]
    ds_read_b128 a[160:163], v40 offset:8192
    s_cbranch_vccnz L_slow2_1
L_back2_1:
    v_mfma_f32_16x16x32_bf16 v[204:207], a[48:51], a[56:59], v[204:207]
    buffer_load_dwordx4 v37, s[8:11], s3 offen offset:1024  lds
    v_mfma_f32_16x16x32_bf16 v[208:211], a[48:51], a[72:75], v[208:211]
    ds_read_b32 a88, v29
    v_perm_b32 v56, v50, v35, s39
    v_mfma_f32_16x16x32_bf16 v[208:211], a[52:55], a[76:79], v[208:211]
    ds_read_b128 a[164:167], v41 offset:8192
    v_perm_b32 v58, v54, v35, s36
    v_mfma_f32_16x16x32_bf16 v[212:215], a[52:55], a[100:103], v[212:215]
    ds_read_b32 a89, v57
    v_perm_b32 v59, v54, v35, s37
    v_mfma_f32_16x16x32_bf16 v[212:215], a[48:51], a[96:99], v[212:215]
    ds_read_b32 a90, v46
    v_perm_b32 v60, v54, v35, s38
    v_mfma_f32_16x16x32_bf16 v[216:219], a[48:51], a[120:123], v[216:219]
    ds_read_b128 a[168:171], v40 offset:10240
    v_perm_b32 v61, v54, v35, s39
    v_mfma_f32_16x16x32_bf16 v[216:219], a[52:55], a[124:127], v[216:219]
    ds_read_b32 a91, v56
    v_perm_b32 v62, v51, v35, s36
    v_mfma_f32_16x16x32_bf16 v[220:223], a[52:55], a[180:183], v[220:223]
    s_waitcnt lgkmcnt(7)
    ds_read_b32 a92, v58
    ds_read_b32 a93, v59
    v_mfma_f32_16x16x32_bf16 v[220:223], a[48:51], a[176:179], v[220:223]
    buffer_load_dwordx4 v38, s[8:11], s3 offen offset:2048  lds
    v_mfma_f32_16x16x32_bf16 v[224:227], a[84:87], a[18:21], v[224:227]
    ds_read_b128 a[172:175], v41 offset:10240
    v_perm_b32 v63, v51, v35, s37
    v_mfma_f32_16x16x32_bf16 v[228:231], a[84:87], a[26:29], v[228:231]
    ds_read_b32 a94, v60
    v_perm_b32 v5, v55, v35, s36
    v_mfma_f32_16x16x32_bf16 v[232:235], a[84:87], a[42:45], v[232:235]
    ds_read_b128 a[184:187], v40 offset:12288
    ds_read_b32 a95, v61
    v_mfma_f32_16x16x32_bf16 v[236:239], a[84:87], a[58:61], v[236:239]
    ds_read_b32 a224, v62
    v_perm_b32 v6, v55, v35, s37
    v_mfma_f32_16x16x32_bf16 v[240:243], a[84:87], a[74:77], v[240:243]
    ds_read_b32 a225, v63
    v_perm_b32 v7, v64, v35, s36
    v_mfma_f32_16x16x32_bf16 v[244:247], a[84:87], a[98:101], v[244:247]
    ds_read_b128 a[188:191], v41 offset:12288
    ds_read_b32 a226, v5
    v_mfma_f32_16x16x32_bf16 v[248:251], a[84:87], a[122:125], v[248:251]
    buffer_load_dwordx4 v39, s[8:11], s3 offen offset:3072  lds
    v_mfma_f32_16x16x32_bf16 v[252:255], a[84:87], a[178:181], v[252:255]
    s_add_u32 m0, s57, 65536
    v_perm_b32 v27, v64, v35, s37
    v_perm_b32 v31, v64, v35, s38
    v_mfma_f32_16x16x32_bf16 v[128:131], a[104:107], a[128:131], v[128:131]
    s_add_u32 s3, s69, 1024
    ds_read_b128 a[64:67], v40 offset:14336
    ds_read_b32 a227, v6
    v_mfma_f32_16x16x32_bf16 v[128:131], a[108:111], a[132:135], v[128:131]
    ds_read_b32 a192, v7
    v_perm_b32 v29, v64, v35, s39
    v_mfma_f32_16x16x32_bf16 v[132:135], a[108:111], a[140:143], v[132:135]
    ds_read_b128 a[68:71], v41 offset:14336
    ds_read_b32 a193, v27
    v_mfma_f32_16x16x32_bf16 v[132:135], a[104:107], a[136:139], v[132:135]
    buffer_load_dwordx4 v[80:83], v34, s[12:15], s42 offen sc1
    v_mfma_f32_16x16x32_bf16 v[136:139], a[104:107], a[144:147], v[136:139]
    v_perm_b32 v57, v68, v35, s36
    v_perm_b32 v46, v68, v35, s37
    v_mfma_f32_16x16x32_bf16 v[136:139], a[108:111], a[148:151], v[136:139]
    ds_read_b32 a194, v31
    v_perm_b32 v56, v68, v35, s38
    v_mfma_f32_16x16x32_bf16 v[140:143], a[108:111], a[156:159], v[140:143]
    ds_read_b32 a195, v29
    v_perm_b32 v58, v68, v35, s39
    v_mfma_f32_16x16x32_bf16 v[140:143], a[104:107], a[152:155], v[140:143]
    s_waitcnt lgkmcnt(7)
    ds_read_b32 a196, v57
    ds_read_b32 a197, v46
    v_mfma_f32_16x16x32_bf16 v[144:147], a[104:107], a[160:163], v[144:147]
    buffer_load_dwordx4 v[84:87], v44, s[12:15], s42 offen sc1
    v_mfma_f32_16x16x32_bf16 v[144:147], a[108:111], a[164:167], v[144:147]
    v_perm_b32 v59, v65, v35, s36
    v_perm_b32 v60, v65, v35, s37
    v_mfma_f32_16x16x32_bf16 v[148:151], a[108:111], a[172:175], v[148:151]
    s_waitcnt vmcnt(15)
    ds_read_b32 a198, v56
    v_bitop3_b32 v61, v75, v79, s76 bitop3:0x7e
    v_mfma_f32_16x16x32_bf16 v[148:151], a[104:107], a[168:171], v[148:151]
    ds_read_b32 a199, v58
    v_cmp_lt_u32 vcc, 0xffff, v61
    v_mfma_f32_16x16x32_bf16 v[152:155], a[104:107], a[184:187], v[152:155]
    v_perm_b32 v62, v65, v35, s38
    v_perm_b32 v63, v65, v35, s39
    v_mfma_f32_16x16x32_bf16 v[152:155], a[108:111], a[188:191], v[152:155]
    s_waitcnt lgkmcnt(6)
    ds_read_b32 a200, v59
    s_cbranch_vccnz L_slow3_0
L_back3_0:
    v_mfma_f32_16x16x32_bf16 v[156:159], a[108:111], a[68:71], v[156:159]
    ds_read_b32 a201, v60
    ds_read_b32 a202, v62
    v_mfma_f32_16x16x32_bf16 v[156:159], a[104:107], a[64:67], v[156:159]
    buffer_load_dwordx4 v36, s[8:11], s56 offen offset:0  lds
    v_mfma_f32_16x16x32_bf16 v[160:163], a[112:115], a[128:131], v[160:163]
    v_perm_b32 v5, v69, v35, s36
    v_perm_b32 v6, v69, v35, s37
    v_mfma_f32_16x16x32_bf16 v[160:163], a[116:119], a[132:135], v[160:163]
    ds_read_b32 a203, v63
    v_perm_b32 v7, v69, v35, s38
    v_mfma_f32_16x16x32_bf16 v[164:167], a[116:119], a[140:143], v[164:167]
    v_perm_b32 v27, v69, v35, s39
    v_perm_b32 v31, v66, v35, s36
    v_mfma_f32_16x16x32_bf16 v[164:167], a[112:115], a[136:139], v[164:167]
    ds_read_b32 a204, v5
    ds_read_b32 a205, v6
    v_mfma_f32_16x16x32_bf16 v[168:171], a[112:115], a[144:147], v[168:171]
    buffer_load_dwordx4 v[96:99], v32, s[12:15], s43 offen sc1
    v_mfma_f32_16x16x32_bf16 v[168:171], a[116:119], a[148:151], v[168:171]
    ds_read_b32 a206, v7
    v_perm_b32 v29, v66, v35, s37
    v_mfma_f32_16x16x32_bf16 v[172:175], a[116:119], a[156:159], v[172:175]
    ds_read_b32 a207, v27
    ds_read_b32 a208, v31
    v_mfma_f32_16x16x32_bf16 v[172:175], a[112:115], a[152:155], v[172:175]
    v_perm_b32 v57, v66, v35, s38
    v_perm_b32 v46, v66, v35, s39
    v_mfma_f32_16x16x32_bf16 v[176:179], a[112:115], a[160:163], v[176:179]
    ds_read_b32 a209, v29
    ds_read_b32 a210, v57
    v_mfma_f32_16x16x32_bf16 v[176:179], a[116:119], a[164:167], v[176:179]
    buffer_load_dwordx4 v[100:103], v33, s[12:15], s43 offen sc1
    v_mfma_f32_16x16x32_bf16 v[180:183], a[116:119], a[172:175], v[180:183]
    ds_read_b32 a211, v46
    v_perm_b32 v56, v70, v35, s36
    v_mfma_f32_16x16x32_bf16 v[180:183], a[112:115], a[168:171], v[180:183]
    ds_read_b32 a212, v56
    v_perm_b32 v58, v70, v35, s37
    v_mfma_f32_16x16x32_bf16 v[184:187], a[112:115], a[184:187], v[184:187]
    ds_read_b32 a213, v58
    v_perm_b32 v61, v70, v35, s38
    v_mfma_f32_16x16x32_bf16 v[184:187], a[116:119], a[188:191], v[184:187]
    ds_read_b32 a214, v61
    v_perm_b32 v59, v70, v35, s39
    v_mfma_f32_16x16x32_bf16 v[188:191], a[116:119], a[68:71], v[188:191]
    v_perm_b32 v60, v67, v35, s36
    v_perm_b32 v62, v67, v35, s37
    v_mfma_f32_16x16x32_bf16 v[188:191], a[112:115], a[64:67], v[188:191]
    s_waitcnt vmcnt(13)
    ds_read_b32 a215, v59
    ds_read_b32 a228, v60
    v_mfma_f32_16x16x32_bf16 v[192:195], a[88:91], a[128:131], v[192:195]
    buffer_load_dwordx4 v37, s[8:11], s56 offen offset:1024  lds
    v_mfma_f32_16x16x32_bf16 v[192:195], a[92:95], a[132:135], v[192:195]
    s_barrier
    v_mfma_f32_16x16x32_bf16 v[196:199], a[92:95], a[140:143], v[196:199]
    ds_read_b32 a229, v62
    v_perm_b32 v63, v71, v35, s36
    v_mfma_f32_16x16x32_bf16 v[196:199], a[88:91], a[136:139], v[196:199]
    ds_read_b32 a230, v63
    v_perm_b32 v5, v71, v35, s37
    v_mfma_f32_16x16x32_bf16 v[200:203], a[88:91], a[144:147], v[200:203]
    ds_read_b32 a231, v5
    v_perm_b32 v6, v72, v35, s36
    v_mfma_f32_16x16x32_bf16 v[200:203], a[92:95], a[148:151], v[200:203]
    ds_read_b32 a216, v6
    v_perm_b32 v7, v72, v35, s37
    v_mfma_f32_16x16x32_bf16 v[204:207], a[92:95], a[156:159], v[204:207]
    ds_read_b128 a[232:235], v40 offset:16384
    ds_read_b32 a217, v7
    v_mfma_f32_16x16x32_bf16 v[204:207], a[88:91], a[152:155], v[204:207]
    buffer_load_dwordx4 v38, s[8:11], s56 offen offset:2048  lds
    v_mfma_f32_16x16x32_bf16 v[208:211], a[88:91], a[160:163], v[208:211]
    ds_read_b128 a[236:239], v41 offset:16384
    v_perm_b32 v27, v72, v35, s38
    v_mfma_f32_16x16x32_bf16 v[208:211], a[92:95], a[164:167], v[208:211]
    ds_read_b32 a218, v27
    v_perm_b32 v31, v72, v35, s39
    v_mfma_f32_16x16x32_bf16 v[212:215], a[92:95], a[172:175], v[212:215]
    ds_read_b128 a[240:243], v40 offset:18432
    v_perm_b32 v29, v76, v35, s36
    v_mfma_f32_16x16x32_bf16 v[212:215], a[88:91], a[168:171], v[212:215]
    ds_read_b32 a219, v31
    v_perm_b32 v57, v76, v35, s37
    v_mfma_f32_16x16x32_bf16 v[216:219], a[88:91], a[184:187], v[216:219]
    ds_read_b128 a[244:247], v41 offset:18432
    v_perm_b32 v46, v76, v35, s38
    v_mfma_f32_16x16x32_bf16 v[216:219], a[92:95], a[188:191], v[216:219]
    ds_read_b32 a220, v29
    ds_read_b32 a221, v57
    v_mfma_f32_16x16x32_bf16 v[220:223], a[92:95], a[68:71], v[220:223]
    ds_read_b128 a[248:251], v40 offset:20480
    ds_read_b32 a222, v46
    v_mfma_f32_16x16x32_bf16 v[220:223], a[88:91], a[64:67], v[220:223]
    buffer_load_dwordx4 v39, s[8:11], s56 offen offset:3072  lds
    v_mfma_f32_16x16x32_bf16 v[224:227], a[224:227], a[130:133], v[224:227]
    s_add_u32 m0, s57, 81920
    ds_read_b128 a[252:255], v41 offset:20480
    v_perm_b32 v56, v76, v35, s39
    v_mfma_f32_16x16x32_bf16 v[228:231], a[224:227], a[138:141], v[228:231]
    ds_read_b32 a223, v56
    v_perm_b32 v58, v73, v35, s36
    v_mfma_f32_16x16x32_bf16 v[232:235], a[224:227], a[146:149], v[232:235]
    ds_read_b128 a[36:39], v41 offset:22528
    v_perm_b32 v61, v73, v35, s37
    v_mfma_f32_16x16x32_bf16 v[236:239], a[224:227], a[154:157], v[236:239]
    ds_read_b128 a[32:35], v40 offset:22528
    v_perm_b32 v59, v73, v35, s38
    v_mfma_f32_16x16x32_bf16 v[240:243], a[224:227], a[162:165], v[240:243]
    ds_read_b128 a[0:3], v40 offset:24576
    ds_read_b32 a8, v58
    v_mfma_f32_16x16x32_bf16 v[244:247], a[224:227], a[170:173], v[244:247]
    ds_read_b128 a[4:7], v41 offset:24576
    ds_read_b32 a9, v61
    v_mfma_f32_16x16x32_bf16 v[248:251], a[224:227], a[186:189], v[248:251]
    buffer_load_dwordx4 v36, s[8:11], s3 offen offset:0  lds
    v_mfma_f32_16x16x32_bf16 v[252:255], a[224:227], a[66:69], v[252:255]
    s_waitcnt lgkmcnt(8)
    ds_read_b128 a[52:55], v41 offset:26624
    v_perm_b32 v60, v73, v35, s39
    v_mfma_f32_16x16x32_bf16 v[128:131], a[192:195], a[232:235], v[128:131]
    ds_read_b128 a[48:51], v40 offset:26624
    ds_read_b32 a10, v59
    v_mfma_f32_16x16x32_bf16 v[128:131], a[196:199], a[236:239], v[128:131]
    ds_read_b128 a[16:19], v40 offset:28672
    v_perm_b32 v62, v77, v35, s36
    v_mfma_f32_16x16x32_bf16 v[132:135], a[196:199], a[244:247], v[132:135]
    s_add_u32 s56, s55, 1280
    ds_read_b32 a11, v60
    v_perm_b32 v63, v77, v35, s37
    v_mfma_f32_16x16x32_bf16 v[132:135], a[192:195], a[240:243], v[132:135]
    ds_read_b128 a[20:23], v41 offset:28672
    v_perm_b32 v5, v77, v35, s38
    v_mfma_f32_16x16x32_bf16 v[136:139], a[192:195], a[248:251], v[136:139]
    s_waitcnt lgkmcnt(10)
    ds_read_b32 a12, v62
    ds_read_b32 a13, v63
    v_mfma_f32_16x16x32_bf16 v[136:139], a[196:199], a[252:255], v[136:139]
    buffer_load_dwordx4 v37, s[8:11], s3 offen offset:1024  lds
    v_mfma_f32_16x16x32_bf16 v[140:143], a[196:199], a[36:39], v[140:143]
    ds_read_b128 a[24:27], v40 offset:30720
    v_perm_b32 v6, v77, v35, s39
    v_mfma_f32_16x16x32_bf16 v[140:143], a[192:195], a[32:35], v[140:143]
    s_waitcnt lgkmcnt(9)
    ds_read_b128 a[28:31], v41 offset:30720
    v_perm_b32 v7, v74, v35, s36
    v_mfma_f32_16x16x32_bf16 v[144:147], a[192:195], a[0:3], v[144:147]
    ds_read_b32 a14, v5
    v_perm_b32 v27, v74, v35, s37
    v_mfma_f32_16x16x32_bf16 v[144:147], a[196:199], a[4:7], v[144:147]
    s_waitcnt lgkmcnt(8)
    ds_read_b32 a15, v6
    v_perm_b32 v31, v74, v35, s38
    v_mfma_f32_16x16x32_bf16 v[148:151], a[196:199], a[52:55], v[148:151]
    ds_read_b32 a40, v7
    v_perm_b32 v29, v74, v35, s39
    v_mfma_f32_16x16x32_bf16 v[148:151], a[192:195], a[48:51], v[148:151]
    s_waitcnt lgkmcnt(8)
    ds_read_b32 a41, v27
    v_perm_b32 v57, v78, v35, s36
    v_mfma_f32_16x16x32_bf16 v[152:155], a[192:195], a[16:19], v[152:155]
    s_waitcnt lgkmcnt(8)
    ds_read_b32 a42, v31
    ds_read_b32 a43, v29
    v_mfma_f32_16x16x32_bf16 v[152:155], a[196:199], a[20:23], v[152:155]
    s_waitcnt lgkmcnt(6)
    buffer_load_dwordx4 v38, s[8:11], s3 offen offset:2048  lds
    v_mfma_f32_16x16x32_bf16 v[156:159], a[196:199], a[28:31], v[156:159]
    ds_read_b32 a44, v57
    v_perm_b32 v46, v78, v35, s37
    v_mfma_f32_16x16x32_bf16 v[156:159], a[192:195], a[24:27], v[156:159]
    ds_read_b32 a45, v46
    v_perm_b32 v56, v78, v35, s38
    v_mfma_f32_16x16x32_bf16 v[160:163], a[200:203], a[232:235], v[160:163]
    ds_read_b32 a46, v56
    v_perm_b32 v58, v78, v35, s39
    v_mfma_f32_16x16x32_bf16 v[160:163], a[204:207], a[236:239], v[160:163]
    v_perm_b32 v61, v75, v35, s36
    v_perm_b32 v59, v75, v35, s37
    v_mfma_f32_16x16x32_bf16 v[164:167], a[204:207], a[244:247], v[164:167]
    ds_read_b32 a47, v58
    ds_read_b32 a56, v61
    v_mfma_f32_16x16x32_bf16 v[164:167], a[200:203], a[240:243], v[164:167]
    buffer_load_dwordx4 v[104:107], v34, s[12:15], s43 offen sc1
    v_mfma_f32_16x16x32_bf16 v[168:171], a[200:203], a[248:251], v[168:171]
    s_waitcnt vmcnt(12)
    ds_read_b32 a57, v59
    v_perm_b32 v60, v79, v35, s36
    v_mfma_f32_16x16x32_bf16 v[168:171], a[204:207], a[252:255], v[168:171]
    s_barrier
    v_mfma_f32_16x16x32_bf16 v[172:175], a[204:207], a[36:39], v[172:175]
    ds_read_b128 a[72:75], v40 offset:32768
    v_perm_b32 v62, v79, v35, s37
    v_mfma_f32_16x16x32_bf16 v[172:175], a[200:203], a[32:35], v[172:175]
    ds_read_b128 a[76:79], v41 offset:32768
    ds_read_b32 a58, v60
    v_mfma_f32_16x16x32_bf16 v[176:179], a[200:203], a[0:3], v[176:179]
    buffer_load_dwordx4 v[108:111], v44, s[12:15], s43 offen sc1
    v_mfma_f32_16x16x32_bf16 v[176:179], a[204:207], a[4:7], v[176:179]
    ds_read_b128 a[100:103], v41 offset:34816
    ds_read_b32 a59, v62
    v_mfma_f32_16x16x32_bf16 v[180:183], a[204:207], a[52:55], v[180:183]
    ds_read_b128 a[96:99], v40 offset:34816
    v_mfma_f32_16x16x32_bf16 v[180:183], a[200:203], a[48:51], v[180:183]
    ds_read_b128 a[120:123], v40 offset:36864
    v_mfma_f32_16x16x32_bf16 v[184:187], a[200:203], a[16:19], v[184:187]
    ds_read_b128 a[124:127], v41 offset:36864
    v_mfma_f32_16x16x32_bf16 v[184:187], a[204:207], a[20:23], v[184:187]
    s_waitcnt vmcnt(11)
    ds_read_b128 a[80:83], v40 offset:38912
    v_mfma_f32_16x16x32_bf16 v[188:191], a[204:207], a[28:31], v[188:191]
    buffer_load_dwordx4 v39, s[8:11], s3 offen offset:3072  lds
    v_mfma_f32_16x16x32_bf16 v[188:191], a[200:203], a[24:27], v[188:191]
    s_add_u32 m0, s57, 0
    ds_read_b128 a[84:87], v41 offset:38912
    v_bitop3_b32 v63, v83, v87, s76 bitop3:0x7e
    v_mfma_f32_16x16x32_bf16 v[192:195], a[208:211], a[232:235], v[192:195]
    s_add_u32 s3, s69, 1280
    v_cmp_lt_u32 vcc, 0xffff, v63
    v_mfma_f32_16x16x32_bf16 v[192:195], a[212:215], a[236:239], v[192:195]
    ds_read_b128 a[176:179], v40 offset:40960
    v_mfma_f32_16x16x32_bf16 v[196:199], a[212:215], a[244:247], v[196:199]
    s_cbranch_vccnz L_slow3_1
L_back3_1:
    v_mfma_f32_16x16x32_bf16 v[196:199], a[208:211], a[240:243], v[196:199]
    buffer_load_dwordx4 v[112:115], v32, s[12:15], s44 offen sc1
    v_mfma_f32_16x16x32_bf16 v[200:203], a[208:211], a[248:251], v[200:203]
    v_perm_b32 v5, v83, v35, s36
    v_perm_b32 v6, v83, v35, s37
    v_mfma_f32_16x16x32_bf16 v[200:203], a[212:215], a[252:255], v[200:203]
    v_perm_b32 v7, v87, v35, s36
    v_perm_b32 v27, v87, v35, s37
    v_mfma_f32_16x16x32_bf16 v[204:207], a[212:215], a[36:39], v[204:207]
    ds_read_b32 a60, v5
    ds_read_b32 a61, v6
    v_mfma_f32_16x16x32_bf16 v[204:207], a[208:211], a[32:35], v[204:207]
    buffer_load_dwordx4 v[116:119], v33, s[12:15], s44 offen sc1
    v_mfma_f32_16x16x32_bf16 v[208:211], a[208:211], a[0:3], v[208:211]
    v_perm_b32 v31, v80, v35, s36
    v_perm_b32 v29, v80, v35, s37
    v_mfma_f32_16x16x32_bf16 v[208:211], a[212:215], a[4:7], v[208:211]
    ds_read_b128 a[180:183], v41 offset:40960
    v_perm_b32 v57, v80, v35, s38
    v_mfma_f32_16x16x32_bf16 v[212:215], a[212:215], a[52:55], v[212:215]
    v_perm_b32 v46, v80, v35, s39
    v_perm_b32 v56, v84, v35, s36
    v_mfma_f32_16x16x32_bf16 v[212:215], a[208:211], a[48:51], v[212:215]
    v_perm_b32 v58, v84, v35, s37
    v_perm_b32 v61, v84, v35, s38
    v_mfma_f32_16x16x32_bf16 v[216:219], a[208:211], a[16:19], v[216:219]
    ds_read_b128 a[104:107], v40 offset:43008
    ds_read_b32 a62, v7
    v_mfma_f32_16x16x32_bf16 v[216:219], a[212:215], a[20:23], v[216:219]
    ds_read_b32 a63, v27
    v_perm_b32 v59, v84, v35, s39
    v_mfma_f32_16x16x32_bf16 v[220:223], a[212:215], a[28:31], v[220:223]
    ds_read_b32 a112, v31
    ds_read_b32 a113, v29
    v_mfma_f32_16x16x32_bf16 v[220:223], a[208:211], a[24:27], v[220:223]
    buffer_load_dwordx4 v36, s[8:11], s56 offen offset:0  lds
    v_mfma_f32_16x16x32_bf16 v[224:227], a[228:231], a[234:237], v[224:227]
    s_waitcnt vmcnt(12)
    ds_read_b128 a[108:111], v41 offset:43008
    v_bitop3_b32 v60, v99, v103, s76 bitop3:0x7e
    v_mfma_f32_16x16x32_bf16 v[228:231], a[228:231], a[242:245], v[228:231]
    v_cmp_lt_u32 vcc, 0xffff, v60
    v_perm_b32 v62, v81, v35, s36
    v_mfma_f32_16x16x32_bf16 v[232:235], a[228:231], a[250:253], v[232:235]
    ds_read_b128 a[88:91], v40 offset:45056
    v_perm_b32 v63, v81, v35, s37
    v_mfma_f32_16x16x32_bf16 v[236:239], a[228:231], a[34:37], v[236:239]
    ds_read_b32 a114, v57
    s_cbranch_vccnz L_slow4_0
L_back4_0:
    v_mfma_f32_16x16x32_bf16 v[240:243], a[228:231], a[2:5], v[240:243]
    ds_read_b32 a115, v46
    ds_read_b32 a116, v56
    v_mfma_f32_16x16x32_bf16 v[244:247], a[228:231], a[50:53], v[244:247]
    ds_read_b128 a[92:95], v41 offset:45056
    ds_read_b32 a117, v58
    v_mfma_f32_16x16x32_bf16 v[248:251], a[228:231], a[18:21], v[248:251]
    buffer_load_dwordx4 v37, s[8:11], s56 offen offset:1024  lds
L_pad2:
    s_cbranch_execz L_pad3
    v_mfma_f32_16x16x32_bf16 v[252:255], a[228:231], a[26:29], v[252:255]
    s_waitcnt lgkmcnt(7)
    ds_read_b32 a118, v61
    v_perm_b32 v5, v81, v35, s38
    v_mfma_f32_16x16x32_bf16 v[128:131], a[216:219], a[72:75], v[128:131]
    ds_read_b128 a[128:131], v40 offset:47104
    v_perm_b32 v6, v81, v35, s39
    v_mfma_f32_16x16x32_bf16 v[128:131], a[220:223], a[76:79], v[128:131]
    ds_read_b32 a119, v59
    v_perm_b32 v7, v85, v35, s36
    v_mfma_f32_16x16x32_bf16 v[132:135], a[220:223], a[100:103], v[132:135]
    ds_read_b128 a[132:135], v41 offset:47104
    v_perm_b32 v27, v85, v35, s37
    v_mfma_f32_16x16x32_bf16 v[132:135], a[216:219], a[96:99], v[132:135]
    ds_read_b32 a136, v62
    v_perm_b32 v31, v85, v35, s38
    v_mfma_f32_16x16x32_bf16 v[136:139], a[216:219], a[120:123], v[136:139]
    ds_read_b32 a137, v63
    v_perm_b32 v29, v85, v35, s39
    v_mfma_f32_16x16x32_bf16 v[136:139], a[220:223], a[124:127], v[136:139]
    v_perm_b32 v60, v82, v35, s36
    v_perm_b32 v57, v82, v35, s37
    v_mfma_f32_16x16x32_bf16 v[140:143], a[220:223], a[84:87], v[140:143]
    ds_read_b32 a138, v5
    v_perm_b32 v46, v82, v35, s38
    v_mfma_f32_16x16x32_bf16 v[140:143], a[216:219], a[80:83], v[140:143]
    ds_read_b32 a139, v6
    v_perm_b32 v56, v82, v35, s39
    v_mfma_f32_16x16x32_bf16 v[144:147], a[216:219], a[176:179], v[144:147]
    s_waitcnt lgkmcnt(7)
    ds_read_b32 a140, v7
    ds_read_b32 a141, v27
    v_mfma_f32_16x16x32_bf16 v[144:147], a[220:223], a[180:183], v[144:147]
    buffer_load_dwordx4 v[120:123], v34, s[12:15], s44 offen sc1
    v_mfma_f32_16x16x32_bf16 v[148:151], a[220:223], a[108:111], v[148:151]
    ds_read_b32 a142, v31
    v_perm_b32 v58, v86, v35, s36
    v_mfma_f32_16x16x32_bf16 v[148:151], a[216:219], a[104:107], v[148:151]
    ds_read_b32 a143, v29
    v_perm_b32 v61, v86, v35, s37
    v_mfma_f32_16x16x32_bf16 v[152:155], a[216:219], a[88:91], v[152:155]
    s_waitcnt lgkmcnt(7)
    ds_read_b128 a[144:147], v40 offset:49152
    ds_read_b32 a152, v60
    v_mfma_f32_16x16x32_bf16 v[152:155], a[220:223], a[92:95], v[152:155]
    buffer_load_dwordx4 v[124:127], v44, s[12:15], s44 offen sc1
    v_mfma_f32_16x16x32_bf16 v[156:159], a[220:223], a[132:135], v[156:159]
    ds_read_b128 a[148:151], v41 offset:49152
    v_perm_b32 v59, v86, v35, s38
    v_mfma_f32_16x16x32_bf16 v[156:159], a[216:219], a[128:131], v[156:159]
    ds_read_b128 a[160:163], v40 offset:51200
    ds_read_b32 a153, v57
    v_mfma_f32_16x16x32_bf16 v[160:163], a[8:11], a[72:75], v[160:163]
    ds_read_b128 a[164:167], v41 offset:51200
    ds_read_b32 a154, v46
    v_mfma_f32_16x16x32_bf16 v[160:163], a[12:15], a[76:79], v[160:163]
    buffer_load_dwordx4 v38, s[8:11], s56 offen offset:2048  lds
    v_mfma_f32_16x16x32_bf16 v[164:167], a[12:15], a[100:103], v[164:167]
    ds_read_b128 a[168:171], v40 offset:53248
    v_perm_b32 v62, v86, v35, s39
    v_mfma_f32_16x16x32_bf16 v[164:167], a[8:11], a[96:99], v[164:167]
    ds_read_b32 a155, v56
    v_perm_b32 v63, v96, v35, s36
    v_mfma_f32_16x16x32_bf16 v[168:171], a[8:11], a[120:123], v[168:171]
    ds_read_b32 a156, v58
    v_perm_b32 v5, v96, v35, s37
    v_mfma_f32_16x16x32_bf16 v[168:171], a[12:15], a[124:127], v[168:171]
    ds_read_b128 a[172:175], v41 offset:53248
    ds_read_b32 a157, v61
    v_mfma_f32_16x16x32_bf16 v[172:175], a[12:15], a[84:87], v[172:175]
    buffer_load_dwordx4 v39, s[8:11], s56 offen offset:3072  lds
    v_mfma_f32_16x16x32_bf16 v[172:175], a[8:11], a[80:83], v[172:175]
    s_add_u32 m0, s57, 16384
    v_perm_b32 v6, v96, v35, s38
    v_perm_b32 v7, v96, v35, s39
    v_mfma_f32_16x16x32_bf16 v[176:179], a[8:11], a[176:179], v[176:179]
    ds_read_b128 a[184:187], v40 offset:55296
    ds_read_b32 a158, v59
    v_mfma_f32_16x16x32_bf16 v[176:179], a[12:15], a[180:183], v[176:179]
    v_perm_b32 v27, v100, v35, s36
    v_perm_b32 v31, v100, v35, s37
    v_mfma_f32_16x16x32_bf16 v[180:183], a[12:15], a[108:111], v[180:183]
    ds_read_b32 a159, v62
    v_perm_b32 v29, v100, v35, s38
    v_mfma_f32_16x16x32_bf16 v[180:183], a[8:11], a[104:107], v[180:183]
    ds_read_b128 a[188:191], v41 offset:55296
    v_perm_b32 v60, v100, v35, s39
    v_mfma_f32_16x16x32_bf16 v[184:187], a[8:11], a[88:91], v[184:187]
    ds_read_b32 a64, v63
    ds_read_b32 a65, v5
    v_mfma_f32_16x16x32_bf16 v[184:187], a[12:15], a[92:95], v[184:187]
    ds_read_b32 a66, v6
    ds_read_b32 a67, v7
    v_mfma_f32_16x16x32_bf16 v[188:191], a[12:15], a[132:135], v[188:191]
    buffer_load_dwordx4 v36, s[8:11], s3 offen offset:0  lds
    v_mfma_f32_16x16x32_bf16 v[188:191], a[8:11], a[128:131], v[188:191]
    ds_read_b128 a[192:195], v40 offset:57344
    v_perm_b32 v57, v97, v35, s36
    v_mfma_f32_16x16x32_bf16 v[192:195], a[40:43], a[72:75], v[192:195]
    v_perm_b32 v46, v97, v35, s37
    v_perm_b32 v56, v97, v35, s38
    v_mfma_f32_16x16x32_bf16 v[192:195], a[44:47], a[76:79], v[192:195]
    ds_read_b128 a[196:199], v41 offset:57344
    v_perm_b32 v58, v97, v35, s39
    v_mfma_f32_16x16x32_bf16 v[196:199], a[44:47], a[100:103], v[196:199]
    ds_read_b32 a68, v27
    ds_read_b32 a69, v31
    v_mfma_f32_16x16x32_bf16 v[196:199], a[40:43], a[96:99], v[196:199]
    ds_read_b32 a70, v29
    v_perm_b32 v61, v101, v35, s36
    v_mfma_f32_16x16x32_bf16 v[200:203], a[40:43], a[120:123], v[200:203]
    ds_read_b128 a[200:203], v40 offset:59392
    ds_read_b32 a71, v60
    v_mfma_f32_16x16x32_bf16 v[200:203], a[44:47], a[124:127], v[200:203]
    buffer_load_dwordx4 v37, s[8:11], s3 offen offset:1024  lds
    v_mfma_f32_16x16x32_bf16 v[204:207], a[44:47], a[84:87], v[204:207]
    v_perm_b32 v59, v101, v35, s37
    v_perm_b32 v62, v101, v35, s38
    v_mfma_f32_16x16x32_bf16 v[204:207], a[40:43], a[80:83], v[204:207]
    ds_read_b128 a[204:207], v41 offset:59392
    ds_read_b32 a208, v57
    v_mfma_f32_16x16x32_bf16 v[208:211], a[40:43], a[176:179], v[208:211]
    ds_read_b32 a209, v46
    v_perm_b32 v63, v101, v35, s39
    v_mfma_f32_16x16x32_bf16 v[208:211], a[44:47], a[180:183], v[208:211]
    ds_read_b32 a210, v56
    v_perm_b32 v5, v98, v35, s36
    v_mfma_f32_16x16x32_bf16 v[212:215], a[44:47], a[108:111], v[212:215]
    ds_read_b128 a[232:235], v40 offset:61440
    ds_read_b32 a211, v58
    v_mfma_f32_16x16x32_bf16 v[212:215], a[40:43], a[104:107], v[212:215]
    ds_read_b32 a212, v61
    ds_read_b32 a213, v59
    v_mfma_f32_16x16x32_bf16 v[216:219], a[40:43], a[88:91], v[216:219]
    buffer_load_dwordx4 v38, s[8:11], s3 offen offset:2048  lds
    v_mfma_f32_16x16x32_bf16 v[216:219], a[44:47], a[92:95], v[216:219]
    s_waitcnt vmcnt(12)
    ds_read_b128 a[236:239], v41 offset:61440
    v_bitop3_b32 v6, v107, v111, s76 bitop3:0x7e
    v_mfma_f32_16x16x32_bf16 v[220:223], a[44:47], a[132:135], v[220:223]
    v_cmp_lt_u32 vcc, 0xffff, v6
    v_perm_b32 v7, v98, v35, s37
    v_mfma_f32_16x16x32_bf16 v[220:223], a[40:43], a[128:131], v[220:223]
    v_perm_b32 v27, v98, v35, s38
    v_perm_b32 v31, v98, v35, s39
    v_mfma_f32_16x16x32_bf16 v[224:227], a[56:59], a[74:77], v[224:227]
    s_waitcnt lgkmcnt(7)
    ds_read_b128 a[240:243], v40 offset:63488
    s_cbranch_vccnz L_slow4_1
L_back4_1:
    v_mfma_f32_16x16x32_bf16 v[224:227], a[60:63], a[146:149], v[224:227]
    ds_read_b32 a214, v62
    v_perm_b32 v29, v102, v35, s36
    v_mfma_f32_16x16x32_bf16 v[228:231], a[60:63], a[162:165], v[228:231]
    ds_read_b128 a[244:247], v41 offset:63488
    ds_read_b32 a215, v63
    v_mfma_f32_16x16x32_bf16 v[228:231], a[56:59], a[98:101], v[228:231]
    ds_read_b32 a248, v5
    ds_read_b32 a249, v7
    v_mfma_f32_16x16x32_bf16 v[232:235], a[56:59], a[122:125], v[232:235]
    buffer_load_dwordx4 v[88:91], v32, s[12:15], s45 offen sc1
    v_mfma_f32_16x16x32_bf16 v[232:235], a[60:63], a[170:173], v[232:235]
    v_perm_b32 v60, v102, v35, s37
    v_perm_b32 v57, v102, v35, s38
    v_mfma_f32_16x16x32_bf16 v[236:239], a[60:63], a[186:189], v[236:239]
    v_perm_b32 v46, v102, v35, s39
    v_perm_b32 v56, v99, v35, s36
    v_mfma_f32_16x16x32_bf16 v[236:239], a[56:59], a[82:85], v[236:239]
    ds_read_b32 a250, v27
    ds_read_b32 a251, v31
    v_mfma_f32_16x16x32_bf16 v[240:243], a[56:59], a[178:181], v[240:243]
    buffer_load_dwordx4 v[92:95], v33, s[12:15], s45 offen sc1
    v_mfma_f32_16x16x32_bf16 v[240:243], a[60:63], a[194:197], v[240:243]
    v_perm_b32 v58, v99, v35, s37
    v_perm_b32 v61, v103, v35, s36
    v_mfma_f32_16x16x32_bf16 v[244:247], a[60:63], a[202:205], v[244:247]
    ds_read_b32 a252, v29
    v_perm_b32 v59, v103, v35, s37
    v_mfma_f32_16x16x32_bf16 v[244:247], a[56:59], a[106:109], v[244:247]
    s_waitcnt vmcnt(13) lgkmcnt(5)
    v_perm_b32 v6, v107, v35, s36
    v_perm_b32 v62, v107, v35, s37
    v_mfma_f32_16x16x32_bf16 v[248:251], a[56:59], a[90:93], v[248:251]
    s_barrier
    v_mfma_f32_16x16x32_bf16 v[248:251], a[60:63], a[234:237], v[248:251]
    buffer_load_dwordx4 v39, s[8:11], s3 offen offset:3072  lds
    v_mfma_f32_16x16x32_bf16 v[252:255], a[60:63], a[242:245], v[252:255]
    s_add_u32 s56, s55, 1536
    ds_read_b32 a253, v60
    ds_read_b32 a254, v57
    v_mfma_f32_16x16x32_bf16 v[252:255], a[56:59], a[130:133], v[252:255]
    ds_read_b32 a255, v46
    ds_read_b32 a32, v56
    v_mfma_f32_16x16x32_bf16 v[128:131], a[112:115], a[144:147], v[128:131]
    v_perm_b32 v63, v111, v35, s36
    v_perm_b32 v5, v111, v35, s37
    v_mfma_f32_16x16x32_bf16 v[128:131], a[116:119], a[148:151], v[128:131]
    s_add_u32 m0, s57, 32768
    ds_read_b32 a33, v58
    ds_read_b32 a34, v61
    v_mfma_f32_16x16x32_bf16 v[132:135], a[116:119], a[164:167], v[132:135]
    buffer_load_dwordx4 v[48:51], v34, s[12:15], s45 offen sc1
    v_mfma_f32_16x16x32_bf16 v[132:135], a[112:115], a[160:163], v[132:135]
    ds_read_b32 a35, v59
    v_perm_b32 v7, v104, v35, s36
    v_mfma_f32_16x16x32_bf16 v[136:139], a[112:115], a[168:171], v[136:139]
    ds_read_b32 a36, v6
    v_perm_b32 v27, v104, v35, s37
    v_mfma_f32_16x16x32_bf16 v[136:139], a[116:119], a[172:175], v[136:139]
    ds_read_b32 a37, v62
    v_perm_b32 v31, v104, v35, s38
    v_mfma_f32_16x16x32_bf16 v[140:143], a[116:119], a[188:191], v[140:143]
    ds_read_b32 a38, v63
    ds_read_b32 a39, v5
    v_mfma_f32_16x16x32_bf16 v[140:143], a[112:115], a[184:187], v[140:143]
    buffer_load_dwordx4 v[52:55], v44, s[12:15], s45 offen sc1
    v_mfma_f32_16x16x32_bf16 v[144:147], a[112:115], a[192:195], v[144:147]
    v_perm_b32 v29, v104, v35, s39
    v_perm_b32 v60, v108, v35, s36
    v_mfma_f32_16x16x32_bf16 v[144:147], a[116:119], a[196:199], v[144:147]
    v_perm_b32 v57, v108, v35, s37
    v_perm_b32 v46, v108, v35, s38
    v_mfma_f32_16x16x32_bf16 v[148:151], a[116:119], a[204:207], v[148:151]
    s_waitcnt vmcnt(14)
    ds_read_b32 a0, v7
    v_bitop3_b32 v56, v115, v119, s76 bitop3:0x7e
    v_mfma_f32_16x16x32_bf16 v[148:151], a[112:115], a[200:203], v[148:151]
    ds_read_b128 a[48:51], v42 offset:0
    v_cmp_lt_u32 vcc, 0xffff, v56
    v_mfma_f32_16x16x32_bf16 v[152:155], a[112:115], a[232:235], v[152:155]
    ds_read_b128 a[52:55], v43 offset:0
    ds_read_b32 a1, v27
    v_mfma_f32_16x16x32_bf16 v[152:155], a[116:119], a[236:239], v[152:155]
    ds_read_b32 a2, v31
    s_cbranch_vccnz L_slow5_0
L_back5_0:
    v_mfma_f32_16x16x32_bf16 v[156:159], a[116:119], a[244:247], v[156:159]
    buffer_load_dwordx4 v36, s[8:11], s56 offen offset:0  lds
    v_mfma_f32_16x16x32_bf16 v[156:159], a[112:115], a[240:243], v[156:159]
    s_add_u32 s3, s69, 1536
    ds_read_b128 a[20:23], v43 offset:2048
    v_perm_b32 v58, v108, v35, s39
    v_mfma_f32_16x16x32_bf16 v[160:163], a[136:139], a[144:147], v[160:163]
    ds_read_b128 a[16:19], v42 offset:2048
    v_perm_b32 v61, v105, v35, s36
    v_mfma_f32_16x16x32_bf16 v[160:163], a[140:143], a[148:151], v[160:163]
    ds_read_b32 a3, v29
    v_perm_b32 v59, v105, v35, s37
    v_mfma_f32_16x16x32_bf16 v[164:167], a[140:143], a[164:167], v[164:167]
    ds_read_b128 a[224:227], v42 offset:4096
    ds_read_b32 a4, v60
    v_mfma_f32_16x16x32_bf16 v[164:167], a[136:139], a[160:163], v[164:167]
    ds_read_b32 a5, v57
    v_perm_b32 v6, v105, v35, s38
    v_mfma_f32_16x16x32_bf16 v[168:171], a[136:139], a[168:171], v[168:171]
    ds_read_b32 a6, v46
    v_perm_b32 v62, v105, v35, s39
    v_mfma_f32_16x16x32_bf16 v[168:171], a[140:143], a[172:175], v[168:171]
    ds_read_b128 a[228:231], v43 offset:4096
    ds_read_b32 a7, v58
    v_mfma_f32_16x16x32_bf16 v[172:175], a[140:143], a[188:191], v[172:175]
    buffer_load_dwordx4 v37, s[8:11], s56 offen offset:1024  lds
    v_mfma_f32_16x16x32_bf16 v[172:175], a[136:139], a[184:187], v[172:175]
    v_perm_b32 v63, v109, v35, s36
    v_perm_b32 v5, v109, v35, s37
    v_mfma_f32_16x16x32_bf16 v[176:179], a[136:139], a[192:195], v[176:179]
    ds_read_b128 a[24:27], v42 offset:6144
    v_perm_b32 v7, v109, v35, s38
    v_mfma_f32_16x16x32_bf16 v[176:179], a[140:143], a[196:199], v[176:179]
    ds_read_b32 a216, v61
    v_perm_b32 v56, v109, v35, s39
    v_mfma_f32_16x16x32_bf16 v[180:183], a[140:143], a[204:207], v[180:183]
    ds_read_b32 a217, v59
    v_perm_b32 v27, v106, v35, s36
    v_mfma_f32_16x16x32_bf16 v[180:183], a[136:139], a[200:203], v[180:183]
    ds_read_b128 a[28:31], v43 offset:6144
    ds_read_b32 a218, v6
    v_mfma_f32_16x16x32_bf16 v[184:187], a[136:139], a[232:235], v[184:187]
    ds_read_b32 a219, v62
    ds_read_b32 a220, v63
    v_mfma_f32_16x16x32_bf16 v[184:187], a[140:143], a[236:239], v[184:187]
    buffer_load_dwordx4 v38, s[8:11], s56 offen offset:2048  lds
    v_mfma_f32_16x16x32_bf16 v[188:191], a[140:143], a[244:247], v[188:191]
    ds_read_b128 a[8:11], v42 offset:8192
    v_perm_b32 v31, v106, v35, s37
    v_mfma_f32_16x16x32_bf16 v[188:191], a[136:139], a[240:243], v[188:191]
    v_perm_b32 v29, v106, v35, s38
    v_perm_b32 v60, v106, v35, s39
    v_mfma_f32_16x16x32_bf16 v[192:195], a[152:155], a[144:147], v[192:195]
    ds_read_b32 a221, v5
    ds_read_b32 a222, v7
    v_mfma_f32_16x16x32_bf16 v[192:195], a[156:159], a[148:151], v[192:195]
    ds_read_b128 a[12:15], v43 offset:8192
    v_perm_b32 v57, v110, v35, s36
    v_mfma_f32_16x16x32_bf16 v[196:199], a[156:159], a[164:167], v[196:199]
    ds_read_b32 a223, v56
    v_perm_b32 v46, v110, v35, s37
    v_mfma_f32_16x16x32_bf16 v[196:199], a[152:155], a[160:163], v[196:199]
    ds_read_b32 a40, v27
    ds_read_b32 a41, v31
    v_mfma_f32_16x16x32_bf16 v[200:203], a[152:155], a[168:171], v[200:203]
    buffer_load_dwordx4 v39, s[8:11], s56 offen offset:3072  lds
    v_mfma_f32_16x16x32_bf16 v[200:203], a[156:159], a[172:175], v[200:203]
    s_add_u32 m0, s57, 49152
    ds_read_b128 a[72:75], v42 offset:10240
    v_perm_b32 v58, v110, v35, s38
    v_mfma_f32_16x16x32_bf16 v[204:207], a[156:159], a[188:191], v[204:207]
    s_add_u32 s56, s55, 1792
    v_perm_b32 v61, v110, v35, s39
    v_perm_b32 v59, v112, v35, s36
    v_mfma_f32_16x16x32_bf16 v[204:207], a[152:155], a[184:187], v[204:207]
    ds_read_b128 a[76:79], v43 offset:10240
    ds_read_b32 a42, v29
    v_mfma_f32_16x16x32_bf16 v[208:211], a[152:155], a[192:195], v[208:211]
    ds_read_b32 a43, v60
    v_perm_b32 v6, v112, v35, s37
    v_mfma_f32_16x16x32_bf16 v[208:211], a[156:159], a[196:199], v[208:211]
    ds_read_b32 a44, v57
    v_perm_b32 v62, v112, v35, s38
    v_mfma_f32_16x16x32_bf16 v[212:215], a[156:159], a[204:207], v[212:215]
    ds_read_b128 a[96:99], v42 offset:12288
    ds_read_b32 a45, v46
    v_mfma_f32_16x16x32_bf16 v[212:215], a[152:155], a[200:203], v[212:215]
    ds_read_b32 a46, v58
    ds_read_b32 a47, v61
    v_mfma_f32_16x16x32_bf16 v[216:219], a[152:155], a[232:235], v[216:219]
    buffer_load_dwordx4 v36, s[8:11], s3 offen offset:0  lds
    v_mfma_f32_16x16x32_bf16 v[216:219], a[156:159], a[236:239], v[216:219]
    ds_read_b128 a[100:103], v43 offset:12288
    v_perm_b32 v63, v112, v35, s39
    v_mfma_f32_16x16x32_bf16 v[220:223], a[156:159], a[244:247], v[220:223]
    v_perm_b32 v5, v116, v35, s36
    v_perm_b32 v7, v116, v35, s37
    v_mfma_f32_16x16x32_bf16 v[220:223], a[152:155], a[240:243], v[220:223]
    s_waitcnt lgkmcnt(9)
    ds_read_b32 a120, v59
    v_perm_b32 v56, v116, v35, s38
    v_mfma_f32_16x16x32_bf16 v[128:131], a[64:67], a[48:51], v[128:131]
    ds_read_b128 a[80:83], v42 offset:14336
    ds_read_b32 a121, v6
    v_mfma_f32_16x16x32_bf16 v[128:131], a[68:71], a[52:55], v[128:131]
    ds_read_b32 a122, v62
    v_perm_b32 v27, v116, v35, s39
    v_mfma_f32_16x16x32_bf16 v[132:135], a[68:71], a[20:23], v[132:135]
    ds_read_b128 a[84:87], v43 offset:14336
    ds_read_b32 a123, v63
    v_mfma_f32_16x16x32_bf16 v[132:135], a[64:67], a[16:19], v[132:135]
    buffer_load_dwordx4 v37, s[8:11], s3 offen offset:1024  lds
    v_mfma_f32_16x16x32_bf16 v[136:139], a[64:67], a[224:227], v[136:139]
    v_perm_b32 v31, v113, v35, s36
    v_perm_b32 v29, v113, v35, s37
    v_mfma_f32_16x16x32_bf16 v[136:139], a[68:71], a[228:231], v[136:139]
    s_waitcnt vmcnt(16)
    v_perm_b32 v57, v113, v35, s38
    v_bitop3_b32 v60, v123, v127, s76 bitop3:0x7e
    v_mfma_f32_16x16x32_bf16 v[140:143], a[68:71], a[28:31], v[140:143]
    ds_read_b32 a124, v5
    v_cmp_lt_u32 vcc, 0xffff, v60
    v_mfma_f32_16x16x32_bf16 v[140:143], a[64:67], a[24:27], v[140:143]
    ds_read_b32 a125, v7
    ds_read_b32 a126, v56
    v_mfma_f32_16x16x32_bf16 v[144:147], a[64:67], a[8:11], v[144:147]
    v_perm_b32 v46, v113, v35, s39
    s_cbranch_vccnz L_slow5_1
L_back5_1:
    v_mfma_f32_16x16x32_bf16 v[144:147], a[68:71], a[12:15], v[144:147]
    s_waitcnt lgkmcnt(6)
    ds_read_b32 a127, v27
    v_perm_b32 v58, v117, v35, s36
    v_mfma_f32_16x16x32_bf16 v[148:151], a[68:71], a[76:79], v[148:151]
    ds_read_b32 a176, v31
    ds_read_b32 a177, v29
    v_mfma_f32_16x16x32_bf16 v[148:151], a[64:67], a[72:75], v[148:151]
    buffer_load_dwordx4 v38, s[8:11], s3 offen offset:2048  lds
    v_mfma_f32_16x16x32_bf16 v[152:155], a[64:67], a[96:99], v[152:155]
    ds_read_b128 a[104:107], v42 offset:16384
    v_perm_b32 v61, v117, v35, s37
    v_mfma_f32_16x16x32_bf16 v[152:155], a[68:71], a[100:103], v[152:155]
    s_waitcnt lgkmcnt(7)
    ds_read_b128 a[108:111], v43 offset:16384
    v_perm_b32 v59, v117, v35, s38
    v_mfma_f32_16x16x32_bf16 v[156:159], a[68:71], a[84:87], v[156:159]
    ds_read_b128 a[88:91], v42 offset:18432
    ds_read_b32 a178, v57
    v_mfma_f32_16x16x32_bf16 v[156:159], a[64:67], a[80:83], v[156:159]
    ds_read_b128 a[92:95], v43 offset:18432
    v_perm_b32 v6, v117, v35, s39
    v_mfma_f32_16x16x32_bf16 v[160:163], a[208:211], a[48:51], v[160:163]
    ds_read_b32 a179, v46
    v_perm_b32 v62, v114, v35, s36
    v_mfma_f32_16x16x32_bf16 v[160:163], a[212:215], a[52:55], v[160:163]
    ds_read_b32 a180, v58
    ds_read_b32 a181, v61
    v_mfma_f32_16x16x32_bf16 v[164:167], a[212:215], a[20:23], v[164:167]
    buffer_load_dwordx4 v39, s[8:11], s3 offen offset:3072  lds
    v_mfma_f32_16x16x32_bf16 v[164:167], a[208:211], a[16:19], v[164:167]
    s_add_u32 m0, s57, 65536
    ds_read_b128 a[56:59], v42 offset:20480
    v_perm_b32 v63, v114, v35, s37
    v_mfma_f32_16x16x32_bf16 v[168:171], a[208:211], a[224:227], v[168:171]
    s_add_u32 s3, s69, 1792
    v_perm_b32 v5, v114, v35, s38
    v_perm_b32 v60, v114, v35, s39
    v_mfma_f32_16x16x32_bf16 v[168:171], a[212:215], a[228:231], v[168:171]
    ds_read_b128 a[60:63], v43 offset:20480
    ds_read_b32 a182, v59
    v_mfma_f32_16x16x32_bf16 v[172:175], a[212:215], a[28:31], v[172:175]
    buffer_load_dwordx4 v[64:67], v22, s[32:35], 0 offen
    v_mfma_f32_16x16x32_bf16 v[172:175], a[208:211], a[24:27], v[172:175]
    v_perm_b32 v7, v118, v35, s36
    v_perm_b32 v56, v118, v35, s37
    v_mfma_f32_16x16x32_bf16 v[176:179], a[208:211], a[8:11], v[176:179]
    ds_read_b128 a[128:131], v42 offset:22528
    ds_read_b32 a183, v6
    v_mfma_f32_16x16x32_bf16 v[176:179], a[212:215], a[12:15], v[176:179]
    ds_read_b32 a112, v62
    ds_read_b32 a113, v63
    v_mfma_f32_16x16x32_bf16 v[180:183], a[212:215], a[76:79], v[180:183]
    buffer_load_dwordx4 v[68:71], v32, s[12:15], s72 offen sc1
    v_mfma_f32_16x16x32_bf16 v[180:183], a[208:211], a[72:75], v[180:183]
    ds_read_b128 a[132:135], v43 offset:22528
    v_perm_b32 v27, v118, v35, s38
    v_mfma_f32_16x16x32_bf16 v[184:187], a[208:211], a[96:99], v[184:187]
    v_perm_b32 v31, v118, v35, s39
    v_perm_b32 v29, v115, v35, s36
    v_mfma_f32_16x16x32_bf16 v[184:187], a[212:215], a[100:103], v[184:187]
    ds_read_b32 a114, v5
    ds_read_b32 a115, v60
    v_mfma_f32_16x16x32_bf16 v[188:191], a[212:215], a[84:87], v[188:191]
    buffer_load_dwordx4 v[72:75], v33, s[12:15], s72 offen sc1
    v_mfma_f32_16x16x32_bf16 v[188:191], a[208:211], a[80:83], v[188:191]
    ds_read_b128 a[136:139], v42 offset:24576
    v_perm_b32 v57, v115, v35, s37
    v_mfma_f32_16x16x32_bf16 v[192:195], a[248:251], a[48:51], v[192:195]
    ds_read_b32 a116, v7
    v_perm_b32 v46, v119, v35, s36
    v_mfma_f32_16x16x32_bf16 v[192:195], a[252:255], a[52:55], v[192:195]
    ds_read_b128 a[140:143], v43 offset:24576
    ds_read_b32 a117, v56
    v_mfma_f32_16x16x32_bf16 v[196:199], a[252:255], a[20:23], v[196:199]
    buffer_load_dwordx4 v[76:79], v34, s[12:15], s72 offen sc1
    v_mfma_f32_16x16x32_bf16 v[196:199], a[248:251], a[16:19], v[196:199]
    v_perm_b32 v58, v119, v35, s37
    v_perm_b32 v61, v123, v35, s36
    v_mfma_f32_16x16x32_bf16 v[200:203], a[248:251], a[224:227], v[200:203]
    ds_read_b128 a[144:147], v42 offset:26624
    v_perm_b32 v59, v123, v35, s37
    v_mfma_f32_16x16x32_bf16 v[200:203], a[252:255], a[228:231], v[200:203]
    ds_read_b32 a118, v27
    ds_read_b32 a119, v31
    v_mfma_f32_16x16x32_bf16 v[204:207], a[252:255], a[28:31], v[204:207]
    buffer_load_dwordx4 v[80:83], v44, s[12:15], s72 offen sc1
    v_mfma_f32_16x16x32_bf16 v[204:207], a[248:251], a[24:27], v[204:207]
    ds_read_b128 a[148:151], v43 offset:26624
    ds_read_b32 a160, v29
    v_mfma_f32_16x16x32_bf16 v[208:211], a[248:251], a[8:11], v[208:211]
    v_perm_b32 v6, v127, v35, s36
    v_perm_b32 v62, v127, v35, s37
    v_mfma_f32_16x16x32_bf16 v[208:211], a[252:255], a[12:15], v[208:211]
    ds_read_b32 a161, v57
    ds_read_b32 a162, v46
    v_mfma_f32_16x16x32_bf16 v[212:215], a[252:255], a[76:79], v[212:215]
    buffer_load_dwordx2 v[84:85], v22, s[32:35], 0 offen offset:16
    v_mfma_f32_16x16x32_bf16 v[212:215], a[248:251], a[72:75], v[212:215]
    ds_read_b128 a[168:171], v42 offset:28672
    v_perm_b32 v63, v120, v35, s36
    v_mfma_f32_16x16x32_bf16 v[216:219], a[248:251], a[96:99], v[216:219]
    v_perm_b32 v5, v120, v35, s37
    v_perm_b32 v60, v120, v35, s38
    v_mfma_f32_16x16x32_bf16 v[216:219], a[252:255], a[100:103], v[216:219]
    ds_read_b128 a[172:175], v43 offset:28672
    ds_read_b32 a163, v58
    v_mfma_f32_16x16x32_bf16 v[220:223], a[252:255], a[84:87], v[220:223]
    buffer_load_dword v86, v23, s[32:35], 0 offen
    v_mfma_f32_16x16x32_bf16 v[220:223], a[248:251], a[80:83], v[220:223]
    ds_read_b32 a164, v61
    v_perm_b32 v7, v120, v35, s39
    v_mfma_f32_16x16x32_bf16 v[224:227], a[32:35], a[50:53], v[224:227]
    s_waitcnt lgkmcnt(6)
    ds_read_b128 a[184:187], v42 offset:30720
    ds_read_b32 a165, v59
    v_mfma_f32_16x16x32_bf16 v[224:227], a[36:39], a[106:109], v[224:227]
    v_perm_b32 v56, v124, v35, s36
    v_perm_b32 v27, v124, v35, s37
    v_mfma_f32_16x16x32_bf16 v[228:231], a[36:39], a[90:93], v[228:231]
    ds_read_b128 a[188:191], v43 offset:30720
    ds_read_b32 a166, v6
    v_mfma_f32_16x16x32_bf16 v[228:231], a[32:35], a[18:21], v[228:231]
    ds_read_b32 a167, v62
    v_perm_b32 v31, v124, v35, s38
    v_mfma_f32_16x16x32_bf16 v[232:235], a[32:35], a[226:229], v[232:235]
    s_waitcnt vmcnt(18)
    v_bitop3_b32 v29, v91, v95, s76 bitop3:0x7e
    v_perm_b32 v57, v124, v35, s39
    v_mfma_f32_16x16x32_bf16 v[232:235], a[36:39], a[58:61], v[232:235]
    ds_read_b32 a192, v63
    v_cmp_lt_u32 vcc, 0xffff, v29
    v_mfma_f32_16x16x32_bf16 v[236:239], a[36:39], a[130:133], v[236:239]
    ds_read_b32 a193, v5
    v_perm_b32 v46, v121, v35, s36
    v_mfma_f32_16x16x32_bf16 v[236:239], a[32:35], a[26:29], v[236:239]
    ds_read_b32 a194, v60
    s_cbranch_vccnz L_slow6_0
L_back6_0:
    v_mfma_f32_16x16x32_bf16 v[240:243], a[32:35], a[10:13], v[240:243]
    v_perm_b32 v58, v121, v35, s37
    v_perm_b32 v61, v121, v35, s38
    v_mfma_f32_16x16x32_bf16 v[240:243], a[36:39], a[138:141], v[240:243]
    s_waitcnt vmcnt(15)
    ds_read_b32 a195, v7
    v_bitop3_b32 v59, v51, v55, s76 bitop3:0x7e
    v_mfma_f32_16x16x32_bf16 v[244:247], a[36:39], a[146:149], v[244:247]
    v_cmp_lt_u32 vcc, 0xffff, v59
    v_perm_b32 v6, v121, v35, s39
    v_mfma_f32_16x16x32_bf16 v[244:247], a[32:35], a[74:77], v[244:247]
    s_waitcnt lgkmcnt(5)
    ds_read_b32 a196, v56
    ds_read_b32 a197, v27
    v_mfma_f32_16x16x32_bf16 v[248:251], a[32:35], a[98:101], v[248:251]
    s_barrier
    v_mfma_f32_16x16x32_bf16 v[248:251], a[36:39], a[170:173], v[248:251]
    buffer_load_dwordx4 v36, s[8:11], s56 offen offset:0  lds
L_pad3:
    s_cbranch_execz L_pad4
    v_mfma_f32_16x16x32_bf16 v[252:255], a[36:39], a[186:189], v[252:255]
    v_perm_b32 v62, v125, v35, s36
    s_cbranch_vccnz L_slow6_1
L_back6_1:
    v_mfma_f32_16x16x32_bf16 v[252:255], a[32:35], a[82:85], v[252:255]
    ds_read_b32 a198, v31
    v_perm_b32 v63, v125, v35, s37
    v_mfma_f32_16x16x32_bf16 v[128:131], a[0:3], a[104:107], v[128:131]
    ds_read_b32 a199, v57
    ds_read_b32 a200, v46
    v_mfma_f32_16x16x32_bf16 v[128:131], a[4:7], a[108:111], v[128:131]
    buffer_load_dwordx4 v37, s[8:11], s56 offen offset:1024  lds
    v_mfma_f32_16x16x32_bf16 v[132:135], a[4:7], a[92:95], v[132:135]
    v_perm_b32 v29, v125, v35, s38
    v_perm_b32 v5, v125, v35, s39
    v_mfma_f32_16x16x32_bf16 v[132:135], a[0:3], a[88:91], v[132:135]
    ds_read_b32 a201, v58
    v_perm_b32 v60, v122, v35, s36
    v_mfma_f32_16x16x32_bf16 v[136:139], a[0:3], a[56:59], v[136:139]
    ds_read_b32 a202, v61
    ds_read_b32 a203, v6
    v_mfma_f32_16x16x32_bf16 v[136:139], a[4:7], a[60:63], v[136:139]
    buffer_load_dwordx4 v38, s[8:11], s56 offen offset:2048  lds
    v_mfma_f32_16x16x32_bf16 v[140:143], a[4:7], a[132:135], v[140:143]
    v_perm_b32 v7, v122, v35, s37
    v_perm_b32 v59, v122, v35, s38
    v_mfma_f32_16x16x32_bf16 v[140:143], a[0:3], a[128:131], v[140:143]
    ds_read_b32 a204, v62
    v_perm_b32 v56, v122, v35, s39
    v_mfma_f32_16x16x32_bf16 v[144:147], a[0:3], a[136:139], v[144:147]
    ds_read_b32 a205, v63
    ds_read_b32 a206, v29
    v_mfma_f32_16x16x32_bf16 v[144:147], a[4:7], a[140:143], v[144:147]
    buffer_load_dwordx4 v39, s[8:11], s56 offen offset:3072  lds
    v_mfma_f32_16x16x32_bf16 v[148:151], a[4:7], a[148:151], v[148:151]
    s_add_u32 m0, s57, 81920
    v_perm_b32 v27, v126, v35, s36
    v_perm_b32 v31, v126, v35, s37
    v_mfma_f32_16x16x32_bf16 v[148:151], a[0:3], a[144:147], v[148:151]
    ds_read_b128 a[232:235], v40 offset:0
    v_perm_b32 v57, v126, v35, s38
    v_mfma_f32_16x16x32_bf16 v[152:155], a[0:3], a[168:171], v[152:155]
    ds_read_b128 a[236:239], v41 offset:0
    ds_read_b32 a207, v5
    v_mfma_f32_16x16x32_bf16 v[152:155], a[4:7], a[172:175], v[152:155]
    buffer_load_dwordx4 v36, s[8:11], s3 offen offset:0  lds
    v_mfma_f32_16x16x32_bf16 v[156:159], a[4:7], a[188:191], v[156:159]
    ds_read_b128 a[152:155], v40 offset:2048
    v_perm_b32 v46, v126, v35, s39
    v_mfma_f32_16x16x32_bf16 v[156:159], a[0:3], a[184:187], v[156:159]
    ds_read_b128 a[156:159], v41 offset:2048
    ds_read_b32 a240, v60
    v_mfma_f32_16x16x32_bf16 v[160:163], a[216:219], a[104:107], v[160:163]
    ds_read_b32 a241, v7
    ds_read_b32 a242, v59
    v_mfma_f32_16x16x32_bf16 v[160:163], a[220:223], a[108:111], v[160:163]
    buffer_load_dwordx4 v37, s[8:11], s3 offen offset:1024  lds
    v_mfma_f32_16x16x32_bf16 v[164:167], a[220:223], a[92:95], v[164:167]
    ds_read_b128 a[64:67], v40 offset:4096
    v_perm_b32 v58, v91, v35, s36
    v_perm_b32 v61, v91, v35, s37
    v_mfma_f32_16x16x32_bf16 v[164:167], a[216:219], a[88:91], v[164:167]
    ds_read_b32 a243, v56
    v_perm_b32 v6, v95, v35, s36
    v_mfma_f32_16x16x32_bf16 v[168:171], a[216:219], a[56:59], v[168:171]
    ds_read_b32 a244, v27
    v_perm_b32 v62, v95, v35, s37
    v_mfma_f32_16x16x32_bf16 v[168:171], a[220:223], a[60:63], v[168:171]
    ds_read_b128 a[68:71], v41 offset:4096
    ds_read_b32 a245, v31
    v_mfma_f32_16x16x32_bf16 v[172:175], a[220:223], a[132:135], v[172:175]
    ds_read_b32 a246, v57
    v_perm_b32 v63, v51, v35, s36
    v_mfma_f32_16x16x32_bf16 v[172:175], a[216:219], a[128:131], v[172:175]
    v_perm_b32 v29, v51, v35, s37
    v_perm_b32 v5, v55, v35, s36
    v_mfma_f32_16x16x32_bf16 v[176:179], a[216:219], a[136:139], v[176:179]
    ds_read_b128 a[208:211], v40 offset:6144
    ds_read_b32 a247, v46
    v_mfma_f32_16x16x32_bf16 v[176:179], a[220:223], a[140:143], v[176:179]
    buffer_load_dwordx4 v38, s[8:11], s3 offen offset:2048  lds
    v_mfma_f32_16x16x32_bf16 v[180:183], a[220:223], a[148:151], v[180:183]
    v_perm_b32 v60, v55, v35, s37
    v_perm_b32 v7, v88, v35, s36
    v_mfma_f32_16x16x32_bf16 v[180:183], a[216:219], a[144:147], v[180:183]
    ds_read_b128 a[212:215], v41 offset:6144
    ds_read_b32 a248, v58
    v_mfma_f32_16x16x32_bf16 v[184:187], a[216:219], a[168:171], v[184:187]
    ds_read_b32 a249, v61
    v_perm_b32 v59, v88, v35, s37
    v_mfma_f32_16x16x32_bf16 v[184:187], a[220:223], a[172:175], v[184:187]
    ds_read_b32 a250, v6
    v_perm_b32 v56, v88, v35, s38
    v_mfma_f32_16x16x32_bf16 v[188:191], a[220:223], a[188:191], v[188:191]
    ds_read_b128 a[48:51], v40 offset:8192
    ds_read_b32 a251, v62
    v_mfma_f32_16x16x32_bf16 v[188:191], a[216:219], a[184:187], v[188:191]
    ds_read_b32 a252, v63
    ds_read_b32 a253, v29
    v_mfma_f32_16x16x32_bf16 v[192:195], a[40:43], a[104:107], v[192:195]
    buffer_load_dwordx4 v39, s[8:11], s3 offen offset:3072  lds
    v_mfma_f32_16x16x32_bf16 v[192:195], a[44:47], a[108:111], v[192:195]
    ds_read_b128 a[52:55], v41 offset:8192
    v_perm_b32 v27, v88, v35, s39
    v_mfma_f32_16x16x32_bf16 v[196:199], a[44:47], a[92:95], v[196:199]
    ds_read_b32 a254, v5
    v_perm_b32 v31, v92, v35, s36
    v_mfma_f32_16x16x32_bf16 v[196:199], a[40:43], a[88:91], v[196:199]
    v_perm_b32 v57, v92, v35, s37
    v_perm_b32 v46, v92, v35, s38
    v_mfma_f32_16x16x32_bf16 v[200:203], a[40:43], a[56:59], v[200:203]
    ds_read_b128 a[16:19], v40 offset:10240
    ds_read_b32 a255, v60
    v_mfma_f32_16x16x32_bf16 v[200:203], a[44:47], a[60:63], v[200:203]
    ds_read_b32 a224, v7
    v_perm_b32 v58, v92, v35, s39
    v_mfma_f32_16x16x32_bf16 v[204:207], a[44:47], a[132:135], v[204:207]
    ds_read_b32 a225, v59
    v_perm_b32 v61, v48, v35, s36
    v_mfma_f32_16x16x32_bf16 v[204:207], a[40:43], a[128:131], v[204:207]
    ds_read_b128 a[20:23], v41 offset:10240
    ds_read_b32 a226, v56
    v_mfma_f32_16x16x32_bf16 v[208:211], a[40:43], a[136:139], v[208:211]
    v_perm_b32 v6, v48, v35, s37
    v_perm_b32 v62, v48, v35, s38
    v_mfma_f32_16x16x32_bf16 v[208:211], a[44:47], a[140:143], v[208:211]
    ds_read_b32 a227, v27
    v_perm_b32 v63, v48, v35, s39
    v_mfma_f32_16x16x32_bf16 v[212:215], a[44:47], a[148:151], v[212:215]
    ds_read_b128 a[24:27], v40 offset:12288
    ds_read_b32 a228, v31
    v_mfma_f32_16x16x32_bf16 v[212:215], a[40:43], a[144:147], v[212:215]
    ds_read_b32 a229, v57
    ds_read_b32 a230, v46
    v_mfma_f32_16x16x32_bf16 v[216:219], a[40:43], a[168:171], v[216:219]
    v_perm_b32 v29, v52, v35, s36
    v_perm_b32 v5, v52, v35, s37
    v_mfma_f32_16x16x32_bf16 v[216:219], a[44:47], a[172:175], v[216:219]
    ds_read_b128 a[28:31], v41 offset:12288
    ds_read_b32 a231, v58
    v_mfma_f32_16x16x32_bf16 v[220:223], a[44:47], a[188:191], v[220:223]
    ds_read_b32 a8, v61
    v_perm_b32 v60, v52, v35, s38
    v_mfma_f32_16x16x32_bf16 v[220:223], a[40:43], a[184:187], v[220:223]
    s_waitcnt lgkmcnt(10)
    ds_read_b32 a9, v6
    v_perm_b32 v7, v52, v35, s39
    v_mfma_f32_16x16x32_bf16 v[128:131], a[120:123], a[232:235], v[128:131]
    ds_read_b32 a10, v62
    ds_read_b32 a11, v63
    v_mfma_f32_16x16x32_bf16 v[128:131], a[124:127], a[236:239], v[128:131]
    v_perm_b32 v59, v89, v35, s36
    v_perm_b32 v56, v89, v35, s37
    v_mfma_f32_16x16x32_bf16 v[132:135], a[124:127], a[156:159], v[132:135]
    ds_read_b32 a12, v29
    ds_read_b32 a13, v5
    v_mfma_f32_16x16x32_bf16 v[132:135], a[120:123], a[152:155], v[132:135]
    v_perm_b32 v27, v89, v35, s38
    v_perm_b32 v31, v89, v35, s39
    v_mfma_f32_16x16x32_bf16 v[136:139], a[120:123], a[64:67], v[136:139]
    ds_read_b32 a14, v60
    ds_read_b32 a15, v7
    v_mfma_f32_16x16x32_bf16 v[136:139], a[124:127], a[68:71], v[136:139]
    v_perm_b32 v57, v93, v35, s36
    v_perm_b32 v46, v93, v35, s37
    v_mfma_f32_16x16x32_bf16 v[140:143], a[124:127], a[212:215], v[140:143]
    ds_read_b128 a[72:75], v40 offset:16384
    ds_read_b32 a96, v59
    v_mfma_f32_16x16x32_bf16 v[140:143], a[120:123], a[208:211], v[140:143]
    ds_read_b32 a97, v56
    v_perm_b32 v58, v93, v35, s38
    v_mfma_f32_16x16x32_bf16 v[144:147], a[120:123], a[48:51], v[144:147]
    ds_read_b32 a98, v27
    ds_read_b32 a99, v31
    v_mfma_f32_16x16x32_bf16 v[144:147], a[124:127], a[52:55], v[144:147]
    s_waitcnt lgkmcnt(9)
    ds_read_b128 a[76:79], v41 offset:16384
    v_perm_b32 v61, v93, v35, s39
    v_mfma_f32_16x16x32_bf16 v[148:151], a[124:127], a[20:23], v[148:151]
    ds_read_b32 a100, v57
    ds_read_b32 a101, v46
    v_mfma_f32_16x16x32_bf16 v[148:151], a[120:123], a[16:19], v[148:151]
    ds_read_b32 a102, v58
    v_perm_b32 v6, v49, v35, s36
    v_mfma_f32_16x16x32_bf16 v[152:155], a[120:123], a[24:27], v[152:155]
    ds_read_b128 a[32:35], v40 offset:18432
    v_perm_b32 v62, v49, v35, s37
    v_mfma_f32_16x16x32_bf16 v[152:155], a[124:127], a[28:31], v[152:155]
    ds_read_b32 a103, v61
    v_perm_b32 v63, v49, v35, s38
    v_mfma_f32_16x16x32_bf16 v[160:163], a[176:179], a[232:235], v[160:163]
    ds_read_b32 a80, v6
    v_perm_b32 v29, v49, v35, s39
    v_mfma_f32_16x16x32_bf16 v[160:163], a[180:183], a[236:239], v[160:163]
    ds_read_b128 a[36:39], v41 offset:18432
    v_perm_b32 v5, v53, v35, s36
    v_mfma_f32_16x16x32_bf16 v[164:167], a[180:183], a[156:159], v[164:167]
    ds_read_b32 a81, v62
    v_perm_b32 v60, v53, v35, s37
    v_mfma_f32_16x16x32_bf16 v[164:167], a[176:179], a[152:155], v[164:167]
    ds_read_b32 a82, v63
    v_perm_b32 v7, v53, v35, s38
    v_mfma_f32_16x16x32_bf16 v[168:171], a[176:179], a[64:67], v[168:171]
    ds_read_b128 a[0:3], v40 offset:20480
    ds_read_b32 a83, v29
    v_mfma_f32_16x16x32_bf16 v[168:171], a[180:183], a[68:71], v[168:171]
    s_waitcnt vmcnt(12)
    ds_read_b32 a84, v5
    v_bitop3_b32 v59, v71, v75, s76 bitop3:0x7e
    v_mfma_f32_16x16x32_bf16 v[172:175], a[180:183], a[212:215], v[172:175]
    ds_read_b32 a85, v60
    v_cmp_lt_u32 vcc, 0xffff, v59
    v_mfma_f32_16x16x32_bf16 v[172:175], a[176:179], a[208:211], v[172:175]
    ds_read_b128 a[4:7], v41 offset:20480
    v_perm_b32 v56, v53, v35, s39
    v_mfma_f32_16x16x32_bf16 v[176:179], a[176:179], a[48:51], v[176:179]
    ds_read_b32 a86, v7
    s_cbranch_vccnz L_slow7_0
L_back7_0:
    v_mfma_f32_16x16x32_bf16 v[176:179], a[180:183], a[52:55], v[176:179]
    v_perm_b32 v27, v90, v35, s36
    v_perm_b32 v31, v90, v35, s37
    v_mfma_f32_16x16x32_bf16 v[180:183], a[180:183], a[20:23], v[180:183]
    ds_read_b128 a[216:219], v40 offset:22528
    v_perm_b32 v57, v90, v35, s38
    v_mfma_f32_16x16x32_bf16 v[180:183], a[176:179], a[16:19], v[180:183]
    s_waitcnt vmcnt(10)
    ds_read_b32 a87, v56
    v_bitop3_b32 v46, v79, v83, s76 bitop3:0x7e
    v_mfma_f32_16x16x32_bf16 v[184:187], a[176:179], a[24:27], v[184:187]
    v_cmp_lt_u32 vcc, 0xffff, v46
    v_perm_b32 v58, v90, v35, s39
    v_mfma_f32_16x16x32_bf16 v[184:187], a[180:183], a[28:31], v[184:187]
    ds_read_b128 a[220:223], v41 offset:22528
    ds_read_b32 a104, v27
    v_mfma_f32_16x16x32_bf16 v[192:195], a[112:115], a[232:235], v[192:195]
    ds_read_b32 a105, v31
    s_cbranch_vccnz L_slow7_1
L_back7_1:
    v_mfma_f32_16x16x32_bf16 v[192:195], a[116:119], a[236:239], v[192:195]
    ds_read_b32 a106, v57
    v_perm_b32 v61, v94, v35, s36
    v_mfma_f32_16x16x32_bf16 v[196:199], a[116:119], a[156:159], v[196:199]
    ds_read_b128 a[88:91], v40 offset:24576
    v_perm_b32 v6, v94, v35, s37
    v_mfma_f32_16x16x32_bf16 v[196:199], a[112:115], a[152:155], v[196:199]
    ds_read_b32 a107, v58
    v_perm_b32 v62, v94, v35, s38
    v_mfma_f32_16x16x32_bf16 v[200:203], a[112:115], a[64:67], v[200:203]
    ds_read_b32 a108, v61
    v_perm_b32 v63, v94, v35, s39
    v_mfma_f32_16x16x32_bf16 v[200:203], a[116:119], a[68:71], v[200:203]
    ds_read_b128 a[92:95], v41 offset:24576
    v_perm_b32 v29, v50, v35, s36
    v_mfma_f32_16x16x32_bf16 v[204:207], a[116:119], a[212:215], v[204:207]
    ds_read_b32 a109, v6
    v_perm_b32 v5, v50, v35, s37
    v_mfma_f32_16x16x32_bf16 v[204:207], a[112:115], a[208:211], v[204:207]
    ds_read_b32 a110, v62
    v_perm_b32 v60, v50, v35, s38
    v_mfma_f32_16x16x32_bf16 v[208:211], a[112:115], a[48:51], v[208:211]
    ds_read_b128 a[56:59], v40 offset:26624
    ds_read_b32 a111, v63
    v_mfma_f32_16x16x32_bf16 v[208:211], a[116:119], a[52:55], v[208:211]
    ds_read_b32 a128, v29
    v_perm_b32 v59, v50, v35, s39
    v_mfma_f32_16x16x32_bf16 v[212:215], a[116:119], a[20:23], v[212:215]
    ds_read_b32 a129, v5
    v_perm_b32 v7, v54, v35, s36
    v_mfma_f32_16x16x32_bf16 v[212:215], a[112:115], a[16:19], v[212:215]
    ds_read_b128 a[60:63], v41 offset:26624
    ds_read_b32 a130, v60
    v_mfma_f32_16x16x32_bf16 v[216:219], a[112:115], a[24:27], v[216:219]
    ds_read_b32 a131, v59
    v_perm_b32 v56, v54, v35, s37
    v_mfma_f32_16x16x32_bf16 v[216:219], a[116:119], a[28:31], v[216:219]
    ds_read_b32 a132, v7
    v_perm_b32 v46, v54, v35, s38
    v_mfma_f32_16x16x32_bf16 v[224:227], a[160:163], a[234:237], v[224:227]
    s_waitcnt lgkmcnt(10)
    ds_read_b128 a[136:139], v40 offset:28672
    v_perm_b32 v27, v54, v35, s39
    v_mfma_f32_16x16x32_bf16 v[224:227], a[164:167], a[74:77], v[224:227]
    ds_read_b128 a[140:143], v41 offset:28672
    v_perm_b32 v31, v71, v35, s36
    v_mfma_f32_16x16x32_bf16 v[228:231], a[164:167], a[34:37], v[228:231]
    ds_read_b32 a133, v56
    v_perm_b32 v57, v71, v35, s37
    v_mfma_f32_16x16x32_bf16 v[228:231], a[160:163], a[154:157], v[228:231]
    ds_read_b32 a134, v46
    v_perm_b32 v58, v75, v35, s36
    v_mfma_f32_16x16x32_bf16 v[232:235], a[160:163], a[66:69], v[232:235]
    ds_read_b32 a135, v27
    v_perm_b32 v61, v75, v35, s37
    v_mfma_f32_16x16x32_bf16 v[232:235], a[164:167], a[2:5], v[232:235]
    ds_read_b32 a144, v31
    v_perm_b32 v6, v79, v35, s36
    v_mfma_f32_16x16x32_bf16 v[236:239], a[164:167], a[218:221], v[236:239]
    ds_read_b32 a145, v57
    v_perm_b32 v62, v79, v35, s37
    v_mfma_f32_16x16x32_bf16 v[236:239], a[160:163], a[210:213], v[236:239]
    ds_read_b32 a146, v58
    v_perm_b32 v63, v83, v35, s36
    v_mfma_f32_16x16x32_bf16 v[240:243], a[160:163], a[50:53], v[240:243]
    ds_read_b32 a147, v61
    v_perm_b32 v29, v83, v35, s37
    v_mfma_f32_16x16x32_bf16 v[240:243], a[164:167], a[90:93], v[240:243]
    s_waitcnt lgkmcnt(8)
    ds_read_b32 a148, v6
    v_perm_b32 v5, v68, v35, s36
    v_mfma_f32_16x16x32_bf16 v[244:247], a[164:167], a[58:61], v[244:247]
    ds_read_b32 a149, v62
    v_perm_b32 v60, v68, v35, s37
    v_mfma_f32_16x16x32_bf16 v[244:247], a[160:163], a[18:21], v[244:247]
    ds_read_b32 a150, v63
    v_perm_b32 v59, v68, v35, s38
    v_mfma_f32_16x16x32_bf16 v[248:251], a[160:163], a[26:29], v[248:251]
    s_waitcnt lgkmcnt(8)
    ds_read_b32 a151, v29
    v_perm_b32 v7, v68, v35, s39
    v_mfma_f32_16x16x32_bf16 v[248:251], a[164:167], a[138:141], v[248:251]
    ds_read_b32 a168, v5
    v_perm_b32 v56, v72, v35, s36
    v_mfma_f32_16x16x32_bf16 v[128:131], a[192:195], a[72:75], v[128:131]
    ds_read_b32 a169, v60
    v_perm_b32 v46, v72, v35, s37
    v_mfma_f32_16x16x32_bf16 v[128:131], a[196:199], a[76:79], v[128:131]
    ds_read_b32 a170, v59
    v_perm_b32 v27, v72, v35, s38
    v_mfma_f32_16x16x32_bf16 v[132:135], a[196:199], a[36:39], v[132:135]
    ds_read_b32 a171, v7
    v_perm_b32 v31, v72, v35, s39
    v_mfma_f32_16x16x32_bf16 v[132:135], a[192:195], a[32:35], v[132:135]
    ds_read_b32 a172, v56
    v_perm_b32 v57, v76, v35, s36
    v_mfma_f32_16x16x32_bf16 v[136:139], a[192:195], a[0:3], v[136:139]
    ds_read_b32 a173, v46
    v_perm_b32 v58, v76, v35, s37
    v_mfma_f32_16x16x32_bf16 v[136:139], a[196:199], a[4:7], v[136:139]
    ds_read_b32 a174, v27
    v_perm_b32 v61, v76, v35, s38
    v_mfma_f32_16x16x32_bf16 v[140:143], a[196:199], a[220:223], v[140:143]
    ds_read_b32 a175, v31
    v_perm_b32 v6, v76, v35, s39
    v_mfma_f32_16x16x32_bf16 v[140:143], a[192:195], a[216:219], v[140:143]
    s_waitcnt vmcnt(0)
    ds_read_b32 a40, v57
    v_perm_b32 v62, v80, v35, s36
    v_mfma_f32_16x16x32_bf16 v[144:147], a[192:195], a[88:91], v[144:147]
    s_barrier
    v_mfma_f32_16x16x32_bf16 v[144:147], a[196:199], a[92:95], v[144:147]
    buffer_atomic_add v45, v1, s[24:27], s77 offen sc0 sc1
    v_mfma_f32_16x16x32_bf16 v[148:151], a[196:199], a[60:63], v[148:151]
    ds_read_b32 a41, v58
    ds_read_b32 a42, v61
    v_mfma_f32_16x16x32_bf16 v[148:151], a[192:195], a[56:59], v[148:151]
    ds_read_b32 a43, v6
    ds_read_b32 a44, v62
    v_mfma_f32_16x16x32_bf16 v[152:155], a[192:195], a[136:139], v[152:155]
    ds_read_b128 a[184:187], v40 offset:32768
    v_perm_b32 v63, v80, v35, s37
    v_mfma_f32_16x16x32_bf16 v[152:155], a[196:199], a[140:143], v[152:155]
    ds_read_b32 a45, v63
    v_perm_b32 v29, v80, v35, s38
    v_mfma_f32_16x16x32_bf16 v[160:163], a[200:203], a[72:75], v[160:163]
    ds_read_b32 a46, v29
    v_perm_b32 v5, v80, v35, s39
    v_mfma_f32_16x16x32_bf16 v[160:163], a[204:207], a[76:79], v[160:163]
    ds_read_b32 a47, v5
    v_perm_b32 v60, v69, v35, s36
    v_mfma_f32_16x16x32_bf16 v[164:167], a[204:207], a[36:39], v[164:167]
    ds_read_b128 a[188:191], v41 offset:32768
    v_perm_b32 v59, v69, v35, s37
    v_mfma_f32_16x16x32_bf16 v[164:167], a[200:203], a[32:35], v[164:167]
    ds_read_b32 a232, v60
    v_perm_b32 v7, v69, v35, s38
    v_mfma_f32_16x16x32_bf16 v[168:171], a[200:203], a[0:3], v[168:171]
    ds_read_b32 a233, v59
    v_perm_b32 v56, v69, v35, s39
    v_mfma_f32_16x16x32_bf16 v[168:171], a[204:207], a[4:7], v[168:171]
    ds_read_b32 a234, v7
    v_perm_b32 v46, v73, v35, s36
    v_mfma_f32_16x16x32_bf16 v[172:175], a[204:207], a[220:223], v[172:175]
    ds_read_b128 a[152:155], v40 offset:49152
    v_perm_b32 v27, v73, v35, s37
    v_mfma_f32_16x16x32_bf16 v[172:175], a[200:203], a[216:219], v[172:175]
    ds_read_b32 a235, v56
    v_perm_b32 v31, v73, v35, s38
    v_mfma_f32_16x16x32_bf16 v[176:179], a[200:203], a[88:91], v[176:179]
    s_mov_b32 m0, s60
    ds_read_b32 a236, v46
    v_perm_b32 v57, v73, v35, s39
    v_mfma_f32_16x16x32_bf16 v[176:179], a[204:207], a[92:95], v[176:179]
    ds_read_b128 a[156:159], v41 offset:49152
    v_perm_b32 v58, v77, v35, s36
    v_mfma_f32_16x16x32_bf16 v[180:183], a[204:207], a[60:63], v[180:183]
    ds_read_b32 a237, v27
    v_perm_b32 v61, v77, v35, s37
    v_mfma_f32_16x16x32_bf16 v[180:183], a[200:203], a[56:59], v[180:183]
    ds_read_b32 a64, v58
    ds_read_b32 a238, v31
    v_mfma_f32_16x16x32_bf16 v[184:187], a[200:203], a[136:139], v[184:187]
    ds_read_b32 a65, v61
    ds_read_b32 a239, v57
    v_mfma_f32_16x16x32_bf16 v[184:187], a[204:207], a[140:143], v[184:187]
    ds_read_b128 a[208:211], v42 offset:0
    v_perm_b32 v6, v77, v35, s38
    v_mfma_f32_16x16x32_bf16 v[192:195], a[240:243], a[72:75], v[192:195]
    ds_read_b32 a66, v6
    v_perm_b32 v62, v77, v35, s39
    v_mfma_f32_16x16x32_bf16 v[192:195], a[244:247], a[76:79], v[192:195]
    ds_read_b32 a67, v62
    v_perm_b32 v63, v81, v35, s36
    v_mfma_f32_16x16x32_bf16 v[196:199], a[244:247], a[36:39], v[196:199]
    ds_read_b128 a[212:215], v43 offset:0
    v_perm_b32 v29, v81, v35, s37
    v_mfma_f32_16x16x32_bf16 v[196:199], a[240:243], a[32:35], v[196:199]
    ds_read_b32 a68, v63
    v_perm_b32 v5, v81, v35, s38
    v_mfma_f32_16x16x32_bf16 v[200:203], a[240:243], a[0:3], v[200:203]
    ds_read_b32 a69, v29
    v_perm_b32 v60, v81, v35, s39
    v_mfma_f32_16x16x32_bf16 v[200:203], a[244:247], a[4:7], v[200:203]
    ds_read_b32 a70, v5
    v_perm_b32 v59, v70, v35, s36
    v_mfma_f32_16x16x32_bf16 v[204:207], a[244:247], a[220:223], v[204:207]
    ds_read_b128 a[48:51], v42 offset:16384
    v_perm_b32 v7, v70, v35, s37
    v_mfma_f32_16x16x32_bf16 v[204:207], a[240:243], a[216:219], v[204:207]
    ds_read_b32 a16, v59
    v_perm_b32 v56, v70, v35, s38
    v_mfma_f32_16x16x32_bf16 v[208:211], a[240:243], a[88:91], v[208:211]
    ds_read_b32 a17, v7
    ds_read_b32 a71, v60
    v_mfma_f32_16x16x32_bf16 v[208:211], a[244:247], a[92:95], v[208:211]
    ds_read_b128 a[52:55], v43 offset:16384
    v_perm_b32 v46, v70, v35, s39
    v_mfma_f32_16x16x32_bf16 v[212:215], a[244:247], a[60:63], v[212:215]
    ds_read_b32 a18, v56
    v_perm_b32 v27, v74, v35, s36
    v_mfma_f32_16x16x32_bf16 v[212:215], a[240:243], a[56:59], v[212:215]
    ds_read_b32 a20, v27
    v_perm_b32 v31, v74, v35, s37
    v_mfma_f32_16x16x32_bf16 v[216:219], a[240:243], a[136:139], v[216:219]
    ds_read_b32 a21, v31
    v_perm_b32 v58, v74, v35, s38
    v_mfma_f32_16x16x32_bf16 v[216:219], a[244:247], a[140:143], v[216:219]
    s_waitcnt lgkmcnt(9)
    ds_read_b32 a19, v46
    v_perm_b32 v57, v74, v35, s39
    v_mfma_f32_16x16x32_bf16 v[224:227], a[248:251], a[186:189], v[224:227]
    s_mov_b32 s66, 0
    ds_read_b32 a22, v58
    v_perm_b32 v61, v78, v35, s36
    v_mfma_f32_16x16x32_bf16 v[224:227], a[252:255], a[154:157], v[224:227]
    s_mov_b32 s67, 14336
    ds_read_b32 a24, v61
    v_perm_b32 v6, v78, v35, s37
    v_mfma_f32_16x16x32_bf16 v[128:131], a[224:227], a[184:187], v[128:131]
    ds_read_b32 a25, v6
    v_perm_b32 v62, v78, v35, s38
    v_mfma_f32_16x16x32_bf16 v[128:131], a[228:231], a[188:191], v[128:131]
    ds_read_b32 a23, v57
    v_perm_b32 v63, v78, v35, s39
    v_mfma_f32_16x16x32_bf16 v[128:131], a[8:11], a[152:155], v[128:131]
    ds_read_b32 a26, v62
    ds_read_b32 a27, v63
    v_mfma_f32_16x16x32_bf16 v[128:131], a[12:15], a[156:159], v[128:131]
    ds_read_b128 a[72:75], v40 offset:34816
    v_perm_b32 v29, v82, v35, s36
    v_mfma_f32_16x16x32_bf16 v[160:163], a[96:99], a[184:187], v[160:163]
    ds_read_b32 a28, v29
    v_perm_b32 v5, v82, v35, s37
    v_mfma_f32_16x16x32_bf16 v[160:163], a[100:103], a[188:191], v[160:163]
    ds_read_b32 a29, v5
    ds_read_b128 a[76:79], v41 offset:34816
    v_mfma_f32_16x16x32_bf16 v[160:163], a[80:83], a[152:155], v[160:163]
    ds_read_b128 a[32:35], v40 offset:51200
    v_perm_b32 v59, v82, v35, s38
    v_mfma_f32_16x16x32_bf16 v[160:163], a[84:87], a[156:159], v[160:163]
    ds_read_b32 a30, v59
    v_perm_b32 v60, v82, v35, s39
    v_mfma_f32_16x16x32_bf16 v[192:195], a[104:107], a[184:187], v[192:195]
    ds_read_b128 a[36:39], v41 offset:51200
    v_lshlrev_b32 v96, 16, v86
    v_mfma_f32_16x16x32_bf16 v[192:195], a[108:111], a[188:191], v[192:195]
    ds_read_b32 a31, v60
    v_and_b32 v97, 0xffff0000, v86
    v_mfma_f32_16x16x32_bf16 v[192:195], a[128:131], a[152:155], v[192:195]
    ds_read_b128 a[0:3], v42 offset:2048
    v_lshlrev_b32 v100, 16, v64
    v_mfma_f32_16x16x32_bf16 v[192:195], a[132:135], a[156:159], v[192:195]
    ds_read_b128 a[4:7], v43 offset:2048
    v_and_b32 v101, 0xffff0000, v65
    v_mfma_f32_16x16x32_bf16 v[224:227], a[144:147], a[210:213], v[224:227]
    s_waitcnt lgkmcnt(9)
    v_lshlrev_b32 v102, 16, v67
    v_and_b32 v103, 0xffff0000, v84
    v_mfma_f32_16x16x32_bf16 v[224:227], a[148:151], a[50:53], v[224:227]
    ds_read_b128 a[216:219], v42 offset:18432
    v_and_b32 v104, 0xffff0000, v64
    v_mfma_f32_16x16x32_bf16 v[128:131], a[168:171], a[208:211], v[128:131]
    v_lshlrev_b32 v105, 16, v66
    v_and_b32 v106, 0xffff0000, v67
    v_mfma_f32_16x16x32_bf16 v[128:131], a[172:175], a[212:215], v[128:131]
    v_lshlrev_b32 v107, 16, v85
    v_lshlrev_b32 v108, 16, v65
    v_mfma_f32_16x16x32_bf16 v[128:131], a[40:43], a[48:51], v[128:131]
    ds_read_b128 a[220:223], v43 offset:18432
    v_and_b32 v109, 0xffff0000, v66
    v_mfma_f32_16x16x32_bf16 v[128:131], a[44:47], a[52:55], v[128:131]
    ds_write_addtid_b32 v226 offset:28928
    v_lshlrev_b32 v110, 16, v84
    v_mfma_f32_16x16x32_bf16 v[160:163], a[232:235], a[208:211], v[160:163]
    ds_write_addtid_b32 v227 offset:29184
    v_and_b32 v111, 0xffff0000, v85
    v_mfma_f32_16x16x32_bf16 v[160:163], a[236:239], a[212:215], v[160:163]
    v_mfma_f32_16x16x32_bf16 v[160:163], a[64:67], a[48:51], v[160:163]
    ds_read_b128 a[88:91], v40 offset:36864
    v_mfma_f32_16x16x32_bf16 v[160:163], a[68:71], a[52:55], v[160:163]
    v_mul_f32 v128, v128, v100
    v_mul_f32 v129, v129, v101
    v_mfma_f32_16x16x32_bf16 v[192:195], a[16:19], a[208:211], v[192:195]
    v_mul_f32 v130, v130, v102
    v_mul_f32 v131, v131, v103
    v_mfma_f32_16x16x32_bf16 v[192:195], a[20:23], a[212:215], v[192:195]
    s_waitcnt lgkmcnt(1)
    s_barrier
    v_mfma_f32_16x16x32_bf16 v[192:195], a[24:27], a[48:51], v[192:195]
    ds_read2st64_b32 v[112:113], v30 offset0:113 offset1:114
    ds_read_b128 a[92:95], v41 offset:36864
L_pad4:
    s_cbranch_execz L_warmed
    v_mfma_f32_16x16x32_bf16 v[192:195], a[28:31], a[52:55], v[192:195]
    v_mul_f32 v160, v160, v104
    v_cvt_pk_bf16_f32 v116, v128, v160
    v_mfma_f32_16x16x32_bf16 v[228:231], a[248:251], a[74:77], v[228:231]
    v_mul_f32 v161, v161, v105
    v_mul_f32 v162, v162, v106
    v_mfma_f32_16x16x32_bf16 v[228:231], a[252:255], a[34:37], v[228:231]
    ds_read_b128 a[56:59], v40 offset:53248
    v_cvt_pk_bf16_f32 v119, v130, v162
    v_mfma_f32_16x16x32_bf16 v[228:231], a[144:147], a[2:5], v[228:231]
    v_mul_f32 v163, v163, v107
    v_mfma_f32_16x16x32_bf16 v[228:231], a[148:151], a[218:221], v[228:231]
    v_mul_f32 v192, v192, v108
    v_mul_f32 v193, v193, v109
    v_mfma_f32_16x16x32_bf16 v[132:135], a[224:227], a[72:75], v[132:135]
    ds_read_b128 a[60:63], v41 offset:53248
    v_mul_f32 v194, v194, v110
    v_mfma_f32_16x16x32_bf16 v[132:135], a[228:231], a[76:79], v[132:135]
    v_mul_f32 v195, v195, v111
    v_cvt_pk_bf16_f32 v117, v192, v129
    v_mfma_f32_16x16x32_bf16 v[132:135], a[8:11], a[32:35], v[132:135]
    ds_write_b64 v26, v[116:117] offset:64512
    v_mfma_f32_16x16x32_bf16 v[132:135], a[12:15], a[36:39], v[132:135]
    ds_write_addtid_b32 v230 offset:30976
    v_cvt_pk_bf16_f32 v118, v161, v193
    v_mfma_f32_16x16x32_bf16 v[132:135], a[168:171], a[0:3], v[132:135]
    ds_write_b64 v26, v[118:119] offset:64520
    v_mfma_f32_16x16x32_bf16 v[132:135], a[172:175], a[4:7], v[132:135]
    ds_write_addtid_b32 v231 offset:31232
    v_cvt_pk_bf16_f32 v120, v194, v131
    v_mfma_f32_16x16x32_bf16 v[132:135], a[40:43], a[216:219], v[132:135]
    ds_read_b128 a[136:139], v42 offset:4096
    v_cvt_pk_bf16_f32 v121, v163, v195
    v_mfma_f32_16x16x32_bf16 v[132:135], a[44:47], a[220:223], v[132:135]
    ds_write_b64 v26, v[120:121] offset:64528
    v_mfma_f32_16x16x32_bf16 v[164:167], a[96:99], a[72:75], v[164:167]
    s_waitcnt lgkmcnt(7)
    v_add_f32 v224, v224, v112
    v_mul_f32 v224, v224, v96
    v_mfma_f32_16x16x32_bf16 v[164:167], a[100:103], a[76:79], v[164:167]
    v_add_f32 v225, v225, v113
    v_mul_f32 v225, v225, v97
    v_mfma_f32_16x16x32_bf16 v[164:167], a[80:83], a[32:35], v[164:167]
    ds_read_b128 a[140:143], v43 offset:4096
    v_cvt_pk_bf16_f32 v112, v224, v225
    v_mfma_f32_16x16x32_bf16 v[164:167], a[84:87], a[36:39], v[164:167]
    ds_write_b32 v28, v112 offset:64512
    v_mfma_f32_16x16x32_bf16 v[164:167], a[232:235], a[0:3], v[164:167]
    ds_read_b128 a[184:187], v42 offset:20480
    v_mul_f32 v132, v132, v100
    v_mfma_f32_16x16x32_bf16 v[164:167], a[236:239], a[4:7], v[164:167]
    v_mul_f32 v133, v133, v101
    v_mul_f32 v134, v134, v102
    v_mfma_f32_16x16x32_bf16 v[164:167], a[64:67], a[216:219], v[164:167]
    ds_read_b128 a[188:191], v43 offset:20480
    v_mul_f32 v135, v135, v103
    v_mfma_f32_16x16x32_bf16 v[164:167], a[68:71], a[220:223], v[164:167]
    v_mfma_f32_16x16x32_bf16 v[196:199], a[104:107], a[72:75], v[196:199]
    s_waitcnt lgkmcnt(2)
    s_barrier
    v_mfma_f32_16x16x32_bf16 v[196:199], a[108:111], a[76:79], v[196:199]
    ds_read_b128 v[124:127], v24 offset:64512
    ds_read2st64_b32 v[88:89], v30 offset0:121 offset1:122
    v_mfma_f32_16x16x32_bf16 v[196:199], a[128:131], a[32:35], v[196:199]
    ds_read_b128 v[92:95], v24 offset:65440
    v_mfma_f32_16x16x32_bf16 v[196:199], a[132:135], a[36:39], v[196:199]
    ds_read_b128 a[152:155], v40 offset:38912
    v_mul_f32 v164, v164, v104
    v_mfma_f32_16x16x32_bf16 v[196:199], a[16:19], a[0:3], v[196:199]
    v_cvt_pk_bf16_f32 v48, v132, v164
    v_mul_f32 v165, v165, v105
    v_mfma_f32_16x16x32_bf16 v[196:199], a[20:23], a[4:7], v[196:199]
    ds_read_b128 a[156:159], v41 offset:38912
    v_mul_f32 v166, v166, v106
    v_mfma_f32_16x16x32_bf16 v[196:199], a[24:27], a[216:219], v[196:199]
    v_cvt_pk_bf16_f32 v51, v134, v166
    v_mul_f32 v167, v167, v107
    v_mfma_f32_16x16x32_bf16 v[196:199], a[28:31], a[220:223], v[196:199]
    s_waitcnt lgkmcnt(3)
    v_mfma_f32_16x16x32_bf16 v[232:235], a[248:251], a[90:93], v[232:235]
    buffer_store_dwordx4 v[124:127], v25, s[16:19], s66 offen sc1
    v_mfma_f32_16x16x32_bf16 v[232:235], a[252:255], a[58:61], v[232:235]
    s_mov_b32 s66, 114688
    v_add_f32 v228, v228, v88
    v_mul_f32 v228, v228, v96
    v_mfma_f32_16x16x32_bf16 v[232:235], a[144:147], a[138:141], v[232:235]
    v_add_f32 v229, v229, v89
    v_mul_f32 v229, v229, v97
    v_mfma_f32_16x16x32_bf16 v[232:235], a[148:151], a[186:189], v[232:235]
    s_waitcnt lgkmcnt(2)
    ds_read_b128 a[208:211], v40 offset:55296
    v_mfma_f32_16x16x32_bf16 v[136:139], a[224:227], a[88:91], v[136:139]
    buffer_store_dwordx4 v[92:95], v25, s[16:19], s67 offen sc1
    v_mfma_f32_16x16x32_bf16 v[136:139], a[228:231], a[92:95], v[136:139]
    s_mov_b32 s67, 129024
    ds_read_b128 a[212:215], v41 offset:55296
    v_cvt_pk_bf16_f32 v88, v228, v229
    v_mfma_f32_16x16x32_bf16 v[136:139], a[8:11], a[56:59], v[136:139]
    ds_write_b32 v28, v88 offset:0
    v_mfma_f32_16x16x32_bf16 v[136:139], a[12:15], a[60:63], v[136:139]
    ds_write_addtid_b32 v234 offset:33024
    v_mul_f32 v196, v196, v108
    v_mfma_f32_16x16x32_bf16 v[136:139], a[168:171], a[136:139], v[136:139]
    ds_write_addtid_b32 v235 offset:33280
    v_mul_f32 v197, v197, v109
    v_mfma_f32_16x16x32_bf16 v[136:139], a[172:175], a[140:143], v[136:139]
    v_mul_f32 v198, v198, v110
    v_mul_f32 v199, v199, v111
    v_mfma_f32_16x16x32_bf16 v[136:139], a[40:43], a[184:187], v[136:139]
    ds_read_b128 a[48:51], v42 offset:6144
    v_cvt_pk_bf16_f32 v49, v196, v133
    v_mfma_f32_16x16x32_bf16 v[136:139], a[44:47], a[188:191], v[136:139]
    ds_write_b64 v26, v[48:49] offset:0
    v_mfma_f32_16x16x32_bf16 v[168:171], a[96:99], a[88:91], v[168:171]
    v_cvt_pk_bf16_f32 v50, v165, v197
    v_cvt_pk_bf16_f32 v52, v198, v135
    v_mfma_f32_16x16x32_bf16 v[168:171], a[100:103], a[92:95], v[168:171]
    ds_write_b64 v26, v[50:51] offset:8
    v_mfma_f32_16x16x32_bf16 v[168:171], a[80:83], a[56:59], v[168:171]
    ds_read_b128 a[52:55], v43 offset:6144
    v_cvt_pk_bf16_f32 v53, v167, v199
    v_mfma_f32_16x16x32_bf16 v[168:171], a[84:87], a[60:63], v[168:171]
    ds_write_b64 v26, v[52:53] offset:16
    v_mfma_f32_16x16x32_bf16 v[168:171], a[232:235], a[136:139], v[168:171]
    ds_read_b128 a[72:75], v42 offset:22528
    v_mul_f32 v136, v136, v100
    v_mfma_f32_16x16x32_bf16 v[168:171], a[236:239], a[140:143], v[168:171]
    v_mul_f32 v137, v137, v101
    v_mul_f32 v138, v138, v102
    v_mfma_f32_16x16x32_bf16 v[168:171], a[64:67], a[184:187], v[168:171]
    ds_read_b128 a[76:79], v43 offset:22528
    v_mul_f32 v139, v139, v103
    v_mfma_f32_16x16x32_bf16 v[168:171], a[68:71], a[188:191], v[168:171]
    v_mfma_f32_16x16x32_bf16 v[200:203], a[104:107], a[88:91], v[200:203]
    s_waitcnt lgkmcnt(2)
    s_barrier
    v_mfma_f32_16x16x32_bf16 v[200:203], a[108:111], a[92:95], v[200:203]
    ds_read_b128 v[68:71], v24 offset:0
    ds_read2st64_b32 v[72:73], v30 offset0:129 offset1:130
    v_mfma_f32_16x16x32_bf16 v[200:203], a[128:131], a[56:59], v[200:203]
    ds_read_b128 v[76:79], v24 offset:928
    v_mfma_f32_16x16x32_bf16 v[200:203], a[132:135], a[60:63], v[200:203]
    ds_read_b128 a[32:35], v40 offset:40960
    v_mul_f32 v168, v168, v104
    v_mfma_f32_16x16x32_bf16 v[200:203], a[16:19], a[136:139], v[200:203]
    v_cvt_pk_bf16_f32 v80, v136, v168
    v_mul_f32 v169, v169, v105
    v_mfma_f32_16x16x32_bf16 v[200:203], a[20:23], a[140:143], v[200:203]
    ds_read_b128 a[36:39], v41 offset:40960
    v_mul_f32 v170, v170, v106
    v_mfma_f32_16x16x32_bf16 v[200:203], a[24:27], a[184:187], v[200:203]
    v_cvt_pk_bf16_f32 v83, v138, v170
    v_mul_f32 v171, v171, v107
    v_mfma_f32_16x16x32_bf16 v[200:203], a[28:31], a[188:191], v[200:203]
    s_waitcnt lgkmcnt(3)
    v_mfma_f32_16x16x32_bf16 v[236:239], a[248:251], a[154:157], v[236:239]
    buffer_store_dwordx4 v[68:71], v25, s[16:19], s66 offen sc1
    v_mfma_f32_16x16x32_bf16 v[236:239], a[252:255], a[210:213], v[236:239]
    s_mov_b32 s66, 229376
    v_add_f32 v232, v232, v72
    v_mul_f32 v232, v232, v96
    v_mfma_f32_16x16x32_bf16 v[236:239], a[144:147], a[50:53], v[236:239]
    v_add_f32 v233, v233, v73
    v_mul_f32 v233, v233, v97
    v_mfma_f32_16x16x32_bf16 v[236:239], a[148:151], a[74:77], v[236:239]
    s_waitcnt lgkmcnt(2)
    ds_read_b128 a[0:3], v40 offset:57344
    v_mfma_f32_16x16x32_bf16 v[140:143], a[224:227], a[152:155], v[140:143]
    buffer_store_dwordx4 v[76:79], v25, s[16:19], s67 offen sc1
    v_mfma_f32_16x16x32_bf16 v[140:143], a[228:231], a[156:159], v[140:143]
    s_mov_b32 s67, 243712
    ds_read_b128 a[4:7], v41 offset:57344
    v_cvt_pk_bf16_f32 v72, v232, v233
    v_mfma_f32_16x16x32_bf16 v[140:143], a[8:11], a[208:211], v[140:143]
    ds_write_b32 v28, v72 offset:7424
    v_mfma_f32_16x16x32_bf16 v[140:143], a[12:15], a[212:215], v[140:143]
    ds_write_addtid_b32 v238 offset:0
    v_mul_f32 v200, v200, v108
    v_mfma_f32_16x16x32_bf16 v[140:143], a[168:171], a[48:51], v[140:143]
    ds_write_addtid_b32 v239 offset:256
    v_mul_f32 v201, v201, v109
    v_mfma_f32_16x16x32_bf16 v[140:143], a[172:175], a[52:55], v[140:143]
    v_mul_f32 v202, v202, v110
    v_mul_f32 v203, v203, v111
    v_mfma_f32_16x16x32_bf16 v[140:143], a[40:43], a[72:75], v[140:143]
    ds_read_b128 a[216:219], v42 offset:8192
    v_cvt_pk_bf16_f32 v81, v200, v137
    v_mfma_f32_16x16x32_bf16 v[140:143], a[44:47], a[76:79], v[140:143]
    ds_write_b64 v26, v[80:81] offset:7424
    v_mfma_f32_16x16x32_bf16 v[172:175], a[96:99], a[152:155], v[172:175]
    v_cvt_pk_bf16_f32 v82, v169, v201
    v_cvt_pk_bf16_f32 v64, v202, v139
    v_mfma_f32_16x16x32_bf16 v[172:175], a[100:103], a[156:159], v[172:175]
    ds_write_b64 v26, v[82:83] offset:7432
    v_mfma_f32_16x16x32_bf16 v[172:175], a[80:83], a[208:211], v[172:175]
    ds_read_b128 a[220:223], v43 offset:8192
    v_cvt_pk_bf16_f32 v65, v171, v203
    v_mfma_f32_16x16x32_bf16 v[172:175], a[84:87], a[212:215], v[172:175]
    ds_write_b64 v26, v[64:65] offset:7440
    v_mfma_f32_16x16x32_bf16 v[172:175], a[232:235], a[48:51], v[172:175]
    ds_read_b128 a[88:91], v42 offset:24576
    v_mul_f32 v140, v140, v100
    v_mfma_f32_16x16x32_bf16 v[172:175], a[236:239], a[52:55], v[172:175]
    v_mul_f32 v141, v141, v101
    v_mul_f32 v142, v142, v102
    v_mfma_f32_16x16x32_bf16 v[172:175], a[64:67], a[72:75], v[172:175]
    ds_read_b128 a[92:95], v43 offset:24576
    v_mul_f32 v143, v143, v103
    v_mfma_f32_16x16x32_bf16 v[172:175], a[68:71], a[76:79], v[172:175]
    v_mfma_f32_16x16x32_bf16 v[204:207], a[104:107], a[152:155], v[204:207]
    s_waitcnt lgkmcnt(2)
    s_barrier
    v_mfma_f32_16x16x32_bf16 v[204:207], a[108:111], a[156:159], v[204:207]
    ds_read_b128 v[84:87], v24 offset:7424
    ds_read2st64_b32 v[116:117], v30 offset0:0 offset1:1
    v_mfma_f32_16x16x32_bf16 v[204:207], a[128:131], a[208:211], v[204:207]
    ds_read_b128 v[120:123], v24 offset:8352
    v_mfma_f32_16x16x32_bf16 v[204:207], a[132:135], a[212:215], v[204:207]
    ds_read_b128 a[56:59], v40 offset:43008
    v_mul_f32 v172, v172, v104
    v_mfma_f32_16x16x32_bf16 v[204:207], a[16:19], a[48:51], v[204:207]
    v_cvt_pk_bf16_f32 v112, v140, v172
    v_mul_f32 v173, v173, v105
    v_mfma_f32_16x16x32_bf16 v[204:207], a[20:23], a[52:55], v[204:207]
    ds_read_b128 a[60:63], v41 offset:43008
    v_mul_f32 v174, v174, v106
    v_mfma_f32_16x16x32_bf16 v[204:207], a[24:27], a[72:75], v[204:207]
    v_cvt_pk_bf16_f32 v115, v142, v174
    v_mul_f32 v175, v175, v107
    v_mfma_f32_16x16x32_bf16 v[204:207], a[28:31], a[76:79], v[204:207]
    s_waitcnt lgkmcnt(3)
    v_mfma_f32_16x16x32_bf16 v[240:243], a[248:251], a[34:37], v[240:243]
    buffer_store_dwordx4 v[84:87], v25, s[16:19], s66 offen sc1
    v_mfma_f32_16x16x32_bf16 v[240:243], a[252:255], a[2:5], v[240:243]
    s_mov_b32 s66, 344064
    v_add_f32 v236, v236, v116
    v_mul_f32 v236, v236, v96
    v_mfma_f32_16x16x32_bf16 v[240:243], a[144:147], a[218:221], v[240:243]
    v_add_f32 v237, v237, v117
    v_mul_f32 v237, v237, v97
    v_mfma_f32_16x16x32_bf16 v[240:243], a[148:151], a[90:93], v[240:243]
    s_waitcnt lgkmcnt(2)
    ds_read_b128 a[136:139], v40 offset:59392
    v_mfma_f32_16x16x32_bf16 v[144:147], a[224:227], a[32:35], v[144:147]
    buffer_store_dwordx4 v[120:123], v25, s[16:19], s67 offen sc1
    v_mfma_f32_16x16x32_bf16 v[144:147], a[228:231], a[36:39], v[144:147]
    s_mov_b32 s67, 358400
    ds_read_b128 a[140:143], v41 offset:59392
    v_cvt_pk_bf16_f32 v116, v236, v237
    v_mfma_f32_16x16x32_bf16 v[144:147], a[8:11], a[0:3], v[144:147]
    ds_write_b32 v28, v116 offset:14848
    v_mfma_f32_16x16x32_bf16 v[144:147], a[12:15], a[4:7], v[144:147]
    ds_write_addtid_b32 v242 offset:2048
    v_mul_f32 v204, v204, v108
    v_mfma_f32_16x16x32_bf16 v[144:147], a[168:171], a[216:219], v[144:147]
    ds_write_addtid_b32 v243 offset:2304
    v_mul_f32 v205, v205, v109
    v_mfma_f32_16x16x32_bf16 v[144:147], a[172:175], a[220:223], v[144:147]
    v_mul_f32 v206, v206, v110
    v_mul_f32 v207, v207, v111
    v_mfma_f32_16x16x32_bf16 v[144:147], a[40:43], a[88:91], v[144:147]
    ds_read_b128 a[184:187], v42 offset:10240
    v_cvt_pk_bf16_f32 v113, v204, v141
    v_mfma_f32_16x16x32_bf16 v[144:147], a[44:47], a[92:95], v[144:147]
    ds_write_b64 v26, v[112:113] offset:14848
    v_mfma_f32_16x16x32_bf16 v[176:179], a[96:99], a[32:35], v[176:179]
    v_cvt_pk_bf16_f32 v114, v173, v205
    v_cvt_pk_bf16_f32 v124, v206, v143
    v_mfma_f32_16x16x32_bf16 v[176:179], a[100:103], a[36:39], v[176:179]
    ds_write_b64 v26, v[114:115] offset:14856
    v_mfma_f32_16x16x32_bf16 v[176:179], a[80:83], a[0:3], v[176:179]
    ds_read_b128 a[188:191], v43 offset:10240
    v_cvt_pk_bf16_f32 v125, v175, v207
    v_mfma_f32_16x16x32_bf16 v[176:179], a[84:87], a[4:7], v[176:179]
    ds_write_b64 v26, v[124:125] offset:14864
    v_mfma_f32_16x16x32_bf16 v[176:179], a[232:235], a[216:219], v[176:179]
    ds_read_b128 a[152:155], v42 offset:26624
    v_mul_f32 v144, v144, v100
    v_mfma_f32_16x16x32_bf16 v[176:179], a[236:239], a[220:223], v[176:179]
    v_mul_f32 v145, v145, v101
    v_mul_f32 v146, v146, v102
    v_mfma_f32_16x16x32_bf16 v[176:179], a[64:67], a[88:91], v[176:179]
    ds_read_b128 a[156:159], v43 offset:26624
    v_mul_f32 v147, v147, v103
    v_mfma_f32_16x16x32_bf16 v[176:179], a[68:71], a[92:95], v[176:179]
    s_waitcnt vmcnt(6)
    v_bitop3_b32 v45, v45, 15, v0 bitop3:0xbe
    v_lshlrev_b32 v45, 22, v45
    v_mfma_f32_16x16x32_bf16 v[208:211], a[104:107], a[32:35], v[208:211]
    s_waitcnt lgkmcnt(2)
    s_barrier
    v_mfma_f32_16x16x32_bf16 v[208:211], a[108:111], a[36:39], v[208:211]
    buffer_store_dword v47, v45, s[12:15], s78 offen sc1
    v_mfma_f32_16x16x32_bf16 v[208:211], a[128:131], a[0:3], v[208:211]
    ds_read_b128 v[92:95], v24 offset:14848
    ds_read2st64_b32 v[88:89], v30 offset0:8 offset1:9
    v_mfma_f32_16x16x32_bf16 v[208:211], a[132:135], a[4:7], v[208:211]
    ds_read_b128 v[48:51], v24 offset:15776
    v_mul_f32 v176, v176, v104
    v_mfma_f32_16x16x32_bf16 v[208:211], a[16:19], a[216:219], v[208:211]
    ds_read_b128 a[208:211], v40 offset:45056
    v_cvt_pk_bf16_f32 v52, v144, v176
    v_mfma_f32_16x16x32_bf16 v[208:211], a[20:23], a[220:223], v[208:211]
    ds_read_b128 a[212:215], v41 offset:45056
    v_mul_f32 v177, v177, v105
    v_mfma_f32_16x16x32_bf16 v[208:211], a[24:27], a[88:91], v[208:211]
    v_mul_f32 v178, v178, v106
    v_cvt_pk_bf16_f32 v55, v146, v178
    v_mfma_f32_16x16x32_bf16 v[208:211], a[28:31], a[92:95], v[208:211]
    v_mul_f32 v179, v179, v107
    v_mfma_f32_16x16x32_bf16 v[244:247], a[248:251], a[58:61], v[244:247]
    s_waitcnt lgkmcnt(3)
    v_mfma_f32_16x16x32_bf16 v[244:247], a[252:255], a[138:141], v[244:247]
    buffer_store_dwordx4 v[92:95], v25, s[16:19], s66 offen sc1
    v_mfma_f32_16x16x32_bf16 v[244:247], a[144:147], a[186:189], v[244:247]
    s_mov_b32 s66, 458752
    v_add_f32 v240, v240, v88
    v_mul_f32 v240, v240, v96
    v_mfma_f32_16x16x32_bf16 v[244:247], a[148:151], a[154:157], v[244:247]
    v_add_f32 v241, v241, v89
    v_mul_f32 v241, v241, v97
    v_mfma_f32_16x16x32_bf16 v[148:151], a[224:227], a[56:59], v[148:151]
    s_waitcnt lgkmcnt(2)
    ds_read_b128 a[48:51], v40 offset:61440
    v_mfma_f32_16x16x32_bf16 v[148:151], a[228:231], a[60:63], v[148:151]
    buffer_store_dwordx4 v[48:51], v25, s[16:19], s67 offen sc1
    v_mfma_f32_16x16x32_bf16 v[148:151], a[8:11], a[136:139], v[148:151]
    s_mov_b32 s67, 473088
    ds_read_b128 a[52:55], v41 offset:61440
    v_cvt_pk_bf16_f32 v88, v240, v241
    v_mfma_f32_16x16x32_bf16 v[148:151], a[12:15], a[140:143], v[148:151]
    ds_write_b32 v28, v88 offset:22272
    v_mfma_f32_16x16x32_bf16 v[148:151], a[168:171], a[184:187], v[148:151]
    ds_write_addtid_b32 v246 offset:4096
    v_mul_f32 v208, v208, v108
    v_mfma_f32_16x16x32_bf16 v[148:151], a[172:175], a[188:191], v[148:151]
    v_mul_f32 v209, v209, v109
    v_mul_f32 v210, v210, v110
    v_mfma_f32_16x16x32_bf16 v[148:151], a[40:43], a[152:155], v[148:151]
    v_mul_f32 v211, v211, v111
    v_cvt_pk_bf16_f32 v53, v208, v145
    v_mfma_f32_16x16x32_bf16 v[148:151], a[44:47], a[156:159], v[148:151]
    ds_write_b64 v26, v[52:53] offset:22272
    v_mfma_f32_16x16x32_bf16 v[180:183], a[96:99], a[56:59], v[180:183]
    v_cvt_pk_bf16_f32 v54, v177, v209
    v_cvt_pk_bf16_f32 v68, v210, v147
    v_mfma_f32_16x16x32_bf16 v[180:183], a[100:103], a[60:63], v[180:183]
    ds_read_b128 a[72:75], v42 offset:12288
    v_cvt_pk_bf16_f32 v69, v179, v211
    v_mfma_f32_16x16x32_bf16 v[180:183], a[80:83], a[136:139], v[180:183]
    ds_write_b64 v26, v[54:55] offset:22280
    v_mfma_f32_16x16x32_bf16 v[180:183], a[84:87], a[140:143], v[180:183]
    ds_write_b64 v26, v[68:69] offset:22288
    v_mfma_f32_16x16x32_bf16 v[180:183], a[232:235], a[184:187], v[180:183]
    ds_read_b128 a[76:79], v43 offset:12288
    ds_write_addtid_b32 v247 offset:4352
    v_mfma_f32_16x16x32_bf16 v[180:183], a[236:239], a[188:191], v[180:183]
    ds_read_b128 a[32:35], v42 offset:28672
    v_mul_f32 v148, v148, v100
    v_mfma_f32_16x16x32_bf16 v[180:183], a[64:67], a[152:155], v[180:183]
    ds_read_b128 a[36:39], v43 offset:28672
    v_mul_f32 v149, v149, v101
    v_mfma_f32_16x16x32_bf16 v[180:183], a[68:71], a[156:159], v[180:183]
    v_mul_f32 v150, v150, v102
    v_mul_f32 v151, v151, v103
    v_mfma_f32_16x16x32_bf16 v[212:215], a[104:107], a[56:59], v[212:215]
    v_mfma_f32_16x16x32_bf16 v[212:215], a[108:111], a[60:63], v[212:215]
    s_waitcnt lgkmcnt(2)
    s_barrier
    v_mfma_f32_16x16x32_bf16 v[212:215], a[128:131], a[136:139], v[212:215]
    ds_read_b128 v[76:79], v24 offset:22272
    ds_read2st64_b32 v[72:73], v30 offset0:16 offset1:17
    v_mfma_f32_16x16x32_bf16 v[212:215], a[132:135], a[140:143], v[212:215]
    ds_read_b128 v[80:83], v24 offset:23200
    v_mul_f32 v180, v180, v104
    v_mfma_f32_16x16x32_bf16 v[212:215], a[16:19], a[184:187], v[212:215]
    ds_read_b128 a[0:3], v40 offset:14336
    v_cvt_pk_bf16_f32 v64, v148, v180
    v_mfma_f32_16x16x32_bf16 v[212:215], a[20:23], a[188:191], v[212:215]
    ds_read_b128 a[4:7], v41 offset:14336
    v_mul_f32 v181, v181, v105
    v_mfma_f32_16x16x32_bf16 v[212:215], a[24:27], a[152:155], v[212:215]
    v_mul_f32 v182, v182, v106
    v_cvt_pk_bf16_f32 v67, v150, v182
    v_mfma_f32_16x16x32_bf16 v[212:215], a[28:31], a[156:159], v[212:215]
    v_mul_f32 v183, v183, v107
    v_mfma_f32_16x16x32_bf16 v[248:251], a[248:251], a[210:213], v[248:251]
    s_waitcnt lgkmcnt(3)
    v_mfma_f32_16x16x32_bf16 v[248:251], a[252:255], a[50:53], v[248:251]
    buffer_store_dwordx4 v[76:79], v25, s[16:19], s66 offen sc1
    v_mfma_f32_16x16x32_bf16 v[248:251], a[144:147], a[74:77], v[248:251]
    s_mov_b32 s66, 573440
    v_add_f32 v244, v244, v72
    v_mul_f32 v244, v244, v96
    v_mfma_f32_16x16x32_bf16 v[248:251], a[148:151], a[34:37], v[248:251]
    v_add_f32 v245, v245, v73
    v_mul_f32 v245, v245, v97
    v_mfma_f32_16x16x32_bf16 v[152:155], a[224:227], a[208:211], v[152:155]
    s_waitcnt lgkmcnt(2)
    ds_read_b128 a[216:219], v40 offset:30720
    v_mfma_f32_16x16x32_bf16 v[152:155], a[228:231], a[212:215], v[152:155]
    buffer_store_dwordx4 v[80:83], v25, s[16:19], s67 offen sc1
    v_mfma_f32_16x16x32_bf16 v[152:155], a[8:11], a[48:51], v[152:155]
    s_mov_b32 s67, 587776
    ds_read_b128 a[220:223], v41 offset:30720
    v_cvt_pk_bf16_f32 v72, v244, v245
    v_mfma_f32_16x16x32_bf16 v[152:155], a[12:15], a[52:55], v[152:155]
    ds_write_b32 v28, v72 offset:29696
    v_mfma_f32_16x16x32_bf16 v[152:155], a[168:171], a[72:75], v[152:155]
    ds_write_addtid_b32 v250 offset:6144
    v_mul_f32 v212, v212, v108
    v_mfma_f32_16x16x32_bf16 v[152:155], a[172:175], a[76:79], v[152:155]
    v_mul_f32 v213, v213, v109
    v_mul_f32 v214, v214, v110
    v_mfma_f32_16x16x32_bf16 v[152:155], a[40:43], a[32:35], v[152:155]
    v_mul_f32 v215, v215, v111
    v_cvt_pk_bf16_f32 v65, v212, v149
    v_mfma_f32_16x16x32_bf16 v[152:155], a[44:47], a[36:39], v[152:155]
    ds_write_b64 v26, v[64:65] offset:29696
    v_mfma_f32_16x16x32_bf16 v[184:187], a[96:99], a[208:211], v[184:187]
    v_cvt_pk_bf16_f32 v66, v181, v213
    v_cvt_pk_bf16_f32 v84, v214, v151
    v_mfma_f32_16x16x32_bf16 v[184:187], a[100:103], a[212:215], v[184:187]
    ds_read_b128 a[88:91], v40 offset:47104
    v_cvt_pk_bf16_f32 v85, v183, v215
    v_mfma_f32_16x16x32_bf16 v[184:187], a[80:83], a[48:51], v[184:187]
    ds_write_b64 v26, v[66:67] offset:29704
    v_mfma_f32_16x16x32_bf16 v[184:187], a[84:87], a[52:55], v[184:187]
    ds_write_b64 v26, v[84:85] offset:29712
    v_mfma_f32_16x16x32_bf16 v[184:187], a[232:235], a[72:75], v[184:187]
    ds_read_b128 a[92:95], v41 offset:47104
    ds_write_addtid_b32 v251 offset:6400
    v_mfma_f32_16x16x32_bf16 v[184:187], a[236:239], a[76:79], v[184:187]
    ds_read_b128 a[56:59], v40 offset:63488
    v_mul_f32 v152, v152, v100
    v_mfma_f32_16x16x32_bf16 v[184:187], a[64:67], a[32:35], v[184:187]
    ds_read_b128 a[60:63], v41 offset:63488
    v_mul_f32 v153, v153, v101
    v_mfma_f32_16x16x32_bf16 v[184:187], a[68:71], a[36:39], v[184:187]
    v_mul_f32 v154, v154, v102
    v_mul_f32 v155, v155, v103
    v_mfma_f32_16x16x32_bf16 v[216:219], a[104:107], a[208:211], v[216:219]
    ds_read_b128 a[136:139], v42 offset:14336
    v_mfma_f32_16x16x32_bf16 v[216:219], a[108:111], a[212:215], v[216:219]
    s_waitcnt lgkmcnt(3)
    s_barrier
    v_mfma_f32_16x16x32_bf16 v[216:219], a[128:131], a[48:51], v[216:219]
    ds_read_b128 a[140:143], v43 offset:14336
    ds_read2st64_b32 v[120:121], v30 offset0:24 offset1:25
    v_mfma_f32_16x16x32_bf16 v[216:219], a[132:135], a[52:55], v[216:219]
    ds_read_b128 a[184:187], v42 offset:30720
    v_mul_f32 v184, v184, v104
    v_mfma_f32_16x16x32_bf16 v[216:219], a[16:19], a[72:75], v[216:219]
    ds_read_b128 a[188:191], v43 offset:30720
    v_cvt_pk_bf16_f32 v116, v152, v184
    v_mfma_f32_16x16x32_bf16 v[216:219], a[20:23], a[76:79], v[216:219]
    ds_read_b128 v[112:115], v24 offset:29696
    v_mul_f32 v185, v185, v105
    v_mfma_f32_16x16x32_bf16 v[216:219], a[24:27], a[32:35], v[216:219]
    ds_read_b128 v[124:127], v24 offset:30624
    v_mul_f32 v186, v186, v106
    v_mfma_f32_16x16x32_bf16 v[216:219], a[28:31], a[36:39], v[216:219]
    v_cvt_pk_bf16_f32 v119, v154, v186
    v_mul_f32 v187, v187, v107
    v_mfma_f32_16x16x32_bf16 v[252:255], a[160:163], a[2:5], v[252:255]
    v_mfma_f32_16x16x32_bf16 v[252:255], a[164:167], a[218:221], v[252:255]
    s_waitcnt lgkmcnt(4)
    v_add_f32 v248, v248, v120
    v_mul_f32 v248, v248, v96
    v_mfma_f32_16x16x32_bf16 v[252:255], a[248:251], a[90:93], v[252:255]
    v_add_f32 v249, v249, v121
    v_mul_f32 v249, v249, v97
    v_mfma_f32_16x16x32_bf16 v[252:255], a[252:255], a[58:61], v[252:255]
    s_waitcnt lgkmcnt(1)
    v_cvt_pk_bf16_f32 v120, v248, v249
    v_mfma_f32_16x16x32_bf16 v[252:255], a[144:147], a[138:141], v[252:255]
    buffer_store_dwordx4 v[112:115], v25, s[16:19], s66 offen sc1
    v_mfma_f32_16x16x32_bf16 v[252:255], a[148:151], a[186:189], v[252:255]
    s_mov_b32 s66, 688128
    ds_write_b32 v28, v120 offset:37120
    v_mfma_f32_16x16x32_bf16 v[156:159], a[120:123], a[0:3], v[156:159]
    v_mul_f32 v216, v216, v108
    v_mul_f32 v217, v217, v109
    v_mfma_f32_16x16x32_bf16 v[156:159], a[124:127], a[4:7], v[156:159]
    s_waitcnt lgkmcnt(1)
    v_mul_f32 v218, v218, v110
    v_mfma_f32_16x16x32_bf16 v[156:159], a[192:195], a[216:219], v[156:159]
    buffer_store_dwordx4 v[124:127], v25, s[16:19], s67 offen sc1
    v_mfma_f32_16x16x32_bf16 v[156:159], a[196:199], a[220:223], v[156:159]
    s_mov_b32 s67, 702464
    ds_write_addtid_b32 v254 offset:8192
    v_mul_f32 v219, v219, v111
    v_mfma_f32_16x16x32_bf16 v[156:159], a[224:227], a[88:91], v[156:159]
    ds_write_addtid_b32 v255 offset:8448
    v_cvt_pk_bf16_f32 v117, v216, v153
    v_mfma_f32_16x16x32_bf16 v[156:159], a[228:231], a[92:95], v[156:159]
    ds_write_b64 v26, v[116:117] offset:37120
    v_mfma_f32_16x16x32_bf16 v[156:159], a[8:11], a[56:59], v[156:159]
    v_cvt_pk_bf16_f32 v118, v185, v217
    v_cvt_pk_bf16_f32 v92, v218, v155
    v_mfma_f32_16x16x32_bf16 v[156:159], a[12:15], a[60:63], v[156:159]
    ds_write_b64 v26, v[118:119] offset:37128
    v_mfma_f32_16x16x32_bf16 v[156:159], a[168:171], a[136:139], v[156:159]
    v_cvt_pk_bf16_f32 v93, v187, v219
    v_mfma_f32_16x16x32_bf16 v[156:159], a[172:175], a[140:143], v[156:159]
    ds_write_b64 v26, v[92:93] offset:37136
    v_mfma_f32_16x16x32_bf16 v[156:159], a[40:43], a[184:187], v[156:159]
    v_mfma_f32_16x16x32_bf16 v[156:159], a[44:47], a[188:191], v[156:159]
    v_mfma_f32_16x16x32_bf16 v[188:191], a[176:179], a[0:3], v[188:191]
    v_mfma_f32_16x16x32_bf16 v[188:191], a[180:183], a[4:7], v[188:191]
    v_mfma_f32_16x16x32_bf16 v[188:191], a[200:203], a[216:219], v[188:191]
    s_waitcnt lgkmcnt(0)
    s_barrier
    v_mfma_f32_16x16x32_bf16 v[188:191], a[204:207], a[220:223], v[188:191]
    ds_read_b128 v[48:51], v24 offset:37120
    ds_read2st64_b32 v[88:89], v30 offset0:32 offset1:33
    v_mfma_f32_16x16x32_bf16 v[188:191], a[96:99], a[88:91], v[188:191]
    ds_read_b128 v[52:55], v24 offset:38048
    v_mul_f32 v156, v156, v100
    v_mfma_f32_16x16x32_bf16 v[188:191], a[100:103], a[92:95], v[188:191]
    v_mul_f32 v157, v157, v101
    v_mul_f32 v158, v158, v102
    v_mfma_f32_16x16x32_bf16 v[188:191], a[80:83], a[56:59], v[188:191]
    v_mul_f32 v159, v159, v103
    v_mfma_f32_16x16x32_bf16 v[188:191], a[84:87], a[60:63], v[188:191]
    v_mfma_f32_16x16x32_bf16 v[188:191], a[232:235], a[136:139], v[188:191]
    v_mfma_f32_16x16x32_bf16 v[188:191], a[236:239], a[140:143], v[188:191]
    s_waitcnt lgkmcnt(1)
    v_mfma_f32_16x16x32_bf16 v[188:191], a[64:67], a[184:187], v[188:191]
    buffer_store_dwordx4 v[48:51], v25, s[16:19], s66 offen sc1
    v_mfma_f32_16x16x32_bf16 v[188:191], a[68:71], a[188:191], v[188:191]
    s_mov_b32 s66, 802816
    v_add_f32 v252, v252, v88
    v_mul_f32 v252, v252, v96
    v_mfma_f32_16x16x32_bf16 v[220:223], a[112:115], a[0:3], v[220:223]
    v_add_f32 v253, v253, v89
    v_mul_f32 v253, v253, v97
    v_mfma_f32_16x16x32_bf16 v[220:223], a[116:119], a[4:7], v[220:223]
    s_waitcnt lgkmcnt(0)
    v_cvt_pk_bf16_f32 v88, v252, v253
    v_mfma_f32_16x16x32_bf16 v[220:223], a[240:243], a[216:219], v[220:223]
    buffer_store_dwordx4 v[52:55], v25, s[16:19], s67 offen sc1
    v_mfma_f32_16x16x32_bf16 v[220:223], a[244:247], a[220:223], v[220:223]
    s_mov_b32 s67, 817152
    ds_write_b32 v28, v88 offset:44544
    v_mfma_f32_16x16x32_bf16 v[220:223], a[104:107], a[88:91], v[220:223]
    v_mul_f32 v188, v188, v104
    v_cvt_pk_bf16_f32 v68, v156, v188
    v_mfma_f32_16x16x32_bf16 v[220:223], a[108:111], a[92:95], v[220:223]
    v_mul_f32 v189, v189, v105
    v_mul_f32 v190, v190, v106
    v_mfma_f32_16x16x32_bf16 v[220:223], a[128:131], a[56:59], v[220:223]
    v_cvt_pk_bf16_f32 v71, v158, v190
    v_mul_f32 v191, v191, v107
    v_mfma_f32_16x16x32_bf16 v[220:223], a[132:135], a[60:63], v[220:223]
    v_mfma_f32_16x16x32_bf16 v[220:223], a[16:19], a[136:139], v[220:223]
    v_mfma_f32_16x16x32_bf16 v[220:223], a[20:23], a[140:143], v[220:223]
    v_mfma_f32_16x16x32_bf16 v[220:223], a[24:27], a[184:187], v[220:223]
    v_mfma_f32_16x16x32_bf16 v[220:223], a[28:31], a[188:191], v[220:223]
    s_nop 7
    v_mul_f32 v220, v220, v108
    v_mul_f32 v221, v221, v109
    v_mul_f32 v222, v222, v110
    v_mul_f32 v223, v223, v111
    v_cvt_pk_bf16_f32 v69, v220, v157
    v_cvt_pk_bf16_f32 v70, v189, v221
    v_cvt_pk_bf16_f32 v76, v222, v159
    v_cvt_pk_bf16_f32 v77, v191, v223
    ds_write_b64 v26, v[68:69] offset:44544
    ds_write_b64 v26, v[70:71] offset:44552
    ds_write_b64 v26, v[76:77] offset:44560
    s_waitcnt lgkmcnt(0)
    s_barrier
    ds_read_b128 v[80:83], v24 offset:44544
    ds_read_b128 v[72:75], v24 offset:45472
    s_waitcnt lgkmcnt(1)
    buffer_store_dwordx4 v[80:83], v25, s[16:19], s66 offen sc1
    s_waitcnt lgkmcnt(0)
    buffer_store_dwordx4 v[72:75], v25, s[16:19], s67 offen sc1
L_end:
    s_endpgm
L_help:
    s_mov_b32 s53, s61
    s_mov_b32 s54, s62
    s_mul_i32 s61, s22, 1835008
    s_add_u32 s61, s61, s79
    s_lshl_b32 s62, s22, 14
    s_add_u32 s62, s62, s68
    s_mov_b32 s22, 0
L_help_row:
    v_mov_b32 v21, v19
    s_xor_b32 s23, s22, s58
    s_bitcmp0_b32 s23, 2
    s_cbranch_scc1 L_help_same
    v_add_u32 v12, 57344, v19
    v_subrev_u32 v13, 57344, v19
    v_min_u32 v21, v12, v13
L_help_same:
    v_mov_b32 v8, 0
    v_mov_b32 v9, 0
    v_mov_b32 v10, 0
    v_mov_b32 v11, s47
    s_mov_b32 s23, 0
L_help_e:
    v_mov_b32 v15, 0
    buffer_load_dwordx3 v[12:14], v18, s[4:7], s61 offen nt
    s_cmp_ge_u32 s23, 16
    s_cbranch_scc1 L_help_own
    buffer_load_dword v15, v21, s[4:7], s61 offen nt
L_help_own:
    s_waitcnt vmcnt(0)
    v_lshl_or_b32 v8, v12, s23, v8
    v_lshl_or_b32 v9, v13, s23, v9
    v_lshl_or_b32 v10, v14, s23, v10
    v_lshl_or_b32 v11, v15, s23, v11
    s_add_u32 s61, s61, 14336
    s_add_u32 s23, s23, 4
    s_cmp_lt_u32 s23, 32
    s_cbranch_scc1 L_help_e
    buffer_store_dwordx4 v[8:11], v20, s[12:15], s62 offen sc1
    s_add_u32 s62, s62, 1024
    s_waitcnt vmcnt(0)
    s_add_u32 s22, s22, 1
    s_cmp_lt_u32 s22, 16
    s_cbranch_scc1 L_help_row
    s_mov_b32 s61, s53
    s_mov_b32 s62, s54
    s_setpc_b64 s[20:21]
L_code_end:

.section .rodata,"a"
.p2align 6
.amdhsa_kernel standalone__normalfloat_lut_af4__prompt_kernel
  .amdhsa_next_free_vgpr 512
  .amdhsa_next_free_sgpr 102
  .amdhsa_accum_offset 256
  .amdhsa_group_segment_fixed_size 0
  .amdhsa_kernarg_size 56
  .amdhsa_user_sgpr_count 2
  .amdhsa_user_sgpr_kernarg_segment_ptr 1
  .amdhsa_system_sgpr_workgroup_id_x 1
.end_amdhsa_kernel
```

```asm
; @launch grid=(256,1,1) block=(256,1,1) lds=163840
.amdgcn_target "amdgcn-amd-amdhsa--gfx950"
.text
.globl standalone__normalfloat_lut_af4__prompt_kernel
.p2align 8
.type standalone__normalfloat_lut_af4__prompt_kernel,@function
standalone__normalfloat_lut_af4__prompt_kernel:
    s_cmp_ge_u32 s2, 256
    s_cbranch_scc1 L_end
    s_load_dwordx2 s[4:5], s[0:1], 8
    s_load_dwordx2 s[12:13], s[0:1], 48
    s_load_dwordx2 s[8:9], s[0:1], 0
    s_load_dwordx2 s[28:29], s[0:1], 16
    s_getpc_b64 s[48:49]
L_pc:
    s_mov_b32 s50, L_code_end-L_pc
    s_mov_b32 s51, 0x20000
    s_lshr_b32 s61, s2, 3
    v_lshl_add_u32 v46, v0, 5, s61
    v_lshlrev_b32 v46, 7, v46
    buffer_load_dword v1, v46, s[48:51], 0 offen offset:256
    v_lshrrev_b32 v5, 6, v0
    v_and_b32 v2, 63, v0
    s_and_b32 s60, s2, 7
    v_readfirstlane_b32 s63, v5
    s_and_b32 s58, s60, 1
    s_lshl_b32 s58, s58, 3
    s_and_b32 s62, s61, 7
    s_add_u32 s58, s58, s62
    s_lshr_b32 s59, s60, 1
    s_lshl_b32 s59, s59, 2
    s_lshr_b32 s62, s61, 3
    s_add_u32 s59, s59, s62
    v_mul_u32_u24 v18, 12, v2
    s_lshl_b32 s60, s63, 4
    s_add_u32 s60, s60, s58
    s_mul_i32 s61, s60, 114688
    s_mul_i32 s79, s59, 896
    s_add_u32 s61, s61, s79
    s_mov_b32 s6, 14680064
    s_mov_b32 s7, 0x20000
    s_lshl_b32 s78, s59, 7
    s_add_u32 s78, s78, 2097164
    v_and_b32 v4, 15, v2
    v_lshrrev_b32 v3, 4, v2
    v_and_b32 v12, 1, v3
    v_lshlrev_b32 v13, 1, v12
    v_xor_b32 v13, v13, v4
    v_lshrrev_b32 v19, 1, v3
    v_lshl_add_u32 v19, v19, 4, v13
    s_bfe_u32 s70, s58, 0x10002
    s_xor_b32 s70, s70, 1
    v_xor_b32 v12, s70, v12
    v_mul_u32_u24 v12, 14336, v12
    v_add_lshl_u32 v19, v19, v12, 2
    v_add_u32 v19, 768, v19
    s_mov_b32 s46, 2
    s_cmp_lg_u32 s63, 0
    s_cbranch_scc1 L_role0
    s_mov_b32 s46, 0
L_role0:
    s_cmp_lg_u32 s63, 1
    s_cbranch_scc1 L_role1
    s_mov_b32 s46, 1
L_role1:
    v_lshlrev_b32 v16, 1, v4
    v_lshrrev_b32 v17, 4, v0
    v_lshlrev_b32 v17, 1, v17
    s_mov_b32 s30, 32
    s_mov_b32 s31, 0x20000
    v_lshrrev_b32 v6, 3, v2
    v_and_b32 v7, 7, v2
    v_xor_b32 v13, v7, v3
    s_lshl_b32 s70, s63, 5
    v_add_lshl_u32 v12, v6, s70, 11
    v_lshl_add_u32 v36, v13, 4, v12
    v_xor_b32 v37, 64, v36
    v_add_u32 v37, 15360, v37
    v_add_u32 v38, 30720, v36
    v_add_u32 v39, 30720, v37
    s_mov_b32 s10, 4194304
    s_mov_b32 s11, 0x20000
    s_lshl_b32 s55, s58, 18
    s_and_b32 s71, s58, 8
    s_lshl_b32 s70, s71, 4
    s_add_u32 s55, s55, s70
    s_lshl_b32 s57, s63, 12
    s_xor_b32 s69, s55, 128
    s_add_u32 s57, s57, 65536
    s_mov_b32 s14, 2099200
    s_mov_b32 s15, 0x20000
    s_lshl_b32 s68, s59, 17
    s_lshl_b32 s62, s60, 10
    s_add_u32 s62, s62, s68
    v_lshlrev_b32 v20, 4, v2
    s_waitcnt lgkmcnt(0)
    s_load_dword s76, s[12:13], s78
    s_cmp_eq_u32 s46, 1
    s_cbranch_scc1 L_L
    s_cmp_eq_u32 s46, 2
    s_cbranch_scc1 L_L
L_X:
    buffer_load_dwordx3 v[128:130], v18, s[4:7], s61 offen nt
    buffer_load_dword v131, v19, s[4:7], s61 offen nt
    s_add_u32 s61, s61, 14336
    buffer_load_dwordx3 v[132:134], v18, s[4:7], s61 offen nt
    buffer_load_dword v135, v19, s[4:7], s61 offen nt
    s_add_u32 s61, s61, 14336
    buffer_load_dwordx3 v[136:138], v18, s[4:7], s61 offen nt
    buffer_load_dword v139, v19, s[4:7], s61 offen nt
    s_add_u32 s61, s61, 14336
    buffer_load_dwordx3 v[140:142], v18, s[4:7], s61 offen nt
    buffer_load_dword v143, v19, s[4:7], s61 offen nt
    s_add_u32 s61, s61, 14336
    buffer_load_dwordx3 v[144:146], v18, s[4:7], s61 offen nt
    s_add_u32 s61, s61, 14336
    buffer_load_dwordx3 v[148:150], v18, s[4:7], s61 offen nt
    s_add_u32 s61, s61, 14336
    buffer_load_dwordx3 v[152:154], v18, s[4:7], s61 offen nt
    s_add_u32 s61, s61, 14336
    buffer_load_dwordx3 v[156:158], v18, s[4:7], s61 offen nt
    s_add_u32 s61, s61, 7239680
    s_cmp_eq_u32 s46, 1
    s_cbranch_scc1 L_D
    s_cmp_eq_u32 s46, 2
    s_cbranch_scc1 L_B
L_L:
    buffer_load_ushort v16, v16, s[28:31], 0 offen
    buffer_load_ushort v17, v17, s[28:31], 0 offen
    s_cmp_eq_u32 s46, 1
    s_cbranch_scc1 L_S
    s_cmp_eq_u32 s46, 2
    s_cbranch_scc1 L_S
L_D:
    s_add_u32 m0, s57, 32768
    s_add_u32 s56, s55, 0
    buffer_load_dwordx4 v36, s[8:11], s56 offen offset:0  lds
    buffer_load_dwordx4 v37, s[8:11], s56 offen offset:1024  lds
    buffer_load_dwordx4 v38, s[8:11], s56 offen offset:2048  lds
    buffer_load_dwordx4 v39, s[8:11], s56 offen offset:3072  lds
    s_cmp_eq_u32 s46, 1
    s_cbranch_scc1 L_G
    s_cmp_eq_u32 s46, 2
    s_cbranch_scc1 L_G
L_S:
    s_load_dwordx2 s[32:33], s[0:1], 24
    s_load_dwordx2 s[16:17], s[0:1], 32
    s_load_dwordx2 s[24:25], s[0:1], 40
    s_and_b32 s64, s63, 1
    s_lshr_b32 s65, s63, 1
    s_and_b32 s70, s58, 8
    s_lshl_b32 s70, s70, 10
    s_lshl_b32 s71, s64, 12
    s_add_u32 s70, s70, s71
    s_lshl_b32 s71, s63, 8
    s_add_u32 s70, s70, s71
    s_add_u32 s70, s70, s68
    v_lshl_add_u32 v32, v4, 4, s70
    v_lshl_add_u32 v32, v3, 10, v32
    v_xor_b32 v33, 4096, v32
    v_xor_b32 v34, 8192, v32
    v_xor_b32 v44, 12288, v32
    s_mov_b32 s36, 202114048
    s_mov_b32 s37, 202114304
    s_mov_b32 s38, 202114560
    s_mov_b32 s39, 202114816
    v_and_b32 v35, 31, v2
    v_lshlrev_b32 v35, 2, v35
    s_lshl_b32 s70, s64, 6
    s_add_u32 s70, s70, 65536
    v_lshrrev_b32 v12, 1, v4
    v_xor_b32 v12, v12, v3
    v_lshlrev_b32 v12, 4, v12
    v_lshl_add_u32 v12, v4, 7, v12
    v_xor_b32 v40, s70, v12
    v_xor_b32 v41, 64, v40
    v_add_u32 v42, 65536, v40
    v_add_u32 v43, 65536, v41
    s_mov_b32 s52, 0
    v_lshlrev_b32 v8, 4, v7
    v_lshl_add_u32 v8, v0, 8, v8
    v_xor_b32 v9, 16, v8
    v_xor_b32 v10, 32, v8
    v_xor_b32 v11, 48, v8
    v_xor_b32 v12, 64, v8
    v_xor_b32 v13, 80, v8
    v_xor_b32 v14, 96, v8
    v_xor_b32 v15, 112, v8
    s_cmp_eq_u32 s46, 1
    s_cbranch_scc1 L_X
    s_cmp_eq_u32 s46, 2
    s_cbranch_scc1 L_D
L_G:
    s_waitcnt lgkmcnt(0)
    s_add_u32 s76, s76, 2654435769
    s_and_b32 s47, s76, 0xffff0000
    s_cmp_eq_u32 s46, 1
    s_cbranch_scc1 L_T
    s_cmp_eq_u32 s46, 2
    s_cbranch_scc1 L_T
L_K:
    s_waitcnt vmcnt(16)
    v_or_b32 v131, s47, v131
    s_waitcnt vmcnt(15)
    v_lshl_or_b32 v128, v132, 4, v128
    v_lshl_or_b32 v129, v133, 4, v129
    v_lshl_or_b32 v130, v134, 4, v130
    s_waitcnt vmcnt(14)
    v_lshl_or_b32 v131, v135, 4, v131
    s_waitcnt vmcnt(13)
    v_lshl_or_b32 v128, v136, 8, v128
    v_lshl_or_b32 v129, v137, 8, v129
    v_lshl_or_b32 v130, v138, 8, v130
    s_waitcnt vmcnt(12)
    v_lshl_or_b32 v131, v139, 8, v131
    s_waitcnt vmcnt(11)
    v_lshl_or_b32 v128, v140, 12, v128
    v_lshl_or_b32 v129, v141, 12, v129
    v_lshl_or_b32 v130, v142, 12, v130
    s_waitcnt vmcnt(10)
    v_lshl_or_b32 v131, v143, 12, v131
    s_waitcnt vmcnt(9)
    v_lshl_or_b32 v128, v144, 16, v128
    v_lshl_or_b32 v129, v145, 16, v129
    v_lshl_or_b32 v130, v146, 16, v130
    s_waitcnt vmcnt(8)
    v_lshl_or_b32 v128, v148, 20, v128
    v_lshl_or_b32 v129, v149, 20, v129
    v_lshl_or_b32 v130, v150, 20, v130
    s_waitcnt vmcnt(7)
    v_lshl_or_b32 v128, v152, 24, v128
    v_lshl_or_b32 v129, v153, 24, v129
    v_lshl_or_b32 v130, v154, 24, v130
    s_waitcnt vmcnt(6)
    v_lshl_or_b32 v128, v156, 28, v128
    v_lshl_or_b32 v129, v157, 28, v129
    v_lshl_or_b32 v130, v158, 28, v130
    buffer_store_dwordx4 v[128:131], v20, s[12:15], s62 offen sc1
    s_add_u32 s62, s62, 65536
    s_cmp_eq_u32 s46, 1
    s_cbranch_scc1 L_B
    s_cmp_eq_u32 s46, 2
    s_cbranch_scc1 L_E
L_T:
    s_waitcnt vmcnt(16)
    s_cmp_eq_u32 s46, 1
    s_cbranch_scc1 L_rw1
    s_waitcnt vmcnt(5)
    s_cmp_eq_u32 s46, 0
    s_cbranch_scc1 L_rw1
    s_waitcnt vmcnt(4)
L_rw1:
    v_lshl_or_b32 v56, v17, 16, v16
    v_lshl_or_b32 v57, v17, 16, v16
    v_lshl_or_b32 v58, v17, 16, v16
    v_lshl_or_b32 v59, v17, 16, v16
    ds_write_b128 v8, v[56:59]
    ds_write_b128 v9, v[56:59]
    ds_write_b128 v10, v[56:59]
    ds_write_b128 v11, v[56:59]
    ds_write_b128 v12, v[56:59]
    ds_write_b128 v13, v[56:59]
    ds_write_b128 v14, v[56:59]
    ds_write_b128 v15, v[56:59]
    s_cmp_lg_u32 s46, 1
    s_cbranch_scc1 L_ed2
    s_waitcnt vmcnt(4)
    s_branch L_K
L_ed2:
    s_cmp_eq_u32 s46, 2
    s_cbranch_scc1 L_X
L_W:
    s_mov_b64 exec, 0
    s_cmp_eq_u32 s63, 0
    s_cbranch_scc1 L_pad0
L_warmed:
    s_mov_b64 exec, -1
L_B:
    s_waitcnt vmcnt(12) lgkmcnt(0)
    s_cmp_eq_u32 s46, 2
    s_cbranch_scc1 L_rw3
    s_waitcnt vmcnt(1)
L_rw3:
    s_barrier
L_Q:
    ds_read_b128 a[0:3], v40 offset:32768
    ds_read_b128 a[4:7], v41 offset:32768
    ds_read_b128 a[8:11], v40 offset:34816
    ds_read_b128 a[12:15], v41 offset:34816
    ds_read_b128 a[16:19], v40 offset:36864
    ds_read_b128 a[20:23], v41 offset:36864
    ds_read_b128 a[24:27], v40 offset:38912
    ds_read_b128 a[28:31], v41 offset:38912
    ds_read_b128 a[40:43], v40 offset:40960
    ds_read_b128 a[44:47], v41 offset:40960
    ds_read_b128 a[48:51], v40 offset:43008
    ds_read_b128 a[52:55], v41 offset:43008
    ds_read_b128 a[56:59], v40 offset:45056
    ds_read_b128 a[60:63], v41 offset:45056
    ds_read_b128 a[72:75], v40 offset:47104
    ds_read_b128 a[76:79], v41 offset:47104
L_P:
    buffer_load_dwordx4 v[64:67], v32, s[12:15], 0 offen sc1
    buffer_load_dwordx4 v[68:71], v33, s[12:15], 0 offen sc1
L_d:
    s_add_u32 m0, s57, 49152
    s_add_u32 s3, s69, 0
    buffer_load_dwordx4 v36, s[8:11], s3 offen offset:0  lds
    buffer_load_dwordx4 v37, s[8:11], s3 offen offset:1024  lds
    buffer_load_dwordx4 v38, s[8:11], s3 offen offset:2048  lds
    buffer_load_dwordx4 v39, s[8:11], s3 offen offset:3072  lds
    s_cmp_lg_u32 s46, 2
    s_cbranch_scc1 L_ed4
    s_waitcnt vmcnt(6)
    s_branch L_K
L_ed4:
L_E:
L_chk0:
    s_waitcnt vmcnt(5)
    s_cmp_eq_u32 s46, 2
    s_cbranch_scc1 L_rw5
    s_waitcnt vmcnt(4)
L_rw5:
    v_bitop3_b32 v12, v67, v71, s76 bitop3:0x7e
    v_cmp_lt_u32 vcc, 0xffff, v12
    s_cbranch_vccnz L_retry0
    buffer_load_dwordx4 v[72:75], v34, s[12:15], 0 offen sc1
    buffer_load_dwordx4 v[76:79], v44, s[12:15], 0 offen sc1
    v_perm_b32 v56, v64, v35, s36
    v_perm_b32 v57, v64, v35, s37
    v_perm_b32 v58, v64, v35, s38
    v_perm_b32 v59, v64, v35, s39
    v_perm_b32 v60, v68, v35, s36
    v_perm_b32 v61, v68, v35, s37
    v_perm_b32 v62, v68, v35, s38
    v_perm_b32 v63, v68, v35, s39
    ds_read_b32 a32, v56
    ds_read_b32 a33, v57
    ds_read_b32 a34, v58
    ds_read_b32 a35, v59
    ds_read_b32 a36, v60
    ds_read_b32 a37, v61
    ds_read_b32 a38, v62
    ds_read_b32 a39, v63
    v_perm_b32 v5, v65, v35, s36
    v_perm_b32 v6, v65, v35, s37
    v_perm_b32 v7, v65, v35, s38
    v_perm_b32 v27, v65, v35, s39
    v_perm_b32 v29, v69, v35, s36
    v_perm_b32 v31, v69, v35, s37
    ds_read_b32 a64, v5
    ds_read_b32 a65, v6
    ds_read_b32 a66, v7
    ds_read_b32 a67, v27
    s_cbranch_vccz L_main
L_retry0:
    s_add_u32 s52, s52, 1
    s_and_b32 s23, s52, 4095
    s_cbranch_scc1 L_retry0b
    s_mov_b32 s22, 0
    s_call_b64 s[20:21], L_help
L_retry0b:
    buffer_load_dwordx4 v[64:67], v32, s[12:15], 0 offen sc1
    buffer_load_dwordx4 v[68:71], v33, s[12:15], 0 offen sc1
    s_waitcnt vmcnt(0) lgkmcnt(0)
    s_branch L_chk0
L_tick:
    s_add_u32 s52, s52, 1
    s_and_b32 s23, s52, 4095
    s_cbranch_scc0 L_help
    s_setpc_b64 s[20:21]
L_slow0_1:
    s_mov_b32 s22, 0
    s_call_b64 s[20:21], L_tick
    buffer_load_dwordx4 v[72:75], v34, s[12:15], 0 offen sc1
    buffer_load_dwordx4 v[76:79], v44, s[12:15], 0 offen sc1
    s_waitcnt vmcnt(0)
    v_bitop3_b32 v12, v75, v79, s76 bitop3:0x7e
    v_cmp_lt_u32 vcc, 0xffff, v12
    s_cbranch_vccnz L_slow0_1
    s_branch L_back0_1
L_slow4_0:
    s_mov_b32 s22, 4
    s_call_b64 s[20:21], L_tick
    buffer_load_dwordx4 v[84:87], v32, s[12:15], s43 offen sc1
    buffer_load_dwordx4 v[96:99], v33, s[12:15], s43 offen sc1
    s_waitcnt vmcnt(0)
    v_bitop3_b32 v12, v87, v99, s76 bitop3:0x7e
    v_cmp_lt_u32 vcc, 0xffff, v12
    s_cbranch_vccnz L_slow4_0
    s_branch L_back4_0
L_slow4_1:
    s_mov_b32 s22, 4
    s_call_b64 s[20:21], L_tick
    buffer_load_dwordx4 v[104:107], v34, s[12:15], s43 offen sc1
    buffer_load_dwordx4 v[108:111], v44, s[12:15], s43 offen sc1
    s_waitcnt vmcnt(0)
    v_bitop3_b32 v12, v107, v111, s76 bitop3:0x7e
    v_cmp_lt_u32 vcc, 0xffff, v12
    s_cbranch_vccnz L_slow4_1
    s_branch L_back4_1
L_slow1_0:
    s_mov_b32 s22, 1
    s_call_b64 s[20:21], L_tick
    buffer_load_dwordx4 v[80:83], v32, s[12:15], s40 offen sc1
    buffer_load_dwordx4 v[84:87], v33, s[12:15], s40 offen sc1
    s_waitcnt vmcnt(0)
    v_bitop3_b32 v12, v83, v87, s76 bitop3:0x7e
    v_cmp_lt_u32 vcc, 0xffff, v12
    s_cbranch_vccnz L_slow1_0
    s_branch L_back1_0
L_slow1_1:
    s_mov_b32 s22, 1
    s_call_b64 s[20:21], L_tick
    buffer_load_dwordx4 v[88:91], v34, s[12:15], s40 offen sc1
    buffer_load_dwordx4 v[92:95], v44, s[12:15], s40 offen sc1
    s_waitcnt vmcnt(0)
    v_bitop3_b32 v12, v91, v95, s76 bitop3:0x7e
    v_cmp_lt_u32 vcc, 0xffff, v12
    s_cbranch_vccnz L_slow1_1
    s_branch L_back1_1
L_slow5_0:
    s_mov_b32 s22, 5
    s_call_b64 s[20:21], L_tick
    buffer_load_dwordx4 v[112:115], v32, s[12:15], s44 offen sc1
    buffer_load_dwordx4 v[116:119], v33, s[12:15], s44 offen sc1
    s_waitcnt vmcnt(0)
    v_bitop3_b32 v12, v115, v119, s76 bitop3:0x7e
    v_cmp_lt_u32 vcc, 0xffff, v12
    s_cbranch_vccnz L_slow5_0
    s_branch L_back5_0
L_slow5_1:
    s_mov_b32 s22, 5
    s_call_b64 s[20:21], L_tick
    buffer_load_dwordx4 v[120:123], v34, s[12:15], s44 offen sc1
    buffer_load_dwordx4 v[124:127], v44, s[12:15], s44 offen sc1
    s_waitcnt vmcnt(0)
    v_bitop3_b32 v12, v123, v127, s76 bitop3:0x7e
    v_cmp_lt_u32 vcc, 0xffff, v12
    s_cbranch_vccnz L_slow5_1
    s_branch L_back5_1
L_slow2_0:
    s_mov_b32 s22, 2
    s_call_b64 s[20:21], L_tick
    buffer_load_dwordx4 v[48:51], v32, s[12:15], s41 offen sc1
    buffer_load_dwordx4 v[52:55], v33, s[12:15], s41 offen sc1
    s_waitcnt vmcnt(0)
    v_bitop3_b32 v12, v51, v55, s76 bitop3:0x7e
    v_cmp_lt_u32 vcc, 0xffff, v12
    s_cbranch_vccnz L_slow2_0
    s_branch L_back2_0
L_slow2_1:
    s_mov_b32 s22, 2
    s_call_b64 s[20:21], L_tick
    buffer_load_dwordx4 v[64:67], v34, s[12:15], s41 offen sc1
    buffer_load_dwordx4 v[68:71], v44, s[12:15], s41 offen sc1
    s_waitcnt vmcnt(0)
    v_bitop3_b32 v12, v67, v71, s76 bitop3:0x7e
    v_cmp_lt_u32 vcc, 0xffff, v12
    s_cbranch_vccnz L_slow2_1
    s_branch L_back2_1
L_slow6_0:
    s_mov_b32 s22, 6
    s_call_b64 s[20:21], L_tick
    buffer_load_dwordx4 v[88:91], v32, s[12:15], s45 offen sc1
    buffer_load_dwordx4 v[92:95], v33, s[12:15], s45 offen sc1
    s_waitcnt vmcnt(0)
    v_bitop3_b32 v12, v91, v95, s76 bitop3:0x7e
    v_cmp_lt_u32 vcc, 0xffff, v12
    s_cbranch_vccnz L_slow6_0
    s_branch L_back6_0
L_slow6_1:
    s_mov_b32 s22, 6
    s_call_b64 s[20:21], L_tick
    buffer_load_dwordx4 v[48:51], v34, s[12:15], s45 offen sc1
    buffer_load_dwordx4 v[52:55], v44, s[12:15], s45 offen sc1
    s_waitcnt vmcnt(0)
    v_bitop3_b32 v12, v51, v55, s76 bitop3:0x7e
    v_cmp_lt_u32 vcc, 0xffff, v12
    s_cbranch_vccnz L_slow6_1
    s_branch L_back6_1
L_slow3_0:
    s_mov_b32 s22, 3
    s_call_b64 s[20:21], L_tick
    buffer_load_dwordx4 v[72:75], v32, s[12:15], s42 offen sc1
    buffer_load_dwordx4 v[76:79], v33, s[12:15], s42 offen sc1
    s_waitcnt vmcnt(0)
    v_bitop3_b32 v12, v75, v79, s76 bitop3:0x7e
    v_cmp_lt_u32 vcc, 0xffff, v12
    s_cbranch_vccnz L_slow3_0
    s_branch L_back3_0
L_slow3_1:
    s_mov_b32 s22, 3
    s_call_b64 s[20:21], L_tick
    buffer_load_dwordx4 v[100:103], v34, s[12:15], s42 offen sc1
    buffer_load_dwordx4 v[80:83], v44, s[12:15], s42 offen sc1
    s_waitcnt vmcnt(0)
    v_bitop3_b32 v12, v103, v83, s76 bitop3:0x7e
    v_cmp_lt_u32 vcc, 0xffff, v12
    s_cbranch_vccnz L_slow3_1
    s_branch L_back3_1
L_slow7_0:
    s_mov_b32 s22, 7
    s_call_b64 s[20:21], L_tick
    buffer_load_dwordx4 v[68:71], v32, s[12:15], s72 offen sc1
    buffer_load_dwordx4 v[72:75], v33, s[12:15], s72 offen sc1
    s_waitcnt vmcnt(0)
    v_bitop3_b32 v12, v71, v75, s76 bitop3:0x7e
    v_cmp_lt_u32 vcc, 0xffff, v12
    s_cbranch_vccnz L_slow7_0
    s_branch L_back7_0
L_slow7_1:
    s_mov_b32 s22, 7
    s_call_b64 s[20:21], L_tick
    buffer_load_dwordx4 v[76:79], v34, s[12:15], s72 offen sc1
    buffer_load_dwordx4 v[100:103], v44, s[12:15], s72 offen sc1
    s_waitcnt vmcnt(0)
    v_bitop3_b32 v12, v79, v103, s76 bitop3:0x7e
    v_cmp_lt_u32 vcc, 0xffff, v12
    s_cbranch_vccnz L_slow7_1
    s_branch L_back7_1
.p2align 12
L_main:
L_pad0:
    s_cbranch_execz L_pad1
    s_waitcnt lgkmcnt(8)
    v_mfma_f32_16x16x32_bf16 v[128:131], a[32:35], a[0:3], 0
    s_waitcnt lgkmcnt(4)
    s_mov_b32 s40, 16384
    ds_read_b32 a68, v29
    v_mfma_f32_16x16x32_bf16 v[128:131], a[36:39], a[4:7], v[128:131]
    buffer_load_dwordx4 v[80:83], v32, s[12:15], s40 offen sc1
    v_mfma_f32_16x16x32_bf16 v[132:135], a[36:39], a[12:15], 0
    s_add_u32 m0, s57, 65536
    ds_read_b32 a69, v31
    v_perm_b32 v46, v69, v35, s38
    v_mfma_f32_16x16x32_bf16 v[132:135], a[32:35], a[8:11], v[132:135]
    s_add_u32 s56, s55, 256
    ds_read_b32 a70, v46
    v_perm_b32 v56, v69, v35, s39
    v_mfma_f32_16x16x32_bf16 v[136:139], a[32:35], a[16:19], 0
    s_add_u32 s3, s69, 256
    ds_read_b32 a71, v56
    v_mfma_f32_16x16x32_bf16 v[136:139], a[36:39], a[20:23], v[136:139]
    buffer_load_dwordx4 v[84:87], v33, s[12:15], s40 offen sc1
    v_mfma_f32_16x16x32_bf16 v[140:143], a[36:39], a[28:31], 0
    v_perm_b32 v57, v66, v35, s36
    v_perm_b32 v58, v66, v35, s37
    v_mfma_f32_16x16x32_bf16 v[140:143], a[32:35], a[24:27], v[140:143]
    ds_read_b32 a80, v57
    v_perm_b32 v59, v66, v35, s38
    v_mfma_f32_16x16x32_bf16 v[144:147], a[32:35], a[40:43], 0
    ds_read_b32 a81, v58
    v_mfma_f32_16x16x32_bf16 v[144:147], a[36:39], a[44:47], v[144:147]
    buffer_load_dwordx4 v36, s[8:11], s56 offen offset:0  lds
    v_mfma_f32_16x16x32_bf16 v[148:151], a[36:39], a[52:55], 0
    ds_read_b32 a82, v59
    v_perm_b32 v60, v66, v35, s39
    v_mfma_f32_16x16x32_bf16 v[148:151], a[32:35], a[48:51], v[148:151]
    v_perm_b32 v61, v70, v35, s36
    v_perm_b32 v62, v70, v35, s37
    v_mfma_f32_16x16x32_bf16 v[152:155], a[32:35], a[56:59], 0
    s_mov_b32 s41, 32768
    ds_read_b32 a83, v60
    ds_read_b32 a84, v61
    v_mfma_f32_16x16x32_bf16 v[152:155], a[36:39], a[60:63], v[152:155]
    buffer_load_dwordx4 v37, s[8:11], s56 offen offset:1024  lds
    v_mfma_f32_16x16x32_bf16 v[156:159], a[36:39], a[76:79], 0
    ds_read_b32 a85, v62
    v_perm_b32 v63, v70, v35, s38
    v_mfma_f32_16x16x32_bf16 v[156:159], a[32:35], a[72:75], v[156:159]
    s_waitcnt lgkmcnt(6)
    ds_read_b32 a86, v63
    v_perm_b32 v5, v70, v35, s39
    v_mfma_f32_16x16x32_bf16 v[160:163], a[64:67], a[0:3], 0
    ds_read_b32 a87, v5
    v_mfma_f32_16x16x32_bf16 v[160:163], a[68:71], a[4:7], v[160:163]
    buffer_load_dwordx4 v38, s[8:11], s56 offen offset:2048  lds
    v_mfma_f32_16x16x32_bf16 v[164:167], a[68:71], a[12:15], 0
    v_perm_b32 v6, v67, v35, s36
    v_perm_b32 v7, v67, v35, s37
    v_mfma_f32_16x16x32_bf16 v[164:167], a[64:67], a[8:11], v[164:167]
    ds_read_b32 a88, v6
    v_perm_b32 v27, v71, v35, s36
    v_mfma_f32_16x16x32_bf16 v[168:171], a[64:67], a[16:19], 0
    ds_read_b32 a89, v7
    v_mfma_f32_16x16x32_bf16 v[168:171], a[68:71], a[20:23], v[168:171]
    buffer_load_dwordx4 v39, s[8:11], s56 offen offset:3072  lds
    v_mfma_f32_16x16x32_bf16 v[172:175], a[68:71], a[28:31], 0
    s_add_u32 m0, s57, 81920
    ds_read_b32 a90, v27
    v_perm_b32 v29, v71, v35, s37
    v_mfma_f32_16x16x32_bf16 v[172:175], a[64:67], a[24:27], v[172:175]
    s_add_u32 s56, s55, 512
    ds_read_b32 a91, v29
    v_mfma_f32_16x16x32_bf16 v[176:179], a[64:67], a[40:43], 0
    s_waitcnt vmcnt(6)
    s_mov_b32 s42, 49152
    v_bitop3_b32 v31, v75, v79, s76 bitop3:0x7e
    v_mfma_f32_16x16x32_bf16 v[176:179], a[68:71], a[44:47], v[176:179]
    buffer_load_dwordx4 v[88:91], v34, s[12:15], s40 offen sc1
    v_mfma_f32_16x16x32_bf16 v[180:183], a[68:71], a[52:55], 0
    v_cmp_lt_u32 vcc, 0xffff, v31
    v_mfma_f32_16x16x32_bf16 v[180:183], a[64:67], a[48:51], v[180:183]
    v_mfma_f32_16x16x32_bf16 v[184:187], a[64:67], a[56:59], 0
    s_cbranch_vccnz L_slow0_1
L_back0_1:
    v_mfma_f32_16x16x32_bf16 v[184:187], a[68:71], a[60:63], v[184:187]
    buffer_load_dwordx4 v[92:95], v44, s[12:15], s40 offen sc1
    v_mfma_f32_16x16x32_bf16 v[188:191], a[68:71], a[76:79], 0
    v_perm_b32 v46, v72, v35, s36
    v_perm_b32 v56, v72, v35, s37
    v_mfma_f32_16x16x32_bf16 v[188:191], a[64:67], a[72:75], v[188:191]
    s_waitcnt lgkmcnt(1)
    ds_read_b32 a96, v46
    v_perm_b32 v57, v72, v35, s38
    v_mfma_f32_16x16x32_bf16 v[192:195], a[80:83], a[0:3], 0
    s_barrier
    v_mfma_f32_16x16x32_bf16 v[192:195], a[84:87], a[4:7], v[192:195]
    buffer_load_dwordx4 v36, s[8:11], s3 offen offset:0  lds
    v_mfma_f32_16x16x32_bf16 v[196:199], a[84:87], a[12:15], 0
    ds_read_b32 a97, v56
    v_perm_b32 v58, v72, v35, s39
    v_mfma_f32_16x16x32_bf16 v[196:199], a[80:83], a[8:11], v[196:199]
    ds_read_b32 a98, v57
    ds_read_b32 a99, v58
    v_mfma_f32_16x16x32_bf16 v[200:203], a[80:83], a[16:19], 0
    s_mov_b32 s43, 65536
    ds_read_b128 a[104:107], v40 offset:49152
    v_mfma_f32_16x16x32_bf16 v[200:203], a[84:87], a[20:23], v[200:203]
    buffer_load_dwordx4 v37, s[8:11], s3 offen offset:1024  lds
    v_mfma_f32_16x16x32_bf16 v[204:207], a[84:87], a[28:31], 0
    ds_read_b128 a[108:111], v41 offset:49152
    v_perm_b32 v59, v76, v35, s36
    v_mfma_f32_16x16x32_bf16 v[204:207], a[80:83], a[24:27], v[204:207]
    ds_read_b32 a100, v59
    v_perm_b32 v60, v76, v35, s37
    v_mfma_f32_16x16x32_bf16 v[208:211], a[80:83], a[40:43], 0
    ds_read_b32 a101, v60
    ds_read_b128 a[112:115], v40 offset:51200
    v_mfma_f32_16x16x32_bf16 v[208:211], a[84:87], a[44:47], v[208:211]
    buffer_load_dwordx4 v38, s[8:11], s3 offen offset:2048  lds
    v_mfma_f32_16x16x32_bf16 v[212:215], a[84:87], a[52:55], 0
    ds_read_b128 a[116:119], v41 offset:51200
    v_perm_b32 v61, v76, v35, s38
    v_mfma_f32_16x16x32_bf16 v[212:215], a[80:83], a[48:51], v[212:215]
    ds_read_b32 a102, v61
    v_perm_b32 v62, v76, v35, s39
    v_mfma_f32_16x16x32_bf16 v[216:219], a[80:83], a[56:59], 0
    ds_read_b32 a103, v62
    v_perm_b32 v63, v73, v35, s36
    v_mfma_f32_16x16x32_bf16 v[216:219], a[84:87], a[60:63], v[216:219]
    ds_read_b32 a120, v63
    v_perm_b32 v5, v73, v35, s37
    v_mfma_f32_16x16x32_bf16 v[220:223], a[84:87], a[76:79], 0
    ds_read_b128 a[128:131], v40 offset:53248
    ds_read_b32 a121, v5
    v_mfma_f32_16x16x32_bf16 v[220:223], a[80:83], a[72:75], v[220:223]
    s_waitcnt lgkmcnt(9)
    ds_read_b128 a[132:135], v41 offset:53248
    v_mfma_f32_16x16x32_bf16 v[224:227], a[88:91], a[2:5], 0
    buffer_load_dwordx4 v39, s[8:11], s3 offen offset:3072  lds
    v_mfma_f32_16x16x32_bf16 v[228:231], a[88:91], a[10:13], 0
    s_add_u32 m0, s57, 0
    ds_read_b128 a[136:139], v40 offset:55296
    v_perm_b32 v6, v73, v35, s38
    v_mfma_f32_16x16x32_bf16 v[232:235], a[88:91], a[18:21], 0
    s_add_u32 s3, s69, 512
    ds_read_b128 a[140:143], v41 offset:55296
    v_perm_b32 v7, v73, v35, s39
    v_mfma_f32_16x16x32_bf16 v[236:239], a[88:91], a[26:29], 0
    s_mov_b32 s44, 81920
    ds_read_b32 a122, v6
    ds_read_b32 a123, v7
    v_mfma_f32_16x16x32_bf16 v[240:243], a[88:91], a[42:45], 0
    ds_read_b128 a[144:147], v40 offset:57344
    v_mfma_f32_16x16x32_bf16 v[244:247], a[88:91], a[50:53], 0
    buffer_load_dwordx3 v[96:98], v18, s[4:7], s61 offen nt
    v_mfma_f32_16x16x32_bf16 v[248:251], a[88:91], a[58:61], 0
    ds_read_b128 a[148:151], v41 offset:57344
    v_perm_b32 v27, v77, v35, s36
    v_mfma_f32_16x16x32_bf16 v[252:255], a[88:91], a[74:77], 0
    ds_read_b128 a[156:159], v41 offset:59392
    v_perm_b32 v29, v77, v35, s37
    v_mfma_f32_16x16x32_bf16 v[128:131], a[96:99], a[104:107], v[128:131]
    s_waitcnt lgkmcnt(7)
    ds_read_b128 a[152:155], v40 offset:59392
    ds_read_b32 a124, v27
    v_mfma_f32_16x16x32_bf16 v[128:131], a[100:103], a[108:111], v[128:131]
    buffer_load_dword v99, v19, s[4:7], s61 offen nt
    v_mfma_f32_16x16x32_bf16 v[132:135], a[100:103], a[116:119], v[132:135]
    s_add_u32 s61, s61, 14336
    ds_read_b128 a[160:163], v40 offset:61440
    v_perm_b32 v31, v77, v35, s38
    v_mfma_f32_16x16x32_bf16 v[132:135], a[96:99], a[112:115], v[132:135]
    s_waitcnt lgkmcnt(8)
    ds_read_b128 a[164:167], v41 offset:61440
    v_perm_b32 v46, v77, v35, s39
    v_mfma_f32_16x16x32_bf16 v[136:139], a[96:99], a[128:131], v[136:139]
    s_mov_b32 s45, 98304
    ds_read_b32 a125, v29
    ds_read_b32 a126, v31
    v_mfma_f32_16x16x32_bf16 v[136:139], a[100:103], a[132:135], v[136:139]
    buffer_load_dwordx3 v[100:102], v18, s[4:7], s61 offen nt
    v_mfma_f32_16x16x32_bf16 v[140:143], a[100:103], a[140:143], v[140:143]
    s_waitcnt vmcnt(13)
    ds_read_b128 a[168:171], v40 offset:63488
    v_bitop3_b32 v56, v83, v87, s76 bitop3:0x7e
    v_mfma_f32_16x16x32_bf16 v[140:143], a[96:99], a[136:139], v[140:143]
    s_waitcnt lgkmcnt(8)
    ds_read_b128 a[172:175], v41 offset:63488
    ds_read_b32 a127, v46
    v_mfma_f32_16x16x32_bf16 v[144:147], a[96:99], a[144:147], v[144:147]
    s_waitcnt lgkmcnt(8)
    v_perm_b32 v57, v74, v35, s36
    v_mfma_f32_16x16x32_bf16 v[144:147], a[100:103], a[148:151], v[144:147]
    buffer_load_dword v103, v19, s[4:7], s61 offen nt
    v_mfma_f32_16x16x32_bf16 v[148:151], a[100:103], a[156:159], v[148:151]
    s_add_u32 s61, s61, 14336
    ds_read_b32 a176, v57
    v_perm_b32 v58, v74, v35, s37
    v_mfma_f32_16x16x32_bf16 v[148:151], a[96:99], a[152:155], v[148:151]
    s_waitcnt lgkmcnt(7)
    v_cmp_lt_u32 vcc, 0xffff, v56
    v_perm_b32 v59, v74, v35, s38
    v_mfma_f32_16x16x32_bf16 v[152:155], a[96:99], a[160:163], v[152:155]
    s_waitcnt lgkmcnt(6)
    ds_read_b32 a177, v58
    ds_read_b32 a178, v59
    v_mfma_f32_16x16x32_bf16 v[152:155], a[100:103], a[164:167], v[152:155]
    s_waitcnt lgkmcnt(4)
    buffer_load_dwordx3 v[104:106], v18, s[4:7], s61 offen nt
    v_mfma_f32_16x16x32_bf16 v[156:159], a[100:103], a[172:175], v[156:159]
    v_perm_b32 v60, v74, v35, s39
    s_cbranch_vccnz L_slow1_0
L_back1_0:
    v_mfma_f32_16x16x32_bf16 v[156:159], a[96:99], a[168:171], v[156:159]
    s_waitcnt lgkmcnt(3)
    v_perm_b32 v61, v78, v35, s36
    v_perm_b32 v62, v78, v35, s37
    v_mfma_f32_16x16x32_bf16 v[160:163], a[120:123], a[104:107], v[160:163]
    s_mov_b32 s72, 114688
    ds_read_b32 a179, v60
    ds_read_b32 a180, v61
    v_mfma_f32_16x16x32_bf16 v[160:163], a[124:127], a[108:111], v[160:163]
    buffer_load_dword v107, v19, s[4:7], s61 offen nt
    v_mfma_f32_16x16x32_bf16 v[164:167], a[124:127], a[116:119], v[164:167]
    s_add_u32 s61, s61, 14336
    ds_read_b32 a181, v62
    v_perm_b32 v63, v78, v35, s38
    v_mfma_f32_16x16x32_bf16 v[164:167], a[120:123], a[112:115], v[164:167]
    v_perm_b32 v5, v78, v35, s39
    v_perm_b32 v6, v75, v35, s36
    v_mfma_f32_16x16x32_bf16 v[168:171], a[120:123], a[128:131], v[168:171]
    ds_read_b32 a182, v63
    ds_read_b32 a183, v5
    v_mfma_f32_16x16x32_bf16 v[168:171], a[124:127], a[132:135], v[168:171]
    buffer_load_dwordx3 v[108:110], v18, s[4:7], s61 offen nt
    v_mfma_f32_16x16x32_bf16 v[172:175], a[124:127], a[140:143], v[172:175]
    ds_read_b32 a92, v6
    v_perm_b32 v7, v75, v35, s37
    v_mfma_f32_16x16x32_bf16 v[172:175], a[120:123], a[136:139], v[172:175]
    v_perm_b32 v27, v79, v35, s36
    v_perm_b32 v29, v79, v35, s37
    v_mfma_f32_16x16x32_bf16 v[176:179], a[120:123], a[144:147], v[176:179]
    ds_read_b32 a93, v7
    ds_read_b32 a94, v27
    v_mfma_f32_16x16x32_bf16 v[176:179], a[124:127], a[148:151], v[176:179]
    buffer_load_dword v111, v19, s[4:7], s61 offen nt
    v_mfma_f32_16x16x32_bf16 v[180:183], a[124:127], a[156:159], v[180:183]
    s_add_u32 s61, s61, 14336
    ds_read_b32 a95, v29
    v_perm_b32 v31, v80, v35, s36
    v_mfma_f32_16x16x32_bf16 v[180:183], a[120:123], a[152:155], v[180:183]
    v_perm_b32 v46, v80, v35, s37
    v_perm_b32 v57, v80, v35, s38
    v_mfma_f32_16x16x32_bf16 v[184:187], a[120:123], a[160:163], v[184:187]
    ds_read_b32 a184, v31
    ds_read_b32 a185, v46
    v_mfma_f32_16x16x32_bf16 v[184:187], a[124:127], a[164:167], v[184:187]
    buffer_load_dwordx3 v[112:114], v18, s[4:7], s61 offen nt
    v_mfma_f32_16x16x32_bf16 v[188:191], a[124:127], a[172:175], v[188:191]
    s_mul_i32 s66, s63, 96
    s_lshl_b32 s67, s65, 5
    s_lshl_b32 s70, s64, 2
    s_add_u32 s67, s67, s70
    s_add_u32 s67, s67, 384
    s_mul_i32 s71, s59, 448
    s_add_u32 s70, s66, s71
    v_mad_u32_u24 v22, v3, 24, s70
    s_add_u32 s70, s67, s71
    v_lshl_add_u32 v23, v3, 3, s70
    s_mov_b32 s34, 7168
    s_mov_b32 s35, 0x20000
    s_mov_b32 s26, 256
    s_mov_b32 s27, 0x20000
    s_lshl_b32 s77, s59, 4
    s_mov_b32 s18, 14680064
    s_mov_b32 s19, 0x20000
    s_sub_u32 s70, 1024, s71
    v_mul_u32_u24 v16, 464, v4
    v_add3_u32 v26, v22, v16, s70
    v_add3_u32 v28, v23, v16, s70
    s_lshl_b32 s70, s63, 9
    s_add_u32 s60, s70, 52992
    s_xor_b32 s70, s70, 512
    s_add_u32 s70, s70, 52992
    v_lshl_add_u32 v30, v2, 2, s70
    v_mul_u32_u24 v16, 2341, v2
    v_lshrrev_b32 v16, 16, v16
    s_mul_i32 s73, s63, 1856
    s_add_u32 s73, s73, 1024
    v_add_lshl_u32 v24, v2, v16, 4
    v_add_u32 v24, s73, v24
    s_lshl_b32 s74, s58, 7
    s_lshl_b32 s75, s63, 2
    s_add_u32 s74, s74, s75
    s_mul_i32 s74, s74, 7168
    s_add_u32 s74, s74, s71
    v_mul_u32_u24 v17, 6720, v16
    v_lshl_add_u32 v25, v2, 4, v17
    v_lshrrev_b32 v16, 1, v16
    v_lshlrev_b32 v16, 30, v16
    v_add3_u32 v25, v25, v16, s74
    v_mov_b32 v45, 1
    v_lshlrev_b32 v1, 22, v0
    v_mov_b32 v47, s76
    v_mfma_f32_16x16x32_bf16 v[188:191], a[120:123], a[168:171], v[188:191]
    s_waitcnt vmcnt(15) lgkmcnt(5)
    s_add_u32 s61, s61, 14336
    ds_read_b32 a186, v57
    v_perm_b32 v56, v80, v35, s39
    v_mfma_f32_16x16x32_bf16 v[192:195], a[176:179], a[104:107], v[192:195]
    s_barrier
    v_mfma_f32_16x16x32_bf16 v[192:195], a[180:183], a[108:111], v[192:195]
    buffer_load_dwordx3 v[116:118], v18, s[4:7], s61 offen nt
    v_mfma_f32_16x16x32_bf16 v[196:199], a[180:183], a[116:119], v[196:199]
    s_add_u32 s61, s61, 14336
    ds_read_b32 a187, v56
    v_perm_b32 v58, v84, v35, s36
    v_mfma_f32_16x16x32_bf16 v[196:199], a[176:179], a[112:115], v[196:199]
    ds_read_b32 a188, v58
    ds_read_b128 a[192:195], v42 offset:0
    v_mfma_f32_16x16x32_bf16 v[200:203], a[176:179], a[128:131], v[200:203]
    ds_read_b128 a[196:199], v43 offset:0
    v_mfma_f32_16x16x32_bf16 v[200:203], a[180:183], a[132:135], v[200:203]
    buffer_load_dwordx3 v[120:122], v18, s[4:7], s61 offen nt
    v_mfma_f32_16x16x32_bf16 v[204:207], a[180:183], a[140:143], v[204:207]
    s_add_u32 s61, s61, 14336
    ds_read_b128 a[204:207], v43 offset:2048
    v_perm_b32 v59, v84, v35, s37
    v_mfma_f32_16x16x32_bf16 v[204:207], a[176:179], a[136:139], v[204:207]
    ds_read_b32 a189, v59
    ds_read_b128 a[200:203], v42 offset:2048
    v_perm_b32 v60, v84, v35, s38
    v_mfma_f32_16x16x32_bf16 v[208:211], a[176:179], a[144:147], v[208:211]
    ds_read_b32 a190, v60
    ds_read_b128 a[208:211], v42 offset:4096
    v_mfma_f32_16x16x32_bf16 v[208:211], a[180:183], a[148:151], v[208:211]
    buffer_load_dwordx3 v[124:126], v18, s[4:7], s61 offen nt
    v_mfma_f32_16x16x32_bf16 v[212:215], a[180:183], a[156:159], v[212:215]
    ds_read_b128 a[212:215], v43 offset:4096
    v_perm_b32 v61, v84, v35, s39
    v_mfma_f32_16x16x32_bf16 v[212:215], a[176:179], a[152:155], v[212:215]
    ds_read_b32 a191, v61
    ds_read_b128 a[220:223], v43 offset:6144
    v_mfma_f32_16x16x32_bf16 v[216:219], a[176:179], a[160:163], v[216:219]
    ds_read_b128 a[216:219], v42 offset:6144
    v_perm_b32 v62, v81, v35, s36
    v_mfma_f32_16x16x32_bf16 v[216:219], a[180:183], a[164:167], v[216:219]
    ds_read_b128 a[224:227], v42 offset:8192
    ds_read_b32 a232, v62
    v_mfma_f32_16x16x32_bf16 v[220:223], a[180:183], a[172:175], v[220:223]
    buffer_load_dwordx4 v[48:51], v32, s[12:15], s41 offen sc1
    v_mfma_f32_16x16x32_bf16 v[220:223], a[176:179], a[168:171], v[220:223]
    s_waitcnt lgkmcnt(10)
    ds_read_b128 a[228:231], v43 offset:8192
    v_perm_b32 v63, v81, v35, s37
    v_mfma_f32_16x16x32_bf16 v[224:227], a[92:95], a[106:109], v[224:227]
    ds_read_b128 a[244:247], v43 offset:10240
    ds_read_b32 a233, v63
    v_mfma_f32_16x16x32_bf16 v[228:231], a[92:95], a[114:117], v[228:231]
    ds_read_b128 a[240:243], v42 offset:10240
    v_perm_b32 v5, v81, v35, s38
    v_mfma_f32_16x16x32_bf16 v[232:235], a[92:95], a[130:133], v[232:235]
    ds_read_b128 a[248:251], v42 offset:12288
    ds_read_b32 a234, v5
    v_mfma_f32_16x16x32_bf16 v[236:239], a[92:95], a[138:141], v[236:239]
    buffer_load_dwordx4 v[52:55], v33, s[12:15], s41 offen sc1
    v_mfma_f32_16x16x32_bf16 v[240:243], a[92:95], a[146:149], v[240:243]
    v_perm_b32 v6, v81, v35, s39
    v_perm_b32 v7, v85, v35, s36
    v_mfma_f32_16x16x32_bf16 v[244:247], a[92:95], a[154:157], v[244:247]
    s_waitcnt vmcnt(10)
    ds_read_b128 a[252:255], v43 offset:12288
    ds_read_b32 a235, v6
    v_mfma_f32_16x16x32_bf16 v[248:251], a[92:95], a[162:165], v[248:251]
    v_or_b32 v99, s47, v99
    v_lshl_or_b32 v96, v100, 4, v96
    v_lshl_or_b32 v97, v101, 4, v97
    v_lshl_or_b32 v98, v102, 4, v98
    v_lshl_or_b32 v99, v103, 4, v99
    v_mfma_f32_16x16x32_bf16 v[252:255], a[92:95], a[170:173], v[252:255]
    buffer_load_dwordx4 v36, s[8:11], s56 offen offset:0  lds
    v_mfma_f32_16x16x32_bf16 v[128:131], a[184:187], a[192:195], v[128:131]
    s_waitcnt lgkmcnt(7)
    ds_read_b32 a236, v7
    v_perm_b32 v27, v85, v35, s37
    v_mfma_f32_16x16x32_bf16 v[128:131], a[188:191], a[196:199], v[128:131]
    ds_read_b128 a[32:35], v42 offset:14336
    v_perm_b32 v31, v85, v35, s38
    v_bitop3_b32 v29, v91, v95, s76 bitop3:0x7e
    v_mfma_f32_16x16x32_bf16 v[132:135], a[188:191], a[204:207], v[132:135]
    ds_read_b128 a[36:39], v43 offset:14336
    v_perm_b32 v46, v85, v35, s39
    v_cmp_lt_u32 vcc, 0xffff, v29
    v_mfma_f32_16x16x32_bf16 v[132:135], a[184:187], a[200:203], v[132:135]
    ds_read_b32 a237, v27
    v_perm_b32 v57, v82, v35, s36
    v_mfma_f32_16x16x32_bf16 v[136:139], a[184:187], a[208:211], v[136:139]
    ds_read_b32 a238, v31
    v_perm_b32 v56, v82, v35, s37
    v_mfma_f32_16x16x32_bf16 v[136:139], a[188:191], a[212:215], v[136:139]
    ds_read_b32 a239, v46
    v_perm_b32 v58, v82, v35, s38
    v_mfma_f32_16x16x32_bf16 v[140:143], a[188:191], a[220:223], v[140:143]
    ds_read_b32 a64, v57
    v_perm_b32 v59, v82, v35, s39
    v_mfma_f32_16x16x32_bf16 v[140:143], a[184:187], a[216:219], v[140:143]
    ds_read_b32 a65, v56
    v_perm_b32 v60, v86, v35, s36
    v_mfma_f32_16x16x32_bf16 v[144:147], a[184:187], a[224:227], v[144:147]
    s_waitcnt lgkmcnt(8)
    ds_read_b32 a66, v58
    ds_read_b32 a67, v59
    v_mfma_f32_16x16x32_bf16 v[144:147], a[188:191], a[228:231], v[144:147]
    buffer_load_dwordx4 v37, s[8:11], s56 offen offset:1024  lds
    v_mfma_f32_16x16x32_bf16 v[148:151], a[188:191], a[244:247], v[148:151]
    ds_read_b32 a68, v60
    s_cbranch_vccnz L_slow1_1
L_back1_1:
    v_mfma_f32_16x16x32_bf16 v[148:151], a[184:187], a[240:243], v[148:151]
    v_perm_b32 v61, v86, v35, s37
    v_perm_b32 v62, v86, v35, s38
    v_mfma_f32_16x16x32_bf16 v[152:155], a[184:187], a[248:251], v[152:155]
    s_waitcnt lgkmcnt(7)
    ds_read_b32 a69, v61
    ds_read_b32 a70, v62
    v_mfma_f32_16x16x32_bf16 v[152:155], a[188:191], a[252:255], v[152:155]
    buffer_load_dwordx4 v38, s[8:11], s56 offen offset:2048  lds
    v_mfma_f32_16x16x32_bf16 v[156:159], a[188:191], a[36:39], v[156:159]
    v_perm_b32 v63, v86, v35, s39
    v_perm_b32 v5, v83, v35, s36
    v_mfma_f32_16x16x32_bf16 v[156:159], a[184:187], a[32:35], v[156:159]
    ds_read_b32 a71, v63
    v_perm_b32 v6, v83, v35, s37
    v_mfma_f32_16x16x32_bf16 v[160:163], a[232:235], a[192:195], v[160:163]
    s_waitcnt lgkmcnt(6)
    ds_read_b32 a80, v5
    ds_read_b32 a81, v6
    v_mfma_f32_16x16x32_bf16 v[160:163], a[236:239], a[196:199], v[160:163]
    buffer_load_dwordx4 v39, s[8:11], s56 offen offset:3072  lds
    v_mfma_f32_16x16x32_bf16 v[164:167], a[236:239], a[204:207], v[164:167]
    s_add_u32 m0, s57, 16384
    v_perm_b32 v7, v87, v35, s36
    v_perm_b32 v29, v87, v35, s37
    v_mfma_f32_16x16x32_bf16 v[164:167], a[232:235], a[200:203], v[164:167]
    s_add_u32 s56, s55, 768
    ds_read_b32 a82, v7
    v_perm_b32 v27, v88, v35, s36
    v_mfma_f32_16x16x32_bf16 v[168:171], a[232:235], a[208:211], v[168:171]
    ds_read_b32 a83, v29
    v_perm_b32 v31, v88, v35, s37
    v_mfma_f32_16x16x32_bf16 v[168:171], a[236:239], a[212:215], v[168:171]
    ds_read_b32 a0, v27
    v_perm_b32 v46, v88, v35, s38
    v_mfma_f32_16x16x32_bf16 v[172:175], a[236:239], a[220:223], v[172:175]
    ds_read_b32 a1, v31
    v_perm_b32 v57, v88, v35, s39
    v_mfma_f32_16x16x32_bf16 v[172:175], a[232:235], a[216:219], v[172:175]
    ds_read_b32 a2, v46
    v_perm_b32 v56, v92, v35, s36
    v_mfma_f32_16x16x32_bf16 v[176:179], a[232:235], a[224:227], v[176:179]
    ds_read_b32 a3, v57
    ds_read_b32 a4, v56
    v_mfma_f32_16x16x32_bf16 v[176:179], a[236:239], a[228:231], v[176:179]
    buffer_load_dwordx4 v[64:67], v34, s[12:15], s41 offen sc1
    v_mfma_f32_16x16x32_bf16 v[180:183], a[236:239], a[244:247], v[180:183]
    v_perm_b32 v58, v92, v35, s37
    v_perm_b32 v59, v92, v35, s38
    v_mfma_f32_16x16x32_bf16 v[180:183], a[232:235], a[240:243], v[180:183]
    ds_read_b32 a5, v58
    v_perm_b32 v60, v92, v35, s39
    v_mfma_f32_16x16x32_bf16 v[184:187], a[232:235], a[248:251], v[184:187]
    ds_read_b32 a6, v59
    ds_read_b32 a7, v60
    v_mfma_f32_16x16x32_bf16 v[184:187], a[236:239], a[252:255], v[184:187]
    buffer_load_dwordx4 v[68:71], v44, s[12:15], s41 offen sc1
    v_mfma_f32_16x16x32_bf16 v[188:191], a[236:239], a[36:39], v[188:191]
    v_perm_b32 v61, v89, v35, s36
    v_perm_b32 v62, v89, v35, s37
    v_mfma_f32_16x16x32_bf16 v[188:191], a[232:235], a[32:35], v[188:191]
    s_waitcnt lgkmcnt(6)
    ds_read_b32 a8, v61
    v_perm_b32 v63, v89, v35, s38
    v_mfma_f32_16x16x32_bf16 v[192:195], a[64:67], a[192:195], v[192:195]
    s_barrier
    v_mfma_f32_16x16x32_bf16 v[192:195], a[68:71], a[196:199], v[192:195]
    buffer_load_dwordx4 v[72:75], v32, s[12:15], s42 offen sc1
    v_mfma_f32_16x16x32_bf16 v[196:199], a[68:71], a[204:207], v[196:199]
    ds_read_b32 a9, v62
    v_perm_b32 v5, v89, v35, s39
    v_mfma_f32_16x16x32_bf16 v[196:199], a[64:67], a[200:203], v[196:199]
    ds_read_b32 a10, v63
    ds_read_b32 a11, v5
    v_mfma_f32_16x16x32_bf16 v[200:203], a[64:67], a[208:211], v[200:203]
    ds_read_b128 a[16:19], v42 offset:16384
    v_mfma_f32_16x16x32_bf16 v[200:203], a[68:71], a[212:215], v[200:203]
    buffer_load_dwordx4 v[76:79], v33, s[12:15], s42 offen sc1
    v_mfma_f32_16x16x32_bf16 v[204:207], a[68:71], a[220:223], v[204:207]
    ds_read_b128 a[20:23], v43 offset:16384
    v_perm_b32 v6, v93, v35, s36
    v_mfma_f32_16x16x32_bf16 v[204:207], a[64:67], a[216:219], v[204:207]
    ds_read_b32 a12, v6
    v_perm_b32 v7, v93, v35, s37
    v_mfma_f32_16x16x32_bf16 v[208:211], a[64:67], a[224:227], v[208:211]
    ds_read_b32 a13, v7
    v_perm_b32 v29, v93, v35, s38
    v_mfma_f32_16x16x32_bf16 v[208:211], a[68:71], a[228:231], v[208:211]
    ds_read_b32 a14, v29
    ds_read_b128 a[24:27], v42 offset:18432
    v_mfma_f32_16x16x32_bf16 v[212:215], a[68:71], a[244:247], v[212:215]
    buffer_load_dwordx4 v36, s[8:11], s3 offen offset:0  lds
    v_mfma_f32_16x16x32_bf16 v[212:215], a[64:67], a[240:243], v[212:215]
    ds_read_b128 a[28:31], v43 offset:18432
    v_perm_b32 v27, v93, v35, s39
    v_mfma_f32_16x16x32_bf16 v[216:219], a[64:67], a[248:251], v[216:219]
    ds_read_b32 a15, v27
    v_perm_b32 v31, v90, v35, s36
    v_mfma_f32_16x16x32_bf16 v[216:219], a[68:71], a[252:255], v[216:219]
    s_waitcnt vmcnt(16)
    ds_read_b32 a48, v31
    ds_read_b128 a[40:43], v42 offset:20480
    v_mfma_f32_16x16x32_bf16 v[220:223], a[68:71], a[36:39], v[220:223]
    buffer_load_dwordx4 v37, s[8:11], s3 offen offset:1024  lds
    v_mfma_f32_16x16x32_bf16 v[220:223], a[64:67], a[32:35], v[220:223]
    v_lshl_or_b32 v96, v104, 8, v96
    v_lshl_or_b32 v97, v105, 8, v97
    v_lshl_or_b32 v98, v106, 8, v98
    v_lshl_or_b32 v99, v107, 8, v99
    v_lshl_or_b32 v96, v108, 12, v96
    v_lshl_or_b32 v97, v109, 12, v97
    v_lshl_or_b32 v98, v110, 12, v98
    s_waitcnt vmcnt(16)
    v_lshl_or_b32 v99, v111, 12, v99
    s_waitcnt vmcnt(15)
    v_lshl_or_b32 v96, v112, 16, v96
    v_lshl_or_b32 v97, v113, 16, v97
    v_lshl_or_b32 v98, v114, 16, v98
    s_waitcnt vmcnt(14)
    v_lshl_or_b32 v96, v116, 20, v96
    v_lshl_or_b32 v97, v117, 20, v97
    v_lshl_or_b32 v98, v118, 20, v98
    s_waitcnt vmcnt(13)
    v_lshl_or_b32 v96, v120, 24, v96
    v_lshl_or_b32 v97, v121, 24, v97
    v_lshl_or_b32 v98, v122, 24, v98
L_pad1:
    s_cbranch_execz L_pad2
    s_waitcnt vmcnt(12)
    v_lshl_or_b32 v96, v124, 28, v96
    v_lshl_or_b32 v97, v125, 28, v97
    v_lshl_or_b32 v98, v126, 28, v98
    buffer_store_dwordx4 v[96:99], v20, s[12:15], s62 offen sc1
    v_mfma_f32_16x16x32_bf16 v[224:227], a[80:83], a[194:197], v[224:227]
    s_waitcnt vmcnt(11)
    ds_read_b128 a[44:47], v43 offset:20480
    v_perm_b32 v57, v90, v35, s37
    v_bitop3_b32 v46, v51, v55, s76 bitop3:0x7e
    v_mfma_f32_16x16x32_bf16 v[228:231], a[80:83], a[202:205], v[228:231]
    ds_read_b32 a49, v57
    v_perm_b32 v56, v90, v35, s38
    v_cmp_lt_u32 vcc, 0xffff, v46
    v_mfma_f32_16x16x32_bf16 v[232:235], a[80:83], a[210:213], v[232:235]
    ds_read_b128 a[60:63], v43 offset:22528
    ds_read_b32 a50, v56
    v_mfma_f32_16x16x32_bf16 v[236:239], a[80:83], a[218:221], v[236:239]
    buffer_load_dwordx4 v38, s[8:11], s3 offen offset:2048  lds
    v_mfma_f32_16x16x32_bf16 v[240:243], a[80:83], a[226:229], v[240:243]
    ds_read_b128 a[56:59], v42 offset:22528
    s_cbranch_vccnz L_slow2_0
L_back2_0:
    v_mfma_f32_16x16x32_bf16 v[244:247], a[80:83], a[242:245], v[244:247]
    ds_read_b128 a[72:75], v42 offset:24576
    v_perm_b32 v58, v90, v35, s39
    v_mfma_f32_16x16x32_bf16 v[248:251], a[80:83], a[250:253], v[248:251]
    s_waitcnt lgkmcnt(6)
    ds_read_b128 a[76:79], v43 offset:24576
    ds_read_b32 a51, v58
    v_mfma_f32_16x16x32_bf16 v[252:255], a[80:83], a[34:37], v[252:255]
    buffer_load_dwordx4 v39, s[8:11], s3 offen offset:3072  lds
    v_mfma_f32_16x16x32_bf16 v[128:131], a[0:3], a[16:19], v[128:131]
    s_add_u32 m0, s57, 32768
    ds_read_b128 a[100:103], v43 offset:26624
    v_perm_b32 v59, v94, v35, s36
    v_mfma_f32_16x16x32_bf16 v[128:131], a[4:7], a[20:23], v[128:131]
    s_add_u32 s3, s69, 768
    ds_read_b128 a[96:99], v42 offset:26624
    v_perm_b32 v60, v94, v35, s37
    v_mfma_f32_16x16x32_bf16 v[132:135], a[4:7], a[28:31], v[132:135]
    ds_read_b128 a[120:123], v42 offset:28672
    ds_read_b32 a52, v59
    v_mfma_f32_16x16x32_bf16 v[132:135], a[0:3], a[24:27], v[132:135]
    buffer_load_dwordx4 v36, s[8:11], s56 offen offset:0  lds
    v_mfma_f32_16x16x32_bf16 v[136:139], a[0:3], a[40:43], v[136:139]
    s_waitcnt lgkmcnt(8)
    ds_read_b128 a[124:127], v43 offset:28672
    v_perm_b32 v61, v94, v35, s38
    v_mfma_f32_16x16x32_bf16 v[136:139], a[4:7], a[44:47], v[136:139]
    ds_read_b128 a[176:179], v42 offset:30720
    v_perm_b32 v62, v94, v35, s39
    v_mfma_f32_16x16x32_bf16 v[140:143], a[4:7], a[60:63], v[140:143]
    s_waitcnt lgkmcnt(8)
    ds_read_b32 a53, v60
    v_perm_b32 v63, v91, v35, s36
    v_mfma_f32_16x16x32_bf16 v[140:143], a[0:3], a[56:59], v[140:143]
    s_waitcnt lgkmcnt(7)
    ds_read_b128 a[180:183], v43 offset:30720
    ds_read_b32 a54, v61
    v_mfma_f32_16x16x32_bf16 v[144:147], a[0:3], a[72:75], v[144:147]
    buffer_load_dwordx4 v37, s[8:11], s56 offen offset:1024  lds
    v_mfma_f32_16x16x32_bf16 v[144:147], a[4:7], a[76:79], v[144:147]
    s_waitcnt lgkmcnt(8)
    ds_read_b32 a55, v62
    v_perm_b32 v5, v91, v35, s37
    v_mfma_f32_16x16x32_bf16 v[148:151], a[4:7], a[100:103], v[148:151]
    s_waitcnt lgkmcnt(8)
    ds_read_b32 a84, v63
    v_perm_b32 v6, v95, v35, s36
    v_mfma_f32_16x16x32_bf16 v[148:151], a[0:3], a[96:99], v[148:151]
    s_waitcnt lgkmcnt(7)
    ds_read_b32 a85, v5
    v_perm_b32 v7, v95, v35, s37
    v_mfma_f32_16x16x32_bf16 v[152:155], a[0:3], a[120:123], v[152:155]
    s_waitcnt lgkmcnt(7)
    ds_read_b32 a86, v6
    v_perm_b32 v29, v48, v35, s36
    v_mfma_f32_16x16x32_bf16 v[152:155], a[4:7], a[124:127], v[152:155]
    s_waitcnt lgkmcnt(5)
    ds_read_b32 a87, v7
    v_perm_b32 v27, v48, v35, s37
    v_mfma_f32_16x16x32_bf16 v[156:159], a[4:7], a[180:183], v[156:159]
    ds_read_b32 a104, v29
    v_perm_b32 v31, v48, v35, s38
    v_mfma_f32_16x16x32_bf16 v[156:159], a[0:3], a[176:179], v[156:159]
    s_waitcnt vmcnt(11)
    ds_read_b32 a105, v27
    v_perm_b32 v46, v48, v35, s39
    v_mfma_f32_16x16x32_bf16 v[160:163], a[8:11], a[16:19], v[160:163]
    s_barrier
    v_mfma_f32_16x16x32_bf16 v[160:163], a[12:15], a[20:23], v[160:163]
    buffer_load_dwordx4 v38, s[8:11], s56 offen offset:2048  lds
    v_mfma_f32_16x16x32_bf16 v[164:167], a[12:15], a[28:31], v[164:167]
    ds_read_b32 a106, v31
    v_perm_b32 v57, v52, v35, s36
    v_mfma_f32_16x16x32_bf16 v[164:167], a[8:11], a[24:27], v[164:167]
    ds_read_b32 a107, v46
    ds_read_b32 a108, v57
    v_mfma_f32_16x16x32_bf16 v[168:171], a[8:11], a[40:43], v[168:171]
    v_perm_b32 v56, v52, v35, s37
    v_perm_b32 v58, v52, v35, s38
    v_mfma_f32_16x16x32_bf16 v[168:171], a[12:15], a[44:47], v[168:171]
    ds_read_b32 a109, v56
    ds_read_b128 a[112:115], v40 offset:0
    v_mfma_f32_16x16x32_bf16 v[172:175], a[12:15], a[60:63], v[172:175]
    buffer_load_dwordx4 v39, s[8:11], s56 offen offset:3072  lds
    v_mfma_f32_16x16x32_bf16 v[172:175], a[8:11], a[56:59], v[172:175]
    s_add_u32 m0, s57, 49152
    ds_read_b32 a110, v58
    v_perm_b32 v59, v52, v35, s39
    v_mfma_f32_16x16x32_bf16 v[176:179], a[8:11], a[72:75], v[176:179]
    s_add_u32 s56, s55, 1024
    ds_read_b128 a[116:119], v41 offset:0
    ds_read_b32 a111, v59
    v_mfma_f32_16x16x32_bf16 v[176:179], a[12:15], a[76:79], v[176:179]
    ds_read_b128 a[132:135], v41 offset:2048
    v_mfma_f32_16x16x32_bf16 v[180:183], a[12:15], a[100:103], v[180:183]
    buffer_load_dwordx4 v36, s[8:11], s3 offen offset:0  lds
    v_mfma_f32_16x16x32_bf16 v[180:183], a[8:11], a[96:99], v[180:183]
    ds_read_b128 a[128:131], v40 offset:2048
    v_perm_b32 v60, v49, v35, s36
    v_mfma_f32_16x16x32_bf16 v[184:187], a[8:11], a[120:123], v[184:187]
    ds_read_b128 a[136:139], v40 offset:4096
    v_perm_b32 v61, v49, v35, s37
    v_mfma_f32_16x16x32_bf16 v[184:187], a[12:15], a[124:127], v[184:187]
    s_waitcnt vmcnt(12) lgkmcnt(8)
    ds_read_b128 a[140:143], v41 offset:4096
    ds_read_b32 a144, v60
    v_mfma_f32_16x16x32_bf16 v[188:191], a[12:15], a[180:183], v[188:191]
    buffer_load_dwordx4 v37, s[8:11], s3 offen offset:1024  lds
    v_mfma_f32_16x16x32_bf16 v[188:191], a[8:11], a[176:179], v[188:191]
    ds_read_b32 a145, v61
    v_perm_b32 v63, v49, v35, s38
    v_bitop3_b32 v62, v67, v71, s76 bitop3:0x7e
    v_mfma_f32_16x16x32_bf16 v[192:195], a[48:51], a[16:19], v[192:195]
    ds_read_b128 a[152:155], v40 offset:6144
    v_perm_b32 v5, v49, v35, s39
    v_cmp_lt_u32 vcc, 0xffff, v62
    v_mfma_f32_16x16x32_bf16 v[192:195], a[52:55], a[20:23], v[192:195]
    ds_read_b32 a146, v63
    v_perm_b32 v6, v53, v35, s36
    v_mfma_f32_16x16x32_bf16 v[196:199], a[52:55], a[28:31], v[196:199]
    ds_read_b32 a147, v5
    s_cbranch_vccnz L_slow2_1
L_back2_1:
    v_mfma_f32_16x16x32_bf16 v[196:199], a[48:51], a[24:27], v[196:199]
    ds_read_b128 a[156:159], v41 offset:6144
    ds_read_b32 a148, v6
    v_perm_b32 v7, v53, v35, s37
    v_mfma_f32_16x16x32_bf16 v[200:203], a[48:51], a[40:43], v[200:203]
    ds_read_b32 a149, v7
    v_perm_b32 v29, v53, v35, s38
    v_mfma_f32_16x16x32_bf16 v[200:203], a[52:55], a[44:47], v[200:203]
    ds_read_b32 a150, v29
    ds_read_b128 a[160:163], v40 offset:8192
    v_mfma_f32_16x16x32_bf16 v[204:207], a[52:55], a[60:63], v[204:207]
    buffer_load_dwordx4 v38, s[8:11], s3 offen offset:2048  lds
    v_mfma_f32_16x16x32_bf16 v[204:207], a[48:51], a[56:59], v[204:207]
    v_perm_b32 v27, v53, v35, s39
    v_perm_b32 v31, v50, v35, s36
    v_mfma_f32_16x16x32_bf16 v[208:211], a[48:51], a[72:75], v[208:211]
    ds_read_b32 a151, v27
    v_perm_b32 v46, v50, v35, s37
    v_mfma_f32_16x16x32_bf16 v[208:211], a[52:55], a[76:79], v[208:211]
    ds_read_b128 a[164:167], v41 offset:8192
    v_perm_b32 v57, v50, v35, s38
    v_mfma_f32_16x16x32_bf16 v[212:215], a[52:55], a[100:103], v[212:215]
    v_perm_b32 v56, v50, v35, s39
    v_perm_b32 v58, v54, v35, s36
    v_mfma_f32_16x16x32_bf16 v[212:215], a[48:51], a[96:99], v[212:215]
    v_perm_b32 v59, v54, v35, s37
    v_perm_b32 v60, v54, v35, s38
    v_mfma_f32_16x16x32_bf16 v[216:219], a[48:51], a[120:123], v[216:219]
    ds_read_b128 a[88:91], v40 offset:10240
    ds_read_b32 a168, v31
    v_mfma_f32_16x16x32_bf16 v[216:219], a[52:55], a[124:127], v[216:219]
    buffer_load_dwordx4 v39, s[8:11], s3 offen offset:3072  lds
    v_mfma_f32_16x16x32_bf16 v[220:223], a[52:55], a[180:183], v[220:223]
    s_add_u32 m0, s57, 65536
    ds_read_b32 a169, v46
    v_perm_b32 v61, v54, v35, s39
    v_mfma_f32_16x16x32_bf16 v[220:223], a[48:51], a[176:179], v[220:223]
    s_add_u32 s3, s69, 1024
    ds_read_b128 a[92:95], v41 offset:10240
    ds_read_b32 a170, v57
    v_mfma_f32_16x16x32_bf16 v[224:227], a[84:87], a[18:21], v[224:227]
    ds_read_b32 a171, v56
    v_perm_b32 v62, v51, v35, s36
    v_mfma_f32_16x16x32_bf16 v[228:231], a[84:87], a[26:29], v[228:231]
    ds_read_b32 a172, v58
    ds_read_b32 a173, v59
    v_mfma_f32_16x16x32_bf16 v[232:235], a[84:87], a[42:45], v[232:235]
    buffer_load_dwordx4 v[100:103], v34, s[12:15], s42 offen sc1
    v_mfma_f32_16x16x32_bf16 v[236:239], a[84:87], a[58:61], v[236:239]
    ds_read_b128 a[184:187], v40 offset:12288
    ds_read_b32 a174, v60
    v_mfma_f32_16x16x32_bf16 v[240:243], a[84:87], a[74:77], v[240:243]
    ds_read_b32 a175, v61
    v_perm_b32 v63, v51, v35, s37
    v_mfma_f32_16x16x32_bf16 v[244:247], a[84:87], a[98:101], v[244:247]
    ds_read_b128 a[188:191], v41 offset:12288
    ds_read_b32 a232, v62
    v_mfma_f32_16x16x32_bf16 v[248:251], a[84:87], a[122:125], v[248:251]
    buffer_load_dwordx4 v[80:83], v44, s[12:15], s42 offen sc1
    v_mfma_f32_16x16x32_bf16 v[252:255], a[84:87], a[178:181], v[252:255]
    s_waitcnt lgkmcnt(10)
    v_perm_b32 v5, v55, v35, s36
    v_perm_b32 v6, v55, v35, s37
    v_mfma_f32_16x16x32_bf16 v[128:131], a[104:107], a[112:115], v[128:131]
    ds_read_b128 a[64:67], v40 offset:14336
    v_perm_b32 v7, v64, v35, s36
    v_mfma_f32_16x16x32_bf16 v[128:131], a[108:111], a[116:119], v[128:131]
    v_perm_b32 v29, v64, v35, s37
    v_perm_b32 v27, v64, v35, s38
    v_mfma_f32_16x16x32_bf16 v[132:135], a[108:111], a[132:135], v[132:135]
    ds_read_b128 a[68:71], v41 offset:14336
    v_perm_b32 v31, v64, v35, s39
    v_mfma_f32_16x16x32_bf16 v[132:135], a[104:107], a[128:131], v[132:135]
    ds_read_b32 a233, v63
    v_perm_b32 v46, v68, v35, s36
    v_mfma_f32_16x16x32_bf16 v[136:139], a[104:107], a[136:139], v[136:139]
    ds_read_b32 a234, v5
    v_perm_b32 v57, v68, v35, s37
    v_mfma_f32_16x16x32_bf16 v[136:139], a[108:111], a[140:143], v[136:139]
    ds_read_b32 a235, v6
    ds_read_b32 a192, v7
    v_mfma_f32_16x16x32_bf16 v[140:143], a[108:111], a[156:159], v[140:143]
    buffer_load_dwordx4 v36, s[8:11], s56 offen offset:0  lds
    v_mfma_f32_16x16x32_bf16 v[140:143], a[104:107], a[152:155], v[140:143]
    ds_read_b32 a193, v29
    v_perm_b32 v56, v68, v35, s38
    v_mfma_f32_16x16x32_bf16 v[144:147], a[104:107], a[160:163], v[144:147]
    ds_read_b32 a194, v27
    v_perm_b32 v58, v68, v35, s39
    v_mfma_f32_16x16x32_bf16 v[144:147], a[108:111], a[164:167], v[144:147]
    s_waitcnt lgkmcnt(7)
    ds_read_b32 a195, v31
    ds_read_b32 a196, v46
    v_mfma_f32_16x16x32_bf16 v[148:151], a[108:111], a[92:95], v[148:151]
    ds_read_b32 a197, v57
    v_perm_b32 v59, v65, v35, s36
    v_mfma_f32_16x16x32_bf16 v[148:151], a[104:107], a[88:91], v[148:151]
    s_waitcnt vmcnt(16)
    v_perm_b32 v61, v65, v35, s37
    v_bitop3_b32 v60, v75, v79, s76 bitop3:0x7e
    v_mfma_f32_16x16x32_bf16 v[152:155], a[104:107], a[184:187], v[152:155]
    s_waitcnt lgkmcnt(8)
    ds_read_b32 a198, v56
    ds_read_b32 a199, v58
    v_mfma_f32_16x16x32_bf16 v[152:155], a[108:111], a[188:191], v[152:155]
    buffer_load_dwordx4 v37, s[8:11], s56 offen offset:1024  lds
    v_mfma_f32_16x16x32_bf16 v[156:159], a[108:111], a[68:71], v[156:159]
    v_cmp_lt_u32 vcc, 0xffff, v60
    v_perm_b32 v62, v65, v35, s38
    v_mfma_f32_16x16x32_bf16 v[156:159], a[104:107], a[64:67], v[156:159]
    v_perm_b32 v63, v65, v35, s39
    v_perm_b32 v5, v69, v35, s36
    v_mfma_f32_16x16x32_bf16 v[160:163], a[144:147], a[112:115], v[160:163]
    ds_read_b32 a200, v59
    s_cbranch_vccnz L_slow3_0
L_back3_0:
    v_mfma_f32_16x16x32_bf16 v[160:163], a[148:151], a[116:119], v[160:163]
    ds_read_b32 a201, v61
    v_perm_b32 v6, v69, v35, s37
    v_mfma_f32_16x16x32_bf16 v[164:167], a[148:151], a[132:135], v[164:167]
    v_perm_b32 v7, v69, v35, s38
    v_perm_b32 v29, v69, v35, s39
    v_mfma_f32_16x16x32_bf16 v[164:167], a[144:147], a[128:131], v[164:167]
    ds_read_b32 a202, v62
    ds_read_b32 a203, v63
    v_mfma_f32_16x16x32_bf16 v[168:171], a[144:147], a[136:139], v[168:171]
    buffer_load_dwordx4 v[84:87], v32, s[12:15], s43 offen sc1
    v_mfma_f32_16x16x32_bf16 v[168:171], a[148:151], a[140:143], v[168:171]
    ds_read_b32 a204, v5
    v_perm_b32 v27, v66, v35, s36
    v_mfma_f32_16x16x32_bf16 v[172:175], a[148:151], a[156:159], v[172:175]
    ds_read_b32 a205, v6
    v_perm_b32 v31, v66, v35, s37
    v_mfma_f32_16x16x32_bf16 v[172:175], a[144:147], a[152:155], v[172:175]
    ds_read_b32 a206, v7
    ds_read_b32 a207, v29
    v_mfma_f32_16x16x32_bf16 v[176:179], a[144:147], a[160:163], v[176:179]
    buffer_load_dwordx4 v[96:99], v33, s[12:15], s43 offen sc1
    v_mfma_f32_16x16x32_bf16 v[176:179], a[148:151], a[164:167], v[176:179]
    v_perm_b32 v46, v66, v35, s38
    v_perm_b32 v57, v66, v35, s39
    v_mfma_f32_16x16x32_bf16 v[180:183], a[148:151], a[92:95], v[180:183]
    ds_read_b32 a208, v27
    v_perm_b32 v56, v70, v35, s36
    v_mfma_f32_16x16x32_bf16 v[180:183], a[144:147], a[88:91], v[180:183]
    ds_read_b32 a209, v31
    v_perm_b32 v58, v70, v35, s37
    v_mfma_f32_16x16x32_bf16 v[184:187], a[144:147], a[184:187], v[184:187]
    ds_read_b32 a210, v46
    v_perm_b32 v60, v70, v35, s38
    v_mfma_f32_16x16x32_bf16 v[184:187], a[148:151], a[188:191], v[184:187]
    ds_read_b32 a211, v57
    ds_read_b32 a212, v56
    v_mfma_f32_16x16x32_bf16 v[188:191], a[148:151], a[68:71], v[188:191]
    buffer_load_dwordx4 v38, s[8:11], s56 offen offset:2048  lds
    v_mfma_f32_16x16x32_bf16 v[188:191], a[144:147], a[64:67], v[188:191]
    s_waitcnt vmcnt(15)
    ds_read_b32 a213, v58
    v_perm_b32 v59, v70, v35, s39
    v_mfma_f32_16x16x32_bf16 v[192:195], a[168:171], a[112:115], v[192:195]
    s_barrier
    v_mfma_f32_16x16x32_bf16 v[192:195], a[172:175], a[116:119], v[192:195]
    ds_read_b32 a214, v60
    v_perm_b32 v61, v67, v35, s36
    v_mfma_f32_16x16x32_bf16 v[196:199], a[172:175], a[132:135], v[196:199]
    v_perm_b32 v62, v67, v35, s37
    v_perm_b32 v63, v71, v35, s36
    v_mfma_f32_16x16x32_bf16 v[196:199], a[168:171], a[128:131], v[196:199]
    ds_read_b32 a215, v59
    v_perm_b32 v5, v71, v35, s37
    v_mfma_f32_16x16x32_bf16 v[200:203], a[168:171], a[136:139], v[200:203]
    ds_read_b32 a236, v61
    ds_read_b32 a237, v62
    v_mfma_f32_16x16x32_bf16 v[200:203], a[172:175], a[140:143], v[200:203]
    buffer_load_dwordx4 v39, s[8:11], s56 offen offset:3072  lds
    v_mfma_f32_16x16x32_bf16 v[204:207], a[172:175], a[156:159], v[204:207]
    s_add_u32 m0, s57, 81920
    ds_read_b128 a[216:219], v40 offset:16384
    v_perm_b32 v6, v72, v35, s36
    v_mfma_f32_16x16x32_bf16 v[204:207], a[168:171], a[152:155], v[204:207]
    ds_read_b32 a238, v63
    ds_read_b32 a239, v5
    v_mfma_f32_16x16x32_bf16 v[208:211], a[168:171], a[160:163], v[208:211]
    ds_read_b128 a[220:223], v41 offset:16384
    v_perm_b32 v7, v72, v35, s37
    v_mfma_f32_16x16x32_bf16 v[208:211], a[172:175], a[164:167], v[208:211]
    ds_read_b32 a224, v6
    v_perm_b32 v29, v72, v35, s38
    v_mfma_f32_16x16x32_bf16 v[212:215], a[172:175], a[92:95], v[212:215]
    ds_read_b128 a[240:243], v40 offset:18432
    v_perm_b32 v27, v72, v35, s39
    v_mfma_f32_16x16x32_bf16 v[212:215], a[168:171], a[88:91], v[212:215]
    ds_read_b32 a225, v7
    v_perm_b32 v31, v76, v35, s36
    v_mfma_f32_16x16x32_bf16 v[216:219], a[168:171], a[184:187], v[216:219]
    ds_read_b128 a[244:247], v41 offset:18432
    ds_read_b32 a226, v29
    v_mfma_f32_16x16x32_bf16 v[216:219], a[172:175], a[188:191], v[216:219]
    buffer_load_dwordx4 v36, s[8:11], s3 offen offset:0  lds
    v_mfma_f32_16x16x32_bf16 v[220:223], a[172:175], a[68:71], v[220:223]
    ds_read_b128 a[248:251], v40 offset:20480
    v_perm_b32 v46, v76, v35, s37
    v_mfma_f32_16x16x32_bf16 v[220:223], a[168:171], a[64:67], v[220:223]
    s_waitcnt lgkmcnt(9)
    ds_read_b32 a227, v27
    ds_read_b32 a228, v31
    v_mfma_f32_16x16x32_bf16 v[224:227], a[232:235], a[114:117], v[224:227]
    ds_read_b128 a[252:255], v41 offset:20480
    v_perm_b32 v57, v76, v35, s38
    v_mfma_f32_16x16x32_bf16 v[228:231], a[232:235], a[130:133], v[228:231]
    ds_read_b32 a229, v46
    v_perm_b32 v56, v76, v35, s39
    v_mfma_f32_16x16x32_bf16 v[232:235], a[232:235], a[138:141], v[232:235]
    ds_read_b128 a[36:39], v41 offset:22528
    v_perm_b32 v58, v73, v35, s36
    v_mfma_f32_16x16x32_bf16 v[236:239], a[232:235], a[154:157], v[236:239]
    ds_read_b128 a[32:35], v40 offset:22528
    ds_read_b32 a230, v57
    v_mfma_f32_16x16x32_bf16 v[240:243], a[232:235], a[162:165], v[240:243]
    buffer_load_dwordx4 v37, s[8:11], s3 offen offset:1024  lds
    v_mfma_f32_16x16x32_bf16 v[244:247], a[232:235], a[90:93], v[244:247]
    ds_read_b128 a[0:3], v40 offset:24576
    v_perm_b32 v60, v73, v35, s37
    v_mfma_f32_16x16x32_bf16 v[248:251], a[232:235], a[186:189], v[248:251]
    ds_read_b128 a[4:7], v41 offset:24576
    ds_read_b32 a231, v56
    v_mfma_f32_16x16x32_bf16 v[252:255], a[232:235], a[66:69], v[252:255]
    ds_read_b128 a[12:15], v41 offset:26624
    v_perm_b32 v59, v73, v35, s38
    v_mfma_f32_16x16x32_bf16 v[128:131], a[192:195], a[216:219], v[128:131]
    s_waitcnt lgkmcnt(9)
    ds_read_b128 a[8:11], v40 offset:26624
    ds_read_b32 a48, v58
    v_mfma_f32_16x16x32_bf16 v[128:131], a[196:199], a[220:223], v[128:131]
    ds_read_b128 a[16:19], v40 offset:28672
    v_perm_b32 v61, v73, v35, s39
    v_mfma_f32_16x16x32_bf16 v[132:135], a[196:199], a[244:247], v[132:135]
    s_add_u32 s56, s55, 1280
    ds_read_b32 a49, v60
    ds_read_b32 a50, v59
    v_mfma_f32_16x16x32_bf16 v[132:135], a[192:195], a[240:243], v[132:135]
    buffer_load_dwordx4 v38, s[8:11], s3 offen offset:2048  lds
    v_mfma_f32_16x16x32_bf16 v[136:139], a[192:195], a[248:251], v[136:139]
    s_waitcnt lgkmcnt(9)
    ds_read_b128 a[20:23], v41 offset:28672
    v_perm_b32 v62, v77, v35, s36
    v_mfma_f32_16x16x32_bf16 v[136:139], a[196:199], a[252:255], v[136:139]
    ds_read_b128 a[24:27], v40 offset:30720
    v_perm_b32 v63, v77, v35, s37
    v_mfma_f32_16x16x32_bf16 v[140:143], a[196:199], a[36:39], v[140:143]
    v_perm_b32 v5, v77, v35, s38
    v_perm_b32 v6, v77, v35, s39
    v_mfma_f32_16x16x32_bf16 v[140:143], a[192:195], a[32:35], v[140:143]
    s_waitcnt lgkmcnt(8)
    ds_read_b128 a[28:31], v41 offset:30720
    ds_read_b32 a51, v61
    v_mfma_f32_16x16x32_bf16 v[144:147], a[192:195], a[0:3], v[144:147]
    ds_read_b32 a52, v62
    v_perm_b32 v7, v74, v35, s36
    v_mfma_f32_16x16x32_bf16 v[144:147], a[196:199], a[4:7], v[144:147]
    s_waitcnt lgkmcnt(8)
    ds_read_b32 a53, v63
    v_perm_b32 v29, v74, v35, s37
    v_mfma_f32_16x16x32_bf16 v[148:151], a[196:199], a[12:15], v[148:151]
    s_waitcnt lgkmcnt(5)
    ds_read_b32 a54, v5
    ds_read_b32 a55, v6
    v_mfma_f32_16x16x32_bf16 v[148:151], a[192:195], a[8:11], v[148:151]
    buffer_load_dwordx4 v39, s[8:11], s3 offen offset:3072  lds
    v_mfma_f32_16x16x32_bf16 v[152:155], a[192:195], a[16:19], v[152:155]
    s_add_u32 m0, s57, 0
    v_perm_b32 v27, v74, v35, s38
    v_perm_b32 v31, v74, v35, s39
    v_mfma_f32_16x16x32_bf16 v[152:155], a[196:199], a[20:23], v[152:155]
    s_waitcnt lgkmcnt(5)
    ds_read_b32 a40, v7
    v_perm_b32 v46, v78, v35, s36
    v_mfma_f32_16x16x32_bf16 v[156:159], a[196:199], a[28:31], v[156:159]
    s_waitcnt vmcnt(12)
    ds_read_b32 a41, v29
    v_perm_b32 v57, v78, v35, s37
    v_mfma_f32_16x16x32_bf16 v[156:159], a[192:195], a[24:27], v[156:159]
    s_barrier
    v_mfma_f32_16x16x32_bf16 v[160:163], a[200:203], a[216:219], v[160:163]
    ds_read_b32 a42, v27
    v_perm_b32 v56, v78, v35, s38
    v_mfma_f32_16x16x32_bf16 v[160:163], a[204:207], a[220:223], v[160:163]
    ds_read_b32 a43, v31
    ds_read_b32 a44, v46
    v_mfma_f32_16x16x32_bf16 v[164:167], a[204:207], a[244:247], v[164:167]
    s_add_u32 s3, s69, 1280
    ds_read_b32 a45, v57
    ds_read_b32 a46, v56
    v_mfma_f32_16x16x32_bf16 v[164:167], a[200:203], a[240:243], v[164:167]
    buffer_load_dwordx4 v[104:107], v34, s[12:15], s43 offen sc1
    v_mfma_f32_16x16x32_bf16 v[168:171], a[200:203], a[248:251], v[168:171]
    ds_read_b128 a[56:59], v40 offset:32768
    v_perm_b32 v58, v78, v35, s39
    v_mfma_f32_16x16x32_bf16 v[168:171], a[204:207], a[252:255], v[168:171]
    s_waitcnt vmcnt(11)
    ds_read_b128 a[60:63], v41 offset:32768
    v_bitop3_b32 v60, v103, v83, s76 bitop3:0x7e
    v_mfma_f32_16x16x32_bf16 v[172:175], a[204:207], a[36:39], v[172:175]
    ds_read_b128 a[72:75], v40 offset:34816
    ds_read_b32 a47, v58
    v_mfma_f32_16x16x32_bf16 v[172:175], a[200:203], a[32:35], v[172:175]
    buffer_load_dwordx4 v[108:111], v44, s[12:15], s43 offen sc1
    v_mfma_f32_16x16x32_bf16 v[176:179], a[200:203], a[0:3], v[176:179]
    ds_read_b128 a[76:79], v41 offset:34816
    v_cmp_lt_u32 vcc, 0xffff, v60
    v_mfma_f32_16x16x32_bf16 v[176:179], a[204:207], a[4:7], v[176:179]
    v_perm_b32 v59, v75, v35, s36
    v_perm_b32 v61, v75, v35, s37
    v_mfma_f32_16x16x32_bf16 v[180:183], a[204:207], a[12:15], v[180:183]
    ds_read_b128 a[96:99], v40 offset:36864
    s_cbranch_vccnz L_slow3_1
L_back3_1:
    v_mfma_f32_16x16x32_bf16 v[180:183], a[200:203], a[8:11], v[180:183]
    buffer_load_dwordx4 v[112:115], v32, s[12:15], s44 offen sc1
    v_mfma_f32_16x16x32_bf16 v[184:187], a[200:203], a[16:19], v[184:187]
    v_perm_b32 v62, v79, v35, s36
    v_perm_b32 v63, v79, v35, s37
    v_mfma_f32_16x16x32_bf16 v[184:187], a[204:207], a[20:23], v[184:187]
    ds_read_b128 a[100:103], v41 offset:36864
    v_perm_b32 v5, v103, v35, s36
    v_mfma_f32_16x16x32_bf16 v[188:191], a[204:207], a[28:31], v[188:191]
    ds_read_b32 a120, v59
    ds_read_b32 a121, v61
    v_mfma_f32_16x16x32_bf16 v[188:191], a[200:203], a[24:27], v[188:191]
    buffer_load_dwordx4 v[116:119], v33, s[12:15], s44 offen sc1
    v_mfma_f32_16x16x32_bf16 v[192:195], a[208:211], a[216:219], v[192:195]
    ds_read_b128 a[80:83], v40 offset:38912
    v_perm_b32 v6, v103, v35, s37
    v_mfma_f32_16x16x32_bf16 v[192:195], a[212:215], a[220:223], v[192:195]
    v_perm_b32 v7, v83, v35, s36
    v_perm_b32 v29, v83, v35, s37
    v_mfma_f32_16x16x32_bf16 v[196:199], a[212:215], a[244:247], v[196:199]
    ds_read_b32 a122, v62
    v_perm_b32 v27, v100, v35, s36
    v_mfma_f32_16x16x32_bf16 v[196:199], a[208:211], a[240:243], v[196:199]
    ds_read_b128 a[84:87], v41 offset:38912
    ds_read_b32 a123, v63
    v_mfma_f32_16x16x32_bf16 v[200:203], a[208:211], a[248:251], v[200:203]
    ds_read_b32 a124, v5
    ds_read_b32 a125, v6
    v_mfma_f32_16x16x32_bf16 v[200:203], a[212:215], a[252:255], v[200:203]
    buffer_load_dwordx4 v36, s[8:11], s56 offen offset:0  lds
    v_mfma_f32_16x16x32_bf16 v[204:207], a[212:215], a[36:39], v[204:207]
    ds_read_b128 a[176:179], v40 offset:40960
    v_perm_b32 v31, v100, v35, s37
    v_mfma_f32_16x16x32_bf16 v[204:207], a[208:211], a[32:35], v[204:207]
    v_perm_b32 v46, v100, v35, s38
    v_perm_b32 v57, v100, v35, s39
    v_mfma_f32_16x16x32_bf16 v[208:211], a[208:211], a[0:3], v[208:211]
    ds_read_b32 a126, v7
    ds_read_b32 a127, v29
    v_mfma_f32_16x16x32_bf16 v[208:211], a[212:215], a[4:7], v[208:211]
    ds_read_b128 a[180:183], v41 offset:40960
    v_perm_b32 v56, v80, v35, s36
    v_mfma_f32_16x16x32_bf16 v[212:215], a[212:215], a[12:15], v[212:215]
    ds_read_b32 a104, v27
    v_perm_b32 v58, v80, v35, s37
    v_mfma_f32_16x16x32_bf16 v[212:215], a[208:211], a[8:11], v[212:215]
    v_perm_b32 v60, v80, v35, s38
    v_perm_b32 v59, v80, v35, s39
    v_mfma_f32_16x16x32_bf16 v[216:219], a[208:211], a[16:19], v[216:219]
    ds_read_b128 a[144:147], v40 offset:43008
    ds_read_b32 a105, v31
    v_mfma_f32_16x16x32_bf16 v[216:219], a[212:215], a[20:23], v[216:219]
    buffer_load_dwordx4 v37, s[8:11], s56 offen offset:1024  lds
    v_mfma_f32_16x16x32_bf16 v[220:223], a[212:215], a[28:31], v[220:223]
    s_waitcnt vmcnt(12)
    ds_read_b32 a106, v46
    v_bitop3_b32 v61, v87, v99, s76 bitop3:0x7e
    v_mfma_f32_16x16x32_bf16 v[220:223], a[208:211], a[24:27], v[220:223]
    ds_read_b128 a[148:151], v41 offset:43008
    v_cmp_lt_u32 vcc, 0xffff, v61
    v_mfma_f32_16x16x32_bf16 v[224:227], a[236:239], a[218:221], v[224:227]
    ds_read_b32 a107, v57
    v_perm_b32 v62, v101, v35, s36
    v_mfma_f32_16x16x32_bf16 v[228:231], a[236:239], a[242:245], v[228:231]
    v_perm_b32 v63, v101, v35, s37
    s_cbranch_vccnz L_slow4_0
L_back4_0:
    v_mfma_f32_16x16x32_bf16 v[232:235], a[236:239], a[250:253], v[232:235]
    ds_read_b128 a[168:171], v40 offset:45056
    ds_read_b32 a108, v56
    v_mfma_f32_16x16x32_bf16 v[236:239], a[236:239], a[34:37], v[236:239]
    ds_read_b32 a109, v58
    ds_read_b32 a110, v60
    v_mfma_f32_16x16x32_bf16 v[240:243], a[236:239], a[2:5], v[240:243]
    buffer_load_dwordx4 v38, s[8:11], s56 offen offset:2048  lds
L_pad2:
    s_cbranch_execz L_pad3
    v_mfma_f32_16x16x32_bf16 v[244:247], a[236:239], a[10:13], v[244:247]
    ds_read_b128 a[172:175], v41 offset:45056
    v_perm_b32 v5, v101, v35, s38
    v_mfma_f32_16x16x32_bf16 v[248:251], a[236:239], a[18:21], v[248:251]
    ds_read_b32 a111, v59
    v_perm_b32 v6, v101, v35, s39
    v_mfma_f32_16x16x32_bf16 v[252:255], a[236:239], a[26:29], v[252:255]
    s_waitcnt lgkmcnt(8)
    v_perm_b32 v7, v81, v35, s36
    v_perm_b32 v29, v81, v35, s37
    v_mfma_f32_16x16x32_bf16 v[128:131], a[224:227], a[56:59], v[128:131]
    ds_read_b128 a[112:115], v40 offset:47104
    ds_read_b32 a128, v62
    v_mfma_f32_16x16x32_bf16 v[128:131], a[228:231], a[60:63], v[128:131]
    ds_read_b32 a129, v63
    v_perm_b32 v27, v81, v35, s38
    v_mfma_f32_16x16x32_bf16 v[132:135], a[228:231], a[76:79], v[132:135]
    ds_read_b128 a[116:119], v41 offset:47104
    ds_read_b32 a130, v5
    v_mfma_f32_16x16x32_bf16 v[132:135], a[224:227], a[72:75], v[132:135]
    buffer_load_dwordx4 v39, s[8:11], s56 offen offset:3072  lds
    v_mfma_f32_16x16x32_bf16 v[136:139], a[224:227], a[96:99], v[136:139]
    s_add_u32 m0, s57, 16384
    v_perm_b32 v31, v81, v35, s39
    v_perm_b32 v46, v102, v35, s36
    v_mfma_f32_16x16x32_bf16 v[136:139], a[228:231], a[100:103], v[136:139]
    ds_read_b32 a131, v6
    v_perm_b32 v61, v102, v35, s37
    v_mfma_f32_16x16x32_bf16 v[140:143], a[228:231], a[84:87], v[140:143]
    ds_read_b32 a132, v7
    v_perm_b32 v57, v102, v35, s38
    v_mfma_f32_16x16x32_bf16 v[140:143], a[224:227], a[80:83], v[140:143]
    ds_read_b32 a133, v29
    v_perm_b32 v56, v102, v35, s39
    v_mfma_f32_16x16x32_bf16 v[144:147], a[224:227], a[176:179], v[144:147]
    s_waitcnt lgkmcnt(8)
    ds_read_b32 a134, v27
    ds_read_b32 a135, v31
    v_mfma_f32_16x16x32_bf16 v[144:147], a[228:231], a[180:183], v[144:147]
    buffer_load_dwordx4 v[120:123], v34, s[12:15], s44 offen sc1
    v_mfma_f32_16x16x32_bf16 v[148:151], a[228:231], a[148:151], v[148:151]
    v_perm_b32 v58, v82, v35, s36
    v_perm_b32 v60, v82, v35, s37
    v_mfma_f32_16x16x32_bf16 v[148:151], a[224:227], a[144:147], v[148:151]
    ds_read_b32 a136, v46
    v_perm_b32 v59, v82, v35, s38
    v_mfma_f32_16x16x32_bf16 v[152:155], a[224:227], a[168:171], v[152:155]
    s_waitcnt lgkmcnt(6)
    ds_read_b128 a[152:155], v40 offset:49152
    ds_read_b32 a137, v61
    v_mfma_f32_16x16x32_bf16 v[152:155], a[228:231], a[172:175], v[152:155]
    buffer_load_dwordx4 v[124:127], v44, s[12:15], s44 offen sc1
    v_mfma_f32_16x16x32_bf16 v[156:159], a[228:231], a[116:119], v[156:159]
    ds_read_b128 a[156:159], v41 offset:49152
    ds_read_b32 a138, v57
    v_mfma_f32_16x16x32_bf16 v[156:159], a[224:227], a[112:115], v[156:159]
    ds_read_b128 a[160:163], v40 offset:51200
    v_perm_b32 v62, v82, v35, s39
    v_mfma_f32_16x16x32_bf16 v[160:163], a[48:51], a[56:59], v[160:163]
    ds_read_b128 a[164:167], v41 offset:51200
    ds_read_b32 a139, v56
    v_mfma_f32_16x16x32_bf16 v[160:163], a[52:55], a[60:63], v[160:163]
    v_perm_b32 v63, v84, v35, s36
    v_perm_b32 v5, v84, v35, s37
    v_mfma_f32_16x16x32_bf16 v[164:167], a[52:55], a[76:79], v[164:167]
    ds_read_b128 a[88:91], v40 offset:53248
    ds_read_b32 a140, v58
    v_mfma_f32_16x16x32_bf16 v[164:167], a[48:51], a[72:75], v[164:167]
    ds_read_b32 a141, v60
    ds_read_b32 a142, v59
    v_mfma_f32_16x16x32_bf16 v[168:171], a[48:51], a[96:99], v[168:171]
    buffer_load_dwordx4 v36, s[8:11], s3 offen offset:0  lds
    v_mfma_f32_16x16x32_bf16 v[168:171], a[52:55], a[100:103], v[168:171]
    ds_read_b128 a[92:95], v41 offset:53248
    v_perm_b32 v6, v84, v35, s38
    v_mfma_f32_16x16x32_bf16 v[172:175], a[52:55], a[84:87], v[172:175]
    v_perm_b32 v7, v84, v35, s39
    v_perm_b32 v29, v96, v35, s36
    v_mfma_f32_16x16x32_bf16 v[172:175], a[48:51], a[80:83], v[172:175]
    ds_read_b32 a143, v62
    v_perm_b32 v27, v96, v35, s37
    v_mfma_f32_16x16x32_bf16 v[176:179], a[48:51], a[176:179], v[176:179]
    ds_read_b128 a[184:187], v40 offset:55296
    ds_read_b32 a64, v63
    v_mfma_f32_16x16x32_bf16 v[176:179], a[52:55], a[180:183], v[176:179]
    ds_read_b32 a65, v5
    v_perm_b32 v31, v96, v35, s38
    v_mfma_f32_16x16x32_bf16 v[180:183], a[52:55], a[148:151], v[180:183]
    v_perm_b32 v46, v96, v35, s39
    v_perm_b32 v61, v85, v35, s36
    v_mfma_f32_16x16x32_bf16 v[180:183], a[48:51], a[144:147], v[180:183]
    ds_read_b128 a[188:191], v41 offset:55296
    ds_read_b32 a66, v6
    v_mfma_f32_16x16x32_bf16 v[184:187], a[48:51], a[168:171], v[184:187]
    buffer_load_dwordx4 v37, s[8:11], s3 offen offset:1024  lds
    v_mfma_f32_16x16x32_bf16 v[184:187], a[52:55], a[172:175], v[184:187]
    ds_read_b32 a67, v7
    v_perm_b32 v57, v85, v35, s37
    v_mfma_f32_16x16x32_bf16 v[188:191], a[52:55], a[116:119], v[188:191]
    ds_read_b128 a[192:195], v40 offset:57344
    ds_read_b32 a68, v29
    v_mfma_f32_16x16x32_bf16 v[188:191], a[48:51], a[112:115], v[188:191]
    ds_read_b32 a69, v27
    v_perm_b32 v56, v85, v35, s38
    v_mfma_f32_16x16x32_bf16 v[192:195], a[40:43], a[56:59], v[192:195]
    ds_read_b32 a70, v31
    v_perm_b32 v58, v85, v35, s39
    v_mfma_f32_16x16x32_bf16 v[192:195], a[44:47], a[60:63], v[192:195]
    ds_read_b128 a[196:199], v41 offset:57344
    ds_read_b32 a71, v46
    v_mfma_f32_16x16x32_bf16 v[196:199], a[44:47], a[76:79], v[196:199]
    ds_read_b32 a200, v61
    ds_read_b32 a201, v57
    v_mfma_f32_16x16x32_bf16 v[196:199], a[40:43], a[72:75], v[196:199]
    buffer_load_dwordx4 v38, s[8:11], s3 offen offset:2048  lds
    v_mfma_f32_16x16x32_bf16 v[200:203], a[40:43], a[96:99], v[200:203]
    ds_read_b128 a[208:211], v40 offset:59392
    v_perm_b32 v60, v97, v35, s36
    v_mfma_f32_16x16x32_bf16 v[200:203], a[44:47], a[100:103], v[200:203]
    v_perm_b32 v59, v97, v35, s37
    v_perm_b32 v62, v97, v35, s38
    v_mfma_f32_16x16x32_bf16 v[204:207], a[44:47], a[84:87], v[204:207]
    ds_read_b32 a202, v56
    v_perm_b32 v63, v97, v35, s39
    v_mfma_f32_16x16x32_bf16 v[204:207], a[40:43], a[80:83], v[204:207]
    ds_read_b128 a[212:215], v41 offset:59392
    ds_read_b32 a203, v58
    v_mfma_f32_16x16x32_bf16 v[208:211], a[40:43], a[176:179], v[208:211]
    v_perm_b32 v5, v86, v35, s36
    v_perm_b32 v6, v86, v35, s37
    v_mfma_f32_16x16x32_bf16 v[208:211], a[44:47], a[180:183], v[208:211]
    ds_read_b32 a204, v60
    v_perm_b32 v7, v86, v35, s38
    v_mfma_f32_16x16x32_bf16 v[212:215], a[44:47], a[148:151], v[212:215]
    ds_read_b128 a[216:219], v40 offset:61440
    ds_read_b32 a205, v59
    v_mfma_f32_16x16x32_bf16 v[212:215], a[40:43], a[144:147], v[212:215]
    buffer_load_dwordx4 v39, s[8:11], s3 offen offset:3072  lds
    v_mfma_f32_16x16x32_bf16 v[216:219], a[40:43], a[168:171], v[216:219]
    s_waitcnt vmcnt(12)
    ds_read_b32 a206, v62
    v_bitop3_b32 v29, v107, v111, s76 bitop3:0x7e
    v_mfma_f32_16x16x32_bf16 v[216:219], a[44:47], a[172:175], v[216:219]
    ds_read_b128 a[220:223], v41 offset:61440
    v_cmp_lt_u32 vcc, 0xffff, v29
    v_mfma_f32_16x16x32_bf16 v[220:223], a[44:47], a[116:119], v[220:223]
    ds_read_b32 a207, v63
    v_perm_b32 v27, v86, v35, s39
    v_mfma_f32_16x16x32_bf16 v[220:223], a[40:43], a[112:115], v[220:223]
    v_perm_b32 v31, v98, v35, s36
    s_cbranch_vccnz L_slow4_1
L_back4_1:
    v_mfma_f32_16x16x32_bf16 v[224:227], a[120:123], a[58:61], v[224:227]
    s_waitcnt lgkmcnt(6)
    ds_read_b128 a[240:243], v40 offset:63488
    ds_read_b32 a248, v5
    v_mfma_f32_16x16x32_bf16 v[224:227], a[124:127], a[154:157], v[224:227]
    ds_read_b32 a249, v6
    v_perm_b32 v46, v98, v35, s37
    v_mfma_f32_16x16x32_bf16 v[228:231], a[124:127], a[162:165], v[228:231]
    ds_read_b128 a[244:247], v41 offset:63488
    ds_read_b32 a250, v7
    v_mfma_f32_16x16x32_bf16 v[228:231], a[120:123], a[74:77], v[228:231]
    ds_read_b32 a251, v27
    ds_read_b32 a252, v31
    v_mfma_f32_16x16x32_bf16 v[232:235], a[120:123], a[98:101], v[232:235]
    buffer_load_dwordx4 v[88:91], v32, s[12:15], s45 offen sc1
    v_mfma_f32_16x16x32_bf16 v[232:235], a[124:127], a[90:93], v[232:235]
    v_perm_b32 v61, v98, v35, s38
    v_perm_b32 v57, v98, v35, s39
    v_mfma_f32_16x16x32_bf16 v[236:239], a[124:127], a[186:189], v[236:239]
    v_perm_b32 v56, v87, v35, s36
    v_perm_b32 v58, v87, v35, s37
    v_mfma_f32_16x16x32_bf16 v[236:239], a[120:123], a[82:85], v[236:239]
    ds_read_b32 a253, v46
    ds_read_b32 a254, v61
    v_mfma_f32_16x16x32_bf16 v[240:243], a[120:123], a[178:181], v[240:243]
    buffer_load_dwordx4 v[92:95], v33, s[12:15], s45 offen sc1
    v_mfma_f32_16x16x32_bf16 v[240:243], a[124:127], a[194:197], v[240:243]
    v_perm_b32 v60, v99, v35, s36
    v_perm_b32 v59, v99, v35, s37
    v_mfma_f32_16x16x32_bf16 v[244:247], a[124:127], a[210:213], v[244:247]
    v_perm_b32 v62, v107, v35, s36
    v_perm_b32 v29, v107, v35, s37
    v_mfma_f32_16x16x32_bf16 v[244:247], a[120:123], a[146:149], v[244:247]
    s_waitcnt lgkmcnt(4)
    ds_read_b32 a255, v57
    ds_read_b32 a32, v56
    v_mfma_f32_16x16x32_bf16 v[248:251], a[120:123], a[170:173], v[248:251]
    buffer_load_dwordx4 v[48:51], v34, s[12:15], s45 offen sc1
    v_mfma_f32_16x16x32_bf16 v[248:251], a[124:127], a[218:221], v[248:251]
    s_barrier
    v_mfma_f32_16x16x32_bf16 v[252:255], a[124:127], a[242:245], v[252:255]
    s_add_u32 s56, s55, 1536
    ds_read_b32 a33, v58
    v_perm_b32 v63, v111, v35, s36
    v_mfma_f32_16x16x32_bf16 v[252:255], a[120:123], a[114:117], v[252:255]
    ds_read_b32 a34, v60
    ds_read_b32 a35, v59
    v_mfma_f32_16x16x32_bf16 v[128:131], a[104:107], a[152:155], v[128:131]
    buffer_load_dwordx4 v[52:55], v44, s[12:15], s45 offen sc1
    v_mfma_f32_16x16x32_bf16 v[128:131], a[108:111], a[156:159], v[128:131]
    s_add_u32 m0, s57, 32768
    v_perm_b32 v5, v111, v35, s37
    v_perm_b32 v6, v104, v35, s36
    v_mfma_f32_16x16x32_bf16 v[132:135], a[108:111], a[164:167], v[132:135]
    ds_read_b32 a36, v62
    ds_read_b32 a37, v29
    v_mfma_f32_16x16x32_bf16 v[132:135], a[104:107], a[160:163], v[132:135]
    v_perm_b32 v7, v104, v35, s37
    v_perm_b32 v27, v104, v35, s38
    v_mfma_f32_16x16x32_bf16 v[136:139], a[104:107], a[88:91], v[136:139]
    ds_read_b32 a38, v63
    ds_read_b32 a39, v5
    v_mfma_f32_16x16x32_bf16 v[136:139], a[108:111], a[92:95], v[136:139]
    buffer_load_dwordx4 v36, s[8:11], s56 offen offset:0  lds
    v_mfma_f32_16x16x32_bf16 v[140:143], a[108:111], a[188:191], v[140:143]
    v_perm_b32 v31, v104, v35, s39
    v_perm_b32 v46, v108, v35, s36
    v_mfma_f32_16x16x32_bf16 v[140:143], a[104:107], a[184:187], v[140:143]
    ds_read_b32 a0, v6
    v_perm_b32 v61, v108, v35, s37
    v_mfma_f32_16x16x32_bf16 v[144:147], a[104:107], a[192:195], v[144:147]
    s_waitcnt vmcnt(15)
    v_perm_b32 v56, v108, v35, s38
    v_bitop3_b32 v57, v115, v119, s76 bitop3:0x7e
    v_mfma_f32_16x16x32_bf16 v[144:147], a[108:111], a[196:199], v[144:147]
    ds_read_b32 a1, v7
    v_cmp_lt_u32 vcc, 0xffff, v57
    v_mfma_f32_16x16x32_bf16 v[148:151], a[108:111], a[212:215], v[148:151]
    ds_read_b32 a2, v27
    v_perm_b32 v58, v108, v35, s39
    v_mfma_f32_16x16x32_bf16 v[148:151], a[104:107], a[208:211], v[148:151]
    ds_read_b128 a[8:11], v42 offset:0
    s_cbranch_vccnz L_slow5_0
L_back5_0:
    v_mfma_f32_16x16x32_bf16 v[152:155], a[104:107], a[216:219], v[152:155]
    buffer_load_dwordx4 v37, s[8:11], s56 offen offset:1024  lds
    v_mfma_f32_16x16x32_bf16 v[152:155], a[108:111], a[220:223], v[152:155]
    ds_read_b128 a[12:15], v43 offset:0
    v_perm_b32 v60, v105, v35, s36
    v_mfma_f32_16x16x32_bf16 v[156:159], a[108:111], a[244:247], v[156:159]
    s_add_u32 s3, s69, 1536
    ds_read_b128 a[16:19], v42 offset:2048
    ds_read_b32 a3, v31
    v_mfma_f32_16x16x32_bf16 v[156:159], a[104:107], a[240:243], v[156:159]
    ds_read_b128 a[20:23], v43 offset:2048
    ds_read_b32 a4, v46
    v_mfma_f32_16x16x32_bf16 v[160:163], a[128:131], a[152:155], v[160:163]
    ds_read_b32 a5, v61
    v_perm_b32 v59, v105, v35, s37
    v_mfma_f32_16x16x32_bf16 v[160:163], a[132:135], a[156:159], v[160:163]
    ds_read_b32 a6, v56
    v_perm_b32 v62, v105, v35, s38
    v_mfma_f32_16x16x32_bf16 v[164:167], a[132:135], a[164:167], v[164:167]
    ds_read_b128 a[232:235], v42 offset:4096
    ds_read_b32 a7, v58
    v_mfma_f32_16x16x32_bf16 v[164:167], a[128:131], a[160:163], v[164:167]
    ds_read_b32 a24, v60
    ds_read_b32 a25, v59
    v_mfma_f32_16x16x32_bf16 v[168:171], a[128:131], a[88:91], v[168:171]
    buffer_load_dwordx4 v38, s[8:11], s56 offen offset:2048  lds
    v_mfma_f32_16x16x32_bf16 v[168:171], a[132:135], a[92:95], v[168:171]
    ds_read_b128 a[236:239], v43 offset:4096
    v_perm_b32 v29, v105, v35, s39
    v_mfma_f32_16x16x32_bf16 v[172:175], a[132:135], a[188:191], v[172:175]
    v_perm_b32 v63, v109, v35, s36
    v_perm_b32 v5, v109, v35, s37
    v_mfma_f32_16x16x32_bf16 v[172:175], a[128:131], a[184:187], v[172:175]
    v_perm_b32 v6, v109, v35, s38
    v_perm_b32 v7, v109, v35, s39
    v_mfma_f32_16x16x32_bf16 v[176:179], a[128:131], a[192:195], v[176:179]
    ds_read_b128 a[224:227], v42 offset:6144
    ds_read_b32 a26, v62
    v_mfma_f32_16x16x32_bf16 v[176:179], a[132:135], a[196:199], v[176:179]
    v_perm_b32 v57, v106, v35, s36
    v_perm_b32 v27, v106, v35, s37
    v_mfma_f32_16x16x32_bf16 v[180:183], a[132:135], a[212:215], v[180:183]
    ds_read_b32 a27, v29
    ds_read_b32 a28, v63
    v_mfma_f32_16x16x32_bf16 v[180:183], a[128:131], a[208:211], v[180:183]
    buffer_load_dwordx4 v39, s[8:11], s56 offen offset:3072  lds
    v_mfma_f32_16x16x32_bf16 v[184:187], a[128:131], a[216:219], v[184:187]
    s_add_u32 m0, s57, 49152
    ds_read_b128 a[228:231], v43 offset:6144
    v_perm_b32 v31, v106, v35, s38
    v_mfma_f32_16x16x32_bf16 v[184:187], a[132:135], a[220:223], v[184:187]
    s_add_u32 s56, s55, 1792
    ds_read_b32 a29, v5
    v_perm_b32 v46, v106, v35, s39
    v_mfma_f32_16x16x32_bf16 v[188:191], a[132:135], a[244:247], v[188:191]
    ds_read_b128 a[48:51], v42 offset:8192
    ds_read_b32 a30, v6
    v_mfma_f32_16x16x32_bf16 v[188:191], a[128:131], a[240:243], v[188:191]
    ds_read_b32 a31, v7
    v_perm_b32 v61, v110, v35, s36
    v_mfma_f32_16x16x32_bf16 v[192:195], a[136:139], a[152:155], v[192:195]
    ds_read_b32 a40, v57
    ds_read_b32 a41, v27
    v_mfma_f32_16x16x32_bf16 v[192:195], a[140:143], a[156:159], v[192:195]
    ds_read_b128 a[52:55], v43 offset:8192
    v_perm_b32 v56, v110, v35, s37
    v_mfma_f32_16x16x32_bf16 v[196:199], a[140:143], a[164:167], v[196:199]
    ds_read_b32 a42, v31
    ds_read_b32 a43, v46
    v_mfma_f32_16x16x32_bf16 v[196:199], a[136:139], a[160:163], v[196:199]
    buffer_load_dwordx4 v36, s[8:11], s3 offen offset:0  lds
    v_mfma_f32_16x16x32_bf16 v[200:203], a[136:139], a[88:91], v[200:203]
    ds_read_b128 a[56:59], v42 offset:10240
    v_perm_b32 v58, v110, v35, s38
    v_mfma_f32_16x16x32_bf16 v[200:203], a[140:143], a[92:95], v[200:203]
    v_perm_b32 v60, v110, v35, s39
    v_perm_b32 v59, v112, v35, s36
    v_mfma_f32_16x16x32_bf16 v[204:207], a[140:143], a[188:191], v[204:207]
    ds_read_b32 a44, v61
    v_perm_b32 v62, v112, v35, s37
    v_mfma_f32_16x16x32_bf16 v[204:207], a[136:139], a[184:187], v[204:207]
    ds_read_b128 a[60:63], v43 offset:10240
    ds_read_b32 a45, v56
    v_mfma_f32_16x16x32_bf16 v[208:211], a[136:139], a[192:195], v[208:211]
    v_perm_b32 v29, v112, v35, s38
    v_perm_b32 v63, v112, v35, s39
    v_mfma_f32_16x16x32_bf16 v[208:211], a[140:143], a[196:199], v[208:211]
    ds_read_b32 a46, v58
    ds_read_b32 a47, v60
    v_mfma_f32_16x16x32_bf16 v[212:215], a[140:143], a[212:215], v[212:215]
    buffer_load_dwordx4 v37, s[8:11], s3 offen offset:1024  lds
    v_mfma_f32_16x16x32_bf16 v[212:215], a[136:139], a[208:211], v[212:215]
    ds_read_b128 a[72:75], v42 offset:12288
    v_perm_b32 v5, v116, v35, s36
    v_mfma_f32_16x16x32_bf16 v[216:219], a[136:139], a[216:219], v[216:219]
    ds_read_b32 a96, v59
    v_perm_b32 v6, v116, v35, s37
    v_mfma_f32_16x16x32_bf16 v[216:219], a[140:143], a[220:223], v[216:219]
    ds_read_b128 a[76:79], v43 offset:12288
    ds_read_b32 a97, v62
    v_mfma_f32_16x16x32_bf16 v[220:223], a[140:143], a[244:247], v[220:223]
    ds_read_b32 a98, v29
    v_perm_b32 v7, v116, v35, s38
    v_mfma_f32_16x16x32_bf16 v[220:223], a[136:139], a[240:243], v[220:223]
    s_waitcnt lgkmcnt(9)
    ds_read_b32 a99, v63
    v_perm_b32 v57, v116, v35, s39
    v_mfma_f32_16x16x32_bf16 v[128:131], a[64:67], a[8:11], v[128:131]
    ds_read_b128 a[80:83], v42 offset:14336
    ds_read_b32 a100, v5
    v_mfma_f32_16x16x32_bf16 v[128:131], a[68:71], a[12:15], v[128:131]
    buffer_load_dwordx4 v38, s[8:11], s3 offen offset:2048  lds
    v_mfma_f32_16x16x32_bf16 v[132:135], a[68:71], a[20:23], v[132:135]
    ds_read_b128 a[84:87], v43 offset:14336
    v_perm_b32 v27, v113, v35, s36
    v_mfma_f32_16x16x32_bf16 v[132:135], a[64:67], a[16:19], v[132:135]
    ds_read_b32 a101, v6
    v_perm_b32 v31, v113, v35, s37
    v_mfma_f32_16x16x32_bf16 v[136:139], a[64:67], a[232:235], v[136:139]
    s_waitcnt vmcnt(15)
    v_perm_b32 v61, v113, v35, s38
    v_bitop3_b32 v46, v123, v127, s76 bitop3:0x7e
    v_mfma_f32_16x16x32_bf16 v[136:139], a[68:71], a[236:239], v[136:139]
    ds_read_b32 a102, v7
    v_cmp_lt_u32 vcc, 0xffff, v46
    v_mfma_f32_16x16x32_bf16 v[140:143], a[68:71], a[228:231], v[140:143]
    ds_read_b32 a103, v57
    v_perm_b32 v56, v113, v35, s39
    v_mfma_f32_16x16x32_bf16 v[140:143], a[64:67], a[224:227], v[140:143]
    v_perm_b32 v58, v117, v35, s36
    s_cbranch_vccnz L_slow5_1
L_back5_1:
    v_mfma_f32_16x16x32_bf16 v[144:147], a[64:67], a[48:51], v[144:147]
    s_waitcnt lgkmcnt(6)
    ds_read_b32 a176, v27
    ds_read_b32 a177, v31
    v_mfma_f32_16x16x32_bf16 v[144:147], a[68:71], a[52:55], v[144:147]
    buffer_load_dwordx4 v39, s[8:11], s3 offen offset:3072  lds
    v_mfma_f32_16x16x32_bf16 v[148:151], a[68:71], a[60:63], v[148:151]
    s_add_u32 m0, s57, 65536
    v_perm_b32 v60, v117, v35, s37
    v_perm_b32 v59, v117, v35, s38
    v_mfma_f32_16x16x32_bf16 v[148:151], a[64:67], a[56:59], v[148:151]
    s_add_u32 s3, s69, 1792
    ds_read_b32 a178, v61
    v_perm_b32 v62, v117, v35, s39
    v_mfma_f32_16x16x32_bf16 v[152:155], a[64:67], a[72:75], v[152:155]
    ds_read_b128 a[144:147], v42 offset:16384
    ds_read_b32 a179, v56
    v_mfma_f32_16x16x32_bf16 v[152:155], a[68:71], a[76:79], v[152:155]
    s_waitcnt lgkmcnt(7)
    ds_read_b128 a[148:151], v43 offset:16384
    v_perm_b32 v29, v114, v35, s36
    v_mfma_f32_16x16x32_bf16 v[156:159], a[68:71], a[84:87], v[156:159]
    ds_read_b128 a[168:171], v42 offset:18432
    ds_read_b32 a180, v58
    v_mfma_f32_16x16x32_bf16 v[156:159], a[64:67], a[80:83], v[156:159]
    ds_read_b128 a[172:175], v43 offset:18432
    v_perm_b32 v63, v114, v35, s37
    v_mfma_f32_16x16x32_bf16 v[160:163], a[200:203], a[8:11], v[160:163]
    ds_read_b32 a181, v60
    v_perm_b32 v5, v114, v35, s38
    v_mfma_f32_16x16x32_bf16 v[160:163], a[204:207], a[12:15], v[160:163]
    ds_read_b32 a182, v59
    ds_read_b32 a183, v62
    v_mfma_f32_16x16x32_bf16 v[164:167], a[204:207], a[20:23], v[164:167]
    ds_read_b128 a[120:123], v42 offset:20480
    v_perm_b32 v6, v114, v35, s39
    v_mfma_f32_16x16x32_bf16 v[164:167], a[200:203], a[16:19], v[164:167]
    ds_read_b32 a112, v29
    v_perm_b32 v7, v118, v35, s36
    v_mfma_f32_16x16x32_bf16 v[168:171], a[200:203], a[232:235], v[168:171]
    ds_read_b32 a113, v63
    v_perm_b32 v46, v118, v35, s37
    v_mfma_f32_16x16x32_bf16 v[168:171], a[204:207], a[236:239], v[168:171]
    ds_read_b128 a[124:127], v43 offset:20480
    ds_read_b32 a114, v5
    v_mfma_f32_16x16x32_bf16 v[172:175], a[204:207], a[228:231], v[172:175]
    buffer_load_dwordx4 v[64:67], v22, s[32:35], 0 offen
    v_mfma_f32_16x16x32_bf16 v[172:175], a[200:203], a[224:227], v[172:175]
    v_perm_b32 v57, v118, v35, s38
    v_perm_b32 v27, v118, v35, s39
    v_mfma_f32_16x16x32_bf16 v[176:179], a[200:203], a[48:51], v[176:179]
    ds_read_b128 a[104:107], v42 offset:22528
    ds_read_b32 a115, v6
    v_mfma_f32_16x16x32_bf16 v[176:179], a[204:207], a[52:55], v[176:179]
    ds_read_b32 a116, v7
    ds_read_b32 a117, v46
    v_mfma_f32_16x16x32_bf16 v[180:183], a[204:207], a[60:63], v[180:183]
    buffer_load_dwordx4 v[68:71], v32, s[12:15], s72 offen sc1
    v_mfma_f32_16x16x32_bf16 v[180:183], a[200:203], a[56:59], v[180:183]
    ds_read_b128 a[108:111], v43 offset:22528
    v_perm_b32 v31, v115, v35, s36
    v_mfma_f32_16x16x32_bf16 v[184:187], a[200:203], a[72:75], v[184:187]
    v_perm_b32 v61, v115, v35, s37
    v_perm_b32 v56, v119, v35, s36
    v_mfma_f32_16x16x32_bf16 v[184:187], a[204:207], a[76:79], v[184:187]
    ds_read_b32 a118, v57
    ds_read_b32 a119, v27
    v_mfma_f32_16x16x32_bf16 v[188:191], a[204:207], a[84:87], v[188:191]
    buffer_load_dwordx4 v[72:75], v33, s[12:15], s72 offen sc1
    v_mfma_f32_16x16x32_bf16 v[188:191], a[200:203], a[80:83], v[188:191]
    ds_read_b128 a[128:131], v42 offset:24576
    v_perm_b32 v58, v119, v35, s37
    v_mfma_f32_16x16x32_bf16 v[192:195], a[248:251], a[8:11], v[192:195]
    v_perm_b32 v60, v123, v35, s36
    v_perm_b32 v59, v123, v35, s37
    v_mfma_f32_16x16x32_bf16 v[192:195], a[252:255], a[12:15], v[192:195]
    ds_read_b128 a[132:135], v43 offset:24576
    ds_read_b32 a152, v31
    v_mfma_f32_16x16x32_bf16 v[196:199], a[252:255], a[20:23], v[196:199]
    buffer_load_dwordx4 v[76:79], v34, s[12:15], s72 offen sc1
    v_mfma_f32_16x16x32_bf16 v[196:199], a[248:251], a[16:19], v[196:199]
    ds_read_b32 a153, v61
    ds_read_b32 a154, v56
    v_mfma_f32_16x16x32_bf16 v[200:203], a[248:251], a[232:235], v[200:203]
    ds_read_b128 a[160:163], v42 offset:26624
    v_perm_b32 v62, v127, v35, s36
    v_mfma_f32_16x16x32_bf16 v[200:203], a[252:255], a[236:239], v[200:203]
    ds_read_b32 a155, v58
    ds_read_b32 a156, v60
    v_mfma_f32_16x16x32_bf16 v[204:207], a[252:255], a[228:231], v[204:207]
    buffer_load_dwordx4 v[100:103], v44, s[12:15], s72 offen sc1
    v_mfma_f32_16x16x32_bf16 v[204:207], a[248:251], a[224:227], v[204:207]
    ds_read_b128 a[164:167], v43 offset:26624
    v_perm_b32 v29, v127, v35, s37
    v_mfma_f32_16x16x32_bf16 v[208:211], a[248:251], a[48:51], v[208:211]
    ds_read_b32 a157, v59
    v_perm_b32 v63, v120, v35, s36
    v_mfma_f32_16x16x32_bf16 v[208:211], a[252:255], a[52:55], v[208:211]
    ds_read_b32 a158, v62
    ds_read_b32 a159, v29
    v_mfma_f32_16x16x32_bf16 v[212:215], a[252:255], a[60:63], v[212:215]
    buffer_load_dwordx2 v[80:81], v22, s[32:35], 0 offen offset:16
    v_mfma_f32_16x16x32_bf16 v[212:215], a[248:251], a[56:59], v[212:215]
    ds_read_b128 a[88:91], v42 offset:28672
    v_perm_b32 v5, v120, v35, s37
    v_mfma_f32_16x16x32_bf16 v[216:219], a[248:251], a[72:75], v[216:219]
    v_perm_b32 v6, v120, v35, s38
    v_perm_b32 v7, v120, v35, s39
    v_mfma_f32_16x16x32_bf16 v[216:219], a[252:255], a[76:79], v[216:219]
    ds_read_b128 a[92:95], v43 offset:28672
    ds_read_b32 a184, v63
    v_mfma_f32_16x16x32_bf16 v[220:223], a[252:255], a[84:87], v[220:223]
    buffer_load_dword v82, v23, s[32:35], 0 offen
    v_mfma_f32_16x16x32_bf16 v[220:223], a[248:251], a[80:83], v[220:223]
    v_perm_b32 v46, v124, v35, s36
    v_perm_b32 v57, v124, v35, s37
    v_mfma_f32_16x16x32_bf16 v[224:227], a[32:35], a[10:13], v[224:227]
    s_waitcnt lgkmcnt(6)
    ds_read_b128 a[192:195], v42 offset:30720
    v_perm_b32 v27, v124, v35, s38
    v_mfma_f32_16x16x32_bf16 v[224:227], a[36:39], a[146:149], v[224:227]
    s_waitcnt vmcnt(17)
    v_bitop3_b32 v31, v91, v95, s76 bitop3:0x7e
    v_perm_b32 v61, v124, v35, s39
    v_mfma_f32_16x16x32_bf16 v[228:231], a[36:39], a[170:173], v[228:231]
    ds_read_b128 a[196:199], v43 offset:30720
    v_cmp_lt_u32 vcc, 0xffff, v31
    v_mfma_f32_16x16x32_bf16 v[228:231], a[32:35], a[18:21], v[228:231]
    ds_read_b32 a185, v5
    v_perm_b32 v56, v121, v35, s36
    v_mfma_f32_16x16x32_bf16 v[232:235], a[32:35], a[234:237], v[232:235]
    ds_read_b32 a186, v6
    s_cbranch_vccnz L_slow6_0
L_back6_0:
    v_mfma_f32_16x16x32_bf16 v[232:235], a[36:39], a[122:125], v[232:235]
    ds_read_b32 a187, v7
    v_perm_b32 v58, v121, v35, s37
    v_mfma_f32_16x16x32_bf16 v[236:239], a[36:39], a[106:109], v[236:239]
    s_waitcnt vmcnt(15)
    v_perm_b32 v59, v121, v35, s38
    v_bitop3_b32 v60, v51, v55, s76 bitop3:0x7e
    v_mfma_f32_16x16x32_bf16 v[236:239], a[32:35], a[226:229], v[236:239]
    ds_read_b32 a188, v46
    v_cmp_lt_u32 vcc, 0xffff, v60
    v_mfma_f32_16x16x32_bf16 v[240:243], a[32:35], a[50:53], v[240:243]
    ds_read_b32 a189, v57
    ds_read_b32 a190, v27
    v_mfma_f32_16x16x32_bf16 v[240:243], a[36:39], a[130:133], v[240:243]
    v_perm_b32 v62, v121, v35, s39
    s_cbranch_vccnz L_slow6_1
L_back6_1:
    v_mfma_f32_16x16x32_bf16 v[244:247], a[36:39], a[162:165], v[244:247]
    ds_read_b32 a191, v61
    v_perm_b32 v29, v125, v35, s36
    v_mfma_f32_16x16x32_bf16 v[244:247], a[32:35], a[58:61], v[244:247]
    s_waitcnt lgkmcnt(7)
    ds_read_b32 a208, v56
    v_perm_b32 v63, v125, v35, s37
    v_mfma_f32_16x16x32_bf16 v[248:251], a[32:35], a[74:77], v[248:251]
    s_barrier
L_pad3:
    s_cbranch_execz L_pad4
    v_mfma_f32_16x16x32_bf16 v[248:251], a[36:39], a[90:93], v[248:251]
    buffer_load_dwordx4 v36, s[8:11], s56 offen offset:0  lds
    v_mfma_f32_16x16x32_bf16 v[252:255], a[36:39], a[194:197], v[252:255]
    ds_read_b32 a209, v58
    v_perm_b32 v31, v125, v35, s38
    v_mfma_f32_16x16x32_bf16 v[252:255], a[32:35], a[82:85], v[252:255]
    ds_read_b32 a210, v59
    v_perm_b32 v5, v125, v35, s39
    v_mfma_f32_16x16x32_bf16 v[128:131], a[0:3], a[144:147], v[128:131]
    ds_read_b32 a211, v62
    ds_read_b32 a212, v29
    v_mfma_f32_16x16x32_bf16 v[128:131], a[4:7], a[148:151], v[128:131]
    buffer_load_dwordx4 v37, s[8:11], s56 offen offset:1024  lds
    v_mfma_f32_16x16x32_bf16 v[132:135], a[4:7], a[172:175], v[132:135]
    v_perm_b32 v6, v122, v35, s36
    v_perm_b32 v7, v122, v35, s37
    v_mfma_f32_16x16x32_bf16 v[132:135], a[0:3], a[168:171], v[132:135]
    ds_read_b32 a213, v63
    v_perm_b32 v46, v122, v35, s38
    v_mfma_f32_16x16x32_bf16 v[136:139], a[0:3], a[120:123], v[136:139]
    ds_read_b32 a214, v31
    ds_read_b32 a215, v5
    v_mfma_f32_16x16x32_bf16 v[136:139], a[4:7], a[124:127], v[136:139]
    buffer_load_dwordx4 v38, s[8:11], s56 offen offset:2048  lds
    v_mfma_f32_16x16x32_bf16 v[140:143], a[4:7], a[108:111], v[140:143]
    v_perm_b32 v60, v122, v35, s39
    v_perm_b32 v57, v126, v35, s36
    v_mfma_f32_16x16x32_bf16 v[140:143], a[0:3], a[104:107], v[140:143]
    v_perm_b32 v27, v126, v35, s37
    v_perm_b32 v61, v126, v35, s38
    v_mfma_f32_16x16x32_bf16 v[144:147], a[0:3], a[128:131], v[144:147]
    ds_read_b32 a216, v6
    ds_read_b32 a217, v7
    v_mfma_f32_16x16x32_bf16 v[144:147], a[4:7], a[132:135], v[144:147]
    buffer_load_dwordx4 v39, s[8:11], s56 offen offset:3072  lds
    v_mfma_f32_16x16x32_bf16 v[148:151], a[4:7], a[164:167], v[148:151]
    s_add_u32 m0, s57, 81920
    ds_read_b32 a218, v46
    v_perm_b32 v56, v126, v35, s39
    v_mfma_f32_16x16x32_bf16 v[148:151], a[0:3], a[160:163], v[148:151]
    ds_read_b128 a[136:139], v40 offset:0
    v_perm_b32 v58, v91, v35, s36
    v_mfma_f32_16x16x32_bf16 v[152:155], a[0:3], a[88:91], v[152:155]
    ds_read_b128 a[140:143], v41 offset:0
    ds_read_b32 a219, v60
    v_mfma_f32_16x16x32_bf16 v[152:155], a[4:7], a[92:95], v[152:155]
    buffer_load_dwordx4 v36, s[8:11], s3 offen offset:0  lds
    v_mfma_f32_16x16x32_bf16 v[156:159], a[4:7], a[196:199], v[156:159]
    ds_read_b128 a[240:243], v40 offset:2048
    v_perm_b32 v59, v91, v35, s37
    v_mfma_f32_16x16x32_bf16 v[156:159], a[0:3], a[192:195], v[156:159]
    ds_read_b128 a[244:247], v41 offset:2048
    ds_read_b32 a220, v57
    v_mfma_f32_16x16x32_bf16 v[160:163], a[24:27], a[144:147], v[160:163]
    ds_read_b32 a221, v27
    ds_read_b32 a222, v61
    v_mfma_f32_16x16x32_bf16 v[160:163], a[28:31], a[148:151], v[160:163]
    buffer_load_dwordx4 v37, s[8:11], s3 offen offset:1024  lds
    v_mfma_f32_16x16x32_bf16 v[164:167], a[28:31], a[172:175], v[164:167]
    ds_read_b128 a[64:67], v40 offset:4096
    v_perm_b32 v62, v95, v35, s36
    v_mfma_f32_16x16x32_bf16 v[164:167], a[24:27], a[168:171], v[164:167]
    ds_read_b32 a223, v56
    v_perm_b32 v29, v95, v35, s37
    v_mfma_f32_16x16x32_bf16 v[168:171], a[24:27], a[120:123], v[168:171]
    ds_read_b32 a200, v58
    ds_read_b32 a201, v59
    v_mfma_f32_16x16x32_bf16 v[168:171], a[28:31], a[124:127], v[168:171]
    buffer_load_dwordx4 v38, s[8:11], s3 offen offset:2048  lds
    v_mfma_f32_16x16x32_bf16 v[172:175], a[28:31], a[108:111], v[172:175]
    ds_read_b128 a[68:71], v41 offset:4096
    v_perm_b32 v63, v51, v35, s36
    v_mfma_f32_16x16x32_bf16 v[172:175], a[24:27], a[104:107], v[172:175]
    v_perm_b32 v31, v51, v35, s37
    v_perm_b32 v5, v55, v35, s36
    v_mfma_f32_16x16x32_bf16 v[176:179], a[24:27], a[128:131], v[176:179]
    ds_read_b128 a[248:251], v40 offset:6144
    v_perm_b32 v6, v55, v35, s37
    v_mfma_f32_16x16x32_bf16 v[176:179], a[28:31], a[132:135], v[176:179]
    ds_read_b32 a202, v62
    ds_read_b32 a203, v29
    v_mfma_f32_16x16x32_bf16 v[180:183], a[28:31], a[164:167], v[180:183]
    buffer_load_dwordx4 v39, s[8:11], s3 offen offset:3072  lds
    v_mfma_f32_16x16x32_bf16 v[180:183], a[24:27], a[160:163], v[180:183]
    ds_read_b128 a[252:255], v41 offset:6144
    v_perm_b32 v7, v88, v35, s36
    v_mfma_f32_16x16x32_bf16 v[184:187], a[24:27], a[88:91], v[184:187]
    v_perm_b32 v46, v88, v35, s37
    v_perm_b32 v60, v88, v35, s38
    v_mfma_f32_16x16x32_bf16 v[184:187], a[28:31], a[92:95], v[184:187]
    ds_read_b32 a204, v63
    v_perm_b32 v57, v88, v35, s39
    v_mfma_f32_16x16x32_bf16 v[188:191], a[28:31], a[196:199], v[188:191]
    ds_read_b128 a[8:11], v40 offset:8192
    v_perm_b32 v27, v92, v35, s36
    v_mfma_f32_16x16x32_bf16 v[188:191], a[24:27], a[192:195], v[188:191]
    ds_read_b32 a205, v31
    ds_read_b32 a206, v5
    v_mfma_f32_16x16x32_bf16 v[192:195], a[40:43], a[144:147], v[192:195]
    ds_read_b32 a207, v6
    v_perm_b32 v61, v92, v35, s37
    v_mfma_f32_16x16x32_bf16 v[192:195], a[44:47], a[148:151], v[192:195]
    ds_read_b128 a[12:15], v41 offset:8192
    v_perm_b32 v56, v92, v35, s38
    v_mfma_f32_16x16x32_bf16 v[196:199], a[44:47], a[172:175], v[196:199]
    ds_read_b32 a16, v7
    v_perm_b32 v58, v92, v35, s39
    v_mfma_f32_16x16x32_bf16 v[196:199], a[40:43], a[168:171], v[196:199]
    ds_read_b32 a17, v46
    ds_read_b32 a18, v60
    v_mfma_f32_16x16x32_bf16 v[200:203], a[40:43], a[120:123], v[200:203]
    ds_read_b128 a[232:235], v40 offset:10240
    v_perm_b32 v59, v48, v35, s36
    v_mfma_f32_16x16x32_bf16 v[200:203], a[44:47], a[124:127], v[200:203]
    ds_read_b32 a19, v57
    ds_read_b32 a20, v27
    v_mfma_f32_16x16x32_bf16 v[204:207], a[44:47], a[108:111], v[204:207]
    v_perm_b32 v62, v48, v35, s37
    v_perm_b32 v29, v48, v35, s38
    v_mfma_f32_16x16x32_bf16 v[204:207], a[40:43], a[104:107], v[204:207]
    ds_read_b128 a[236:239], v41 offset:10240
    ds_read_b32 a21, v61
    v_mfma_f32_16x16x32_bf16 v[208:211], a[40:43], a[128:131], v[208:211]
    ds_read_b32 a22, v56
    v_perm_b32 v63, v48, v35, s39
    v_mfma_f32_16x16x32_bf16 v[208:211], a[44:47], a[132:135], v[208:211]
    ds_read_b32 a23, v58
    v_perm_b32 v31, v52, v35, s36
    v_mfma_f32_16x16x32_bf16 v[212:215], a[44:47], a[164:167], v[212:215]
    ds_read_b128 a[224:227], v40 offset:12288
    ds_read_b32 a48, v59
    v_mfma_f32_16x16x32_bf16 v[212:215], a[40:43], a[160:163], v[212:215]
    ds_read_b32 a49, v62
    v_perm_b32 v5, v52, v35, s37
    v_mfma_f32_16x16x32_bf16 v[216:219], a[40:43], a[88:91], v[216:219]
    ds_read_b32 a50, v29
    v_perm_b32 v6, v52, v35, s38
    v_mfma_f32_16x16x32_bf16 v[216:219], a[44:47], a[92:95], v[216:219]
    ds_read_b128 a[228:231], v41 offset:12288
    v_perm_b32 v7, v52, v35, s39
    v_mfma_f32_16x16x32_bf16 v[220:223], a[44:47], a[196:199], v[220:223]
    ds_read_b32 a51, v63
    ds_read_b32 a52, v31
    v_mfma_f32_16x16x32_bf16 v[220:223], a[40:43], a[192:195], v[220:223]
    s_waitcnt lgkmcnt(11)
    v_perm_b32 v46, v89, v35, s36
    v_perm_b32 v60, v89, v35, s37
    v_mfma_f32_16x16x32_bf16 v[128:131], a[96:99], a[136:139], v[128:131]
    ds_read_b32 a53, v5
    ds_read_b32 a54, v6
    v_mfma_f32_16x16x32_bf16 v[128:131], a[100:103], a[140:143], v[128:131]
    ds_read_b32 a55, v7
    v_perm_b32 v57, v89, v35, s38
    v_mfma_f32_16x16x32_bf16 v[132:135], a[100:103], a[244:247], v[132:135]
    ds_read_b32 a56, v46
    v_perm_b32 v27, v89, v35, s39
    v_mfma_f32_16x16x32_bf16 v[132:135], a[96:99], a[240:243], v[132:135]
    ds_read_b32 a57, v60
    v_perm_b32 v61, v93, v35, s36
    v_mfma_f32_16x16x32_bf16 v[136:139], a[96:99], a[64:67], v[136:139]
    ds_read_b32 a58, v57
    v_perm_b32 v56, v93, v35, s37
    v_mfma_f32_16x16x32_bf16 v[136:139], a[100:103], a[68:71], v[136:139]
    ds_read_b32 a59, v27
    v_perm_b32 v58, v93, v35, s38
    v_mfma_f32_16x16x32_bf16 v[140:143], a[100:103], a[252:255], v[140:143]
    ds_read_b128 a[72:75], v40 offset:16384
    v_perm_b32 v59, v93, v35, s39
    v_mfma_f32_16x16x32_bf16 v[140:143], a[96:99], a[248:251], v[140:143]
    ds_read_b32 a60, v61
    v_perm_b32 v62, v49, v35, s36
    v_mfma_f32_16x16x32_bf16 v[144:147], a[96:99], a[8:11], v[144:147]
    ds_read_b32 a61, v56
    v_perm_b32 v29, v49, v35, s37
    v_mfma_f32_16x16x32_bf16 v[144:147], a[100:103], a[12:15], v[144:147]
    s_waitcnt lgkmcnt(8)
    ds_read_b128 a[76:79], v41 offset:16384
    ds_read_b32 a62, v58
    v_mfma_f32_16x16x32_bf16 v[148:151], a[100:103], a[236:239], v[148:151]
    ds_read_b32 a63, v59
    v_perm_b32 v63, v49, v35, s38
    v_mfma_f32_16x16x32_bf16 v[148:151], a[96:99], a[232:235], v[148:151]
    ds_read_b32 a32, v62
    v_perm_b32 v31, v49, v35, s39
    v_mfma_f32_16x16x32_bf16 v[152:155], a[96:99], a[224:227], v[152:155]
    ds_read_b128 a[80:83], v40 offset:18432
    ds_read_b32 a33, v29
    v_mfma_f32_16x16x32_bf16 v[152:155], a[100:103], a[228:231], v[152:155]
    ds_read_b32 a34, v63
    v_perm_b32 v5, v53, v35, s36
    v_mfma_f32_16x16x32_bf16 v[160:163], a[176:179], a[136:139], v[160:163]
    ds_read_b32 a35, v31
    v_perm_b32 v6, v53, v35, s37
    v_mfma_f32_16x16x32_bf16 v[160:163], a[180:183], a[140:143], v[160:163]
    ds_read_b128 a[84:87], v41 offset:18432
    v_perm_b32 v7, v53, v35, s38
    v_mfma_f32_16x16x32_bf16 v[164:167], a[180:183], a[244:247], v[164:167]
    s_waitcnt vmcnt(12)
    ds_read_b32 a36, v5
    v_bitop3_b32 v46, v71, v75, s76 bitop3:0x7e
    v_mfma_f32_16x16x32_bf16 v[164:167], a[176:179], a[240:243], v[164:167]
    ds_read_b32 a37, v6
    v_cmp_lt_u32 vcc, 0xffff, v46
    v_mfma_f32_16x16x32_bf16 v[168:171], a[176:179], a[64:67], v[168:171]
    ds_read_b128 a[0:3], v40 offset:20480
    v_perm_b32 v60, v53, v35, s39
    v_mfma_f32_16x16x32_bf16 v[168:171], a[180:183], a[68:71], v[168:171]
    ds_read_b32 a38, v7
    s_cbranch_vccnz L_slow7_0
L_back7_0:
    v_mfma_f32_16x16x32_bf16 v[172:175], a[180:183], a[252:255], v[172:175]
    ds_read_b32 a39, v60
    v_perm_b32 v57, v90, v35, s36
    v_mfma_f32_16x16x32_bf16 v[172:175], a[176:179], a[248:251], v[172:175]
    ds_read_b128 a[4:7], v41 offset:20480
    v_perm_b32 v27, v90, v35, s37
    v_mfma_f32_16x16x32_bf16 v[176:179], a[176:179], a[8:11], v[176:179]
    ds_read_b32 a24, v57
    v_perm_b32 v61, v90, v35, s38
    v_mfma_f32_16x16x32_bf16 v[176:179], a[180:183], a[12:15], v[176:179]
    s_waitcnt vmcnt(10)
    ds_read_b32 a25, v27
    v_bitop3_b32 v56, v79, v103, s76 bitop3:0x7e
    v_mfma_f32_16x16x32_bf16 v[180:183], a[180:183], a[236:239], v[180:183]
    ds_read_b128 a[144:147], v40 offset:22528
    v_cmp_lt_u32 vcc, 0xffff, v56
    v_mfma_f32_16x16x32_bf16 v[180:183], a[176:179], a[232:235], v[180:183]
    ds_read_b32 a26, v61
    v_perm_b32 v58, v90, v35, s39
    v_mfma_f32_16x16x32_bf16 v[184:187], a[176:179], a[224:227], v[184:187]
    v_perm_b32 v59, v94, v35, s36
    s_cbranch_vccnz L_slow7_1
L_back7_1:
    v_mfma_f32_16x16x32_bf16 v[184:187], a[180:183], a[228:231], v[184:187]
    ds_read_b128 a[148:151], v41 offset:22528
    v_perm_b32 v62, v94, v35, s37
    v_mfma_f32_16x16x32_bf16 v[192:195], a[112:115], a[136:139], v[192:195]
    ds_read_b32 a27, v58
    v_perm_b32 v29, v94, v35, s38
    v_mfma_f32_16x16x32_bf16 v[192:195], a[116:119], a[140:143], v[192:195]
    ds_read_b32 a28, v59
    v_perm_b32 v63, v94, v35, s39
    v_mfma_f32_16x16x32_bf16 v[196:199], a[116:119], a[244:247], v[196:199]
    ds_read_b128 a[168:171], v40 offset:24576
    v_perm_b32 v31, v50, v35, s36
    v_mfma_f32_16x16x32_bf16 v[196:199], a[112:115], a[240:243], v[196:199]
    ds_read_b32 a29, v62
    v_perm_b32 v5, v50, v35, s37
    v_mfma_f32_16x16x32_bf16 v[200:203], a[112:115], a[64:67], v[200:203]
    ds_read_b32 a30, v29
    v_perm_b32 v6, v50, v35, s38
    v_mfma_f32_16x16x32_bf16 v[200:203], a[116:119], a[68:71], v[200:203]
    ds_read_b128 a[172:175], v41 offset:24576
    ds_read_b32 a31, v63
    v_mfma_f32_16x16x32_bf16 v[204:207], a[116:119], a[252:255], v[204:207]
    ds_read_b32 a120, v31
    v_perm_b32 v46, v50, v35, s39
    v_mfma_f32_16x16x32_bf16 v[204:207], a[112:115], a[248:251], v[204:207]
    ds_read_b32 a121, v5
    v_perm_b32 v7, v54, v35, s36
    v_mfma_f32_16x16x32_bf16 v[208:211], a[112:115], a[8:11], v[208:211]
    ds_read_b128 a[104:107], v40 offset:26624
    ds_read_b32 a122, v6
    v_mfma_f32_16x16x32_bf16 v[208:211], a[116:119], a[12:15], v[208:211]
    ds_read_b32 a123, v46
    v_perm_b32 v60, v54, v35, s37
    v_mfma_f32_16x16x32_bf16 v[212:215], a[116:119], a[236:239], v[212:215]
    ds_read_b32 a124, v7
    v_perm_b32 v57, v54, v35, s38
    v_mfma_f32_16x16x32_bf16 v[212:215], a[112:115], a[232:235], v[212:215]
    ds_read_b128 a[108:111], v41 offset:26624
    v_perm_b32 v27, v54, v35, s39
    v_mfma_f32_16x16x32_bf16 v[216:219], a[112:115], a[224:227], v[216:219]
    ds_read_b32 a125, v60
    v_perm_b32 v56, v71, v35, s36
    v_mfma_f32_16x16x32_bf16 v[216:219], a[116:119], a[228:231], v[216:219]
    ds_read_b32 a126, v57
    v_perm_b32 v61, v71, v35, s37
    v_mfma_f32_16x16x32_bf16 v[224:227], a[152:155], a[138:141], v[224:227]
    s_waitcnt lgkmcnt(9)
    ds_read_b128 a[128:131], v40 offset:28672
    v_perm_b32 v58, v75, v35, s36
    v_mfma_f32_16x16x32_bf16 v[224:227], a[156:159], a[74:77], v[224:227]
    ds_read_b128 a[132:135], v41 offset:28672
    ds_read_b32 a127, v27
    v_mfma_f32_16x16x32_bf16 v[228:231], a[156:159], a[82:85], v[228:231]
    ds_read_b32 a160, v56
    v_perm_b32 v59, v75, v35, s37
    v_mfma_f32_16x16x32_bf16 v[228:231], a[152:155], a[242:245], v[228:231]
    ds_read_b32 a161, v61
    v_perm_b32 v62, v79, v35, s36
    v_mfma_f32_16x16x32_bf16 v[232:235], a[152:155], a[66:69], v[232:235]
    ds_read_b32 a162, v58
    v_perm_b32 v29, v79, v35, s37
    v_mfma_f32_16x16x32_bf16 v[232:235], a[156:159], a[2:5], v[232:235]
    ds_read_b32 a163, v59
    v_perm_b32 v63, v103, v35, s36
    v_mfma_f32_16x16x32_bf16 v[236:239], a[156:159], a[146:149], v[236:239]
    ds_read_b32 a164, v62
    v_perm_b32 v31, v103, v35, s37
    v_mfma_f32_16x16x32_bf16 v[236:239], a[152:155], a[250:253], v[236:239]
    ds_read_b32 a165, v29
    v_perm_b32 v5, v68, v35, s36
    v_mfma_f32_16x16x32_bf16 v[240:243], a[152:155], a[10:13], v[240:243]
    ds_read_b32 a166, v63
    v_perm_b32 v6, v68, v35, s37
    v_mfma_f32_16x16x32_bf16 v[240:243], a[156:159], a[170:173], v[240:243]
    s_waitcnt lgkmcnt(9)
    ds_read_b32 a167, v31
    v_perm_b32 v46, v68, v35, s38
    v_mfma_f32_16x16x32_bf16 v[244:247], a[156:159], a[106:109], v[244:247]
    ds_read_b32 a88, v5
    v_perm_b32 v7, v68, v35, s39
    v_mfma_f32_16x16x32_bf16 v[244:247], a[152:155], a[234:237], v[244:247]
    ds_read_b32 a89, v6
    v_perm_b32 v60, v72, v35, s36
    v_mfma_f32_16x16x32_bf16 v[248:251], a[152:155], a[226:229], v[248:251]
    s_waitcnt lgkmcnt(8)
    ds_read_b32 a90, v46
    v_perm_b32 v57, v72, v35, s37
    v_mfma_f32_16x16x32_bf16 v[248:251], a[156:159], a[130:133], v[248:251]
    ds_read_b32 a91, v7
    v_perm_b32 v27, v72, v35, s38
    v_mfma_f32_16x16x32_bf16 v[128:131], a[184:187], a[72:75], v[128:131]
    ds_read_b32 a92, v60
    v_perm_b32 v56, v72, v35, s39
    v_mfma_f32_16x16x32_bf16 v[128:131], a[188:191], a[76:79], v[128:131]
    ds_read_b32 a93, v57
    v_perm_b32 v61, v76, v35, s36
    v_mfma_f32_16x16x32_bf16 v[132:135], a[188:191], a[84:87], v[132:135]
    ds_read_b32 a94, v27
    v_perm_b32 v58, v76, v35, s37
    v_mfma_f32_16x16x32_bf16 v[132:135], a[184:187], a[80:83], v[132:135]
    ds_read_b32 a95, v56
    v_perm_b32 v59, v76, v35, s38
    v_mfma_f32_16x16x32_bf16 v[136:139], a[184:187], a[0:3], v[136:139]
    ds_read_b32 a40, v61
    v_perm_b32 v62, v76, v35, s39
    v_mfma_f32_16x16x32_bf16 v[136:139], a[188:191], a[4:7], v[136:139]
    ds_read_b32 a41, v58
    v_perm_b32 v29, v100, v35, s36
    v_mfma_f32_16x16x32_bf16 v[140:143], a[188:191], a[148:151], v[140:143]
    ds_read_b32 a42, v59
    v_perm_b32 v63, v100, v35, s37
    v_mfma_f32_16x16x32_bf16 v[140:143], a[184:187], a[144:147], v[140:143]
    s_waitcnt vmcnt(0)
    ds_read_b32 a43, v62
    v_perm_b32 v31, v100, v35, s38
    v_mfma_f32_16x16x32_bf16 v[144:147], a[184:187], a[168:171], v[144:147]
    s_barrier
    v_mfma_f32_16x16x32_bf16 v[144:147], a[188:191], a[172:175], v[144:147]
    buffer_atomic_add v45, v1, s[24:27], s77 offen sc0 sc1
    v_mfma_f32_16x16x32_bf16 v[148:151], a[188:191], a[108:111], v[148:151]
    ds_read_b32 a44, v29
    ds_read_b32 a45, v63
    v_mfma_f32_16x16x32_bf16 v[148:151], a[184:187], a[104:107], v[148:151]
    ds_read_b32 a46, v31
    v_perm_b32 v5, v100, v35, s39
    v_mfma_f32_16x16x32_bf16 v[152:155], a[184:187], a[128:131], v[152:155]
    ds_read_b32 a47, v5
    v_perm_b32 v6, v69, v35, s36
    v_mfma_f32_16x16x32_bf16 v[152:155], a[188:191], a[132:135], v[152:155]
    ds_read_b128 a[192:195], v40 offset:32768
    v_perm_b32 v46, v69, v35, s37
    v_mfma_f32_16x16x32_bf16 v[160:163], a[208:211], a[72:75], v[160:163]
    ds_read_b32 a136, v6
    v_perm_b32 v7, v69, v35, s38
    v_mfma_f32_16x16x32_bf16 v[160:163], a[212:215], a[76:79], v[160:163]
    ds_read_b32 a137, v46
    v_perm_b32 v60, v69, v35, s39
    v_mfma_f32_16x16x32_bf16 v[164:167], a[212:215], a[84:87], v[164:167]
    ds_read_b128 a[196:199], v41 offset:32768
    v_perm_b32 v57, v73, v35, s36
    v_mfma_f32_16x16x32_bf16 v[164:167], a[208:211], a[80:83], v[164:167]
    ds_read_b32 a138, v7
    v_perm_b32 v27, v73, v35, s37
    v_mfma_f32_16x16x32_bf16 v[168:171], a[208:211], a[0:3], v[168:171]
    ds_read_b32 a139, v60
    v_perm_b32 v56, v73, v35, s38
    v_mfma_f32_16x16x32_bf16 v[168:171], a[212:215], a[4:7], v[168:171]
    ds_read_b32 a140, v57
    v_perm_b32 v61, v73, v35, s39
    v_mfma_f32_16x16x32_bf16 v[172:175], a[212:215], a[148:151], v[172:175]
    ds_read_b128 a[240:243], v40 offset:49152
    v_perm_b32 v58, v77, v35, s36
    v_mfma_f32_16x16x32_bf16 v[172:175], a[208:211], a[144:147], v[172:175]
    ds_read_b32 a141, v27
    v_perm_b32 v59, v77, v35, s37
    v_mfma_f32_16x16x32_bf16 v[176:179], a[208:211], a[168:171], v[176:179]
    s_mov_b32 m0, s60
    ds_read_b32 a142, v56
    v_perm_b32 v62, v77, v35, s38
    v_mfma_f32_16x16x32_bf16 v[176:179], a[212:215], a[172:175], v[176:179]
    ds_read_b128 a[244:247], v41 offset:49152
    ds_read_b32 a143, v61
    v_mfma_f32_16x16x32_bf16 v[180:183], a[212:215], a[108:111], v[180:183]
    ds_read_b32 a64, v58
    v_perm_b32 v29, v77, v35, s39
    v_mfma_f32_16x16x32_bf16 v[180:183], a[208:211], a[104:107], v[180:183]
    ds_read_b32 a65, v59
    v_perm_b32 v63, v101, v35, s36
    v_mfma_f32_16x16x32_bf16 v[184:187], a[208:211], a[128:131], v[184:187]
    ds_read_b32 a68, v63
    ds_read_b32 a66, v62
    v_mfma_f32_16x16x32_bf16 v[184:187], a[212:215], a[132:135], v[184:187]
    ds_read_b128 a[248:251], v42 offset:0
    v_perm_b32 v31, v101, v35, s37
    v_mfma_f32_16x16x32_bf16 v[192:195], a[216:219], a[72:75], v[192:195]
    ds_read_b32 a69, v31
    ds_read_b32 a67, v29
    v_mfma_f32_16x16x32_bf16 v[192:195], a[220:223], a[76:79], v[192:195]
    ds_read_b128 a[252:255], v43 offset:0
    v_perm_b32 v5, v101, v35, s38
    v_mfma_f32_16x16x32_bf16 v[196:199], a[220:223], a[84:87], v[196:199]
    ds_read_b32 a70, v5
    v_perm_b32 v6, v101, v35, s39
    v_mfma_f32_16x16x32_bf16 v[196:199], a[216:219], a[80:83], v[196:199]
    ds_read_b32 a71, v6
    v_perm_b32 v46, v70, v35, s36
    v_mfma_f32_16x16x32_bf16 v[200:203], a[216:219], a[0:3], v[200:203]
    ds_read_b32 a8, v46
    v_perm_b32 v7, v70, v35, s37
    v_mfma_f32_16x16x32_bf16 v[200:203], a[220:223], a[4:7], v[200:203]
    ds_read_b32 a9, v7
    v_perm_b32 v60, v70, v35, s38
    v_mfma_f32_16x16x32_bf16 v[204:207], a[220:223], a[148:151], v[204:207]
    ds_read_b128 a[232:235], v42 offset:16384
    v_perm_b32 v57, v70, v35, s39
    v_mfma_f32_16x16x32_bf16 v[204:207], a[216:219], a[144:147], v[204:207]
    ds_read_b32 a10, v60
    v_perm_b32 v27, v74, v35, s36
    v_mfma_f32_16x16x32_bf16 v[208:211], a[216:219], a[168:171], v[208:211]
    ds_read_b32 a12, v27
    v_perm_b32 v56, v74, v35, s37
    v_mfma_f32_16x16x32_bf16 v[208:211], a[220:223], a[172:175], v[208:211]
    ds_read_b128 a[236:239], v43 offset:16384
    v_perm_b32 v61, v74, v35, s38
    v_mfma_f32_16x16x32_bf16 v[212:215], a[220:223], a[108:111], v[212:215]
    ds_read_b32 a13, v56
    ds_read_b32 a11, v57
    v_mfma_f32_16x16x32_bf16 v[212:215], a[216:219], a[104:107], v[212:215]
    ds_read_b32 a14, v61
    v_perm_b32 v58, v74, v35, s39
    v_mfma_f32_16x16x32_bf16 v[216:219], a[216:219], a[128:131], v[216:219]
    ds_read_b32 a15, v58
    v_perm_b32 v59, v78, v35, s36
    v_mfma_f32_16x16x32_bf16 v[216:219], a[220:223], a[132:135], v[216:219]
    s_waitcnt lgkmcnt(9)
    ds_read_b128 a[224:227], v40 offset:34816
    v_perm_b32 v62, v78, v35, s37
    v_mfma_f32_16x16x32_bf16 v[224:227], a[200:203], a[194:197], v[224:227]
    s_mov_b32 s66, 0
    ds_read_b32 a72, v59
    v_lshlrev_b32 v84, 16, v82
    v_mfma_f32_16x16x32_bf16 v[224:227], a[204:207], a[242:245], v[224:227]
    s_mov_b32 s67, 14336
    ds_read_b32 a73, v62
    v_perm_b32 v63, v78, v35, s38
    v_mfma_f32_16x16x32_bf16 v[128:131], a[16:19], a[192:195], v[128:131]
    ds_read_b128 a[228:231], v41 offset:34816
    v_perm_b32 v29, v78, v35, s39
    v_mfma_f32_16x16x32_bf16 v[128:131], a[20:23], a[196:199], v[128:131]
    ds_read_b32 a74, v63
    v_and_b32 v85, 0xffff0000, v82
    v_mfma_f32_16x16x32_bf16 v[128:131], a[48:51], a[240:243], v[128:131]
    ds_read_b32 a75, v29
    v_perm_b32 v31, v102, v35, s36
    v_mfma_f32_16x16x32_bf16 v[128:131], a[52:55], a[244:247], v[128:131]
    ds_read_b128 a[80:83], v40 offset:51200
    v_perm_b32 v5, v102, v35, s37
    v_mfma_f32_16x16x32_bf16 v[160:163], a[56:59], a[192:195], v[160:163]
    ds_read_b32 a76, v31
    v_lshlrev_b32 v96, 16, v64
    v_mfma_f32_16x16x32_bf16 v[160:163], a[60:63], a[196:199], v[160:163]
    ds_read_b32 a77, v5
    v_perm_b32 v6, v102, v35, s38
    v_mfma_f32_16x16x32_bf16 v[160:163], a[32:35], a[240:243], v[160:163]
    ds_read_b128 a[84:87], v41 offset:51200
    v_and_b32 v97, 0xffff0000, v65
    v_mfma_f32_16x16x32_bf16 v[160:163], a[36:39], a[244:247], v[160:163]
    ds_read_b32 a78, v6
    v_perm_b32 v46, v102, v35, s39
    v_mfma_f32_16x16x32_bf16 v[192:195], a[24:27], a[192:195], v[192:195]
    ds_read_b128 a[0:3], v42 offset:2048
    v_lshlrev_b32 v98, 16, v67
    v_mfma_f32_16x16x32_bf16 v[192:195], a[28:31], a[196:199], v[192:195]
    ds_read_b32 a79, v46
    v_and_b32 v99, 0xffff0000, v80
    v_mfma_f32_16x16x32_bf16 v[192:195], a[120:123], a[240:243], v[192:195]
    ds_read_b128 a[4:7], v43 offset:2048
    v_and_b32 v104, 0xffff0000, v64
    v_mfma_f32_16x16x32_bf16 v[192:195], a[124:127], a[244:247], v[192:195]
    v_lshlrev_b32 v105, 16, v66
    v_and_b32 v106, 0xffff0000, v67
    v_mfma_f32_16x16x32_bf16 v[224:227], a[160:163], a[250:253], v[224:227]
    s_waitcnt lgkmcnt(7)
    v_lshlrev_b32 v107, 16, v81
    v_lshlrev_b32 v108, 16, v65
    v_mfma_f32_16x16x32_bf16 v[224:227], a[164:167], a[234:237], v[224:227]
    ds_read_b128 a[144:147], v42 offset:18432
    v_and_b32 v109, 0xffff0000, v66
    v_mfma_f32_16x16x32_bf16 v[128:131], a[88:91], a[248:251], v[128:131]
    v_lshlrev_b32 v110, 16, v80
    v_and_b32 v111, 0xffff0000, v81
    v_mfma_f32_16x16x32_bf16 v[128:131], a[92:95], a[252:255], v[128:131]
    v_mfma_f32_16x16x32_bf16 v[128:131], a[40:43], a[232:235], v[128:131]
    ds_read_b128 a[148:151], v43 offset:18432
    v_mfma_f32_16x16x32_bf16 v[128:131], a[44:47], a[236:239], v[128:131]
    ds_write_addtid_b32 v226 offset:28928
    ds_write_addtid_b32 v227 offset:29184
    v_mfma_f32_16x16x32_bf16 v[160:163], a[136:139], a[248:251], v[160:163]
    v_mfma_f32_16x16x32_bf16 v[160:163], a[140:143], a[252:255], v[160:163]
    v_mfma_f32_16x16x32_bf16 v[160:163], a[64:67], a[232:235], v[160:163]
    ds_read_b128 a[168:171], v40 offset:36864
    v_mfma_f32_16x16x32_bf16 v[160:163], a[68:71], a[236:239], v[160:163]
    s_nop 0
    v_mul_f32 v128, v128, v96
    v_mul_f32 v129, v129, v97
    v_mfma_f32_16x16x32_bf16 v[192:195], a[8:11], a[248:251], v[192:195]
    s_waitcnt lgkmcnt(1)
    s_barrier
    v_mfma_f32_16x16x32_bf16 v[192:195], a[12:15], a[252:255], v[192:195]
    ds_read2st64_b32 v[112:113], v30 offset0:113 offset1:114
    v_mul_f32 v130, v130, v98
L_pad4:
    s_cbranch_execz L_warmed
    v_mfma_f32_16x16x32_bf16 v[192:195], a[72:75], a[232:235], v[192:195]
    ds_read_b128 a[172:175], v41 offset:36864
    v_mul_f32 v131, v131, v99
    v_mfma_f32_16x16x32_bf16 v[192:195], a[76:79], a[236:239], v[192:195]
    v_mul_f32 v160, v160, v104
    v_cvt_pk_bf16_f32 v116, v128, v160
    v_mfma_f32_16x16x32_bf16 v[228:231], a[200:203], a[226:229], v[228:231]
    v_mul_f32 v161, v161, v105
    v_mul_f32 v162, v162, v106
    v_mfma_f32_16x16x32_bf16 v[228:231], a[204:207], a[82:85], v[228:231]
    ds_read_b128 a[104:107], v40 offset:53248
    v_cvt_pk_bf16_f32 v119, v130, v162
    v_mfma_f32_16x16x32_bf16 v[228:231], a[160:163], a[2:5], v[228:231]
    v_mul_f32 v163, v163, v107
    v_mfma_f32_16x16x32_bf16 v[228:231], a[164:167], a[146:149], v[228:231]
    v_mul_f32 v192, v192, v108
    v_mul_f32 v193, v193, v109
    v_mfma_f32_16x16x32_bf16 v[132:135], a[16:19], a[224:227], v[132:135]
    ds_read_b128 a[108:111], v41 offset:53248
    v_mul_f32 v194, v194, v110
    v_mfma_f32_16x16x32_bf16 v[132:135], a[20:23], a[228:231], v[132:135]
    v_mul_f32 v195, v195, v111
    v_cvt_pk_bf16_f32 v117, v192, v129
    v_mfma_f32_16x16x32_bf16 v[132:135], a[48:51], a[80:83], v[132:135]
    ds_write_b64 v26, v[116:117] offset:64512
    v_mfma_f32_16x16x32_bf16 v[132:135], a[52:55], a[84:87], v[132:135]
    ds_write_addtid_b32 v230 offset:30976
    v_cvt_pk_bf16_f32 v118, v161, v193
    v_mfma_f32_16x16x32_bf16 v[132:135], a[88:91], a[0:3], v[132:135]
    ds_write_b64 v26, v[118:119] offset:64520
    v_mfma_f32_16x16x32_bf16 v[132:135], a[92:95], a[4:7], v[132:135]
    ds_write_addtid_b32 v231 offset:31232
    v_cvt_pk_bf16_f32 v120, v194, v131
    v_mfma_f32_16x16x32_bf16 v[132:135], a[40:43], a[144:147], v[132:135]
    ds_read_b128 a[128:131], v42 offset:4096
    v_cvt_pk_bf16_f32 v121, v163, v195
    v_mfma_f32_16x16x32_bf16 v[132:135], a[44:47], a[148:151], v[132:135]
    ds_write_b64 v26, v[120:121] offset:64528
    v_mfma_f32_16x16x32_bf16 v[164:167], a[56:59], a[224:227], v[164:167]
    s_waitcnt lgkmcnt(7)
    v_add_f32 v224, v224, v112
    v_mul_f32 v224, v224, v84
    v_mfma_f32_16x16x32_bf16 v[164:167], a[60:63], a[228:231], v[164:167]
    v_add_f32 v225, v225, v113
    v_mul_f32 v225, v225, v85
    v_mfma_f32_16x16x32_bf16 v[164:167], a[32:35], a[80:83], v[164:167]
    ds_read_b128 a[132:135], v43 offset:4096
    v_cvt_pk_bf16_f32 v112, v224, v225
    v_mfma_f32_16x16x32_bf16 v[164:167], a[36:39], a[84:87], v[164:167]
    ds_write_b32 v28, v112 offset:64512
    v_mfma_f32_16x16x32_bf16 v[164:167], a[136:139], a[0:3], v[164:167]
    ds_read_b128 a[192:195], v42 offset:20480
    v_mul_f32 v132, v132, v96
    v_mfma_f32_16x16x32_bf16 v[164:167], a[140:143], a[4:7], v[164:167]
    v_mul_f32 v133, v133, v97
    v_mul_f32 v134, v134, v98
    v_mfma_f32_16x16x32_bf16 v[164:167], a[64:67], a[144:147], v[164:167]
    ds_read_b128 a[196:199], v43 offset:20480
    v_mul_f32 v135, v135, v99
    v_mfma_f32_16x16x32_bf16 v[164:167], a[68:71], a[148:151], v[164:167]
    v_mfma_f32_16x16x32_bf16 v[196:199], a[24:27], a[224:227], v[196:199]
    s_waitcnt lgkmcnt(2)
    s_barrier
    v_mfma_f32_16x16x32_bf16 v[196:199], a[28:31], a[228:231], v[196:199]
    ds_read_b128 v[124:127], v24 offset:64512
    ds_read2st64_b32 v[88:89], v30 offset0:121 offset1:122
    v_mfma_f32_16x16x32_bf16 v[196:199], a[120:123], a[80:83], v[196:199]
    ds_read_b128 v[92:95], v24 offset:65440
    v_mfma_f32_16x16x32_bf16 v[196:199], a[124:127], a[84:87], v[196:199]
    ds_read_b128 a[240:243], v40 offset:38912
    v_mul_f32 v164, v164, v104
    v_mfma_f32_16x16x32_bf16 v[196:199], a[8:11], a[0:3], v[196:199]
    v_cvt_pk_bf16_f32 v48, v132, v164
    v_mul_f32 v165, v165, v105
    v_mfma_f32_16x16x32_bf16 v[196:199], a[12:15], a[4:7], v[196:199]
    ds_read_b128 a[244:247], v41 offset:38912
    v_mul_f32 v166, v166, v106
    v_mfma_f32_16x16x32_bf16 v[196:199], a[72:75], a[144:147], v[196:199]
    v_cvt_pk_bf16_f32 v51, v134, v166
    v_mul_f32 v167, v167, v107
    v_mfma_f32_16x16x32_bf16 v[196:199], a[76:79], a[148:151], v[196:199]
    s_waitcnt lgkmcnt(3)
    v_mfma_f32_16x16x32_bf16 v[232:235], a[200:203], a[170:173], v[232:235]
    buffer_store_dwordx4 v[124:127], v25, s[16:19], s66 offen sc1
    v_mfma_f32_16x16x32_bf16 v[232:235], a[204:207], a[106:109], v[232:235]
    s_mov_b32 s66, 114688
    v_add_f32 v228, v228, v88
    v_mul_f32 v228, v228, v84
    v_mfma_f32_16x16x32_bf16 v[232:235], a[160:163], a[130:133], v[232:235]
    v_add_f32 v229, v229, v89
    v_mul_f32 v229, v229, v85
    v_mfma_f32_16x16x32_bf16 v[232:235], a[164:167], a[194:197], v[232:235]
    s_waitcnt lgkmcnt(2)
    ds_read_b128 a[248:251], v40 offset:55296
    v_mfma_f32_16x16x32_bf16 v[136:139], a[16:19], a[168:171], v[136:139]
    buffer_store_dwordx4 v[92:95], v25, s[16:19], s67 offen sc1
    v_mfma_f32_16x16x32_bf16 v[136:139], a[20:23], a[172:175], v[136:139]
    s_mov_b32 s67, 129024
    ds_read_b128 a[252:255], v41 offset:55296
    v_cvt_pk_bf16_f32 v88, v228, v229
    v_mfma_f32_16x16x32_bf16 v[136:139], a[48:51], a[104:107], v[136:139]
    ds_write_b32 v28, v88 offset:0
    v_mfma_f32_16x16x32_bf16 v[136:139], a[52:55], a[108:111], v[136:139]
    ds_write_addtid_b32 v234 offset:33024
    v_mul_f32 v196, v196, v108
    v_mfma_f32_16x16x32_bf16 v[136:139], a[88:91], a[128:131], v[136:139]
    ds_write_addtid_b32 v235 offset:33280
    v_mul_f32 v197, v197, v109
    v_mfma_f32_16x16x32_bf16 v[136:139], a[92:95], a[132:135], v[136:139]
    v_mul_f32 v198, v198, v110
    v_mul_f32 v199, v199, v111
    v_mfma_f32_16x16x32_bf16 v[136:139], a[40:43], a[192:195], v[136:139]
    ds_read_b128 a[232:235], v42 offset:6144
    v_cvt_pk_bf16_f32 v49, v196, v133
    v_mfma_f32_16x16x32_bf16 v[136:139], a[44:47], a[196:199], v[136:139]
    ds_write_b64 v26, v[48:49] offset:0
    v_mfma_f32_16x16x32_bf16 v[168:171], a[56:59], a[168:171], v[168:171]
    v_cvt_pk_bf16_f32 v50, v165, v197
    v_cvt_pk_bf16_f32 v52, v198, v135
    v_mfma_f32_16x16x32_bf16 v[168:171], a[60:63], a[172:175], v[168:171]
    ds_write_b64 v26, v[50:51] offset:8
    v_mfma_f32_16x16x32_bf16 v[168:171], a[32:35], a[104:107], v[168:171]
    ds_read_b128 a[236:239], v43 offset:6144
    v_cvt_pk_bf16_f32 v53, v167, v199
    v_mfma_f32_16x16x32_bf16 v[168:171], a[36:39], a[108:111], v[168:171]
    ds_write_b64 v26, v[52:53] offset:16
    v_mfma_f32_16x16x32_bf16 v[168:171], a[136:139], a[128:131], v[168:171]
    ds_read_b128 a[224:227], v42 offset:22528
    v_mul_f32 v136, v136, v96
    v_mfma_f32_16x16x32_bf16 v[168:171], a[140:143], a[132:135], v[168:171]
    v_mul_f32 v137, v137, v97
    v_mul_f32 v138, v138, v98
    v_mfma_f32_16x16x32_bf16 v[168:171], a[64:67], a[192:195], v[168:171]
    ds_read_b128 a[228:231], v43 offset:22528
    v_mul_f32 v139, v139, v99
    v_mfma_f32_16x16x32_bf16 v[168:171], a[68:71], a[196:199], v[168:171]
    v_mfma_f32_16x16x32_bf16 v[200:203], a[24:27], a[168:171], v[200:203]
    s_waitcnt lgkmcnt(2)
    s_barrier
    v_mfma_f32_16x16x32_bf16 v[200:203], a[28:31], a[172:175], v[200:203]
    ds_read_b128 v[68:71], v24 offset:0
    ds_read2st64_b32 v[72:73], v30 offset0:129 offset1:130
    v_mfma_f32_16x16x32_bf16 v[200:203], a[120:123], a[104:107], v[200:203]
    ds_read_b128 v[76:79], v24 offset:928
    v_mfma_f32_16x16x32_bf16 v[200:203], a[124:127], a[108:111], v[200:203]
    ds_read_b128 a[80:83], v40 offset:40960
    v_mul_f32 v168, v168, v104
    v_mfma_f32_16x16x32_bf16 v[200:203], a[8:11], a[128:131], v[200:203]
    v_cvt_pk_bf16_f32 v100, v136, v168
    v_mul_f32 v169, v169, v105
    v_mfma_f32_16x16x32_bf16 v[200:203], a[12:15], a[132:135], v[200:203]
    ds_read_b128 a[84:87], v41 offset:40960
    v_mul_f32 v170, v170, v106
    v_mfma_f32_16x16x32_bf16 v[200:203], a[72:75], a[192:195], v[200:203]
    v_cvt_pk_bf16_f32 v103, v138, v170
    v_mul_f32 v171, v171, v107
    v_mfma_f32_16x16x32_bf16 v[200:203], a[76:79], a[196:199], v[200:203]
    s_waitcnt lgkmcnt(3)
    v_mfma_f32_16x16x32_bf16 v[236:239], a[200:203], a[242:245], v[236:239]
    buffer_store_dwordx4 v[68:71], v25, s[16:19], s66 offen sc1
    v_mfma_f32_16x16x32_bf16 v[236:239], a[204:207], a[250:253], v[236:239]
    s_mov_b32 s66, 229376
    v_add_f32 v232, v232, v72
    v_mul_f32 v232, v232, v84
    v_mfma_f32_16x16x32_bf16 v[236:239], a[160:163], a[234:237], v[236:239]
    v_add_f32 v233, v233, v73
    v_mul_f32 v233, v233, v85
    v_mfma_f32_16x16x32_bf16 v[236:239], a[164:167], a[226:229], v[236:239]
    s_waitcnt lgkmcnt(2)
    ds_read_b128 a[0:3], v40 offset:57344
    v_mfma_f32_16x16x32_bf16 v[140:143], a[16:19], a[240:243], v[140:143]
    buffer_store_dwordx4 v[76:79], v25, s[16:19], s67 offen sc1
    v_mfma_f32_16x16x32_bf16 v[140:143], a[20:23], a[244:247], v[140:143]
    s_mov_b32 s67, 243712
    ds_read_b128 a[4:7], v41 offset:57344
    v_cvt_pk_bf16_f32 v72, v232, v233
    v_mfma_f32_16x16x32_bf16 v[140:143], a[48:51], a[248:251], v[140:143]
    ds_write_b32 v28, v72 offset:7424
    v_mfma_f32_16x16x32_bf16 v[140:143], a[52:55], a[252:255], v[140:143]
    ds_write_addtid_b32 v238 offset:0
    v_mul_f32 v200, v200, v108
    v_mfma_f32_16x16x32_bf16 v[140:143], a[88:91], a[232:235], v[140:143]
    ds_write_addtid_b32 v239 offset:256
    v_mul_f32 v201, v201, v109
    v_mfma_f32_16x16x32_bf16 v[140:143], a[92:95], a[236:239], v[140:143]
    v_mul_f32 v202, v202, v110
    v_mul_f32 v203, v203, v111
    v_mfma_f32_16x16x32_bf16 v[140:143], a[40:43], a[224:227], v[140:143]
    ds_read_b128 a[144:147], v42 offset:8192
    v_cvt_pk_bf16_f32 v101, v200, v137
    v_mfma_f32_16x16x32_bf16 v[140:143], a[44:47], a[228:231], v[140:143]
    ds_write_b64 v26, v[100:101] offset:7424
    v_mfma_f32_16x16x32_bf16 v[172:175], a[56:59], a[240:243], v[172:175]
    v_cvt_pk_bf16_f32 v102, v169, v201
    v_cvt_pk_bf16_f32 v64, v202, v139
    v_mfma_f32_16x16x32_bf16 v[172:175], a[60:63], a[244:247], v[172:175]
    ds_write_b64 v26, v[102:103] offset:7432
    v_mfma_f32_16x16x32_bf16 v[172:175], a[32:35], a[248:251], v[172:175]
    ds_read_b128 a[148:151], v43 offset:8192
    v_cvt_pk_bf16_f32 v65, v171, v203
    v_mfma_f32_16x16x32_bf16 v[172:175], a[36:39], a[252:255], v[172:175]
    ds_write_b64 v26, v[64:65] offset:7440
    v_mfma_f32_16x16x32_bf16 v[172:175], a[136:139], a[232:235], v[172:175]
    ds_read_b128 a[168:171], v42 offset:24576
    v_mul_f32 v140, v140, v96
    v_mfma_f32_16x16x32_bf16 v[172:175], a[140:143], a[236:239], v[172:175]
    v_mul_f32 v141, v141, v97
    v_mul_f32 v142, v142, v98
    v_mfma_f32_16x16x32_bf16 v[172:175], a[64:67], a[224:227], v[172:175]
    ds_read_b128 a[172:175], v43 offset:24576
    v_mul_f32 v143, v143, v99
    v_mfma_f32_16x16x32_bf16 v[172:175], a[68:71], a[228:231], v[172:175]
    v_mfma_f32_16x16x32_bf16 v[204:207], a[24:27], a[240:243], v[204:207]
    s_waitcnt lgkmcnt(2)
    s_barrier
    v_mfma_f32_16x16x32_bf16 v[204:207], a[28:31], a[244:247], v[204:207]
    ds_read_b128 v[80:83], v24 offset:7424
    ds_read2st64_b32 v[116:117], v30 offset0:0 offset1:1
    v_mfma_f32_16x16x32_bf16 v[204:207], a[120:123], a[248:251], v[204:207]
    ds_read_b128 v[120:123], v24 offset:8352
    v_mfma_f32_16x16x32_bf16 v[204:207], a[124:127], a[252:255], v[204:207]
    ds_read_b128 a[104:107], v40 offset:43008
    v_mul_f32 v172, v172, v104
    v_mfma_f32_16x16x32_bf16 v[204:207], a[8:11], a[232:235], v[204:207]
    v_cvt_pk_bf16_f32 v112, v140, v172
    v_mul_f32 v173, v173, v105
    v_mfma_f32_16x16x32_bf16 v[204:207], a[12:15], a[236:239], v[204:207]
    ds_read_b128 a[108:111], v41 offset:43008
    v_mul_f32 v174, v174, v106
    v_mfma_f32_16x16x32_bf16 v[204:207], a[72:75], a[224:227], v[204:207]
    v_cvt_pk_bf16_f32 v115, v142, v174
    v_mul_f32 v175, v175, v107
    v_mfma_f32_16x16x32_bf16 v[204:207], a[76:79], a[228:231], v[204:207]
    s_waitcnt lgkmcnt(3)
    v_mfma_f32_16x16x32_bf16 v[240:243], a[200:203], a[82:85], v[240:243]
    buffer_store_dwordx4 v[80:83], v25, s[16:19], s66 offen sc1
    v_mfma_f32_16x16x32_bf16 v[240:243], a[204:207], a[2:5], v[240:243]
    s_mov_b32 s66, 344064
    v_add_f32 v236, v236, v116
    v_mul_f32 v236, v236, v84
    v_mfma_f32_16x16x32_bf16 v[240:243], a[160:163], a[146:149], v[240:243]
    v_add_f32 v237, v237, v117
    v_mul_f32 v237, v237, v85
    v_mfma_f32_16x16x32_bf16 v[240:243], a[164:167], a[170:173], v[240:243]
    s_waitcnt lgkmcnt(2)
    ds_read_b128 a[128:131], v40 offset:59392
    v_mfma_f32_16x16x32_bf16 v[144:147], a[16:19], a[80:83], v[144:147]
    buffer_store_dwordx4 v[120:123], v25, s[16:19], s67 offen sc1
    v_mfma_f32_16x16x32_bf16 v[144:147], a[20:23], a[84:87], v[144:147]
    s_mov_b32 s67, 358400
    ds_read_b128 a[132:135], v41 offset:59392
    v_cvt_pk_bf16_f32 v116, v236, v237
    v_mfma_f32_16x16x32_bf16 v[144:147], a[48:51], a[0:3], v[144:147]
    ds_write_b32 v28, v116 offset:14848
    v_mfma_f32_16x16x32_bf16 v[144:147], a[52:55], a[4:7], v[144:147]
    ds_write_addtid_b32 v242 offset:2048
    v_mul_f32 v204, v204, v108
    v_mfma_f32_16x16x32_bf16 v[144:147], a[88:91], a[144:147], v[144:147]
    ds_write_addtid_b32 v243 offset:2304
    v_mul_f32 v205, v205, v109
    v_mfma_f32_16x16x32_bf16 v[144:147], a[92:95], a[148:151], v[144:147]
    v_mul_f32 v206, v206, v110
    v_mul_f32 v207, v207, v111
    v_mfma_f32_16x16x32_bf16 v[144:147], a[40:43], a[168:171], v[144:147]
    ds_read_b128 a[192:195], v42 offset:10240
    v_cvt_pk_bf16_f32 v113, v204, v141
    v_mfma_f32_16x16x32_bf16 v[144:147], a[44:47], a[172:175], v[144:147]
    ds_write_b64 v26, v[112:113] offset:14848
    v_mfma_f32_16x16x32_bf16 v[176:179], a[56:59], a[80:83], v[176:179]
    v_cvt_pk_bf16_f32 v114, v173, v205
    v_cvt_pk_bf16_f32 v124, v206, v143
    v_mfma_f32_16x16x32_bf16 v[176:179], a[60:63], a[84:87], v[176:179]
    ds_write_b64 v26, v[114:115] offset:14856
    v_mfma_f32_16x16x32_bf16 v[176:179], a[32:35], a[0:3], v[176:179]
    ds_read_b128 a[196:199], v43 offset:10240
    v_cvt_pk_bf16_f32 v125, v175, v207
    v_mfma_f32_16x16x32_bf16 v[176:179], a[36:39], a[4:7], v[176:179]
    ds_write_b64 v26, v[124:125] offset:14864
    v_mfma_f32_16x16x32_bf16 v[176:179], a[136:139], a[144:147], v[176:179]
    ds_read_b128 a[240:243], v42 offset:26624
    v_mul_f32 v144, v144, v96
    v_mfma_f32_16x16x32_bf16 v[176:179], a[140:143], a[148:151], v[176:179]
    v_mul_f32 v145, v145, v97
    v_mul_f32 v146, v146, v98
    v_mfma_f32_16x16x32_bf16 v[176:179], a[64:67], a[168:171], v[176:179]
    ds_read_b128 a[244:247], v43 offset:26624
    v_mul_f32 v147, v147, v99
    v_mfma_f32_16x16x32_bf16 v[176:179], a[68:71], a[172:175], v[176:179]
    s_waitcnt vmcnt(6)
    v_bitop3_b32 v45, v45, 15, v0 bitop3:0xbe
    v_lshlrev_b32 v45, 22, v45
    v_mfma_f32_16x16x32_bf16 v[208:211], a[24:27], a[80:83], v[208:211]
    s_waitcnt lgkmcnt(2)
    s_barrier
    v_mfma_f32_16x16x32_bf16 v[208:211], a[28:31], a[84:87], v[208:211]
    buffer_store_dword v47, v45, s[12:15], s78 offen sc1
    v_mfma_f32_16x16x32_bf16 v[208:211], a[120:123], a[0:3], v[208:211]
    ds_read_b128 v[92:95], v24 offset:14848
    ds_read2st64_b32 v[88:89], v30 offset0:8 offset1:9
    v_mfma_f32_16x16x32_bf16 v[208:211], a[124:127], a[4:7], v[208:211]
    ds_read_b128 v[48:51], v24 offset:15776
    v_mul_f32 v176, v176, v104
    v_mfma_f32_16x16x32_bf16 v[208:211], a[8:11], a[144:147], v[208:211]
    ds_read_b128 a[248:251], v40 offset:45056
    v_cvt_pk_bf16_f32 v52, v144, v176
    v_mfma_f32_16x16x32_bf16 v[208:211], a[12:15], a[148:151], v[208:211]
    ds_read_b128 a[252:255], v41 offset:45056
    v_mul_f32 v177, v177, v105
    v_mfma_f32_16x16x32_bf16 v[208:211], a[72:75], a[168:171], v[208:211]
    v_mul_f32 v178, v178, v106
    v_cvt_pk_bf16_f32 v55, v146, v178
    v_mfma_f32_16x16x32_bf16 v[208:211], a[76:79], a[172:175], v[208:211]
    v_mul_f32 v179, v179, v107
    v_mfma_f32_16x16x32_bf16 v[244:247], a[200:203], a[106:109], v[244:247]
    s_waitcnt lgkmcnt(3)
    v_mfma_f32_16x16x32_bf16 v[244:247], a[204:207], a[130:133], v[244:247]
    buffer_store_dwordx4 v[92:95], v25, s[16:19], s66 offen sc1
    v_mfma_f32_16x16x32_bf16 v[244:247], a[160:163], a[194:197], v[244:247]
    s_mov_b32 s66, 458752
    v_add_f32 v240, v240, v88
    v_mul_f32 v240, v240, v84
    v_mfma_f32_16x16x32_bf16 v[244:247], a[164:167], a[242:245], v[244:247]
    v_add_f32 v241, v241, v89
    v_mul_f32 v241, v241, v85
    v_mfma_f32_16x16x32_bf16 v[148:151], a[16:19], a[104:107], v[148:151]
    s_waitcnt lgkmcnt(2)
    ds_read_b128 a[232:235], v40 offset:61440
    v_mfma_f32_16x16x32_bf16 v[148:151], a[20:23], a[108:111], v[148:151]
    buffer_store_dwordx4 v[48:51], v25, s[16:19], s67 offen sc1
    v_mfma_f32_16x16x32_bf16 v[148:151], a[48:51], a[128:131], v[148:151]
    s_mov_b32 s67, 473088
    ds_read_b128 a[236:239], v41 offset:61440
    v_cvt_pk_bf16_f32 v88, v240, v241
    v_mfma_f32_16x16x32_bf16 v[148:151], a[52:55], a[132:135], v[148:151]
    ds_write_b32 v28, v88 offset:22272
    v_mfma_f32_16x16x32_bf16 v[148:151], a[88:91], a[192:195], v[148:151]
    ds_write_addtid_b32 v246 offset:4096
    v_mul_f32 v208, v208, v108
    v_mfma_f32_16x16x32_bf16 v[148:151], a[92:95], a[196:199], v[148:151]
    v_mul_f32 v209, v209, v109
    v_mul_f32 v210, v210, v110
    v_mfma_f32_16x16x32_bf16 v[148:151], a[40:43], a[240:243], v[148:151]
    v_mul_f32 v211, v211, v111
    v_cvt_pk_bf16_f32 v53, v208, v145
    v_mfma_f32_16x16x32_bf16 v[148:151], a[44:47], a[244:247], v[148:151]
    ds_write_b64 v26, v[52:53] offset:22272
    v_mfma_f32_16x16x32_bf16 v[180:183], a[56:59], a[104:107], v[180:183]
    v_cvt_pk_bf16_f32 v54, v177, v209
    v_cvt_pk_bf16_f32 v68, v210, v147
    v_mfma_f32_16x16x32_bf16 v[180:183], a[60:63], a[108:111], v[180:183]
    ds_read_b128 a[224:227], v42 offset:12288
    v_cvt_pk_bf16_f32 v69, v179, v211
    v_mfma_f32_16x16x32_bf16 v[180:183], a[32:35], a[128:131], v[180:183]
    ds_write_b64 v26, v[54:55] offset:22280
    v_mfma_f32_16x16x32_bf16 v[180:183], a[36:39], a[132:135], v[180:183]
    ds_write_b64 v26, v[68:69] offset:22288
    v_mfma_f32_16x16x32_bf16 v[180:183], a[136:139], a[192:195], v[180:183]
    ds_read_b128 a[228:231], v43 offset:12288
    ds_write_addtid_b32 v247 offset:4352
    v_mfma_f32_16x16x32_bf16 v[180:183], a[140:143], a[196:199], v[180:183]
    ds_read_b128 a[80:83], v42 offset:28672
    v_mul_f32 v148, v148, v96
    v_mfma_f32_16x16x32_bf16 v[180:183], a[64:67], a[240:243], v[180:183]
    ds_read_b128 a[84:87], v43 offset:28672
    v_mul_f32 v149, v149, v97
    v_mfma_f32_16x16x32_bf16 v[180:183], a[68:71], a[244:247], v[180:183]
    v_mul_f32 v150, v150, v98
    v_mul_f32 v151, v151, v99
    v_mfma_f32_16x16x32_bf16 v[212:215], a[24:27], a[104:107], v[212:215]
    v_mfma_f32_16x16x32_bf16 v[212:215], a[28:31], a[108:111], v[212:215]
    s_waitcnt lgkmcnt(2)
    s_barrier
    v_mfma_f32_16x16x32_bf16 v[212:215], a[120:123], a[128:131], v[212:215]
    ds_read_b128 v[76:79], v24 offset:22272
    ds_read2st64_b32 v[72:73], v30 offset0:16 offset1:17
    v_mfma_f32_16x16x32_bf16 v[212:215], a[124:127], a[132:135], v[212:215]
    ds_read_b128 v[100:103], v24 offset:23200
    v_mul_f32 v180, v180, v104
    v_mfma_f32_16x16x32_bf16 v[212:215], a[8:11], a[192:195], v[212:215]
    ds_read_b128 a[0:3], v40 offset:14336
    v_cvt_pk_bf16_f32 v64, v148, v180
    v_mfma_f32_16x16x32_bf16 v[212:215], a[12:15], a[196:199], v[212:215]
    ds_read_b128 a[4:7], v41 offset:14336
    v_mul_f32 v181, v181, v105
    v_mfma_f32_16x16x32_bf16 v[212:215], a[72:75], a[240:243], v[212:215]
    v_mul_f32 v182, v182, v106
    v_cvt_pk_bf16_f32 v67, v150, v182
    v_mfma_f32_16x16x32_bf16 v[212:215], a[76:79], a[244:247], v[212:215]
    v_mul_f32 v183, v183, v107
    v_mfma_f32_16x16x32_bf16 v[248:251], a[200:203], a[250:253], v[248:251]
    s_waitcnt lgkmcnt(3)
    v_mfma_f32_16x16x32_bf16 v[248:251], a[204:207], a[234:237], v[248:251]
    buffer_store_dwordx4 v[76:79], v25, s[16:19], s66 offen sc1
    v_mfma_f32_16x16x32_bf16 v[248:251], a[160:163], a[226:229], v[248:251]
    s_mov_b32 s66, 573440
    v_add_f32 v244, v244, v72
    v_mul_f32 v244, v244, v84
    v_mfma_f32_16x16x32_bf16 v[248:251], a[164:167], a[82:85], v[248:251]
    v_add_f32 v245, v245, v73
    v_mul_f32 v245, v245, v85
    v_mfma_f32_16x16x32_bf16 v[152:155], a[16:19], a[248:251], v[152:155]
    s_waitcnt lgkmcnt(2)
    ds_read_b128 a[144:147], v40 offset:30720
    v_mfma_f32_16x16x32_bf16 v[152:155], a[20:23], a[252:255], v[152:155]
    buffer_store_dwordx4 v[100:103], v25, s[16:19], s67 offen sc1
    v_mfma_f32_16x16x32_bf16 v[152:155], a[48:51], a[232:235], v[152:155]
    s_mov_b32 s67, 587776
    ds_read_b128 a[148:151], v41 offset:30720
    v_cvt_pk_bf16_f32 v72, v244, v245
    v_mfma_f32_16x16x32_bf16 v[152:155], a[52:55], a[236:239], v[152:155]
    ds_write_b32 v28, v72 offset:29696
    v_mfma_f32_16x16x32_bf16 v[152:155], a[88:91], a[224:227], v[152:155]
    ds_write_addtid_b32 v250 offset:6144
    v_mul_f32 v212, v212, v108
    v_mfma_f32_16x16x32_bf16 v[152:155], a[92:95], a[228:231], v[152:155]
    v_mul_f32 v213, v213, v109
    v_mul_f32 v214, v214, v110
    v_mfma_f32_16x16x32_bf16 v[152:155], a[40:43], a[80:83], v[152:155]
    v_mul_f32 v215, v215, v111
    v_cvt_pk_bf16_f32 v65, v212, v149
    v_mfma_f32_16x16x32_bf16 v[152:155], a[44:47], a[84:87], v[152:155]
    ds_write_b64 v26, v[64:65] offset:29696
    v_mfma_f32_16x16x32_bf16 v[184:187], a[56:59], a[248:251], v[184:187]
    v_cvt_pk_bf16_f32 v66, v181, v213
    v_cvt_pk_bf16_f32 v80, v214, v151
    v_mfma_f32_16x16x32_bf16 v[184:187], a[60:63], a[252:255], v[184:187]
    ds_read_b128 a[168:171], v40 offset:47104
    v_cvt_pk_bf16_f32 v81, v183, v215
    v_mfma_f32_16x16x32_bf16 v[184:187], a[32:35], a[232:235], v[184:187]
    ds_write_b64 v26, v[66:67] offset:29704
    v_mfma_f32_16x16x32_bf16 v[184:187], a[36:39], a[236:239], v[184:187]
    ds_write_b64 v26, v[80:81] offset:29712
    v_mfma_f32_16x16x32_bf16 v[184:187], a[136:139], a[224:227], v[184:187]
    ds_read_b128 a[172:175], v41 offset:47104
    ds_write_addtid_b32 v251 offset:6400
    v_mfma_f32_16x16x32_bf16 v[184:187], a[140:143], a[228:231], v[184:187]
    ds_read_b128 a[104:107], v40 offset:63488
    v_mul_f32 v152, v152, v96
    v_mfma_f32_16x16x32_bf16 v[184:187], a[64:67], a[80:83], v[184:187]
    ds_read_b128 a[108:111], v41 offset:63488
    v_mul_f32 v153, v153, v97
    v_mfma_f32_16x16x32_bf16 v[184:187], a[68:71], a[84:87], v[184:187]
    v_mul_f32 v154, v154, v98
    v_mul_f32 v155, v155, v99
    v_mfma_f32_16x16x32_bf16 v[216:219], a[24:27], a[248:251], v[216:219]
    ds_read_b128 a[128:131], v42 offset:14336
    v_mfma_f32_16x16x32_bf16 v[216:219], a[28:31], a[252:255], v[216:219]
    s_waitcnt lgkmcnt(3)
    s_barrier
    v_mfma_f32_16x16x32_bf16 v[216:219], a[120:123], a[232:235], v[216:219]
    ds_read_b128 a[132:135], v43 offset:14336
    ds_read2st64_b32 v[120:121], v30 offset0:24 offset1:25
    v_mfma_f32_16x16x32_bf16 v[216:219], a[124:127], a[236:239], v[216:219]
    ds_read_b128 a[192:195], v42 offset:30720
    v_mul_f32 v184, v184, v104
    v_mfma_f32_16x16x32_bf16 v[216:219], a[8:11], a[224:227], v[216:219]
    ds_read_b128 a[196:199], v43 offset:30720
    v_cvt_pk_bf16_f32 v116, v152, v184
    v_mfma_f32_16x16x32_bf16 v[216:219], a[12:15], a[228:231], v[216:219]
    ds_read_b128 v[112:115], v24 offset:29696
    v_mul_f32 v185, v185, v105
    v_mfma_f32_16x16x32_bf16 v[216:219], a[72:75], a[80:83], v[216:219]
    ds_read_b128 v[124:127], v24 offset:30624
    v_mul_f32 v186, v186, v106
    v_mfma_f32_16x16x32_bf16 v[216:219], a[76:79], a[84:87], v[216:219]
    v_cvt_pk_bf16_f32 v119, v154, v186
    v_mul_f32 v187, v187, v107
    v_mfma_f32_16x16x32_bf16 v[252:255], a[152:155], a[2:5], v[252:255]
    v_mfma_f32_16x16x32_bf16 v[252:255], a[156:159], a[146:149], v[252:255]
    s_waitcnt lgkmcnt(4)
    v_add_f32 v248, v248, v120
    v_mul_f32 v248, v248, v84
    v_mfma_f32_16x16x32_bf16 v[252:255], a[200:203], a[170:173], v[252:255]
    v_add_f32 v249, v249, v121
    v_mul_f32 v249, v249, v85
    v_mfma_f32_16x16x32_bf16 v[252:255], a[204:207], a[106:109], v[252:255]
    s_waitcnt lgkmcnt(1)
    v_cvt_pk_bf16_f32 v120, v248, v249
    v_mfma_f32_16x16x32_bf16 v[252:255], a[160:163], a[130:133], v[252:255]
    buffer_store_dwordx4 v[112:115], v25, s[16:19], s66 offen sc1
    v_mfma_f32_16x16x32_bf16 v[252:255], a[164:167], a[194:197], v[252:255]
    s_mov_b32 s66, 688128
    ds_write_b32 v28, v120 offset:37120
    v_mfma_f32_16x16x32_bf16 v[156:159], a[96:99], a[0:3], v[156:159]
    v_mul_f32 v216, v216, v108
    v_mul_f32 v217, v217, v109
    v_mfma_f32_16x16x32_bf16 v[156:159], a[100:103], a[4:7], v[156:159]
    s_waitcnt lgkmcnt(1)
    v_mul_f32 v218, v218, v110
    v_mfma_f32_16x16x32_bf16 v[156:159], a[184:187], a[144:147], v[156:159]
    buffer_store_dwordx4 v[124:127], v25, s[16:19], s67 offen sc1
    v_mfma_f32_16x16x32_bf16 v[156:159], a[188:191], a[148:151], v[156:159]
    s_mov_b32 s67, 702464
    ds_write_addtid_b32 v254 offset:8192
    v_mul_f32 v219, v219, v111
    v_mfma_f32_16x16x32_bf16 v[156:159], a[16:19], a[168:171], v[156:159]
    ds_write_addtid_b32 v255 offset:8448
    v_cvt_pk_bf16_f32 v117, v216, v153
    v_mfma_f32_16x16x32_bf16 v[156:159], a[20:23], a[172:175], v[156:159]
    ds_write_b64 v26, v[116:117] offset:37120
    v_mfma_f32_16x16x32_bf16 v[156:159], a[48:51], a[104:107], v[156:159]
    v_cvt_pk_bf16_f32 v118, v185, v217
    v_cvt_pk_bf16_f32 v92, v218, v155
    v_mfma_f32_16x16x32_bf16 v[156:159], a[52:55], a[108:111], v[156:159]
    ds_write_b64 v26, v[118:119] offset:37128
    v_mfma_f32_16x16x32_bf16 v[156:159], a[88:91], a[128:131], v[156:159]
    v_cvt_pk_bf16_f32 v93, v187, v219
    v_mfma_f32_16x16x32_bf16 v[156:159], a[92:95], a[132:135], v[156:159]
    ds_write_b64 v26, v[92:93] offset:37136
    v_mfma_f32_16x16x32_bf16 v[156:159], a[40:43], a[192:195], v[156:159]
    v_mfma_f32_16x16x32_bf16 v[156:159], a[44:47], a[196:199], v[156:159]
    v_mfma_f32_16x16x32_bf16 v[188:191], a[176:179], a[0:3], v[188:191]
    v_mfma_f32_16x16x32_bf16 v[188:191], a[180:183], a[4:7], v[188:191]
    v_mfma_f32_16x16x32_bf16 v[188:191], a[208:211], a[144:147], v[188:191]
    s_waitcnt lgkmcnt(0)
    s_barrier
    v_mfma_f32_16x16x32_bf16 v[188:191], a[212:215], a[148:151], v[188:191]
    ds_read_b128 v[48:51], v24 offset:37120
    ds_read2st64_b32 v[88:89], v30 offset0:32 offset1:33
    v_mfma_f32_16x16x32_bf16 v[188:191], a[56:59], a[168:171], v[188:191]
    ds_read_b128 v[52:55], v24 offset:38048
    v_mul_f32 v156, v156, v96
    v_mfma_f32_16x16x32_bf16 v[188:191], a[60:63], a[172:175], v[188:191]
    v_mul_f32 v157, v157, v97
    v_mul_f32 v158, v158, v98
    v_mfma_f32_16x16x32_bf16 v[188:191], a[32:35], a[104:107], v[188:191]
    v_mul_f32 v159, v159, v99
    v_mfma_f32_16x16x32_bf16 v[188:191], a[36:39], a[108:111], v[188:191]
    v_mfma_f32_16x16x32_bf16 v[188:191], a[136:139], a[128:131], v[188:191]
    v_mfma_f32_16x16x32_bf16 v[188:191], a[140:143], a[132:135], v[188:191]
    s_waitcnt lgkmcnt(1)
    v_mfma_f32_16x16x32_bf16 v[188:191], a[64:67], a[192:195], v[188:191]
    buffer_store_dwordx4 v[48:51], v25, s[16:19], s66 offen sc1
    v_mfma_f32_16x16x32_bf16 v[188:191], a[68:71], a[196:199], v[188:191]
    s_mov_b32 s66, 802816
    v_add_f32 v252, v252, v88
    v_mul_f32 v252, v252, v84
    v_mfma_f32_16x16x32_bf16 v[220:223], a[112:115], a[0:3], v[220:223]
    v_add_f32 v253, v253, v89
    v_mul_f32 v253, v253, v85
    v_mfma_f32_16x16x32_bf16 v[220:223], a[116:119], a[4:7], v[220:223]
    s_waitcnt lgkmcnt(0)
    v_cvt_pk_bf16_f32 v88, v252, v253
    v_mfma_f32_16x16x32_bf16 v[220:223], a[216:219], a[144:147], v[220:223]
    buffer_store_dwordx4 v[52:55], v25, s[16:19], s67 offen sc1
    v_mfma_f32_16x16x32_bf16 v[220:223], a[220:223], a[148:151], v[220:223]
    s_mov_b32 s67, 817152
    ds_write_b32 v28, v88 offset:44544
    v_mfma_f32_16x16x32_bf16 v[220:223], a[24:27], a[168:171], v[220:223]
    v_mul_f32 v188, v188, v104
    v_cvt_pk_bf16_f32 v68, v156, v188
    v_mfma_f32_16x16x32_bf16 v[220:223], a[28:31], a[172:175], v[220:223]
    v_mul_f32 v189, v189, v105
    v_mul_f32 v190, v190, v106
    v_mfma_f32_16x16x32_bf16 v[220:223], a[120:123], a[104:107], v[220:223]
    v_cvt_pk_bf16_f32 v71, v158, v190
    v_mul_f32 v191, v191, v107
    v_mfma_f32_16x16x32_bf16 v[220:223], a[124:127], a[108:111], v[220:223]
    v_mfma_f32_16x16x32_bf16 v[220:223], a[8:11], a[128:131], v[220:223]
    v_mfma_f32_16x16x32_bf16 v[220:223], a[12:15], a[132:135], v[220:223]
    v_mfma_f32_16x16x32_bf16 v[220:223], a[72:75], a[192:195], v[220:223]
    v_mfma_f32_16x16x32_bf16 v[220:223], a[76:79], a[196:199], v[220:223]
    s_nop 7
    v_mul_f32 v220, v220, v108
    v_mul_f32 v221, v221, v109
    v_mul_f32 v222, v222, v110
    v_mul_f32 v223, v223, v111
    v_cvt_pk_bf16_f32 v69, v220, v157
    v_cvt_pk_bf16_f32 v70, v189, v221
    v_cvt_pk_bf16_f32 v76, v222, v159
    v_cvt_pk_bf16_f32 v77, v191, v223
    ds_write_b64 v26, v[68:69] offset:44544
    ds_write_b64 v26, v[70:71] offset:44552
    ds_write_b64 v26, v[76:77] offset:44560
    s_waitcnt lgkmcnt(0)
    s_barrier
    ds_read_b128 v[100:103], v24 offset:44544
    ds_read_b128 v[72:75], v24 offset:45472
    s_waitcnt lgkmcnt(1)
    buffer_store_dwordx4 v[100:103], v25, s[16:19], s66 offen sc1
    s_waitcnt lgkmcnt(0)
    buffer_store_dwordx4 v[72:75], v25, s[16:19], s67 offen sc1
L_end:
    s_endpgm
L_help:
    s_mov_b32 s53, s61
    s_mov_b32 s54, s62
    s_mul_i32 s61, s22, 1835008
    s_add_u32 s61, s61, s79
    s_lshl_b32 s62, s22, 14
    s_add_u32 s62, s62, s68
    s_mov_b32 s22, 0
L_help_row:
    v_mov_b32 v21, v19
    s_xor_b32 s23, s22, s58
    s_bitcmp0_b32 s23, 2
    s_cbranch_scc1 L_help_same
    v_add_u32 v12, 57344, v19
    v_subrev_u32 v13, 57344, v19
    v_min_u32 v21, v12, v13
L_help_same:
    v_mov_b32 v8, 0
    v_mov_b32 v9, 0
    v_mov_b32 v10, 0
    v_mov_b32 v11, s47
    s_mov_b32 s23, 0
L_help_e:
    v_mov_b32 v15, 0
    buffer_load_dwordx3 v[12:14], v18, s[4:7], s61 offen nt
    s_cmp_ge_u32 s23, 16
    s_cbranch_scc1 L_help_own
    buffer_load_dword v15, v21, s[4:7], s61 offen nt
L_help_own:
    s_waitcnt vmcnt(0)
    v_lshl_or_b32 v8, v12, s23, v8
    v_lshl_or_b32 v9, v13, s23, v9
    v_lshl_or_b32 v10, v14, s23, v10
    v_lshl_or_b32 v11, v15, s23, v11
    s_add_u32 s61, s61, 14336
    s_add_u32 s23, s23, 4
    s_cmp_lt_u32 s23, 32
    s_cbranch_scc1 L_help_e
    buffer_store_dwordx4 v[8:11], v20, s[12:15], s62 offen sc1
    s_add_u32 s62, s62, 1024
    s_waitcnt vmcnt(0)
    s_add_u32 s22, s22, 1
    s_cmp_lt_u32 s22, 16
    s_cbranch_scc1 L_help_row
    s_mov_b32 s61, s53
    s_mov_b32 s62, s54
    s_setpc_b64 s[20:21]
L_code_end:

.section .rodata,"a"
.p2align 6
.amdhsa_kernel standalone__normalfloat_lut_af4__prompt_kernel
  .amdhsa_next_free_vgpr 512
  .amdhsa_next_free_sgpr 102
  .amdhsa_accum_offset 256
  .amdhsa_group_segment_fixed_size 0
  .amdhsa_kernarg_size 56
  .amdhsa_user_sgpr_count 2
  .amdhsa_user_sgpr_kernarg_segment_ptr 1
  .amdhsa_system_sgpr_workgroup_id_x 1
.end_amdhsa_kernel
```

```asm
; @launch grid=(256,1,1) block=(256,1,1) lds=163840
.amdgcn_target "amdgcn-amd-amdhsa--gfx950"
.text
.globl standalone__normalfloat_lut_af4__prompt_kernel
.p2align 8
.type standalone__normalfloat_lut_af4__prompt_kernel,@function
standalone__normalfloat_lut_af4__prompt_kernel:
    s_cmp_ge_u32 s2, 256
    s_cbranch_scc1 L_end
    s_load_dwordx2 s[4:5], s[0:1], 8
    s_load_dwordx2 s[12:13], s[0:1], 48
    s_load_dwordx2 s[8:9], s[0:1], 0
    s_load_dwordx2 s[28:29], s[0:1], 16
    s_getpc_b64 s[48:49]
L_pc:
    s_mov_b32 s50, L_code_end-L_pc
    s_mov_b32 s51, 0x20000
    s_lshr_b32 s61, s2, 3
    v_lshl_add_u32 v46, v0, 5, s61
    v_lshlrev_b32 v46, 7, v46
    buffer_load_dword v1, v46, s[48:51], 0 offen offset:256
    v_lshrrev_b32 v5, 6, v0
    v_and_b32 v2, 63, v0
    s_and_b32 s60, s2, 7
    v_readfirstlane_b32 s63, v5
    s_and_b32 s58, s60, 3
    s_lshl_b32 s58, s58, 2
    s_and_b32 s62, s61, 3
    s_add_u32 s58, s58, s62
    s_lshr_b32 s59, s60, 2
    s_lshl_b32 s59, s59, 3
    s_lshr_b32 s62, s61, 2
    s_add_u32 s59, s59, s62
    v_mul_u32_u24 v18, 12, v2
    s_lshl_b32 s60, s63, 4
    s_add_u32 s60, s60, s58
    s_mul_i32 s61, s60, 114688
    s_mul_i32 s79, s59, 896
    s_add_u32 s61, s61, s79
    s_mov_b32 s6, 14680064
    s_mov_b32 s7, 0x20000
    s_lshl_b32 s78, s59, 7
    s_add_u32 s78, s78, 2097164
    v_and_b32 v4, 15, v2
    v_lshrrev_b32 v3, 4, v2
    v_and_b32 v12, 1, v3
    v_lshlrev_b32 v13, 1, v12
    v_xor_b32 v13, v13, v4
    v_lshrrev_b32 v19, 1, v3
    v_lshl_add_u32 v19, v19, 4, v13
    s_bfe_u32 s70, s58, 0x10002
    s_xor_b32 s70, s70, 1
    v_xor_b32 v12, s70, v12
    v_mul_u32_u24 v12, 14336, v12
    v_add_lshl_u32 v19, v19, v12, 2
    v_add_u32 v19, 768, v19
    s_mov_b32 s46, 2
    s_cmp_lg_u32 s63, 0
    s_cbranch_scc1 L_role0
    s_mov_b32 s46, 0
L_role0:
    s_cmp_lg_u32 s63, 1
    s_cbranch_scc1 L_role1
    s_mov_b32 s46, 1
L_role1:
    v_lshlrev_b32 v16, 1, v4
    v_lshrrev_b32 v17, 4, v0
    v_lshlrev_b32 v17, 1, v17
    s_mov_b32 s30, 32
    s_mov_b32 s31, 0x20000
    v_lshrrev_b32 v6, 3, v2
    v_and_b32 v7, 7, v2
    v_xor_b32 v13, v7, v3
    s_lshl_b32 s70, s63, 5
    v_add_lshl_u32 v12, v6, s70, 11
    v_lshl_add_u32 v36, v13, 4, v12
    v_xor_b32 v37, 64, v36
    v_add_u32 v37, 15360, v37
    v_add_u32 v38, 30720, v36
    v_add_u32 v39, 30720, v37
    s_mov_b32 s10, 4194304
    s_mov_b32 s11, 0x20000
    s_lshl_b32 s55, s58, 18
    s_and_b32 s71, s58, 8
    s_lshl_b32 s70, s71, 4
    s_add_u32 s55, s55, s70
    s_lshl_b32 s57, s63, 12
    s_xor_b32 s69, s55, 128
    s_add_u32 s57, s57, 65536
    s_mov_b32 s14, 2099200
    s_mov_b32 s15, 0x20000
    s_lshl_b32 s68, s59, 17
    s_lshl_b32 s62, s60, 10
    s_add_u32 s62, s62, s68
    v_lshlrev_b32 v20, 4, v2
    s_waitcnt lgkmcnt(0)
    s_load_dword s76, s[12:13], s78
    s_cmp_eq_u32 s46, 1
    s_cbranch_scc1 L_L
    s_cmp_eq_u32 s46, 2
    s_cbranch_scc1 L_L
L_X:
    buffer_load_dwordx3 v[128:130], v18, s[4:7], s61 offen nt
    buffer_load_dword v131, v19, s[4:7], s61 offen nt
    s_add_u32 s61, s61, 14336
    buffer_load_dwordx3 v[132:134], v18, s[4:7], s61 offen nt
    buffer_load_dword v135, v19, s[4:7], s61 offen nt
    s_add_u32 s61, s61, 14336
    buffer_load_dwordx3 v[136:138], v18, s[4:7], s61 offen nt
    buffer_load_dword v139, v19, s[4:7], s61 offen nt
    s_add_u32 s61, s61, 14336
    buffer_load_dwordx3 v[140:142], v18, s[4:7], s61 offen nt
    buffer_load_dword v143, v19, s[4:7], s61 offen nt
    s_add_u32 s61, s61, 14336
    buffer_load_dwordx3 v[144:146], v18, s[4:7], s61 offen nt
    s_add_u32 s61, s61, 14336
    buffer_load_dwordx3 v[148:150], v18, s[4:7], s61 offen nt
    s_add_u32 s61, s61, 14336
    buffer_load_dwordx3 v[152:154], v18, s[4:7], s61 offen nt
    s_add_u32 s61, s61, 14336
    buffer_load_dwordx3 v[156:158], v18, s[4:7], s61 offen nt
    s_add_u32 s61, s61, 7239680
    s_cmp_eq_u32 s46, 1
    s_cbranch_scc1 L_D
    s_cmp_eq_u32 s46, 2
    s_cbranch_scc1 L_B
L_L:
    buffer_load_ushort v16, v16, s[28:31], 0 offen
    buffer_load_ushort v17, v17, s[28:31], 0 offen
    s_cmp_eq_u32 s46, 1
    s_cbranch_scc1 L_S
    s_cmp_eq_u32 s46, 2
    s_cbranch_scc1 L_S
L_D:
    s_add_u32 m0, s57, 32768
    s_add_u32 s56, s55, 0
    buffer_load_dwordx4 v36, s[8:11], s56 offen offset:0  lds
    buffer_load_dwordx4 v37, s[8:11], s56 offen offset:1024  lds
    buffer_load_dwordx4 v38, s[8:11], s56 offen offset:2048  lds
    buffer_load_dwordx4 v39, s[8:11], s56 offen offset:3072  lds
    s_cmp_eq_u32 s46, 1
    s_cbranch_scc1 L_G
    s_cmp_eq_u32 s46, 2
    s_cbranch_scc1 L_G
L_S:
    s_load_dwordx2 s[32:33], s[0:1], 24
    s_load_dwordx2 s[16:17], s[0:1], 32
    s_load_dwordx2 s[24:25], s[0:1], 40
    s_and_b32 s64, s63, 1
    s_lshr_b32 s65, s63, 1
    s_and_b32 s70, s58, 8
    s_lshl_b32 s70, s70, 10
    s_lshl_b32 s71, s64, 12
    s_add_u32 s70, s70, s71
    s_lshl_b32 s71, s63, 8
    s_add_u32 s70, s70, s71
    s_add_u32 s70, s70, s68
    v_lshl_add_u32 v32, v4, 4, s70
    v_lshl_add_u32 v32, v3, 10, v32
    v_xor_b32 v33, 4096, v32
    v_xor_b32 v34, 8192, v32
    v_xor_b32 v44, 12288, v32
    s_mov_b32 s36, 202114048
    s_mov_b32 s37, 202114304
    s_mov_b32 s38, 202114560
    s_mov_b32 s39, 202114816
    v_and_b32 v35, 31, v2
    v_lshlrev_b32 v35, 2, v35
    s_lshl_b32 s70, s64, 6
    s_add_u32 s70, s70, 65536
    v_lshrrev_b32 v12, 1, v4
    v_xor_b32 v12, v12, v3
    v_lshlrev_b32 v12, 4, v12
    v_lshl_add_u32 v12, v4, 7, v12
    v_xor_b32 v40, s70, v12
    v_xor_b32 v41, 64, v40
    v_add_u32 v42, 65536, v40
    v_add_u32 v43, 65536, v41
    s_mov_b32 s52, 0
    v_lshlrev_b32 v8, 4, v7
    v_lshl_add_u32 v8, v0, 8, v8
    v_xor_b32 v9, 16, v8
    v_xor_b32 v10, 32, v8
    v_xor_b32 v11, 48, v8
    v_xor_b32 v12, 64, v8
    v_xor_b32 v13, 80, v8
    v_xor_b32 v14, 96, v8
    v_xor_b32 v15, 112, v8
    s_cmp_eq_u32 s46, 1
    s_cbranch_scc1 L_X
    s_cmp_eq_u32 s46, 2
    s_cbranch_scc1 L_D
L_G:
    s_waitcnt lgkmcnt(0)
    s_add_u32 s76, s76, 2654435769
    s_and_b32 s47, s76, 0xffff0000
    s_cmp_eq_u32 s46, 1
    s_cbranch_scc1 L_T
    s_cmp_eq_u32 s46, 2
    s_cbranch_scc1 L_T
L_K:
    s_waitcnt vmcnt(16)
    v_or_b32 v131, s47, v131
    s_waitcnt vmcnt(15)
    v_lshl_or_b32 v128, v132, 4, v128
    v_lshl_or_b32 v129, v133, 4, v129
    v_lshl_or_b32 v130, v134, 4, v130
    s_waitcnt vmcnt(14)
    v_lshl_or_b32 v131, v135, 4, v131
    s_waitcnt vmcnt(13)
    v_lshl_or_b32 v128, v136, 8, v128
    v_lshl_or_b32 v129, v137, 8, v129
    v_lshl_or_b32 v130, v138, 8, v130
    s_waitcnt vmcnt(12)
    v_lshl_or_b32 v131, v139, 8, v131
    s_waitcnt vmcnt(11)
    v_lshl_or_b32 v128, v140, 12, v128
    v_lshl_or_b32 v129, v141, 12, v129
    v_lshl_or_b32 v130, v142, 12, v130
    s_waitcnt vmcnt(10)
    v_lshl_or_b32 v131, v143, 12, v131
    s_waitcnt vmcnt(9)
    v_lshl_or_b32 v128, v144, 16, v128
    v_lshl_or_b32 v129, v145, 16, v129
    v_lshl_or_b32 v130, v146, 16, v130
    s_waitcnt vmcnt(8)
    v_lshl_or_b32 v128, v148, 20, v128
    v_lshl_or_b32 v129, v149, 20, v129
    v_lshl_or_b32 v130, v150, 20, v130
    s_waitcnt vmcnt(7)
    v_lshl_or_b32 v128, v152, 24, v128
    v_lshl_or_b32 v129, v153, 24, v129
    v_lshl_or_b32 v130, v154, 24, v130
    s_waitcnt vmcnt(6)
    v_lshl_or_b32 v128, v156, 28, v128
    v_lshl_or_b32 v129, v157, 28, v129
    v_lshl_or_b32 v130, v158, 28, v130
    buffer_store_dwordx4 v[128:131], v20, s[12:15], s62 offen sc1
    s_add_u32 s62, s62, 65536
    s_cmp_eq_u32 s46, 1
    s_cbranch_scc1 L_B
    s_cmp_eq_u32 s46, 2
    s_cbranch_scc1 L_E
L_T:
    s_waitcnt vmcnt(16)
    s_cmp_eq_u32 s46, 1
    s_cbranch_scc1 L_rw1
    s_waitcnt vmcnt(5)
    s_cmp_eq_u32 s46, 0
    s_cbranch_scc1 L_rw1
    s_waitcnt vmcnt(4)
L_rw1:
    v_lshl_or_b32 v56, v17, 16, v16
    v_lshl_or_b32 v57, v17, 16, v16
    v_lshl_or_b32 v58, v17, 16, v16
    v_lshl_or_b32 v59, v17, 16, v16
    ds_write_b128 v8, v[56:59]
    ds_write_b128 v9, v[56:59]
    ds_write_b128 v10, v[56:59]
    ds_write_b128 v11, v[56:59]
    ds_write_b128 v12, v[56:59]
    ds_write_b128 v13, v[56:59]
    ds_write_b128 v14, v[56:59]
    ds_write_b128 v15, v[56:59]
    s_cmp_lg_u32 s46, 1
    s_cbranch_scc1 L_ed2
    s_waitcnt vmcnt(4)
    s_branch L_K
L_ed2:
    s_cmp_eq_u32 s46, 2
    s_cbranch_scc1 L_X
L_W:
    s_mov_b64 exec, 0
    s_cmp_eq_u32 s63, 0
    s_cbranch_scc1 L_pad0
L_warmed:
    s_mov_b64 exec, -1
L_B:
    s_waitcnt vmcnt(12) lgkmcnt(0)
    s_cmp_eq_u32 s46, 2
    s_cbranch_scc1 L_rw3
    s_waitcnt vmcnt(1)
L_rw3:
    s_barrier
L_Q:
    ds_read_b128 a[0:3], v40 offset:32768
    ds_read_b128 a[4:7], v41 offset:32768
    ds_read_b128 a[8:11], v40 offset:34816
    ds_read_b128 a[12:15], v41 offset:34816
    ds_read_b128 a[16:19], v40 offset:36864
    ds_read_b128 a[20:23], v41 offset:36864
    ds_read_b128 a[24:27], v40 offset:38912
    ds_read_b128 a[28:31], v41 offset:38912
    ds_read_b128 a[40:43], v40 offset:40960
    ds_read_b128 a[44:47], v41 offset:40960
    ds_read_b128 a[48:51], v40 offset:43008
    ds_read_b128 a[52:55], v41 offset:43008
    ds_read_b128 a[56:59], v40 offset:45056
    ds_read_b128 a[60:63], v41 offset:45056
    ds_read_b128 a[72:75], v40 offset:47104
    ds_read_b128 a[76:79], v41 offset:47104
L_P:
    buffer_load_dwordx4 v[64:67], v32, s[12:15], 0 offen sc1
    buffer_load_dwordx4 v[68:71], v33, s[12:15], 0 offen sc1
L_d:
    s_add_u32 m0, s57, 49152
    s_add_u32 s3, s69, 0
    buffer_load_dwordx4 v36, s[8:11], s3 offen offset:0  lds
    buffer_load_dwordx4 v37, s[8:11], s3 offen offset:1024  lds
    buffer_load_dwordx4 v38, s[8:11], s3 offen offset:2048  lds
    buffer_load_dwordx4 v39, s[8:11], s3 offen offset:3072  lds
    s_cmp_lg_u32 s46, 2
    s_cbranch_scc1 L_ed4
    s_waitcnt vmcnt(6)
    s_branch L_K
L_ed4:
L_E:
L_chk0:
    s_waitcnt vmcnt(5)
    s_cmp_eq_u32 s46, 2
    s_cbranch_scc1 L_rw5
    s_waitcnt vmcnt(4)
L_rw5:
    v_bitop3_b32 v12, v67, v71, s76 bitop3:0x7e
    v_cmp_lt_u32 vcc, 0xffff, v12
    s_cbranch_vccnz L_retry0
    buffer_load_dwordx4 v[72:75], v34, s[12:15], 0 offen sc1
    buffer_load_dwordx4 v[76:79], v44, s[12:15], 0 offen sc1
    v_perm_b32 v56, v64, v35, s36
    v_perm_b32 v57, v64, v35, s37
    v_perm_b32 v58, v64, v35, s38
    v_perm_b32 v59, v64, v35, s39
    v_perm_b32 v60, v68, v35, s36
    v_perm_b32 v61, v68, v35, s37
    v_perm_b32 v62, v68, v35, s38
    v_perm_b32 v63, v68, v35, s39
    ds_read_b32 a32, v56
    ds_read_b32 a33, v57
    ds_read_b32 a34, v58
    ds_read_b32 a35, v59
    ds_read_b32 a36, v60
    ds_read_b32 a37, v61
    ds_read_b32 a38, v62
    ds_read_b32 a39, v63
    v_perm_b32 v5, v65, v35, s36
    v_perm_b32 v6, v65, v35, s37
    v_perm_b32 v7, v65, v35, s38
    v_perm_b32 v27, v65, v35, s39
    v_perm_b32 v29, v69, v35, s36
    v_perm_b32 v31, v69, v35, s37
    ds_read_b32 a64, v5
    ds_read_b32 a65, v6
    ds_read_b32 a66, v7
    ds_read_b32 a67, v27
    s_cbranch_vccz L_main
L_retry0:
    s_add_u32 s52, s52, 1
    s_and_b32 s23, s52, 4095
    s_cbranch_scc1 L_retry0b
    s_mov_b32 s22, 0
    s_call_b64 s[20:21], L_help
L_retry0b:
    buffer_load_dwordx4 v[64:67], v32, s[12:15], 0 offen sc1
    buffer_load_dwordx4 v[68:71], v33, s[12:15], 0 offen sc1
    s_waitcnt vmcnt(0) lgkmcnt(0)
    s_branch L_chk0
L_tick:
    s_add_u32 s52, s52, 1
    s_and_b32 s23, s52, 4095
    s_cbranch_scc0 L_help
    s_setpc_b64 s[20:21]
L_slow0_1:
    s_mov_b32 s22, 0
    s_call_b64 s[20:21], L_tick
    buffer_load_dwordx4 v[72:75], v34, s[12:15], 0 offen sc1
    buffer_load_dwordx4 v[76:79], v44, s[12:15], 0 offen sc1
    s_waitcnt vmcnt(0)
    v_bitop3_b32 v12, v75, v79, s76 bitop3:0x7e
    v_cmp_lt_u32 vcc, 0xffff, v12
    s_cbranch_vccnz L_slow0_1
    s_branch L_back0_1
L_slow4_0:
    s_mov_b32 s22, 4
    s_call_b64 s[20:21], L_tick
    buffer_load_dwordx4 v[84:87], v32, s[12:15], s43 offen sc1
    buffer_load_dwordx4 v[96:99], v33, s[12:15], s43 offen sc1
    s_waitcnt vmcnt(0)
    v_bitop3_b32 v12, v87, v99, s76 bitop3:0x7e
    v_cmp_lt_u32 vcc, 0xffff, v12
    s_cbranch_vccnz L_slow4_0
    s_branch L_back4_0
L_slow4_1:
    s_mov_b32 s22, 4
    s_call_b64 s[20:21], L_tick
    buffer_load_dwordx4 v[104:107], v34, s[12:15], s43 offen sc1
    buffer_load_dwordx4 v[108:111], v44, s[12:15], s43 offen sc1
    s_waitcnt vmcnt(0)
    v_bitop3_b32 v12, v107, v111, s76 bitop3:0x7e
    v_cmp_lt_u32 vcc, 0xffff, v12
    s_cbranch_vccnz L_slow4_1
    s_branch L_back4_1
L_slow1_0:
    s_mov_b32 s22, 1
    s_call_b64 s[20:21], L_tick
    buffer_load_dwordx4 v[80:83], v32, s[12:15], s40 offen sc1
    buffer_load_dwordx4 v[84:87], v33, s[12:15], s40 offen sc1
    s_waitcnt vmcnt(0)
    v_bitop3_b32 v12, v83, v87, s76 bitop3:0x7e
    v_cmp_lt_u32 vcc, 0xffff, v12
    s_cbranch_vccnz L_slow1_0
    s_branch L_back1_0
L_slow1_1:
    s_mov_b32 s22, 1
    s_call_b64 s[20:21], L_tick
    buffer_load_dwordx4 v[88:91], v34, s[12:15], s40 offen sc1
    buffer_load_dwordx4 v[92:95], v44, s[12:15], s40 offen sc1
    s_waitcnt vmcnt(0)
    v_bitop3_b32 v12, v91, v95, s76 bitop3:0x7e
    v_cmp_lt_u32 vcc, 0xffff, v12
    s_cbranch_vccnz L_slow1_1
    s_branch L_back1_1
L_slow5_0:
    s_mov_b32 s22, 5
    s_call_b64 s[20:21], L_tick
    buffer_load_dwordx4 v[112:115], v32, s[12:15], s44 offen sc1
    buffer_load_dwordx4 v[116:119], v33, s[12:15], s44 offen sc1
    s_waitcnt vmcnt(0)
    v_bitop3_b32 v12, v115, v119, s76 bitop3:0x7e
    v_cmp_lt_u32 vcc, 0xffff, v12
    s_cbranch_vccnz L_slow5_0
    s_branch L_back5_0
L_slow5_1:
    s_mov_b32 s22, 5
    s_call_b64 s[20:21], L_tick
    buffer_load_dwordx4 v[120:123], v34, s[12:15], s44 offen sc1
    buffer_load_dwordx4 v[124:127], v44, s[12:15], s44 offen sc1
    s_waitcnt vmcnt(0)
    v_bitop3_b32 v12, v123, v127, s76 bitop3:0x7e
    v_cmp_lt_u32 vcc, 0xffff, v12
    s_cbranch_vccnz L_slow5_1
    s_branch L_back5_1
L_slow2_0:
    s_mov_b32 s22, 2
    s_call_b64 s[20:21], L_tick
    buffer_load_dwordx4 v[48:51], v32, s[12:15], s41 offen sc1
    buffer_load_dwordx4 v[52:55], v33, s[12:15], s41 offen sc1
    s_waitcnt vmcnt(0)
    v_bitop3_b32 v12, v51, v55, s76 bitop3:0x7e
    v_cmp_lt_u32 vcc, 0xffff, v12
    s_cbranch_vccnz L_slow2_0
    s_branch L_back2_0
L_slow2_1:
    s_mov_b32 s22, 2
    s_call_b64 s[20:21], L_tick
    buffer_load_dwordx4 v[64:67], v34, s[12:15], s41 offen sc1
    buffer_load_dwordx4 v[68:71], v44, s[12:15], s41 offen sc1
    s_waitcnt vmcnt(0)
    v_bitop3_b32 v12, v67, v71, s76 bitop3:0x7e
    v_cmp_lt_u32 vcc, 0xffff, v12
    s_cbranch_vccnz L_slow2_1
    s_branch L_back2_1
L_slow6_0:
    s_mov_b32 s22, 6
    s_call_b64 s[20:21], L_tick
    buffer_load_dwordx4 v[88:91], v32, s[12:15], s45 offen sc1
    buffer_load_dwordx4 v[92:95], v33, s[12:15], s45 offen sc1
    s_waitcnt vmcnt(0)
    v_bitop3_b32 v12, v91, v95, s76 bitop3:0x7e
    v_cmp_lt_u32 vcc, 0xffff, v12
    s_cbranch_vccnz L_slow6_0
    s_branch L_back6_0
L_slow6_1:
    s_mov_b32 s22, 6
    s_call_b64 s[20:21], L_tick
    buffer_load_dwordx4 v[48:51], v34, s[12:15], s45 offen sc1
    buffer_load_dwordx4 v[52:55], v44, s[12:15], s45 offen sc1
    s_waitcnt vmcnt(0)
    v_bitop3_b32 v12, v51, v55, s76 bitop3:0x7e
    v_cmp_lt_u32 vcc, 0xffff, v12
    s_cbranch_vccnz L_slow6_1
    s_branch L_back6_1
L_slow3_0:
    s_mov_b32 s22, 3
    s_call_b64 s[20:21], L_tick
    buffer_load_dwordx4 v[72:75], v32, s[12:15], s42 offen sc1
    buffer_load_dwordx4 v[76:79], v33, s[12:15], s42 offen sc1
    s_waitcnt vmcnt(0)
    v_bitop3_b32 v12, v75, v79, s76 bitop3:0x7e
    v_cmp_lt_u32 vcc, 0xffff, v12
    s_cbranch_vccnz L_slow3_0
    s_branch L_back3_0
L_slow3_1:
    s_mov_b32 s22, 3
    s_call_b64 s[20:21], L_tick
    buffer_load_dwordx4 v[100:103], v34, s[12:15], s42 offen sc1
    buffer_load_dwordx4 v[80:83], v44, s[12:15], s42 offen sc1
    s_waitcnt vmcnt(0)
    v_bitop3_b32 v12, v103, v83, s76 bitop3:0x7e
    v_cmp_lt_u32 vcc, 0xffff, v12
    s_cbranch_vccnz L_slow3_1
    s_branch L_back3_1
L_slow7_0:
    s_mov_b32 s22, 7
    s_call_b64 s[20:21], L_tick
    buffer_load_dwordx4 v[68:71], v32, s[12:15], s72 offen sc1
    buffer_load_dwordx4 v[72:75], v33, s[12:15], s72 offen sc1
    s_waitcnt vmcnt(0)
    v_bitop3_b32 v12, v71, v75, s76 bitop3:0x7e
    v_cmp_lt_u32 vcc, 0xffff, v12
    s_cbranch_vccnz L_slow7_0
    s_branch L_back7_0
L_slow7_1:
    s_mov_b32 s22, 7
    s_call_b64 s[20:21], L_tick
    buffer_load_dwordx4 v[76:79], v34, s[12:15], s72 offen sc1
    buffer_load_dwordx4 v[100:103], v44, s[12:15], s72 offen sc1
    s_waitcnt vmcnt(0)
    v_bitop3_b32 v12, v79, v103, s76 bitop3:0x7e
    v_cmp_lt_u32 vcc, 0xffff, v12
    s_cbranch_vccnz L_slow7_1
    s_branch L_back7_1
.p2align 12
L_main:
L_pad0:
    s_cbranch_execz L_pad1
    s_waitcnt lgkmcnt(8)
    v_mfma_f32_16x16x32_bf16 v[128:131], a[32:35], a[0:3], 0
    s_waitcnt lgkmcnt(4)
    s_mov_b32 s40, 16384
    ds_read_b32 a68, v29
    v_mfma_f32_16x16x32_bf16 v[128:131], a[36:39], a[4:7], v[128:131]
    buffer_load_dwordx4 v[80:83], v32, s[12:15], s40 offen sc1
    v_mfma_f32_16x16x32_bf16 v[132:135], a[36:39], a[12:15], 0
    s_add_u32 m0, s57, 65536
    ds_read_b32 a69, v31
    v_perm_b32 v46, v69, v35, s38
    v_mfma_f32_16x16x32_bf16 v[132:135], a[32:35], a[8:11], v[132:135]
    s_add_u32 s56, s55, 256
    ds_read_b32 a70, v46
    v_perm_b32 v56, v69, v35, s39
    v_mfma_f32_16x16x32_bf16 v[136:139], a[32:35], a[16:19], 0
    s_add_u32 s3, s69, 256
    ds_read_b32 a71, v56
    v_mfma_f32_16x16x32_bf16 v[136:139], a[36:39], a[20:23], v[136:139]
    buffer_load_dwordx4 v[84:87], v33, s[12:15], s40 offen sc1
    v_mfma_f32_16x16x32_bf16 v[140:143], a[36:39], a[28:31], 0
    v_perm_b32 v57, v66, v35, s36
    v_perm_b32 v58, v66, v35, s37
    v_mfma_f32_16x16x32_bf16 v[140:143], a[32:35], a[24:27], v[140:143]
    ds_read_b32 a80, v57
    v_perm_b32 v59, v66, v35, s38
    v_mfma_f32_16x16x32_bf16 v[144:147], a[32:35], a[40:43], 0
    ds_read_b32 a81, v58
    v_mfma_f32_16x16x32_bf16 v[144:147], a[36:39], a[44:47], v[144:147]
    buffer_load_dwordx4 v36, s[8:11], s56 offen offset:0  lds
    v_mfma_f32_16x16x32_bf16 v[148:151], a[36:39], a[52:55], 0
    ds_read_b32 a82, v59
    v_perm_b32 v60, v66, v35, s39
    v_mfma_f32_16x16x32_bf16 v[148:151], a[32:35], a[48:51], v[148:151]
    v_perm_b32 v61, v70, v35, s36
    v_perm_b32 v62, v70, v35, s37
    v_mfma_f32_16x16x32_bf16 v[152:155], a[32:35], a[56:59], 0
    s_mov_b32 s41, 32768
    ds_read_b32 a83, v60
    ds_read_b32 a84, v61
    v_mfma_f32_16x16x32_bf16 v[152:155], a[36:39], a[60:63], v[152:155]
    buffer_load_dwordx4 v37, s[8:11], s56 offen offset:1024  lds
    v_mfma_f32_16x16x32_bf16 v[156:159], a[36:39], a[76:79], 0
    ds_read_b32 a85, v62
    v_perm_b32 v63, v70, v35, s38
    v_mfma_f32_16x16x32_bf16 v[156:159], a[32:35], a[72:75], v[156:159]
    s_waitcnt lgkmcnt(6)
    ds_read_b32 a86, v63
    v_perm_b32 v5, v70, v35, s39
    v_mfma_f32_16x16x32_bf16 v[160:163], a[64:67], a[0:3], 0
    ds_read_b32 a87, v5
    v_mfma_f32_16x16x32_bf16 v[160:163], a[68:71], a[4:7], v[160:163]
    buffer_load_dwordx4 v38, s[8:11], s56 offen offset:2048  lds
    v_mfma_f32_16x16x32_bf16 v[164:167], a[68:71], a[12:15], 0
    v_perm_b32 v6, v67, v35, s36
    v_perm_b32 v7, v67, v35, s37
    v_mfma_f32_16x16x32_bf16 v[164:167], a[64:67], a[8:11], v[164:167]
    ds_read_b32 a88, v6
    v_perm_b32 v27, v71, v35, s36
    v_mfma_f32_16x16x32_bf16 v[168:171], a[64:67], a[16:19], 0
    ds_read_b32 a89, v7
    v_mfma_f32_16x16x32_bf16 v[168:171], a[68:71], a[20:23], v[168:171]
    buffer_load_dwordx4 v39, s[8:11], s56 offen offset:3072  lds
    v_mfma_f32_16x16x32_bf16 v[172:175], a[68:71], a[28:31], 0
    s_add_u32 m0, s57, 81920
    ds_read_b32 a90, v27
    v_perm_b32 v29, v71, v35, s37
    v_mfma_f32_16x16x32_bf16 v[172:175], a[64:67], a[24:27], v[172:175]
    s_add_u32 s56, s55, 512
    ds_read_b32 a91, v29
    v_mfma_f32_16x16x32_bf16 v[176:179], a[64:67], a[40:43], 0
    s_waitcnt vmcnt(6)
    s_mov_b32 s42, 49152
    v_bitop3_b32 v31, v75, v79, s76 bitop3:0x7e
    v_mfma_f32_16x16x32_bf16 v[176:179], a[68:71], a[44:47], v[176:179]
    buffer_load_dwordx4 v[88:91], v34, s[12:15], s40 offen sc1
    v_mfma_f32_16x16x32_bf16 v[180:183], a[68:71], a[52:55], 0
    v_cmp_lt_u32 vcc, 0xffff, v31
    v_mfma_f32_16x16x32_bf16 v[180:183], a[64:67], a[48:51], v[180:183]
    v_mfma_f32_16x16x32_bf16 v[184:187], a[64:67], a[56:59], 0
    s_cbranch_vccnz L_slow0_1
L_back0_1:
    v_mfma_f32_16x16x32_bf16 v[184:187], a[68:71], a[60:63], v[184:187]
    buffer_load_dwordx4 v[92:95], v44, s[12:15], s40 offen sc1
    v_mfma_f32_16x16x32_bf16 v[188:191], a[68:71], a[76:79], 0
    v_perm_b32 v46, v72, v35, s36
    v_perm_b32 v56, v72, v35, s37
    v_mfma_f32_16x16x32_bf16 v[188:191], a[64:67], a[72:75], v[188:191]
    s_waitcnt lgkmcnt(1)
    ds_read_b32 a96, v46
    v_perm_b32 v57, v72, v35, s38
    v_mfma_f32_16x16x32_bf16 v[192:195], a[80:83], a[0:3], 0
    s_barrier
    v_mfma_f32_16x16x32_bf16 v[192:195], a[84:87], a[4:7], v[192:195]
    buffer_load_dwordx4 v36, s[8:11], s3 offen offset:0  lds
    v_mfma_f32_16x16x32_bf16 v[196:199], a[84:87], a[12:15], 0
    ds_read_b32 a97, v56
    v_perm_b32 v58, v72, v35, s39
    v_mfma_f32_16x16x32_bf16 v[196:199], a[80:83], a[8:11], v[196:199]
    ds_read_b32 a98, v57
    ds_read_b32 a99, v58
    v_mfma_f32_16x16x32_bf16 v[200:203], a[80:83], a[16:19], 0
    s_mov_b32 s43, 65536
    ds_read_b128 a[104:107], v40 offset:49152
    v_mfma_f32_16x16x32_bf16 v[200:203], a[84:87], a[20:23], v[200:203]
    buffer_load_dwordx4 v37, s[8:11], s3 offen offset:1024  lds
    v_mfma_f32_16x16x32_bf16 v[204:207], a[84:87], a[28:31], 0
    ds_read_b128 a[108:111], v41 offset:49152
    v_perm_b32 v59, v76, v35, s36
    v_mfma_f32_16x16x32_bf16 v[204:207], a[80:83], a[24:27], v[204:207]
    ds_read_b32 a100, v59
    v_perm_b32 v60, v76, v35, s37
    v_mfma_f32_16x16x32_bf16 v[208:211], a[80:83], a[40:43], 0
    ds_read_b32 a101, v60
    ds_read_b128 a[112:115], v40 offset:51200
    v_mfma_f32_16x16x32_bf16 v[208:211], a[84:87], a[44:47], v[208:211]
    buffer_load_dwordx4 v38, s[8:11], s3 offen offset:2048  lds
    v_mfma_f32_16x16x32_bf16 v[212:215], a[84:87], a[52:55], 0
    ds_read_b128 a[116:119], v41 offset:51200
    v_perm_b32 v61, v76, v35, s38
    v_mfma_f32_16x16x32_bf16 v[212:215], a[80:83], a[48:51], v[212:215]
    ds_read_b32 a102, v61
    v_perm_b32 v62, v76, v35, s39
    v_mfma_f32_16x16x32_bf16 v[216:219], a[80:83], a[56:59], 0
    ds_read_b32 a103, v62
    v_perm_b32 v63, v73, v35, s36
    v_mfma_f32_16x16x32_bf16 v[216:219], a[84:87], a[60:63], v[216:219]
    ds_read_b32 a120, v63
    v_perm_b32 v5, v73, v35, s37
    v_mfma_f32_16x16x32_bf16 v[220:223], a[84:87], a[76:79], 0
    ds_read_b128 a[128:131], v40 offset:53248
    ds_read_b32 a121, v5
    v_mfma_f32_16x16x32_bf16 v[220:223], a[80:83], a[72:75], v[220:223]
    s_waitcnt lgkmcnt(9)
    ds_read_b128 a[132:135], v41 offset:53248
    v_mfma_f32_16x16x32_bf16 v[224:227], a[88:91], a[2:5], 0
    buffer_load_dwordx4 v39, s[8:11], s3 offen offset:3072  lds
    v_mfma_f32_16x16x32_bf16 v[228:231], a[88:91], a[10:13], 0
    s_add_u32 m0, s57, 0
    ds_read_b128 a[136:139], v40 offset:55296
    v_perm_b32 v6, v73, v35, s38
    v_mfma_f32_16x16x32_bf16 v[232:235], a[88:91], a[18:21], 0
    s_add_u32 s3, s69, 512
    ds_read_b128 a[140:143], v41 offset:55296
    v_perm_b32 v7, v73, v35, s39
    v_mfma_f32_16x16x32_bf16 v[236:239], a[88:91], a[26:29], 0
    s_mov_b32 s44, 81920
    ds_read_b32 a122, v6
    ds_read_b32 a123, v7
    v_mfma_f32_16x16x32_bf16 v[240:243], a[88:91], a[42:45], 0
    ds_read_b128 a[144:147], v40 offset:57344
    v_mfma_f32_16x16x32_bf16 v[244:247], a[88:91], a[50:53], 0
    buffer_load_dwordx3 v[96:98], v18, s[4:7], s61 offen nt
    v_mfma_f32_16x16x32_bf16 v[248:251], a[88:91], a[58:61], 0
    ds_read_b128 a[148:151], v41 offset:57344
    v_perm_b32 v27, v77, v35, s36
    v_mfma_f32_16x16x32_bf16 v[252:255], a[88:91], a[74:77], 0
    ds_read_b128 a[156:159], v41 offset:59392
    v_perm_b32 v29, v77, v35, s37
    v_mfma_f32_16x16x32_bf16 v[128:131], a[96:99], a[104:107], v[128:131]
    s_waitcnt lgkmcnt(7)
    ds_read_b128 a[152:155], v40 offset:59392
    ds_read_b32 a124, v27
    v_mfma_f32_16x16x32_bf16 v[128:131], a[100:103], a[108:111], v[128:131]
    buffer_load_dword v99, v19, s[4:7], s61 offen nt
    v_mfma_f32_16x16x32_bf16 v[132:135], a[100:103], a[116:119], v[132:135]
    s_add_u32 s61, s61, 14336
    ds_read_b128 a[160:163], v40 offset:61440
    v_perm_b32 v31, v77, v35, s38
    v_mfma_f32_16x16x32_bf16 v[132:135], a[96:99], a[112:115], v[132:135]
    s_waitcnt lgkmcnt(8)
    ds_read_b128 a[164:167], v41 offset:61440
    v_perm_b32 v46, v77, v35, s39
    v_mfma_f32_16x16x32_bf16 v[136:139], a[96:99], a[128:131], v[136:139]
    s_mov_b32 s45, 98304
    ds_read_b32 a125, v29
    ds_read_b32 a126, v31
    v_mfma_f32_16x16x32_bf16 v[136:139], a[100:103], a[132:135], v[136:139]
    buffer_load_dwordx3 v[100:102], v18, s[4:7], s61 offen nt
    v_mfma_f32_16x16x32_bf16 v[140:143], a[100:103], a[140:143], v[140:143]
    s_waitcnt vmcnt(13)
    ds_read_b128 a[168:171], v40 offset:63488
    v_bitop3_b32 v56, v83, v87, s76 bitop3:0x7e
    v_mfma_f32_16x16x32_bf16 v[140:143], a[96:99], a[136:139], v[140:143]
    s_waitcnt lgkmcnt(8)
    ds_read_b128 a[172:175], v41 offset:63488
    ds_read_b32 a127, v46
    v_mfma_f32_16x16x32_bf16 v[144:147], a[96:99], a[144:147], v[144:147]
    s_waitcnt lgkmcnt(8)
    v_perm_b32 v57, v74, v35, s36
    v_mfma_f32_16x16x32_bf16 v[144:147], a[100:103], a[148:151], v[144:147]
    buffer_load_dword v103, v19, s[4:7], s61 offen nt
    v_mfma_f32_16x16x32_bf16 v[148:151], a[100:103], a[156:159], v[148:151]
    s_add_u32 s61, s61, 14336
    ds_read_b32 a176, v57
    v_perm_b32 v58, v74, v35, s37
    v_mfma_f32_16x16x32_bf16 v[148:151], a[96:99], a[152:155], v[148:151]
    s_waitcnt lgkmcnt(7)
    v_cmp_lt_u32 vcc, 0xffff, v56
    v_perm_b32 v59, v74, v35, s38
    v_mfma_f32_16x16x32_bf16 v[152:155], a[96:99], a[160:163], v[152:155]
    s_waitcnt lgkmcnt(6)
    ds_read_b32 a177, v58
    ds_read_b32 a178, v59
    v_mfma_f32_16x16x32_bf16 v[152:155], a[100:103], a[164:167], v[152:155]
    s_waitcnt lgkmcnt(4)
    buffer_load_dwordx3 v[104:106], v18, s[4:7], s61 offen nt
    v_mfma_f32_16x16x32_bf16 v[156:159], a[100:103], a[172:175], v[156:159]
    v_perm_b32 v60, v74, v35, s39
    s_cbranch_vccnz L_slow1_0
L_back1_0:
    v_mfma_f32_16x16x32_bf16 v[156:159], a[96:99], a[168:171], v[156:159]
    s_waitcnt lgkmcnt(3)
    v_perm_b32 v61, v78, v35, s36
    v_perm_b32 v62, v78, v35, s37
    v_mfma_f32_16x16x32_bf16 v[160:163], a[120:123], a[104:107], v[160:163]
    s_mov_b32 s72, 114688
    ds_read_b32 a179, v60
    ds_read_b32 a180, v61
    v_mfma_f32_16x16x32_bf16 v[160:163], a[124:127], a[108:111], v[160:163]
    buffer_load_dword v107, v19, s[4:7], s61 offen nt
    v_mfma_f32_16x16x32_bf16 v[164:167], a[124:127], a[116:119], v[164:167]
    s_add_u32 s61, s61, 14336
    ds_read_b32 a181, v62
    v_perm_b32 v63, v78, v35, s38
    v_mfma_f32_16x16x32_bf16 v[164:167], a[120:123], a[112:115], v[164:167]
    v_perm_b32 v5, v78, v35, s39
    v_perm_b32 v6, v75, v35, s36
    v_mfma_f32_16x16x32_bf16 v[168:171], a[120:123], a[128:131], v[168:171]
    ds_read_b32 a182, v63
    ds_read_b32 a183, v5
    v_mfma_f32_16x16x32_bf16 v[168:171], a[124:127], a[132:135], v[168:171]
    buffer_load_dwordx3 v[108:110], v18, s[4:7], s61 offen nt
    v_mfma_f32_16x16x32_bf16 v[172:175], a[124:127], a[140:143], v[172:175]
    ds_read_b32 a92, v6
    v_perm_b32 v7, v75, v35, s37
    v_mfma_f32_16x16x32_bf16 v[172:175], a[120:123], a[136:139], v[172:175]
    v_perm_b32 v27, v79, v35, s36
    v_perm_b32 v29, v79, v35, s37
    v_mfma_f32_16x16x32_bf16 v[176:179], a[120:123], a[144:147], v[176:179]
    ds_read_b32 a93, v7
    ds_read_b32 a94, v27
    v_mfma_f32_16x16x32_bf16 v[176:179], a[124:127], a[148:151], v[176:179]
    buffer_load_dword v111, v19, s[4:7], s61 offen nt
    v_mfma_f32_16x16x32_bf16 v[180:183], a[124:127], a[156:159], v[180:183]
    s_add_u32 s61, s61, 14336
    ds_read_b32 a95, v29
    v_perm_b32 v31, v80, v35, s36
    v_mfma_f32_16x16x32_bf16 v[180:183], a[120:123], a[152:155], v[180:183]
    v_perm_b32 v46, v80, v35, s37
    v_perm_b32 v57, v80, v35, s38
    v_mfma_f32_16x16x32_bf16 v[184:187], a[120:123], a[160:163], v[184:187]
    ds_read_b32 a184, v31
    ds_read_b32 a185, v46
    v_mfma_f32_16x16x32_bf16 v[184:187], a[124:127], a[164:167], v[184:187]
    buffer_load_dwordx3 v[112:114], v18, s[4:7], s61 offen nt
    v_mfma_f32_16x16x32_bf16 v[188:191], a[124:127], a[172:175], v[188:191]
    s_mul_i32 s66, s63, 96
    s_lshl_b32 s67, s65, 5
    s_lshl_b32 s70, s64, 2
    s_add_u32 s67, s67, s70
    s_add_u32 s67, s67, 384
    s_mul_i32 s71, s59, 448
    s_add_u32 s70, s66, s71
    v_mad_u32_u24 v22, v3, 24, s70
    s_add_u32 s70, s67, s71
    v_lshl_add_u32 v23, v3, 3, s70
    s_mov_b32 s34, 7168
    s_mov_b32 s35, 0x20000
    s_mov_b32 s26, 256
    s_mov_b32 s27, 0x20000
    s_lshl_b32 s77, s59, 4
    s_mov_b32 s18, 14680064
    s_mov_b32 s19, 0x20000
    s_sub_u32 s70, 1024, s71
    v_mul_u32_u24 v16, 464, v4
    v_add3_u32 v26, v22, v16, s70
    v_add3_u32 v28, v23, v16, s70
    s_lshl_b32 s70, s63, 9
    s_add_u32 s60, s70, 52992
    s_xor_b32 s70, s70, 512
    s_add_u32 s70, s70, 52992
    v_lshl_add_u32 v30, v2, 2, s70
    v_mul_u32_u24 v16, 2341, v2
    v_lshrrev_b32 v16, 16, v16
    s_mul_i32 s73, s63, 1856
    s_add_u32 s73, s73, 1024
    v_add_lshl_u32 v24, v2, v16, 4
    v_add_u32 v24, s73, v24
    s_lshl_b32 s74, s58, 7
    s_lshl_b32 s75, s63, 2
    s_add_u32 s74, s74, s75
    s_mul_i32 s74, s74, 7168
    s_add_u32 s74, s74, s71
    v_mul_u32_u24 v17, 6720, v16
    v_lshl_add_u32 v25, v2, 4, v17
    v_lshrrev_b32 v16, 1, v16
    v_lshlrev_b32 v16, 30, v16
    v_add3_u32 v25, v25, v16, s74
    v_mov_b32 v45, 1
    v_lshlrev_b32 v1, 22, v0
    v_mov_b32 v47, s76
    v_mfma_f32_16x16x32_bf16 v[188:191], a[120:123], a[168:171], v[188:191]
    s_waitcnt vmcnt(15) lgkmcnt(5)
    s_add_u32 s61, s61, 14336
    ds_read_b32 a186, v57
    v_perm_b32 v56, v80, v35, s39
    v_mfma_f32_16x16x32_bf16 v[192:195], a[176:179], a[104:107], v[192:195]
    s_barrier
    v_mfma_f32_16x16x32_bf16 v[192:195], a[180:183], a[108:111], v[192:195]
    buffer_load_dwordx3 v[116:118], v18, s[4:7], s61 offen nt
    v_mfma_f32_16x16x32_bf16 v[196:199], a[180:183], a[116:119], v[196:199]
    s_add_u32 s61, s61, 14336
    ds_read_b32 a187, v56
    v_perm_b32 v58, v84, v35, s36
    v_mfma_f32_16x16x32_bf16 v[196:199], a[176:179], a[112:115], v[196:199]
    ds_read_b32 a188, v58
    ds_read_b128 a[192:195], v42 offset:0
    v_mfma_f32_16x16x32_bf16 v[200:203], a[176:179], a[128:131], v[200:203]
    ds_read_b128 a[196:199], v43 offset:0
    v_mfma_f32_16x16x32_bf16 v[200:203], a[180:183], a[132:135], v[200:203]
    buffer_load_dwordx3 v[120:122], v18, s[4:7], s61 offen nt
    v_mfma_f32_16x16x32_bf16 v[204:207], a[180:183], a[140:143], v[204:207]
    s_add_u32 s61, s61, 14336
    ds_read_b128 a[204:207], v43 offset:2048
    v_perm_b32 v59, v84, v35, s37
    v_mfma_f32_16x16x32_bf16 v[204:207], a[176:179], a[136:139], v[204:207]
    ds_read_b32 a189, v59
    ds_read_b128 a[200:203], v42 offset:2048
    v_perm_b32 v60, v84, v35, s38
    v_mfma_f32_16x16x32_bf16 v[208:211], a[176:179], a[144:147], v[208:211]
    ds_read_b32 a190, v60
    ds_read_b128 a[208:211], v42 offset:4096
    v_mfma_f32_16x16x32_bf16 v[208:211], a[180:183], a[148:151], v[208:211]
    buffer_load_dwordx3 v[124:126], v18, s[4:7], s61 offen nt
    v_mfma_f32_16x16x32_bf16 v[212:215], a[180:183], a[156:159], v[212:215]
    ds_read_b128 a[212:215], v43 offset:4096
    v_perm_b32 v61, v84, v35, s39
    v_mfma_f32_16x16x32_bf16 v[212:215], a[176:179], a[152:155], v[212:215]
    ds_read_b32 a191, v61
    ds_read_b128 a[220:223], v43 offset:6144
    v_mfma_f32_16x16x32_bf16 v[216:219], a[176:179], a[160:163], v[216:219]
    ds_read_b128 a[216:219], v42 offset:6144
    v_perm_b32 v62, v81, v35, s36
    v_mfma_f32_16x16x32_bf16 v[216:219], a[180:183], a[164:167], v[216:219]
    ds_read_b128 a[224:227], v42 offset:8192
    ds_read_b32 a232, v62
    v_mfma_f32_16x16x32_bf16 v[220:223], a[180:183], a[172:175], v[220:223]
    buffer_load_dwordx4 v[48:51], v32, s[12:15], s41 offen sc1
    v_mfma_f32_16x16x32_bf16 v[220:223], a[176:179], a[168:171], v[220:223]
    s_waitcnt lgkmcnt(10)
    ds_read_b128 a[228:231], v43 offset:8192
    v_perm_b32 v63, v81, v35, s37
    v_mfma_f32_16x16x32_bf16 v[224:227], a[92:95], a[106:109], v[224:227]
    ds_read_b128 a[244:247], v43 offset:10240
    ds_read_b32 a233, v63
    v_mfma_f32_16x16x32_bf16 v[228:231], a[92:95], a[114:117], v[228:231]
    ds_read_b128 a[240:243], v42 offset:10240
    v_perm_b32 v5, v81, v35, s38
    v_mfma_f32_16x16x32_bf16 v[232:235], a[92:95], a[130:133], v[232:235]
    ds_read_b128 a[248:251], v42 offset:12288
    ds_read_b32 a234, v5
    v_mfma_f32_16x16x32_bf16 v[236:239], a[92:95], a[138:141], v[236:239]
    buffer_load_dwordx4 v[52:55], v33, s[12:15], s41 offen sc1
    v_mfma_f32_16x16x32_bf16 v[240:243], a[92:95], a[146:149], v[240:243]
    v_perm_b32 v6, v81, v35, s39
    v_perm_b32 v7, v85, v35, s36
    v_mfma_f32_16x16x32_bf16 v[244:247], a[92:95], a[154:157], v[244:247]
    s_waitcnt vmcnt(10)
    ds_read_b128 a[252:255], v43 offset:12288
    ds_read_b32 a235, v6
    v_mfma_f32_16x16x32_bf16 v[248:251], a[92:95], a[162:165], v[248:251]
    v_or_b32 v99, s47, v99
    v_lshl_or_b32 v96, v100, 4, v96
    v_lshl_or_b32 v97, v101, 4, v97
    v_lshl_or_b32 v98, v102, 4, v98
    v_lshl_or_b32 v99, v103, 4, v99
    v_mfma_f32_16x16x32_bf16 v[252:255], a[92:95], a[170:173], v[252:255]
    buffer_load_dwordx4 v36, s[8:11], s56 offen offset:0  lds
    v_mfma_f32_16x16x32_bf16 v[128:131], a[184:187], a[192:195], v[128:131]
    s_waitcnt lgkmcnt(7)
    ds_read_b32 a236, v7
    v_perm_b32 v27, v85, v35, s37
    v_mfma_f32_16x16x32_bf16 v[128:131], a[188:191], a[196:199], v[128:131]
    ds_read_b128 a[32:35], v42 offset:14336
    v_perm_b32 v31, v85, v35, s38
    v_bitop3_b32 v29, v91, v95, s76 bitop3:0x7e
    v_mfma_f32_16x16x32_bf16 v[132:135], a[188:191], a[204:207], v[132:135]
    ds_read_b128 a[36:39], v43 offset:14336
    v_perm_b32 v46, v85, v35, s39
    v_cmp_lt_u32 vcc, 0xffff, v29
    v_mfma_f32_16x16x32_bf16 v[132:135], a[184:187], a[200:203], v[132:135]
    ds_read_b32 a237, v27
    v_perm_b32 v57, v82, v35, s36
    v_mfma_f32_16x16x32_bf16 v[136:139], a[184:187], a[208:211], v[136:139]
    ds_read_b32 a238, v31
    v_perm_b32 v56, v82, v35, s37
    v_mfma_f32_16x16x32_bf16 v[136:139], a[188:191], a[212:215], v[136:139]
    ds_read_b32 a239, v46
    v_perm_b32 v58, v82, v35, s38
    v_mfma_f32_16x16x32_bf16 v[140:143], a[188:191], a[220:223], v[140:143]
    ds_read_b32 a64, v57
    v_perm_b32 v59, v82, v35, s39
    v_mfma_f32_16x16x32_bf16 v[140:143], a[184:187], a[216:219], v[140:143]
    ds_read_b32 a65, v56
    v_perm_b32 v60, v86, v35, s36
    v_mfma_f32_16x16x32_bf16 v[144:147], a[184:187], a[224:227], v[144:147]
    s_waitcnt lgkmcnt(8)
    ds_read_b32 a66, v58
    ds_read_b32 a67, v59
    v_mfma_f32_16x16x32_bf16 v[144:147], a[188:191], a[228:231], v[144:147]
    buffer_load_dwordx4 v37, s[8:11], s56 offen offset:1024  lds
    v_mfma_f32_16x16x32_bf16 v[148:151], a[188:191], a[244:247], v[148:151]
    ds_read_b32 a68, v60
    s_cbranch_vccnz L_slow1_1
L_back1_1:
    v_mfma_f32_16x16x32_bf16 v[148:151], a[184:187], a[240:243], v[148:151]
    v_perm_b32 v61, v86, v35, s37
    v_perm_b32 v62, v86, v35, s38
    v_mfma_f32_16x16x32_bf16 v[152:155], a[184:187], a[248:251], v[152:155]
    s_waitcnt lgkmcnt(7)
    ds_read_b32 a69, v61
    ds_read_b32 a70, v62
    v_mfma_f32_16x16x32_bf16 v[152:155], a[188:191], a[252:255], v[152:155]
    buffer_load_dwordx4 v38, s[8:11], s56 offen offset:2048  lds
    v_mfma_f32_16x16x32_bf16 v[156:159], a[188:191], a[36:39], v[156:159]
    v_perm_b32 v63, v86, v35, s39
    v_perm_b32 v5, v83, v35, s36
    v_mfma_f32_16x16x32_bf16 v[156:159], a[184:187], a[32:35], v[156:159]
    ds_read_b32 a71, v63
    v_perm_b32 v6, v83, v35, s37
    v_mfma_f32_16x16x32_bf16 v[160:163], a[232:235], a[192:195], v[160:163]
    s_waitcnt lgkmcnt(6)
    ds_read_b32 a80, v5
    ds_read_b32 a81, v6
    v_mfma_f32_16x16x32_bf16 v[160:163], a[236:239], a[196:199], v[160:163]
    buffer_load_dwordx4 v39, s[8:11], s56 offen offset:3072  lds
    v_mfma_f32_16x16x32_bf16 v[164:167], a[236:239], a[204:207], v[164:167]
    s_add_u32 m0, s57, 16384
    v_perm_b32 v7, v87, v35, s36
    v_perm_b32 v29, v87, v35, s37
    v_mfma_f32_16x16x32_bf16 v[164:167], a[232:235], a[200:203], v[164:167]
    s_add_u32 s56, s55, 768
    ds_read_b32 a82, v7
    v_perm_b32 v27, v88, v35, s36
    v_mfma_f32_16x16x32_bf16 v[168:171], a[232:235], a[208:211], v[168:171]
    ds_read_b32 a83, v29
    v_perm_b32 v31, v88, v35, s37
    v_mfma_f32_16x16x32_bf16 v[168:171], a[236:239], a[212:215], v[168:171]
    ds_read_b32 a0, v27
    v_perm_b32 v46, v88, v35, s38
    v_mfma_f32_16x16x32_bf16 v[172:175], a[236:239], a[220:223], v[172:175]
    ds_read_b32 a1, v31
    v_perm_b32 v57, v88, v35, s39
    v_mfma_f32_16x16x32_bf16 v[172:175], a[232:235], a[216:219], v[172:175]
    ds_read_b32 a2, v46
    v_perm_b32 v56, v92, v35, s36
    v_mfma_f32_16x16x32_bf16 v[176:179], a[232:235], a[224:227], v[176:179]
    ds_read_b32 a3, v57
    ds_read_b32 a4, v56
    v_mfma_f32_16x16x32_bf16 v[176:179], a[236:239], a[228:231], v[176:179]
    buffer_load_dwordx4 v[64:67], v34, s[12:15], s41 offen sc1
    v_mfma_f32_16x16x32_bf16 v[180:183], a[236:239], a[244:247], v[180:183]
    v_perm_b32 v58, v92, v35, s37
    v_perm_b32 v59, v92, v35, s38
    v_mfma_f32_16x16x32_bf16 v[180:183], a[232:235], a[240:243], v[180:183]
    ds_read_b32 a5, v58
    v_perm_b32 v60, v92, v35, s39
    v_mfma_f32_16x16x32_bf16 v[184:187], a[232:235], a[248:251], v[184:187]
    ds_read_b32 a6, v59
    ds_read_b32 a7, v60
    v_mfma_f32_16x16x32_bf16 v[184:187], a[236:239], a[252:255], v[184:187]
    buffer_load_dwordx4 v[68:71], v44, s[12:15], s41 offen sc1
    v_mfma_f32_16x16x32_bf16 v[188:191], a[236:239], a[36:39], v[188:191]
    v_perm_b32 v61, v89, v35, s36
    v_perm_b32 v62, v89, v35, s37
    v_mfma_f32_16x16x32_bf16 v[188:191], a[232:235], a[32:35], v[188:191]
    s_waitcnt lgkmcnt(6)
    ds_read_b32 a8, v61
    v_perm_b32 v63, v89, v35, s38
    v_mfma_f32_16x16x32_bf16 v[192:195], a[64:67], a[192:195], v[192:195]
    s_barrier
    v_mfma_f32_16x16x32_bf16 v[192:195], a[68:71], a[196:199], v[192:195]
    buffer_load_dwordx4 v[72:75], v32, s[12:15], s42 offen sc1
    v_mfma_f32_16x16x32_bf16 v[196:199], a[68:71], a[204:207], v[196:199]
    ds_read_b32 a9, v62
    v_perm_b32 v5, v89, v35, s39
    v_mfma_f32_16x16x32_bf16 v[196:199], a[64:67], a[200:203], v[196:199]
    ds_read_b32 a10, v63
    ds_read_b32 a11, v5
    v_mfma_f32_16x16x32_bf16 v[200:203], a[64:67], a[208:211], v[200:203]
    ds_read_b128 a[16:19], v42 offset:16384
    v_mfma_f32_16x16x32_bf16 v[200:203], a[68:71], a[212:215], v[200:203]
    buffer_load_dwordx4 v[76:79], v33, s[12:15], s42 offen sc1
    v_mfma_f32_16x16x32_bf16 v[204:207], a[68:71], a[220:223], v[204:207]
    ds_read_b128 a[20:23], v43 offset:16384
    v_perm_b32 v6, v93, v35, s36
    v_mfma_f32_16x16x32_bf16 v[204:207], a[64:67], a[216:219], v[204:207]
    ds_read_b32 a12, v6
    v_perm_b32 v7, v93, v35, s37
    v_mfma_f32_16x16x32_bf16 v[208:211], a[64:67], a[224:227], v[208:211]
    ds_read_b32 a13, v7
    v_perm_b32 v29, v93, v35, s38
    v_mfma_f32_16x16x32_bf16 v[208:211], a[68:71], a[228:231], v[208:211]
    ds_read_b32 a14, v29
    ds_read_b128 a[24:27], v42 offset:18432
    v_mfma_f32_16x16x32_bf16 v[212:215], a[68:71], a[244:247], v[212:215]
    buffer_load_dwordx4 v36, s[8:11], s3 offen offset:0  lds
    v_mfma_f32_16x16x32_bf16 v[212:215], a[64:67], a[240:243], v[212:215]
    ds_read_b128 a[28:31], v43 offset:18432
    v_perm_b32 v27, v93, v35, s39
    v_mfma_f32_16x16x32_bf16 v[216:219], a[64:67], a[248:251], v[216:219]
    ds_read_b32 a15, v27
    v_perm_b32 v31, v90, v35, s36
    v_mfma_f32_16x16x32_bf16 v[216:219], a[68:71], a[252:255], v[216:219]
    s_waitcnt vmcnt(16)
    ds_read_b32 a48, v31
    ds_read_b128 a[40:43], v42 offset:20480
    v_mfma_f32_16x16x32_bf16 v[220:223], a[68:71], a[36:39], v[220:223]
    buffer_load_dwordx4 v37, s[8:11], s3 offen offset:1024  lds
    v_mfma_f32_16x16x32_bf16 v[220:223], a[64:67], a[32:35], v[220:223]
    v_lshl_or_b32 v96, v104, 8, v96
    v_lshl_or_b32 v97, v105, 8, v97
    v_lshl_or_b32 v98, v106, 8, v98
    v_lshl_or_b32 v99, v107, 8, v99
    v_lshl_or_b32 v96, v108, 12, v96
    v_lshl_or_b32 v97, v109, 12, v97
    v_lshl_or_b32 v98, v110, 12, v98
    s_waitcnt vmcnt(16)
    v_lshl_or_b32 v99, v111, 12, v99
    s_waitcnt vmcnt(15)
    v_lshl_or_b32 v96, v112, 16, v96
    v_lshl_or_b32 v97, v113, 16, v97
    v_lshl_or_b32 v98, v114, 16, v98
    s_waitcnt vmcnt(14)
    v_lshl_or_b32 v96, v116, 20, v96
    v_lshl_or_b32 v97, v117, 20, v97
    v_lshl_or_b32 v98, v118, 20, v98
    s_waitcnt vmcnt(13)
    v_lshl_or_b32 v96, v120, 24, v96
    v_lshl_or_b32 v97, v121, 24, v97
    v_lshl_or_b32 v98, v122, 24, v98
L_pad1:
    s_cbranch_execz L_pad2
    s_waitcnt vmcnt(12)
    v_lshl_or_b32 v96, v124, 28, v96
    v_lshl_or_b32 v97, v125, 28, v97
    v_lshl_or_b32 v98, v126, 28, v98
    buffer_store_dwordx4 v[96:99], v20, s[12:15], s62 offen sc1
    v_mfma_f32_16x16x32_bf16 v[224:227], a[80:83], a[194:197], v[224:227]
    s_waitcnt vmcnt(11)
    ds_read_b128 a[44:47], v43 offset:20480
    v_perm_b32 v57, v90, v35, s37
    v_bitop3_b32 v46, v51, v55, s76 bitop3:0x7e
    v_mfma_f32_16x16x32_bf16 v[228:231], a[80:83], a[202:205], v[228:231]
    ds_read_b32 a49, v57
    v_perm_b32 v56, v90, v35, s38
    v_cmp_lt_u32 vcc, 0xffff, v46
    v_mfma_f32_16x16x32_bf16 v[232:235], a[80:83], a[210:213], v[232:235]
    ds_read_b128 a[60:63], v43 offset:22528
    ds_read_b32 a50, v56
    v_mfma_f32_16x16x32_bf16 v[236:239], a[80:83], a[218:221], v[236:239]
    buffer_load_dwordx4 v38, s[8:11], s3 offen offset:2048  lds
    v_mfma_f32_16x16x32_bf16 v[240:243], a[80:83], a[226:229], v[240:243]
    ds_read_b128 a[56:59], v42 offset:22528
    s_cbranch_vccnz L_slow2_0
L_back2_0:
    v_mfma_f32_16x16x32_bf16 v[244:247], a[80:83], a[242:245], v[244:247]
    ds_read_b128 a[72:75], v42 offset:24576
    v_perm_b32 v58, v90, v35, s39
    v_mfma_f32_16x16x32_bf16 v[248:251], a[80:83], a[250:253], v[248:251]
    s_waitcnt lgkmcnt(6)
    ds_read_b128 a[76:79], v43 offset:24576
    ds_read_b32 a51, v58
    v_mfma_f32_16x16x32_bf16 v[252:255], a[80:83], a[34:37], v[252:255]
    buffer_load_dwordx4 v39, s[8:11], s3 offen offset:3072  lds
    v_mfma_f32_16x16x32_bf16 v[128:131], a[0:3], a[16:19], v[128:131]
    s_add_u32 m0, s57, 32768
    ds_read_b128 a[100:103], v43 offset:26624
    v_perm_b32 v59, v94, v35, s36
    v_mfma_f32_16x16x32_bf16 v[128:131], a[4:7], a[20:23], v[128:131]
    s_add_u32 s3, s69, 768
    ds_read_b128 a[96:99], v42 offset:26624
    v_perm_b32 v60, v94, v35, s37
    v_mfma_f32_16x16x32_bf16 v[132:135], a[4:7], a[28:31], v[132:135]
    ds_read_b128 a[120:123], v42 offset:28672
    ds_read_b32 a52, v59
    v_mfma_f32_16x16x32_bf16 v[132:135], a[0:3], a[24:27], v[132:135]
    buffer_load_dwordx4 v36, s[8:11], s56 offen offset:0  lds
    v_mfma_f32_16x16x32_bf16 v[136:139], a[0:3], a[40:43], v[136:139]
    s_waitcnt lgkmcnt(8)
    ds_read_b128 a[124:127], v43 offset:28672
    v_perm_b32 v61, v94, v35, s38
    v_mfma_f32_16x16x32_bf16 v[136:139], a[4:7], a[44:47], v[136:139]
    ds_read_b128 a[176:179], v42 offset:30720
    v_perm_b32 v62, v94, v35, s39
    v_mfma_f32_16x16x32_bf16 v[140:143], a[4:7], a[60:63], v[140:143]
    s_waitcnt lgkmcnt(8)
    ds_read_b32 a53, v60
    v_perm_b32 v63, v91, v35, s36
    v_mfma_f32_16x16x32_bf16 v[140:143], a[0:3], a[56:59], v[140:143]
    s_waitcnt lgkmcnt(7)
    ds_read_b128 a[180:183], v43 offset:30720
    ds_read_b32 a54, v61
    v_mfma_f32_16x16x32_bf16 v[144:147], a[0:3], a[72:75], v[144:147]
    buffer_load_dwordx4 v37, s[8:11], s56 offen offset:1024  lds
    v_mfma_f32_16x16x32_bf16 v[144:147], a[4:7], a[76:79], v[144:147]
    s_waitcnt lgkmcnt(8)
    ds_read_b32 a55, v62
    v_perm_b32 v5, v91, v35, s37
    v_mfma_f32_16x16x32_bf16 v[148:151], a[4:7], a[100:103], v[148:151]
    s_waitcnt lgkmcnt(8)
    ds_read_b32 a84, v63
    v_perm_b32 v6, v95, v35, s36
    v_mfma_f32_16x16x32_bf16 v[148:151], a[0:3], a[96:99], v[148:151]
    s_waitcnt lgkmcnt(7)
    ds_read_b32 a85, v5
    v_perm_b32 v7, v95, v35, s37
    v_mfma_f32_16x16x32_bf16 v[152:155], a[0:3], a[120:123], v[152:155]
    s_waitcnt lgkmcnt(7)
    ds_read_b32 a86, v6
    v_perm_b32 v29, v48, v35, s36
    v_mfma_f32_16x16x32_bf16 v[152:155], a[4:7], a[124:127], v[152:155]
    s_waitcnt lgkmcnt(5)
    ds_read_b32 a87, v7
    v_perm_b32 v27, v48, v35, s37
    v_mfma_f32_16x16x32_bf16 v[156:159], a[4:7], a[180:183], v[156:159]
    ds_read_b32 a104, v29
    v_perm_b32 v31, v48, v35, s38
    v_mfma_f32_16x16x32_bf16 v[156:159], a[0:3], a[176:179], v[156:159]
    s_waitcnt vmcnt(11)
    ds_read_b32 a105, v27
    v_perm_b32 v46, v48, v35, s39
    v_mfma_f32_16x16x32_bf16 v[160:163], a[8:11], a[16:19], v[160:163]
    s_barrier
    v_mfma_f32_16x16x32_bf16 v[160:163], a[12:15], a[20:23], v[160:163]
    buffer_load_dwordx4 v38, s[8:11], s56 offen offset:2048  lds
    v_mfma_f32_16x16x32_bf16 v[164:167], a[12:15], a[28:31], v[164:167]
    ds_read_b32 a106, v31
    v_perm_b32 v57, v52, v35, s36
    v_mfma_f32_16x16x32_bf16 v[164:167], a[8:11], a[24:27], v[164:167]
    ds_read_b32 a107, v46
    ds_read_b32 a108, v57
    v_mfma_f32_16x16x32_bf16 v[168:171], a[8:11], a[40:43], v[168:171]
    v_perm_b32 v56, v52, v35, s37
    v_perm_b32 v58, v52, v35, s38
    v_mfma_f32_16x16x32_bf16 v[168:171], a[12:15], a[44:47], v[168:171]
    ds_read_b32 a109, v56
    ds_read_b128 a[112:115], v40 offset:0
    v_mfma_f32_16x16x32_bf16 v[172:175], a[12:15], a[60:63], v[172:175]
    buffer_load_dwordx4 v39, s[8:11], s56 offen offset:3072  lds
    v_mfma_f32_16x16x32_bf16 v[172:175], a[8:11], a[56:59], v[172:175]
    s_add_u32 m0, s57, 49152
    ds_read_b32 a110, v58
    v_perm_b32 v59, v52, v35, s39
    v_mfma_f32_16x16x32_bf16 v[176:179], a[8:11], a[72:75], v[176:179]
    s_add_u32 s56, s55, 1024
    ds_read_b128 a[116:119], v41 offset:0
    ds_read_b32 a111, v59
    v_mfma_f32_16x16x32_bf16 v[176:179], a[12:15], a[76:79], v[176:179]
    ds_read_b128 a[132:135], v41 offset:2048
    v_mfma_f32_16x16x32_bf16 v[180:183], a[12:15], a[100:103], v[180:183]
    buffer_load_dwordx4 v36, s[8:11], s3 offen offset:0  lds
    v_mfma_f32_16x16x32_bf16 v[180:183], a[8:11], a[96:99], v[180:183]
    ds_read_b128 a[128:131], v40 offset:2048
    v_perm_b32 v60, v49, v35, s36
    v_mfma_f32_16x16x32_bf16 v[184:187], a[8:11], a[120:123], v[184:187]
    ds_read_b128 a[136:139], v40 offset:4096
    v_perm_b32 v61, v49, v35, s37
    v_mfma_f32_16x16x32_bf16 v[184:187], a[12:15], a[124:127], v[184:187]
    s_waitcnt vmcnt(12) lgkmcnt(8)
    ds_read_b128 a[140:143], v41 offset:4096
    ds_read_b32 a144, v60
    v_mfma_f32_16x16x32_bf16 v[188:191], a[12:15], a[180:183], v[188:191]
    buffer_load_dwordx4 v37, s[8:11], s3 offen offset:1024  lds
    v_mfma_f32_16x16x32_bf16 v[188:191], a[8:11], a[176:179], v[188:191]
    ds_read_b32 a145, v61
    v_perm_b32 v63, v49, v35, s38
    v_bitop3_b32 v62, v67, v71, s76 bitop3:0x7e
    v_mfma_f32_16x16x32_bf16 v[192:195], a[48:51], a[16:19], v[192:195]
    ds_read_b128 a[152:155], v40 offset:6144
    v_perm_b32 v5, v49, v35, s39
    v_cmp_lt_u32 vcc, 0xffff, v62
    v_mfma_f32_16x16x32_bf16 v[192:195], a[52:55], a[20:23], v[192:195]
    ds_read_b32 a146, v63
    v_perm_b32 v6, v53, v35, s36
    v_mfma_f32_16x16x32_bf16 v[196:199], a[52:55], a[28:31], v[196:199]
    ds_read_b32 a147, v5
    s_cbranch_vccnz L_slow2_1
L_back2_1:
    v_mfma_f32_16x16x32_bf16 v[196:199], a[48:51], a[24:27], v[196:199]
    ds_read_b128 a[156:159], v41 offset:6144
    ds_read_b32 a148, v6
    v_perm_b32 v7, v53, v35, s37
    v_mfma_f32_16x16x32_bf16 v[200:203], a[48:51], a[40:43], v[200:203]
    ds_read_b32 a149, v7
    v_perm_b32 v29, v53, v35, s38
    v_mfma_f32_16x16x32_bf16 v[200:203], a[52:55], a[44:47], v[200:203]
    ds_read_b32 a150, v29
    ds_read_b128 a[160:163], v40 offset:8192
    v_mfma_f32_16x16x32_bf16 v[204:207], a[52:55], a[60:63], v[204:207]
    buffer_load_dwordx4 v38, s[8:11], s3 offen offset:2048  lds
    v_mfma_f32_16x16x32_bf16 v[204:207], a[48:51], a[56:59], v[204:207]
    v_perm_b32 v27, v53, v35, s39
    v_perm_b32 v31, v50, v35, s36
    v_mfma_f32_16x16x32_bf16 v[208:211], a[48:51], a[72:75], v[208:211]
    ds_read_b32 a151, v27
    v_perm_b32 v46, v50, v35, s37
    v_mfma_f32_16x16x32_bf16 v[208:211], a[52:55], a[76:79], v[208:211]
    ds_read_b128 a[164:167], v41 offset:8192
    v_perm_b32 v57, v50, v35, s38
    v_mfma_f32_16x16x32_bf16 v[212:215], a[52:55], a[100:103], v[212:215]
    v_perm_b32 v56, v50, v35, s39
    v_perm_b32 v58, v54, v35, s36
    v_mfma_f32_16x16x32_bf16 v[212:215], a[48:51], a[96:99], v[212:215]
    v_perm_b32 v59, v54, v35, s37
    v_perm_b32 v60, v54, v35, s38
    v_mfma_f32_16x16x32_bf16 v[216:219], a[48:51], a[120:123], v[216:219]
    ds_read_b128 a[88:91], v40 offset:10240
    ds_read_b32 a168, v31
    v_mfma_f32_16x16x32_bf16 v[216:219], a[52:55], a[124:127], v[216:219]
    buffer_load_dwordx4 v39, s[8:11], s3 offen offset:3072  lds
    v_mfma_f32_16x16x32_bf16 v[220:223], a[52:55], a[180:183], v[220:223]
    s_add_u32 m0, s57, 65536
    ds_read_b32 a169, v46
    v_perm_b32 v61, v54, v35, s39
    v_mfma_f32_16x16x32_bf16 v[220:223], a[48:51], a[176:179], v[220:223]
    s_add_u32 s3, s69, 1024
    ds_read_b128 a[92:95], v41 offset:10240
    ds_read_b32 a170, v57
    v_mfma_f32_16x16x32_bf16 v[224:227], a[84:87], a[18:21], v[224:227]
    ds_read_b32 a171, v56
    v_perm_b32 v62, v51, v35, s36
    v_mfma_f32_16x16x32_bf16 v[228:231], a[84:87], a[26:29], v[228:231]
    ds_read_b32 a172, v58
    ds_read_b32 a173, v59
    v_mfma_f32_16x16x32_bf16 v[232:235], a[84:87], a[42:45], v[232:235]
    buffer_load_dwordx4 v[100:103], v34, s[12:15], s42 offen sc1
    v_mfma_f32_16x16x32_bf16 v[236:239], a[84:87], a[58:61], v[236:239]
    ds_read_b128 a[184:187], v40 offset:12288
    ds_read_b32 a174, v60
    v_mfma_f32_16x16x32_bf16 v[240:243], a[84:87], a[74:77], v[240:243]
    ds_read_b32 a175, v61
    v_perm_b32 v63, v51, v35, s37
    v_mfma_f32_16x16x32_bf16 v[244:247], a[84:87], a[98:101], v[244:247]
    ds_read_b128 a[188:191], v41 offset:12288
    ds_read_b32 a232, v62
    v_mfma_f32_16x16x32_bf16 v[248:251], a[84:87], a[122:125], v[248:251]
    buffer_load_dwordx4 v[80:83], v44, s[12:15], s42 offen sc1
    v_mfma_f32_16x16x32_bf16 v[252:255], a[84:87], a[178:181], v[252:255]
    s_waitcnt lgkmcnt(10)
    v_perm_b32 v5, v55, v35, s36
    v_perm_b32 v6, v55, v35, s37
    v_mfma_f32_16x16x32_bf16 v[128:131], a[104:107], a[112:115], v[128:131]
    ds_read_b128 a[64:67], v40 offset:14336
    v_perm_b32 v7, v64, v35, s36
    v_mfma_f32_16x16x32_bf16 v[128:131], a[108:111], a[116:119], v[128:131]
    v_perm_b32 v29, v64, v35, s37
    v_perm_b32 v27, v64, v35, s38
    v_mfma_f32_16x16x32_bf16 v[132:135], a[108:111], a[132:135], v[132:135]
    ds_read_b128 a[68:71], v41 offset:14336
    v_perm_b32 v31, v64, v35, s39
    v_mfma_f32_16x16x32_bf16 v[132:135], a[104:107], a[128:131], v[132:135]
    ds_read_b32 a233, v63
    v_perm_b32 v46, v68, v35, s36
    v_mfma_f32_16x16x32_bf16 v[136:139], a[104:107], a[136:139], v[136:139]
    ds_read_b32 a234, v5
    v_perm_b32 v57, v68, v35, s37
    v_mfma_f32_16x16x32_bf16 v[136:139], a[108:111], a[140:143], v[136:139]
    ds_read_b32 a235, v6
    ds_read_b32 a192, v7
    v_mfma_f32_16x16x32_bf16 v[140:143], a[108:111], a[156:159], v[140:143]
    buffer_load_dwordx4 v36, s[8:11], s56 offen offset:0  lds
    v_mfma_f32_16x16x32_bf16 v[140:143], a[104:107], a[152:155], v[140:143]
    ds_read_b32 a193, v29
    v_perm_b32 v56, v68, v35, s38
    v_mfma_f32_16x16x32_bf16 v[144:147], a[104:107], a[160:163], v[144:147]
    ds_read_b32 a194, v27
    v_perm_b32 v58, v68, v35, s39
    v_mfma_f32_16x16x32_bf16 v[144:147], a[108:111], a[164:167], v[144:147]
    s_waitcnt lgkmcnt(7)
    ds_read_b32 a195, v31
    ds_read_b32 a196, v46
    v_mfma_f32_16x16x32_bf16 v[148:151], a[108:111], a[92:95], v[148:151]
    ds_read_b32 a197, v57
    v_perm_b32 v59, v65, v35, s36
    v_mfma_f32_16x16x32_bf16 v[148:151], a[104:107], a[88:91], v[148:151]
    s_waitcnt vmcnt(16)
    v_perm_b32 v61, v65, v35, s37
    v_bitop3_b32 v60, v75, v79, s76 bitop3:0x7e
    v_mfma_f32_16x16x32_bf16 v[152:155], a[104:107], a[184:187], v[152:155]
    s_waitcnt lgkmcnt(8)
    ds_read_b32 a198, v56
    ds_read_b32 a199, v58
    v_mfma_f32_16x16x32_bf16 v[152:155], a[108:111], a[188:191], v[152:155]
    buffer_load_dwordx4 v37, s[8:11], s56 offen offset:1024  lds
    v_mfma_f32_16x16x32_bf16 v[156:159], a[108:111], a[68:71], v[156:159]
    v_cmp_lt_u32 vcc, 0xffff, v60
    v_perm_b32 v62, v65, v35, s38
    v_mfma_f32_16x16x32_bf16 v[156:159], a[104:107], a[64:67], v[156:159]
    v_perm_b32 v63, v65, v35, s39
    v_perm_b32 v5, v69, v35, s36
    v_mfma_f32_16x16x32_bf16 v[160:163], a[144:147], a[112:115], v[160:163]
    ds_read_b32 a200, v59
    s_cbranch_vccnz L_slow3_0
L_back3_0:
    v_mfma_f32_16x16x32_bf16 v[160:163], a[148:151], a[116:119], v[160:163]
    ds_read_b32 a201, v61
    v_perm_b32 v6, v69, v35, s37
    v_mfma_f32_16x16x32_bf16 v[164:167], a[148:151], a[132:135], v[164:167]
    v_perm_b32 v7, v69, v35, s38
    v_perm_b32 v29, v69, v35, s39
    v_mfma_f32_16x16x32_bf16 v[164:167], a[144:147], a[128:131], v[164:167]
    ds_read_b32 a202, v62
    ds_read_b32 a203, v63
    v_mfma_f32_16x16x32_bf16 v[168:171], a[144:147], a[136:139], v[168:171]
    buffer_load_dwordx4 v[84:87], v32, s[12:15], s43 offen sc1
    v_mfma_f32_16x16x32_bf16 v[168:171], a[148:151], a[140:143], v[168:171]
    ds_read_b32 a204, v5
    v_perm_b32 v27, v66, v35, s36
    v_mfma_f32_16x16x32_bf16 v[172:175], a[148:151], a[156:159], v[172:175]
    ds_read_b32 a205, v6
    v_perm_b32 v31, v66, v35, s37
    v_mfma_f32_16x16x32_bf16 v[172:175], a[144:147], a[152:155], v[172:175]
    ds_read_b32 a206, v7
    ds_read_b32 a207, v29
    v_mfma_f32_16x16x32_bf16 v[176:179], a[144:147], a[160:163], v[176:179]
    buffer_load_dwordx4 v[96:99], v33, s[12:15], s43 offen sc1
    v_mfma_f32_16x16x32_bf16 v[176:179], a[148:151], a[164:167], v[176:179]
    v_perm_b32 v46, v66, v35, s38
    v_perm_b32 v57, v66, v35, s39
    v_mfma_f32_16x16x32_bf16 v[180:183], a[148:151], a[92:95], v[180:183]
    ds_read_b32 a208, v27
    v_perm_b32 v56, v70, v35, s36
    v_mfma_f32_16x16x32_bf16 v[180:183], a[144:147], a[88:91], v[180:183]
    ds_read_b32 a209, v31
    v_perm_b32 v58, v70, v35, s37
    v_mfma_f32_16x16x32_bf16 v[184:187], a[144:147], a[184:187], v[184:187]
    ds_read_b32 a210, v46
    v_perm_b32 v60, v70, v35, s38
    v_mfma_f32_16x16x32_bf16 v[184:187], a[148:151], a[188:191], v[184:187]
    ds_read_b32 a211, v57
    ds_read_b32 a212, v56
    v_mfma_f32_16x16x32_bf16 v[188:191], a[148:151], a[68:71], v[188:191]
    buffer_load_dwordx4 v38, s[8:11], s56 offen offset:2048  lds
    v_mfma_f32_16x16x32_bf16 v[188:191], a[144:147], a[64:67], v[188:191]
    s_waitcnt vmcnt(15)
    ds_read_b32 a213, v58
    v_perm_b32 v59, v70, v35, s39
    v_mfma_f32_16x16x32_bf16 v[192:195], a[168:171], a[112:115], v[192:195]
    s_barrier
    v_mfma_f32_16x16x32_bf16 v[192:195], a[172:175], a[116:119], v[192:195]
    ds_read_b32 a214, v60
    v_perm_b32 v61, v67, v35, s36
    v_mfma_f32_16x16x32_bf16 v[196:199], a[172:175], a[132:135], v[196:199]
    v_perm_b32 v62, v67, v35, s37
    v_perm_b32 v63, v71, v35, s36
    v_mfma_f32_16x16x32_bf16 v[196:199], a[168:171], a[128:131], v[196:199]
    ds_read_b32 a215, v59
    v_perm_b32 v5, v71, v35, s37
    v_mfma_f32_16x16x32_bf16 v[200:203], a[168:171], a[136:139], v[200:203]
    ds_read_b32 a236, v61
    ds_read_b32 a237, v62
    v_mfma_f32_16x16x32_bf16 v[200:203], a[172:175], a[140:143], v[200:203]
    buffer_load_dwordx4 v39, s[8:11], s56 offen offset:3072  lds
    v_mfma_f32_16x16x32_bf16 v[204:207], a[172:175], a[156:159], v[204:207]
    s_add_u32 m0, s57, 81920
    ds_read_b128 a[216:219], v40 offset:16384
    v_perm_b32 v6, v72, v35, s36
    v_mfma_f32_16x16x32_bf16 v[204:207], a[168:171], a[152:155], v[204:207]
    ds_read_b32 a238, v63
    ds_read_b32 a239, v5
    v_mfma_f32_16x16x32_bf16 v[208:211], a[168:171], a[160:163], v[208:211]
    ds_read_b128 a[220:223], v41 offset:16384
    v_perm_b32 v7, v72, v35, s37
    v_mfma_f32_16x16x32_bf16 v[208:211], a[172:175], a[164:167], v[208:211]
    ds_read_b32 a224, v6
    v_perm_b32 v29, v72, v35, s38
    v_mfma_f32_16x16x32_bf16 v[212:215], a[172:175], a[92:95], v[212:215]
    ds_read_b128 a[240:243], v40 offset:18432
    v_perm_b32 v27, v72, v35, s39
    v_mfma_f32_16x16x32_bf16 v[212:215], a[168:171], a[88:91], v[212:215]
    ds_read_b32 a225, v7
    v_perm_b32 v31, v76, v35, s36
    v_mfma_f32_16x16x32_bf16 v[216:219], a[168:171], a[184:187], v[216:219]
    ds_read_b128 a[244:247], v41 offset:18432
    ds_read_b32 a226, v29
    v_mfma_f32_16x16x32_bf16 v[216:219], a[172:175], a[188:191], v[216:219]
    buffer_load_dwordx4 v36, s[8:11], s3 offen offset:0  lds
    v_mfma_f32_16x16x32_bf16 v[220:223], a[172:175], a[68:71], v[220:223]
    ds_read_b128 a[248:251], v40 offset:20480
    v_perm_b32 v46, v76, v35, s37
    v_mfma_f32_16x16x32_bf16 v[220:223], a[168:171], a[64:67], v[220:223]
    s_waitcnt lgkmcnt(9)
    ds_read_b32 a227, v27
    ds_read_b32 a228, v31
    v_mfma_f32_16x16x32_bf16 v[224:227], a[232:235], a[114:117], v[224:227]
    ds_read_b128 a[252:255], v41 offset:20480
    v_perm_b32 v57, v76, v35, s38
    v_mfma_f32_16x16x32_bf16 v[228:231], a[232:235], a[130:133], v[228:231]
    ds_read_b32 a229, v46
    v_perm_b32 v56, v76, v35, s39
    v_mfma_f32_16x16x32_bf16 v[232:235], a[232:235], a[138:141], v[232:235]
    ds_read_b128 a[36:39], v41 offset:22528
    v_perm_b32 v58, v73, v35, s36
    v_mfma_f32_16x16x32_bf16 v[236:239], a[232:235], a[154:157], v[236:239]
    ds_read_b128 a[32:35], v40 offset:22528
    ds_read_b32 a230, v57
    v_mfma_f32_16x16x32_bf16 v[240:243], a[232:235], a[162:165], v[240:243]
    buffer_load_dwordx4 v37, s[8:11], s3 offen offset:1024  lds
    v_mfma_f32_16x16x32_bf16 v[244:247], a[232:235], a[90:93], v[244:247]
    ds_read_b128 a[0:3], v40 offset:24576
    v_perm_b32 v60, v73, v35, s37
    v_mfma_f32_16x16x32_bf16 v[248:251], a[232:235], a[186:189], v[248:251]
    ds_read_b128 a[4:7], v41 offset:24576
    ds_read_b32 a231, v56
    v_mfma_f32_16x16x32_bf16 v[252:255], a[232:235], a[66:69], v[252:255]
    ds_read_b128 a[12:15], v41 offset:26624
    v_perm_b32 v59, v73, v35, s38
    v_mfma_f32_16x16x32_bf16 v[128:131], a[192:195], a[216:219], v[128:131]
    s_waitcnt lgkmcnt(9)
    ds_read_b128 a[8:11], v40 offset:26624
    ds_read_b32 a48, v58
    v_mfma_f32_16x16x32_bf16 v[128:131], a[196:199], a[220:223], v[128:131]
    ds_read_b128 a[16:19], v40 offset:28672
    v_perm_b32 v61, v73, v35, s39
    v_mfma_f32_16x16x32_bf16 v[132:135], a[196:199], a[244:247], v[132:135]
    s_add_u32 s56, s55, 1280
    ds_read_b32 a49, v60
    ds_read_b32 a50, v59
    v_mfma_f32_16x16x32_bf16 v[132:135], a[192:195], a[240:243], v[132:135]
    buffer_load_dwordx4 v38, s[8:11], s3 offen offset:2048  lds
    v_mfma_f32_16x16x32_bf16 v[136:139], a[192:195], a[248:251], v[136:139]
    s_waitcnt lgkmcnt(9)
    ds_read_b128 a[20:23], v41 offset:28672
    v_perm_b32 v62, v77, v35, s36
    v_mfma_f32_16x16x32_bf16 v[136:139], a[196:199], a[252:255], v[136:139]
    ds_read_b128 a[24:27], v40 offset:30720
    v_perm_b32 v63, v77, v35, s37
    v_mfma_f32_16x16x32_bf16 v[140:143], a[196:199], a[36:39], v[140:143]
    v_perm_b32 v5, v77, v35, s38
    v_perm_b32 v6, v77, v35, s39
    v_mfma_f32_16x16x32_bf16 v[140:143], a[192:195], a[32:35], v[140:143]
    s_waitcnt lgkmcnt(8)
    ds_read_b128 a[28:31], v41 offset:30720
    ds_read_b32 a51, v61
    v_mfma_f32_16x16x32_bf16 v[144:147], a[192:195], a[0:3], v[144:147]
    ds_read_b32 a52, v62
    v_perm_b32 v7, v74, v35, s36
    v_mfma_f32_16x16x32_bf16 v[144:147], a[196:199], a[4:7], v[144:147]
    s_waitcnt lgkmcnt(8)
    ds_read_b32 a53, v63
    v_perm_b32 v29, v74, v35, s37
    v_mfma_f32_16x16x32_bf16 v[148:151], a[196:199], a[12:15], v[148:151]
    s_waitcnt lgkmcnt(5)
    ds_read_b32 a54, v5
    ds_read_b32 a55, v6
    v_mfma_f32_16x16x32_bf16 v[148:151], a[192:195], a[8:11], v[148:151]
    buffer_load_dwordx4 v39, s[8:11], s3 offen offset:3072  lds
    v_mfma_f32_16x16x32_bf16 v[152:155], a[192:195], a[16:19], v[152:155]
    s_add_u32 m0, s57, 0
    v_perm_b32 v27, v74, v35, s38
    v_perm_b32 v31, v74, v35, s39
    v_mfma_f32_16x16x32_bf16 v[152:155], a[196:199], a[20:23], v[152:155]
    s_waitcnt lgkmcnt(5)
    ds_read_b32 a40, v7
    v_perm_b32 v46, v78, v35, s36
    v_mfma_f32_16x16x32_bf16 v[156:159], a[196:199], a[28:31], v[156:159]
    s_waitcnt vmcnt(12)
    ds_read_b32 a41, v29
    v_perm_b32 v57, v78, v35, s37
    v_mfma_f32_16x16x32_bf16 v[156:159], a[192:195], a[24:27], v[156:159]
    s_barrier
    v_mfma_f32_16x16x32_bf16 v[160:163], a[200:203], a[216:219], v[160:163]
    ds_read_b32 a42, v27
    v_perm_b32 v56, v78, v35, s38
    v_mfma_f32_16x16x32_bf16 v[160:163], a[204:207], a[220:223], v[160:163]
    ds_read_b32 a43, v31
    ds_read_b32 a44, v46
    v_mfma_f32_16x16x32_bf16 v[164:167], a[204:207], a[244:247], v[164:167]
    s_add_u32 s3, s69, 1280
    ds_read_b32 a45, v57
    ds_read_b32 a46, v56
    v_mfma_f32_16x16x32_bf16 v[164:167], a[200:203], a[240:243], v[164:167]
    buffer_load_dwordx4 v[104:107], v34, s[12:15], s43 offen sc1
    v_mfma_f32_16x16x32_bf16 v[168:171], a[200:203], a[248:251], v[168:171]
    ds_read_b128 a[56:59], v40 offset:32768
    v_perm_b32 v58, v78, v35, s39
    v_mfma_f32_16x16x32_bf16 v[168:171], a[204:207], a[252:255], v[168:171]
    s_waitcnt vmcnt(11)
    ds_read_b128 a[60:63], v41 offset:32768
    v_bitop3_b32 v60, v103, v83, s76 bitop3:0x7e
    v_mfma_f32_16x16x32_bf16 v[172:175], a[204:207], a[36:39], v[172:175]
    ds_read_b128 a[72:75], v40 offset:34816
    ds_read_b32 a47, v58
    v_mfma_f32_16x16x32_bf16 v[172:175], a[200:203], a[32:35], v[172:175]
    buffer_load_dwordx4 v[108:111], v44, s[12:15], s43 offen sc1
    v_mfma_f32_16x16x32_bf16 v[176:179], a[200:203], a[0:3], v[176:179]
    ds_read_b128 a[76:79], v41 offset:34816
    v_cmp_lt_u32 vcc, 0xffff, v60
    v_mfma_f32_16x16x32_bf16 v[176:179], a[204:207], a[4:7], v[176:179]
    v_perm_b32 v59, v75, v35, s36
    v_perm_b32 v61, v75, v35, s37
    v_mfma_f32_16x16x32_bf16 v[180:183], a[204:207], a[12:15], v[180:183]
    ds_read_b128 a[96:99], v40 offset:36864
    s_cbranch_vccnz L_slow3_1
L_back3_1:
    v_mfma_f32_16x16x32_bf16 v[180:183], a[200:203], a[8:11], v[180:183]
    buffer_load_dwordx4 v[112:115], v32, s[12:15], s44 offen sc1
    v_mfma_f32_16x16x32_bf16 v[184:187], a[200:203], a[16:19], v[184:187]
    v_perm_b32 v62, v79, v35, s36
    v_perm_b32 v63, v79, v35, s37
    v_mfma_f32_16x16x32_bf16 v[184:187], a[204:207], a[20:23], v[184:187]
    ds_read_b128 a[100:103], v41 offset:36864
    v_perm_b32 v5, v103, v35, s36
    v_mfma_f32_16x16x32_bf16 v[188:191], a[204:207], a[28:31], v[188:191]
    ds_read_b32 a120, v59
    ds_read_b32 a121, v61
    v_mfma_f32_16x16x32_bf16 v[188:191], a[200:203], a[24:27], v[188:191]
    buffer_load_dwordx4 v[116:119], v33, s[12:15], s44 offen sc1
    v_mfma_f32_16x16x32_bf16 v[192:195], a[208:211], a[216:219], v[192:195]
    ds_read_b128 a[80:83], v40 offset:38912
    v_perm_b32 v6, v103, v35, s37
    v_mfma_f32_16x16x32_bf16 v[192:195], a[212:215], a[220:223], v[192:195]
    v_perm_b32 v7, v83, v35, s36
    v_perm_b32 v29, v83, v35, s37
    v_mfma_f32_16x16x32_bf16 v[196:199], a[212:215], a[244:247], v[196:199]
    ds_read_b32 a122, v62
    v_perm_b32 v27, v100, v35, s36
    v_mfma_f32_16x16x32_bf16 v[196:199], a[208:211], a[240:243], v[196:199]
    ds_read_b128 a[84:87], v41 offset:38912
    ds_read_b32 a123, v63
    v_mfma_f32_16x16x32_bf16 v[200:203], a[208:211], a[248:251], v[200:203]
    ds_read_b32 a124, v5
    ds_read_b32 a125, v6
    v_mfma_f32_16x16x32_bf16 v[200:203], a[212:215], a[252:255], v[200:203]
    buffer_load_dwordx4 v36, s[8:11], s56 offen offset:0  lds
    v_mfma_f32_16x16x32_bf16 v[204:207], a[212:215], a[36:39], v[204:207]
    ds_read_b128 a[176:179], v40 offset:40960
    v_perm_b32 v31, v100, v35, s37
    v_mfma_f32_16x16x32_bf16 v[204:207], a[208:211], a[32:35], v[204:207]
    v_perm_b32 v46, v100, v35, s38
    v_perm_b32 v57, v100, v35, s39
    v_mfma_f32_16x16x32_bf16 v[208:211], a[208:211], a[0:3], v[208:211]
    ds_read_b32 a126, v7
    ds_read_b32 a127, v29
    v_mfma_f32_16x16x32_bf16 v[208:211], a[212:215], a[4:7], v[208:211]
    ds_read_b128 a[180:183], v41 offset:40960
    v_perm_b32 v56, v80, v35, s36
    v_mfma_f32_16x16x32_bf16 v[212:215], a[212:215], a[12:15], v[212:215]
    ds_read_b32 a104, v27
    v_perm_b32 v58, v80, v35, s37
    v_mfma_f32_16x16x32_bf16 v[212:215], a[208:211], a[8:11], v[212:215]
    v_perm_b32 v60, v80, v35, s38
    v_perm_b32 v59, v80, v35, s39
    v_mfma_f32_16x16x32_bf16 v[216:219], a[208:211], a[16:19], v[216:219]
    ds_read_b128 a[144:147], v40 offset:43008
    ds_read_b32 a105, v31
    v_mfma_f32_16x16x32_bf16 v[216:219], a[212:215], a[20:23], v[216:219]
    buffer_load_dwordx4 v37, s[8:11], s56 offen offset:1024  lds
    v_mfma_f32_16x16x32_bf16 v[220:223], a[212:215], a[28:31], v[220:223]
    s_waitcnt vmcnt(12)
    ds_read_b32 a106, v46
    v_bitop3_b32 v61, v87, v99, s76 bitop3:0x7e
    v_mfma_f32_16x16x32_bf16 v[220:223], a[208:211], a[24:27], v[220:223]
    ds_read_b128 a[148:151], v41 offset:43008
    v_cmp_lt_u32 vcc, 0xffff, v61
    v_mfma_f32_16x16x32_bf16 v[224:227], a[236:239], a[218:221], v[224:227]
    ds_read_b32 a107, v57
    v_perm_b32 v62, v101, v35, s36
    v_mfma_f32_16x16x32_bf16 v[228:231], a[236:239], a[242:245], v[228:231]
    v_perm_b32 v63, v101, v35, s37
    s_cbranch_vccnz L_slow4_0
L_back4_0:
    v_mfma_f32_16x16x32_bf16 v[232:235], a[236:239], a[250:253], v[232:235]
    ds_read_b128 a[168:171], v40 offset:45056
    ds_read_b32 a108, v56
    v_mfma_f32_16x16x32_bf16 v[236:239], a[236:239], a[34:37], v[236:239]
    ds_read_b32 a109, v58
    ds_read_b32 a110, v60
    v_mfma_f32_16x16x32_bf16 v[240:243], a[236:239], a[2:5], v[240:243]
    buffer_load_dwordx4 v38, s[8:11], s56 offen offset:2048  lds
L_pad2:
    s_cbranch_execz L_pad3
    v_mfma_f32_16x16x32_bf16 v[244:247], a[236:239], a[10:13], v[244:247]
    ds_read_b128 a[172:175], v41 offset:45056
    v_perm_b32 v5, v101, v35, s38
    v_mfma_f32_16x16x32_bf16 v[248:251], a[236:239], a[18:21], v[248:251]
    ds_read_b32 a111, v59
    v_perm_b32 v6, v101, v35, s39
    v_mfma_f32_16x16x32_bf16 v[252:255], a[236:239], a[26:29], v[252:255]
    s_waitcnt lgkmcnt(8)
    v_perm_b32 v7, v81, v35, s36
    v_perm_b32 v29, v81, v35, s37
    v_mfma_f32_16x16x32_bf16 v[128:131], a[224:227], a[56:59], v[128:131]
    ds_read_b128 a[112:115], v40 offset:47104
    ds_read_b32 a128, v62
    v_mfma_f32_16x16x32_bf16 v[128:131], a[228:231], a[60:63], v[128:131]
    ds_read_b32 a129, v63
    v_perm_b32 v27, v81, v35, s38
    v_mfma_f32_16x16x32_bf16 v[132:135], a[228:231], a[76:79], v[132:135]
    ds_read_b128 a[116:119], v41 offset:47104
    ds_read_b32 a130, v5
    v_mfma_f32_16x16x32_bf16 v[132:135], a[224:227], a[72:75], v[132:135]
    buffer_load_dwordx4 v39, s[8:11], s56 offen offset:3072  lds
    v_mfma_f32_16x16x32_bf16 v[136:139], a[224:227], a[96:99], v[136:139]
    s_add_u32 m0, s57, 16384
    v_perm_b32 v31, v81, v35, s39
    v_perm_b32 v46, v102, v35, s36
    v_mfma_f32_16x16x32_bf16 v[136:139], a[228:231], a[100:103], v[136:139]
    ds_read_b32 a131, v6
    v_perm_b32 v61, v102, v35, s37
    v_mfma_f32_16x16x32_bf16 v[140:143], a[228:231], a[84:87], v[140:143]
    ds_read_b32 a132, v7
    v_perm_b32 v57, v102, v35, s38
    v_mfma_f32_16x16x32_bf16 v[140:143], a[224:227], a[80:83], v[140:143]
    ds_read_b32 a133, v29
    v_perm_b32 v56, v102, v35, s39
    v_mfma_f32_16x16x32_bf16 v[144:147], a[224:227], a[176:179], v[144:147]
    s_waitcnt lgkmcnt(8)
    ds_read_b32 a134, v27
    ds_read_b32 a135, v31
    v_mfma_f32_16x16x32_bf16 v[144:147], a[228:231], a[180:183], v[144:147]
    buffer_load_dwordx4 v[120:123], v34, s[12:15], s44 offen sc1
    v_mfma_f32_16x16x32_bf16 v[148:151], a[228:231], a[148:151], v[148:151]
    v_perm_b32 v58, v82, v35, s36
    v_perm_b32 v60, v82, v35, s37
    v_mfma_f32_16x16x32_bf16 v[148:151], a[224:227], a[144:147], v[148:151]
    ds_read_b32 a136, v46
    v_perm_b32 v59, v82, v35, s38
    v_mfma_f32_16x16x32_bf16 v[152:155], a[224:227], a[168:171], v[152:155]
    s_waitcnt lgkmcnt(6)
    ds_read_b128 a[152:155], v40 offset:49152
    ds_read_b32 a137, v61
    v_mfma_f32_16x16x32_bf16 v[152:155], a[228:231], a[172:175], v[152:155]
    buffer_load_dwordx4 v[124:127], v44, s[12:15], s44 offen sc1
    v_mfma_f32_16x16x32_bf16 v[156:159], a[228:231], a[116:119], v[156:159]
    ds_read_b128 a[156:159], v41 offset:49152
    ds_read_b32 a138, v57
    v_mfma_f32_16x16x32_bf16 v[156:159], a[224:227], a[112:115], v[156:159]
    ds_read_b128 a[160:163], v40 offset:51200
    v_perm_b32 v62, v82, v35, s39
    v_mfma_f32_16x16x32_bf16 v[160:163], a[48:51], a[56:59], v[160:163]
    ds_read_b128 a[164:167], v41 offset:51200
    ds_read_b32 a139, v56
    v_mfma_f32_16x16x32_bf16 v[160:163], a[52:55], a[60:63], v[160:163]
    v_perm_b32 v63, v84, v35, s36
    v_perm_b32 v5, v84, v35, s37
    v_mfma_f32_16x16x32_bf16 v[164:167], a[52:55], a[76:79], v[164:167]
    ds_read_b128 a[88:91], v40 offset:53248
    ds_read_b32 a140, v58
    v_mfma_f32_16x16x32_bf16 v[164:167], a[48:51], a[72:75], v[164:167]
    ds_read_b32 a141, v60
    ds_read_b32 a142, v59
    v_mfma_f32_16x16x32_bf16 v[168:171], a[48:51], a[96:99], v[168:171]
    buffer_load_dwordx4 v36, s[8:11], s3 offen offset:0  lds
    v_mfma_f32_16x16x32_bf16 v[168:171], a[52:55], a[100:103], v[168:171]
    ds_read_b128 a[92:95], v41 offset:53248
    v_perm_b32 v6, v84, v35, s38
    v_mfma_f32_16x16x32_bf16 v[172:175], a[52:55], a[84:87], v[172:175]
    v_perm_b32 v7, v84, v35, s39
    v_perm_b32 v29, v96, v35, s36
    v_mfma_f32_16x16x32_bf16 v[172:175], a[48:51], a[80:83], v[172:175]
    ds_read_b32 a143, v62
    v_perm_b32 v27, v96, v35, s37
    v_mfma_f32_16x16x32_bf16 v[176:179], a[48:51], a[176:179], v[176:179]
    ds_read_b128 a[184:187], v40 offset:55296
    ds_read_b32 a64, v63
    v_mfma_f32_16x16x32_bf16 v[176:179], a[52:55], a[180:183], v[176:179]
    ds_read_b32 a65, v5
    v_perm_b32 v31, v96, v35, s38
    v_mfma_f32_16x16x32_bf16 v[180:183], a[52:55], a[148:151], v[180:183]
    v_perm_b32 v46, v96, v35, s39
    v_perm_b32 v61, v85, v35, s36
    v_mfma_f32_16x16x32_bf16 v[180:183], a[48:51], a[144:147], v[180:183]
    ds_read_b128 a[188:191], v41 offset:55296
    ds_read_b32 a66, v6
    v_mfma_f32_16x16x32_bf16 v[184:187], a[48:51], a[168:171], v[184:187]
    buffer_load_dwordx4 v37, s[8:11], s3 offen offset:1024  lds
    v_mfma_f32_16x16x32_bf16 v[184:187], a[52:55], a[172:175], v[184:187]
    ds_read_b32 a67, v7
    v_perm_b32 v57, v85, v35, s37
    v_mfma_f32_16x16x32_bf16 v[188:191], a[52:55], a[116:119], v[188:191]
    ds_read_b128 a[192:195], v40 offset:57344
    ds_read_b32 a68, v29
    v_mfma_f32_16x16x32_bf16 v[188:191], a[48:51], a[112:115], v[188:191]
    ds_read_b32 a69, v27
    v_perm_b32 v56, v85, v35, s38
    v_mfma_f32_16x16x32_bf16 v[192:195], a[40:43], a[56:59], v[192:195]
    ds_read_b32 a70, v31
    v_perm_b32 v58, v85, v35, s39
    v_mfma_f32_16x16x32_bf16 v[192:195], a[44:47], a[60:63], v[192:195]
    ds_read_b128 a[196:199], v41 offset:57344
    ds_read_b32 a71, v46
    v_mfma_f32_16x16x32_bf16 v[196:199], a[44:47], a[76:79], v[196:199]
    ds_read_b32 a200, v61
    ds_read_b32 a201, v57
    v_mfma_f32_16x16x32_bf16 v[196:199], a[40:43], a[72:75], v[196:199]
    buffer_load_dwordx4 v38, s[8:11], s3 offen offset:2048  lds
    v_mfma_f32_16x16x32_bf16 v[200:203], a[40:43], a[96:99], v[200:203]
    ds_read_b128 a[208:211], v40 offset:59392
    v_perm_b32 v60, v97, v35, s36
    v_mfma_f32_16x16x32_bf16 v[200:203], a[44:47], a[100:103], v[200:203]
    v_perm_b32 v59, v97, v35, s37
    v_perm_b32 v62, v97, v35, s38
    v_mfma_f32_16x16x32_bf16 v[204:207], a[44:47], a[84:87], v[204:207]
    ds_read_b32 a202, v56
    v_perm_b32 v63, v97, v35, s39
    v_mfma_f32_16x16x32_bf16 v[204:207], a[40:43], a[80:83], v[204:207]
    ds_read_b128 a[212:215], v41 offset:59392
    ds_read_b32 a203, v58
    v_mfma_f32_16x16x32_bf16 v[208:211], a[40:43], a[176:179], v[208:211]
    v_perm_b32 v5, v86, v35, s36
    v_perm_b32 v6, v86, v35, s37
    v_mfma_f32_16x16x32_bf16 v[208:211], a[44:47], a[180:183], v[208:211]
    ds_read_b32 a204, v60
    v_perm_b32 v7, v86, v35, s38
    v_mfma_f32_16x16x32_bf16 v[212:215], a[44:47], a[148:151], v[212:215]
    ds_read_b128 a[216:219], v40 offset:61440
    ds_read_b32 a205, v59
    v_mfma_f32_16x16x32_bf16 v[212:215], a[40:43], a[144:147], v[212:215]
    buffer_load_dwordx4 v39, s[8:11], s3 offen offset:3072  lds
    v_mfma_f32_16x16x32_bf16 v[216:219], a[40:43], a[168:171], v[216:219]
    s_waitcnt vmcnt(12)
    ds_read_b32 a206, v62
    v_bitop3_b32 v29, v107, v111, s76 bitop3:0x7e
    v_mfma_f32_16x16x32_bf16 v[216:219], a[44:47], a[172:175], v[216:219]
    ds_read_b128 a[220:223], v41 offset:61440
    v_cmp_lt_u32 vcc, 0xffff, v29
    v_mfma_f32_16x16x32_bf16 v[220:223], a[44:47], a[116:119], v[220:223]
    ds_read_b32 a207, v63
    v_perm_b32 v27, v86, v35, s39
    v_mfma_f32_16x16x32_bf16 v[220:223], a[40:43], a[112:115], v[220:223]
    v_perm_b32 v31, v98, v35, s36
    s_cbranch_vccnz L_slow4_1
L_back4_1:
    v_mfma_f32_16x16x32_bf16 v[224:227], a[120:123], a[58:61], v[224:227]
    s_waitcnt lgkmcnt(6)
    ds_read_b128 a[240:243], v40 offset:63488
    ds_read_b32 a248, v5
    v_mfma_f32_16x16x32_bf16 v[224:227], a[124:127], a[154:157], v[224:227]
    ds_read_b32 a249, v6
    v_perm_b32 v46, v98, v35, s37
    v_mfma_f32_16x16x32_bf16 v[228:231], a[124:127], a[162:165], v[228:231]
    ds_read_b128 a[244:247], v41 offset:63488
    ds_read_b32 a250, v7
    v_mfma_f32_16x16x32_bf16 v[228:231], a[120:123], a[74:77], v[228:231]
    ds_read_b32 a251, v27
    ds_read_b32 a252, v31
    v_mfma_f32_16x16x32_bf16 v[232:235], a[120:123], a[98:101], v[232:235]
    buffer_load_dwordx4 v[88:91], v32, s[12:15], s45 offen sc1
    v_mfma_f32_16x16x32_bf16 v[232:235], a[124:127], a[90:93], v[232:235]
    v_perm_b32 v61, v98, v35, s38
    v_perm_b32 v57, v98, v35, s39
    v_mfma_f32_16x16x32_bf16 v[236:239], a[124:127], a[186:189], v[236:239]
    v_perm_b32 v56, v87, v35, s36
    v_perm_b32 v58, v87, v35, s37
    v_mfma_f32_16x16x32_bf16 v[236:239], a[120:123], a[82:85], v[236:239]
    ds_read_b32 a253, v46
    ds_read_b32 a254, v61
    v_mfma_f32_16x16x32_bf16 v[240:243], a[120:123], a[178:181], v[240:243]
    buffer_load_dwordx4 v[92:95], v33, s[12:15], s45 offen sc1
    v_mfma_f32_16x16x32_bf16 v[240:243], a[124:127], a[194:197], v[240:243]
    v_perm_b32 v60, v99, v35, s36
    v_perm_b32 v59, v99, v35, s37
    v_mfma_f32_16x16x32_bf16 v[244:247], a[124:127], a[210:213], v[244:247]
    v_perm_b32 v62, v107, v35, s36
    v_perm_b32 v29, v107, v35, s37
    v_mfma_f32_16x16x32_bf16 v[244:247], a[120:123], a[146:149], v[244:247]
    s_waitcnt lgkmcnt(4)
    ds_read_b32 a255, v57
    ds_read_b32 a32, v56
    v_mfma_f32_16x16x32_bf16 v[248:251], a[120:123], a[170:173], v[248:251]
    buffer_load_dwordx4 v[48:51], v34, s[12:15], s45 offen sc1
    v_mfma_f32_16x16x32_bf16 v[248:251], a[124:127], a[218:221], v[248:251]
    s_barrier
    v_mfma_f32_16x16x32_bf16 v[252:255], a[124:127], a[242:245], v[252:255]
    s_add_u32 s56, s55, 1536
    ds_read_b32 a33, v58
    v_perm_b32 v63, v111, v35, s36
    v_mfma_f32_16x16x32_bf16 v[252:255], a[120:123], a[114:117], v[252:255]
    ds_read_b32 a34, v60
    ds_read_b32 a35, v59
    v_mfma_f32_16x16x32_bf16 v[128:131], a[104:107], a[152:155], v[128:131]
    buffer_load_dwordx4 v[52:55], v44, s[12:15], s45 offen sc1
    v_mfma_f32_16x16x32_bf16 v[128:131], a[108:111], a[156:159], v[128:131]
    s_add_u32 m0, s57, 32768
    v_perm_b32 v5, v111, v35, s37
    v_perm_b32 v6, v104, v35, s36
    v_mfma_f32_16x16x32_bf16 v[132:135], a[108:111], a[164:167], v[132:135]
    ds_read_b32 a36, v62
    ds_read_b32 a37, v29
    v_mfma_f32_16x16x32_bf16 v[132:135], a[104:107], a[160:163], v[132:135]
    v_perm_b32 v7, v104, v35, s37
    v_perm_b32 v27, v104, v35, s38
    v_mfma_f32_16x16x32_bf16 v[136:139], a[104:107], a[88:91], v[136:139]
    ds_read_b32 a38, v63
    ds_read_b32 a39, v5
    v_mfma_f32_16x16x32_bf16 v[136:139], a[108:111], a[92:95], v[136:139]
    buffer_load_dwordx4 v36, s[8:11], s56 offen offset:0  lds
    v_mfma_f32_16x16x32_bf16 v[140:143], a[108:111], a[188:191], v[140:143]
    v_perm_b32 v31, v104, v35, s39
    v_perm_b32 v46, v108, v35, s36
    v_mfma_f32_16x16x32_bf16 v[140:143], a[104:107], a[184:187], v[140:143]
    ds_read_b32 a0, v6
    v_perm_b32 v61, v108, v35, s37
    v_mfma_f32_16x16x32_bf16 v[144:147], a[104:107], a[192:195], v[144:147]
    s_waitcnt vmcnt(15)
    v_perm_b32 v56, v108, v35, s38
    v_bitop3_b32 v57, v115, v119, s76 bitop3:0x7e
    v_mfma_f32_16x16x32_bf16 v[144:147], a[108:111], a[196:199], v[144:147]
    ds_read_b32 a1, v7
    v_cmp_lt_u32 vcc, 0xffff, v57
    v_mfma_f32_16x16x32_bf16 v[148:151], a[108:111], a[212:215], v[148:151]
    ds_read_b32 a2, v27
    v_perm_b32 v58, v108, v35, s39
    v_mfma_f32_16x16x32_bf16 v[148:151], a[104:107], a[208:211], v[148:151]
    ds_read_b128 a[8:11], v42 offset:0
    s_cbranch_vccnz L_slow5_0
L_back5_0:
    v_mfma_f32_16x16x32_bf16 v[152:155], a[104:107], a[216:219], v[152:155]
    buffer_load_dwordx4 v37, s[8:11], s56 offen offset:1024  lds
    v_mfma_f32_16x16x32_bf16 v[152:155], a[108:111], a[220:223], v[152:155]
    ds_read_b128 a[12:15], v43 offset:0
    v_perm_b32 v60, v105, v35, s36
    v_mfma_f32_16x16x32_bf16 v[156:159], a[108:111], a[244:247], v[156:159]
    s_add_u32 s3, s69, 1536
    ds_read_b128 a[16:19], v42 offset:2048
    ds_read_b32 a3, v31
    v_mfma_f32_16x16x32_bf16 v[156:159], a[104:107], a[240:243], v[156:159]
    ds_read_b128 a[20:23], v43 offset:2048
    ds_read_b32 a4, v46
    v_mfma_f32_16x16x32_bf16 v[160:163], a[128:131], a[152:155], v[160:163]
    ds_read_b32 a5, v61
    v_perm_b32 v59, v105, v35, s37
    v_mfma_f32_16x16x32_bf16 v[160:163], a[132:135], a[156:159], v[160:163]
    ds_read_b32 a6, v56
    v_perm_b32 v62, v105, v35, s38
    v_mfma_f32_16x16x32_bf16 v[164:167], a[132:135], a[164:167], v[164:167]
    ds_read_b128 a[232:235], v42 offset:4096
    ds_read_b32 a7, v58
    v_mfma_f32_16x16x32_bf16 v[164:167], a[128:131], a[160:163], v[164:167]
    ds_read_b32 a24, v60
    ds_read_b32 a25, v59
    v_mfma_f32_16x16x32_bf16 v[168:171], a[128:131], a[88:91], v[168:171]
    buffer_load_dwordx4 v38, s[8:11], s56 offen offset:2048  lds
    v_mfma_f32_16x16x32_bf16 v[168:171], a[132:135], a[92:95], v[168:171]
    ds_read_b128 a[236:239], v43 offset:4096
    v_perm_b32 v29, v105, v35, s39
    v_mfma_f32_16x16x32_bf16 v[172:175], a[132:135], a[188:191], v[172:175]
    v_perm_b32 v63, v109, v35, s36
    v_perm_b32 v5, v109, v35, s37
    v_mfma_f32_16x16x32_bf16 v[172:175], a[128:131], a[184:187], v[172:175]
    v_perm_b32 v6, v109, v35, s38
    v_perm_b32 v7, v109, v35, s39
    v_mfma_f32_16x16x32_bf16 v[176:179], a[128:131], a[192:195], v[176:179]
    ds_read_b128 a[224:227], v42 offset:6144
    ds_read_b32 a26, v62
    v_mfma_f32_16x16x32_bf16 v[176:179], a[132:135], a[196:199], v[176:179]
    v_perm_b32 v57, v106, v35, s36
    v_perm_b32 v27, v106, v35, s37
    v_mfma_f32_16x16x32_bf16 v[180:183], a[132:135], a[212:215], v[180:183]
    ds_read_b32 a27, v29
    ds_read_b32 a28, v63
    v_mfma_f32_16x16x32_bf16 v[180:183], a[128:131], a[208:211], v[180:183]
    buffer_load_dwordx4 v39, s[8:11], s56 offen offset:3072  lds
    v_mfma_f32_16x16x32_bf16 v[184:187], a[128:131], a[216:219], v[184:187]
    s_add_u32 m0, s57, 49152
    ds_read_b128 a[228:231], v43 offset:6144
    v_perm_b32 v31, v106, v35, s38
    v_mfma_f32_16x16x32_bf16 v[184:187], a[132:135], a[220:223], v[184:187]
    s_add_u32 s56, s55, 1792
    ds_read_b32 a29, v5
    v_perm_b32 v46, v106, v35, s39
    v_mfma_f32_16x16x32_bf16 v[188:191], a[132:135], a[244:247], v[188:191]
    ds_read_b128 a[48:51], v42 offset:8192
    ds_read_b32 a30, v6
    v_mfma_f32_16x16x32_bf16 v[188:191], a[128:131], a[240:243], v[188:191]
    ds_read_b32 a31, v7
    v_perm_b32 v61, v110, v35, s36
    v_mfma_f32_16x16x32_bf16 v[192:195], a[136:139], a[152:155], v[192:195]
    ds_read_b32 a40, v57
    ds_read_b32 a41, v27
    v_mfma_f32_16x16x32_bf16 v[192:195], a[140:143], a[156:159], v[192:195]
    ds_read_b128 a[52:55], v43 offset:8192
    v_perm_b32 v56, v110, v35, s37
    v_mfma_f32_16x16x32_bf16 v[196:199], a[140:143], a[164:167], v[196:199]
    ds_read_b32 a42, v31
    ds_read_b32 a43, v46
    v_mfma_f32_16x16x32_bf16 v[196:199], a[136:139], a[160:163], v[196:199]
    buffer_load_dwordx4 v36, s[8:11], s3 offen offset:0  lds
    v_mfma_f32_16x16x32_bf16 v[200:203], a[136:139], a[88:91], v[200:203]
    ds_read_b128 a[56:59], v42 offset:10240
    v_perm_b32 v58, v110, v35, s38
    v_mfma_f32_16x16x32_bf16 v[200:203], a[140:143], a[92:95], v[200:203]
    v_perm_b32 v60, v110, v35, s39
    v_perm_b32 v59, v112, v35, s36
    v_mfma_f32_16x16x32_bf16 v[204:207], a[140:143], a[188:191], v[204:207]
    ds_read_b32 a44, v61
    v_perm_b32 v62, v112, v35, s37
    v_mfma_f32_16x16x32_bf16 v[204:207], a[136:139], a[184:187], v[204:207]
    ds_read_b128 a[60:63], v43 offset:10240
    ds_read_b32 a45, v56
    v_mfma_f32_16x16x32_bf16 v[208:211], a[136:139], a[192:195], v[208:211]
    v_perm_b32 v29, v112, v35, s38
    v_perm_b32 v63, v112, v35, s39
    v_mfma_f32_16x16x32_bf16 v[208:211], a[140:143], a[196:199], v[208:211]
    ds_read_b32 a46, v58
    ds_read_b32 a47, v60
    v_mfma_f32_16x16x32_bf16 v[212:215], a[140:143], a[212:215], v[212:215]
    buffer_load_dwordx4 v37, s[8:11], s3 offen offset:1024  lds
    v_mfma_f32_16x16x32_bf16 v[212:215], a[136:139], a[208:211], v[212:215]
    ds_read_b128 a[72:75], v42 offset:12288
    v_perm_b32 v5, v116, v35, s36
    v_mfma_f32_16x16x32_bf16 v[216:219], a[136:139], a[216:219], v[216:219]
    ds_read_b32 a96, v59
    v_perm_b32 v6, v116, v35, s37
    v_mfma_f32_16x16x32_bf16 v[216:219], a[140:143], a[220:223], v[216:219]
    ds_read_b128 a[76:79], v43 offset:12288
    ds_read_b32 a97, v62
    v_mfma_f32_16x16x32_bf16 v[220:223], a[140:143], a[244:247], v[220:223]
    ds_read_b32 a98, v29
    v_perm_b32 v7, v116, v35, s38
    v_mfma_f32_16x16x32_bf16 v[220:223], a[136:139], a[240:243], v[220:223]
    s_waitcnt lgkmcnt(9)
    ds_read_b32 a99, v63
    v_perm_b32 v57, v116, v35, s39
    v_mfma_f32_16x16x32_bf16 v[128:131], a[64:67], a[8:11], v[128:131]
    ds_read_b128 a[80:83], v42 offset:14336
    ds_read_b32 a100, v5
    v_mfma_f32_16x16x32_bf16 v[128:131], a[68:71], a[12:15], v[128:131]
    buffer_load_dwordx4 v38, s[8:11], s3 offen offset:2048  lds
    v_mfma_f32_16x16x32_bf16 v[132:135], a[68:71], a[20:23], v[132:135]
    ds_read_b128 a[84:87], v43 offset:14336
    v_perm_b32 v27, v113, v35, s36
    v_mfma_f32_16x16x32_bf16 v[132:135], a[64:67], a[16:19], v[132:135]
    ds_read_b32 a101, v6
    v_perm_b32 v31, v113, v35, s37
    v_mfma_f32_16x16x32_bf16 v[136:139], a[64:67], a[232:235], v[136:139]
    s_waitcnt vmcnt(15)
    v_perm_b32 v61, v113, v35, s38
    v_bitop3_b32 v46, v123, v127, s76 bitop3:0x7e
    v_mfma_f32_16x16x32_bf16 v[136:139], a[68:71], a[236:239], v[136:139]
    ds_read_b32 a102, v7
    v_cmp_lt_u32 vcc, 0xffff, v46
    v_mfma_f32_16x16x32_bf16 v[140:143], a[68:71], a[228:231], v[140:143]
    ds_read_b32 a103, v57
    v_perm_b32 v56, v113, v35, s39
    v_mfma_f32_16x16x32_bf16 v[140:143], a[64:67], a[224:227], v[140:143]
    v_perm_b32 v58, v117, v35, s36
    s_cbranch_vccnz L_slow5_1
L_back5_1:
    v_mfma_f32_16x16x32_bf16 v[144:147], a[64:67], a[48:51], v[144:147]
    s_waitcnt lgkmcnt(6)
    ds_read_b32 a176, v27
    ds_read_b32 a177, v31
    v_mfma_f32_16x16x32_bf16 v[144:147], a[68:71], a[52:55], v[144:147]
    buffer_load_dwordx4 v39, s[8:11], s3 offen offset:3072  lds
    v_mfma_f32_16x16x32_bf16 v[148:151], a[68:71], a[60:63], v[148:151]
    s_add_u32 m0, s57, 65536
    v_perm_b32 v60, v117, v35, s37
    v_perm_b32 v59, v117, v35, s38
    v_mfma_f32_16x16x32_bf16 v[148:151], a[64:67], a[56:59], v[148:151]
    s_add_u32 s3, s69, 1792
    ds_read_b32 a178, v61
    v_perm_b32 v62, v117, v35, s39
    v_mfma_f32_16x16x32_bf16 v[152:155], a[64:67], a[72:75], v[152:155]
    ds_read_b128 a[144:147], v42 offset:16384
    ds_read_b32 a179, v56
    v_mfma_f32_16x16x32_bf16 v[152:155], a[68:71], a[76:79], v[152:155]
    s_waitcnt lgkmcnt(7)
    ds_read_b128 a[148:151], v43 offset:16384
    v_perm_b32 v29, v114, v35, s36
    v_mfma_f32_16x16x32_bf16 v[156:159], a[68:71], a[84:87], v[156:159]
    ds_read_b128 a[168:171], v42 offset:18432
    ds_read_b32 a180, v58
    v_mfma_f32_16x16x32_bf16 v[156:159], a[64:67], a[80:83], v[156:159]
    ds_read_b128 a[172:175], v43 offset:18432
    v_perm_b32 v63, v114, v35, s37
    v_mfma_f32_16x16x32_bf16 v[160:163], a[200:203], a[8:11], v[160:163]
    ds_read_b32 a181, v60
    v_perm_b32 v5, v114, v35, s38
    v_mfma_f32_16x16x32_bf16 v[160:163], a[204:207], a[12:15], v[160:163]
    ds_read_b32 a182, v59
    ds_read_b32 a183, v62
    v_mfma_f32_16x16x32_bf16 v[164:167], a[204:207], a[20:23], v[164:167]
    ds_read_b128 a[120:123], v42 offset:20480
    v_perm_b32 v6, v114, v35, s39
    v_mfma_f32_16x16x32_bf16 v[164:167], a[200:203], a[16:19], v[164:167]
    ds_read_b32 a112, v29
    v_perm_b32 v7, v118, v35, s36
    v_mfma_f32_16x16x32_bf16 v[168:171], a[200:203], a[232:235], v[168:171]
    ds_read_b32 a113, v63
    v_perm_b32 v46, v118, v35, s37
    v_mfma_f32_16x16x32_bf16 v[168:171], a[204:207], a[236:239], v[168:171]
    ds_read_b128 a[124:127], v43 offset:20480
    ds_read_b32 a114, v5
    v_mfma_f32_16x16x32_bf16 v[172:175], a[204:207], a[228:231], v[172:175]
    buffer_load_dwordx4 v[64:67], v22, s[32:35], 0 offen
    v_mfma_f32_16x16x32_bf16 v[172:175], a[200:203], a[224:227], v[172:175]
    v_perm_b32 v57, v118, v35, s38
    v_perm_b32 v27, v118, v35, s39
    v_mfma_f32_16x16x32_bf16 v[176:179], a[200:203], a[48:51], v[176:179]
    ds_read_b128 a[104:107], v42 offset:22528
    ds_read_b32 a115, v6
    v_mfma_f32_16x16x32_bf16 v[176:179], a[204:207], a[52:55], v[176:179]
    ds_read_b32 a116, v7
    ds_read_b32 a117, v46
    v_mfma_f32_16x16x32_bf16 v[180:183], a[204:207], a[60:63], v[180:183]
    buffer_load_dwordx4 v[68:71], v32, s[12:15], s72 offen sc1
    v_mfma_f32_16x16x32_bf16 v[180:183], a[200:203], a[56:59], v[180:183]
    ds_read_b128 a[108:111], v43 offset:22528
    v_perm_b32 v31, v115, v35, s36
    v_mfma_f32_16x16x32_bf16 v[184:187], a[200:203], a[72:75], v[184:187]
    v_perm_b32 v61, v115, v35, s37
    v_perm_b32 v56, v119, v35, s36
    v_mfma_f32_16x16x32_bf16 v[184:187], a[204:207], a[76:79], v[184:187]
    ds_read_b32 a118, v57
    ds_read_b32 a119, v27
    v_mfma_f32_16x16x32_bf16 v[188:191], a[204:207], a[84:87], v[188:191]
    buffer_load_dwordx4 v[72:75], v33, s[12:15], s72 offen sc1
    v_mfma_f32_16x16x32_bf16 v[188:191], a[200:203], a[80:83], v[188:191]
    ds_read_b128 a[128:131], v42 offset:24576
    v_perm_b32 v58, v119, v35, s37
    v_mfma_f32_16x16x32_bf16 v[192:195], a[248:251], a[8:11], v[192:195]
    v_perm_b32 v60, v123, v35, s36
    v_perm_b32 v59, v123, v35, s37
    v_mfma_f32_16x16x32_bf16 v[192:195], a[252:255], a[12:15], v[192:195]
    ds_read_b128 a[132:135], v43 offset:24576
    ds_read_b32 a152, v31
    v_mfma_f32_16x16x32_bf16 v[196:199], a[252:255], a[20:23], v[196:199]
    buffer_load_dwordx4 v[76:79], v34, s[12:15], s72 offen sc1
    v_mfma_f32_16x16x32_bf16 v[196:199], a[248:251], a[16:19], v[196:199]
    ds_read_b32 a153, v61
    ds_read_b32 a154, v56
    v_mfma_f32_16x16x32_bf16 v[200:203], a[248:251], a[232:235], v[200:203]
    ds_read_b128 a[160:163], v42 offset:26624
    v_perm_b32 v62, v127, v35, s36
    v_mfma_f32_16x16x32_bf16 v[200:203], a[252:255], a[236:239], v[200:203]
    ds_read_b32 a155, v58
    ds_read_b32 a156, v60
    v_mfma_f32_16x16x32_bf16 v[204:207], a[252:255], a[228:231], v[204:207]
    buffer_load_dwordx4 v[100:103], v44, s[12:15], s72 offen sc1
    v_mfma_f32_16x16x32_bf16 v[204:207], a[248:251], a[224:227], v[204:207]
    ds_read_b128 a[164:167], v43 offset:26624
    v_perm_b32 v29, v127, v35, s37
    v_mfma_f32_16x16x32_bf16 v[208:211], a[248:251], a[48:51], v[208:211]
    ds_read_b32 a157, v59
    v_perm_b32 v63, v120, v35, s36
    v_mfma_f32_16x16x32_bf16 v[208:211], a[252:255], a[52:55], v[208:211]
    ds_read_b32 a158, v62
    ds_read_b32 a159, v29
    v_mfma_f32_16x16x32_bf16 v[212:215], a[252:255], a[60:63], v[212:215]
    buffer_load_dwordx2 v[80:81], v22, s[32:35], 0 offen offset:16
    v_mfma_f32_16x16x32_bf16 v[212:215], a[248:251], a[56:59], v[212:215]
    ds_read_b128 a[88:91], v42 offset:28672
    v_perm_b32 v5, v120, v35, s37
    v_mfma_f32_16x16x32_bf16 v[216:219], a[248:251], a[72:75], v[216:219]
    v_perm_b32 v6, v120, v35, s38
    v_perm_b32 v7, v120, v35, s39
    v_mfma_f32_16x16x32_bf16 v[216:219], a[252:255], a[76:79], v[216:219]
    ds_read_b128 a[92:95], v43 offset:28672
    ds_read_b32 a184, v63
    v_mfma_f32_16x16x32_bf16 v[220:223], a[252:255], a[84:87], v[220:223]
    buffer_load_dword v82, v23, s[32:35], 0 offen
    v_mfma_f32_16x16x32_bf16 v[220:223], a[248:251], a[80:83], v[220:223]
    v_perm_b32 v46, v124, v35, s36
    v_perm_b32 v57, v124, v35, s37
    v_mfma_f32_16x16x32_bf16 v[224:227], a[32:35], a[10:13], v[224:227]
    s_waitcnt lgkmcnt(6)
    ds_read_b128 a[192:195], v42 offset:30720
    v_perm_b32 v27, v124, v35, s38
    v_mfma_f32_16x16x32_bf16 v[224:227], a[36:39], a[146:149], v[224:227]
    s_waitcnt vmcnt(17)
    v_bitop3_b32 v31, v91, v95, s76 bitop3:0x7e
    v_perm_b32 v61, v124, v35, s39
    v_mfma_f32_16x16x32_bf16 v[228:231], a[36:39], a[170:173], v[228:231]
    ds_read_b128 a[196:199], v43 offset:30720
    v_cmp_lt_u32 vcc, 0xffff, v31
    v_mfma_f32_16x16x32_bf16 v[228:231], a[32:35], a[18:21], v[228:231]
    ds_read_b32 a185, v5
    v_perm_b32 v56, v121, v35, s36
    v_mfma_f32_16x16x32_bf16 v[232:235], a[32:35], a[234:237], v[232:235]
    ds_read_b32 a186, v6
    s_cbranch_vccnz L_slow6_0
L_back6_0:
    v_mfma_f32_16x16x32_bf16 v[232:235], a[36:39], a[122:125], v[232:235]
    ds_read_b32 a187, v7
    v_perm_b32 v58, v121, v35, s37
    v_mfma_f32_16x16x32_bf16 v[236:239], a[36:39], a[106:109], v[236:239]
    s_waitcnt vmcnt(15)
    v_perm_b32 v59, v121, v35, s38
    v_bitop3_b32 v60, v51, v55, s76 bitop3:0x7e
    v_mfma_f32_16x16x32_bf16 v[236:239], a[32:35], a[226:229], v[236:239]
    ds_read_b32 a188, v46
    v_cmp_lt_u32 vcc, 0xffff, v60
    v_mfma_f32_16x16x32_bf16 v[240:243], a[32:35], a[50:53], v[240:243]
    ds_read_b32 a189, v57
    ds_read_b32 a190, v27
    v_mfma_f32_16x16x32_bf16 v[240:243], a[36:39], a[130:133], v[240:243]
    v_perm_b32 v62, v121, v35, s39
    s_cbranch_vccnz L_slow6_1
L_back6_1:
    v_mfma_f32_16x16x32_bf16 v[244:247], a[36:39], a[162:165], v[244:247]
    ds_read_b32 a191, v61
    v_perm_b32 v29, v125, v35, s36
    v_mfma_f32_16x16x32_bf16 v[244:247], a[32:35], a[58:61], v[244:247]
    s_waitcnt lgkmcnt(7)
    ds_read_b32 a208, v56
    v_perm_b32 v63, v125, v35, s37
    v_mfma_f32_16x16x32_bf16 v[248:251], a[32:35], a[74:77], v[248:251]
    s_barrier
L_pad3:
    s_cbranch_execz L_pad4
    v_mfma_f32_16x16x32_bf16 v[248:251], a[36:39], a[90:93], v[248:251]
    buffer_load_dwordx4 v36, s[8:11], s56 offen offset:0  lds
    v_mfma_f32_16x16x32_bf16 v[252:255], a[36:39], a[194:197], v[252:255]
    ds_read_b32 a209, v58
    v_perm_b32 v31, v125, v35, s38
    v_mfma_f32_16x16x32_bf16 v[252:255], a[32:35], a[82:85], v[252:255]
    ds_read_b32 a210, v59
    v_perm_b32 v5, v125, v35, s39
    v_mfma_f32_16x16x32_bf16 v[128:131], a[0:3], a[144:147], v[128:131]
    ds_read_b32 a211, v62
    ds_read_b32 a212, v29
    v_mfma_f32_16x16x32_bf16 v[128:131], a[4:7], a[148:151], v[128:131]
    buffer_load_dwordx4 v37, s[8:11], s56 offen offset:1024  lds
    v_mfma_f32_16x16x32_bf16 v[132:135], a[4:7], a[172:175], v[132:135]
    v_perm_b32 v6, v122, v35, s36
    v_perm_b32 v7, v122, v35, s37
    v_mfma_f32_16x16x32_bf16 v[132:135], a[0:3], a[168:171], v[132:135]
    ds_read_b32 a213, v63
    v_perm_b32 v46, v122, v35, s38
    v_mfma_f32_16x16x32_bf16 v[136:139], a[0:3], a[120:123], v[136:139]
    ds_read_b32 a214, v31
    ds_read_b32 a215, v5
    v_mfma_f32_16x16x32_bf16 v[136:139], a[4:7], a[124:127], v[136:139]
    buffer_load_dwordx4 v38, s[8:11], s56 offen offset:2048  lds
    v_mfma_f32_16x16x32_bf16 v[140:143], a[4:7], a[108:111], v[140:143]
    v_perm_b32 v60, v122, v35, s39
    v_perm_b32 v57, v126, v35, s36
    v_mfma_f32_16x16x32_bf16 v[140:143], a[0:3], a[104:107], v[140:143]
    v_perm_b32 v27, v126, v35, s37
    v_perm_b32 v61, v126, v35, s38
    v_mfma_f32_16x16x32_bf16 v[144:147], a[0:3], a[128:131], v[144:147]
    ds_read_b32 a216, v6
    ds_read_b32 a217, v7
    v_mfma_f32_16x16x32_bf16 v[144:147], a[4:7], a[132:135], v[144:147]
    buffer_load_dwordx4 v39, s[8:11], s56 offen offset:3072  lds
    v_mfma_f32_16x16x32_bf16 v[148:151], a[4:7], a[164:167], v[148:151]
    s_add_u32 m0, s57, 81920
    ds_read_b32 a218, v46
    v_perm_b32 v56, v126, v35, s39
    v_mfma_f32_16x16x32_bf16 v[148:151], a[0:3], a[160:163], v[148:151]
    ds_read_b128 a[136:139], v40 offset:0
    v_perm_b32 v58, v91, v35, s36
    v_mfma_f32_16x16x32_bf16 v[152:155], a[0:3], a[88:91], v[152:155]
    ds_read_b128 a[140:143], v41 offset:0
    ds_read_b32 a219, v60
    v_mfma_f32_16x16x32_bf16 v[152:155], a[4:7], a[92:95], v[152:155]
    buffer_load_dwordx4 v36, s[8:11], s3 offen offset:0  lds
    v_mfma_f32_16x16x32_bf16 v[156:159], a[4:7], a[196:199], v[156:159]
    ds_read_b128 a[240:243], v40 offset:2048
    v_perm_b32 v59, v91, v35, s37
    v_mfma_f32_16x16x32_bf16 v[156:159], a[0:3], a[192:195], v[156:159]
    ds_read_b128 a[244:247], v41 offset:2048
    ds_read_b32 a220, v57
    v_mfma_f32_16x16x32_bf16 v[160:163], a[24:27], a[144:147], v[160:163]
    ds_read_b32 a221, v27
    ds_read_b32 a222, v61
    v_mfma_f32_16x16x32_bf16 v[160:163], a[28:31], a[148:151], v[160:163]
    buffer_load_dwordx4 v37, s[8:11], s3 offen offset:1024  lds
    v_mfma_f32_16x16x32_bf16 v[164:167], a[28:31], a[172:175], v[164:167]
    ds_read_b128 a[64:67], v40 offset:4096
    v_perm_b32 v62, v95, v35, s36
    v_mfma_f32_16x16x32_bf16 v[164:167], a[24:27], a[168:171], v[164:167]
    ds_read_b32 a223, v56
    v_perm_b32 v29, v95, v35, s37
    v_mfma_f32_16x16x32_bf16 v[168:171], a[24:27], a[120:123], v[168:171]
    ds_read_b32 a200, v58
    ds_read_b32 a201, v59
    v_mfma_f32_16x16x32_bf16 v[168:171], a[28:31], a[124:127], v[168:171]
    buffer_load_dwordx4 v38, s[8:11], s3 offen offset:2048  lds
    v_mfma_f32_16x16x32_bf16 v[172:175], a[28:31], a[108:111], v[172:175]
    ds_read_b128 a[68:71], v41 offset:4096
    v_perm_b32 v63, v51, v35, s36
    v_mfma_f32_16x16x32_bf16 v[172:175], a[24:27], a[104:107], v[172:175]
    v_perm_b32 v31, v51, v35, s37
    v_perm_b32 v5, v55, v35, s36
    v_mfma_f32_16x16x32_bf16 v[176:179], a[24:27], a[128:131], v[176:179]
    ds_read_b128 a[248:251], v40 offset:6144
    v_perm_b32 v6, v55, v35, s37
    v_mfma_f32_16x16x32_bf16 v[176:179], a[28:31], a[132:135], v[176:179]
    ds_read_b32 a202, v62
    ds_read_b32 a203, v29
    v_mfma_f32_16x16x32_bf16 v[180:183], a[28:31], a[164:167], v[180:183]
    buffer_load_dwordx4 v39, s[8:11], s3 offen offset:3072  lds
    v_mfma_f32_16x16x32_bf16 v[180:183], a[24:27], a[160:163], v[180:183]
    ds_read_b128 a[252:255], v41 offset:6144
    v_perm_b32 v7, v88, v35, s36
    v_mfma_f32_16x16x32_bf16 v[184:187], a[24:27], a[88:91], v[184:187]
    v_perm_b32 v46, v88, v35, s37
    v_perm_b32 v60, v88, v35, s38
    v_mfma_f32_16x16x32_bf16 v[184:187], a[28:31], a[92:95], v[184:187]
    ds_read_b32 a204, v63
    v_perm_b32 v57, v88, v35, s39
    v_mfma_f32_16x16x32_bf16 v[188:191], a[28:31], a[196:199], v[188:191]
    ds_read_b128 a[8:11], v40 offset:8192
    v_perm_b32 v27, v92, v35, s36
    v_mfma_f32_16x16x32_bf16 v[188:191], a[24:27], a[192:195], v[188:191]
    ds_read_b32 a205, v31
    ds_read_b32 a206, v5
    v_mfma_f32_16x16x32_bf16 v[192:195], a[40:43], a[144:147], v[192:195]
    ds_read_b32 a207, v6
    v_perm_b32 v61, v92, v35, s37
    v_mfma_f32_16x16x32_bf16 v[192:195], a[44:47], a[148:151], v[192:195]
    ds_read_b128 a[12:15], v41 offset:8192
    v_perm_b32 v56, v92, v35, s38
    v_mfma_f32_16x16x32_bf16 v[196:199], a[44:47], a[172:175], v[196:199]
    ds_read_b32 a16, v7
    v_perm_b32 v58, v92, v35, s39
    v_mfma_f32_16x16x32_bf16 v[196:199], a[40:43], a[168:171], v[196:199]
    ds_read_b32 a17, v46
    ds_read_b32 a18, v60
    v_mfma_f32_16x16x32_bf16 v[200:203], a[40:43], a[120:123], v[200:203]
    ds_read_b128 a[232:235], v40 offset:10240
    v_perm_b32 v59, v48, v35, s36
    v_mfma_f32_16x16x32_bf16 v[200:203], a[44:47], a[124:127], v[200:203]
    ds_read_b32 a19, v57
    ds_read_b32 a20, v27
    v_mfma_f32_16x16x32_bf16 v[204:207], a[44:47], a[108:111], v[204:207]
    v_perm_b32 v62, v48, v35, s37
    v_perm_b32 v29, v48, v35, s38
    v_mfma_f32_16x16x32_bf16 v[204:207], a[40:43], a[104:107], v[204:207]
    ds_read_b128 a[236:239], v41 offset:10240
    ds_read_b32 a21, v61
    v_mfma_f32_16x16x32_bf16 v[208:211], a[40:43], a[128:131], v[208:211]
    ds_read_b32 a22, v56
    v_perm_b32 v63, v48, v35, s39
    v_mfma_f32_16x16x32_bf16 v[208:211], a[44:47], a[132:135], v[208:211]
    ds_read_b32 a23, v58
    v_perm_b32 v31, v52, v35, s36
    v_mfma_f32_16x16x32_bf16 v[212:215], a[44:47], a[164:167], v[212:215]
    ds_read_b128 a[224:227], v40 offset:12288
    ds_read_b32 a48, v59
    v_mfma_f32_16x16x32_bf16 v[212:215], a[40:43], a[160:163], v[212:215]
    ds_read_b32 a49, v62
    v_perm_b32 v5, v52, v35, s37
    v_mfma_f32_16x16x32_bf16 v[216:219], a[40:43], a[88:91], v[216:219]
    ds_read_b32 a50, v29
    v_perm_b32 v6, v52, v35, s38
    v_mfma_f32_16x16x32_bf16 v[216:219], a[44:47], a[92:95], v[216:219]
    ds_read_b128 a[228:231], v41 offset:12288
    v_perm_b32 v7, v52, v35, s39
    v_mfma_f32_16x16x32_bf16 v[220:223], a[44:47], a[196:199], v[220:223]
    ds_read_b32 a51, v63
    ds_read_b32 a52, v31
    v_mfma_f32_16x16x32_bf16 v[220:223], a[40:43], a[192:195], v[220:223]
    s_waitcnt lgkmcnt(11)
    v_perm_b32 v46, v89, v35, s36
    v_perm_b32 v60, v89, v35, s37
    v_mfma_f32_16x16x32_bf16 v[128:131], a[96:99], a[136:139], v[128:131]
    ds_read_b32 a53, v5
    ds_read_b32 a54, v6
    v_mfma_f32_16x16x32_bf16 v[128:131], a[100:103], a[140:143], v[128:131]
    ds_read_b32 a55, v7
    v_perm_b32 v57, v89, v35, s38
    v_mfma_f32_16x16x32_bf16 v[132:135], a[100:103], a[244:247], v[132:135]
    ds_read_b32 a56, v46
    v_perm_b32 v27, v89, v35, s39
    v_mfma_f32_16x16x32_bf16 v[132:135], a[96:99], a[240:243], v[132:135]
    ds_read_b32 a57, v60
    v_perm_b32 v61, v93, v35, s36
    v_mfma_f32_16x16x32_bf16 v[136:139], a[96:99], a[64:67], v[136:139]
    ds_read_b32 a58, v57
    v_perm_b32 v56, v93, v35, s37
    v_mfma_f32_16x16x32_bf16 v[136:139], a[100:103], a[68:71], v[136:139]
    ds_read_b32 a59, v27
    v_perm_b32 v58, v93, v35, s38
    v_mfma_f32_16x16x32_bf16 v[140:143], a[100:103], a[252:255], v[140:143]
    ds_read_b128 a[72:75], v40 offset:16384
    v_perm_b32 v59, v93, v35, s39
    v_mfma_f32_16x16x32_bf16 v[140:143], a[96:99], a[248:251], v[140:143]
    ds_read_b32 a60, v61
    v_perm_b32 v62, v49, v35, s36
    v_mfma_f32_16x16x32_bf16 v[144:147], a[96:99], a[8:11], v[144:147]
    ds_read_b32 a61, v56
    v_perm_b32 v29, v49, v35, s37
    v_mfma_f32_16x16x32_bf16 v[144:147], a[100:103], a[12:15], v[144:147]
    s_waitcnt lgkmcnt(8)
    ds_read_b128 a[76:79], v41 offset:16384
    ds_read_b32 a62, v58
    v_mfma_f32_16x16x32_bf16 v[148:151], a[100:103], a[236:239], v[148:151]
    ds_read_b32 a63, v59
    v_perm_b32 v63, v49, v35, s38
    v_mfma_f32_16x16x32_bf16 v[148:151], a[96:99], a[232:235], v[148:151]
    ds_read_b32 a32, v62
    v_perm_b32 v31, v49, v35, s39
    v_mfma_f32_16x16x32_bf16 v[152:155], a[96:99], a[224:227], v[152:155]
    ds_read_b128 a[80:83], v40 offset:18432
    ds_read_b32 a33, v29
    v_mfma_f32_16x16x32_bf16 v[152:155], a[100:103], a[228:231], v[152:155]
    ds_read_b32 a34, v63
    v_perm_b32 v5, v53, v35, s36
    v_mfma_f32_16x16x32_bf16 v[160:163], a[176:179], a[136:139], v[160:163]
    ds_read_b32 a35, v31
    v_perm_b32 v6, v53, v35, s37
    v_mfma_f32_16x16x32_bf16 v[160:163], a[180:183], a[140:143], v[160:163]
    ds_read_b128 a[84:87], v41 offset:18432
    v_perm_b32 v7, v53, v35, s38
    v_mfma_f32_16x16x32_bf16 v[164:167], a[180:183], a[244:247], v[164:167]
    s_waitcnt vmcnt(12)
    ds_read_b32 a36, v5
    v_bitop3_b32 v46, v71, v75, s76 bitop3:0x7e
    v_mfma_f32_16x16x32_bf16 v[164:167], a[176:179], a[240:243], v[164:167]
    ds_read_b32 a37, v6
    v_cmp_lt_u32 vcc, 0xffff, v46
    v_mfma_f32_16x16x32_bf16 v[168:171], a[176:179], a[64:67], v[168:171]
    ds_read_b128 a[0:3], v40 offset:20480
    v_perm_b32 v60, v53, v35, s39
    v_mfma_f32_16x16x32_bf16 v[168:171], a[180:183], a[68:71], v[168:171]
    ds_read_b32 a38, v7
    s_cbranch_vccnz L_slow7_0
L_back7_0:
    v_mfma_f32_16x16x32_bf16 v[172:175], a[180:183], a[252:255], v[172:175]
    ds_read_b32 a39, v60
    v_perm_b32 v57, v90, v35, s36
    v_mfma_f32_16x16x32_bf16 v[172:175], a[176:179], a[248:251], v[172:175]
    ds_read_b128 a[4:7], v41 offset:20480
    v_perm_b32 v27, v90, v35, s37
    v_mfma_f32_16x16x32_bf16 v[176:179], a[176:179], a[8:11], v[176:179]
    ds_read_b32 a24, v57
    v_perm_b32 v61, v90, v35, s38
    v_mfma_f32_16x16x32_bf16 v[176:179], a[180:183], a[12:15], v[176:179]
    s_waitcnt vmcnt(10)
    ds_read_b32 a25, v27
    v_bitop3_b32 v56, v79, v103, s76 bitop3:0x7e
    v_mfma_f32_16x16x32_bf16 v[180:183], a[180:183], a[236:239], v[180:183]
    ds_read_b128 a[144:147], v40 offset:22528
    v_cmp_lt_u32 vcc, 0xffff, v56
    v_mfma_f32_16x16x32_bf16 v[180:183], a[176:179], a[232:235], v[180:183]
    ds_read_b32 a26, v61
    v_perm_b32 v58, v90, v35, s39
    v_mfma_f32_16x16x32_bf16 v[184:187], a[176:179], a[224:227], v[184:187]
    v_perm_b32 v59, v94, v35, s36
    s_cbranch_vccnz L_slow7_1
L_back7_1:
    v_mfma_f32_16x16x32_bf16 v[184:187], a[180:183], a[228:231], v[184:187]
    ds_read_b128 a[148:151], v41 offset:22528
    v_perm_b32 v62, v94, v35, s37
    v_mfma_f32_16x16x32_bf16 v[192:195], a[112:115], a[136:139], v[192:195]
    ds_read_b32 a27, v58
    v_perm_b32 v29, v94, v35, s38
    v_mfma_f32_16x16x32_bf16 v[192:195], a[116:119], a[140:143], v[192:195]
    ds_read_b32 a28, v59
    v_perm_b32 v63, v94, v35, s39
    v_mfma_f32_16x16x32_bf16 v[196:199], a[116:119], a[244:247], v[196:199]
    ds_read_b128 a[168:171], v40 offset:24576
    v_perm_b32 v31, v50, v35, s36
    v_mfma_f32_16x16x32_bf16 v[196:199], a[112:115], a[240:243], v[196:199]
    ds_read_b32 a29, v62
    v_perm_b32 v5, v50, v35, s37
    v_mfma_f32_16x16x32_bf16 v[200:203], a[112:115], a[64:67], v[200:203]
    ds_read_b32 a30, v29
    v_perm_b32 v6, v50, v35, s38
    v_mfma_f32_16x16x32_bf16 v[200:203], a[116:119], a[68:71], v[200:203]
    ds_read_b128 a[172:175], v41 offset:24576
    ds_read_b32 a31, v63
    v_mfma_f32_16x16x32_bf16 v[204:207], a[116:119], a[252:255], v[204:207]
    ds_read_b32 a120, v31
    v_perm_b32 v46, v50, v35, s39
    v_mfma_f32_16x16x32_bf16 v[204:207], a[112:115], a[248:251], v[204:207]
    ds_read_b32 a121, v5
    v_perm_b32 v7, v54, v35, s36
    v_mfma_f32_16x16x32_bf16 v[208:211], a[112:115], a[8:11], v[208:211]
    ds_read_b128 a[104:107], v40 offset:26624
    ds_read_b32 a122, v6
    v_mfma_f32_16x16x32_bf16 v[208:211], a[116:119], a[12:15], v[208:211]
    ds_read_b32 a123, v46
    v_perm_b32 v60, v54, v35, s37
    v_mfma_f32_16x16x32_bf16 v[212:215], a[116:119], a[236:239], v[212:215]
    ds_read_b32 a124, v7
    v_perm_b32 v57, v54, v35, s38
    v_mfma_f32_16x16x32_bf16 v[212:215], a[112:115], a[232:235], v[212:215]
    ds_read_b128 a[108:111], v41 offset:26624
    v_perm_b32 v27, v54, v35, s39
    v_mfma_f32_16x16x32_bf16 v[216:219], a[112:115], a[224:227], v[216:219]
    ds_read_b32 a125, v60
    v_perm_b32 v56, v71, v35, s36
    v_mfma_f32_16x16x32_bf16 v[216:219], a[116:119], a[228:231], v[216:219]
    ds_read_b32 a126, v57
    v_perm_b32 v61, v71, v35, s37
    v_mfma_f32_16x16x32_bf16 v[224:227], a[152:155], a[138:141], v[224:227]
    s_waitcnt lgkmcnt(9)
    ds_read_b128 a[128:131], v40 offset:28672
    v_perm_b32 v58, v75, v35, s36
    v_mfma_f32_16x16x32_bf16 v[224:227], a[156:159], a[74:77], v[224:227]
    ds_read_b128 a[132:135], v41 offset:28672
    ds_read_b32 a127, v27
    v_mfma_f32_16x16x32_bf16 v[228:231], a[156:159], a[82:85], v[228:231]
    ds_read_b32 a160, v56
    v_perm_b32 v59, v75, v35, s37
    v_mfma_f32_16x16x32_bf16 v[228:231], a[152:155], a[242:245], v[228:231]
    ds_read_b32 a161, v61
    v_perm_b32 v62, v79, v35, s36
    v_mfma_f32_16x16x32_bf16 v[232:235], a[152:155], a[66:69], v[232:235]
    ds_read_b32 a162, v58
    v_perm_b32 v29, v79, v35, s37
    v_mfma_f32_16x16x32_bf16 v[232:235], a[156:159], a[2:5], v[232:235]
    ds_read_b32 a163, v59
    v_perm_b32 v63, v103, v35, s36
    v_mfma_f32_16x16x32_bf16 v[236:239], a[156:159], a[146:149], v[236:239]
    ds_read_b32 a164, v62
    v_perm_b32 v31, v103, v35, s37
    v_mfma_f32_16x16x32_bf16 v[236:239], a[152:155], a[250:253], v[236:239]
    ds_read_b32 a165, v29
    v_perm_b32 v5, v68, v35, s36
    v_mfma_f32_16x16x32_bf16 v[240:243], a[152:155], a[10:13], v[240:243]
    ds_read_b32 a166, v63
    v_perm_b32 v6, v68, v35, s37
    v_mfma_f32_16x16x32_bf16 v[240:243], a[156:159], a[170:173], v[240:243]
    s_waitcnt lgkmcnt(9)
    ds_read_b32 a167, v31
    v_perm_b32 v46, v68, v35, s38
    v_mfma_f32_16x16x32_bf16 v[244:247], a[156:159], a[106:109], v[244:247]
    ds_read_b32 a88, v5
    v_perm_b32 v7, v68, v35, s39
    v_mfma_f32_16x16x32_bf16 v[244:247], a[152:155], a[234:237], v[244:247]
    ds_read_b32 a89, v6
    v_perm_b32 v60, v72, v35, s36
    v_mfma_f32_16x16x32_bf16 v[248:251], a[152:155], a[226:229], v[248:251]
    s_waitcnt lgkmcnt(8)
    ds_read_b32 a90, v46
    v_perm_b32 v57, v72, v35, s37
    v_mfma_f32_16x16x32_bf16 v[248:251], a[156:159], a[130:133], v[248:251]
    ds_read_b32 a91, v7
    v_perm_b32 v27, v72, v35, s38
    v_mfma_f32_16x16x32_bf16 v[128:131], a[184:187], a[72:75], v[128:131]
    ds_read_b32 a92, v60
    v_perm_b32 v56, v72, v35, s39
    v_mfma_f32_16x16x32_bf16 v[128:131], a[188:191], a[76:79], v[128:131]
    ds_read_b32 a93, v57
    v_perm_b32 v61, v76, v35, s36
    v_mfma_f32_16x16x32_bf16 v[132:135], a[188:191], a[84:87], v[132:135]
    ds_read_b32 a94, v27
    v_perm_b32 v58, v76, v35, s37
    v_mfma_f32_16x16x32_bf16 v[132:135], a[184:187], a[80:83], v[132:135]
    ds_read_b32 a95, v56
    v_perm_b32 v59, v76, v35, s38
    v_mfma_f32_16x16x32_bf16 v[136:139], a[184:187], a[0:3], v[136:139]
    ds_read_b32 a40, v61
    v_perm_b32 v62, v76, v35, s39
    v_mfma_f32_16x16x32_bf16 v[136:139], a[188:191], a[4:7], v[136:139]
    ds_read_b32 a41, v58
    v_perm_b32 v29, v100, v35, s36
    v_mfma_f32_16x16x32_bf16 v[140:143], a[188:191], a[148:151], v[140:143]
    ds_read_b32 a42, v59
    v_perm_b32 v63, v100, v35, s37
    v_mfma_f32_16x16x32_bf16 v[140:143], a[184:187], a[144:147], v[140:143]
    s_waitcnt vmcnt(0)
    ds_read_b32 a43, v62
    v_perm_b32 v31, v100, v35, s38
    v_mfma_f32_16x16x32_bf16 v[144:147], a[184:187], a[168:171], v[144:147]
    s_barrier
    v_mfma_f32_16x16x32_bf16 v[144:147], a[188:191], a[172:175], v[144:147]
    buffer_atomic_add v45, v1, s[24:27], s77 offen sc0 sc1
    v_mfma_f32_16x16x32_bf16 v[148:151], a[188:191], a[108:111], v[148:151]
    ds_read_b32 a44, v29
    ds_read_b32 a45, v63
    v_mfma_f32_16x16x32_bf16 v[148:151], a[184:187], a[104:107], v[148:151]
    ds_read_b32 a46, v31
    v_perm_b32 v5, v100, v35, s39
    v_mfma_f32_16x16x32_bf16 v[152:155], a[184:187], a[128:131], v[152:155]
    ds_read_b32 a47, v5
    v_perm_b32 v6, v69, v35, s36
    v_mfma_f32_16x16x32_bf16 v[152:155], a[188:191], a[132:135], v[152:155]
    ds_read_b128 a[192:195], v40 offset:32768
    v_perm_b32 v46, v69, v35, s37
    v_mfma_f32_16x16x32_bf16 v[160:163], a[208:211], a[72:75], v[160:163]
    ds_read_b32 a136, v6
    v_perm_b32 v7, v69, v35, s38
    v_mfma_f32_16x16x32_bf16 v[160:163], a[212:215], a[76:79], v[160:163]
    ds_read_b32 a137, v46
    v_perm_b32 v60, v69, v35, s39
    v_mfma_f32_16x16x32_bf16 v[164:167], a[212:215], a[84:87], v[164:167]
    ds_read_b128 a[196:199], v41 offset:32768
    v_perm_b32 v57, v73, v35, s36
    v_mfma_f32_16x16x32_bf16 v[164:167], a[208:211], a[80:83], v[164:167]
    ds_read_b32 a138, v7
    v_perm_b32 v27, v73, v35, s37
    v_mfma_f32_16x16x32_bf16 v[168:171], a[208:211], a[0:3], v[168:171]
    ds_read_b32 a139, v60
    v_perm_b32 v56, v73, v35, s38
    v_mfma_f32_16x16x32_bf16 v[168:171], a[212:215], a[4:7], v[168:171]
    ds_read_b32 a140, v57
    v_perm_b32 v61, v73, v35, s39
    v_mfma_f32_16x16x32_bf16 v[172:175], a[212:215], a[148:151], v[172:175]
    ds_read_b128 a[240:243], v40 offset:49152
    v_perm_b32 v58, v77, v35, s36
    v_mfma_f32_16x16x32_bf16 v[172:175], a[208:211], a[144:147], v[172:175]
    ds_read_b32 a141, v27
    v_perm_b32 v59, v77, v35, s37
    v_mfma_f32_16x16x32_bf16 v[176:179], a[208:211], a[168:171], v[176:179]
    s_mov_b32 m0, s60
    ds_read_b32 a142, v56
    v_perm_b32 v62, v77, v35, s38
    v_mfma_f32_16x16x32_bf16 v[176:179], a[212:215], a[172:175], v[176:179]
    ds_read_b128 a[244:247], v41 offset:49152
    ds_read_b32 a143, v61
    v_mfma_f32_16x16x32_bf16 v[180:183], a[212:215], a[108:111], v[180:183]
    ds_read_b32 a64, v58
    v_perm_b32 v29, v77, v35, s39
    v_mfma_f32_16x16x32_bf16 v[180:183], a[208:211], a[104:107], v[180:183]
    ds_read_b32 a65, v59
    v_perm_b32 v63, v101, v35, s36
    v_mfma_f32_16x16x32_bf16 v[184:187], a[208:211], a[128:131], v[184:187]
    ds_read_b32 a68, v63
    ds_read_b32 a66, v62
    v_mfma_f32_16x16x32_bf16 v[184:187], a[212:215], a[132:135], v[184:187]
    ds_read_b128 a[248:251], v42 offset:0
    v_perm_b32 v31, v101, v35, s37
    v_mfma_f32_16x16x32_bf16 v[192:195], a[216:219], a[72:75], v[192:195]
    ds_read_b32 a69, v31
    ds_read_b32 a67, v29
    v_mfma_f32_16x16x32_bf16 v[192:195], a[220:223], a[76:79], v[192:195]
    ds_read_b128 a[252:255], v43 offset:0
    v_perm_b32 v5, v101, v35, s38
    v_mfma_f32_16x16x32_bf16 v[196:199], a[220:223], a[84:87], v[196:199]
    ds_read_b32 a70, v5
    v_perm_b32 v6, v101, v35, s39
    v_mfma_f32_16x16x32_bf16 v[196:199], a[216:219], a[80:83], v[196:199]
    ds_read_b32 a71, v6
    v_perm_b32 v46, v70, v35, s36
    v_mfma_f32_16x16x32_bf16 v[200:203], a[216:219], a[0:3], v[200:203]
    ds_read_b32 a8, v46
    v_perm_b32 v7, v70, v35, s37
    v_mfma_f32_16x16x32_bf16 v[200:203], a[220:223], a[4:7], v[200:203]
    ds_read_b32 a9, v7
    v_perm_b32 v60, v70, v35, s38
    v_mfma_f32_16x16x32_bf16 v[204:207], a[220:223], a[148:151], v[204:207]
    ds_read_b128 a[232:235], v42 offset:16384
    v_perm_b32 v57, v70, v35, s39
    v_mfma_f32_16x16x32_bf16 v[204:207], a[216:219], a[144:147], v[204:207]
    ds_read_b32 a10, v60
    v_perm_b32 v27, v74, v35, s36
    v_mfma_f32_16x16x32_bf16 v[208:211], a[216:219], a[168:171], v[208:211]
    ds_read_b32 a12, v27
    v_perm_b32 v56, v74, v35, s37
    v_mfma_f32_16x16x32_bf16 v[208:211], a[220:223], a[172:175], v[208:211]
    ds_read_b128 a[236:239], v43 offset:16384
    v_perm_b32 v61, v74, v35, s38
    v_mfma_f32_16x16x32_bf16 v[212:215], a[220:223], a[108:111], v[212:215]
    ds_read_b32 a13, v56
    ds_read_b32 a11, v57
    v_mfma_f32_16x16x32_bf16 v[212:215], a[216:219], a[104:107], v[212:215]
    ds_read_b32 a14, v61
    v_perm_b32 v58, v74, v35, s39
    v_mfma_f32_16x16x32_bf16 v[216:219], a[216:219], a[128:131], v[216:219]
    ds_read_b32 a15, v58
    v_perm_b32 v59, v78, v35, s36
    v_mfma_f32_16x16x32_bf16 v[216:219], a[220:223], a[132:135], v[216:219]
    s_waitcnt lgkmcnt(9)
    ds_read_b128 a[224:227], v40 offset:34816
    v_perm_b32 v62, v78, v35, s37
    v_mfma_f32_16x16x32_bf16 v[224:227], a[200:203], a[194:197], v[224:227]
    s_mov_b32 s66, 0
    ds_read_b32 a72, v59
    v_lshlrev_b32 v84, 16, v82
    v_mfma_f32_16x16x32_bf16 v[224:227], a[204:207], a[242:245], v[224:227]
    s_mov_b32 s67, 14336
    ds_read_b32 a73, v62
    v_perm_b32 v63, v78, v35, s38
    v_mfma_f32_16x16x32_bf16 v[128:131], a[16:19], a[192:195], v[128:131]
    ds_read_b128 a[228:231], v41 offset:34816
    v_perm_b32 v29, v78, v35, s39
    v_mfma_f32_16x16x32_bf16 v[128:131], a[20:23], a[196:199], v[128:131]
    ds_read_b32 a74, v63
    v_and_b32 v85, 0xffff0000, v82
    v_mfma_f32_16x16x32_bf16 v[128:131], a[48:51], a[240:243], v[128:131]
    ds_read_b32 a75, v29
    v_perm_b32 v31, v102, v35, s36
    v_mfma_f32_16x16x32_bf16 v[128:131], a[52:55], a[244:247], v[128:131]
    ds_read_b128 a[80:83], v40 offset:51200
    v_perm_b32 v5, v102, v35, s37
    v_mfma_f32_16x16x32_bf16 v[160:163], a[56:59], a[192:195], v[160:163]
    ds_read_b32 a76, v31
    v_lshlrev_b32 v96, 16, v64
    v_mfma_f32_16x16x32_bf16 v[160:163], a[60:63], a[196:199], v[160:163]
    ds_read_b32 a77, v5
    v_perm_b32 v6, v102, v35, s38
    v_mfma_f32_16x16x32_bf16 v[160:163], a[32:35], a[240:243], v[160:163]
    ds_read_b128 a[84:87], v41 offset:51200
    v_and_b32 v97, 0xffff0000, v65
    v_mfma_f32_16x16x32_bf16 v[160:163], a[36:39], a[244:247], v[160:163]
    ds_read_b32 a78, v6
    v_perm_b32 v46, v102, v35, s39
    v_mfma_f32_16x16x32_bf16 v[192:195], a[24:27], a[192:195], v[192:195]
    ds_read_b128 a[0:3], v42 offset:2048
    v_lshlrev_b32 v98, 16, v67
    v_mfma_f32_16x16x32_bf16 v[192:195], a[28:31], a[196:199], v[192:195]
    ds_read_b32 a79, v46
    v_and_b32 v99, 0xffff0000, v80
    v_mfma_f32_16x16x32_bf16 v[192:195], a[120:123], a[240:243], v[192:195]
    ds_read_b128 a[4:7], v43 offset:2048
    v_and_b32 v104, 0xffff0000, v64
    v_mfma_f32_16x16x32_bf16 v[192:195], a[124:127], a[244:247], v[192:195]
    v_lshlrev_b32 v105, 16, v66
    v_and_b32 v106, 0xffff0000, v67
    v_mfma_f32_16x16x32_bf16 v[224:227], a[160:163], a[250:253], v[224:227]
    s_waitcnt lgkmcnt(7)
    v_lshlrev_b32 v107, 16, v81
    v_lshlrev_b32 v108, 16, v65
    v_mfma_f32_16x16x32_bf16 v[224:227], a[164:167], a[234:237], v[224:227]
    ds_read_b128 a[144:147], v42 offset:18432
    v_and_b32 v109, 0xffff0000, v66
    v_mfma_f32_16x16x32_bf16 v[128:131], a[88:91], a[248:251], v[128:131]
    v_lshlrev_b32 v110, 16, v80
    v_and_b32 v111, 0xffff0000, v81
    v_mfma_f32_16x16x32_bf16 v[128:131], a[92:95], a[252:255], v[128:131]
    v_mfma_f32_16x16x32_bf16 v[128:131], a[40:43], a[232:235], v[128:131]
    ds_read_b128 a[148:151], v43 offset:18432
    v_mfma_f32_16x16x32_bf16 v[128:131], a[44:47], a[236:239], v[128:131]
    ds_write_addtid_b32 v226 offset:28928
    ds_write_addtid_b32 v227 offset:29184
    v_mfma_f32_16x16x32_bf16 v[160:163], a[136:139], a[248:251], v[160:163]
    v_mfma_f32_16x16x32_bf16 v[160:163], a[140:143], a[252:255], v[160:163]
    v_mfma_f32_16x16x32_bf16 v[160:163], a[64:67], a[232:235], v[160:163]
    ds_read_b128 a[168:171], v40 offset:36864
    v_mfma_f32_16x16x32_bf16 v[160:163], a[68:71], a[236:239], v[160:163]
    s_nop 0
    v_mul_f32 v128, v128, v96
    v_mul_f32 v129, v129, v97
    v_mfma_f32_16x16x32_bf16 v[192:195], a[8:11], a[248:251], v[192:195]
    s_waitcnt lgkmcnt(1)
    s_barrier
    v_mfma_f32_16x16x32_bf16 v[192:195], a[12:15], a[252:255], v[192:195]
    ds_read2st64_b32 v[112:113], v30 offset0:113 offset1:114
    v_mul_f32 v130, v130, v98
L_pad4:
    s_cbranch_execz L_warmed
    v_mfma_f32_16x16x32_bf16 v[192:195], a[72:75], a[232:235], v[192:195]
    ds_read_b128 a[172:175], v41 offset:36864
    v_mul_f32 v131, v131, v99
    v_mfma_f32_16x16x32_bf16 v[192:195], a[76:79], a[236:239], v[192:195]
    v_mul_f32 v160, v160, v104
    v_cvt_pk_bf16_f32 v116, v128, v160
    v_mfma_f32_16x16x32_bf16 v[228:231], a[200:203], a[226:229], v[228:231]
    v_mul_f32 v161, v161, v105
    v_mul_f32 v162, v162, v106
    v_mfma_f32_16x16x32_bf16 v[228:231], a[204:207], a[82:85], v[228:231]
    ds_read_b128 a[104:107], v40 offset:53248
    v_cvt_pk_bf16_f32 v119, v130, v162
    v_mfma_f32_16x16x32_bf16 v[228:231], a[160:163], a[2:5], v[228:231]
    v_mul_f32 v163, v163, v107
    v_mfma_f32_16x16x32_bf16 v[228:231], a[164:167], a[146:149], v[228:231]
    v_mul_f32 v192, v192, v108
    v_mul_f32 v193, v193, v109
    v_mfma_f32_16x16x32_bf16 v[132:135], a[16:19], a[224:227], v[132:135]
    ds_read_b128 a[108:111], v41 offset:53248
    v_mul_f32 v194, v194, v110
    v_mfma_f32_16x16x32_bf16 v[132:135], a[20:23], a[228:231], v[132:135]
    v_mul_f32 v195, v195, v111
    v_cvt_pk_bf16_f32 v117, v192, v129
    v_mfma_f32_16x16x32_bf16 v[132:135], a[48:51], a[80:83], v[132:135]
    ds_write_b64 v26, v[116:117] offset:64512
    v_mfma_f32_16x16x32_bf16 v[132:135], a[52:55], a[84:87], v[132:135]
    ds_write_addtid_b32 v230 offset:30976
    v_cvt_pk_bf16_f32 v118, v161, v193
    v_mfma_f32_16x16x32_bf16 v[132:135], a[88:91], a[0:3], v[132:135]
    ds_write_b64 v26, v[118:119] offset:64520
    v_mfma_f32_16x16x32_bf16 v[132:135], a[92:95], a[4:7], v[132:135]
    ds_write_addtid_b32 v231 offset:31232
    v_cvt_pk_bf16_f32 v120, v194, v131
    v_mfma_f32_16x16x32_bf16 v[132:135], a[40:43], a[144:147], v[132:135]
    ds_read_b128 a[128:131], v42 offset:4096
    v_cvt_pk_bf16_f32 v121, v163, v195
    v_mfma_f32_16x16x32_bf16 v[132:135], a[44:47], a[148:151], v[132:135]
    ds_write_b64 v26, v[120:121] offset:64528
    v_mfma_f32_16x16x32_bf16 v[164:167], a[56:59], a[224:227], v[164:167]
    s_waitcnt lgkmcnt(7)
    v_add_f32 v224, v224, v112
    v_mul_f32 v224, v224, v84
    v_mfma_f32_16x16x32_bf16 v[164:167], a[60:63], a[228:231], v[164:167]
    v_add_f32 v225, v225, v113
    v_mul_f32 v225, v225, v85
    v_mfma_f32_16x16x32_bf16 v[164:167], a[32:35], a[80:83], v[164:167]
    ds_read_b128 a[132:135], v43 offset:4096
    v_cvt_pk_bf16_f32 v112, v224, v225
    v_mfma_f32_16x16x32_bf16 v[164:167], a[36:39], a[84:87], v[164:167]
    ds_write_b32 v28, v112 offset:64512
    v_mfma_f32_16x16x32_bf16 v[164:167], a[136:139], a[0:3], v[164:167]
    ds_read_b128 a[192:195], v42 offset:20480
    v_mul_f32 v132, v132, v96
    v_mfma_f32_16x16x32_bf16 v[164:167], a[140:143], a[4:7], v[164:167]
    v_mul_f32 v133, v133, v97
    v_mul_f32 v134, v134, v98
    v_mfma_f32_16x16x32_bf16 v[164:167], a[64:67], a[144:147], v[164:167]
    ds_read_b128 a[196:199], v43 offset:20480
    v_mul_f32 v135, v135, v99
    v_mfma_f32_16x16x32_bf16 v[164:167], a[68:71], a[148:151], v[164:167]
    v_mfma_f32_16x16x32_bf16 v[196:199], a[24:27], a[224:227], v[196:199]
    s_waitcnt lgkmcnt(2)
    s_barrier
    v_mfma_f32_16x16x32_bf16 v[196:199], a[28:31], a[228:231], v[196:199]
    ds_read_b128 v[124:127], v24 offset:64512
    ds_read2st64_b32 v[88:89], v30 offset0:121 offset1:122
    v_mfma_f32_16x16x32_bf16 v[196:199], a[120:123], a[80:83], v[196:199]
    ds_read_b128 v[92:95], v24 offset:65440
    v_mfma_f32_16x16x32_bf16 v[196:199], a[124:127], a[84:87], v[196:199]
    ds_read_b128 a[240:243], v40 offset:38912
    v_mul_f32 v164, v164, v104
    v_mfma_f32_16x16x32_bf16 v[196:199], a[8:11], a[0:3], v[196:199]
    v_cvt_pk_bf16_f32 v48, v132, v164
    v_mul_f32 v165, v165, v105
    v_mfma_f32_16x16x32_bf16 v[196:199], a[12:15], a[4:7], v[196:199]
    ds_read_b128 a[244:247], v41 offset:38912
    v_mul_f32 v166, v166, v106
    v_mfma_f32_16x16x32_bf16 v[196:199], a[72:75], a[144:147], v[196:199]
    v_cvt_pk_bf16_f32 v51, v134, v166
    v_mul_f32 v167, v167, v107
    v_mfma_f32_16x16x32_bf16 v[196:199], a[76:79], a[148:151], v[196:199]
    s_waitcnt lgkmcnt(3)
    v_mfma_f32_16x16x32_bf16 v[232:235], a[200:203], a[170:173], v[232:235]
    buffer_store_dwordx4 v[124:127], v25, s[16:19], s66 offen sc1
    v_mfma_f32_16x16x32_bf16 v[232:235], a[204:207], a[106:109], v[232:235]
    s_mov_b32 s66, 114688
    v_add_f32 v228, v228, v88
    v_mul_f32 v228, v228, v84
    v_mfma_f32_16x16x32_bf16 v[232:235], a[160:163], a[130:133], v[232:235]
    v_add_f32 v229, v229, v89
    v_mul_f32 v229, v229, v85
    v_mfma_f32_16x16x32_bf16 v[232:235], a[164:167], a[194:197], v[232:235]
    s_waitcnt lgkmcnt(2)
    ds_read_b128 a[248:251], v40 offset:55296
    v_mfma_f32_16x16x32_bf16 v[136:139], a[16:19], a[168:171], v[136:139]
    buffer_store_dwordx4 v[92:95], v25, s[16:19], s67 offen sc1
    v_mfma_f32_16x16x32_bf16 v[136:139], a[20:23], a[172:175], v[136:139]
    s_mov_b32 s67, 129024
    ds_read_b128 a[252:255], v41 offset:55296
    v_cvt_pk_bf16_f32 v88, v228, v229
    v_mfma_f32_16x16x32_bf16 v[136:139], a[48:51], a[104:107], v[136:139]
    ds_write_b32 v28, v88 offset:0
    v_mfma_f32_16x16x32_bf16 v[136:139], a[52:55], a[108:111], v[136:139]
    ds_write_addtid_b32 v234 offset:33024
    v_mul_f32 v196, v196, v108
    v_mfma_f32_16x16x32_bf16 v[136:139], a[88:91], a[128:131], v[136:139]
    ds_write_addtid_b32 v235 offset:33280
    v_mul_f32 v197, v197, v109
    v_mfma_f32_16x16x32_bf16 v[136:139], a[92:95], a[132:135], v[136:139]
    v_mul_f32 v198, v198, v110
    v_mul_f32 v199, v199, v111
    v_mfma_f32_16x16x32_bf16 v[136:139], a[40:43], a[192:195], v[136:139]
    ds_read_b128 a[232:235], v42 offset:6144
    v_cvt_pk_bf16_f32 v49, v196, v133
    v_mfma_f32_16x16x32_bf16 v[136:139], a[44:47], a[196:199], v[136:139]
    ds_write_b64 v26, v[48:49] offset:0
    v_mfma_f32_16x16x32_bf16 v[168:171], a[56:59], a[168:171], v[168:171]
    v_cvt_pk_bf16_f32 v50, v165, v197
    v_cvt_pk_bf16_f32 v52, v198, v135
    v_mfma_f32_16x16x32_bf16 v[168:171], a[60:63], a[172:175], v[168:171]
    ds_write_b64 v26, v[50:51] offset:8
    v_mfma_f32_16x16x32_bf16 v[168:171], a[32:35], a[104:107], v[168:171]
    ds_read_b128 a[236:239], v43 offset:6144
    v_cvt_pk_bf16_f32 v53, v167, v199
    v_mfma_f32_16x16x32_bf16 v[168:171], a[36:39], a[108:111], v[168:171]
    ds_write_b64 v26, v[52:53] offset:16
    v_mfma_f32_16x16x32_bf16 v[168:171], a[136:139], a[128:131], v[168:171]
    ds_read_b128 a[224:227], v42 offset:22528
    v_mul_f32 v136, v136, v96
    v_mfma_f32_16x16x32_bf16 v[168:171], a[140:143], a[132:135], v[168:171]
    v_mul_f32 v137, v137, v97
    v_mul_f32 v138, v138, v98
    v_mfma_f32_16x16x32_bf16 v[168:171], a[64:67], a[192:195], v[168:171]
    ds_read_b128 a[228:231], v43 offset:22528
    v_mul_f32 v139, v139, v99
    v_mfma_f32_16x16x32_bf16 v[168:171], a[68:71], a[196:199], v[168:171]
    v_mfma_f32_16x16x32_bf16 v[200:203], a[24:27], a[168:171], v[200:203]
    s_waitcnt lgkmcnt(2)
    s_barrier
    v_mfma_f32_16x16x32_bf16 v[200:203], a[28:31], a[172:175], v[200:203]
    ds_read_b128 v[68:71], v24 offset:0
    ds_read2st64_b32 v[72:73], v30 offset0:129 offset1:130
    v_mfma_f32_16x16x32_bf16 v[200:203], a[120:123], a[104:107], v[200:203]
    ds_read_b128 v[76:79], v24 offset:928
    v_mfma_f32_16x16x32_bf16 v[200:203], a[124:127], a[108:111], v[200:203]
    ds_read_b128 a[80:83], v40 offset:40960
    v_mul_f32 v168, v168, v104
    v_mfma_f32_16x16x32_bf16 v[200:203], a[8:11], a[128:131], v[200:203]
    v_cvt_pk_bf16_f32 v100, v136, v168
    v_mul_f32 v169, v169, v105
    v_mfma_f32_16x16x32_bf16 v[200:203], a[12:15], a[132:135], v[200:203]
    ds_read_b128 a[84:87], v41 offset:40960
    v_mul_f32 v170, v170, v106
    v_mfma_f32_16x16x32_bf16 v[200:203], a[72:75], a[192:195], v[200:203]
    v_cvt_pk_bf16_f32 v103, v138, v170
    v_mul_f32 v171, v171, v107
    v_mfma_f32_16x16x32_bf16 v[200:203], a[76:79], a[196:199], v[200:203]
    s_waitcnt lgkmcnt(3)
    v_mfma_f32_16x16x32_bf16 v[236:239], a[200:203], a[242:245], v[236:239]
    buffer_store_dwordx4 v[68:71], v25, s[16:19], s66 offen sc1
    v_mfma_f32_16x16x32_bf16 v[236:239], a[204:207], a[250:253], v[236:239]
    s_mov_b32 s66, 229376
    v_add_f32 v232, v232, v72
    v_mul_f32 v232, v232, v84
    v_mfma_f32_16x16x32_bf16 v[236:239], a[160:163], a[234:237], v[236:239]
    v_add_f32 v233, v233, v73
    v_mul_f32 v233, v233, v85
    v_mfma_f32_16x16x32_bf16 v[236:239], a[164:167], a[226:229], v[236:239]
    s_waitcnt lgkmcnt(2)
    ds_read_b128 a[0:3], v40 offset:57344
    v_mfma_f32_16x16x32_bf16 v[140:143], a[16:19], a[240:243], v[140:143]
    buffer_store_dwordx4 v[76:79], v25, s[16:19], s67 offen sc1
    v_mfma_f32_16x16x32_bf16 v[140:143], a[20:23], a[244:247], v[140:143]
    s_mov_b32 s67, 243712
    ds_read_b128 a[4:7], v41 offset:57344
    v_cvt_pk_bf16_f32 v72, v232, v233
    v_mfma_f32_16x16x32_bf16 v[140:143], a[48:51], a[248:251], v[140:143]
    ds_write_b32 v28, v72 offset:7424
    v_mfma_f32_16x16x32_bf16 v[140:143], a[52:55], a[252:255], v[140:143]
    ds_write_addtid_b32 v238 offset:0
    v_mul_f32 v200, v200, v108
    v_mfma_f32_16x16x32_bf16 v[140:143], a[88:91], a[232:235], v[140:143]
    ds_write_addtid_b32 v239 offset:256
    v_mul_f32 v201, v201, v109
    v_mfma_f32_16x16x32_bf16 v[140:143], a[92:95], a[236:239], v[140:143]
    v_mul_f32 v202, v202, v110
    v_mul_f32 v203, v203, v111
    v_mfma_f32_16x16x32_bf16 v[140:143], a[40:43], a[224:227], v[140:143]
    ds_read_b128 a[144:147], v42 offset:8192
    v_cvt_pk_bf16_f32 v101, v200, v137
    v_mfma_f32_16x16x32_bf16 v[140:143], a[44:47], a[228:231], v[140:143]
    ds_write_b64 v26, v[100:101] offset:7424
    v_mfma_f32_16x16x32_bf16 v[172:175], a[56:59], a[240:243], v[172:175]
    v_cvt_pk_bf16_f32 v102, v169, v201
    v_cvt_pk_bf16_f32 v64, v202, v139
    v_mfma_f32_16x16x32_bf16 v[172:175], a[60:63], a[244:247], v[172:175]
    ds_write_b64 v26, v[102:103] offset:7432
    v_mfma_f32_16x16x32_bf16 v[172:175], a[32:35], a[248:251], v[172:175]
    ds_read_b128 a[148:151], v43 offset:8192
    v_cvt_pk_bf16_f32 v65, v171, v203
    v_mfma_f32_16x16x32_bf16 v[172:175], a[36:39], a[252:255], v[172:175]
    ds_write_b64 v26, v[64:65] offset:7440
    v_mfma_f32_16x16x32_bf16 v[172:175], a[136:139], a[232:235], v[172:175]
    ds_read_b128 a[168:171], v42 offset:24576
    v_mul_f32 v140, v140, v96
    v_mfma_f32_16x16x32_bf16 v[172:175], a[140:143], a[236:239], v[172:175]
    v_mul_f32 v141, v141, v97
    v_mul_f32 v142, v142, v98
    v_mfma_f32_16x16x32_bf16 v[172:175], a[64:67], a[224:227], v[172:175]
    ds_read_b128 a[172:175], v43 offset:24576
    v_mul_f32 v143, v143, v99
    v_mfma_f32_16x16x32_bf16 v[172:175], a[68:71], a[228:231], v[172:175]
    v_mfma_f32_16x16x32_bf16 v[204:207], a[24:27], a[240:243], v[204:207]
    s_waitcnt lgkmcnt(2)
    s_barrier
    v_mfma_f32_16x16x32_bf16 v[204:207], a[28:31], a[244:247], v[204:207]
    ds_read_b128 v[80:83], v24 offset:7424
    ds_read2st64_b32 v[116:117], v30 offset0:0 offset1:1
    v_mfma_f32_16x16x32_bf16 v[204:207], a[120:123], a[248:251], v[204:207]
    ds_read_b128 v[120:123], v24 offset:8352
    v_mfma_f32_16x16x32_bf16 v[204:207], a[124:127], a[252:255], v[204:207]
    ds_read_b128 a[104:107], v40 offset:43008
    v_mul_f32 v172, v172, v104
    v_mfma_f32_16x16x32_bf16 v[204:207], a[8:11], a[232:235], v[204:207]
    v_cvt_pk_bf16_f32 v112, v140, v172
    v_mul_f32 v173, v173, v105
    v_mfma_f32_16x16x32_bf16 v[204:207], a[12:15], a[236:239], v[204:207]
    ds_read_b128 a[108:111], v41 offset:43008
    v_mul_f32 v174, v174, v106
    v_mfma_f32_16x16x32_bf16 v[204:207], a[72:75], a[224:227], v[204:207]
    v_cvt_pk_bf16_f32 v115, v142, v174
    v_mul_f32 v175, v175, v107
    v_mfma_f32_16x16x32_bf16 v[204:207], a[76:79], a[228:231], v[204:207]
    s_waitcnt lgkmcnt(3)
    v_mfma_f32_16x16x32_bf16 v[240:243], a[200:203], a[82:85], v[240:243]
    buffer_store_dwordx4 v[80:83], v25, s[16:19], s66 offen sc1
    v_mfma_f32_16x16x32_bf16 v[240:243], a[204:207], a[2:5], v[240:243]
    s_mov_b32 s66, 344064
    v_add_f32 v236, v236, v116
    v_mul_f32 v236, v236, v84
    v_mfma_f32_16x16x32_bf16 v[240:243], a[160:163], a[146:149], v[240:243]
    v_add_f32 v237, v237, v117
    v_mul_f32 v237, v237, v85
    v_mfma_f32_16x16x32_bf16 v[240:243], a[164:167], a[170:173], v[240:243]
    s_waitcnt lgkmcnt(2)
    ds_read_b128 a[128:131], v40 offset:59392
    v_mfma_f32_16x16x32_bf16 v[144:147], a[16:19], a[80:83], v[144:147]
    buffer_store_dwordx4 v[120:123], v25, s[16:19], s67 offen sc1
    v_mfma_f32_16x16x32_bf16 v[144:147], a[20:23], a[84:87], v[144:147]
    s_mov_b32 s67, 358400
    ds_read_b128 a[132:135], v41 offset:59392
    v_cvt_pk_bf16_f32 v116, v236, v237
    v_mfma_f32_16x16x32_bf16 v[144:147], a[48:51], a[0:3], v[144:147]
    ds_write_b32 v28, v116 offset:14848
    v_mfma_f32_16x16x32_bf16 v[144:147], a[52:55], a[4:7], v[144:147]
    ds_write_addtid_b32 v242 offset:2048
    v_mul_f32 v204, v204, v108
    v_mfma_f32_16x16x32_bf16 v[144:147], a[88:91], a[144:147], v[144:147]
    ds_write_addtid_b32 v243 offset:2304
    v_mul_f32 v205, v205, v109
    v_mfma_f32_16x16x32_bf16 v[144:147], a[92:95], a[148:151], v[144:147]
    v_mul_f32 v206, v206, v110
    v_mul_f32 v207, v207, v111
    v_mfma_f32_16x16x32_bf16 v[144:147], a[40:43], a[168:171], v[144:147]
    ds_read_b128 a[192:195], v42 offset:10240
    v_cvt_pk_bf16_f32 v113, v204, v141
    v_mfma_f32_16x16x32_bf16 v[144:147], a[44:47], a[172:175], v[144:147]
    ds_write_b64 v26, v[112:113] offset:14848
    v_mfma_f32_16x16x32_bf16 v[176:179], a[56:59], a[80:83], v[176:179]
    v_cvt_pk_bf16_f32 v114, v173, v205
    v_cvt_pk_bf16_f32 v124, v206, v143
    v_mfma_f32_16x16x32_bf16 v[176:179], a[60:63], a[84:87], v[176:179]
    ds_write_b64 v26, v[114:115] offset:14856
    v_mfma_f32_16x16x32_bf16 v[176:179], a[32:35], a[0:3], v[176:179]
    ds_read_b128 a[196:199], v43 offset:10240
    v_cvt_pk_bf16_f32 v125, v175, v207
    v_mfma_f32_16x16x32_bf16 v[176:179], a[36:39], a[4:7], v[176:179]
    ds_write_b64 v26, v[124:125] offset:14864
    v_mfma_f32_16x16x32_bf16 v[176:179], a[136:139], a[144:147], v[176:179]
    ds_read_b128 a[240:243], v42 offset:26624
    v_mul_f32 v144, v144, v96
    v_mfma_f32_16x16x32_bf16 v[176:179], a[140:143], a[148:151], v[176:179]
    v_mul_f32 v145, v145, v97
    v_mul_f32 v146, v146, v98
    v_mfma_f32_16x16x32_bf16 v[176:179], a[64:67], a[168:171], v[176:179]
    ds_read_b128 a[244:247], v43 offset:26624
    v_mul_f32 v147, v147, v99
    v_mfma_f32_16x16x32_bf16 v[176:179], a[68:71], a[172:175], v[176:179]
    s_waitcnt vmcnt(6)
    v_bitop3_b32 v45, v45, 15, v0 bitop3:0xbe
    v_lshlrev_b32 v45, 22, v45
    v_mfma_f32_16x16x32_bf16 v[208:211], a[24:27], a[80:83], v[208:211]
    s_waitcnt lgkmcnt(2)
    s_barrier
    v_mfma_f32_16x16x32_bf16 v[208:211], a[28:31], a[84:87], v[208:211]
    buffer_store_dword v47, v45, s[12:15], s78 offen sc1
    v_mfma_f32_16x16x32_bf16 v[208:211], a[120:123], a[0:3], v[208:211]
    ds_read_b128 v[92:95], v24 offset:14848
    ds_read2st64_b32 v[88:89], v30 offset0:8 offset1:9
    v_mfma_f32_16x16x32_bf16 v[208:211], a[124:127], a[4:7], v[208:211]
    ds_read_b128 v[48:51], v24 offset:15776
    v_mul_f32 v176, v176, v104
    v_mfma_f32_16x16x32_bf16 v[208:211], a[8:11], a[144:147], v[208:211]
    ds_read_b128 a[248:251], v40 offset:45056
    v_cvt_pk_bf16_f32 v52, v144, v176
    v_mfma_f32_16x16x32_bf16 v[208:211], a[12:15], a[148:151], v[208:211]
    ds_read_b128 a[252:255], v41 offset:45056
    v_mul_f32 v177, v177, v105
    v_mfma_f32_16x16x32_bf16 v[208:211], a[72:75], a[168:171], v[208:211]
    v_mul_f32 v178, v178, v106
    v_cvt_pk_bf16_f32 v55, v146, v178
    v_mfma_f32_16x16x32_bf16 v[208:211], a[76:79], a[172:175], v[208:211]
    v_mul_f32 v179, v179, v107
    v_mfma_f32_16x16x32_bf16 v[244:247], a[200:203], a[106:109], v[244:247]
    s_waitcnt lgkmcnt(3)
    v_mfma_f32_16x16x32_bf16 v[244:247], a[204:207], a[130:133], v[244:247]
    buffer_store_dwordx4 v[92:95], v25, s[16:19], s66 offen sc1
    v_mfma_f32_16x16x32_bf16 v[244:247], a[160:163], a[194:197], v[244:247]
    s_mov_b32 s66, 458752
    v_add_f32 v240, v240, v88
    v_mul_f32 v240, v240, v84
    v_mfma_f32_16x16x32_bf16 v[244:247], a[164:167], a[242:245], v[244:247]
    v_add_f32 v241, v241, v89
    v_mul_f32 v241, v241, v85
    v_mfma_f32_16x16x32_bf16 v[148:151], a[16:19], a[104:107], v[148:151]
    s_waitcnt lgkmcnt(2)
    ds_read_b128 a[232:235], v40 offset:61440
    v_mfma_f32_16x16x32_bf16 v[148:151], a[20:23], a[108:111], v[148:151]
    buffer_store_dwordx4 v[48:51], v25, s[16:19], s67 offen sc1
    v_mfma_f32_16x16x32_bf16 v[148:151], a[48:51], a[128:131], v[148:151]
    s_mov_b32 s67, 473088
    ds_read_b128 a[236:239], v41 offset:61440
    v_cvt_pk_bf16_f32 v88, v240, v241
    v_mfma_f32_16x16x32_bf16 v[148:151], a[52:55], a[132:135], v[148:151]
    ds_write_b32 v28, v88 offset:22272
    v_mfma_f32_16x16x32_bf16 v[148:151], a[88:91], a[192:195], v[148:151]
    ds_write_addtid_b32 v246 offset:4096
    v_mul_f32 v208, v208, v108
    v_mfma_f32_16x16x32_bf16 v[148:151], a[92:95], a[196:199], v[148:151]
    v_mul_f32 v209, v209, v109
    v_mul_f32 v210, v210, v110
    v_mfma_f32_16x16x32_bf16 v[148:151], a[40:43], a[240:243], v[148:151]
    v_mul_f32 v211, v211, v111
    v_cvt_pk_bf16_f32 v53, v208, v145
    v_mfma_f32_16x16x32_bf16 v[148:151], a[44:47], a[244:247], v[148:151]
    ds_write_b64 v26, v[52:53] offset:22272
    v_mfma_f32_16x16x32_bf16 v[180:183], a[56:59], a[104:107], v[180:183]
    v_cvt_pk_bf16_f32 v54, v177, v209
    v_cvt_pk_bf16_f32 v68, v210, v147
    v_mfma_f32_16x16x32_bf16 v[180:183], a[60:63], a[108:111], v[180:183]
    ds_read_b128 a[224:227], v42 offset:12288
    v_cvt_pk_bf16_f32 v69, v179, v211
    v_mfma_f32_16x16x32_bf16 v[180:183], a[32:35], a[128:131], v[180:183]
    ds_write_b64 v26, v[54:55] offset:22280
    v_mfma_f32_16x16x32_bf16 v[180:183], a[36:39], a[132:135], v[180:183]
    ds_write_b64 v26, v[68:69] offset:22288
    v_mfma_f32_16x16x32_bf16 v[180:183], a[136:139], a[192:195], v[180:183]
    ds_read_b128 a[228:231], v43 offset:12288
    ds_write_addtid_b32 v247 offset:4352
    v_mfma_f32_16x16x32_bf16 v[180:183], a[140:143], a[196:199], v[180:183]
    ds_read_b128 a[80:83], v42 offset:28672
    v_mul_f32 v148, v148, v96
    v_mfma_f32_16x16x32_bf16 v[180:183], a[64:67], a[240:243], v[180:183]
    ds_read_b128 a[84:87], v43 offset:28672
    v_mul_f32 v149, v149, v97
    v_mfma_f32_16x16x32_bf16 v[180:183], a[68:71], a[244:247], v[180:183]
    v_mul_f32 v150, v150, v98
    v_mul_f32 v151, v151, v99
    v_mfma_f32_16x16x32_bf16 v[212:215], a[24:27], a[104:107], v[212:215]
    v_mfma_f32_16x16x32_bf16 v[212:215], a[28:31], a[108:111], v[212:215]
    s_waitcnt lgkmcnt(2)
    s_barrier
    v_mfma_f32_16x16x32_bf16 v[212:215], a[120:123], a[128:131], v[212:215]
    ds_read_b128 v[76:79], v24 offset:22272
    ds_read2st64_b32 v[72:73], v30 offset0:16 offset1:17
    v_mfma_f32_16x16x32_bf16 v[212:215], a[124:127], a[132:135], v[212:215]
    ds_read_b128 v[100:103], v24 offset:23200
    v_mul_f32 v180, v180, v104
    v_mfma_f32_16x16x32_bf16 v[212:215], a[8:11], a[192:195], v[212:215]
    ds_read_b128 a[0:3], v40 offset:14336
    v_cvt_pk_bf16_f32 v64, v148, v180
    v_mfma_f32_16x16x32_bf16 v[212:215], a[12:15], a[196:199], v[212:215]
    ds_read_b128 a[4:7], v41 offset:14336
    v_mul_f32 v181, v181, v105
    v_mfma_f32_16x16x32_bf16 v[212:215], a[72:75], a[240:243], v[212:215]
    v_mul_f32 v182, v182, v106
    v_cvt_pk_bf16_f32 v67, v150, v182
    v_mfma_f32_16x16x32_bf16 v[212:215], a[76:79], a[244:247], v[212:215]
    v_mul_f32 v183, v183, v107
    v_mfma_f32_16x16x32_bf16 v[248:251], a[200:203], a[250:253], v[248:251]
    s_waitcnt lgkmcnt(3)
    v_mfma_f32_16x16x32_bf16 v[248:251], a[204:207], a[234:237], v[248:251]
    buffer_store_dwordx4 v[76:79], v25, s[16:19], s66 offen sc1
    v_mfma_f32_16x16x32_bf16 v[248:251], a[160:163], a[226:229], v[248:251]
    s_mov_b32 s66, 573440
    v_add_f32 v244, v244, v72
    v_mul_f32 v244, v244, v84
    v_mfma_f32_16x16x32_bf16 v[248:251], a[164:167], a[82:85], v[248:251]
    v_add_f32 v245, v245, v73
    v_mul_f32 v245, v245, v85
    v_mfma_f32_16x16x32_bf16 v[152:155], a[16:19], a[248:251], v[152:155]
    s_waitcnt lgkmcnt(2)
    ds_read_b128 a[144:147], v40 offset:30720
    v_mfma_f32_16x16x32_bf16 v[152:155], a[20:23], a[252:255], v[152:155]
    buffer_store_dwordx4 v[100:103], v25, s[16:19], s67 offen sc1
    v_mfma_f32_16x16x32_bf16 v[152:155], a[48:51], a[232:235], v[152:155]
    s_mov_b32 s67, 587776
    ds_read_b128 a[148:151], v41 offset:30720
    v_cvt_pk_bf16_f32 v72, v244, v245
    v_mfma_f32_16x16x32_bf16 v[152:155], a[52:55], a[236:239], v[152:155]
    ds_write_b32 v28, v72 offset:29696
    v_mfma_f32_16x16x32_bf16 v[152:155], a[88:91], a[224:227], v[152:155]
    ds_write_addtid_b32 v250 offset:6144
    v_mul_f32 v212, v212, v108
    v_mfma_f32_16x16x32_bf16 v[152:155], a[92:95], a[228:231], v[152:155]
    v_mul_f32 v213, v213, v109
    v_mul_f32 v214, v214, v110
    v_mfma_f32_16x16x32_bf16 v[152:155], a[40:43], a[80:83], v[152:155]
    v_mul_f32 v215, v215, v111
    v_cvt_pk_bf16_f32 v65, v212, v149
    v_mfma_f32_16x16x32_bf16 v[152:155], a[44:47], a[84:87], v[152:155]
    ds_write_b64 v26, v[64:65] offset:29696
    v_mfma_f32_16x16x32_bf16 v[184:187], a[56:59], a[248:251], v[184:187]
    v_cvt_pk_bf16_f32 v66, v181, v213
    v_cvt_pk_bf16_f32 v80, v214, v151
    v_mfma_f32_16x16x32_bf16 v[184:187], a[60:63], a[252:255], v[184:187]
    ds_read_b128 a[168:171], v40 offset:47104
    v_cvt_pk_bf16_f32 v81, v183, v215
    v_mfma_f32_16x16x32_bf16 v[184:187], a[32:35], a[232:235], v[184:187]
    ds_write_b64 v26, v[66:67] offset:29704
    v_mfma_f32_16x16x32_bf16 v[184:187], a[36:39], a[236:239], v[184:187]
    ds_write_b64 v26, v[80:81] offset:29712
    v_mfma_f32_16x16x32_bf16 v[184:187], a[136:139], a[224:227], v[184:187]
    ds_read_b128 a[172:175], v41 offset:47104
    ds_write_addtid_b32 v251 offset:6400
    v_mfma_f32_16x16x32_bf16 v[184:187], a[140:143], a[228:231], v[184:187]
    ds_read_b128 a[104:107], v40 offset:63488
    v_mul_f32 v152, v152, v96
    v_mfma_f32_16x16x32_bf16 v[184:187], a[64:67], a[80:83], v[184:187]
    ds_read_b128 a[108:111], v41 offset:63488
    v_mul_f32 v153, v153, v97
    v_mfma_f32_16x16x32_bf16 v[184:187], a[68:71], a[84:87], v[184:187]
    v_mul_f32 v154, v154, v98
    v_mul_f32 v155, v155, v99
    v_mfma_f32_16x16x32_bf16 v[216:219], a[24:27], a[248:251], v[216:219]
    ds_read_b128 a[128:131], v42 offset:14336
    v_mfma_f32_16x16x32_bf16 v[216:219], a[28:31], a[252:255], v[216:219]
    s_waitcnt lgkmcnt(3)
    s_barrier
    v_mfma_f32_16x16x32_bf16 v[216:219], a[120:123], a[232:235], v[216:219]
    ds_read_b128 a[132:135], v43 offset:14336
    ds_read2st64_b32 v[120:121], v30 offset0:24 offset1:25
    v_mfma_f32_16x16x32_bf16 v[216:219], a[124:127], a[236:239], v[216:219]
    ds_read_b128 a[192:195], v42 offset:30720
    v_mul_f32 v184, v184, v104
    v_mfma_f32_16x16x32_bf16 v[216:219], a[8:11], a[224:227], v[216:219]
    ds_read_b128 a[196:199], v43 offset:30720
    v_cvt_pk_bf16_f32 v116, v152, v184
    v_mfma_f32_16x16x32_bf16 v[216:219], a[12:15], a[228:231], v[216:219]
    ds_read_b128 v[112:115], v24 offset:29696
    v_mul_f32 v185, v185, v105
    v_mfma_f32_16x16x32_bf16 v[216:219], a[72:75], a[80:83], v[216:219]
    ds_read_b128 v[124:127], v24 offset:30624
    v_mul_f32 v186, v186, v106
    v_mfma_f32_16x16x32_bf16 v[216:219], a[76:79], a[84:87], v[216:219]
    v_cvt_pk_bf16_f32 v119, v154, v186
    v_mul_f32 v187, v187, v107
    v_mfma_f32_16x16x32_bf16 v[252:255], a[152:155], a[2:5], v[252:255]
    v_mfma_f32_16x16x32_bf16 v[252:255], a[156:159], a[146:149], v[252:255]
    s_waitcnt lgkmcnt(4)
    v_add_f32 v248, v248, v120
    v_mul_f32 v248, v248, v84
    v_mfma_f32_16x16x32_bf16 v[252:255], a[200:203], a[170:173], v[252:255]
    v_add_f32 v249, v249, v121
    v_mul_f32 v249, v249, v85
    v_mfma_f32_16x16x32_bf16 v[252:255], a[204:207], a[106:109], v[252:255]
    s_waitcnt lgkmcnt(1)
    v_cvt_pk_bf16_f32 v120, v248, v249
    v_mfma_f32_16x16x32_bf16 v[252:255], a[160:163], a[130:133], v[252:255]
    buffer_store_dwordx4 v[112:115], v25, s[16:19], s66 offen sc1
    v_mfma_f32_16x16x32_bf16 v[252:255], a[164:167], a[194:197], v[252:255]
    s_mov_b32 s66, 688128
    ds_write_b32 v28, v120 offset:37120
    v_mfma_f32_16x16x32_bf16 v[156:159], a[96:99], a[0:3], v[156:159]
    v_mul_f32 v216, v216, v108
    v_mul_f32 v217, v217, v109
    v_mfma_f32_16x16x32_bf16 v[156:159], a[100:103], a[4:7], v[156:159]
    s_waitcnt lgkmcnt(1)
    v_mul_f32 v218, v218, v110
    v_mfma_f32_16x16x32_bf16 v[156:159], a[184:187], a[144:147], v[156:159]
    buffer_store_dwordx4 v[124:127], v25, s[16:19], s67 offen sc1
    v_mfma_f32_16x16x32_bf16 v[156:159], a[188:191], a[148:151], v[156:159]
    s_mov_b32 s67, 702464
    ds_write_addtid_b32 v254 offset:8192
    v_mul_f32 v219, v219, v111
    v_mfma_f32_16x16x32_bf16 v[156:159], a[16:19], a[168:171], v[156:159]
    ds_write_addtid_b32 v255 offset:8448
    v_cvt_pk_bf16_f32 v117, v216, v153
    v_mfma_f32_16x16x32_bf16 v[156:159], a[20:23], a[172:175], v[156:159]
    ds_write_b64 v26, v[116:117] offset:37120
    v_mfma_f32_16x16x32_bf16 v[156:159], a[48:51], a[104:107], v[156:159]
    v_cvt_pk_bf16_f32 v118, v185, v217
    v_cvt_pk_bf16_f32 v92, v218, v155
    v_mfma_f32_16x16x32_bf16 v[156:159], a[52:55], a[108:111], v[156:159]
    ds_write_b64 v26, v[118:119] offset:37128
    v_mfma_f32_16x16x32_bf16 v[156:159], a[88:91], a[128:131], v[156:159]
    v_cvt_pk_bf16_f32 v93, v187, v219
    v_mfma_f32_16x16x32_bf16 v[156:159], a[92:95], a[132:135], v[156:159]
    ds_write_b64 v26, v[92:93] offset:37136
    v_mfma_f32_16x16x32_bf16 v[156:159], a[40:43], a[192:195], v[156:159]
    v_mfma_f32_16x16x32_bf16 v[156:159], a[44:47], a[196:199], v[156:159]
    v_mfma_f32_16x16x32_bf16 v[188:191], a[176:179], a[0:3], v[188:191]
    v_mfma_f32_16x16x32_bf16 v[188:191], a[180:183], a[4:7], v[188:191]
    v_mfma_f32_16x16x32_bf16 v[188:191], a[208:211], a[144:147], v[188:191]
    s_waitcnt lgkmcnt(0)
    s_barrier
    v_mfma_f32_16x16x32_bf16 v[188:191], a[212:215], a[148:151], v[188:191]
    ds_read_b128 v[48:51], v24 offset:37120
    ds_read2st64_b32 v[88:89], v30 offset0:32 offset1:33
    v_mfma_f32_16x16x32_bf16 v[188:191], a[56:59], a[168:171], v[188:191]
    ds_read_b128 v[52:55], v24 offset:38048
    v_mul_f32 v156, v156, v96
    v_mfma_f32_16x16x32_bf16 v[188:191], a[60:63], a[172:175], v[188:191]
    v_mul_f32 v157, v157, v97
    v_mul_f32 v158, v158, v98
    v_mfma_f32_16x16x32_bf16 v[188:191], a[32:35], a[104:107], v[188:191]
    v_mul_f32 v159, v159, v99
    v_mfma_f32_16x16x32_bf16 v[188:191], a[36:39], a[108:111], v[188:191]
    v_mfma_f32_16x16x32_bf16 v[188:191], a[136:139], a[128:131], v[188:191]
    v_mfma_f32_16x16x32_bf16 v[188:191], a[140:143], a[132:135], v[188:191]
    s_waitcnt lgkmcnt(1)
    v_mfma_f32_16x16x32_bf16 v[188:191], a[64:67], a[192:195], v[188:191]
    buffer_store_dwordx4 v[48:51], v25, s[16:19], s66 offen sc1
    v_mfma_f32_16x16x32_bf16 v[188:191], a[68:71], a[196:199], v[188:191]
    s_mov_b32 s66, 802816
    v_add_f32 v252, v252, v88
    v_mul_f32 v252, v252, v84
    v_mfma_f32_16x16x32_bf16 v[220:223], a[112:115], a[0:3], v[220:223]
    v_add_f32 v253, v253, v89
    v_mul_f32 v253, v253, v85
    v_mfma_f32_16x16x32_bf16 v[220:223], a[116:119], a[4:7], v[220:223]
    s_waitcnt lgkmcnt(0)
    v_cvt_pk_bf16_f32 v88, v252, v253
    v_mfma_f32_16x16x32_bf16 v[220:223], a[216:219], a[144:147], v[220:223]
    buffer_store_dwordx4 v[52:55], v25, s[16:19], s67 offen sc1
    v_mfma_f32_16x16x32_bf16 v[220:223], a[220:223], a[148:151], v[220:223]
    s_mov_b32 s67, 817152
    ds_write_b32 v28, v88 offset:44544
    v_mfma_f32_16x16x32_bf16 v[220:223], a[24:27], a[168:171], v[220:223]
    v_mul_f32 v188, v188, v104
    v_cvt_pk_bf16_f32 v68, v156, v188
    v_mfma_f32_16x16x32_bf16 v[220:223], a[28:31], a[172:175], v[220:223]
    v_mul_f32 v189, v189, v105
    v_mul_f32 v190, v190, v106
    v_mfma_f32_16x16x32_bf16 v[220:223], a[120:123], a[104:107], v[220:223]
    v_cvt_pk_bf16_f32 v71, v158, v190
    v_mul_f32 v191, v191, v107
    v_mfma_f32_16x16x32_bf16 v[220:223], a[124:127], a[108:111], v[220:223]
    v_mfma_f32_16x16x32_bf16 v[220:223], a[8:11], a[128:131], v[220:223]
    v_mfma_f32_16x16x32_bf16 v[220:223], a[12:15], a[132:135], v[220:223]
    v_mfma_f32_16x16x32_bf16 v[220:223], a[72:75], a[192:195], v[220:223]
    v_mfma_f32_16x16x32_bf16 v[220:223], a[76:79], a[196:199], v[220:223]
    s_nop 7
    v_mul_f32 v220, v220, v108
    v_mul_f32 v221, v221, v109
    v_mul_f32 v222, v222, v110
    v_mul_f32 v223, v223, v111
    v_cvt_pk_bf16_f32 v69, v220, v157
    v_cvt_pk_bf16_f32 v70, v189, v221
    v_cvt_pk_bf16_f32 v76, v222, v159
    v_cvt_pk_bf16_f32 v77, v191, v223
    ds_write_b64 v26, v[68:69] offset:44544
    ds_write_b64 v26, v[70:71] offset:44552
    ds_write_b64 v26, v[76:77] offset:44560
    s_waitcnt lgkmcnt(0)
    s_barrier
    ds_read_b128 v[100:103], v24 offset:44544
    ds_read_b128 v[72:75], v24 offset:45472
    s_waitcnt lgkmcnt(1)
    buffer_store_dwordx4 v[100:103], v25, s[16:19], s66 offen sc1
    s_waitcnt lgkmcnt(0)
    buffer_store_dwordx4 v[72:75], v25, s[16:19], s67 offen sc1
L_end:
    s_endpgm
L_help:
    s_mov_b32 s53, s61
    s_mov_b32 s54, s62
    s_mul_i32 s61, s22, 1835008
    s_add_u32 s61, s61, s79
    s_lshl_b32 s62, s22, 14
    s_add_u32 s62, s62, s68
    s_mov_b32 s22, 0
L_help_row:
    v_mov_b32 v21, v19
    s_xor_b32 s23, s22, s58
    s_bitcmp0_b32 s23, 2
    s_cbranch_scc1 L_help_same
    v_add_u32 v12, 57344, v19
    v_subrev_u32 v13, 57344, v19
    v_min_u32 v21, v12, v13
L_help_same:
    v_mov_b32 v8, 0
    v_mov_b32 v9, 0
    v_mov_b32 v10, 0
    v_mov_b32 v11, s47
    s_mov_b32 s23, 0
L_help_e:
    v_mov_b32 v15, 0
    buffer_load_dwordx3 v[12:14], v18, s[4:7], s61 offen nt
    s_cmp_ge_u32 s23, 16
    s_cbranch_scc1 L_help_own
    buffer_load_dword v15, v21, s[4:7], s61 offen nt
L_help_own:
    s_waitcnt vmcnt(0)
    v_lshl_or_b32 v8, v12, s23, v8
    v_lshl_or_b32 v9, v13, s23, v9
    v_lshl_or_b32 v10, v14, s23, v10
    v_lshl_or_b32 v11, v15, s23, v11
    s_add_u32 s61, s61, 14336
    s_add_u32 s23, s23, 4
    s_cmp_lt_u32 s23, 32
    s_cbranch_scc1 L_help_e
    buffer_store_dwordx4 v[8:11], v20, s[12:15], s62 offen sc1
    s_add_u32 s62, s62, 1024
    s_waitcnt vmcnt(0)
    s_add_u32 s22, s22, 1
    s_cmp_lt_u32 s22, 16
    s_cbranch_scc1 L_help_row
    s_mov_b32 s61, s53
    s_mov_b32 s62, s54
    s_setpc_b64 s[20:21]
L_code_end:

.section .rodata,"a"
.p2align 6
.amdhsa_kernel standalone__normalfloat_lut_af4__prompt_kernel
  .amdhsa_next_free_vgpr 512
  .amdhsa_next_free_sgpr 102
  .amdhsa_accum_offset 256
  .amdhsa_group_segment_fixed_size 0
  .amdhsa_kernarg_size 56
  .amdhsa_user_sgpr_count 2
  .amdhsa_user_sgpr_kernarg_segment_ptr 1
  .amdhsa_system_sgpr_workgroup_id_x 1
.end_amdhsa_kernel
```

```asm
; @launch grid=(256,1,1) block=(256,1,1) lds=163840
.amdgcn_target "amdgcn-amd-amdhsa--gfx950"
.text
.globl standalone__normalfloat_lut_af4__prompt_kernel
.p2align 8
.type standalone__normalfloat_lut_af4__prompt_kernel,@function
standalone__normalfloat_lut_af4__prompt_kernel:
    s_cmp_ge_u32 s2, 256
    s_cbranch_scc1 L_end
    s_load_dwordx2 s[4:5], s[0:1], 8
    s_load_dwordx2 s[12:13], s[0:1], 48
    s_load_dwordx2 s[8:9], s[0:1], 0
    s_load_dwordx2 s[28:29], s[0:1], 16
    s_getpc_b64 s[48:49]
L_pc:
    s_mov_b32 s50, L_code_end-L_pc
    s_mov_b32 s51, 0x20000
    s_lshr_b32 s61, s2, 3
    v_lshl_add_u32 v46, v0, 5, s61
    v_lshlrev_b32 v46, 7, v46
    buffer_load_dword v1, v46, s[48:51], 0 offen offset:256
    v_lshrrev_b32 v5, 6, v0
    v_and_b32 v2, 63, v0
    s_and_b32 s60, s2, 7
    v_readfirstlane_b32 s63, v5
    s_and_b32 s58, s60, 3
    s_lshl_b32 s58, s58, 2
    s_and_b32 s62, s61, 3
    s_add_u32 s58, s58, s62
    s_lshr_b32 s59, s60, 2
    s_lshl_b32 s59, s59, 3
    s_lshr_b32 s62, s61, 2
    s_add_u32 s59, s59, s62
    v_mul_u32_u24 v18, 12, v2
    s_lshl_b32 s60, s63, 4
    s_add_u32 s60, s60, s58
    s_mul_i32 s61, s60, 114688
    s_mul_i32 s79, s59, 896
    s_add_u32 s61, s61, s79
    s_mov_b32 s6, 14680064
    s_mov_b32 s7, 0x20000
    s_lshl_b32 s78, s59, 7
    s_add_u32 s78, s78, 2097164
    v_and_b32 v4, 15, v2
    v_lshrrev_b32 v3, 4, v2
    v_and_b32 v12, 1, v3
    v_lshlrev_b32 v13, 1, v12
    v_xor_b32 v13, v13, v4
    v_lshrrev_b32 v19, 1, v3
    v_lshl_add_u32 v19, v19, 4, v13
    s_bfe_u32 s70, s58, 0x10002
    s_xor_b32 s70, s70, 1
    v_xor_b32 v12, s70, v12
    v_mul_u32_u24 v12, 14336, v12
    v_add_lshl_u32 v19, v19, v12, 2
    v_add_u32 v19, 768, v19
    s_mov_b32 s46, 2
    s_cmp_lg_u32 s63, 0
    s_cbranch_scc1 L_role0
    s_mov_b32 s46, 0
L_role0:
    s_cmp_lg_u32 s63, 1
    s_cbranch_scc1 L_role1
    s_mov_b32 s46, 1
L_role1:
    v_lshlrev_b32 v16, 1, v4
    v_lshrrev_b32 v17, 4, v0
    v_lshlrev_b32 v17, 1, v17
    s_mov_b32 s30, 32
    s_mov_b32 s31, 0x20000
    v_lshrrev_b32 v6, 3, v2
    v_and_b32 v7, 7, v2
    v_xor_b32 v13, v7, v3
    s_lshl_b32 s70, s63, 5
    v_add_lshl_u32 v12, v6, s70, 11
    v_lshl_add_u32 v36, v13, 4, v12
    v_xor_b32 v37, 64, v36
    v_add_u32 v37, 15360, v37
    v_add_u32 v38, 30720, v36
    v_add_u32 v39, 30720, v37
    s_mov_b32 s10, 4194304
    s_mov_b32 s11, 0x20000
    s_lshl_b32 s55, s58, 18
    s_and_b32 s71, s58, 8
    s_lshl_b32 s70, s71, 4
    s_add_u32 s55, s55, s70
    s_lshl_b32 s57, s63, 12
    s_xor_b32 s69, s55, 128
    s_add_u32 s57, s57, 65536
    s_mov_b32 s14, 2099200
    s_mov_b32 s15, 0x20000
    s_lshl_b32 s68, s59, 17
    s_lshl_b32 s62, s60, 10
    s_add_u32 s62, s62, s68
    v_lshlrev_b32 v20, 4, v2
    s_waitcnt lgkmcnt(0)
    s_load_dword s76, s[12:13], s78
    s_cmp_eq_u32 s46, 1
    s_cbranch_scc1 L_L
    s_cmp_eq_u32 s46, 2
    s_cbranch_scc1 L_L
L_X:
    buffer_load_dwordx3 v[128:130], v18, s[4:7], s61 offen nt
    buffer_load_dword v131, v19, s[4:7], s61 offen nt
    s_add_u32 s61, s61, 14336
    buffer_load_dwordx3 v[132:134], v18, s[4:7], s61 offen nt
    buffer_load_dword v135, v19, s[4:7], s61 offen nt
    s_add_u32 s61, s61, 14336
    buffer_load_dwordx3 v[136:138], v18, s[4:7], s61 offen nt
    buffer_load_dword v139, v19, s[4:7], s61 offen nt
    s_add_u32 s61, s61, 14336
    buffer_load_dwordx3 v[140:142], v18, s[4:7], s61 offen nt
    buffer_load_dword v143, v19, s[4:7], s61 offen nt
    s_add_u32 s61, s61, 14336
    buffer_load_dwordx3 v[144:146], v18, s[4:7], s61 offen nt
    s_add_u32 s61, s61, 14336
    buffer_load_dwordx3 v[148:150], v18, s[4:7], s61 offen nt
    s_add_u32 s61, s61, 14336
    buffer_load_dwordx3 v[152:154], v18, s[4:7], s61 offen nt
    s_add_u32 s61, s61, 14336
    buffer_load_dwordx3 v[156:158], v18, s[4:7], s61 offen nt
    s_add_u32 s61, s61, 7239680
    s_cmp_eq_u32 s46, 1
    s_cbranch_scc1 L_D
    s_cmp_eq_u32 s46, 2
    s_cbranch_scc1 L_B
L_L:
    buffer_load_ushort v16, v16, s[28:31], 0 offen
    buffer_load_ushort v17, v17, s[28:31], 0 offen
    s_cmp_eq_u32 s46, 1
    s_cbranch_scc1 L_S
    s_cmp_eq_u32 s46, 2
    s_cbranch_scc1 L_S
L_D:
    s_add_u32 m0, s57, 32768
    s_add_u32 s56, s55, 0
    buffer_load_dwordx4 v36, s[8:11], s56 offen offset:0  lds
    buffer_load_dwordx4 v37, s[8:11], s56 offen offset:1024  lds
    buffer_load_dwordx4 v38, s[8:11], s56 offen offset:2048  lds
    buffer_load_dwordx4 v39, s[8:11], s56 offen offset:3072  lds
    s_cmp_eq_u32 s46, 1
    s_cbranch_scc1 L_G
    s_cmp_eq_u32 s46, 2
    s_cbranch_scc1 L_G
L_S:
    s_load_dwordx2 s[32:33], s[0:1], 24
    s_load_dwordx2 s[16:17], s[0:1], 32
    s_load_dwordx2 s[24:25], s[0:1], 40
    s_and_b32 s64, s63, 1
    s_lshr_b32 s65, s63, 1
    s_and_b32 s70, s58, 8
    s_lshl_b32 s70, s70, 10
    s_lshl_b32 s71, s64, 12
    s_add_u32 s70, s70, s71
    s_lshl_b32 s71, s63, 8
    s_add_u32 s70, s70, s71
    s_add_u32 s70, s70, s68
    v_lshl_add_u32 v32, v4, 4, s70
    v_lshl_add_u32 v32, v3, 10, v32
    v_xor_b32 v33, 4096, v32
    v_xor_b32 v34, 8192, v32
    v_xor_b32 v44, 12288, v32
    s_mov_b32 s36, 202114048
    s_mov_b32 s37, 202114304
    s_mov_b32 s38, 202114560
    s_mov_b32 s39, 202114816
    v_and_b32 v35, 31, v2
    v_lshlrev_b32 v35, 2, v35
    s_lshl_b32 s70, s64, 6
    s_add_u32 s70, s70, 65536
    v_lshrrev_b32 v12, 1, v4
    v_xor_b32 v12, v12, v3
    v_lshlrev_b32 v12, 4, v12
    v_lshl_add_u32 v12, v4, 7, v12
    v_xor_b32 v40, s70, v12
    v_xor_b32 v41, 64, v40
    v_add_u32 v42, 65536, v40
    v_add_u32 v43, 65536, v41
    s_mov_b32 s52, 0
    v_lshlrev_b32 v8, 4, v7
    v_lshl_add_u32 v8, v0, 8, v8
    v_xor_b32 v9, 16, v8
    v_xor_b32 v10, 32, v8
    v_xor_b32 v11, 48, v8
    v_xor_b32 v12, 64, v8
    v_xor_b32 v13, 80, v8
    v_xor_b32 v14, 96, v8
    v_xor_b32 v15, 112, v8
    s_cmp_eq_u32 s46, 1
    s_cbranch_scc1 L_X
    s_cmp_eq_u32 s46, 2
    s_cbranch_scc1 L_D
L_G:
    s_waitcnt lgkmcnt(0)
    s_add_u32 s76, s76, 2654435769
    s_and_b32 s47, s76, 0xffff0000
    s_cmp_eq_u32 s46, 1
    s_cbranch_scc1 L_T
    s_cmp_eq_u32 s46, 2
    s_cbranch_scc1 L_T
L_K:
    s_waitcnt vmcnt(16)
    v_or_b32 v131, s47, v131
    s_waitcnt vmcnt(15)
    v_lshl_or_b32 v128, v132, 4, v128
    v_lshl_or_b32 v129, v133, 4, v129
    v_lshl_or_b32 v130, v134, 4, v130
    s_waitcnt vmcnt(14)
    v_lshl_or_b32 v131, v135, 4, v131
    s_waitcnt vmcnt(13)
    v_lshl_or_b32 v128, v136, 8, v128
    v_lshl_or_b32 v129, v137, 8, v129
    v_lshl_or_b32 v130, v138, 8, v130
    s_waitcnt vmcnt(12)
    v_lshl_or_b32 v131, v139, 8, v131
    s_waitcnt vmcnt(11)
    v_lshl_or_b32 v128, v140, 12, v128
    v_lshl_or_b32 v129, v141, 12, v129
    v_lshl_or_b32 v130, v142, 12, v130
    s_waitcnt vmcnt(10)
    v_lshl_or_b32 v131, v143, 12, v131
    s_waitcnt vmcnt(9)
    v_lshl_or_b32 v128, v144, 16, v128
    v_lshl_or_b32 v129, v145, 16, v129
    v_lshl_or_b32 v130, v146, 16, v130
    s_waitcnt vmcnt(8)
    v_lshl_or_b32 v128, v148, 20, v128
    v_lshl_or_b32 v129, v149, 20, v129
    v_lshl_or_b32 v130, v150, 20, v130
    s_waitcnt vmcnt(7)
    v_lshl_or_b32 v128, v152, 24, v128
    v_lshl_or_b32 v129, v153, 24, v129
    v_lshl_or_b32 v130, v154, 24, v130
    s_waitcnt vmcnt(6)
    v_lshl_or_b32 v128, v156, 28, v128
    v_lshl_or_b32 v129, v157, 28, v129
    v_lshl_or_b32 v130, v158, 28, v130
    buffer_store_dwordx4 v[128:131], v20, s[12:15], s62 offen sc1
    s_add_u32 s62, s62, 65536
    s_cmp_eq_u32 s46, 1
    s_cbranch_scc1 L_B
    s_cmp_eq_u32 s46, 2
    s_cbranch_scc1 L_E
L_T:
    s_waitcnt vmcnt(16)
    s_cmp_eq_u32 s46, 1
    s_cbranch_scc1 L_rw1
    s_waitcnt vmcnt(5)
    s_cmp_eq_u32 s46, 0
    s_cbranch_scc1 L_rw1
    s_waitcnt vmcnt(4)
L_rw1:
    v_lshl_or_b32 v56, v17, 16, v16
    v_lshl_or_b32 v57, v17, 16, v16
    v_lshl_or_b32 v58, v17, 16, v16
    v_lshl_or_b32 v59, v17, 16, v16
    ds_write_b128 v8, v[56:59]
    ds_write_b128 v9, v[56:59]
    ds_write_b128 v10, v[56:59]
    ds_write_b128 v11, v[56:59]
    ds_write_b128 v12, v[56:59]
    ds_write_b128 v13, v[56:59]
    ds_write_b128 v14, v[56:59]
    ds_write_b128 v15, v[56:59]
    s_cmp_lg_u32 s46, 1
    s_cbranch_scc1 L_ed2
    s_waitcnt vmcnt(4)
    s_branch L_K
L_ed2:
    s_cmp_eq_u32 s46, 2
    s_cbranch_scc1 L_X
L_W:
    s_mov_b64 exec, 0
    s_cmp_eq_u32 s63, 0
    s_cbranch_scc1 L_pad0
L_warmed:
    s_mov_b64 exec, -1
L_B:
    s_waitcnt vmcnt(12) lgkmcnt(0)
    s_cmp_eq_u32 s46, 2
    s_cbranch_scc1 L_rw3
    s_waitcnt vmcnt(1)
L_rw3:
    s_barrier
L_Q:
    ds_read_b128 a[0:3], v40 offset:32768
    ds_read_b128 a[4:7], v41 offset:32768
    ds_read_b128 a[8:11], v40 offset:34816
    ds_read_b128 a[12:15], v41 offset:34816
    ds_read_b128 a[16:19], v40 offset:36864
    ds_read_b128 a[20:23], v41 offset:36864
    ds_read_b128 a[24:27], v40 offset:38912
    ds_read_b128 a[28:31], v41 offset:38912
    ds_read_b128 a[40:43], v40 offset:40960
    ds_read_b128 a[44:47], v41 offset:40960
    ds_read_b128 a[48:51], v40 offset:43008
    ds_read_b128 a[52:55], v41 offset:43008
    ds_read_b128 a[56:59], v40 offset:45056
    ds_read_b128 a[60:63], v41 offset:45056
    ds_read_b128 a[72:75], v40 offset:47104
    ds_read_b128 a[76:79], v41 offset:47104
L_P:
    buffer_load_dwordx4 v[64:67], v32, s[12:15], 0 offen sc1
    buffer_load_dwordx4 v[68:71], v33, s[12:15], 0 offen sc1
L_d:
    s_add_u32 m0, s57, 49152
    s_add_u32 s3, s69, 0
    buffer_load_dwordx4 v36, s[8:11], s3 offen offset:0  lds
    buffer_load_dwordx4 v37, s[8:11], s3 offen offset:1024  lds
    buffer_load_dwordx4 v38, s[8:11], s3 offen offset:2048  lds
    buffer_load_dwordx4 v39, s[8:11], s3 offen offset:3072  lds
    s_cmp_lg_u32 s46, 2
    s_cbranch_scc1 L_ed4
    s_waitcnt vmcnt(6)
    s_branch L_K
L_ed4:
L_E:
L_chk0:
    s_waitcnt vmcnt(5)
    s_cmp_eq_u32 s46, 2
    s_cbranch_scc1 L_rw5
    s_waitcnt vmcnt(4)
L_rw5:
    v_bitop3_b32 v12, v67, v71, s76 bitop3:0x7e
    v_cmp_lt_u32 vcc, 0xffff, v12
    s_cbranch_vccnz L_retry0
    buffer_load_dwordx4 v[72:75], v34, s[12:15], 0 offen sc1
    buffer_load_dwordx4 v[76:79], v44, s[12:15], 0 offen sc1
    v_perm_b32 v56, v64, v35, s36
    v_perm_b32 v57, v64, v35, s37
    v_perm_b32 v58, v64, v35, s38
    v_perm_b32 v59, v64, v35, s39
    v_perm_b32 v60, v68, v35, s36
    v_perm_b32 v61, v68, v35, s37
    v_perm_b32 v62, v68, v35, s38
    v_perm_b32 v63, v68, v35, s39
    ds_read_b32 a32, v56
    ds_read_b32 a33, v57
    ds_read_b32 a34, v58
    ds_read_b32 a35, v59
    ds_read_b32 a36, v60
    ds_read_b32 a37, v61
    ds_read_b32 a38, v62
    ds_read_b32 a39, v63
    v_perm_b32 v5, v65, v35, s36
    v_perm_b32 v6, v65, v35, s37
    v_perm_b32 v7, v65, v35, s38
    v_perm_b32 v27, v65, v35, s39
    v_perm_b32 v29, v69, v35, s36
    v_perm_b32 v31, v69, v35, s37
    ds_read_b32 a64, v5
    ds_read_b32 a65, v6
    ds_read_b32 a66, v7
    ds_read_b32 a67, v27
    s_cbranch_vccz L_main
L_retry0:
    s_add_u32 s52, s52, 1
    s_and_b32 s23, s52, 4095
    s_cbranch_scc1 L_retry0b
    s_mov_b32 s22, 0
    s_call_b64 s[20:21], L_help
L_retry0b:
    buffer_load_dwordx4 v[64:67], v32, s[12:15], 0 offen sc1
    buffer_load_dwordx4 v[68:71], v33, s[12:15], 0 offen sc1
    s_waitcnt vmcnt(0) lgkmcnt(0)
    s_branch L_chk0
L_tick:
    s_add_u32 s52, s52, 1
    s_and_b32 s23, s52, 4095
    s_cbranch_scc0 L_help
    s_setpc_b64 s[20:21]
L_slow0_1:
    s_mov_b32 s22, 0
    s_call_b64 s[20:21], L_tick
    buffer_load_dwordx4 v[72:75], v34, s[12:15], 0 offen sc1
    buffer_load_dwordx4 v[76:79], v44, s[12:15], 0 offen sc1
    s_waitcnt vmcnt(0)
    v_bitop3_b32 v12, v75, v79, s76 bitop3:0x7e
    v_cmp_lt_u32 vcc, 0xffff, v12
    s_cbranch_vccnz L_slow0_1
    s_branch L_back0_1
L_slow4_0:
    s_mov_b32 s22, 4
    s_call_b64 s[20:21], L_tick
    buffer_load_dwordx4 v[84:87], v32, s[12:15], s43 offen sc1
    buffer_load_dwordx4 v[96:99], v33, s[12:15], s43 offen sc1
    s_waitcnt vmcnt(0)
    v_bitop3_b32 v12, v87, v99, s76 bitop3:0x7e
    v_cmp_lt_u32 vcc, 0xffff, v12
    s_cbranch_vccnz L_slow4_0
    s_branch L_back4_0
L_slow4_1:
    s_mov_b32 s22, 4
    s_call_b64 s[20:21], L_tick
    buffer_load_dwordx4 v[104:107], v34, s[12:15], s43 offen sc1
    buffer_load_dwordx4 v[108:111], v44, s[12:15], s43 offen sc1
    s_waitcnt vmcnt(0)
    v_bitop3_b32 v12, v107, v111, s76 bitop3:0x7e
    v_cmp_lt_u32 vcc, 0xffff, v12
    s_cbranch_vccnz L_slow4_1
    s_branch L_back4_1
L_slow1_0:
    s_mov_b32 s22, 1
    s_call_b64 s[20:21], L_tick
    buffer_load_dwordx4 v[80:83], v32, s[12:15], s40 offen sc1
    buffer_load_dwordx4 v[84:87], v33, s[12:15], s40 offen sc1
    s_waitcnt vmcnt(0)
    v_bitop3_b32 v12, v83, v87, s76 bitop3:0x7e
    v_cmp_lt_u32 vcc, 0xffff, v12
    s_cbranch_vccnz L_slow1_0
    s_branch L_back1_0
L_slow1_1:
    s_mov_b32 s22, 1
    s_call_b64 s[20:21], L_tick
    buffer_load_dwordx4 v[88:91], v34, s[12:15], s40 offen sc1
    buffer_load_dwordx4 v[92:95], v44, s[12:15], s40 offen sc1
    s_waitcnt vmcnt(0)
    v_bitop3_b32 v12, v91, v95, s76 bitop3:0x7e
    v_cmp_lt_u32 vcc, 0xffff, v12
    s_cbranch_vccnz L_slow1_1
    s_branch L_back1_1
L_slow5_0:
    s_mov_b32 s22, 5
    s_call_b64 s[20:21], L_tick
    buffer_load_dwordx4 v[112:115], v32, s[12:15], s44 offen sc1
    buffer_load_dwordx4 v[116:119], v33, s[12:15], s44 offen sc1
    s_waitcnt vmcnt(0)
    v_bitop3_b32 v12, v115, v119, s76 bitop3:0x7e
    v_cmp_lt_u32 vcc, 0xffff, v12
    s_cbranch_vccnz L_slow5_0
    s_branch L_back5_0
L_slow5_1:
    s_mov_b32 s22, 5
    s_call_b64 s[20:21], L_tick
    buffer_load_dwordx4 v[120:123], v34, s[12:15], s44 offen sc1
    buffer_load_dwordx4 v[124:127], v44, s[12:15], s44 offen sc1
    s_waitcnt vmcnt(0)
    v_bitop3_b32 v12, v123, v127, s76 bitop3:0x7e
    v_cmp_lt_u32 vcc, 0xffff, v12
    s_cbranch_vccnz L_slow5_1
    s_branch L_back5_1
L_slow2_0:
    s_mov_b32 s22, 2
    s_call_b64 s[20:21], L_tick
    buffer_load_dwordx4 v[48:51], v32, s[12:15], s41 offen sc1
    buffer_load_dwordx4 v[52:55], v33, s[12:15], s41 offen sc1
    s_waitcnt vmcnt(0)
    v_bitop3_b32 v12, v51, v55, s76 bitop3:0x7e
    v_cmp_lt_u32 vcc, 0xffff, v12
    s_cbranch_vccnz L_slow2_0
    s_branch L_back2_0
L_slow2_1:
    s_mov_b32 s22, 2
    s_call_b64 s[20:21], L_tick
    buffer_load_dwordx4 v[64:67], v34, s[12:15], s41 offen sc1
    buffer_load_dwordx4 v[68:71], v44, s[12:15], s41 offen sc1
    s_waitcnt vmcnt(0)
    v_bitop3_b32 v12, v67, v71, s76 bitop3:0x7e
    v_cmp_lt_u32 vcc, 0xffff, v12
    s_cbranch_vccnz L_slow2_1
    s_branch L_back2_1
L_slow6_0:
    s_mov_b32 s22, 6
    s_call_b64 s[20:21], L_tick
    buffer_load_dwordx4 v[88:91], v32, s[12:15], s45 offen sc1
    buffer_load_dwordx4 v[92:95], v33, s[12:15], s45 offen sc1
    s_waitcnt vmcnt(0)
    v_bitop3_b32 v12, v91, v95, s76 bitop3:0x7e
    v_cmp_lt_u32 vcc, 0xffff, v12
    s_cbranch_vccnz L_slow6_0
    s_branch L_back6_0
L_slow6_1:
    s_mov_b32 s22, 6
    s_call_b64 s[20:21], L_tick
    buffer_load_dwordx4 v[48:51], v34, s[12:15], s45 offen sc1
    buffer_load_dwordx4 v[52:55], v44, s[12:15], s45 offen sc1
    s_waitcnt vmcnt(0)
    v_bitop3_b32 v12, v51, v55, s76 bitop3:0x7e
    v_cmp_lt_u32 vcc, 0xffff, v12
    s_cbranch_vccnz L_slow6_1
    s_branch L_back6_1
L_slow3_0:
    s_mov_b32 s22, 3
    s_call_b64 s[20:21], L_tick
    buffer_load_dwordx4 v[72:75], v32, s[12:15], s42 offen sc1
    buffer_load_dwordx4 v[76:79], v33, s[12:15], s42 offen sc1
    s_waitcnt vmcnt(0)
    v_bitop3_b32 v12, v75, v79, s76 bitop3:0x7e
    v_cmp_lt_u32 vcc, 0xffff, v12
    s_cbranch_vccnz L_slow3_0
    s_branch L_back3_0
L_slow3_1:
    s_mov_b32 s22, 3
    s_call_b64 s[20:21], L_tick
    buffer_load_dwordx4 v[100:103], v34, s[12:15], s42 offen sc1
    buffer_load_dwordx4 v[80:83], v44, s[12:15], s42 offen sc1
    s_waitcnt vmcnt(0)
    v_bitop3_b32 v12, v103, v83, s76 bitop3:0x7e
    v_cmp_lt_u32 vcc, 0xffff, v12
    s_cbranch_vccnz L_slow3_1
    s_branch L_back3_1
L_slow7_0:
    s_mov_b32 s22, 7
    s_call_b64 s[20:21], L_tick
    buffer_load_dwordx4 v[68:71], v32, s[12:15], s72 offen sc1
    buffer_load_dwordx4 v[72:75], v33, s[12:15], s72 offen sc1
    s_waitcnt vmcnt(0)
    v_bitop3_b32 v12, v71, v75, s76 bitop3:0x7e
    v_cmp_lt_u32 vcc, 0xffff, v12
    s_cbranch_vccnz L_slow7_0
    s_branch L_back7_0
L_slow7_1:
    s_mov_b32 s22, 7
    s_call_b64 s[20:21], L_tick
    buffer_load_dwordx4 v[76:79], v34, s[12:15], s72 offen sc1
    buffer_load_dwordx4 v[100:103], v44, s[12:15], s72 offen sc1
    s_waitcnt vmcnt(0)
    v_bitop3_b32 v12, v79, v103, s76 bitop3:0x7e
    v_cmp_lt_u32 vcc, 0xffff, v12
    s_cbranch_vccnz L_slow7_1
    s_branch L_back7_1
.p2align 12
L_main:
L_pad0:
    s_cbranch_execz L_pad1
    s_waitcnt lgkmcnt(8)
    v_mfma_f32_16x16x32_bf16 v[128:131], a[32:35], a[0:3], 0
    s_waitcnt lgkmcnt(4)
    s_mov_b32 s40, 16384
    ds_read_b32 a68, v29
    v_mfma_f32_16x16x32_bf16 v[128:131], a[36:39], a[4:7], v[128:131]
    buffer_load_dwordx4 v[80:83], v32, s[12:15], s40 offen sc1
    v_mfma_f32_16x16x32_bf16 v[132:135], a[36:39], a[12:15], 0
    s_add_u32 m0, s57, 65536
    ds_read_b32 a69, v31
    v_perm_b32 v46, v69, v35, s38
    v_mfma_f32_16x16x32_bf16 v[132:135], a[32:35], a[8:11], v[132:135]
    s_add_u32 s56, s55, 256
    ds_read_b32 a70, v46
    v_perm_b32 v56, v69, v35, s39
    v_mfma_f32_16x16x32_bf16 v[136:139], a[32:35], a[16:19], 0
    s_add_u32 s3, s69, 256
    ds_read_b32 a71, v56
    v_mfma_f32_16x16x32_bf16 v[136:139], a[36:39], a[20:23], v[136:139]
    buffer_load_dwordx4 v[84:87], v33, s[12:15], s40 offen sc1
    v_mfma_f32_16x16x32_bf16 v[140:143], a[36:39], a[28:31], 0
    v_perm_b32 v57, v66, v35, s36
    v_perm_b32 v58, v66, v35, s37
    v_mfma_f32_16x16x32_bf16 v[140:143], a[32:35], a[24:27], v[140:143]
    ds_read_b32 a80, v57
    v_perm_b32 v59, v66, v35, s38
    v_mfma_f32_16x16x32_bf16 v[144:147], a[32:35], a[40:43], 0
    ds_read_b32 a81, v58
    v_mfma_f32_16x16x32_bf16 v[144:147], a[36:39], a[44:47], v[144:147]
    buffer_load_dwordx4 v36, s[8:11], s56 offen offset:0  lds
    v_mfma_f32_16x16x32_bf16 v[148:151], a[36:39], a[52:55], 0
    ds_read_b32 a82, v59
    v_perm_b32 v60, v66, v35, s39
    v_mfma_f32_16x16x32_bf16 v[148:151], a[32:35], a[48:51], v[148:151]
    v_perm_b32 v61, v70, v35, s36
    v_perm_b32 v62, v70, v35, s37
    v_mfma_f32_16x16x32_bf16 v[152:155], a[32:35], a[56:59], 0
    s_mov_b32 s41, 32768
    ds_read_b32 a83, v60
    ds_read_b32 a84, v61
    v_mfma_f32_16x16x32_bf16 v[152:155], a[36:39], a[60:63], v[152:155]
    buffer_load_dwordx4 v37, s[8:11], s56 offen offset:1024  lds
    v_mfma_f32_16x16x32_bf16 v[156:159], a[36:39], a[76:79], 0
    ds_read_b32 a85, v62
    v_perm_b32 v63, v70, v35, s38
    v_mfma_f32_16x16x32_bf16 v[156:159], a[32:35], a[72:75], v[156:159]
    s_waitcnt lgkmcnt(6)
    ds_read_b32 a86, v63
    v_perm_b32 v5, v70, v35, s39
    v_mfma_f32_16x16x32_bf16 v[160:163], a[64:67], a[0:3], 0
    ds_read_b32 a87, v5
    v_mfma_f32_16x16x32_bf16 v[160:163], a[68:71], a[4:7], v[160:163]
    buffer_load_dwordx4 v38, s[8:11], s56 offen offset:2048  lds
    v_mfma_f32_16x16x32_bf16 v[164:167], a[68:71], a[12:15], 0
    v_perm_b32 v6, v67, v35, s36
    v_perm_b32 v7, v67, v35, s37
    v_mfma_f32_16x16x32_bf16 v[164:167], a[64:67], a[8:11], v[164:167]
    ds_read_b32 a88, v6
    v_perm_b32 v27, v71, v35, s36
    v_mfma_f32_16x16x32_bf16 v[168:171], a[64:67], a[16:19], 0
    ds_read_b32 a89, v7
    v_mfma_f32_16x16x32_bf16 v[168:171], a[68:71], a[20:23], v[168:171]
    buffer_load_dwordx4 v39, s[8:11], s56 offen offset:3072  lds
    v_mfma_f32_16x16x32_bf16 v[172:175], a[68:71], a[28:31], 0
    s_add_u32 m0, s57, 81920
    ds_read_b32 a90, v27
    v_perm_b32 v29, v71, v35, s37
    v_mfma_f32_16x16x32_bf16 v[172:175], a[64:67], a[24:27], v[172:175]
    s_add_u32 s56, s55, 512
    ds_read_b32 a91, v29
    v_mfma_f32_16x16x32_bf16 v[176:179], a[64:67], a[40:43], 0
    s_waitcnt vmcnt(6)
    s_mov_b32 s42, 49152
    v_bitop3_b32 v31, v75, v79, s76 bitop3:0x7e
    v_mfma_f32_16x16x32_bf16 v[176:179], a[68:71], a[44:47], v[176:179]
    buffer_load_dwordx4 v[88:91], v34, s[12:15], s40 offen sc1
    v_mfma_f32_16x16x32_bf16 v[180:183], a[68:71], a[52:55], 0
    v_cmp_lt_u32 vcc, 0xffff, v31
    v_mfma_f32_16x16x32_bf16 v[180:183], a[64:67], a[48:51], v[180:183]
    v_mfma_f32_16x16x32_bf16 v[184:187], a[64:67], a[56:59], 0
    s_cbranch_vccnz L_slow0_1
L_back0_1:
    v_mfma_f32_16x16x32_bf16 v[184:187], a[68:71], a[60:63], v[184:187]
    buffer_load_dwordx4 v[92:95], v44, s[12:15], s40 offen sc1
    v_mfma_f32_16x16x32_bf16 v[188:191], a[68:71], a[76:79], 0
    v_perm_b32 v46, v72, v35, s36
    v_perm_b32 v56, v72, v35, s37
    v_mfma_f32_16x16x32_bf16 v[188:191], a[64:67], a[72:75], v[188:191]
    s_waitcnt lgkmcnt(1)
    ds_read_b32 a96, v46
    v_perm_b32 v57, v72, v35, s38
    v_mfma_f32_16x16x32_bf16 v[192:195], a[80:83], a[0:3], 0
    s_barrier
    v_mfma_f32_16x16x32_bf16 v[192:195], a[84:87], a[4:7], v[192:195]
    buffer_load_dwordx4 v36, s[8:11], s3 offen offset:0  lds
    v_mfma_f32_16x16x32_bf16 v[196:199], a[84:87], a[12:15], 0
    ds_read_b32 a97, v56
    v_perm_b32 v58, v72, v35, s39
    v_mfma_f32_16x16x32_bf16 v[196:199], a[80:83], a[8:11], v[196:199]
    ds_read_b32 a98, v57
    ds_read_b32 a99, v58
    v_mfma_f32_16x16x32_bf16 v[200:203], a[80:83], a[16:19], 0
    s_mov_b32 s43, 65536
    ds_read_b128 a[104:107], v40 offset:49152
    v_mfma_f32_16x16x32_bf16 v[200:203], a[84:87], a[20:23], v[200:203]
    buffer_load_dwordx4 v37, s[8:11], s3 offen offset:1024  lds
    v_mfma_f32_16x16x32_bf16 v[204:207], a[84:87], a[28:31], 0
    ds_read_b128 a[108:111], v41 offset:49152
    v_perm_b32 v59, v76, v35, s36
    v_mfma_f32_16x16x32_bf16 v[204:207], a[80:83], a[24:27], v[204:207]
    ds_read_b32 a100, v59
    v_perm_b32 v60, v76, v35, s37
    v_mfma_f32_16x16x32_bf16 v[208:211], a[80:83], a[40:43], 0
    ds_read_b32 a101, v60
    ds_read_b128 a[112:115], v40 offset:51200
    v_mfma_f32_16x16x32_bf16 v[208:211], a[84:87], a[44:47], v[208:211]
    buffer_load_dwordx4 v38, s[8:11], s3 offen offset:2048  lds
    v_mfma_f32_16x16x32_bf16 v[212:215], a[84:87], a[52:55], 0
    ds_read_b128 a[116:119], v41 offset:51200
    v_perm_b32 v61, v76, v35, s38
    v_mfma_f32_16x16x32_bf16 v[212:215], a[80:83], a[48:51], v[212:215]
    ds_read_b32 a102, v61
    v_perm_b32 v62, v76, v35, s39
    v_mfma_f32_16x16x32_bf16 v[216:219], a[80:83], a[56:59], 0
    ds_read_b32 a103, v62
    v_perm_b32 v63, v73, v35, s36
    v_mfma_f32_16x16x32_bf16 v[216:219], a[84:87], a[60:63], v[216:219]
    ds_read_b32 a120, v63
    v_perm_b32 v5, v73, v35, s37
    v_mfma_f32_16x16x32_bf16 v[220:223], a[84:87], a[76:79], 0
    ds_read_b128 a[128:131], v40 offset:53248
    ds_read_b32 a121, v5
    v_mfma_f32_16x16x32_bf16 v[220:223], a[80:83], a[72:75], v[220:223]
    s_waitcnt lgkmcnt(9)
    ds_read_b128 a[132:135], v41 offset:53248
    v_mfma_f32_16x16x32_bf16 v[224:227], a[88:91], a[2:5], 0
    buffer_load_dwordx4 v39, s[8:11], s3 offen offset:3072  lds
    v_mfma_f32_16x16x32_bf16 v[228:231], a[88:91], a[10:13], 0
    s_add_u32 m0, s57, 0
    ds_read_b128 a[136:139], v40 offset:55296
    v_perm_b32 v6, v73, v35, s38
    v_mfma_f32_16x16x32_bf16 v[232:235], a[88:91], a[18:21], 0
    s_add_u32 s3, s69, 512
    ds_read_b128 a[140:143], v41 offset:55296
    v_perm_b32 v7, v73, v35, s39
    v_mfma_f32_16x16x32_bf16 v[236:239], a[88:91], a[26:29], 0
    s_mov_b32 s44, 81920
    ds_read_b32 a122, v6
    ds_read_b32 a123, v7
    v_mfma_f32_16x16x32_bf16 v[240:243], a[88:91], a[42:45], 0
    ds_read_b128 a[144:147], v40 offset:57344
    v_mfma_f32_16x16x32_bf16 v[244:247], a[88:91], a[50:53], 0
    buffer_load_dwordx3 v[96:98], v18, s[4:7], s61 offen nt
    v_mfma_f32_16x16x32_bf16 v[248:251], a[88:91], a[58:61], 0
    ds_read_b128 a[148:151], v41 offset:57344
    v_perm_b32 v27, v77, v35, s36
    v_mfma_f32_16x16x32_bf16 v[252:255], a[88:91], a[74:77], 0
    ds_read_b128 a[156:159], v41 offset:59392
    v_perm_b32 v29, v77, v35, s37
    v_mfma_f32_16x16x32_bf16 v[128:131], a[96:99], a[104:107], v[128:131]
    s_waitcnt lgkmcnt(7)
    ds_read_b128 a[152:155], v40 offset:59392
    ds_read_b32 a124, v27
    v_mfma_f32_16x16x32_bf16 v[128:131], a[100:103], a[108:111], v[128:131]
    buffer_load_dword v99, v19, s[4:7], s61 offen nt
    v_mfma_f32_16x16x32_bf16 v[132:135], a[100:103], a[116:119], v[132:135]
    s_add_u32 s61, s61, 14336
    ds_read_b128 a[160:163], v40 offset:61440
    v_perm_b32 v31, v77, v35, s38
    v_mfma_f32_16x16x32_bf16 v[132:135], a[96:99], a[112:115], v[132:135]
    s_waitcnt lgkmcnt(8)
    ds_read_b128 a[164:167], v41 offset:61440
    v_perm_b32 v46, v77, v35, s39
    v_mfma_f32_16x16x32_bf16 v[136:139], a[96:99], a[128:131], v[136:139]
    s_mov_b32 s45, 98304
    ds_read_b32 a125, v29
    ds_read_b32 a126, v31
    v_mfma_f32_16x16x32_bf16 v[136:139], a[100:103], a[132:135], v[136:139]
    buffer_load_dwordx3 v[100:102], v18, s[4:7], s61 offen nt
    v_mfma_f32_16x16x32_bf16 v[140:143], a[100:103], a[140:143], v[140:143]
    s_waitcnt vmcnt(13)
    ds_read_b128 a[168:171], v40 offset:63488
    v_bitop3_b32 v56, v83, v87, s76 bitop3:0x7e
    v_mfma_f32_16x16x32_bf16 v[140:143], a[96:99], a[136:139], v[140:143]
    s_waitcnt lgkmcnt(8)
    ds_read_b128 a[172:175], v41 offset:63488
    ds_read_b32 a127, v46
    v_mfma_f32_16x16x32_bf16 v[144:147], a[96:99], a[144:147], v[144:147]
    s_waitcnt lgkmcnt(8)
    v_perm_b32 v57, v74, v35, s36
    v_mfma_f32_16x16x32_bf16 v[144:147], a[100:103], a[148:151], v[144:147]
    buffer_load_dword v103, v19, s[4:7], s61 offen nt
    v_mfma_f32_16x16x32_bf16 v[148:151], a[100:103], a[156:159], v[148:151]
    s_add_u32 s61, s61, 14336
    ds_read_b32 a176, v57
    v_perm_b32 v58, v74, v35, s37
    v_mfma_f32_16x16x32_bf16 v[148:151], a[96:99], a[152:155], v[148:151]
    s_waitcnt lgkmcnt(7)
    v_cmp_lt_u32 vcc, 0xffff, v56
    v_perm_b32 v59, v74, v35, s38
    v_mfma_f32_16x16x32_bf16 v[152:155], a[96:99], a[160:163], v[152:155]
    s_waitcnt lgkmcnt(6)
    ds_read_b32 a177, v58
    ds_read_b32 a178, v59
    v_mfma_f32_16x16x32_bf16 v[152:155], a[100:103], a[164:167], v[152:155]
    s_waitcnt lgkmcnt(4)
    buffer_load_dwordx3 v[104:106], v18, s[4:7], s61 offen nt
    v_mfma_f32_16x16x32_bf16 v[156:159], a[100:103], a[172:175], v[156:159]
    v_perm_b32 v60, v74, v35, s39
    s_cbranch_vccnz L_slow1_0
L_back1_0:
    v_mfma_f32_16x16x32_bf16 v[156:159], a[96:99], a[168:171], v[156:159]
    s_waitcnt lgkmcnt(3)
    v_perm_b32 v61, v78, v35, s36
    v_perm_b32 v62, v78, v35, s37
    v_mfma_f32_16x16x32_bf16 v[160:163], a[120:123], a[104:107], v[160:163]
    s_mov_b32 s72, 114688
    ds_read_b32 a179, v60
    ds_read_b32 a180, v61
    v_mfma_f32_16x16x32_bf16 v[160:163], a[124:127], a[108:111], v[160:163]
    buffer_load_dword v107, v19, s[4:7], s61 offen nt
    v_mfma_f32_16x16x32_bf16 v[164:167], a[124:127], a[116:119], v[164:167]
    s_add_u32 s61, s61, 14336
    ds_read_b32 a181, v62
    v_perm_b32 v63, v78, v35, s38
    v_mfma_f32_16x16x32_bf16 v[164:167], a[120:123], a[112:115], v[164:167]
    v_perm_b32 v5, v78, v35, s39
    v_perm_b32 v6, v75, v35, s36
    v_mfma_f32_16x16x32_bf16 v[168:171], a[120:123], a[128:131], v[168:171]
    ds_read_b32 a182, v63
    ds_read_b32 a183, v5
    v_mfma_f32_16x16x32_bf16 v[168:171], a[124:127], a[132:135], v[168:171]
    buffer_load_dwordx3 v[108:110], v18, s[4:7], s61 offen nt
    v_mfma_f32_16x16x32_bf16 v[172:175], a[124:127], a[140:143], v[172:175]
    ds_read_b32 a92, v6
    v_perm_b32 v7, v75, v35, s37
    v_mfma_f32_16x16x32_bf16 v[172:175], a[120:123], a[136:139], v[172:175]
    v_perm_b32 v27, v79, v35, s36
    v_perm_b32 v29, v79, v35, s37
    v_mfma_f32_16x16x32_bf16 v[176:179], a[120:123], a[144:147], v[176:179]
    ds_read_b32 a93, v7
    ds_read_b32 a94, v27
    v_mfma_f32_16x16x32_bf16 v[176:179], a[124:127], a[148:151], v[176:179]
    buffer_load_dword v111, v19, s[4:7], s61 offen nt
    v_mfma_f32_16x16x32_bf16 v[180:183], a[124:127], a[156:159], v[180:183]
    s_add_u32 s61, s61, 14336
    ds_read_b32 a95, v29
    v_perm_b32 v31, v80, v35, s36
    v_mfma_f32_16x16x32_bf16 v[180:183], a[120:123], a[152:155], v[180:183]
    v_perm_b32 v46, v80, v35, s37
    v_perm_b32 v57, v80, v35, s38
    v_mfma_f32_16x16x32_bf16 v[184:187], a[120:123], a[160:163], v[184:187]
    ds_read_b32 a184, v31
    ds_read_b32 a185, v46
    v_mfma_f32_16x16x32_bf16 v[184:187], a[124:127], a[164:167], v[184:187]
    buffer_load_dwordx3 v[112:114], v18, s[4:7], s61 offen nt
    v_mfma_f32_16x16x32_bf16 v[188:191], a[124:127], a[172:175], v[188:191]
    s_add_u32 s61, s61, 14336
    ds_read_b32 a186, v57
    v_perm_b32 v56, v80, v35, s39
    v_mfma_f32_16x16x32_bf16 v[188:191], a[120:123], a[168:171], v[188:191]
    s_waitcnt vmcnt(15) lgkmcnt(6)
    v_perm_b32 v58, v84, v35, s36
    v_perm_b32 v59, v84, v35, s37
    v_mfma_f32_16x16x32_bf16 v[192:195], a[176:179], a[104:107], v[192:195]
    s_barrier
    v_mfma_f32_16x16x32_bf16 v[192:195], a[180:183], a[108:111], v[192:195]
    buffer_load_dwordx3 v[116:118], v18, s[4:7], s61 offen nt
    v_mfma_f32_16x16x32_bf16 v[196:199], a[180:183], a[116:119], v[196:199]
    s_mul_i32 s66, s63, 96
    s_lshl_b32 s67, s65, 5
    s_lshl_b32 s70, s64, 2
    s_add_u32 s67, s67, s70
    s_add_u32 s67, s67, 384
    s_mul_i32 s71, s59, 448
    s_add_u32 s70, s66, s71
    v_mad_u32_u24 v22, v3, 24, s70
    s_add_u32 s70, s67, s71
    v_lshl_add_u32 v23, v3, 3, s70
    s_mov_b32 s34, 7168
    s_mov_b32 s35, 0x20000
    s_mov_b32 s26, 256
    s_mov_b32 s27, 0x20000
    s_lshl_b32 s77, s59, 4
    s_mov_b32 s18, 14680064
    s_mov_b32 s19, 0x20000
    s_sub_u32 s70, 1024, s71
    v_mul_u32_u24 v16, 464, v4
    v_add3_u32 v26, v22, v16, s70
    v_add3_u32 v28, v23, v16, s70
    s_lshl_b32 s70, s63, 9
    s_add_u32 s60, s70, 52992
    s_xor_b32 s70, s70, 512
    s_add_u32 s70, s70, 52992
    v_lshl_add_u32 v30, v2, 2, s70
    v_mul_u32_u24 v16, 2341, v2
    v_lshrrev_b32 v16, 16, v16
    s_mul_i32 s73, s63, 1856
    s_add_u32 s73, s73, 1024
    v_add_lshl_u32 v24, v2, v16, 4
    v_add_u32 v24, s73, v24
    s_lshl_b32 s74, s58, 7
    s_lshl_b32 s75, s63, 2
    s_add_u32 s74, s74, s75
    s_mul_i32 s74, s74, 7168
    s_add_u32 s74, s74, s71
    v_mul_u32_u24 v17, 6720, v16
    v_lshl_add_u32 v25, v2, 4, v17
    v_lshrrev_b32 v16, 1, v16
    v_lshlrev_b32 v16, 30, v16
    v_add3_u32 v25, v25, v16, s74
    v_mov_b32 v45, 1
    v_lshlrev_b32 v1, 22, v0
    v_mov_b32 v47, s76
    v_mfma_f32_16x16x32_bf16 v[196:199], a[176:179], a[112:115], v[196:199]
    s_add_u32 s61, s61, 14336
    ds_read_b32 a187, v56
    ds_read_b32 a188, v58
    v_mfma_f32_16x16x32_bf16 v[200:203], a[176:179], a[128:131], v[200:203]
    ds_read_b32 a189, v59
    ds_read_b128 a[192:195], v42 offset:0
    v_mfma_f32_16x16x32_bf16 v[200:203], a[180:183], a[132:135], v[200:203]
    buffer_load_dwordx3 v[120:122], v18, s[4:7], s61 offen nt
    v_mfma_f32_16x16x32_bf16 v[204:207], a[180:183], a[140:143], v[204:207]
    s_add_u32 s61, s61, 14336
    ds_read_b128 a[196:199], v43 offset:0
    v_perm_b32 v60, v84, v35, s38
    v_mfma_f32_16x16x32_bf16 v[204:207], a[176:179], a[136:139], v[204:207]
    ds_read_b32 a190, v60
    ds_read_b128 a[204:207], v43 offset:2048
    v_perm_b32 v61, v84, v35, s39
    v_mfma_f32_16x16x32_bf16 v[208:211], a[176:179], a[144:147], v[208:211]
    ds_read_b32 a191, v61
    ds_read_b128 a[200:203], v42 offset:2048
    v_mfma_f32_16x16x32_bf16 v[208:211], a[180:183], a[148:151], v[208:211]
    buffer_load_dwordx3 v[124:126], v18, s[4:7], s61 offen nt
    v_mfma_f32_16x16x32_bf16 v[212:215], a[180:183], a[156:159], v[212:215]
    ds_read_b128 a[208:211], v42 offset:4096
    v_perm_b32 v62, v81, v35, s36
    v_mfma_f32_16x16x32_bf16 v[212:215], a[176:179], a[152:155], v[212:215]
    ds_read_b128 a[212:215], v43 offset:4096
    ds_read_b32 a216, v62
    v_mfma_f32_16x16x32_bf16 v[216:219], a[176:179], a[160:163], v[216:219]
    ds_read_b128 a[228:231], v43 offset:6144
    v_perm_b32 v63, v81, v35, s37
    v_mfma_f32_16x16x32_bf16 v[216:219], a[180:183], a[164:167], v[216:219]
    ds_read_b128 a[224:227], v42 offset:6144
    ds_read_b32 a217, v63
    v_mfma_f32_16x16x32_bf16 v[220:223], a[180:183], a[172:175], v[220:223]
    buffer_load_dwordx4 v[48:51], v32, s[12:15], s41 offen sc1
    v_mfma_f32_16x16x32_bf16 v[220:223], a[176:179], a[168:171], v[220:223]
    s_waitcnt lgkmcnt(10)
    ds_read_b128 a[232:235], v42 offset:8192
    v_perm_b32 v5, v81, v35, s38
    v_mfma_f32_16x16x32_bf16 v[224:227], a[92:95], a[106:109], v[224:227]
    ds_read_b128 a[236:239], v43 offset:8192
    ds_read_b32 a218, v5
    v_mfma_f32_16x16x32_bf16 v[228:231], a[92:95], a[114:117], v[228:231]
    ds_read_b128 a[244:247], v43 offset:10240
    v_perm_b32 v6, v81, v35, s39
    v_mfma_f32_16x16x32_bf16 v[232:235], a[92:95], a[130:133], v[232:235]
    ds_read_b128 a[240:243], v42 offset:10240
    ds_read_b32 a219, v6
    v_mfma_f32_16x16x32_bf16 v[236:239], a[92:95], a[138:141], v[236:239]
    buffer_load_dwordx4 v[52:55], v33, s[12:15], s41 offen sc1
    v_mfma_f32_16x16x32_bf16 v[240:243], a[92:95], a[146:149], v[240:243]
    ds_read_b128 a[248:251], v42 offset:12288
    v_perm_b32 v7, v85, v35, s36
    v_mfma_f32_16x16x32_bf16 v[244:247], a[92:95], a[154:157], v[244:247]
    ds_read_b128 a[252:255], v43 offset:12288
    ds_read_b32 a220, v7
    v_mfma_f32_16x16x32_bf16 v[248:251], a[92:95], a[162:165], v[248:251]
    v_perm_b32 v27, v85, v35, s37
    v_perm_b32 v29, v85, v35, s38
    v_mfma_f32_16x16x32_bf16 v[252:255], a[92:95], a[170:173], v[252:255]
    s_waitcnt vmcnt(18) lgkmcnt(9)
    ds_read_b32 a221, v27
    ds_read_b32 a222, v29
    v_mfma_f32_16x16x32_bf16 v[128:131], a[184:187], a[192:195], v[128:131]
    buffer_load_dwordx4 v36, s[8:11], s56 offen offset:0  lds
    v_mfma_f32_16x16x32_bf16 v[128:131], a[188:191], a[196:199], v[128:131]
    ds_read_b128 a[32:35], v42 offset:14336
    v_perm_b32 v46, v85, v35, s39
    v_bitop3_b32 v31, v91, v95, s76 bitop3:0x7e
    v_mfma_f32_16x16x32_bf16 v[132:135], a[188:191], a[204:207], v[132:135]
    ds_read_b128 a[36:39], v43 offset:14336
    v_perm_b32 v57, v82, v35, s36
    v_cmp_lt_u32 vcc, 0xffff, v31
    v_mfma_f32_16x16x32_bf16 v[132:135], a[184:187], a[200:203], v[132:135]
    s_waitcnt vmcnt(11)
    ds_read_b32 a223, v46
    v_perm_b32 v56, v82, v35, s37
    v_mfma_f32_16x16x32_bf16 v[136:139], a[184:187], a[208:211], v[136:139]
    v_or_b32 v99, s47, v99
    v_lshl_or_b32 v96, v100, 4, v96
    v_lshl_or_b32 v97, v101, 4, v97
    v_lshl_or_b32 v98, v102, 4, v98
    v_lshl_or_b32 v99, v103, 4, v99
    v_mfma_f32_16x16x32_bf16 v[136:139], a[188:191], a[212:215], v[136:139]
    buffer_load_dwordx4 v37, s[8:11], s56 offen offset:1024  lds
    v_mfma_f32_16x16x32_bf16 v[140:143], a[188:191], a[228:231], v[140:143]
    ds_read_b32 a64, v57
    s_cbranch_vccnz L_slow1_1
L_back1_1:
    v_mfma_f32_16x16x32_bf16 v[140:143], a[184:187], a[224:227], v[140:143]
    s_waitcnt lgkmcnt(6)
    v_perm_b32 v58, v82, v35, s38
    v_perm_b32 v59, v82, v35, s39
    v_mfma_f32_16x16x32_bf16 v[144:147], a[184:187], a[232:235], v[144:147]
    ds_read_b32 a65, v56
    v_perm_b32 v60, v86, v35, s36
    v_mfma_f32_16x16x32_bf16 v[144:147], a[188:191], a[236:239], v[144:147]
    ds_read_b32 a66, v58
    v_perm_b32 v61, v86, v35, s37
    v_mfma_f32_16x16x32_bf16 v[148:151], a[188:191], a[244:247], v[148:151]
    ds_read_b32 a67, v59
    v_perm_b32 v62, v86, v35, s38
    v_mfma_f32_16x16x32_bf16 v[148:151], a[184:187], a[240:243], v[148:151]
    ds_read_b32 a68, v60
    ds_read_b32 a69, v61
    v_mfma_f32_16x16x32_bf16 v[152:155], a[184:187], a[248:251], v[152:155]
    buffer_load_dwordx4 v38, s[8:11], s56 offen offset:2048  lds
    v_mfma_f32_16x16x32_bf16 v[152:155], a[188:191], a[252:255], v[152:155]
    s_waitcnt lgkmcnt(6)
    ds_read_b32 a70, v62
    v_perm_b32 v63, v86, v35, s39
    v_mfma_f32_16x16x32_bf16 v[156:159], a[188:191], a[36:39], v[156:159]
    v_perm_b32 v5, v83, v35, s36
    v_perm_b32 v6, v83, v35, s37
    v_mfma_f32_16x16x32_bf16 v[156:159], a[184:187], a[32:35], v[156:159]
    ds_read_b32 a71, v63
    ds_read_b32 a80, v5
    v_mfma_f32_16x16x32_bf16 v[160:163], a[216:219], a[192:195], v[160:163]
    buffer_load_dwordx4 v39, s[8:11], s56 offen offset:3072  lds
    v_mfma_f32_16x16x32_bf16 v[160:163], a[220:223], a[196:199], v[160:163]
    s_add_u32 m0, s57, 16384
    ds_read_b32 a81, v6
    v_perm_b32 v7, v87, v35, s36
    v_mfma_f32_16x16x32_bf16 v[164:167], a[220:223], a[204:207], v[164:167]
    s_add_u32 s56, s55, 768
    v_perm_b32 v27, v87, v35, s37
    v_perm_b32 v29, v88, v35, s36
    v_mfma_f32_16x16x32_bf16 v[164:167], a[216:219], a[200:203], v[164:167]
    ds_read_b32 a82, v7
    v_perm_b32 v31, v88, v35, s37
    v_mfma_f32_16x16x32_bf16 v[168:171], a[216:219], a[208:211], v[168:171]
    ds_read_b32 a83, v27
    v_perm_b32 v46, v88, v35, s38
    v_mfma_f32_16x16x32_bf16 v[168:171], a[220:223], a[212:215], v[168:171]
    ds_read_b32 a0, v29
    v_perm_b32 v57, v88, v35, s39
    v_mfma_f32_16x16x32_bf16 v[172:175], a[220:223], a[228:231], v[172:175]
    ds_read_b32 a1, v31
    v_perm_b32 v56, v92, v35, s36
    v_mfma_f32_16x16x32_bf16 v[172:175], a[216:219], a[224:227], v[172:175]
    ds_read_b32 a2, v46
    v_perm_b32 v58, v92, v35, s37
    v_mfma_f32_16x16x32_bf16 v[176:179], a[216:219], a[232:235], v[176:179]
    ds_read_b32 a3, v57
    v_perm_b32 v59, v92, v35, s38
    v_mfma_f32_16x16x32_bf16 v[176:179], a[220:223], a[236:239], v[176:179]
    ds_read_b32 a4, v56
    v_perm_b32 v60, v92, v35, s39
    v_mfma_f32_16x16x32_bf16 v[180:183], a[220:223], a[244:247], v[180:183]
    ds_read_b32 a5, v58
    v_perm_b32 v61, v89, v35, s36
    v_mfma_f32_16x16x32_bf16 v[180:183], a[216:219], a[240:243], v[180:183]
    ds_read_b32 a6, v59
    ds_read_b32 a7, v60
    v_mfma_f32_16x16x32_bf16 v[184:187], a[216:219], a[248:251], v[184:187]
    buffer_load_dwordx4 v[64:67], v34, s[12:15], s41 offen sc1
    v_mfma_f32_16x16x32_bf16 v[184:187], a[220:223], a[252:255], v[184:187]
    ds_read_b32 a8, v61
    v_perm_b32 v62, v89, v35, s37
    v_mfma_f32_16x16x32_bf16 v[188:191], a[220:223], a[36:39], v[188:191]
    v_perm_b32 v63, v89, v35, s38
    v_perm_b32 v5, v89, v35, s39
    v_mfma_f32_16x16x32_bf16 v[188:191], a[216:219], a[32:35], v[188:191]
    s_waitcnt lgkmcnt(7)
    ds_read_b32 a9, v62
    ds_read_b32 a10, v63
    v_mfma_f32_16x16x32_bf16 v[192:195], a[64:67], a[192:195], v[192:195]
    buffer_load_dwordx4 v[68:71], v44, s[12:15], s41 offen sc1
    v_mfma_f32_16x16x32_bf16 v[192:195], a[68:71], a[196:199], v[192:195]
    s_barrier
    v_mfma_f32_16x16x32_bf16 v[196:199], a[68:71], a[204:207], v[196:199]
    ds_read_b32 a11, v5
    v_perm_b32 v6, v93, v35, s36
    v_mfma_f32_16x16x32_bf16 v[196:199], a[64:67], a[200:203], v[196:199]
    ds_read_b32 a12, v6
    ds_read_b128 a[16:19], v42 offset:16384
    v_mfma_f32_16x16x32_bf16 v[200:203], a[64:67], a[208:211], v[200:203]
    buffer_load_dwordx4 v[72:75], v32, s[12:15], s42 offen sc1
    v_mfma_f32_16x16x32_bf16 v[200:203], a[68:71], a[212:215], v[200:203]
    ds_read_b128 a[20:23], v43 offset:16384
    v_perm_b32 v7, v93, v35, s37
    v_mfma_f32_16x16x32_bf16 v[204:207], a[68:71], a[228:231], v[204:207]
    ds_read_b32 a13, v7
    v_perm_b32 v27, v93, v35, s38
    v_mfma_f32_16x16x32_bf16 v[204:207], a[64:67], a[224:227], v[204:207]
    ds_read_b32 a14, v27
    ds_read_b128 a[24:27], v42 offset:18432
    v_mfma_f32_16x16x32_bf16 v[208:211], a[64:67], a[232:235], v[208:211]
    buffer_load_dwordx4 v[76:79], v33, s[12:15], s42 offen sc1
    v_mfma_f32_16x16x32_bf16 v[208:211], a[68:71], a[236:239], v[208:211]
    ds_read_b128 a[28:31], v43 offset:18432
    v_perm_b32 v29, v93, v35, s39
    v_mfma_f32_16x16x32_bf16 v[212:215], a[68:71], a[244:247], v[212:215]
    ds_read_b32 a15, v29
    v_perm_b32 v31, v90, v35, s36
    v_mfma_f32_16x16x32_bf16 v[212:215], a[64:67], a[240:243], v[212:215]
    ds_read_b32 a48, v31
    ds_read_b128 a[40:43], v42 offset:20480
    v_mfma_f32_16x16x32_bf16 v[216:219], a[64:67], a[248:251], v[216:219]
    buffer_load_dwordx4 v36, s[8:11], s3 offen offset:0  lds
    v_mfma_f32_16x16x32_bf16 v[216:219], a[68:71], a[252:255], v[216:219]
    ds_read_b128 a[44:47], v43 offset:20480
    v_perm_b32 v46, v90, v35, s37
    v_mfma_f32_16x16x32_bf16 v[220:223], a[68:71], a[36:39], v[220:223]
    s_waitcnt vmcnt(16)
    ds_read_b32 a49, v46
    v_perm_b32 v57, v90, v35, s38
    v_mfma_f32_16x16x32_bf16 v[220:223], a[64:67], a[32:35], v[220:223]
    v_lshl_or_b32 v96, v104, 8, v96
    v_lshl_or_b32 v97, v105, 8, v97
    v_lshl_or_b32 v98, v106, 8, v98
    v_lshl_or_b32 v99, v107, 8, v99
    v_lshl_or_b32 v96, v108, 12, v96
    v_lshl_or_b32 v97, v109, 12, v97
    v_lshl_or_b32 v98, v110, 12, v98
    s_waitcnt vmcnt(15)
    v_lshl_or_b32 v99, v111, 12, v99
    s_waitcnt vmcnt(14)
    v_lshl_or_b32 v96, v112, 16, v96
    v_lshl_or_b32 v97, v113, 16, v97
    v_lshl_or_b32 v98, v114, 16, v98
    s_waitcnt vmcnt(13)
    v_lshl_or_b32 v96, v116, 20, v96
    v_lshl_or_b32 v97, v117, 20, v97
    v_lshl_or_b32 v98, v118, 20, v98
    s_waitcnt vmcnt(12)
L_pad1:
    s_cbranch_execz L_pad2
    v_lshl_or_b32 v96, v120, 24, v96
    v_lshl_or_b32 v97, v121, 24, v97
    v_lshl_or_b32 v98, v122, 24, v98
    s_waitcnt vmcnt(11)
    v_lshl_or_b32 v96, v124, 28, v96
    v_lshl_or_b32 v97, v125, 28, v97
    v_lshl_or_b32 v98, v126, 28, v98
    buffer_store_dwordx4 v[96:99], v20, s[12:15], s62 offen sc1
    v_mfma_f32_16x16x32_bf16 v[224:227], a[80:83], a[194:197], v[224:227]
    buffer_load_dwordx4 v37, s[8:11], s3 offen offset:1024  lds
    v_mfma_f32_16x16x32_bf16 v[228:231], a[80:83], a[202:205], v[228:231]
    ds_read_b32 a50, v57
    v_perm_b32 v56, v90, v35, s39
    v_mfma_f32_16x16x32_bf16 v[232:235], a[80:83], a[210:213], v[232:235]
    s_waitcnt vmcnt(11)
    ds_read_b128 a[60:63], v43 offset:22528
    ds_read_b32 a51, v56
    v_mfma_f32_16x16x32_bf16 v[236:239], a[80:83], a[226:229], v[236:239]
    ds_read_b128 a[56:59], v42 offset:22528
    v_perm_b32 v59, v94, v35, s36
    v_bitop3_b32 v58, v51, v55, s76 bitop3:0x7e
    v_mfma_f32_16x16x32_bf16 v[240:243], a[80:83], a[234:237], v[240:243]
    ds_read_b128 a[72:75], v42 offset:24576
    ds_read_b32 a52, v59
    v_cmp_lt_u32 vcc, 0xffff, v58
    v_mfma_f32_16x16x32_bf16 v[244:247], a[80:83], a[242:245], v[244:247]
    ds_read_b128 a[76:79], v43 offset:24576
    v_perm_b32 v60, v94, v35, s37
    v_mfma_f32_16x16x32_bf16 v[248:251], a[80:83], a[250:253], v[248:251]
    ds_read_b32 a53, v60
    v_perm_b32 v61, v94, v35, s38
    v_mfma_f32_16x16x32_bf16 v[252:255], a[80:83], a[34:37], v[252:255]
    s_waitcnt lgkmcnt(8)
    ds_read_b128 a[100:103], v43 offset:26624
    ds_read_b32 a54, v61
    v_mfma_f32_16x16x32_bf16 v[128:131], a[0:3], a[16:19], v[128:131]
    buffer_load_dwordx4 v38, s[8:11], s3 offen offset:2048  lds
    v_mfma_f32_16x16x32_bf16 v[128:131], a[4:7], a[20:23], v[128:131]
    ds_read_b128 a[96:99], v42 offset:26624
    s_cbranch_vccnz L_slow2_0
L_back2_0:
    v_mfma_f32_16x16x32_bf16 v[132:135], a[4:7], a[28:31], v[132:135]
    ds_read_b128 a[120:123], v42 offset:28672
    v_perm_b32 v62, v94, v35, s39
    v_mfma_f32_16x16x32_bf16 v[132:135], a[0:3], a[24:27], v[132:135]
    s_waitcnt lgkmcnt(8)
    ds_read_b128 a[124:127], v43 offset:28672
    ds_read_b32 a55, v62
    v_mfma_f32_16x16x32_bf16 v[136:139], a[0:3], a[40:43], v[136:139]
    buffer_load_dwordx4 v39, s[8:11], s3 offen offset:3072  lds
    v_mfma_f32_16x16x32_bf16 v[136:139], a[4:7], a[44:47], v[136:139]
    s_add_u32 m0, s57, 32768
    ds_read_b128 a[176:179], v42 offset:30720
    v_perm_b32 v63, v91, v35, s36
    v_mfma_f32_16x16x32_bf16 v[140:143], a[4:7], a[60:63], v[140:143]
    s_add_u32 s3, s69, 768
    v_perm_b32 v5, v91, v35, s37
    v_perm_b32 v6, v95, v35, s36
    v_mfma_f32_16x16x32_bf16 v[140:143], a[0:3], a[56:59], v[140:143]
    s_waitcnt lgkmcnt(7)
    ds_read_b128 a[180:183], v43 offset:30720
    ds_read_b32 a84, v63
    v_mfma_f32_16x16x32_bf16 v[144:147], a[0:3], a[72:75], v[144:147]
    buffer_load_dwordx4 v36, s[8:11], s56 offen offset:0  lds
    v_mfma_f32_16x16x32_bf16 v[144:147], a[4:7], a[76:79], v[144:147]
    s_waitcnt lgkmcnt(7)
    ds_read_b32 a85, v5
    v_perm_b32 v7, v95, v35, s37
    v_mfma_f32_16x16x32_bf16 v[148:151], a[4:7], a[100:103], v[148:151]
    s_waitcnt lgkmcnt(7)
    ds_read_b32 a86, v6
    v_perm_b32 v27, v48, v35, s36
    v_mfma_f32_16x16x32_bf16 v[148:151], a[0:3], a[96:99], v[148:151]
    s_waitcnt lgkmcnt(6)
    ds_read_b32 a87, v7
    ds_read_b32 a104, v27
    v_mfma_f32_16x16x32_bf16 v[152:155], a[0:3], a[120:123], v[152:155]
    buffer_load_dwordx4 v37, s[8:11], s56 offen offset:1024  lds
    v_mfma_f32_16x16x32_bf16 v[152:155], a[4:7], a[124:127], v[152:155]
    s_waitcnt lgkmcnt(5)
    v_perm_b32 v29, v48, v35, s37
    v_perm_b32 v31, v48, v35, s38
    v_mfma_f32_16x16x32_bf16 v[156:159], a[4:7], a[180:183], v[156:159]
    ds_read_b32 a105, v29
    v_perm_b32 v46, v48, v35, s39
    v_mfma_f32_16x16x32_bf16 v[156:159], a[0:3], a[176:179], v[156:159]
    ds_read_b32 a106, v31
    ds_read_b32 a107, v46
    v_mfma_f32_16x16x32_bf16 v[160:163], a[8:11], a[16:19], v[160:163]
    buffer_load_dwordx4 v38, s[8:11], s56 offen offset:2048  lds
    v_mfma_f32_16x16x32_bf16 v[160:163], a[12:15], a[20:23], v[160:163]
    v_perm_b32 v57, v52, v35, s36
    v_perm_b32 v56, v52, v35, s37
    v_mfma_f32_16x16x32_bf16 v[164:167], a[12:15], a[28:31], v[164:167]
    s_waitcnt vmcnt(12)
    ds_read_b32 a108, v57
    v_perm_b32 v58, v52, v35, s38
    v_mfma_f32_16x16x32_bf16 v[164:167], a[8:11], a[24:27], v[164:167]
    s_barrier
    v_mfma_f32_16x16x32_bf16 v[168:171], a[8:11], a[40:43], v[168:171]
    buffer_load_dwordx4 v39, s[8:11], s56 offen offset:3072  lds
    v_mfma_f32_16x16x32_bf16 v[168:171], a[12:15], a[44:47], v[168:171]
    s_add_u32 m0, s57, 49152
    ds_read_b32 a109, v56
    v_perm_b32 v59, v52, v35, s39
    v_mfma_f32_16x16x32_bf16 v[172:175], a[12:15], a[60:63], v[172:175]
    s_add_u32 s56, s55, 1024
    ds_read_b128 a[112:115], v40 offset:0
    ds_read_b32 a110, v58
    v_mfma_f32_16x16x32_bf16 v[172:175], a[8:11], a[56:59], v[172:175]
    ds_read_b128 a[116:119], v41 offset:0
    v_perm_b32 v60, v49, v35, s36
    v_mfma_f32_16x16x32_bf16 v[176:179], a[8:11], a[72:75], v[176:179]
    ds_read_b32 a111, v59
    ds_read_b128 a[132:135], v41 offset:2048
    v_mfma_f32_16x16x32_bf16 v[176:179], a[12:15], a[76:79], v[176:179]
    ds_read_b128 a[128:131], v40 offset:2048
    ds_read_b32 a136, v60
    v_mfma_f32_16x16x32_bf16 v[180:183], a[12:15], a[100:103], v[180:183]
    buffer_load_dwordx4 v36, s[8:11], s3 offen offset:0  lds
    v_mfma_f32_16x16x32_bf16 v[180:183], a[8:11], a[96:99], v[180:183]
    ds_read_b128 a[144:147], v40 offset:4096
    v_perm_b32 v61, v49, v35, s37
    v_mfma_f32_16x16x32_bf16 v[184:187], a[8:11], a[120:123], v[184:187]
    v_perm_b32 v62, v49, v35, s38
    v_perm_b32 v63, v49, v35, s39
    v_mfma_f32_16x16x32_bf16 v[184:187], a[12:15], a[124:127], v[184:187]
    s_waitcnt vmcnt(12)
    ds_read_b128 a[148:151], v41 offset:4096
    v_bitop3_b32 v5, v67, v71, s76 bitop3:0x7e
    v_mfma_f32_16x16x32_bf16 v[188:191], a[12:15], a[180:183], v[188:191]
    ds_read_b32 a137, v61
    v_cmp_lt_u32 vcc, 0xffff, v5
    v_mfma_f32_16x16x32_bf16 v[188:191], a[8:11], a[176:179], v[188:191]
    ds_read_b32 a138, v62
    v_perm_b32 v6, v53, v35, s36
    v_mfma_f32_16x16x32_bf16 v[192:195], a[48:51], a[16:19], v[192:195]
    ds_read_b128 a[152:155], v40 offset:6144
    ds_read_b32 a139, v63
    v_mfma_f32_16x16x32_bf16 v[192:195], a[52:55], a[20:23], v[192:195]
    buffer_load_dwordx4 v37, s[8:11], s3 offen offset:1024  lds
    v_mfma_f32_16x16x32_bf16 v[196:199], a[52:55], a[28:31], v[196:199]
    ds_read_b32 a140, v6
    s_cbranch_vccnz L_slow2_1
L_back2_1:
    v_mfma_f32_16x16x32_bf16 v[196:199], a[48:51], a[24:27], v[196:199]
    ds_read_b128 a[156:159], v41 offset:6144
    v_perm_b32 v7, v53, v35, s37
    v_mfma_f32_16x16x32_bf16 v[200:203], a[48:51], a[40:43], v[200:203]
    ds_read_b32 a141, v7
    v_perm_b32 v27, v53, v35, s38
    v_mfma_f32_16x16x32_bf16 v[200:203], a[52:55], a[44:47], v[200:203]
    ds_read_b32 a142, v27
    v_perm_b32 v29, v53, v35, s39
    v_mfma_f32_16x16x32_bf16 v[204:207], a[52:55], a[60:63], v[204:207]
    ds_read_b128 a[160:163], v40 offset:8192
    v_perm_b32 v31, v50, v35, s36
    v_mfma_f32_16x16x32_bf16 v[204:207], a[48:51], a[56:59], v[204:207]
    ds_read_b32 a143, v29
    v_perm_b32 v46, v50, v35, s37
    v_mfma_f32_16x16x32_bf16 v[208:211], a[48:51], a[72:75], v[208:211]
    ds_read_b32 a88, v31
    ds_read_b32 a89, v46
    v_mfma_f32_16x16x32_bf16 v[208:211], a[52:55], a[76:79], v[208:211]
    buffer_load_dwordx4 v38, s[8:11], s3 offen offset:2048  lds
    v_mfma_f32_16x16x32_bf16 v[212:215], a[52:55], a[100:103], v[212:215]
    ds_read_b128 a[164:167], v41 offset:8192
    v_perm_b32 v57, v50, v35, s38
    v_mfma_f32_16x16x32_bf16 v[212:215], a[48:51], a[96:99], v[212:215]
    v_perm_b32 v56, v50, v35, s39
    v_perm_b32 v58, v54, v35, s36
    v_mfma_f32_16x16x32_bf16 v[216:219], a[48:51], a[120:123], v[216:219]
    ds_read_b128 a[168:171], v40 offset:10240
    v_perm_b32 v59, v54, v35, s37
    v_mfma_f32_16x16x32_bf16 v[216:219], a[52:55], a[124:127], v[216:219]
    v_perm_b32 v60, v54, v35, s38
    v_perm_b32 v61, v54, v35, s39
    v_mfma_f32_16x16x32_bf16 v[220:223], a[52:55], a[180:183], v[220:223]
    ds_read_b32 a90, v57
    v_perm_b32 v5, v51, v35, s36
    v_mfma_f32_16x16x32_bf16 v[220:223], a[48:51], a[176:179], v[220:223]
    s_waitcnt lgkmcnt(6)
    ds_read_b128 a[172:175], v41 offset:10240
    ds_read_b32 a91, v56
    v_mfma_f32_16x16x32_bf16 v[224:227], a[84:87], a[18:21], v[224:227]
    buffer_load_dwordx4 v39, s[8:11], s3 offen offset:3072  lds
    v_mfma_f32_16x16x32_bf16 v[228:231], a[84:87], a[26:29], v[228:231]
    s_add_u32 m0, s57, 65536
    ds_read_b32 a92, v58
    v_perm_b32 v62, v51, v35, s37
    v_mfma_f32_16x16x32_bf16 v[232:235], a[84:87], a[42:45], v[232:235]
    s_add_u32 s3, s69, 1024
    ds_read_b128 a[184:187], v40 offset:12288
    ds_read_b32 a93, v59
    v_mfma_f32_16x16x32_bf16 v[236:239], a[84:87], a[58:61], v[236:239]
    ds_read_b32 a94, v60
    v_perm_b32 v63, v55, v35, s36
    v_mfma_f32_16x16x32_bf16 v[240:243], a[84:87], a[74:77], v[240:243]
    ds_read_b32 a95, v61
    ds_read_b32 a216, v5
    v_mfma_f32_16x16x32_bf16 v[244:247], a[84:87], a[98:101], v[244:247]
    buffer_load_dwordx4 v[100:103], v34, s[12:15], s42 offen sc1
    v_mfma_f32_16x16x32_bf16 v[248:251], a[84:87], a[122:125], v[248:251]
    ds_read_b128 a[188:191], v41 offset:12288
    v_perm_b32 v6, v55, v35, s37
    v_mfma_f32_16x16x32_bf16 v[252:255], a[84:87], a[178:181], v[252:255]
    v_perm_b32 v7, v64, v35, s36
    v_perm_b32 v27, v64, v35, s37
    v_mfma_f32_16x16x32_bf16 v[128:131], a[104:107], a[112:115], v[128:131]
    ds_read_b128 a[64:67], v40 offset:14336
    ds_read_b32 a217, v62
    v_mfma_f32_16x16x32_bf16 v[128:131], a[108:111], a[116:119], v[128:131]
    buffer_load_dwordx4 v[80:83], v44, s[12:15], s42 offen sc1
    v_mfma_f32_16x16x32_bf16 v[132:135], a[108:111], a[132:135], v[132:135]
    ds_read_b128 a[68:71], v41 offset:14336
    v_perm_b32 v29, v64, v35, s38
    v_mfma_f32_16x16x32_bf16 v[132:135], a[104:107], a[128:131], v[132:135]
    ds_read_b32 a218, v63
    v_perm_b32 v31, v64, v35, s39
    v_mfma_f32_16x16x32_bf16 v[136:139], a[104:107], a[144:147], v[136:139]
    ds_read_b32 a219, v6
    v_perm_b32 v46, v68, v35, s36
    v_mfma_f32_16x16x32_bf16 v[136:139], a[108:111], a[148:151], v[136:139]
    ds_read_b32 a192, v7
    v_perm_b32 v57, v68, v35, s37
    v_mfma_f32_16x16x32_bf16 v[140:143], a[108:111], a[156:159], v[140:143]
    ds_read_b32 a193, v27
    v_perm_b32 v56, v68, v35, s38
    v_mfma_f32_16x16x32_bf16 v[140:143], a[104:107], a[152:155], v[140:143]
    ds_read_b32 a194, v29
    v_perm_b32 v58, v68, v35, s39
    v_mfma_f32_16x16x32_bf16 v[144:147], a[104:107], a[160:163], v[144:147]
    s_waitcnt lgkmcnt(8)
    ds_read_b32 a195, v31
    ds_read_b32 a196, v46
    v_mfma_f32_16x16x32_bf16 v[144:147], a[108:111], a[164:167], v[144:147]
    buffer_load_dwordx4 v36, s[8:11], s56 offen offset:0  lds
    v_mfma_f32_16x16x32_bf16 v[148:151], a[108:111], a[172:175], v[148:151]
    v_perm_b32 v59, v65, v35, s36
    v_perm_b32 v60, v65, v35, s37
    v_mfma_f32_16x16x32_bf16 v[148:151], a[104:107], a[168:171], v[148:151]
    s_waitcnt vmcnt(16)
    ds_read_b32 a197, v57
    v_bitop3_b32 v61, v75, v79, s76 bitop3:0x7e
    v_mfma_f32_16x16x32_bf16 v[152:155], a[104:107], a[184:187], v[152:155]
    ds_read_b32 a198, v56
    v_cmp_lt_u32 vcc, 0xffff, v61
    v_mfma_f32_16x16x32_bf16 v[152:155], a[108:111], a[188:191], v[152:155]
    s_waitcnt lgkmcnt(7)
    ds_read_b32 a199, v58
    v_perm_b32 v5, v65, v35, s38
    v_mfma_f32_16x16x32_bf16 v[156:159], a[108:111], a[68:71], v[156:159]
    v_perm_b32 v62, v65, v35, s39
    s_cbranch_vccnz L_slow3_0
L_back3_0:
    v_mfma_f32_16x16x32_bf16 v[156:159], a[104:107], a[64:67], v[156:159]
    ds_read_b32 a200, v59
    v_perm_b32 v63, v69, v35, s36
    v_mfma_f32_16x16x32_bf16 v[160:163], a[136:139], a[112:115], v[160:163]
    ds_read_b32 a201, v60
    v_perm_b32 v6, v69, v35, s37
    v_mfma_f32_16x16x32_bf16 v[160:163], a[140:143], a[116:119], v[160:163]
    ds_read_b32 a202, v5
    v_perm_b32 v7, v69, v35, s38
    v_mfma_f32_16x16x32_bf16 v[164:167], a[140:143], a[132:135], v[164:167]
    ds_read_b32 a203, v62
    v_perm_b32 v27, v69, v35, s39
    v_mfma_f32_16x16x32_bf16 v[164:167], a[136:139], a[128:131], v[164:167]
    ds_read_b32 a204, v63
    ds_read_b32 a205, v6
    v_mfma_f32_16x16x32_bf16 v[168:171], a[136:139], a[144:147], v[168:171]
    buffer_load_dwordx4 v[84:87], v32, s[12:15], s43 offen sc1
    v_mfma_f32_16x16x32_bf16 v[168:171], a[140:143], a[148:151], v[168:171]
    ds_read_b32 a206, v7
    v_perm_b32 v29, v66, v35, s36
    v_mfma_f32_16x16x32_bf16 v[172:175], a[140:143], a[156:159], v[172:175]
    ds_read_b32 a207, v27
    v_perm_b32 v31, v66, v35, s37
    v_mfma_f32_16x16x32_bf16 v[172:175], a[136:139], a[152:155], v[172:175]
    ds_read_b32 a208, v29
    ds_read_b32 a209, v31
    v_mfma_f32_16x16x32_bf16 v[176:179], a[136:139], a[160:163], v[176:179]
    buffer_load_dwordx4 v[96:99], v33, s[12:15], s43 offen sc1
    v_mfma_f32_16x16x32_bf16 v[176:179], a[140:143], a[164:167], v[176:179]
    v_perm_b32 v46, v66, v35, s38
    v_perm_b32 v57, v66, v35, s39
    v_mfma_f32_16x16x32_bf16 v[180:183], a[140:143], a[172:175], v[180:183]
    v_perm_b32 v56, v70, v35, s36
    v_perm_b32 v61, v70, v35, s37
    v_mfma_f32_16x16x32_bf16 v[180:183], a[136:139], a[168:171], v[180:183]
    ds_read_b32 a210, v46
    ds_read_b32 a211, v57
    v_mfma_f32_16x16x32_bf16 v[184:187], a[136:139], a[184:187], v[184:187]
    buffer_load_dwordx4 v37, s[8:11], s56 offen offset:1024  lds
    v_mfma_f32_16x16x32_bf16 v[184:187], a[140:143], a[188:191], v[184:187]
    ds_read_b32 a212, v56
    v_perm_b32 v58, v70, v35, s38
    v_mfma_f32_16x16x32_bf16 v[188:191], a[140:143], a[68:71], v[188:191]
    ds_read_b32 a213, v61
    v_perm_b32 v59, v70, v35, s39
    v_mfma_f32_16x16x32_bf16 v[188:191], a[136:139], a[64:67], v[188:191]
    s_waitcnt vmcnt(14)
    ds_read_b32 a214, v58
    v_perm_b32 v60, v67, v35, s36
    v_mfma_f32_16x16x32_bf16 v[192:195], a[88:91], a[112:115], v[192:195]
    s_barrier
    v_mfma_f32_16x16x32_bf16 v[192:195], a[92:95], a[116:119], v[192:195]
    buffer_load_dwordx4 v38, s[8:11], s56 offen offset:2048  lds
    v_mfma_f32_16x16x32_bf16 v[196:199], a[92:95], a[132:135], v[196:199]
    ds_read_b32 a215, v59
    v_perm_b32 v5, v67, v35, s37
    v_mfma_f32_16x16x32_bf16 v[196:199], a[88:91], a[128:131], v[196:199]
    ds_read_b32 a220, v60
    v_perm_b32 v62, v71, v35, s36
    v_mfma_f32_16x16x32_bf16 v[200:203], a[88:91], a[144:147], v[200:203]
    ds_read_b32 a221, v5
    v_perm_b32 v63, v71, v35, s37
    v_mfma_f32_16x16x32_bf16 v[200:203], a[92:95], a[148:151], v[200:203]
    ds_read_b32 a222, v62
    v_perm_b32 v6, v72, v35, s36
    v_mfma_f32_16x16x32_bf16 v[204:207], a[92:95], a[156:159], v[204:207]
    ds_read_b128 a[224:227], v40 offset:16384
    v_perm_b32 v7, v72, v35, s37
    v_mfma_f32_16x16x32_bf16 v[204:207], a[88:91], a[152:155], v[204:207]
    ds_read_b32 a223, v63
    v_perm_b32 v27, v72, v35, s38
    v_mfma_f32_16x16x32_bf16 v[208:211], a[88:91], a[160:163], v[208:211]
    ds_read_b128 a[228:231], v41 offset:16384
    ds_read_b32 a232, v6
    v_mfma_f32_16x16x32_bf16 v[208:211], a[92:95], a[164:167], v[208:211]
    buffer_load_dwordx4 v39, s[8:11], s56 offen offset:3072  lds
    v_mfma_f32_16x16x32_bf16 v[212:215], a[92:95], a[172:175], v[212:215]
    s_add_u32 m0, s57, 81920
    ds_read_b128 a[240:243], v40 offset:18432
    ds_read_b32 a233, v7
    v_mfma_f32_16x16x32_bf16 v[212:215], a[88:91], a[168:171], v[212:215]
    ds_read_b32 a234, v27
    v_perm_b32 v29, v72, v35, s39
    v_mfma_f32_16x16x32_bf16 v[216:219], a[88:91], a[184:187], v[216:219]
    ds_read_b128 a[244:247], v41 offset:18432
    v_perm_b32 v31, v76, v35, s36
    v_mfma_f32_16x16x32_bf16 v[216:219], a[92:95], a[188:191], v[216:219]
    ds_read_b32 a235, v29
    v_perm_b32 v46, v76, v35, s37
    v_mfma_f32_16x16x32_bf16 v[220:223], a[92:95], a[68:71], v[220:223]
    ds_read_b128 a[248:251], v40 offset:20480
    v_perm_b32 v57, v76, v35, s38
    v_mfma_f32_16x16x32_bf16 v[220:223], a[88:91], a[64:67], v[220:223]
    ds_read_b32 a236, v31
    ds_read_b32 a237, v46
    v_mfma_f32_16x16x32_bf16 v[224:227], a[216:219], a[114:117], v[224:227]
    buffer_load_dwordx4 v36, s[8:11], s3 offen offset:0  lds
    v_mfma_f32_16x16x32_bf16 v[228:231], a[216:219], a[130:133], v[228:231]
    ds_read_b128 a[252:255], v41 offset:20480
    v_perm_b32 v56, v76, v35, s39
    v_mfma_f32_16x16x32_bf16 v[232:235], a[216:219], a[146:149], v[232:235]
    ds_read_b128 a[36:39], v41 offset:22528
    ds_read_b32 a238, v57
    v_mfma_f32_16x16x32_bf16 v[236:239], a[216:219], a[154:157], v[236:239]
    ds_read_b128 a[32:35], v40 offset:22528
    v_perm_b32 v61, v73, v35, s36
    v_mfma_f32_16x16x32_bf16 v[240:243], a[216:219], a[162:165], v[240:243]
    ds_read_b128 a[0:3], v40 offset:24576
    v_perm_b32 v58, v73, v35, s37
    v_mfma_f32_16x16x32_bf16 v[244:247], a[216:219], a[170:173], v[244:247]
    ds_read_b128 a[4:7], v41 offset:24576
    ds_read_b32 a239, v56
    v_mfma_f32_16x16x32_bf16 v[248:251], a[216:219], a[186:189], v[248:251]
    s_waitcnt lgkmcnt(10)
    ds_read_b32 a8, v61
    ds_read_b32 a9, v58
    v_mfma_f32_16x16x32_bf16 v[252:255], a[216:219], a[66:69], v[252:255]
    buffer_load_dwordx4 v37, s[8:11], s3 offen offset:1024  lds
    v_mfma_f32_16x16x32_bf16 v[128:131], a[192:195], a[224:227], v[128:131]
    ds_read_b128 a[52:55], v41 offset:26624
    v_perm_b32 v59, v73, v35, s38
    v_mfma_f32_16x16x32_bf16 v[128:131], a[196:199], a[228:231], v[128:131]
    ds_read_b128 a[48:51], v40 offset:26624
    v_perm_b32 v60, v73, v35, s39
    v_mfma_f32_16x16x32_bf16 v[132:135], a[196:199], a[244:247], v[132:135]
    s_add_u32 s56, s55, 1280
    ds_read_b128 a[16:19], v40 offset:28672
    v_perm_b32 v5, v77, v35, s36
    v_mfma_f32_16x16x32_bf16 v[132:135], a[192:195], a[240:243], v[132:135]
    s_waitcnt lgkmcnt(9)
    ds_read_b128 a[20:23], v41 offset:28672
    v_perm_b32 v62, v77, v35, s37
    v_mfma_f32_16x16x32_bf16 v[136:139], a[192:195], a[248:251], v[136:139]
    ds_read_b32 a10, v59
    v_perm_b32 v63, v77, v35, s38
    v_mfma_f32_16x16x32_bf16 v[136:139], a[196:199], a[252:255], v[136:139]
    ds_read_b128 a[24:27], v40 offset:30720
    v_perm_b32 v6, v77, v35, s39
    v_mfma_f32_16x16x32_bf16 v[140:143], a[196:199], a[36:39], v[140:143]
    s_waitcnt lgkmcnt(8)
    ds_read_b32 a11, v60
    ds_read_b32 a12, v5
    v_mfma_f32_16x16x32_bf16 v[140:143], a[192:195], a[32:35], v[140:143]
    buffer_load_dwordx4 v38, s[8:11], s3 offen offset:2048  lds
    v_mfma_f32_16x16x32_bf16 v[144:147], a[192:195], a[0:3], v[144:147]
    ds_read_b128 a[28:31], v41 offset:30720
    v_perm_b32 v7, v74, v35, s36
    v_mfma_f32_16x16x32_bf16 v[144:147], a[196:199], a[4:7], v[144:147]
    s_waitcnt lgkmcnt(8)
    ds_read_b32 a13, v62
    ds_read_b32 a14, v63
    v_mfma_f32_16x16x32_bf16 v[148:151], a[196:199], a[52:55], v[148:151]
    s_waitcnt lgkmcnt(9)
    ds_read_b32 a15, v6
    v_perm_b32 v27, v74, v35, s37
    v_mfma_f32_16x16x32_bf16 v[148:151], a[192:195], a[48:51], v[148:151]
    s_waitcnt lgkmcnt(9)
    v_perm_b32 v29, v74, v35, s38
    v_perm_b32 v31, v74, v35, s39
    v_mfma_f32_16x16x32_bf16 v[152:155], a[192:195], a[16:19], v[152:155]
    s_waitcnt lgkmcnt(8)
    ds_read_b32 a40, v7
    v_perm_b32 v46, v78, v35, s36
    v_mfma_f32_16x16x32_bf16 v[152:155], a[196:199], a[20:23], v[152:155]
    s_waitcnt vmcnt(11) lgkmcnt(4)
    ds_read_b32 a41, v27
    ds_read_b32 a42, v29
    v_mfma_f32_16x16x32_bf16 v[156:159], a[196:199], a[28:31], v[156:159]
    buffer_load_dwordx4 v39, s[8:11], s3 offen offset:3072  lds
    v_mfma_f32_16x16x32_bf16 v[156:159], a[192:195], a[24:27], v[156:159]
    s_add_u32 m0, s57, 0
    ds_read_b32 a43, v31
    v_perm_b32 v57, v78, v35, s37
    v_mfma_f32_16x16x32_bf16 v[160:163], a[200:203], a[224:227], v[160:163]
    s_barrier
    v_mfma_f32_16x16x32_bf16 v[160:163], a[204:207], a[228:231], v[160:163]
    ds_read_b32 a44, v46
    v_perm_b32 v56, v78, v35, s38
    v_mfma_f32_16x16x32_bf16 v[164:167], a[204:207], a[244:247], v[164:167]
    s_add_u32 s3, s69, 1280
    ds_read_b32 a45, v57
    ds_read_b32 a46, v56
    v_mfma_f32_16x16x32_bf16 v[164:167], a[200:203], a[240:243], v[164:167]
    buffer_load_dwordx4 v[104:107], v34, s[12:15], s43 offen sc1
    v_mfma_f32_16x16x32_bf16 v[168:171], a[200:203], a[248:251], v[168:171]
    ds_read_b128 a[56:59], v40 offset:32768
    v_perm_b32 v61, v78, v35, s39
    v_mfma_f32_16x16x32_bf16 v[168:171], a[204:207], a[252:255], v[168:171]
    ds_read_b128 a[60:63], v41 offset:32768
    v_perm_b32 v58, v75, v35, s36
    v_mfma_f32_16x16x32_bf16 v[172:175], a[204:207], a[36:39], v[172:175]
    ds_read_b128 a[72:75], v40 offset:34816
    v_perm_b32 v59, v75, v35, s37
    v_mfma_f32_16x16x32_bf16 v[172:175], a[200:203], a[32:35], v[172:175]
    ds_read_b128 a[76:79], v41 offset:34816
    ds_read_b32 a47, v61
    v_mfma_f32_16x16x32_bf16 v[176:179], a[200:203], a[0:3], v[176:179]
    buffer_load_dwordx4 v[108:111], v44, s[12:15], s43 offen sc1
    v_mfma_f32_16x16x32_bf16 v[176:179], a[204:207], a[4:7], v[176:179]
    s_waitcnt vmcnt(12)
    v_bitop3_b32 v60, v103, v83, s76 bitop3:0x7e
    v_perm_b32 v5, v79, v35, s36
    v_mfma_f32_16x16x32_bf16 v[180:183], a[204:207], a[52:55], v[180:183]
    ds_read_b128 a[96:99], v40 offset:36864
    v_cmp_lt_u32 vcc, 0xffff, v60
    v_mfma_f32_16x16x32_bf16 v[180:183], a[200:203], a[48:51], v[180:183]
    ds_read_b32 a120, v58
    ds_read_b32 a121, v59
    v_mfma_f32_16x16x32_bf16 v[184:187], a[200:203], a[16:19], v[184:187]
    buffer_load_dwordx4 v[112:115], v32, s[12:15], s44 offen sc1
    v_mfma_f32_16x16x32_bf16 v[184:187], a[204:207], a[20:23], v[184:187]
    ds_read_b128 a[100:103], v41 offset:36864
    s_cbranch_vccnz L_slow3_1
L_back3_1:
    v_mfma_f32_16x16x32_bf16 v[188:191], a[204:207], a[28:31], v[188:191]
    v_perm_b32 v62, v79, v35, s37
    v_perm_b32 v63, v103, v35, s36
    v_mfma_f32_16x16x32_bf16 v[188:191], a[200:203], a[24:27], v[188:191]
    v_perm_b32 v6, v103, v35, s37
    v_perm_b32 v7, v83, v35, s36
    v_mfma_f32_16x16x32_bf16 v[192:195], a[208:211], a[224:227], v[192:195]
    ds_read_b128 a[80:83], v40 offset:38912
    ds_read_b32 a122, v5
    v_mfma_f32_16x16x32_bf16 v[192:195], a[212:215], a[228:231], v[192:195]
    buffer_load_dwordx4 v[116:119], v33, s[12:15], s44 offen sc1
    v_mfma_f32_16x16x32_bf16 v[196:199], a[212:215], a[244:247], v[196:199]
    v_perm_b32 v27, v83, v35, s37
    v_perm_b32 v29, v100, v35, s36
    v_mfma_f32_16x16x32_bf16 v[196:199], a[208:211], a[240:243], v[196:199]
    ds_read_b128 a[84:87], v41 offset:38912
    v_perm_b32 v31, v100, v35, s37
    v_mfma_f32_16x16x32_bf16 v[200:203], a[208:211], a[248:251], v[200:203]
    ds_read_b32 a123, v62
    ds_read_b32 a124, v63
    v_mfma_f32_16x16x32_bf16 v[200:203], a[212:215], a[252:255], v[200:203]
    ds_read_b32 a125, v6
    v_perm_b32 v46, v100, v35, s38
    v_mfma_f32_16x16x32_bf16 v[204:207], a[212:215], a[36:39], v[204:207]
    ds_read_b128 a[176:179], v40 offset:40960
    ds_read_b32 a126, v7
    v_mfma_f32_16x16x32_bf16 v[204:207], a[208:211], a[32:35], v[204:207]
    v_perm_b32 v57, v100, v35, s39
    v_perm_b32 v56, v80, v35, s36
    v_mfma_f32_16x16x32_bf16 v[208:211], a[208:211], a[0:3], v[208:211]
    ds_read_b32 a127, v27
    ds_read_b32 a104, v29
    v_mfma_f32_16x16x32_bf16 v[208:211], a[212:215], a[4:7], v[208:211]
    buffer_load_dwordx4 v36, s[8:11], s56 offen offset:0  lds
    v_mfma_f32_16x16x32_bf16 v[212:215], a[212:215], a[52:55], v[212:215]
    ds_read_b128 a[180:183], v41 offset:40960
    v_perm_b32 v61, v80, v35, s37
    v_mfma_f32_16x16x32_bf16 v[212:215], a[208:211], a[48:51], v[212:215]
    ds_read_b32 a105, v31
    v_perm_b32 v60, v80, v35, s38
    v_mfma_f32_16x16x32_bf16 v[216:219], a[208:211], a[16:19], v[216:219]
    s_waitcnt vmcnt(12)
    ds_read_b128 a[136:139], v40 offset:43008
    v_bitop3_b32 v58, v87, v99, s76 bitop3:0x7e
    v_mfma_f32_16x16x32_bf16 v[216:219], a[212:215], a[20:23], v[216:219]
    ds_read_b32 a106, v46
    v_cmp_lt_u32 vcc, 0xffff, v58
    v_mfma_f32_16x16x32_bf16 v[220:223], a[212:215], a[28:31], v[220:223]
    ds_read_b32 a107, v57
    v_perm_b32 v59, v80, v35, s39
    v_mfma_f32_16x16x32_bf16 v[220:223], a[208:211], a[24:27], v[220:223]
    ds_read_b128 a[140:143], v41 offset:43008
    s_cbranch_vccnz L_slow4_0
L_back4_0:
    v_mfma_f32_16x16x32_bf16 v[224:227], a[220:223], a[226:229], v[224:227]
    buffer_load_dwordx4 v37, s[8:11], s56 offen offset:1024  lds
    v_mfma_f32_16x16x32_bf16 v[228:231], a[220:223], a[242:245], v[228:231]
    ds_read_b32 a108, v56
    v_perm_b32 v5, v101, v35, s36
    v_mfma_f32_16x16x32_bf16 v[232:235], a[220:223], a[250:253], v[232:235]
    ds_read_b128 a[88:91], v40 offset:45056
    v_perm_b32 v62, v101, v35, s37
    v_mfma_f32_16x16x32_bf16 v[236:239], a[220:223], a[34:37], v[236:239]
    ds_read_b32 a109, v61
    v_perm_b32 v63, v101, v35, s38
L_pad2:
    s_cbranch_execz L_pad3
    v_mfma_f32_16x16x32_bf16 v[240:243], a[220:223], a[2:5], v[240:243]
    ds_read_b32 a110, v60
    v_perm_b32 v6, v101, v35, s39
    v_mfma_f32_16x16x32_bf16 v[244:247], a[220:223], a[50:53], v[244:247]
    ds_read_b128 a[92:95], v41 offset:45056
    v_perm_b32 v7, v81, v35, s36
    v_mfma_f32_16x16x32_bf16 v[248:251], a[220:223], a[18:21], v[248:251]
    s_waitcnt lgkmcnt(7)
    ds_read_b32 a111, v59
    ds_read_b32 a112, v5
    v_mfma_f32_16x16x32_bf16 v[252:255], a[220:223], a[26:29], v[252:255]
    buffer_load_dwordx4 v38, s[8:11], s56 offen offset:2048  lds
    v_mfma_f32_16x16x32_bf16 v[128:131], a[232:235], a[56:59], v[128:131]
    ds_read_b128 a[128:131], v40 offset:47104
    v_perm_b32 v27, v81, v35, s37
    v_mfma_f32_16x16x32_bf16 v[128:131], a[236:239], a[60:63], v[128:131]
    ds_read_b32 a113, v62
    v_perm_b32 v29, v81, v35, s38
    v_mfma_f32_16x16x32_bf16 v[132:135], a[236:239], a[76:79], v[132:135]
    ds_read_b128 a[132:135], v41 offset:47104
    v_perm_b32 v31, v81, v35, s39
    v_mfma_f32_16x16x32_bf16 v[132:135], a[232:235], a[72:75], v[132:135]
    ds_read_b32 a114, v63
    v_perm_b32 v46, v102, v35, s36
    v_mfma_f32_16x16x32_bf16 v[136:139], a[232:235], a[96:99], v[136:139]
    ds_read_b32 a115, v6
    ds_read_b32 a116, v7
    v_mfma_f32_16x16x32_bf16 v[136:139], a[236:239], a[100:103], v[136:139]
    v_perm_b32 v58, v102, v35, s37
    v_perm_b32 v57, v102, v35, s38
    v_mfma_f32_16x16x32_bf16 v[140:143], a[236:239], a[84:87], v[140:143]
    ds_read_b32 a117, v27
    v_perm_b32 v56, v102, v35, s39
    v_mfma_f32_16x16x32_bf16 v[140:143], a[232:235], a[80:83], v[140:143]
    ds_read_b32 a118, v29
    v_perm_b32 v61, v82, v35, s36
    v_mfma_f32_16x16x32_bf16 v[144:147], a[232:235], a[176:179], v[144:147]
    s_waitcnt lgkmcnt(8)
    ds_read_b32 a119, v31
    ds_read_b32 a144, v46
    v_mfma_f32_16x16x32_bf16 v[144:147], a[236:239], a[180:183], v[144:147]
    buffer_load_dwordx4 v[120:123], v34, s[12:15], s44 offen sc1
    v_mfma_f32_16x16x32_bf16 v[148:151], a[236:239], a[140:143], v[148:151]
    v_perm_b32 v60, v82, v35, s37
    v_perm_b32 v59, v82, v35, s38
    v_mfma_f32_16x16x32_bf16 v[148:151], a[232:235], a[136:139], v[148:151]
    ds_read_b32 a145, v58
    ds_read_b32 a146, v57
    v_mfma_f32_16x16x32_bf16 v[152:155], a[232:235], a[88:91], v[152:155]
    s_waitcnt lgkmcnt(8)
    ds_read_b128 a[152:155], v40 offset:49152
    ds_read_b32 a147, v56
    v_mfma_f32_16x16x32_bf16 v[152:155], a[236:239], a[92:95], v[152:155]
    buffer_load_dwordx4 v[124:127], v44, s[12:15], s44 offen sc1
    v_mfma_f32_16x16x32_bf16 v[156:159], a[236:239], a[132:135], v[156:159]
    ds_read_b128 a[156:159], v41 offset:49152
    v_perm_b32 v5, v82, v35, s39
    v_mfma_f32_16x16x32_bf16 v[156:159], a[232:235], a[128:131], v[156:159]
    ds_read_b128 a[160:163], v40 offset:51200
    ds_read_b32 a148, v61
    v_mfma_f32_16x16x32_bf16 v[160:163], a[8:11], a[56:59], v[160:163]
    ds_read_b128 a[164:167], v41 offset:51200
    ds_read_b32 a149, v60
    v_mfma_f32_16x16x32_bf16 v[160:163], a[12:15], a[60:63], v[160:163]
    buffer_load_dwordx4 v39, s[8:11], s56 offen offset:3072  lds
    v_mfma_f32_16x16x32_bf16 v[164:167], a[12:15], a[76:79], v[164:167]
    s_add_u32 m0, s57, 16384
    ds_read_b128 a[168:171], v40 offset:53248
    v_perm_b32 v62, v84, v35, s36
    v_mfma_f32_16x16x32_bf16 v[164:167], a[8:11], a[72:75], v[164:167]
    ds_read_b32 a150, v59
    v_perm_b32 v63, v84, v35, s37
    v_mfma_f32_16x16x32_bf16 v[168:171], a[8:11], a[96:99], v[168:171]
    v_perm_b32 v6, v84, v35, s38
    v_perm_b32 v7, v84, v35, s39
    v_mfma_f32_16x16x32_bf16 v[168:171], a[12:15], a[100:103], v[168:171]
    ds_read_b128 a[172:175], v41 offset:53248
    ds_read_b32 a151, v5
    v_mfma_f32_16x16x32_bf16 v[172:175], a[12:15], a[84:87], v[172:175]
    v_perm_b32 v27, v96, v35, s36
    v_perm_b32 v29, v96, v35, s37
    v_mfma_f32_16x16x32_bf16 v[172:175], a[8:11], a[80:83], v[172:175]
    ds_read_b32 a184, v62
    ds_read_b32 a185, v63
    v_mfma_f32_16x16x32_bf16 v[176:179], a[8:11], a[176:179], v[176:179]
    buffer_load_dwordx4 v36, s[8:11], s3 offen offset:0  lds
    v_mfma_f32_16x16x32_bf16 v[176:179], a[12:15], a[180:183], v[176:179]
    ds_read_b128 a[64:67], v40 offset:55296
    v_perm_b32 v31, v96, v35, s38
    v_mfma_f32_16x16x32_bf16 v[180:183], a[12:15], a[140:143], v[180:183]
    ds_read_b32 a186, v6
    v_perm_b32 v46, v96, v35, s39
    v_mfma_f32_16x16x32_bf16 v[180:183], a[8:11], a[136:139], v[180:183]
    ds_read_b128 a[68:71], v41 offset:55296
    ds_read_b32 a187, v7
    v_mfma_f32_16x16x32_bf16 v[184:187], a[8:11], a[88:91], v[184:187]
    v_perm_b32 v58, v85, v35, s36
    v_perm_b32 v57, v85, v35, s37
    v_mfma_f32_16x16x32_bf16 v[184:187], a[12:15], a[92:95], v[184:187]
    ds_read_b32 a188, v27
    ds_read_b32 a189, v29
    v_mfma_f32_16x16x32_bf16 v[188:191], a[12:15], a[132:135], v[188:191]
    ds_read_b128 a[192:195], v40 offset:57344
    ds_read_b32 a190, v31
    v_mfma_f32_16x16x32_bf16 v[188:191], a[8:11], a[128:131], v[188:191]
    buffer_load_dwordx4 v37, s[8:11], s3 offen offset:1024  lds
    v_mfma_f32_16x16x32_bf16 v[192:195], a[40:43], a[56:59], v[192:195]
    v_perm_b32 v56, v85, v35, s38
    v_perm_b32 v61, v85, v35, s39
    v_mfma_f32_16x16x32_bf16 v[192:195], a[44:47], a[60:63], v[192:195]
    ds_read_b128 a[196:199], v41 offset:57344
    ds_read_b32 a191, v46
    v_mfma_f32_16x16x32_bf16 v[196:199], a[44:47], a[76:79], v[196:199]
    ds_read_b32 a200, v58
    v_perm_b32 v60, v97, v35, s36
    v_mfma_f32_16x16x32_bf16 v[196:199], a[40:43], a[72:75], v[196:199]
    ds_read_b32 a201, v57
    v_perm_b32 v59, v97, v35, s37
    v_mfma_f32_16x16x32_bf16 v[200:203], a[40:43], a[96:99], v[200:203]
    ds_read_b128 a[208:211], v40 offset:59392
    v_perm_b32 v5, v97, v35, s38
    v_mfma_f32_16x16x32_bf16 v[200:203], a[44:47], a[100:103], v[200:203]
    ds_read_b32 a202, v56
    ds_read_b32 a203, v61
    v_mfma_f32_16x16x32_bf16 v[204:207], a[44:47], a[84:87], v[204:207]
    buffer_load_dwordx4 v38, s[8:11], s3 offen offset:2048  lds
    v_mfma_f32_16x16x32_bf16 v[204:207], a[40:43], a[80:83], v[204:207]
    ds_read_b128 a[212:215], v41 offset:59392
    v_perm_b32 v62, v97, v35, s39
    v_mfma_f32_16x16x32_bf16 v[208:211], a[40:43], a[176:179], v[208:211]
    ds_read_b32 a204, v60
    v_perm_b32 v63, v86, v35, s36
    v_mfma_f32_16x16x32_bf16 v[208:211], a[44:47], a[180:183], v[208:211]
    ds_read_b32 a205, v59
    v_perm_b32 v6, v86, v35, s37
    v_mfma_f32_16x16x32_bf16 v[212:215], a[44:47], a[140:143], v[212:215]
    ds_read_b128 a[224:227], v40 offset:61440
    v_perm_b32 v7, v86, v35, s38
    v_mfma_f32_16x16x32_bf16 v[212:215], a[40:43], a[136:139], v[212:215]
    ds_read_b32 a206, v5
    v_perm_b32 v27, v86, v35, s39
    v_mfma_f32_16x16x32_bf16 v[216:219], a[40:43], a[88:91], v[216:219]
    ds_read_b32 a207, v62
    v_perm_b32 v29, v98, v35, s36
    v_mfma_f32_16x16x32_bf16 v[216:219], a[44:47], a[92:95], v[216:219]
    ds_read_b128 a[228:231], v41 offset:61440
    ds_read_b32 a240, v63
    v_mfma_f32_16x16x32_bf16 v[220:223], a[44:47], a[132:135], v[220:223]
    buffer_load_dwordx4 v39, s[8:11], s3 offen offset:3072  lds
    v_mfma_f32_16x16x32_bf16 v[220:223], a[40:43], a[128:131], v[220:223]
    s_waitcnt vmcnt(12)
    v_bitop3_b32 v31, v107, v111, s76 bitop3:0x7e
    v_perm_b32 v46, v98, v35, s37
    v_mfma_f32_16x16x32_bf16 v[224:227], a[120:123], a[58:61], v[224:227]
    s_waitcnt lgkmcnt(7)
    ds_read_b128 a[248:251], v40 offset:63488
    v_cmp_lt_u32 vcc, 0xffff, v31
    v_mfma_f32_16x16x32_bf16 v[224:227], a[124:127], a[154:157], v[224:227]
    ds_read_b32 a241, v6
    v_perm_b32 v58, v98, v35, s38
    v_mfma_f32_16x16x32_bf16 v[228:231], a[124:127], a[162:165], v[228:231]
    ds_read_b128 a[252:255], v41 offset:63488
    s_cbranch_vccnz L_slow4_1
L_back4_1:
    v_mfma_f32_16x16x32_bf16 v[228:231], a[120:123], a[74:77], v[228:231]
    ds_read_b32 a242, v7
    ds_read_b32 a243, v27
    v_mfma_f32_16x16x32_bf16 v[232:235], a[120:123], a[98:101], v[232:235]
    buffer_load_dwordx4 v[88:91], v32, s[12:15], s45 offen sc1
    v_mfma_f32_16x16x32_bf16 v[232:235], a[124:127], a[170:173], v[232:235]
    ds_read_b32 a244, v29
    v_perm_b32 v57, v98, v35, s39
    v_mfma_f32_16x16x32_bf16 v[236:239], a[124:127], a[66:69], v[236:239]
    v_perm_b32 v56, v87, v35, s36
    v_perm_b32 v61, v87, v35, s37
    v_mfma_f32_16x16x32_bf16 v[236:239], a[120:123], a[82:85], v[236:239]
    ds_read_b32 a245, v46
    ds_read_b32 a246, v58
    v_mfma_f32_16x16x32_bf16 v[240:243], a[120:123], a[178:181], v[240:243]
    buffer_load_dwordx4 v[92:95], v33, s[12:15], s45 offen sc1
    v_mfma_f32_16x16x32_bf16 v[240:243], a[124:127], a[194:197], v[240:243]
    v_perm_b32 v60, v99, v35, s36
    v_perm_b32 v59, v99, v35, s37
    v_mfma_f32_16x16x32_bf16 v[244:247], a[124:127], a[210:213], v[244:247]
    v_perm_b32 v5, v107, v35, s36
    v_perm_b32 v62, v107, v35, s37
    v_mfma_f32_16x16x32_bf16 v[244:247], a[120:123], a[138:141], v[244:247]
    s_waitcnt lgkmcnt(5)
    ds_read_b32 a247, v57
    ds_read_b32 a32, v56
    v_mfma_f32_16x16x32_bf16 v[248:251], a[120:123], a[90:93], v[248:251]
    buffer_load_dwordx4 v[48:51], v34, s[12:15], s45 offen sc1
    v_mfma_f32_16x16x32_bf16 v[248:251], a[124:127], a[226:229], v[248:251]
    s_barrier
    v_mfma_f32_16x16x32_bf16 v[252:255], a[124:127], a[250:253], v[252:255]
    s_add_u32 s56, s55, 1536
    ds_read_b32 a33, v61
    v_perm_b32 v63, v111, v35, s36
    v_mfma_f32_16x16x32_bf16 v[252:255], a[120:123], a[130:133], v[252:255]
    ds_read_b32 a34, v60
    v_perm_b32 v31, v111, v35, s37
    v_mfma_f32_16x16x32_bf16 v[128:131], a[104:107], a[152:155], v[128:131]
    ds_read_b32 a35, v59
    ds_read_b32 a36, v5
    v_mfma_f32_16x16x32_bf16 v[128:131], a[108:111], a[156:159], v[128:131]
    buffer_load_dwordx4 v[52:55], v44, s[12:15], s45 offen sc1
    v_mfma_f32_16x16x32_bf16 v[132:135], a[108:111], a[164:167], v[132:135]
    s_add_u32 m0, s57, 32768
    ds_read_b32 a37, v62
    v_perm_b32 v6, v104, v35, s36
    v_mfma_f32_16x16x32_bf16 v[132:135], a[104:107], a[160:163], v[132:135]
    v_perm_b32 v7, v104, v35, s37
    v_perm_b32 v27, v104, v35, s38
    v_mfma_f32_16x16x32_bf16 v[136:139], a[104:107], a[168:171], v[136:139]
    ds_read_b32 a38, v63
    v_perm_b32 v29, v104, v35, s39
    v_mfma_f32_16x16x32_bf16 v[136:139], a[108:111], a[172:175], v[136:139]
    ds_read_b32 a39, v31
    v_perm_b32 v46, v108, v35, s36
    v_mfma_f32_16x16x32_bf16 v[140:143], a[108:111], a[68:71], v[140:143]
    ds_read_b32 a0, v6
    v_perm_b32 v58, v108, v35, s37
    v_mfma_f32_16x16x32_bf16 v[140:143], a[104:107], a[64:67], v[140:143]
    ds_read_b32 a1, v7
    ds_read_b32 a2, v27
    v_mfma_f32_16x16x32_bf16 v[144:147], a[104:107], a[192:195], v[144:147]
    buffer_load_dwordx4 v36, s[8:11], s56 offen offset:0  lds
    v_mfma_f32_16x16x32_bf16 v[144:147], a[108:111], a[196:199], v[144:147]
    s_waitcnt vmcnt(15)
    v_perm_b32 v56, v108, v35, s38
    v_bitop3_b32 v57, v115, v119, s76 bitop3:0x7e
    v_mfma_f32_16x16x32_bf16 v[148:151], a[108:111], a[212:215], v[148:151]
    ds_read_b32 a3, v29
    v_cmp_lt_u32 vcc, 0xffff, v57
    v_mfma_f32_16x16x32_bf16 v[148:151], a[104:107], a[208:211], v[148:151]
    ds_read_b128 a[48:51], v42 offset:0
    v_perm_b32 v61, v108, v35, s39
    v_mfma_f32_16x16x32_bf16 v[152:155], a[104:107], a[224:227], v[152:155]
    ds_read_b128 a[52:55], v43 offset:0
    s_cbranch_vccnz L_slow5_0
L_back5_0:
    v_mfma_f32_16x16x32_bf16 v[152:155], a[108:111], a[228:231], v[152:155]
    ds_read_b32 a4, v46
    v_perm_b32 v60, v105, v35, s36
    v_mfma_f32_16x16x32_bf16 v[156:159], a[108:111], a[252:255], v[156:159]
    s_add_u32 s3, s69, 1536
    ds_read_b128 a[16:19], v42 offset:2048
    ds_read_b32 a5, v58
    v_mfma_f32_16x16x32_bf16 v[156:159], a[104:107], a[248:251], v[156:159]
    ds_read_b128 a[20:23], v43 offset:2048
    ds_read_b32 a6, v56
    v_mfma_f32_16x16x32_bf16 v[160:163], a[112:115], a[152:155], v[160:163]
    buffer_load_dwordx4 v37, s[8:11], s56 offen offset:1024  lds
    v_mfma_f32_16x16x32_bf16 v[160:163], a[116:119], a[156:159], v[160:163]
    v_perm_b32 v59, v105, v35, s37
    v_perm_b32 v5, v105, v35, s38
    v_mfma_f32_16x16x32_bf16 v[164:167], a[116:119], a[164:167], v[164:167]
    ds_read_b128 a[216:219], v42 offset:4096
    v_perm_b32 v62, v105, v35, s39
    v_mfma_f32_16x16x32_bf16 v[164:167], a[112:115], a[160:163], v[164:167]
    ds_read_b32 a7, v61
    v_perm_b32 v63, v109, v35, s36
    v_mfma_f32_16x16x32_bf16 v[168:171], a[112:115], a[168:171], v[168:171]
    ds_read_b32 a24, v60
    v_perm_b32 v31, v109, v35, s37
    v_mfma_f32_16x16x32_bf16 v[168:171], a[116:119], a[172:175], v[168:171]
    ds_read_b128 a[220:223], v43 offset:4096
    v_perm_b32 v6, v109, v35, s38
    v_mfma_f32_16x16x32_bf16 v[172:175], a[116:119], a[68:71], v[172:175]
    ds_read_b32 a25, v59
    ds_read_b32 a26, v5
    v_mfma_f32_16x16x32_bf16 v[172:175], a[112:115], a[64:67], v[172:175]
    buffer_load_dwordx4 v38, s[8:11], s56 offen offset:2048  lds
    v_mfma_f32_16x16x32_bf16 v[176:179], a[112:115], a[192:195], v[176:179]
    ds_read_b128 a[232:235], v42 offset:6144
    v_perm_b32 v7, v109, v35, s39
    v_mfma_f32_16x16x32_bf16 v[176:179], a[116:119], a[196:199], v[176:179]
    ds_read_b32 a27, v62
    v_perm_b32 v27, v106, v35, s36
    v_mfma_f32_16x16x32_bf16 v[180:183], a[116:119], a[212:215], v[180:183]
    ds_read_b32 a28, v63
    v_perm_b32 v29, v106, v35, s37
    v_mfma_f32_16x16x32_bf16 v[180:183], a[112:115], a[208:211], v[180:183]
    ds_read_b128 a[236:239], v43 offset:6144
    ds_read_b32 a29, v31
    v_mfma_f32_16x16x32_bf16 v[184:187], a[112:115], a[224:227], v[184:187]
    ds_read_b32 a30, v6
    v_perm_b32 v57, v106, v35, s38
    v_mfma_f32_16x16x32_bf16 v[184:187], a[116:119], a[228:231], v[184:187]
    ds_read_b32 a31, v7
    ds_read_b32 a8, v27
    v_mfma_f32_16x16x32_bf16 v[188:191], a[116:119], a[252:255], v[188:191]
    buffer_load_dwordx4 v39, s[8:11], s56 offen offset:3072  lds
    v_mfma_f32_16x16x32_bf16 v[188:191], a[112:115], a[248:251], v[188:191]
    s_add_u32 m0, s57, 49152
    ds_read_b128 a[40:43], v42 offset:8192
    v_perm_b32 v46, v106, v35, s39
    v_mfma_f32_16x16x32_bf16 v[192:195], a[144:147], a[152:155], v[192:195]
    s_add_u32 s56, s55, 1792
    v_perm_b32 v58, v110, v35, s36
    v_perm_b32 v56, v110, v35, s37
    v_mfma_f32_16x16x32_bf16 v[192:195], a[148:151], a[156:159], v[192:195]
    ds_read_b128 a[44:47], v43 offset:8192
    ds_read_b32 a9, v29
    v_mfma_f32_16x16x32_bf16 v[196:199], a[148:151], a[164:167], v[196:199]
    ds_read_b32 a10, v57
    v_perm_b32 v61, v110, v35, s38
    v_mfma_f32_16x16x32_bf16 v[196:199], a[144:147], a[160:163], v[196:199]
    v_perm_b32 v60, v110, v35, s39
    v_perm_b32 v59, v112, v35, s36
    v_mfma_f32_16x16x32_bf16 v[200:203], a[144:147], a[168:171], v[200:203]
    ds_read_b128 a[56:59], v42 offset:10240
    ds_read_b32 a11, v46
    v_mfma_f32_16x16x32_bf16 v[200:203], a[148:151], a[172:175], v[200:203]
    ds_read_b32 a12, v58
    ds_read_b32 a13, v56
    v_mfma_f32_16x16x32_bf16 v[204:207], a[148:151], a[68:71], v[204:207]
    buffer_load_dwordx4 v36, s[8:11], s3 offen offset:0  lds
    v_mfma_f32_16x16x32_bf16 v[204:207], a[144:147], a[64:67], v[204:207]
    ds_read_b128 a[60:63], v43 offset:10240
    v_perm_b32 v5, v112, v35, s37
    v_mfma_f32_16x16x32_bf16 v[208:211], a[144:147], a[192:195], v[208:211]
    ds_read_b32 a14, v61
    v_perm_b32 v62, v112, v35, s38
    v_mfma_f32_16x16x32_bf16 v[208:211], a[148:151], a[196:199], v[208:211]
    ds_read_b32 a15, v60
    v_perm_b32 v63, v112, v35, s39
    v_mfma_f32_16x16x32_bf16 v[212:215], a[148:151], a[212:215], v[212:215]
    ds_read_b128 a[72:75], v42 offset:12288
    ds_read_b32 a96, v59
    v_mfma_f32_16x16x32_bf16 v[212:215], a[144:147], a[208:211], v[212:215]
    v_perm_b32 v31, v116, v35, s36
    v_perm_b32 v6, v116, v35, s37
    v_mfma_f32_16x16x32_bf16 v[216:219], a[144:147], a[224:227], v[216:219]
    ds_read_b32 a97, v5
    ds_read_b32 a98, v62
    v_mfma_f32_16x16x32_bf16 v[216:219], a[148:151], a[228:231], v[216:219]
    buffer_load_dwordx4 v37, s[8:11], s3 offen offset:1024  lds
    v_mfma_f32_16x16x32_bf16 v[220:223], a[148:151], a[252:255], v[220:223]
    ds_read_b128 a[76:79], v43 offset:12288
    v_perm_b32 v7, v116, v35, s38
    v_mfma_f32_16x16x32_bf16 v[220:223], a[144:147], a[248:251], v[220:223]
    s_waitcnt lgkmcnt(8)
    ds_read_b32 a99, v63
    v_perm_b32 v27, v116, v35, s39
    v_mfma_f32_16x16x32_bf16 v[128:131], a[184:187], a[48:51], v[128:131]
    ds_read_b128 a[80:83], v42 offset:14336
    v_perm_b32 v29, v113, v35, s36
    v_mfma_f32_16x16x32_bf16 v[128:131], a[188:191], a[52:55], v[128:131]
    ds_read_b32 a100, v31
    ds_read_b32 a101, v6
    v_mfma_f32_16x16x32_bf16 v[132:135], a[188:191], a[20:23], v[132:135]
    ds_read_b128 a[84:87], v43 offset:14336
    v_perm_b32 v57, v113, v35, s37
    v_mfma_f32_16x16x32_bf16 v[132:135], a[184:187], a[16:19], v[132:135]
    ds_read_b32 a102, v7
    ds_read_b32 a103, v27
    v_mfma_f32_16x16x32_bf16 v[136:139], a[184:187], a[216:219], v[136:139]
    buffer_load_dwordx4 v38, s[8:11], s3 offen offset:2048  lds
    v_mfma_f32_16x16x32_bf16 v[136:139], a[188:191], a[220:223], v[136:139]
    s_waitcnt vmcnt(16)
    v_perm_b32 v58, v113, v35, s38
    v_bitop3_b32 v46, v123, v127, s76 bitop3:0x7e
    v_mfma_f32_16x16x32_bf16 v[140:143], a[188:191], a[236:239], v[140:143]
    v_cmp_lt_u32 vcc, 0xffff, v46
    v_perm_b32 v56, v113, v35, s39
    v_mfma_f32_16x16x32_bf16 v[140:143], a[184:187], a[232:235], v[140:143]
    ds_read_b32 a176, v29
    v_perm_b32 v61, v117, v35, s36
    v_mfma_f32_16x16x32_bf16 v[144:147], a[184:187], a[40:43], v[144:147]
    ds_read_b32 a177, v57
    s_cbranch_vccnz L_slow5_1
L_back5_1:
    v_mfma_f32_16x16x32_bf16 v[144:147], a[188:191], a[44:47], v[144:147]
    s_waitcnt lgkmcnt(7)
    v_perm_b32 v60, v117, v35, s37
    v_perm_b32 v59, v117, v35, s38
    v_mfma_f32_16x16x32_bf16 v[148:151], a[188:191], a[60:63], v[148:151]
    ds_read_b32 a178, v58
    v_perm_b32 v5, v117, v35, s39
    v_mfma_f32_16x16x32_bf16 v[148:151], a[184:187], a[56:59], v[148:151]
    s_waitcnt lgkmcnt(5)
    ds_read_b32 a179, v56
    ds_read_b128 a[136:139], v42 offset:16384
    v_mfma_f32_16x16x32_bf16 v[152:155], a[184:187], a[72:75], v[152:155]
    buffer_load_dwordx4 v39, s[8:11], s3 offen offset:3072  lds
    v_mfma_f32_16x16x32_bf16 v[152:155], a[188:191], a[76:79], v[152:155]
    s_add_u32 m0, s57, 65536
    ds_read_b128 a[140:143], v43 offset:16384
    v_perm_b32 v62, v114, v35, s36
    v_mfma_f32_16x16x32_bf16 v[156:159], a[188:191], a[84:87], v[156:159]
    s_add_u32 s3, s69, 1792
    ds_read_b128 a[88:91], v42 offset:18432
    ds_read_b32 a180, v61
    v_mfma_f32_16x16x32_bf16 v[156:159], a[184:187], a[80:83], v[156:159]
    ds_read_b128 a[92:95], v43 offset:18432
    v_perm_b32 v63, v114, v35, s37
    v_mfma_f32_16x16x32_bf16 v[160:163], a[200:203], a[48:51], v[160:163]
    ds_read_b32 a181, v60
    ds_read_b32 a182, v59
    v_mfma_f32_16x16x32_bf16 v[160:163], a[204:207], a[52:55], v[160:163]
    ds_read_b32 a183, v5
    v_perm_b32 v31, v114, v35, s38
    v_mfma_f32_16x16x32_bf16 v[164:167], a[204:207], a[20:23], v[164:167]
    ds_read_b128 a[120:123], v42 offset:20480
    v_perm_b32 v6, v114, v35, s39
    v_mfma_f32_16x16x32_bf16 v[164:167], a[200:203], a[16:19], v[164:167]
    ds_read_b32 a128, v62
    v_perm_b32 v7, v118, v35, s36
    v_mfma_f32_16x16x32_bf16 v[168:171], a[200:203], a[216:219], v[168:171]
    ds_read_b32 a129, v63
    v_perm_b32 v27, v118, v35, s37
    v_mfma_f32_16x16x32_bf16 v[168:171], a[204:207], a[220:223], v[168:171]
    ds_read_b128 a[124:127], v43 offset:20480
    ds_read_b32 a130, v31
    v_mfma_f32_16x16x32_bf16 v[172:175], a[204:207], a[236:239], v[172:175]
    buffer_load_dwordx4 v[64:67], v22, s[32:35], 0 offen
    v_mfma_f32_16x16x32_bf16 v[172:175], a[200:203], a[232:235], v[172:175]
    v_perm_b32 v46, v118, v35, s38
    v_perm_b32 v29, v118, v35, s39
    v_mfma_f32_16x16x32_bf16 v[176:179], a[200:203], a[40:43], v[176:179]
    ds_read_b128 a[104:107], v42 offset:22528
    ds_read_b32 a131, v6
    v_mfma_f32_16x16x32_bf16 v[176:179], a[204:207], a[44:47], v[176:179]
    ds_read_b32 a132, v7
    ds_read_b32 a133, v27
    v_mfma_f32_16x16x32_bf16 v[180:183], a[204:207], a[60:63], v[180:183]
    buffer_load_dwordx4 v[68:71], v32, s[12:15], s72 offen sc1
    v_mfma_f32_16x16x32_bf16 v[180:183], a[200:203], a[56:59], v[180:183]
    ds_read_b128 a[108:111], v43 offset:22528
    v_perm_b32 v57, v115, v35, s36
    v_mfma_f32_16x16x32_bf16 v[184:187], a[200:203], a[72:75], v[184:187]
    v_perm_b32 v58, v115, v35, s37
    v_perm_b32 v56, v119, v35, s36
    v_mfma_f32_16x16x32_bf16 v[184:187], a[204:207], a[76:79], v[184:187]
    ds_read_b32 a134, v46
    ds_read_b32 a135, v29
    v_mfma_f32_16x16x32_bf16 v[188:191], a[204:207], a[84:87], v[188:191]
    buffer_load_dwordx4 v[72:75], v33, s[12:15], s72 offen sc1
    v_mfma_f32_16x16x32_bf16 v[188:191], a[200:203], a[80:83], v[188:191]
    ds_read_b128 a[112:115], v42 offset:24576
    v_perm_b32 v61, v119, v35, s37
    v_mfma_f32_16x16x32_bf16 v[192:195], a[240:243], a[48:51], v[192:195]
    v_perm_b32 v60, v123, v35, s36
    v_perm_b32 v59, v123, v35, s37
    v_mfma_f32_16x16x32_bf16 v[192:195], a[244:247], a[52:55], v[192:195]
    ds_read_b128 a[116:119], v43 offset:24576
    ds_read_b32 a152, v57
    v_mfma_f32_16x16x32_bf16 v[196:199], a[244:247], a[20:23], v[196:199]
    buffer_load_dwordx4 v[76:79], v34, s[12:15], s72 offen sc1
    v_mfma_f32_16x16x32_bf16 v[196:199], a[240:243], a[16:19], v[196:199]
    ds_read_b32 a153, v58
    ds_read_b32 a154, v56
    v_mfma_f32_16x16x32_bf16 v[200:203], a[240:243], a[216:219], v[200:203]
    ds_read_b128 a[160:163], v42 offset:26624
    v_perm_b32 v5, v127, v35, s36
    v_mfma_f32_16x16x32_bf16 v[200:203], a[244:247], a[220:223], v[200:203]
    ds_read_b32 a155, v61
    ds_read_b32 a156, v60
    v_mfma_f32_16x16x32_bf16 v[204:207], a[244:247], a[236:239], v[204:207]
    buffer_load_dwordx4 v[100:103], v44, s[12:15], s72 offen sc1
    v_mfma_f32_16x16x32_bf16 v[204:207], a[240:243], a[232:235], v[204:207]
    ds_read_b128 a[164:167], v43 offset:26624
    v_perm_b32 v62, v127, v35, s37
    v_mfma_f32_16x16x32_bf16 v[208:211], a[240:243], a[40:43], v[208:211]
    ds_read_b32 a157, v59
    v_perm_b32 v63, v120, v35, s36
    v_mfma_f32_16x16x32_bf16 v[208:211], a[244:247], a[44:47], v[208:211]
    ds_read_b32 a158, v5
    ds_read_b32 a159, v62
    v_mfma_f32_16x16x32_bf16 v[212:215], a[244:247], a[60:63], v[212:215]
    buffer_load_dwordx2 v[80:81], v22, s[32:35], 0 offen offset:16
    v_mfma_f32_16x16x32_bf16 v[212:215], a[240:243], a[56:59], v[212:215]
    ds_read_b128 a[168:171], v42 offset:28672
    v_perm_b32 v31, v120, v35, s37
    v_mfma_f32_16x16x32_bf16 v[216:219], a[240:243], a[72:75], v[216:219]
    v_perm_b32 v6, v120, v35, s38
    v_perm_b32 v7, v120, v35, s39
    v_mfma_f32_16x16x32_bf16 v[216:219], a[244:247], a[76:79], v[216:219]
    ds_read_b128 a[172:175], v43 offset:28672
    ds_read_b32 a64, v63
    v_mfma_f32_16x16x32_bf16 v[220:223], a[244:247], a[84:87], v[220:223]
    buffer_load_dword v82, v23, s[32:35], 0 offen
    v_mfma_f32_16x16x32_bf16 v[220:223], a[240:243], a[80:83], v[220:223]
    v_perm_b32 v27, v124, v35, s36
    v_perm_b32 v46, v124, v35, s37
    v_mfma_f32_16x16x32_bf16 v[224:227], a[32:35], a[50:53], v[224:227]
    s_waitcnt lgkmcnt(6)
    ds_read_b128 a[192:195], v42 offset:30720
    v_perm_b32 v29, v124, v35, s38
    v_mfma_f32_16x16x32_bf16 v[224:227], a[36:39], a[138:141], v[224:227]
    s_waitcnt vmcnt(17)
    v_bitop3_b32 v57, v91, v95, s76 bitop3:0x7e
    v_perm_b32 v58, v124, v35, s39
    v_mfma_f32_16x16x32_bf16 v[228:231], a[36:39], a[90:93], v[228:231]
    ds_read_b128 a[196:199], v43 offset:30720
    v_cmp_lt_u32 vcc, 0xffff, v57
    v_mfma_f32_16x16x32_bf16 v[228:231], a[32:35], a[18:21], v[228:231]
    ds_read_b32 a65, v31
    v_perm_b32 v56, v121, v35, s36
    v_mfma_f32_16x16x32_bf16 v[232:235], a[32:35], a[218:221], v[232:235]
    ds_read_b32 a66, v6
    s_cbranch_vccnz L_slow6_0
L_back6_0:
    v_mfma_f32_16x16x32_bf16 v[232:235], a[36:39], a[122:125], v[232:235]
    ds_read_b32 a67, v7
    v_perm_b32 v61, v121, v35, s37
    v_mfma_f32_16x16x32_bf16 v[236:239], a[36:39], a[106:109], v[236:239]
    s_waitcnt vmcnt(15)
    v_perm_b32 v59, v121, v35, s38
    v_bitop3_b32 v60, v51, v55, s76 bitop3:0x7e
    v_mfma_f32_16x16x32_bf16 v[236:239], a[32:35], a[234:237], v[236:239]
    ds_read_b32 a68, v27
    v_cmp_lt_u32 vcc, 0xffff, v60
    v_mfma_f32_16x16x32_bf16 v[240:243], a[32:35], a[42:45], v[240:243]
    ds_read_b32 a69, v46
    ds_read_b32 a70, v29
    v_mfma_f32_16x16x32_bf16 v[240:243], a[36:39], a[114:117], v[240:243]
    v_perm_b32 v5, v121, v35, s39
    s_cbranch_vccnz L_slow6_1
L_back6_1:
    v_mfma_f32_16x16x32_bf16 v[244:247], a[36:39], a[162:165], v[244:247]
    ds_read_b32 a71, v58
    v_perm_b32 v62, v125, v35, s36
    v_mfma_f32_16x16x32_bf16 v[244:247], a[32:35], a[58:61], v[244:247]
    s_waitcnt lgkmcnt(7)
    ds_read_b32 a208, v56
    v_perm_b32 v63, v125, v35, s37
    v_mfma_f32_16x16x32_bf16 v[248:251], a[32:35], a[74:77], v[248:251]
    s_barrier
L_pad3:
    s_cbranch_execz L_pad4
    v_mfma_f32_16x16x32_bf16 v[248:251], a[36:39], a[170:173], v[248:251]
    buffer_load_dwordx4 v36, s[8:11], s56 offen offset:0  lds
    v_mfma_f32_16x16x32_bf16 v[252:255], a[36:39], a[194:197], v[252:255]
    ds_read_b32 a209, v61
    v_perm_b32 v57, v125, v35, s38
    v_mfma_f32_16x16x32_bf16 v[252:255], a[32:35], a[82:85], v[252:255]
    ds_read_b32 a210, v59
    v_perm_b32 v31, v125, v35, s39
    v_mfma_f32_16x16x32_bf16 v[128:131], a[0:3], a[136:139], v[128:131]
    ds_read_b32 a211, v5
    ds_read_b32 a212, v62
    v_mfma_f32_16x16x32_bf16 v[128:131], a[4:7], a[140:143], v[128:131]
    buffer_load_dwordx4 v37, s[8:11], s56 offen offset:1024  lds
    v_mfma_f32_16x16x32_bf16 v[132:135], a[4:7], a[92:95], v[132:135]
    v_perm_b32 v6, v122, v35, s36
    v_perm_b32 v7, v122, v35, s37
    v_mfma_f32_16x16x32_bf16 v[132:135], a[0:3], a[88:91], v[132:135]
    ds_read_b32 a213, v63
    v_perm_b32 v27, v122, v35, s38
    v_mfma_f32_16x16x32_bf16 v[136:139], a[0:3], a[120:123], v[136:139]
    ds_read_b32 a214, v57
    ds_read_b32 a215, v31
    v_mfma_f32_16x16x32_bf16 v[136:139], a[4:7], a[124:127], v[136:139]
    buffer_load_dwordx4 v38, s[8:11], s56 offen offset:2048  lds
    v_mfma_f32_16x16x32_bf16 v[140:143], a[4:7], a[108:111], v[140:143]
    v_perm_b32 v60, v122, v35, s39
    v_perm_b32 v46, v126, v35, s36
    v_mfma_f32_16x16x32_bf16 v[140:143], a[0:3], a[104:107], v[140:143]
    v_perm_b32 v29, v126, v35, s37
    v_perm_b32 v58, v126, v35, s38
    v_mfma_f32_16x16x32_bf16 v[144:147], a[0:3], a[112:115], v[144:147]
    ds_read_b32 a224, v6
    ds_read_b32 a225, v7
    v_mfma_f32_16x16x32_bf16 v[144:147], a[4:7], a[116:119], v[144:147]
    buffer_load_dwordx4 v39, s[8:11], s56 offen offset:3072  lds
    v_mfma_f32_16x16x32_bf16 v[148:151], a[4:7], a[164:167], v[148:151]
    s_add_u32 m0, s57, 81920
    ds_read_b32 a226, v27
    v_perm_b32 v56, v126, v35, s39
    v_mfma_f32_16x16x32_bf16 v[148:151], a[0:3], a[160:163], v[148:151]
    ds_read_b128 a[144:147], v40 offset:0
    v_perm_b32 v61, v91, v35, s36
    v_mfma_f32_16x16x32_bf16 v[152:155], a[0:3], a[168:171], v[152:155]
    ds_read_b128 a[148:151], v41 offset:0
    ds_read_b32 a227, v60
    v_mfma_f32_16x16x32_bf16 v[152:155], a[4:7], a[172:175], v[152:155]
    buffer_load_dwordx4 v36, s[8:11], s3 offen offset:0  lds
    v_mfma_f32_16x16x32_bf16 v[156:159], a[4:7], a[196:199], v[156:159]
    ds_read_b128 a[248:251], v40 offset:2048
    v_perm_b32 v59, v91, v35, s37
    v_mfma_f32_16x16x32_bf16 v[156:159], a[0:3], a[192:195], v[156:159]
    ds_read_b128 a[252:255], v41 offset:2048
    ds_read_b32 a228, v46
    v_mfma_f32_16x16x32_bf16 v[160:163], a[24:27], a[136:139], v[160:163]
    ds_read_b32 a229, v29
    ds_read_b32 a230, v58
    v_mfma_f32_16x16x32_bf16 v[160:163], a[28:31], a[140:143], v[160:163]
    buffer_load_dwordx4 v37, s[8:11], s3 offen offset:1024  lds
    v_mfma_f32_16x16x32_bf16 v[164:167], a[28:31], a[92:95], v[164:167]
    ds_read_b128 a[184:187], v40 offset:4096
    v_perm_b32 v5, v95, v35, s36
    v_mfma_f32_16x16x32_bf16 v[164:167], a[24:27], a[88:91], v[164:167]
    ds_read_b32 a231, v56
    v_perm_b32 v62, v95, v35, s37
    v_mfma_f32_16x16x32_bf16 v[168:171], a[24:27], a[120:123], v[168:171]
    ds_read_b32 a200, v61
    ds_read_b32 a201, v59
    v_mfma_f32_16x16x32_bf16 v[168:171], a[28:31], a[124:127], v[168:171]
    buffer_load_dwordx4 v38, s[8:11], s3 offen offset:2048  lds
    v_mfma_f32_16x16x32_bf16 v[172:175], a[28:31], a[108:111], v[172:175]
    ds_read_b128 a[188:191], v41 offset:4096
    v_perm_b32 v63, v51, v35, s36
    v_mfma_f32_16x16x32_bf16 v[172:175], a[24:27], a[104:107], v[172:175]
    v_perm_b32 v57, v51, v35, s37
    v_perm_b32 v31, v55, v35, s36
    v_mfma_f32_16x16x32_bf16 v[176:179], a[24:27], a[112:115], v[176:179]
    ds_read_b128 a[240:243], v40 offset:6144
    v_perm_b32 v6, v55, v35, s37
    v_mfma_f32_16x16x32_bf16 v[176:179], a[28:31], a[116:119], v[176:179]
    ds_read_b32 a202, v5
    ds_read_b32 a203, v62
    v_mfma_f32_16x16x32_bf16 v[180:183], a[28:31], a[164:167], v[180:183]
    buffer_load_dwordx4 v39, s[8:11], s3 offen offset:3072  lds
    v_mfma_f32_16x16x32_bf16 v[180:183], a[24:27], a[160:163], v[180:183]
    ds_read_b128 a[244:247], v41 offset:6144
    v_perm_b32 v7, v88, v35, s36
    v_mfma_f32_16x16x32_bf16 v[184:187], a[24:27], a[168:171], v[184:187]
    v_perm_b32 v27, v88, v35, s37
    v_perm_b32 v60, v88, v35, s38
    v_mfma_f32_16x16x32_bf16 v[184:187], a[28:31], a[172:175], v[184:187]
    ds_read_b32 a204, v63
    v_perm_b32 v46, v88, v35, s39
    v_mfma_f32_16x16x32_bf16 v[188:191], a[28:31], a[196:199], v[188:191]
    ds_read_b128 a[48:51], v40 offset:8192
    v_perm_b32 v29, v92, v35, s36
    v_mfma_f32_16x16x32_bf16 v[188:191], a[24:27], a[192:195], v[188:191]
    ds_read_b32 a205, v57
    ds_read_b32 a206, v31
    v_mfma_f32_16x16x32_bf16 v[192:195], a[8:11], a[136:139], v[192:195]
    ds_read_b32 a207, v6
    v_perm_b32 v58, v92, v35, s37
    v_mfma_f32_16x16x32_bf16 v[192:195], a[12:15], a[140:143], v[192:195]
    ds_read_b128 a[52:55], v41 offset:8192
    v_perm_b32 v56, v92, v35, s38
    v_mfma_f32_16x16x32_bf16 v[196:199], a[12:15], a[92:95], v[196:199]
    ds_read_b32 a16, v7
    v_perm_b32 v61, v92, v35, s39
    v_mfma_f32_16x16x32_bf16 v[196:199], a[8:11], a[88:91], v[196:199]
    ds_read_b32 a17, v27
    ds_read_b32 a18, v60
    v_mfma_f32_16x16x32_bf16 v[200:203], a[8:11], a[120:123], v[200:203]
    ds_read_b128 a[216:219], v40 offset:10240
    v_perm_b32 v59, v48, v35, s36
    v_mfma_f32_16x16x32_bf16 v[200:203], a[12:15], a[124:127], v[200:203]
    ds_read_b32 a19, v46
    ds_read_b32 a20, v29
    v_mfma_f32_16x16x32_bf16 v[204:207], a[12:15], a[108:111], v[204:207]
    v_perm_b32 v5, v48, v35, s37
    v_perm_b32 v62, v48, v35, s38
    v_mfma_f32_16x16x32_bf16 v[204:207], a[8:11], a[104:107], v[204:207]
    ds_read_b128 a[220:223], v41 offset:10240
    ds_read_b32 a21, v58
    v_mfma_f32_16x16x32_bf16 v[208:211], a[8:11], a[112:115], v[208:211]
    ds_read_b32 a22, v56
    v_perm_b32 v63, v48, v35, s39
    v_mfma_f32_16x16x32_bf16 v[208:211], a[12:15], a[116:119], v[208:211]
    ds_read_b32 a23, v61
    v_perm_b32 v57, v52, v35, s36
    v_mfma_f32_16x16x32_bf16 v[212:215], a[12:15], a[164:167], v[212:215]
    ds_read_b128 a[232:235], v40 offset:12288
    ds_read_b32 a40, v59
    v_mfma_f32_16x16x32_bf16 v[212:215], a[8:11], a[160:163], v[212:215]
    ds_read_b32 a41, v5
    v_perm_b32 v31, v52, v35, s37
    v_mfma_f32_16x16x32_bf16 v[216:219], a[8:11], a[168:171], v[216:219]
    ds_read_b32 a42, v62
    v_perm_b32 v6, v52, v35, s38
    v_mfma_f32_16x16x32_bf16 v[216:219], a[12:15], a[172:175], v[216:219]
    ds_read_b128 a[236:239], v41 offset:12288
    v_perm_b32 v7, v52, v35, s39
    v_mfma_f32_16x16x32_bf16 v[220:223], a[12:15], a[196:199], v[220:223]
    ds_read_b32 a43, v63
    ds_read_b32 a44, v57
    v_mfma_f32_16x16x32_bf16 v[220:223], a[8:11], a[192:195], v[220:223]
    s_waitcnt lgkmcnt(11)
    v_perm_b32 v27, v89, v35, s36
    v_perm_b32 v60, v89, v35, s37
    v_mfma_f32_16x16x32_bf16 v[128:131], a[96:99], a[144:147], v[128:131]
    ds_read_b32 a45, v31
    ds_read_b32 a46, v6
    v_mfma_f32_16x16x32_bf16 v[128:131], a[100:103], a[148:151], v[128:131]
    ds_read_b32 a47, v7
    v_perm_b32 v46, v89, v35, s38
    v_mfma_f32_16x16x32_bf16 v[132:135], a[100:103], a[252:255], v[132:135]
    ds_read_b32 a56, v27
    v_perm_b32 v29, v89, v35, s39
    v_mfma_f32_16x16x32_bf16 v[132:135], a[96:99], a[248:251], v[132:135]
    ds_read_b32 a57, v60
    v_perm_b32 v58, v93, v35, s36
    v_mfma_f32_16x16x32_bf16 v[136:139], a[96:99], a[184:187], v[136:139]
    ds_read_b32 a58, v46
    v_perm_b32 v56, v93, v35, s37
    v_mfma_f32_16x16x32_bf16 v[136:139], a[100:103], a[188:191], v[136:139]
    ds_read_b32 a59, v29
    v_perm_b32 v61, v93, v35, s38
    v_mfma_f32_16x16x32_bf16 v[140:143], a[100:103], a[244:247], v[140:143]
    ds_read_b128 a[72:75], v40 offset:16384
    v_perm_b32 v59, v93, v35, s39
    v_mfma_f32_16x16x32_bf16 v[140:143], a[96:99], a[240:243], v[140:143]
    ds_read_b32 a60, v58
    v_perm_b32 v5, v49, v35, s36
    v_mfma_f32_16x16x32_bf16 v[144:147], a[96:99], a[48:51], v[144:147]
    ds_read_b32 a61, v56
    v_perm_b32 v62, v49, v35, s37
    v_mfma_f32_16x16x32_bf16 v[144:147], a[100:103], a[52:55], v[144:147]
    s_waitcnt lgkmcnt(8)
    ds_read_b128 a[76:79], v41 offset:16384
    ds_read_b32 a62, v61
    v_mfma_f32_16x16x32_bf16 v[148:151], a[100:103], a[220:223], v[148:151]
    ds_read_b32 a63, v59
    v_perm_b32 v63, v49, v35, s38
    v_mfma_f32_16x16x32_bf16 v[148:151], a[96:99], a[216:219], v[148:151]
    ds_read_b32 a32, v5
    v_perm_b32 v57, v49, v35, s39
    v_mfma_f32_16x16x32_bf16 v[152:155], a[96:99], a[232:235], v[152:155]
    ds_read_b128 a[80:83], v40 offset:18432
    ds_read_b32 a33, v62
    v_mfma_f32_16x16x32_bf16 v[152:155], a[100:103], a[236:239], v[152:155]
    ds_read_b32 a34, v63
    v_perm_b32 v31, v53, v35, s36
    v_mfma_f32_16x16x32_bf16 v[160:163], a[176:179], a[144:147], v[160:163]
    ds_read_b32 a35, v57
    v_perm_b32 v6, v53, v35, s37
    v_mfma_f32_16x16x32_bf16 v[160:163], a[180:183], a[148:151], v[160:163]
    ds_read_b128 a[84:87], v41 offset:18432
    v_perm_b32 v7, v53, v35, s38
    v_mfma_f32_16x16x32_bf16 v[164:167], a[180:183], a[252:255], v[164:167]
    s_waitcnt vmcnt(12)
    ds_read_b32 a36, v31
    v_bitop3_b32 v27, v71, v75, s76 bitop3:0x7e
    v_mfma_f32_16x16x32_bf16 v[164:167], a[176:179], a[248:251], v[164:167]
    ds_read_b32 a37, v6
    v_cmp_lt_u32 vcc, 0xffff, v27
    v_mfma_f32_16x16x32_bf16 v[168:171], a[176:179], a[184:187], v[168:171]
    ds_read_b128 a[0:3], v40 offset:20480
    v_perm_b32 v60, v53, v35, s39
    v_mfma_f32_16x16x32_bf16 v[168:171], a[180:183], a[188:191], v[168:171]
    ds_read_b32 a38, v7
    s_cbranch_vccnz L_slow7_0
L_back7_0:
    v_mfma_f32_16x16x32_bf16 v[172:175], a[180:183], a[244:247], v[172:175]
    ds_read_b32 a39, v60
    v_perm_b32 v46, v90, v35, s36
    v_mfma_f32_16x16x32_bf16 v[172:175], a[176:179], a[240:243], v[172:175]
    ds_read_b128 a[4:7], v41 offset:20480
    v_perm_b32 v29, v90, v35, s37
    v_mfma_f32_16x16x32_bf16 v[176:179], a[176:179], a[48:51], v[176:179]
    ds_read_b32 a24, v46
    v_perm_b32 v58, v90, v35, s38
    v_mfma_f32_16x16x32_bf16 v[176:179], a[180:183], a[52:55], v[176:179]
    s_waitcnt vmcnt(10)
    ds_read_b32 a25, v29
    v_bitop3_b32 v56, v79, v103, s76 bitop3:0x7e
    v_mfma_f32_16x16x32_bf16 v[180:183], a[180:183], a[220:223], v[180:183]
    ds_read_b128 a[136:139], v40 offset:22528
    v_cmp_lt_u32 vcc, 0xffff, v56
    v_mfma_f32_16x16x32_bf16 v[180:183], a[176:179], a[216:219], v[180:183]
    ds_read_b32 a26, v58
    v_perm_b32 v61, v90, v35, s39
    v_mfma_f32_16x16x32_bf16 v[184:187], a[176:179], a[232:235], v[184:187]
    v_perm_b32 v59, v94, v35, s36
    s_cbranch_vccnz L_slow7_1
L_back7_1:
    v_mfma_f32_16x16x32_bf16 v[184:187], a[180:183], a[236:239], v[184:187]
    ds_read_b128 a[140:143], v41 offset:22528
    v_perm_b32 v5, v94, v35, s37
    v_mfma_f32_16x16x32_bf16 v[192:195], a[128:131], a[144:147], v[192:195]
    ds_read_b32 a27, v61
    v_perm_b32 v62, v94, v35, s38
    v_mfma_f32_16x16x32_bf16 v[192:195], a[132:135], a[148:151], v[192:195]
    ds_read_b32 a28, v59
    v_perm_b32 v63, v94, v35, s39
    v_mfma_f32_16x16x32_bf16 v[196:199], a[132:135], a[252:255], v[196:199]
    ds_read_b128 a[88:91], v40 offset:24576
    v_perm_b32 v57, v50, v35, s36
    v_mfma_f32_16x16x32_bf16 v[196:199], a[128:131], a[248:251], v[196:199]
    ds_read_b32 a29, v5
    v_perm_b32 v31, v50, v35, s37
    v_mfma_f32_16x16x32_bf16 v[200:203], a[128:131], a[184:187], v[200:203]
    ds_read_b32 a30, v62
    v_perm_b32 v6, v50, v35, s38
    v_mfma_f32_16x16x32_bf16 v[200:203], a[132:135], a[188:191], v[200:203]
    ds_read_b128 a[92:95], v41 offset:24576
    ds_read_b32 a31, v63
    v_mfma_f32_16x16x32_bf16 v[204:207], a[132:135], a[244:247], v[204:207]
    ds_read_b32 a120, v57
    v_perm_b32 v27, v50, v35, s39
    v_mfma_f32_16x16x32_bf16 v[204:207], a[128:131], a[240:243], v[204:207]
    ds_read_b32 a121, v31
    v_perm_b32 v7, v54, v35, s36
    v_mfma_f32_16x16x32_bf16 v[208:211], a[128:131], a[48:51], v[208:211]
    ds_read_b128 a[104:107], v40 offset:26624
    ds_read_b32 a122, v6
    v_mfma_f32_16x16x32_bf16 v[208:211], a[132:135], a[52:55], v[208:211]
    ds_read_b32 a123, v27
    v_perm_b32 v60, v54, v35, s37
    v_mfma_f32_16x16x32_bf16 v[212:215], a[132:135], a[220:223], v[212:215]
    ds_read_b32 a124, v7
    v_perm_b32 v46, v54, v35, s38
    v_mfma_f32_16x16x32_bf16 v[212:215], a[128:131], a[216:219], v[212:215]
    ds_read_b128 a[108:111], v41 offset:26624
    v_perm_b32 v29, v54, v35, s39
    v_mfma_f32_16x16x32_bf16 v[216:219], a[128:131], a[232:235], v[216:219]
    ds_read_b32 a125, v60
    v_perm_b32 v56, v71, v35, s36
    v_mfma_f32_16x16x32_bf16 v[216:219], a[132:135], a[236:239], v[216:219]
    ds_read_b32 a126, v46
    v_perm_b32 v58, v71, v35, s37
    v_mfma_f32_16x16x32_bf16 v[224:227], a[152:155], a[146:149], v[224:227]
    s_waitcnt lgkmcnt(9)
    ds_read_b128 a[112:115], v40 offset:28672
    v_perm_b32 v61, v75, v35, s36
    v_mfma_f32_16x16x32_bf16 v[224:227], a[156:159], a[74:77], v[224:227]
    ds_read_b128 a[116:119], v41 offset:28672
    ds_read_b32 a127, v29
    v_mfma_f32_16x16x32_bf16 v[228:231], a[156:159], a[82:85], v[228:231]
    ds_read_b32 a160, v56
    v_perm_b32 v59, v75, v35, s37
    v_mfma_f32_16x16x32_bf16 v[228:231], a[152:155], a[250:253], v[228:231]
    ds_read_b32 a161, v58
    v_perm_b32 v5, v79, v35, s36
    v_mfma_f32_16x16x32_bf16 v[232:235], a[152:155], a[186:189], v[232:235]
    ds_read_b32 a162, v61
    v_perm_b32 v62, v79, v35, s37
    v_mfma_f32_16x16x32_bf16 v[232:235], a[156:159], a[2:5], v[232:235]
    ds_read_b32 a163, v59
    v_perm_b32 v63, v103, v35, s36
    v_mfma_f32_16x16x32_bf16 v[236:239], a[156:159], a[138:141], v[236:239]
    ds_read_b32 a164, v5
    v_perm_b32 v57, v103, v35, s37
    v_mfma_f32_16x16x32_bf16 v[236:239], a[152:155], a[242:245], v[236:239]
    ds_read_b32 a165, v62
    v_perm_b32 v31, v68, v35, s36
    v_mfma_f32_16x16x32_bf16 v[240:243], a[152:155], a[50:53], v[240:243]
    ds_read_b32 a166, v63
    v_perm_b32 v6, v68, v35, s37
    v_mfma_f32_16x16x32_bf16 v[240:243], a[156:159], a[90:93], v[240:243]
    s_waitcnt lgkmcnt(9)
    ds_read_b32 a167, v57
    v_perm_b32 v27, v68, v35, s38
    v_mfma_f32_16x16x32_bf16 v[244:247], a[156:159], a[106:109], v[244:247]
    ds_read_b32 a168, v31
    v_perm_b32 v7, v68, v35, s39
    v_mfma_f32_16x16x32_bf16 v[244:247], a[152:155], a[218:221], v[244:247]
    ds_read_b32 a169, v6
    v_perm_b32 v60, v72, v35, s36
    v_mfma_f32_16x16x32_bf16 v[248:251], a[152:155], a[234:237], v[248:251]
    s_waitcnt lgkmcnt(8)
    ds_read_b32 a170, v27
    v_perm_b32 v46, v72, v35, s37
    v_mfma_f32_16x16x32_bf16 v[248:251], a[156:159], a[114:117], v[248:251]
    ds_read_b32 a171, v7
    v_perm_b32 v29, v72, v35, s38
    v_mfma_f32_16x16x32_bf16 v[128:131], a[64:67], a[72:75], v[128:131]
    ds_read_b32 a172, v60
    v_perm_b32 v56, v72, v35, s39
    v_mfma_f32_16x16x32_bf16 v[128:131], a[68:71], a[76:79], v[128:131]
    ds_read_b32 a173, v46
    v_perm_b32 v58, v76, v35, s36
    v_mfma_f32_16x16x32_bf16 v[132:135], a[68:71], a[84:87], v[132:135]
    ds_read_b32 a174, v29
    v_perm_b32 v61, v76, v35, s37
    v_mfma_f32_16x16x32_bf16 v[132:135], a[64:67], a[80:83], v[132:135]
    ds_read_b32 a175, v56
    v_perm_b32 v59, v76, v35, s38
    v_mfma_f32_16x16x32_bf16 v[136:139], a[64:67], a[0:3], v[136:139]
    ds_read_b32 a8, v58
    v_perm_b32 v5, v76, v35, s39
    v_mfma_f32_16x16x32_bf16 v[136:139], a[68:71], a[4:7], v[136:139]
    ds_read_b32 a9, v61
    v_perm_b32 v62, v100, v35, s36
    v_mfma_f32_16x16x32_bf16 v[140:143], a[68:71], a[140:143], v[140:143]
    ds_read_b32 a10, v59
    v_perm_b32 v63, v100, v35, s37
    v_mfma_f32_16x16x32_bf16 v[140:143], a[64:67], a[136:139], v[140:143]
    s_waitcnt vmcnt(0)
    ds_read_b32 a11, v5
    v_perm_b32 v57, v100, v35, s38
    v_mfma_f32_16x16x32_bf16 v[144:147], a[64:67], a[88:91], v[144:147]
    s_barrier
    v_mfma_f32_16x16x32_bf16 v[144:147], a[68:71], a[92:95], v[144:147]
    buffer_atomic_add v45, v1, s[24:27], s77 offen sc0 sc1
    v_mfma_f32_16x16x32_bf16 v[148:151], a[68:71], a[108:111], v[148:151]
    ds_read_b32 a12, v62
    ds_read_b32 a13, v63
    v_mfma_f32_16x16x32_bf16 v[148:151], a[64:67], a[104:107], v[148:151]
    ds_read_b32 a14, v57
    v_perm_b32 v31, v100, v35, s39
    v_mfma_f32_16x16x32_bf16 v[152:155], a[64:67], a[112:115], v[152:155]
    ds_read_b32 a15, v31
    v_perm_b32 v6, v69, v35, s36
    v_mfma_f32_16x16x32_bf16 v[152:155], a[68:71], a[116:119], v[152:155]
    ds_read_b128 a[192:195], v40 offset:32768
    v_perm_b32 v27, v69, v35, s37
    v_mfma_f32_16x16x32_bf16 v[160:163], a[208:211], a[72:75], v[160:163]
    ds_read_b32 a144, v6
    v_perm_b32 v7, v69, v35, s38
    v_mfma_f32_16x16x32_bf16 v[160:163], a[212:215], a[76:79], v[160:163]
    ds_read_b32 a145, v27
    v_perm_b32 v60, v69, v35, s39
    v_mfma_f32_16x16x32_bf16 v[164:167], a[212:215], a[84:87], v[164:167]
    ds_read_b128 a[196:199], v41 offset:32768
    v_perm_b32 v46, v73, v35, s36
    v_mfma_f32_16x16x32_bf16 v[164:167], a[208:211], a[80:83], v[164:167]
    ds_read_b32 a146, v7
    v_perm_b32 v29, v73, v35, s37
    v_mfma_f32_16x16x32_bf16 v[168:171], a[208:211], a[0:3], v[168:171]
    ds_read_b32 a147, v60
    v_perm_b32 v56, v73, v35, s38
    v_mfma_f32_16x16x32_bf16 v[168:171], a[212:215], a[4:7], v[168:171]
    ds_read_b32 a148, v46
    v_perm_b32 v58, v73, v35, s39
    v_mfma_f32_16x16x32_bf16 v[172:175], a[212:215], a[140:143], v[172:175]
    ds_read_b128 a[248:251], v40 offset:49152
    v_perm_b32 v61, v77, v35, s36
    v_mfma_f32_16x16x32_bf16 v[172:175], a[208:211], a[136:139], v[172:175]
    ds_read_b32 a149, v29
    v_perm_b32 v59, v77, v35, s37
    v_mfma_f32_16x16x32_bf16 v[176:179], a[208:211], a[88:91], v[176:179]
    s_mov_b32 m0, s60
    ds_read_b32 a150, v56
    v_perm_b32 v5, v77, v35, s38
    v_mfma_f32_16x16x32_bf16 v[176:179], a[212:215], a[92:95], v[176:179]
    ds_read_b128 a[252:255], v41 offset:49152
    ds_read_b32 a151, v58
    v_mfma_f32_16x16x32_bf16 v[180:183], a[212:215], a[108:111], v[180:183]
    ds_read_b32 a184, v61
    v_perm_b32 v62, v77, v35, s39
    v_mfma_f32_16x16x32_bf16 v[180:183], a[208:211], a[104:107], v[180:183]
    ds_read_b32 a185, v59
    v_perm_b32 v63, v101, v35, s36
    v_mfma_f32_16x16x32_bf16 v[184:187], a[208:211], a[112:115], v[184:187]
    ds_read_b32 a188, v63
    ds_read_b32 a186, v5
    v_mfma_f32_16x16x32_bf16 v[184:187], a[212:215], a[116:119], v[184:187]
    ds_read_b128 a[240:243], v42 offset:0
    v_perm_b32 v57, v101, v35, s37
    v_mfma_f32_16x16x32_bf16 v[192:195], a[224:227], a[72:75], v[192:195]
    ds_read_b32 a189, v57
    ds_read_b32 a187, v62
    v_mfma_f32_16x16x32_bf16 v[192:195], a[228:231], a[76:79], v[192:195]
    ds_read_b128 a[244:247], v43 offset:0
    v_perm_b32 v31, v101, v35, s38
    v_mfma_f32_16x16x32_bf16 v[196:199], a[228:231], a[84:87], v[196:199]
    ds_read_b32 a190, v31
    v_perm_b32 v6, v101, v35, s39
    v_mfma_f32_16x16x32_bf16 v[196:199], a[224:227], a[80:83], v[196:199]
    ds_read_b32 a191, v6
    v_perm_b32 v27, v70, v35, s36
    v_mfma_f32_16x16x32_bf16 v[200:203], a[224:227], a[0:3], v[200:203]
    ds_read_b32 a48, v27
    v_perm_b32 v7, v70, v35, s37
    v_mfma_f32_16x16x32_bf16 v[200:203], a[228:231], a[4:7], v[200:203]
    ds_read_b32 a49, v7
    v_perm_b32 v60, v70, v35, s38
    v_mfma_f32_16x16x32_bf16 v[204:207], a[228:231], a[140:143], v[204:207]
    ds_read_b128 a[216:219], v42 offset:16384
    v_perm_b32 v46, v70, v35, s39
    v_mfma_f32_16x16x32_bf16 v[204:207], a[224:227], a[136:139], v[204:207]
    ds_read_b32 a50, v60
    v_perm_b32 v29, v74, v35, s36
    v_mfma_f32_16x16x32_bf16 v[208:211], a[224:227], a[88:91], v[208:211]
    ds_read_b32 a52, v29
    v_perm_b32 v56, v74, v35, s37
    v_mfma_f32_16x16x32_bf16 v[208:211], a[228:231], a[92:95], v[208:211]
    ds_read_b128 a[220:223], v43 offset:16384
    v_perm_b32 v58, v74, v35, s38
    v_mfma_f32_16x16x32_bf16 v[212:215], a[228:231], a[108:111], v[212:215]
    ds_read_b32 a53, v56
    ds_read_b32 a51, v46
    v_mfma_f32_16x16x32_bf16 v[212:215], a[224:227], a[104:107], v[212:215]
    ds_read_b32 a54, v58
    v_perm_b32 v61, v74, v35, s39
    v_mfma_f32_16x16x32_bf16 v[216:219], a[224:227], a[112:115], v[216:219]
    ds_read_b32 a55, v61
    v_perm_b32 v59, v78, v35, s36
    v_mfma_f32_16x16x32_bf16 v[216:219], a[228:231], a[116:119], v[216:219]
    s_waitcnt lgkmcnt(9)
    ds_read_b128 a[232:235], v40 offset:34816
    v_perm_b32 v5, v78, v35, s37
    v_mfma_f32_16x16x32_bf16 v[224:227], a[200:203], a[194:197], v[224:227]
    s_mov_b32 s66, 0
    ds_read_b32 a72, v59
    v_lshlrev_b32 v84, 16, v82
    v_mfma_f32_16x16x32_bf16 v[224:227], a[204:207], a[250:253], v[224:227]
    s_mov_b32 s67, 14336
    ds_read_b32 a73, v5
    v_perm_b32 v63, v78, v35, s38
    v_mfma_f32_16x16x32_bf16 v[128:131], a[16:19], a[192:195], v[128:131]
    ds_read_b128 a[236:239], v41 offset:34816
    v_perm_b32 v62, v78, v35, s39
    v_mfma_f32_16x16x32_bf16 v[128:131], a[20:23], a[196:199], v[128:131]
    ds_read_b32 a74, v63
    v_and_b32 v85, 0xffff0000, v82
    v_mfma_f32_16x16x32_bf16 v[128:131], a[40:43], a[248:251], v[128:131]
    ds_read_b32 a75, v62
    v_perm_b32 v57, v102, v35, s36
    v_mfma_f32_16x16x32_bf16 v[128:131], a[44:47], a[252:255], v[128:131]
    ds_read_b128 a[80:83], v40 offset:51200
    v_perm_b32 v31, v102, v35, s37
    v_mfma_f32_16x16x32_bf16 v[160:163], a[56:59], a[192:195], v[160:163]
    ds_read_b32 a76, v57
    v_lshlrev_b32 v96, 16, v64
    v_mfma_f32_16x16x32_bf16 v[160:163], a[60:63], a[196:199], v[160:163]
    ds_read_b32 a77, v31
    v_perm_b32 v6, v102, v35, s38
    v_mfma_f32_16x16x32_bf16 v[160:163], a[32:35], a[248:251], v[160:163]
    ds_read_b128 a[84:87], v41 offset:51200
    v_and_b32 v97, 0xffff0000, v65
    v_mfma_f32_16x16x32_bf16 v[160:163], a[36:39], a[252:255], v[160:163]
    ds_read_b32 a78, v6
    v_perm_b32 v27, v102, v35, s39
    v_mfma_f32_16x16x32_bf16 v[192:195], a[24:27], a[192:195], v[192:195]
    ds_read_b128 a[0:3], v42 offset:2048
    v_lshlrev_b32 v98, 16, v67
    v_mfma_f32_16x16x32_bf16 v[192:195], a[28:31], a[196:199], v[192:195]
    ds_read_b32 a79, v27
    v_and_b32 v99, 0xffff0000, v80
    v_mfma_f32_16x16x32_bf16 v[192:195], a[120:123], a[248:251], v[192:195]
    ds_read_b128 a[4:7], v43 offset:2048
    v_and_b32 v104, 0xffff0000, v64
    v_mfma_f32_16x16x32_bf16 v[192:195], a[124:127], a[252:255], v[192:195]
    v_lshlrev_b32 v105, 16, v66
    v_and_b32 v106, 0xffff0000, v67
    v_mfma_f32_16x16x32_bf16 v[224:227], a[160:163], a[242:245], v[224:227]
    s_waitcnt lgkmcnt(7)
    v_lshlrev_b32 v107, 16, v81
    v_lshlrev_b32 v108, 16, v65
    v_mfma_f32_16x16x32_bf16 v[224:227], a[164:167], a[218:221], v[224:227]
    ds_read_b128 a[136:139], v42 offset:18432
    v_and_b32 v109, 0xffff0000, v66
    v_mfma_f32_16x16x32_bf16 v[128:131], a[168:171], a[240:243], v[128:131]
    v_lshlrev_b32 v110, 16, v80
    v_and_b32 v111, 0xffff0000, v81
    v_mfma_f32_16x16x32_bf16 v[128:131], a[172:175], a[244:247], v[128:131]
    v_mfma_f32_16x16x32_bf16 v[128:131], a[8:11], a[216:219], v[128:131]
    ds_read_b128 a[140:143], v43 offset:18432
    v_mfma_f32_16x16x32_bf16 v[128:131], a[12:15], a[220:223], v[128:131]
    ds_write_addtid_b32 v226 offset:28928
    ds_write_addtid_b32 v227 offset:29184
    v_mfma_f32_16x16x32_bf16 v[160:163], a[144:147], a[240:243], v[160:163]
    v_mfma_f32_16x16x32_bf16 v[160:163], a[148:151], a[244:247], v[160:163]
    v_mfma_f32_16x16x32_bf16 v[160:163], a[184:187], a[216:219], v[160:163]
    ds_read_b128 a[88:91], v40 offset:36864
    v_mfma_f32_16x16x32_bf16 v[160:163], a[188:191], a[220:223], v[160:163]
    s_nop 0
    v_mul_f32 v128, v128, v96
    v_mul_f32 v129, v129, v97
    v_mfma_f32_16x16x32_bf16 v[192:195], a[48:51], a[240:243], v[192:195]
    s_waitcnt lgkmcnt(1)
    s_barrier
    v_mfma_f32_16x16x32_bf16 v[192:195], a[52:55], a[244:247], v[192:195]
    ds_read2st64_b32 v[112:113], v30 offset0:113 offset1:114
    v_mul_f32 v130, v130, v98
    v_mfma_f32_16x16x32_bf16 v[192:195], a[72:75], a[216:219], v[192:195]
    ds_read_b128 a[92:95], v41 offset:36864
    v_mul_f32 v131, v131, v99
L_pad4:
    s_cbranch_execz L_warmed
    v_mfma_f32_16x16x32_bf16 v[192:195], a[76:79], a[220:223], v[192:195]
    v_mul_f32 v160, v160, v104
    v_cvt_pk_bf16_f32 v116, v128, v160
    v_mfma_f32_16x16x32_bf16 v[228:231], a[200:203], a[234:237], v[228:231]
    v_mul_f32 v161, v161, v105
    v_mul_f32 v162, v162, v106
    v_mfma_f32_16x16x32_bf16 v[228:231], a[204:207], a[82:85], v[228:231]
    ds_read_b128 a[104:107], v40 offset:53248
    v_cvt_pk_bf16_f32 v119, v130, v162
    v_mfma_f32_16x16x32_bf16 v[228:231], a[160:163], a[2:5], v[228:231]
    v_mul_f32 v163, v163, v107
    v_mfma_f32_16x16x32_bf16 v[228:231], a[164:167], a[138:141], v[228:231]
    v_mul_f32 v192, v192, v108
    v_mul_f32 v193, v193, v109
    v_mfma_f32_16x16x32_bf16 v[132:135], a[16:19], a[232:235], v[132:135]
    ds_read_b128 a[108:111], v41 offset:53248
    v_mul_f32 v194, v194, v110
    v_mfma_f32_16x16x32_bf16 v[132:135], a[20:23], a[236:239], v[132:135]
    v_mul_f32 v195, v195, v111
    v_cvt_pk_bf16_f32 v117, v192, v129
    v_mfma_f32_16x16x32_bf16 v[132:135], a[40:43], a[80:83], v[132:135]
    ds_write_b64 v26, v[116:117] offset:64512
    v_mfma_f32_16x16x32_bf16 v[132:135], a[44:47], a[84:87], v[132:135]
    ds_write_addtid_b32 v230 offset:30976
    v_cvt_pk_bf16_f32 v118, v161, v193
    v_mfma_f32_16x16x32_bf16 v[132:135], a[168:171], a[0:3], v[132:135]
    ds_write_b64 v26, v[118:119] offset:64520
    v_mfma_f32_16x16x32_bf16 v[132:135], a[172:175], a[4:7], v[132:135]
    ds_write_addtid_b32 v231 offset:31232
    v_cvt_pk_bf16_f32 v120, v194, v131
    v_mfma_f32_16x16x32_bf16 v[132:135], a[8:11], a[136:139], v[132:135]
    ds_read_b128 a[112:115], v42 offset:4096
    v_cvt_pk_bf16_f32 v121, v163, v195
    v_mfma_f32_16x16x32_bf16 v[132:135], a[12:15], a[140:143], v[132:135]
    ds_write_b64 v26, v[120:121] offset:64528
    v_mfma_f32_16x16x32_bf16 v[164:167], a[56:59], a[232:235], v[164:167]
    s_waitcnt lgkmcnt(7)
    v_add_f32 v224, v224, v112
    v_mul_f32 v224, v224, v84
    v_mfma_f32_16x16x32_bf16 v[164:167], a[60:63], a[236:239], v[164:167]
    v_add_f32 v225, v225, v113
    v_mul_f32 v225, v225, v85
    v_mfma_f32_16x16x32_bf16 v[164:167], a[32:35], a[80:83], v[164:167]
    ds_read_b128 a[116:119], v43 offset:4096
    v_cvt_pk_bf16_f32 v112, v224, v225
    v_mfma_f32_16x16x32_bf16 v[164:167], a[36:39], a[84:87], v[164:167]
    ds_write_b32 v28, v112 offset:64512
    v_mfma_f32_16x16x32_bf16 v[164:167], a[144:147], a[0:3], v[164:167]
    ds_read_b128 a[192:195], v42 offset:20480
    v_mul_f32 v132, v132, v96
    v_mfma_f32_16x16x32_bf16 v[164:167], a[148:151], a[4:7], v[164:167]
    v_mul_f32 v133, v133, v97
    v_mul_f32 v134, v134, v98
    v_mfma_f32_16x16x32_bf16 v[164:167], a[184:187], a[136:139], v[164:167]
    ds_read_b128 a[196:199], v43 offset:20480
    v_mul_f32 v135, v135, v99
    v_mfma_f32_16x16x32_bf16 v[164:167], a[188:191], a[140:143], v[164:167]
    v_mfma_f32_16x16x32_bf16 v[196:199], a[24:27], a[232:235], v[196:199]
    s_waitcnt lgkmcnt(2)
    s_barrier
    v_mfma_f32_16x16x32_bf16 v[196:199], a[28:31], a[236:239], v[196:199]
    ds_read_b128 v[124:127], v24 offset:64512
    ds_read2st64_b32 v[88:89], v30 offset0:121 offset1:122
    v_mfma_f32_16x16x32_bf16 v[196:199], a[120:123], a[80:83], v[196:199]
    ds_read_b128 v[92:95], v24 offset:65440
    v_mfma_f32_16x16x32_bf16 v[196:199], a[124:127], a[84:87], v[196:199]
    ds_read_b128 a[248:251], v40 offset:38912
    v_mul_f32 v164, v164, v104
    v_mfma_f32_16x16x32_bf16 v[196:199], a[48:51], a[0:3], v[196:199]
    v_cvt_pk_bf16_f32 v48, v132, v164
    v_mul_f32 v165, v165, v105
    v_mfma_f32_16x16x32_bf16 v[196:199], a[52:55], a[4:7], v[196:199]
    ds_read_b128 a[252:255], v41 offset:38912
    v_mul_f32 v166, v166, v106
    v_mfma_f32_16x16x32_bf16 v[196:199], a[72:75], a[136:139], v[196:199]
    v_cvt_pk_bf16_f32 v51, v134, v166
    v_mul_f32 v167, v167, v107
    v_mfma_f32_16x16x32_bf16 v[196:199], a[76:79], a[140:143], v[196:199]
    s_waitcnt lgkmcnt(3)
    v_mfma_f32_16x16x32_bf16 v[232:235], a[200:203], a[90:93], v[232:235]
    buffer_store_dwordx4 v[124:127], v25, s[16:19], s66 offen sc1
    v_mfma_f32_16x16x32_bf16 v[232:235], a[204:207], a[106:109], v[232:235]
    s_mov_b32 s66, 114688
    v_add_f32 v228, v228, v88
    v_mul_f32 v228, v228, v84
    v_mfma_f32_16x16x32_bf16 v[232:235], a[160:163], a[114:117], v[232:235]
    v_add_f32 v229, v229, v89
    v_mul_f32 v229, v229, v85
    v_mfma_f32_16x16x32_bf16 v[232:235], a[164:167], a[194:197], v[232:235]
    s_waitcnt lgkmcnt(2)
    ds_read_b128 a[240:243], v40 offset:55296
    v_mfma_f32_16x16x32_bf16 v[136:139], a[16:19], a[88:91], v[136:139]
    buffer_store_dwordx4 v[92:95], v25, s[16:19], s67 offen sc1
    v_mfma_f32_16x16x32_bf16 v[136:139], a[20:23], a[92:95], v[136:139]
    s_mov_b32 s67, 129024
    ds_read_b128 a[244:247], v41 offset:55296
    v_cvt_pk_bf16_f32 v88, v228, v229
    v_mfma_f32_16x16x32_bf16 v[136:139], a[40:43], a[104:107], v[136:139]
    ds_write_b32 v28, v88 offset:0
    v_mfma_f32_16x16x32_bf16 v[136:139], a[44:47], a[108:111], v[136:139]
    ds_write_addtid_b32 v234 offset:33024
    v_mul_f32 v196, v196, v108
    v_mfma_f32_16x16x32_bf16 v[136:139], a[168:171], a[112:115], v[136:139]
    ds_write_addtid_b32 v235 offset:33280
    v_mul_f32 v197, v197, v109
    v_mfma_f32_16x16x32_bf16 v[136:139], a[172:175], a[116:119], v[136:139]
    v_mul_f32 v198, v198, v110
    v_mul_f32 v199, v199, v111
    v_mfma_f32_16x16x32_bf16 v[136:139], a[8:11], a[192:195], v[136:139]
    ds_read_b128 a[216:219], v42 offset:6144
    v_cvt_pk_bf16_f32 v49, v196, v133
    v_mfma_f32_16x16x32_bf16 v[136:139], a[12:15], a[196:199], v[136:139]
    ds_write_b64 v26, v[48:49] offset:0
    v_mfma_f32_16x16x32_bf16 v[168:171], a[56:59], a[88:91], v[168:171]
    v_cvt_pk_bf16_f32 v50, v165, v197
    v_cvt_pk_bf16_f32 v52, v198, v135
    v_mfma_f32_16x16x32_bf16 v[168:171], a[60:63], a[92:95], v[168:171]
    ds_write_b64 v26, v[50:51] offset:8
    v_mfma_f32_16x16x32_bf16 v[168:171], a[32:35], a[104:107], v[168:171]
    ds_read_b128 a[220:223], v43 offset:6144
    v_cvt_pk_bf16_f32 v53, v167, v199
    v_mfma_f32_16x16x32_bf16 v[168:171], a[36:39], a[108:111], v[168:171]
    ds_write_b64 v26, v[52:53] offset:16
    v_mfma_f32_16x16x32_bf16 v[168:171], a[144:147], a[112:115], v[168:171]
    ds_read_b128 a[232:235], v42 offset:22528
    v_mul_f32 v136, v136, v96
    v_mfma_f32_16x16x32_bf16 v[168:171], a[148:151], a[116:119], v[168:171]
    v_mul_f32 v137, v137, v97
    v_mul_f32 v138, v138, v98
    v_mfma_f32_16x16x32_bf16 v[168:171], a[184:187], a[192:195], v[168:171]
    ds_read_b128 a[236:239], v43 offset:22528
    v_mul_f32 v139, v139, v99
    v_mfma_f32_16x16x32_bf16 v[168:171], a[188:191], a[196:199], v[168:171]
    v_mfma_f32_16x16x32_bf16 v[200:203], a[24:27], a[88:91], v[200:203]
    s_waitcnt lgkmcnt(2)
    s_barrier
    v_mfma_f32_16x16x32_bf16 v[200:203], a[28:31], a[92:95], v[200:203]
    ds_read_b128 v[68:71], v24 offset:0
    ds_read2st64_b32 v[72:73], v30 offset0:129 offset1:130
    v_mfma_f32_16x16x32_bf16 v[200:203], a[120:123], a[104:107], v[200:203]
    ds_read_b128 v[76:79], v24 offset:928
    v_mfma_f32_16x16x32_bf16 v[200:203], a[124:127], a[108:111], v[200:203]
    ds_read_b128 a[80:83], v40 offset:40960
    v_mul_f32 v168, v168, v104
    v_mfma_f32_16x16x32_bf16 v[200:203], a[48:51], a[112:115], v[200:203]
    v_cvt_pk_bf16_f32 v100, v136, v168
    v_mul_f32 v169, v169, v105
    v_mfma_f32_16x16x32_bf16 v[200:203], a[52:55], a[116:119], v[200:203]
    ds_read_b128 a[84:87], v41 offset:40960
    v_mul_f32 v170, v170, v106
    v_mfma_f32_16x16x32_bf16 v[200:203], a[72:75], a[192:195], v[200:203]
    v_cvt_pk_bf16_f32 v103, v138, v170
    v_mul_f32 v171, v171, v107
    v_mfma_f32_16x16x32_bf16 v[200:203], a[76:79], a[196:199], v[200:203]
    s_waitcnt lgkmcnt(3)
    v_mfma_f32_16x16x32_bf16 v[236:239], a[200:203], a[250:253], v[236:239]
    buffer_store_dwordx4 v[68:71], v25, s[16:19], s66 offen sc1
    v_mfma_f32_16x16x32_bf16 v[236:239], a[204:207], a[242:245], v[236:239]
    s_mov_b32 s66, 229376
    v_add_f32 v232, v232, v72
    v_mul_f32 v232, v232, v84
    v_mfma_f32_16x16x32_bf16 v[236:239], a[160:163], a[218:221], v[236:239]
    v_add_f32 v233, v233, v73
    v_mul_f32 v233, v233, v85
    v_mfma_f32_16x16x32_bf16 v[236:239], a[164:167], a[234:237], v[236:239]
    s_waitcnt lgkmcnt(2)
    ds_read_b128 a[0:3], v40 offset:57344
    v_mfma_f32_16x16x32_bf16 v[140:143], a[16:19], a[248:251], v[140:143]
    buffer_store_dwordx4 v[76:79], v25, s[16:19], s67 offen sc1
    v_mfma_f32_16x16x32_bf16 v[140:143], a[20:23], a[252:255], v[140:143]
    s_mov_b32 s67, 243712
    ds_read_b128 a[4:7], v41 offset:57344
    v_cvt_pk_bf16_f32 v72, v232, v233
    v_mfma_f32_16x16x32_bf16 v[140:143], a[40:43], a[240:243], v[140:143]
    ds_write_b32 v28, v72 offset:7424
    v_mfma_f32_16x16x32_bf16 v[140:143], a[44:47], a[244:247], v[140:143]
    ds_write_addtid_b32 v238 offset:0
    v_mul_f32 v200, v200, v108
    v_mfma_f32_16x16x32_bf16 v[140:143], a[168:171], a[216:219], v[140:143]
    ds_write_addtid_b32 v239 offset:256
    v_mul_f32 v201, v201, v109
    v_mfma_f32_16x16x32_bf16 v[140:143], a[172:175], a[220:223], v[140:143]
    v_mul_f32 v202, v202, v110
    v_mul_f32 v203, v203, v111
    v_mfma_f32_16x16x32_bf16 v[140:143], a[8:11], a[232:235], v[140:143]
    ds_read_b128 a[136:139], v42 offset:8192
    v_cvt_pk_bf16_f32 v101, v200, v137
    v_mfma_f32_16x16x32_bf16 v[140:143], a[12:15], a[236:239], v[140:143]
    ds_write_b64 v26, v[100:101] offset:7424
    v_mfma_f32_16x16x32_bf16 v[172:175], a[56:59], a[248:251], v[172:175]
    v_cvt_pk_bf16_f32 v102, v169, v201
    v_cvt_pk_bf16_f32 v64, v202, v139
    v_mfma_f32_16x16x32_bf16 v[172:175], a[60:63], a[252:255], v[172:175]
    ds_write_b64 v26, v[102:103] offset:7432
    v_mfma_f32_16x16x32_bf16 v[172:175], a[32:35], a[240:243], v[172:175]
    ds_read_b128 a[140:143], v43 offset:8192
    v_cvt_pk_bf16_f32 v65, v171, v203
    v_mfma_f32_16x16x32_bf16 v[172:175], a[36:39], a[244:247], v[172:175]
    ds_write_b64 v26, v[64:65] offset:7440
    v_mfma_f32_16x16x32_bf16 v[172:175], a[144:147], a[216:219], v[172:175]
    ds_read_b128 a[88:91], v42 offset:24576
    v_mul_f32 v140, v140, v96
    v_mfma_f32_16x16x32_bf16 v[172:175], a[148:151], a[220:223], v[172:175]
    v_mul_f32 v141, v141, v97
    v_mul_f32 v142, v142, v98
    v_mfma_f32_16x16x32_bf16 v[172:175], a[184:187], a[232:235], v[172:175]
    ds_read_b128 a[92:95], v43 offset:24576
    v_mul_f32 v143, v143, v99
    v_mfma_f32_16x16x32_bf16 v[172:175], a[188:191], a[236:239], v[172:175]
    v_mfma_f32_16x16x32_bf16 v[204:207], a[24:27], a[248:251], v[204:207]
    s_waitcnt lgkmcnt(2)
    s_barrier
    v_mfma_f32_16x16x32_bf16 v[204:207], a[28:31], a[252:255], v[204:207]
    ds_read_b128 v[80:83], v24 offset:7424
    ds_read2st64_b32 v[116:117], v30 offset0:0 offset1:1
    v_mfma_f32_16x16x32_bf16 v[204:207], a[120:123], a[240:243], v[204:207]
    ds_read_b128 v[120:123], v24 offset:8352
    v_mfma_f32_16x16x32_bf16 v[204:207], a[124:127], a[244:247], v[204:207]
    ds_read_b128 a[104:107], v40 offset:43008
    v_mul_f32 v172, v172, v104
    v_mfma_f32_16x16x32_bf16 v[204:207], a[48:51], a[216:219], v[204:207]
    v_cvt_pk_bf16_f32 v112, v140, v172
    v_mul_f32 v173, v173, v105
    v_mfma_f32_16x16x32_bf16 v[204:207], a[52:55], a[220:223], v[204:207]
    ds_read_b128 a[108:111], v41 offset:43008
    v_mul_f32 v174, v174, v106
    v_mfma_f32_16x16x32_bf16 v[204:207], a[72:75], a[232:235], v[204:207]
    v_cvt_pk_bf16_f32 v115, v142, v174
    v_mul_f32 v175, v175, v107
    v_mfma_f32_16x16x32_bf16 v[204:207], a[76:79], a[236:239], v[204:207]
    s_waitcnt lgkmcnt(3)
    v_mfma_f32_16x16x32_bf16 v[240:243], a[200:203], a[82:85], v[240:243]
    buffer_store_dwordx4 v[80:83], v25, s[16:19], s66 offen sc1
    v_mfma_f32_16x16x32_bf16 v[240:243], a[204:207], a[2:5], v[240:243]
    s_mov_b32 s66, 344064
    v_add_f32 v236, v236, v116
    v_mul_f32 v236, v236, v84
    v_mfma_f32_16x16x32_bf16 v[240:243], a[160:163], a[138:141], v[240:243]
    v_add_f32 v237, v237, v117
    v_mul_f32 v237, v237, v85
    v_mfma_f32_16x16x32_bf16 v[240:243], a[164:167], a[90:93], v[240:243]
    s_waitcnt lgkmcnt(2)
    ds_read_b128 a[112:115], v40 offset:59392
    v_mfma_f32_16x16x32_bf16 v[144:147], a[16:19], a[80:83], v[144:147]
    buffer_store_dwordx4 v[120:123], v25, s[16:19], s67 offen sc1
    v_mfma_f32_16x16x32_bf16 v[144:147], a[20:23], a[84:87], v[144:147]
    s_mov_b32 s67, 358400
    ds_read_b128 a[116:119], v41 offset:59392
    v_cvt_pk_bf16_f32 v116, v236, v237
    v_mfma_f32_16x16x32_bf16 v[144:147], a[40:43], a[0:3], v[144:147]
    ds_write_b32 v28, v116 offset:14848
    v_mfma_f32_16x16x32_bf16 v[144:147], a[44:47], a[4:7], v[144:147]
    ds_write_addtid_b32 v242 offset:2048
    v_mul_f32 v204, v204, v108
    v_mfma_f32_16x16x32_bf16 v[144:147], a[168:171], a[136:139], v[144:147]
    ds_write_addtid_b32 v243 offset:2304
    v_mul_f32 v205, v205, v109
    v_mfma_f32_16x16x32_bf16 v[144:147], a[172:175], a[140:143], v[144:147]
    v_mul_f32 v206, v206, v110
    v_mul_f32 v207, v207, v111
    v_mfma_f32_16x16x32_bf16 v[144:147], a[8:11], a[88:91], v[144:147]
    ds_read_b128 a[192:195], v42 offset:10240
    v_cvt_pk_bf16_f32 v113, v204, v141
    v_mfma_f32_16x16x32_bf16 v[144:147], a[12:15], a[92:95], v[144:147]
    ds_write_b64 v26, v[112:113] offset:14848
    v_mfma_f32_16x16x32_bf16 v[176:179], a[56:59], a[80:83], v[176:179]
    v_cvt_pk_bf16_f32 v114, v173, v205
    v_cvt_pk_bf16_f32 v124, v206, v143
    v_mfma_f32_16x16x32_bf16 v[176:179], a[60:63], a[84:87], v[176:179]
    ds_write_b64 v26, v[114:115] offset:14856
    v_mfma_f32_16x16x32_bf16 v[176:179], a[32:35], a[0:3], v[176:179]
    ds_read_b128 a[196:199], v43 offset:10240
    v_cvt_pk_bf16_f32 v125, v175, v207
    v_mfma_f32_16x16x32_bf16 v[176:179], a[36:39], a[4:7], v[176:179]
    ds_write_b64 v26, v[124:125] offset:14864
    v_mfma_f32_16x16x32_bf16 v[176:179], a[144:147], a[136:139], v[176:179]
    ds_read_b128 a[248:251], v42 offset:26624
    v_mul_f32 v144, v144, v96
    v_mfma_f32_16x16x32_bf16 v[176:179], a[148:151], a[140:143], v[176:179]
    v_mul_f32 v145, v145, v97
    v_mul_f32 v146, v146, v98
    v_mfma_f32_16x16x32_bf16 v[176:179], a[184:187], a[88:91], v[176:179]
    ds_read_b128 a[252:255], v43 offset:26624
    v_mul_f32 v147, v147, v99
    v_mfma_f32_16x16x32_bf16 v[176:179], a[188:191], a[92:95], v[176:179]
    s_waitcnt vmcnt(6)
    v_bitop3_b32 v45, v45, 15, v0 bitop3:0xbe
    v_lshlrev_b32 v45, 22, v45
    v_mfma_f32_16x16x32_bf16 v[208:211], a[24:27], a[80:83], v[208:211]
    s_waitcnt lgkmcnt(2)
    s_barrier
    v_mfma_f32_16x16x32_bf16 v[208:211], a[28:31], a[84:87], v[208:211]
    buffer_store_dword v47, v45, s[12:15], s78 offen sc1
    v_mfma_f32_16x16x32_bf16 v[208:211], a[120:123], a[0:3], v[208:211]
    ds_read_b128 v[92:95], v24 offset:14848
    ds_read2st64_b32 v[88:89], v30 offset0:8 offset1:9
    v_mfma_f32_16x16x32_bf16 v[208:211], a[124:127], a[4:7], v[208:211]
    ds_read_b128 v[48:51], v24 offset:15776
    v_mul_f32 v176, v176, v104
    v_mfma_f32_16x16x32_bf16 v[208:211], a[48:51], a[136:139], v[208:211]
    ds_read_b128 a[240:243], v40 offset:45056
    v_cvt_pk_bf16_f32 v52, v144, v176
    v_mfma_f32_16x16x32_bf16 v[208:211], a[52:55], a[140:143], v[208:211]
    ds_read_b128 a[244:247], v41 offset:45056
    v_mul_f32 v177, v177, v105
    v_mfma_f32_16x16x32_bf16 v[208:211], a[72:75], a[88:91], v[208:211]
    v_mul_f32 v178, v178, v106
    v_cvt_pk_bf16_f32 v55, v146, v178
    v_mfma_f32_16x16x32_bf16 v[208:211], a[76:79], a[92:95], v[208:211]
    v_mul_f32 v179, v179, v107
    v_mfma_f32_16x16x32_bf16 v[244:247], a[200:203], a[106:109], v[244:247]
    s_waitcnt lgkmcnt(3)
    v_mfma_f32_16x16x32_bf16 v[244:247], a[204:207], a[114:117], v[244:247]
    buffer_store_dwordx4 v[92:95], v25, s[16:19], s66 offen sc1
    v_mfma_f32_16x16x32_bf16 v[244:247], a[160:163], a[194:197], v[244:247]
    s_mov_b32 s66, 458752
    v_add_f32 v240, v240, v88
    v_mul_f32 v240, v240, v84
    v_mfma_f32_16x16x32_bf16 v[244:247], a[164:167], a[250:253], v[244:247]
    v_add_f32 v241, v241, v89
    v_mul_f32 v241, v241, v85
    v_mfma_f32_16x16x32_bf16 v[148:151], a[16:19], a[104:107], v[148:151]
    s_waitcnt lgkmcnt(2)
    ds_read_b128 a[216:219], v40 offset:61440
    v_mfma_f32_16x16x32_bf16 v[148:151], a[20:23], a[108:111], v[148:151]
    buffer_store_dwordx4 v[48:51], v25, s[16:19], s67 offen sc1
    v_mfma_f32_16x16x32_bf16 v[148:151], a[40:43], a[112:115], v[148:151]
    s_mov_b32 s67, 473088
    ds_read_b128 a[220:223], v41 offset:61440
    v_cvt_pk_bf16_f32 v88, v240, v241
    v_mfma_f32_16x16x32_bf16 v[148:151], a[44:47], a[116:119], v[148:151]
    ds_write_b32 v28, v88 offset:22272
    v_mfma_f32_16x16x32_bf16 v[148:151], a[168:171], a[192:195], v[148:151]
    ds_write_addtid_b32 v246 offset:4096
    v_mul_f32 v208, v208, v108
    v_mfma_f32_16x16x32_bf16 v[148:151], a[172:175], a[196:199], v[148:151]
    v_mul_f32 v209, v209, v109
    v_mul_f32 v210, v210, v110
    v_mfma_f32_16x16x32_bf16 v[148:151], a[8:11], a[248:251], v[148:151]
    v_mul_f32 v211, v211, v111
    v_cvt_pk_bf16_f32 v53, v208, v145
    v_mfma_f32_16x16x32_bf16 v[148:151], a[12:15], a[252:255], v[148:151]
    ds_write_b64 v26, v[52:53] offset:22272
    v_mfma_f32_16x16x32_bf16 v[180:183], a[56:59], a[104:107], v[180:183]
    v_cvt_pk_bf16_f32 v54, v177, v209
    v_cvt_pk_bf16_f32 v68, v210, v147
    v_mfma_f32_16x16x32_bf16 v[180:183], a[60:63], a[108:111], v[180:183]
    ds_read_b128 a[232:235], v42 offset:12288
    v_cvt_pk_bf16_f32 v69, v179, v211
    v_mfma_f32_16x16x32_bf16 v[180:183], a[32:35], a[112:115], v[180:183]
    ds_write_b64 v26, v[54:55] offset:22280
    v_mfma_f32_16x16x32_bf16 v[180:183], a[36:39], a[116:119], v[180:183]
    ds_write_b64 v26, v[68:69] offset:22288
    v_mfma_f32_16x16x32_bf16 v[180:183], a[144:147], a[192:195], v[180:183]
    ds_read_b128 a[236:239], v43 offset:12288
    ds_write_addtid_b32 v247 offset:4352
    v_mfma_f32_16x16x32_bf16 v[180:183], a[148:151], a[196:199], v[180:183]
    ds_read_b128 a[80:83], v42 offset:28672
    v_mul_f32 v148, v148, v96
    v_mfma_f32_16x16x32_bf16 v[180:183], a[184:187], a[248:251], v[180:183]
    ds_read_b128 a[84:87], v43 offset:28672
    v_mul_f32 v149, v149, v97
    v_mfma_f32_16x16x32_bf16 v[180:183], a[188:191], a[252:255], v[180:183]
    v_mul_f32 v150, v150, v98
    v_mul_f32 v151, v151, v99
    v_mfma_f32_16x16x32_bf16 v[212:215], a[24:27], a[104:107], v[212:215]
    v_mfma_f32_16x16x32_bf16 v[212:215], a[28:31], a[108:111], v[212:215]
    s_waitcnt lgkmcnt(2)
    s_barrier
    v_mfma_f32_16x16x32_bf16 v[212:215], a[120:123], a[112:115], v[212:215]
    ds_read_b128 v[76:79], v24 offset:22272
    ds_read2st64_b32 v[72:73], v30 offset0:16 offset1:17
    v_mfma_f32_16x16x32_bf16 v[212:215], a[124:127], a[116:119], v[212:215]
    ds_read_b128 v[100:103], v24 offset:23200
    v_mul_f32 v180, v180, v104
    v_mfma_f32_16x16x32_bf16 v[212:215], a[48:51], a[192:195], v[212:215]
    ds_read_b128 a[0:3], v40 offset:14336
    v_cvt_pk_bf16_f32 v64, v148, v180
    v_mfma_f32_16x16x32_bf16 v[212:215], a[52:55], a[196:199], v[212:215]
    ds_read_b128 a[4:7], v41 offset:14336
    v_mul_f32 v181, v181, v105
    v_mfma_f32_16x16x32_bf16 v[212:215], a[72:75], a[248:251], v[212:215]
    v_mul_f32 v182, v182, v106
    v_cvt_pk_bf16_f32 v67, v150, v182
    v_mfma_f32_16x16x32_bf16 v[212:215], a[76:79], a[252:255], v[212:215]
    v_mul_f32 v183, v183, v107
    v_mfma_f32_16x16x32_bf16 v[248:251], a[200:203], a[242:245], v[248:251]
    s_waitcnt lgkmcnt(3)
    v_mfma_f32_16x16x32_bf16 v[248:251], a[204:207], a[218:221], v[248:251]
    buffer_store_dwordx4 v[76:79], v25, s[16:19], s66 offen sc1
    v_mfma_f32_16x16x32_bf16 v[248:251], a[160:163], a[234:237], v[248:251]
    s_mov_b32 s66, 573440
    v_add_f32 v244, v244, v72
    v_mul_f32 v244, v244, v84
    v_mfma_f32_16x16x32_bf16 v[248:251], a[164:167], a[82:85], v[248:251]
    v_add_f32 v245, v245, v73
    v_mul_f32 v245, v245, v85
    v_mfma_f32_16x16x32_bf16 v[152:155], a[16:19], a[240:243], v[152:155]
    s_waitcnt lgkmcnt(2)
    ds_read_b128 a[136:139], v40 offset:30720
    v_mfma_f32_16x16x32_bf16 v[152:155], a[20:23], a[244:247], v[152:155]
    buffer_store_dwordx4 v[100:103], v25, s[16:19], s67 offen sc1
    v_mfma_f32_16x16x32_bf16 v[152:155], a[40:43], a[216:219], v[152:155]
    s_mov_b32 s67, 587776
    ds_read_b128 a[140:143], v41 offset:30720
    v_cvt_pk_bf16_f32 v72, v244, v245
    v_mfma_f32_16x16x32_bf16 v[152:155], a[44:47], a[220:223], v[152:155]
    ds_write_b32 v28, v72 offset:29696
    v_mfma_f32_16x16x32_bf16 v[152:155], a[168:171], a[232:235], v[152:155]
    ds_write_addtid_b32 v250 offset:6144
    v_mul_f32 v212, v212, v108
    v_mfma_f32_16x16x32_bf16 v[152:155], a[172:175], a[236:239], v[152:155]
    v_mul_f32 v213, v213, v109
    v_mul_f32 v214, v214, v110
    v_mfma_f32_16x16x32_bf16 v[152:155], a[8:11], a[80:83], v[152:155]
    v_mul_f32 v215, v215, v111
    v_cvt_pk_bf16_f32 v65, v212, v149
    v_mfma_f32_16x16x32_bf16 v[152:155], a[12:15], a[84:87], v[152:155]
    ds_write_b64 v26, v[64:65] offset:29696
    v_mfma_f32_16x16x32_bf16 v[184:187], a[56:59], a[240:243], v[184:187]
    v_cvt_pk_bf16_f32 v66, v181, v213
    v_cvt_pk_bf16_f32 v80, v214, v151
    v_mfma_f32_16x16x32_bf16 v[184:187], a[60:63], a[244:247], v[184:187]
    ds_read_b128 a[88:91], v40 offset:47104
    v_cvt_pk_bf16_f32 v81, v183, v215
    v_mfma_f32_16x16x32_bf16 v[184:187], a[32:35], a[216:219], v[184:187]
    ds_write_b64 v26, v[66:67] offset:29704
    v_mfma_f32_16x16x32_bf16 v[184:187], a[36:39], a[220:223], v[184:187]
    ds_write_b64 v26, v[80:81] offset:29712
    v_mfma_f32_16x16x32_bf16 v[184:187], a[144:147], a[232:235], v[184:187]
    ds_read_b128 a[92:95], v41 offset:47104
    ds_write_addtid_b32 v251 offset:6400
    v_mfma_f32_16x16x32_bf16 v[184:187], a[148:151], a[236:239], v[184:187]
    ds_read_b128 a[104:107], v40 offset:63488
    v_mul_f32 v152, v152, v96
    v_mfma_f32_16x16x32_bf16 v[184:187], a[184:187], a[80:83], v[184:187]
    ds_read_b128 a[108:111], v41 offset:63488
    v_mul_f32 v153, v153, v97
    v_mfma_f32_16x16x32_bf16 v[184:187], a[188:191], a[84:87], v[184:187]
    v_mul_f32 v154, v154, v98
    v_mul_f32 v155, v155, v99
    v_mfma_f32_16x16x32_bf16 v[216:219], a[24:27], a[240:243], v[216:219]
    ds_read_b128 a[112:115], v42 offset:14336
    v_mfma_f32_16x16x32_bf16 v[216:219], a[28:31], a[244:247], v[216:219]
    s_waitcnt lgkmcnt(3)
    s_barrier
    v_mfma_f32_16x16x32_bf16 v[216:219], a[120:123], a[216:219], v[216:219]
    ds_read_b128 a[116:119], v43 offset:14336
    ds_read2st64_b32 v[120:121], v30 offset0:24 offset1:25
    v_mfma_f32_16x16x32_bf16 v[216:219], a[124:127], a[220:223], v[216:219]
    ds_read_b128 a[192:195], v42 offset:30720
    v_mul_f32 v184, v184, v104
    v_mfma_f32_16x16x32_bf16 v[216:219], a[48:51], a[232:235], v[216:219]
    ds_read_b128 a[196:199], v43 offset:30720
    v_cvt_pk_bf16_f32 v116, v152, v184
    v_mfma_f32_16x16x32_bf16 v[216:219], a[52:55], a[236:239], v[216:219]
    ds_read_b128 v[112:115], v24 offset:29696
    v_mul_f32 v185, v185, v105
    v_mfma_f32_16x16x32_bf16 v[216:219], a[72:75], a[80:83], v[216:219]
    ds_read_b128 v[124:127], v24 offset:30624
    v_mul_f32 v186, v186, v106
    v_mfma_f32_16x16x32_bf16 v[216:219], a[76:79], a[84:87], v[216:219]
    v_cvt_pk_bf16_f32 v119, v154, v186
    v_mul_f32 v187, v187, v107
    v_mfma_f32_16x16x32_bf16 v[252:255], a[152:155], a[2:5], v[252:255]
    v_mfma_f32_16x16x32_bf16 v[252:255], a[156:159], a[138:141], v[252:255]
    s_waitcnt lgkmcnt(4)
    v_add_f32 v248, v248, v120
    v_mul_f32 v248, v248, v84
    v_mfma_f32_16x16x32_bf16 v[252:255], a[200:203], a[90:93], v[252:255]
    v_add_f32 v249, v249, v121
    v_mul_f32 v249, v249, v85
    v_mfma_f32_16x16x32_bf16 v[252:255], a[204:207], a[106:109], v[252:255]
    s_waitcnt lgkmcnt(1)
    v_cvt_pk_bf16_f32 v120, v248, v249
    v_mfma_f32_16x16x32_bf16 v[252:255], a[160:163], a[114:117], v[252:255]
    buffer_store_dwordx4 v[112:115], v25, s[16:19], s66 offen sc1
    v_mfma_f32_16x16x32_bf16 v[252:255], a[164:167], a[194:197], v[252:255]
    s_mov_b32 s66, 688128
    ds_write_b32 v28, v120 offset:37120
    v_mfma_f32_16x16x32_bf16 v[156:159], a[96:99], a[0:3], v[156:159]
    v_mul_f32 v216, v216, v108
    v_mul_f32 v217, v217, v109
    v_mfma_f32_16x16x32_bf16 v[156:159], a[100:103], a[4:7], v[156:159]
    s_waitcnt lgkmcnt(1)
    v_mul_f32 v218, v218, v110
    v_mfma_f32_16x16x32_bf16 v[156:159], a[64:67], a[136:139], v[156:159]
    buffer_store_dwordx4 v[124:127], v25, s[16:19], s67 offen sc1
    v_mfma_f32_16x16x32_bf16 v[156:159], a[68:71], a[140:143], v[156:159]
    s_mov_b32 s67, 702464
    ds_write_addtid_b32 v254 offset:8192
    v_mul_f32 v219, v219, v111
    v_mfma_f32_16x16x32_bf16 v[156:159], a[16:19], a[88:91], v[156:159]
    ds_write_addtid_b32 v255 offset:8448
    v_cvt_pk_bf16_f32 v117, v216, v153
    v_mfma_f32_16x16x32_bf16 v[156:159], a[20:23], a[92:95], v[156:159]
    ds_write_b64 v26, v[116:117] offset:37120
    v_mfma_f32_16x16x32_bf16 v[156:159], a[40:43], a[104:107], v[156:159]
    v_cvt_pk_bf16_f32 v118, v185, v217
    v_cvt_pk_bf16_f32 v92, v218, v155
    v_mfma_f32_16x16x32_bf16 v[156:159], a[44:47], a[108:111], v[156:159]
    ds_write_b64 v26, v[118:119] offset:37128
    v_mfma_f32_16x16x32_bf16 v[156:159], a[168:171], a[112:115], v[156:159]
    v_cvt_pk_bf16_f32 v93, v187, v219
    v_mfma_f32_16x16x32_bf16 v[156:159], a[172:175], a[116:119], v[156:159]
    ds_write_b64 v26, v[92:93] offset:37136
    v_mfma_f32_16x16x32_bf16 v[156:159], a[8:11], a[192:195], v[156:159]
    v_mfma_f32_16x16x32_bf16 v[156:159], a[12:15], a[196:199], v[156:159]
    v_mfma_f32_16x16x32_bf16 v[188:191], a[176:179], a[0:3], v[188:191]
    v_mfma_f32_16x16x32_bf16 v[188:191], a[180:183], a[4:7], v[188:191]
    v_mfma_f32_16x16x32_bf16 v[188:191], a[208:211], a[136:139], v[188:191]
    s_waitcnt lgkmcnt(0)
    s_barrier
    v_mfma_f32_16x16x32_bf16 v[188:191], a[212:215], a[140:143], v[188:191]
    ds_read_b128 v[48:51], v24 offset:37120
    ds_read2st64_b32 v[88:89], v30 offset0:32 offset1:33
    v_mfma_f32_16x16x32_bf16 v[188:191], a[56:59], a[88:91], v[188:191]
    ds_read_b128 v[52:55], v24 offset:38048
    v_mul_f32 v156, v156, v96
    v_mfma_f32_16x16x32_bf16 v[188:191], a[60:63], a[92:95], v[188:191]
    v_mul_f32 v157, v157, v97
    v_mul_f32 v158, v158, v98
    v_mfma_f32_16x16x32_bf16 v[188:191], a[32:35], a[104:107], v[188:191]
    v_mul_f32 v159, v159, v99
    v_mfma_f32_16x16x32_bf16 v[188:191], a[36:39], a[108:111], v[188:191]
    v_mfma_f32_16x16x32_bf16 v[188:191], a[144:147], a[112:115], v[188:191]
    v_mfma_f32_16x16x32_bf16 v[188:191], a[148:151], a[116:119], v[188:191]
    s_waitcnt lgkmcnt(1)
    v_mfma_f32_16x16x32_bf16 v[188:191], a[184:187], a[192:195], v[188:191]
    buffer_store_dwordx4 v[48:51], v25, s[16:19], s66 offen sc1
    v_mfma_f32_16x16x32_bf16 v[188:191], a[188:191], a[196:199], v[188:191]
    s_mov_b32 s66, 802816
    v_add_f32 v252, v252, v88
    v_mul_f32 v252, v252, v84
    v_mfma_f32_16x16x32_bf16 v[220:223], a[128:131], a[0:3], v[220:223]
    v_add_f32 v253, v253, v89
    v_mul_f32 v253, v253, v85
    v_mfma_f32_16x16x32_bf16 v[220:223], a[132:135], a[4:7], v[220:223]
    s_waitcnt lgkmcnt(0)
    v_cvt_pk_bf16_f32 v88, v252, v253
    v_mfma_f32_16x16x32_bf16 v[220:223], a[224:227], a[136:139], v[220:223]
    buffer_store_dwordx4 v[52:55], v25, s[16:19], s67 offen sc1
    v_mfma_f32_16x16x32_bf16 v[220:223], a[228:231], a[140:143], v[220:223]
    s_mov_b32 s67, 817152
    ds_write_b32 v28, v88 offset:44544
    v_mfma_f32_16x16x32_bf16 v[220:223], a[24:27], a[88:91], v[220:223]
    v_mul_f32 v188, v188, v104
    v_cvt_pk_bf16_f32 v68, v156, v188
    v_mfma_f32_16x16x32_bf16 v[220:223], a[28:31], a[92:95], v[220:223]
    v_mul_f32 v189, v189, v105
    v_mul_f32 v190, v190, v106
    v_mfma_f32_16x16x32_bf16 v[220:223], a[120:123], a[104:107], v[220:223]
    v_cvt_pk_bf16_f32 v71, v158, v190
    v_mul_f32 v191, v191, v107
    v_mfma_f32_16x16x32_bf16 v[220:223], a[124:127], a[108:111], v[220:223]
    v_mfma_f32_16x16x32_bf16 v[220:223], a[48:51], a[112:115], v[220:223]
    v_mfma_f32_16x16x32_bf16 v[220:223], a[52:55], a[116:119], v[220:223]
    v_mfma_f32_16x16x32_bf16 v[220:223], a[72:75], a[192:195], v[220:223]
    v_mfma_f32_16x16x32_bf16 v[220:223], a[76:79], a[196:199], v[220:223]
    s_nop 7
    v_mul_f32 v220, v220, v108
    v_mul_f32 v221, v221, v109
    v_mul_f32 v222, v222, v110
    v_mul_f32 v223, v223, v111
    v_cvt_pk_bf16_f32 v69, v220, v157
    v_cvt_pk_bf16_f32 v70, v189, v221
    v_cvt_pk_bf16_f32 v76, v222, v159
    v_cvt_pk_bf16_f32 v77, v191, v223
    ds_write_b64 v26, v[68:69] offset:44544
    ds_write_b64 v26, v[70:71] offset:44552
    ds_write_b64 v26, v[76:77] offset:44560
    s_waitcnt lgkmcnt(0)
    s_barrier
    ds_read_b128 v[100:103], v24 offset:44544
    ds_read_b128 v[72:75], v24 offset:45472
    s_waitcnt lgkmcnt(1)
    buffer_store_dwordx4 v[100:103], v25, s[16:19], s66 offen sc1
    s_waitcnt lgkmcnt(0)
    buffer_store_dwordx4 v[72:75], v25, s[16:19], s67 offen sc1
L_end:
    s_endpgm
L_help:
    s_mov_b32 s53, s61
    s_mov_b32 s54, s62
    s_mul_i32 s61, s22, 1835008
    s_add_u32 s61, s61, s79
    s_lshl_b32 s62, s22, 14
    s_add_u32 s62, s62, s68
    s_mov_b32 s22, 0
L_help_row:
    v_mov_b32 v21, v19
    s_xor_b32 s23, s22, s58
    s_bitcmp0_b32 s23, 2
    s_cbranch_scc1 L_help_same
    v_add_u32 v12, 57344, v19
    v_subrev_u32 v13, 57344, v19
    v_min_u32 v21, v12, v13
L_help_same:
    v_mov_b32 v8, 0
    v_mov_b32 v9, 0
    v_mov_b32 v10, 0
    v_mov_b32 v11, s47
    s_mov_b32 s23, 0
L_help_e:
    v_mov_b32 v15, 0
    buffer_load_dwordx3 v[12:14], v18, s[4:7], s61 offen nt
    s_cmp_ge_u32 s23, 16
    s_cbranch_scc1 L_help_own
    buffer_load_dword v15, v21, s[4:7], s61 offen nt
L_help_own:
    s_waitcnt vmcnt(0)
    v_lshl_or_b32 v8, v12, s23, v8
    v_lshl_or_b32 v9, v13, s23, v9
    v_lshl_or_b32 v10, v14, s23, v10
    v_lshl_or_b32 v11, v15, s23, v11
    s_add_u32 s61, s61, 14336
    s_add_u32 s23, s23, 4
    s_cmp_lt_u32 s23, 32
    s_cbranch_scc1 L_help_e
    buffer_store_dwordx4 v[8:11], v20, s[12:15], s62 offen sc1
    s_add_u32 s62, s62, 1024
    s_waitcnt vmcnt(0)
    s_add_u32 s22, s22, 1
    s_cmp_lt_u32 s22, 16
    s_cbranch_scc1 L_help_row
    s_mov_b32 s61, s53
    s_mov_b32 s62, s54
    s_setpc_b64 s[20:21]
L_code_end:

.section .rodata,"a"
.p2align 6
.amdhsa_kernel standalone__normalfloat_lut_af4__prompt_kernel
  .amdhsa_next_free_vgpr 512
  .amdhsa_next_free_sgpr 102
  .amdhsa_accum_offset 256
  .amdhsa_group_segment_fixed_size 0
  .amdhsa_kernarg_size 56
  .amdhsa_user_sgpr_count 2
  .amdhsa_user_sgpr_kernarg_segment_ptr 1
  .amdhsa_system_sgpr_workgroup_id_x 1
.end_amdhsa_kernel
```

```asm
; @launch grid=(256,1,1) block=(256,1,1) lds=163840
.amdgcn_target "amdgcn-amd-amdhsa--gfx950"
.text
.globl standalone__normalfloat_lut_af4__prompt_kernel
.p2align 8
.type standalone__normalfloat_lut_af4__prompt_kernel,@function
standalone__normalfloat_lut_af4__prompt_kernel:
    s_cmp_ge_u32 s2, 256
    s_cbranch_scc1 L_end
    s_load_dwordx2 s[4:5], s[0:1], 8
    s_load_dwordx2 s[12:13], s[0:1], 48
    s_load_dwordx2 s[8:9], s[0:1], 0
    s_load_dwordx2 s[28:29], s[0:1], 16
    s_getpc_b64 s[48:49]
L_pc:
    s_mov_b32 s50, L_code_end-L_pc
    s_mov_b32 s51, 0x20000
    s_lshr_b32 s61, s2, 3
    v_lshl_add_u32 v46, v0, 5, s61
    v_lshlrev_b32 v46, 7, v46
    buffer_load_dword v1, v46, s[48:51], 0 offen offset:256
    v_lshrrev_b32 v5, 6, v0
    v_and_b32 v2, 63, v0
    s_and_b32 s60, s2, 7
    v_readfirstlane_b32 s63, v5
    s_and_b32 s58, s60, 3
    s_lshl_b32 s58, s58, 2
    s_and_b32 s62, s61, 3
    s_add_u32 s58, s58, s62
    s_lshr_b32 s59, s60, 2
    s_lshl_b32 s59, s59, 3
    s_lshr_b32 s62, s61, 2
    s_add_u32 s59, s59, s62
    v_mul_u32_u24 v18, 12, v2
    s_lshl_b32 s60, s63, 4
    s_add_u32 s60, s60, s58
    s_mul_i32 s61, s60, 114688
    s_mul_i32 s79, s59, 896
    s_add_u32 s61, s61, s79
    s_mov_b32 s6, 14680064
    s_mov_b32 s7, 0x20000
    s_lshl_b32 s78, s59, 7
    s_add_u32 s78, s78, 2097164
    v_and_b32 v4, 15, v2
    v_lshrrev_b32 v3, 4, v2
    v_and_b32 v12, 1, v3
    v_lshlrev_b32 v13, 1, v12
    v_xor_b32 v13, v13, v4
    v_lshrrev_b32 v19, 1, v3
    v_lshl_add_u32 v19, v19, 4, v13
    s_bfe_u32 s70, s58, 0x10002
    s_xor_b32 s70, s70, 1
    v_xor_b32 v12, s70, v12
    v_mul_u32_u24 v12, 14336, v12
    v_add_lshl_u32 v19, v19, v12, 2
    v_add_u32 v19, 768, v19
    s_mov_b32 s46, 2
    s_cmp_lg_u32 s63, 0
    s_cbranch_scc1 L_role0
    s_mov_b32 s46, 0
L_role0:
    s_cmp_lg_u32 s63, 1
    s_cbranch_scc1 L_role1
    s_mov_b32 s46, 1
L_role1:
    v_lshlrev_b32 v16, 1, v4
    v_lshrrev_b32 v17, 4, v0
    v_lshlrev_b32 v17, 1, v17
    s_mov_b32 s30, 32
    s_mov_b32 s31, 0x20000
    v_lshrrev_b32 v6, 3, v2
    v_and_b32 v7, 7, v2
    v_xor_b32 v13, v7, v3
    s_lshl_b32 s70, s63, 5
    v_add_lshl_u32 v12, v6, s70, 11
    v_lshl_add_u32 v36, v13, 4, v12
    v_xor_b32 v37, 64, v36
    v_add_u32 v37, 15360, v37
    v_add_u32 v38, 30720, v36
    v_add_u32 v39, 30720, v37
    s_mov_b32 s10, 4194304
    s_mov_b32 s11, 0x20000
    s_lshl_b32 s55, s58, 18
    s_and_b32 s71, s58, 8
    s_lshl_b32 s70, s71, 4
    s_add_u32 s55, s55, s70
    s_lshl_b32 s57, s63, 12
    s_xor_b32 s69, s55, 128
    s_add_u32 s57, s57, 65536
    s_mov_b32 s14, 2099200
    s_mov_b32 s15, 0x20000
    s_lshl_b32 s68, s59, 17
    s_lshl_b32 s62, s60, 10
    s_add_u32 s62, s62, s68
    v_lshlrev_b32 v20, 4, v2
    s_waitcnt lgkmcnt(0)
    s_load_dword s76, s[12:13], s78
    s_cmp_eq_u32 s46, 1
    s_cbranch_scc1 L_L
    s_cmp_eq_u32 s46, 2
    s_cbranch_scc1 L_L
L_X:
    buffer_load_dwordx3 v[128:130], v18, s[4:7], s61 offen nt
    buffer_load_dword v131, v19, s[4:7], s61 offen nt
    s_add_u32 s61, s61, 14336
    buffer_load_dwordx3 v[132:134], v18, s[4:7], s61 offen nt
    buffer_load_dword v135, v19, s[4:7], s61 offen nt
    s_add_u32 s61, s61, 14336
    buffer_load_dwordx3 v[136:138], v18, s[4:7], s61 offen nt
    buffer_load_dword v139, v19, s[4:7], s61 offen nt
    s_add_u32 s61, s61, 14336
    buffer_load_dwordx3 v[140:142], v18, s[4:7], s61 offen nt
    buffer_load_dword v143, v19, s[4:7], s61 offen nt
    s_add_u32 s61, s61, 14336
    buffer_load_dwordx3 v[144:146], v18, s[4:7], s61 offen nt
    s_add_u32 s61, s61, 14336
    buffer_load_dwordx3 v[148:150], v18, s[4:7], s61 offen nt
    s_add_u32 s61, s61, 14336
    buffer_load_dwordx3 v[152:154], v18, s[4:7], s61 offen nt
    s_add_u32 s61, s61, 14336
    buffer_load_dwordx3 v[156:158], v18, s[4:7], s61 offen nt
    s_add_u32 s61, s61, 7239680
    s_cmp_eq_u32 s46, 1
    s_cbranch_scc1 L_D
    s_cmp_eq_u32 s46, 2
    s_cbranch_scc1 L_B
L_L:
    buffer_load_ushort v16, v16, s[28:31], 0 offen
    buffer_load_ushort v17, v17, s[28:31], 0 offen
    s_cmp_eq_u32 s46, 1
    s_cbranch_scc1 L_S
    s_cmp_eq_u32 s46, 2
    s_cbranch_scc1 L_S
L_D:
    s_add_u32 m0, s57, 32768
    s_add_u32 s56, s55, 0
    buffer_load_dwordx4 v36, s[8:11], s56 offen offset:0  lds
    buffer_load_dwordx4 v37, s[8:11], s56 offen offset:1024  lds
    buffer_load_dwordx4 v38, s[8:11], s56 offen offset:2048  lds
    buffer_load_dwordx4 v39, s[8:11], s56 offen offset:3072  lds
    s_cmp_eq_u32 s46, 1
    s_cbranch_scc1 L_G
    s_cmp_eq_u32 s46, 2
    s_cbranch_scc1 L_G
L_S:
    s_load_dwordx2 s[32:33], s[0:1], 24
    s_load_dwordx2 s[16:17], s[0:1], 32
    s_load_dwordx2 s[24:25], s[0:1], 40
    s_and_b32 s64, s63, 1
    s_lshr_b32 s65, s63, 1
    s_and_b32 s70, s58, 8
    s_lshl_b32 s70, s70, 10
    s_lshl_b32 s71, s64, 12
    s_add_u32 s70, s70, s71
    s_lshl_b32 s71, s63, 8
    s_add_u32 s70, s70, s71
    s_add_u32 s70, s70, s68
    v_lshl_add_u32 v32, v4, 4, s70
    v_lshl_add_u32 v32, v3, 10, v32
    v_xor_b32 v33, 4096, v32
    v_xor_b32 v34, 8192, v32
    v_xor_b32 v44, 12288, v32
    s_mov_b32 s36, 202114048
    s_mov_b32 s37, 202114304
    s_mov_b32 s38, 202114560
    s_mov_b32 s39, 202114816
    v_and_b32 v35, 31, v2
    v_lshlrev_b32 v35, 2, v35
    s_lshl_b32 s70, s64, 6
    s_add_u32 s70, s70, 65536
    v_lshrrev_b32 v12, 1, v4
    v_xor_b32 v12, v12, v3
    v_lshlrev_b32 v12, 4, v12
    v_lshl_add_u32 v12, v4, 7, v12
    v_xor_b32 v40, s70, v12
    v_xor_b32 v41, 64, v40
    v_add_u32 v42, 65536, v40
    v_add_u32 v43, 65536, v41
    s_mov_b32 s52, 0
    v_lshlrev_b32 v8, 4, v7
    v_lshl_add_u32 v8, v0, 8, v8
    v_xor_b32 v9, 16, v8
    v_xor_b32 v10, 32, v8
    v_xor_b32 v11, 48, v8
    v_xor_b32 v12, 64, v8
    v_xor_b32 v13, 80, v8
    v_xor_b32 v14, 96, v8
    v_xor_b32 v15, 112, v8
    s_cmp_eq_u32 s46, 1
    s_cbranch_scc1 L_X
    s_cmp_eq_u32 s46, 2
    s_cbranch_scc1 L_D
L_G:
    s_waitcnt lgkmcnt(0)
    s_add_u32 s76, s76, 2654435769
    s_cmp_eq_u32 s46, 1
    s_cbranch_scc1 L_T
    s_cmp_eq_u32 s46, 2
    s_cbranch_scc1 L_T
L_K:
    s_waitcnt vmcnt(15)
    v_lshl_or_b32 v128, v132, 4, v128
    v_lshl_or_b32 v129, v133, 4, v129
    v_lshl_or_b32 v130, v134, 4, v130
    s_waitcnt vmcnt(14)
    v_lshl_or_b32 v131, v135, 4, v131
    s_waitcnt vmcnt(13)
    v_lshl_or_b32 v128, v136, 8, v128
    v_lshl_or_b32 v129, v137, 8, v129
    v_lshl_or_b32 v130, v138, 8, v130
    s_waitcnt vmcnt(12)
    v_lshl_or_b32 v131, v139, 8, v131
    s_waitcnt vmcnt(11)
    v_lshl_or_b32 v128, v140, 12, v128
    v_lshl_or_b32 v129, v141, 12, v129
    v_lshl_or_b32 v130, v142, 12, v130
    s_waitcnt vmcnt(10)
    v_lshl_or_b32 v131, v143, 12, v131
    v_mov_b32_sdwa v131, s76 dst_sel:WORD_1 dst_unused:UNUSED_PRESERVE src0_sel:WORD_1
    s_waitcnt vmcnt(9)
    v_lshl_or_b32 v128, v144, 16, v128
    v_lshl_or_b32 v129, v145, 16, v129
    v_lshl_or_b32 v130, v146, 16, v130
    s_waitcnt vmcnt(8)
    v_lshl_or_b32 v128, v148, 20, v128
    v_lshl_or_b32 v129, v149, 20, v129
    v_lshl_or_b32 v130, v150, 20, v130
    s_waitcnt vmcnt(7)
    v_lshl_or_b32 v128, v152, 24, v128
    v_lshl_or_b32 v129, v153, 24, v129
    v_lshl_or_b32 v130, v154, 24, v130
    s_waitcnt vmcnt(6)
    v_lshl_or_b32 v128, v156, 28, v128
    v_lshl_or_b32 v129, v157, 28, v129
    v_lshl_or_b32 v130, v158, 28, v130
    buffer_store_dwordx4 v[128:131], v20, s[12:15], s62 offen sc1
    s_add_u32 s62, s62, 65536
    s_cmp_eq_u32 s46, 1
    s_cbranch_scc1 L_B
    s_cmp_eq_u32 s46, 2
    s_cbranch_scc1 L_E
L_T:
    s_waitcnt vmcnt(16)
    s_cmp_eq_u32 s46, 1
    s_cbranch_scc1 L_rw1
    s_waitcnt vmcnt(5)
    s_cmp_eq_u32 s46, 0
    s_cbranch_scc1 L_rw1
    s_waitcnt vmcnt(4)
L_rw1:
    v_lshl_or_b32 v56, v17, 16, v16
    v_lshl_or_b32 v57, v17, 16, v16
    v_lshl_or_b32 v58, v17, 16, v16
    v_lshl_or_b32 v59, v17, 16, v16
    ds_write_b128 v8, v[56:59]
    ds_write_b128 v9, v[56:59]
    ds_write_b128 v10, v[56:59]
    ds_write_b128 v11, v[56:59]
    ds_write_b128 v12, v[56:59]
    ds_write_b128 v13, v[56:59]
    ds_write_b128 v14, v[56:59]
    ds_write_b128 v15, v[56:59]
    s_cmp_lg_u32 s46, 1
    s_cbranch_scc1 L_ed2
    s_waitcnt vmcnt(4)
    s_branch L_K
L_ed2:
    s_cmp_eq_u32 s46, 2
    s_cbranch_scc1 L_X
L_W:
    s_mov_b64 exec, 0
    s_cmp_eq_u32 s63, 0
    s_cbranch_scc1 L_pad0
L_warmed:
    s_mov_b64 exec, -1
L_B:
    s_waitcnt vmcnt(12) lgkmcnt(0)
    s_cmp_eq_u32 s46, 2
    s_cbranch_scc1 L_rw3
    s_waitcnt vmcnt(1)
L_rw3:
    s_barrier
L_Q:
    ds_read_b128 a[0:3], v40 offset:32768
    ds_read_b128 a[4:7], v41 offset:32768
    ds_read_b128 a[8:11], v40 offset:34816
    ds_read_b128 a[12:15], v41 offset:34816
    ds_read_b128 a[16:19], v40 offset:36864
    ds_read_b128 a[20:23], v41 offset:36864
    ds_read_b128 a[24:27], v40 offset:38912
    ds_read_b128 a[28:31], v41 offset:38912
    ds_read_b128 a[40:43], v40 offset:40960
    ds_read_b128 a[44:47], v41 offset:40960
    ds_read_b128 a[48:51], v40 offset:43008
    ds_read_b128 a[52:55], v41 offset:43008
    ds_read_b128 a[56:59], v40 offset:45056
    ds_read_b128 a[60:63], v41 offset:45056
    ds_read_b128 a[72:75], v40 offset:47104
    ds_read_b128 a[76:79], v41 offset:47104
L_P:
    buffer_load_dwordx4 v[64:67], v32, s[12:15], 0 offen sc1
    buffer_load_dwordx4 v[68:71], v33, s[12:15], 0 offen sc1
L_d:
    s_add_u32 m0, s57, 49152
    s_add_u32 s3, s69, 0
    buffer_load_dwordx4 v36, s[8:11], s3 offen offset:0  lds
    buffer_load_dwordx4 v37, s[8:11], s3 offen offset:1024  lds
    buffer_load_dwordx4 v38, s[8:11], s3 offen offset:2048  lds
    buffer_load_dwordx4 v39, s[8:11], s3 offen offset:3072  lds
    s_cmp_lg_u32 s46, 2
    s_cbranch_scc1 L_ed4
    s_waitcnt vmcnt(6)
    s_branch L_K
L_ed4:
L_E:
L_chk0:
    s_waitcnt vmcnt(5)
    s_cmp_eq_u32 s46, 2
    s_cbranch_scc1 L_rw5
    s_waitcnt vmcnt(4)
L_rw5:
    v_bitop3_b32 v12, v67, v71, s76 bitop3:0x7e
    v_cmp_lt_u32 vcc, 0xffff, v12
    s_cbranch_vccnz L_retry0
    buffer_load_dwordx4 v[72:75], v34, s[12:15], 0 offen sc1
    buffer_load_dwordx4 v[76:79], v44, s[12:15], 0 offen sc1
    v_perm_b32 v56, v64, v35, s36
    v_perm_b32 v57, v64, v35, s37
    v_perm_b32 v58, v64, v35, s38
    v_perm_b32 v59, v64, v35, s39
    v_perm_b32 v60, v68, v35, s36
    v_perm_b32 v61, v68, v35, s37
    v_perm_b32 v62, v68, v35, s38
    v_perm_b32 v63, v68, v35, s39
    ds_read_b32 a32, v56
    ds_read_b32 a33, v57
    ds_read_b32 a34, v58
    ds_read_b32 a35, v59
    ds_read_b32 a36, v60
    ds_read_b32 a37, v61
    ds_read_b32 a38, v62
    ds_read_b32 a39, v63
    v_perm_b32 v5, v65, v35, s36
    v_perm_b32 v6, v65, v35, s37
    v_perm_b32 v7, v65, v35, s38
    v_perm_b32 v27, v65, v35, s39
    v_perm_b32 v29, v69, v35, s36
    v_perm_b32 v31, v69, v35, s37
    ds_read_b32 a64, v5
    ds_read_b32 a65, v6
    ds_read_b32 a66, v7
    ds_read_b32 a67, v27
    s_cbranch_vccz L_main
L_retry0:
    s_add_u32 s52, s52, 1
    s_and_b32 s23, s52, 4095
    s_cbranch_scc1 L_retry0b
    s_mov_b32 s22, 0
    s_call_b64 s[20:21], L_help
L_retry0b:
    buffer_load_dwordx4 v[64:67], v32, s[12:15], 0 offen sc1
    buffer_load_dwordx4 v[68:71], v33, s[12:15], 0 offen sc1
    s_waitcnt vmcnt(0) lgkmcnt(0)
    s_branch L_chk0
L_tick:
    s_add_u32 s52, s52, 1
    s_and_b32 s23, s52, 4095
    s_cbranch_scc0 L_help
    s_setpc_b64 s[20:21]
L_slow0_1:
    s_mov_b32 s22, 0
    s_call_b64 s[20:21], L_tick
    buffer_load_dwordx4 v[72:75], v34, s[12:15], 0 offen sc1
    buffer_load_dwordx4 v[76:79], v44, s[12:15], 0 offen sc1
    s_waitcnt vmcnt(0)
    v_bitop3_b32 v12, v75, v79, s76 bitop3:0x7e
    v_cmp_lt_u32 vcc, 0xffff, v12
    s_cbranch_vccnz L_slow0_1
    s_branch L_back0_1
L_slow4_0:
    s_mov_b32 s22, 4
    s_call_b64 s[20:21], L_tick
    buffer_load_dwordx4 v[84:87], v32, s[12:15], s43 offen sc1
    buffer_load_dwordx4 v[96:99], v33, s[12:15], s43 offen sc1
    s_waitcnt vmcnt(0)
    v_bitop3_b32 v12, v87, v99, s76 bitop3:0x7e
    v_cmp_lt_u32 vcc, 0xffff, v12
    s_cbranch_vccnz L_slow4_0
    s_branch L_back4_0
L_slow4_1:
    s_mov_b32 s22, 4
    s_call_b64 s[20:21], L_tick
    buffer_load_dwordx4 v[104:107], v34, s[12:15], s43 offen sc1
    buffer_load_dwordx4 v[108:111], v44, s[12:15], s43 offen sc1
    s_waitcnt vmcnt(0)
    v_bitop3_b32 v12, v107, v111, s76 bitop3:0x7e
    v_cmp_lt_u32 vcc, 0xffff, v12
    s_cbranch_vccnz L_slow4_1
    s_branch L_back4_1
L_slow1_0:
    s_mov_b32 s22, 1
    s_call_b64 s[20:21], L_tick
    buffer_load_dwordx4 v[80:83], v32, s[12:15], s40 offen sc1
    buffer_load_dwordx4 v[84:87], v33, s[12:15], s40 offen sc1
    s_waitcnt vmcnt(0)
    v_bitop3_b32 v12, v83, v87, s76 bitop3:0x7e
    v_cmp_lt_u32 vcc, 0xffff, v12
    s_cbranch_vccnz L_slow1_0
    s_branch L_back1_0
L_slow1_1:
    s_mov_b32 s22, 1
    s_call_b64 s[20:21], L_tick
    buffer_load_dwordx4 v[88:91], v34, s[12:15], s40 offen sc1
    buffer_load_dwordx4 v[92:95], v44, s[12:15], s40 offen sc1
    s_waitcnt vmcnt(0)
    v_bitop3_b32 v12, v91, v95, s76 bitop3:0x7e
    v_cmp_lt_u32 vcc, 0xffff, v12
    s_cbranch_vccnz L_slow1_1
    s_branch L_back1_1
L_slow5_0:
    s_mov_b32 s22, 5
    s_call_b64 s[20:21], L_tick
    buffer_load_dwordx4 v[112:115], v32, s[12:15], s44 offen sc1
    buffer_load_dwordx4 v[116:119], v33, s[12:15], s44 offen sc1
    s_waitcnt vmcnt(0)
    v_bitop3_b32 v12, v115, v119, s76 bitop3:0x7e
    v_cmp_lt_u32 vcc, 0xffff, v12
    s_cbranch_vccnz L_slow5_0
    s_branch L_back5_0
L_slow5_1:
    s_mov_b32 s22, 5
    s_call_b64 s[20:21], L_tick
    buffer_load_dwordx4 v[120:123], v34, s[12:15], s44 offen sc1
    buffer_load_dwordx4 v[124:127], v44, s[12:15], s44 offen sc1
    s_waitcnt vmcnt(0)
    v_bitop3_b32 v12, v123, v127, s76 bitop3:0x7e
    v_cmp_lt_u32 vcc, 0xffff, v12
    s_cbranch_vccnz L_slow5_1
    s_branch L_back5_1
L_slow2_0:
    s_mov_b32 s22, 2
    s_call_b64 s[20:21], L_tick
    buffer_load_dwordx4 v[48:51], v32, s[12:15], s41 offen sc1
    buffer_load_dwordx4 v[52:55], v33, s[12:15], s41 offen sc1
    s_waitcnt vmcnt(0)
    v_bitop3_b32 v12, v51, v55, s76 bitop3:0x7e
    v_cmp_lt_u32 vcc, 0xffff, v12
    s_cbranch_vccnz L_slow2_0
    s_branch L_back2_0
L_slow2_1:
    s_mov_b32 s22, 2
    s_call_b64 s[20:21], L_tick
    buffer_load_dwordx4 v[64:67], v34, s[12:15], s41 offen sc1
    buffer_load_dwordx4 v[68:71], v44, s[12:15], s41 offen sc1
    s_waitcnt vmcnt(0)
    v_bitop3_b32 v12, v67, v71, s76 bitop3:0x7e
    v_cmp_lt_u32 vcc, 0xffff, v12
    s_cbranch_vccnz L_slow2_1
    s_branch L_back2_1
L_slow6_0:
    s_mov_b32 s22, 6
    s_call_b64 s[20:21], L_tick
    buffer_load_dwordx4 v[88:91], v32, s[12:15], s45 offen sc1
    buffer_load_dwordx4 v[92:95], v33, s[12:15], s45 offen sc1
    s_waitcnt vmcnt(0)
    v_bitop3_b32 v12, v91, v95, s76 bitop3:0x7e
    v_cmp_lt_u32 vcc, 0xffff, v12
    s_cbranch_vccnz L_slow6_0
    s_branch L_back6_0
L_slow6_1:
    s_mov_b32 s22, 6
    s_call_b64 s[20:21], L_tick
    buffer_load_dwordx4 v[48:51], v34, s[12:15], s45 offen sc1
    buffer_load_dwordx4 v[52:55], v44, s[12:15], s45 offen sc1
    s_waitcnt vmcnt(0)
    v_bitop3_b32 v12, v51, v55, s76 bitop3:0x7e
    v_cmp_lt_u32 vcc, 0xffff, v12
    s_cbranch_vccnz L_slow6_1
    s_branch L_back6_1
L_slow3_0:
    s_mov_b32 s22, 3
    s_call_b64 s[20:21], L_tick
    buffer_load_dwordx4 v[72:75], v32, s[12:15], s42 offen sc1
    buffer_load_dwordx4 v[76:79], v33, s[12:15], s42 offen sc1
    s_waitcnt vmcnt(0)
    v_bitop3_b32 v12, v75, v79, s76 bitop3:0x7e
    v_cmp_lt_u32 vcc, 0xffff, v12
    s_cbranch_vccnz L_slow3_0
    s_branch L_back3_0
L_slow3_1:
    s_mov_b32 s22, 3
    s_call_b64 s[20:21], L_tick
    buffer_load_dwordx4 v[100:103], v34, s[12:15], s42 offen sc1
    buffer_load_dwordx4 v[80:83], v44, s[12:15], s42 offen sc1
    s_waitcnt vmcnt(0)
    v_bitop3_b32 v12, v103, v83, s76 bitop3:0x7e
    v_cmp_lt_u32 vcc, 0xffff, v12
    s_cbranch_vccnz L_slow3_1
    s_branch L_back3_1
L_slow7_0:
    s_mov_b32 s22, 7
    s_call_b64 s[20:21], L_tick
    buffer_load_dwordx4 v[68:71], v32, s[12:15], s72 offen sc1
    buffer_load_dwordx4 v[72:75], v33, s[12:15], s72 offen sc1
    s_waitcnt vmcnt(0)
    v_bitop3_b32 v12, v71, v75, s76 bitop3:0x7e
    v_cmp_lt_u32 vcc, 0xffff, v12
    s_cbranch_vccnz L_slow7_0
    s_branch L_back7_0
L_slow7_1:
    s_mov_b32 s22, 7
    s_call_b64 s[20:21], L_tick
    buffer_load_dwordx4 v[76:79], v34, s[12:15], s72 offen sc1
    buffer_load_dwordx4 v[100:103], v44, s[12:15], s72 offen sc1
    s_waitcnt vmcnt(0)
    v_bitop3_b32 v12, v79, v103, s76 bitop3:0x7e
    v_cmp_lt_u32 vcc, 0xffff, v12
    s_cbranch_vccnz L_slow7_1
    s_branch L_back7_1
.p2align 12
L_main:
L_pad0:
    s_cbranch_execz L_pad1
    s_waitcnt lgkmcnt(8)
    v_mfma_f32_16x16x32_bf16 v[128:131], a[32:35], a[0:3], 0
    s_waitcnt lgkmcnt(4)
    s_mov_b32 s40, 16384
    ds_read_b32 a68, v29
    v_mfma_f32_16x16x32_bf16 v[128:131], a[36:39], a[4:7], v[128:131]
    buffer_load_dwordx4 v[80:83], v32, s[12:15], s40 offen sc1
    v_mfma_f32_16x16x32_bf16 v[132:135], a[36:39], a[12:15], 0
    s_add_u32 m0, s57, 65536
    ds_read_b32 a69, v31
    v_perm_b32 v46, v69, v35, s38
    v_mfma_f32_16x16x32_bf16 v[132:135], a[32:35], a[8:11], v[132:135]
    s_add_u32 s56, s55, 256
    ds_read_b32 a70, v46
    v_perm_b32 v56, v69, v35, s39
    v_mfma_f32_16x16x32_bf16 v[136:139], a[32:35], a[16:19], 0
    s_add_u32 s3, s69, 256
    ds_read_b32 a71, v56
    v_mfma_f32_16x16x32_bf16 v[136:139], a[36:39], a[20:23], v[136:139]
    buffer_load_dwordx4 v[84:87], v33, s[12:15], s40 offen sc1
    v_mfma_f32_16x16x32_bf16 v[140:143], a[36:39], a[28:31], 0
    v_perm_b32 v57, v66, v35, s36
    v_perm_b32 v58, v66, v35, s37
    v_mfma_f32_16x16x32_bf16 v[140:143], a[32:35], a[24:27], v[140:143]
    ds_read_b32 a80, v57
    v_perm_b32 v59, v66, v35, s38
    v_mfma_f32_16x16x32_bf16 v[144:147], a[32:35], a[40:43], 0
    ds_read_b32 a81, v58
    v_mfma_f32_16x16x32_bf16 v[144:147], a[36:39], a[44:47], v[144:147]
    buffer_load_dwordx4 v36, s[8:11], s56 offen offset:0  lds
    v_mfma_f32_16x16x32_bf16 v[148:151], a[36:39], a[52:55], 0
    ds_read_b32 a82, v59
    v_perm_b32 v60, v66, v35, s39
    v_mfma_f32_16x16x32_bf16 v[148:151], a[32:35], a[48:51], v[148:151]
    v_perm_b32 v61, v70, v35, s36
    v_perm_b32 v62, v70, v35, s37
    v_mfma_f32_16x16x32_bf16 v[152:155], a[32:35], a[56:59], 0
    s_mov_b32 s41, 32768
    ds_read_b32 a83, v60
    ds_read_b32 a84, v61
    v_mfma_f32_16x16x32_bf16 v[152:155], a[36:39], a[60:63], v[152:155]
    buffer_load_dwordx4 v37, s[8:11], s56 offen offset:1024  lds
    v_mfma_f32_16x16x32_bf16 v[156:159], a[36:39], a[76:79], 0
    ds_read_b32 a85, v62
    v_perm_b32 v63, v70, v35, s38
    v_mfma_f32_16x16x32_bf16 v[156:159], a[32:35], a[72:75], v[156:159]
    s_waitcnt lgkmcnt(6)
    ds_read_b32 a86, v63
    v_perm_b32 v5, v70, v35, s39
    v_mfma_f32_16x16x32_bf16 v[160:163], a[64:67], a[0:3], 0
    ds_read_b32 a87, v5
    v_mfma_f32_16x16x32_bf16 v[160:163], a[68:71], a[4:7], v[160:163]
    buffer_load_dwordx4 v38, s[8:11], s56 offen offset:2048  lds
    v_mfma_f32_16x16x32_bf16 v[164:167], a[68:71], a[12:15], 0
    v_perm_b32 v6, v67, v35, s36
    v_perm_b32 v7, v67, v35, s37
    v_mfma_f32_16x16x32_bf16 v[164:167], a[64:67], a[8:11], v[164:167]
    ds_read_b32 a88, v6
    v_perm_b32 v27, v71, v35, s36
    v_mfma_f32_16x16x32_bf16 v[168:171], a[64:67], a[16:19], 0
    ds_read_b32 a89, v7
    v_mfma_f32_16x16x32_bf16 v[168:171], a[68:71], a[20:23], v[168:171]
    buffer_load_dwordx4 v39, s[8:11], s56 offen offset:3072  lds
    v_mfma_f32_16x16x32_bf16 v[172:175], a[68:71], a[28:31], 0
    s_add_u32 m0, s57, 81920
    ds_read_b32 a90, v27
    v_perm_b32 v29, v71, v35, s37
    v_mfma_f32_16x16x32_bf16 v[172:175], a[64:67], a[24:27], v[172:175]
    s_add_u32 s56, s55, 512
    ds_read_b32 a91, v29
    v_mfma_f32_16x16x32_bf16 v[176:179], a[64:67], a[40:43], 0
    s_waitcnt vmcnt(6)
    s_mov_b32 s42, 49152
    v_bitop3_b32 v31, v75, v79, s76 bitop3:0x7e
    v_mfma_f32_16x16x32_bf16 v[176:179], a[68:71], a[44:47], v[176:179]
    buffer_load_dwordx4 v[88:91], v34, s[12:15], s40 offen sc1
    v_mfma_f32_16x16x32_bf16 v[180:183], a[68:71], a[52:55], 0
    v_cmp_lt_u32 vcc, 0xffff, v31
    v_mfma_f32_16x16x32_bf16 v[180:183], a[64:67], a[48:51], v[180:183]
    v_mfma_f32_16x16x32_bf16 v[184:187], a[64:67], a[56:59], 0
    s_cbranch_vccnz L_slow0_1
L_back0_1:
    v_mfma_f32_16x16x32_bf16 v[184:187], a[68:71], a[60:63], v[184:187]
    buffer_load_dwordx4 v[92:95], v44, s[12:15], s40 offen sc1
    v_mfma_f32_16x16x32_bf16 v[188:191], a[68:71], a[76:79], 0
    v_perm_b32 v46, v72, v35, s36
    v_perm_b32 v56, v72, v35, s37
    v_mfma_f32_16x16x32_bf16 v[188:191], a[64:67], a[72:75], v[188:191]
    s_waitcnt lgkmcnt(1)
    ds_read_b32 a96, v46
    v_perm_b32 v57, v72, v35, s38
    v_mfma_f32_16x16x32_bf16 v[192:195], a[80:83], a[0:3], 0
    s_barrier
    v_mfma_f32_16x16x32_bf16 v[192:195], a[84:87], a[4:7], v[192:195]
    buffer_load_dwordx4 v36, s[8:11], s3 offen offset:0  lds
    v_mfma_f32_16x16x32_bf16 v[196:199], a[84:87], a[12:15], 0
    ds_read_b32 a97, v56
    v_perm_b32 v58, v72, v35, s39
    v_mfma_f32_16x16x32_bf16 v[196:199], a[80:83], a[8:11], v[196:199]
    ds_read_b32 a98, v57
    ds_read_b32 a99, v58
    v_mfma_f32_16x16x32_bf16 v[200:203], a[80:83], a[16:19], 0
    s_mov_b32 s43, 65536
    ds_read_b128 a[104:107], v40 offset:49152
    v_mfma_f32_16x16x32_bf16 v[200:203], a[84:87], a[20:23], v[200:203]
    buffer_load_dwordx4 v37, s[8:11], s3 offen offset:1024  lds
    v_mfma_f32_16x16x32_bf16 v[204:207], a[84:87], a[28:31], 0
    ds_read_b128 a[108:111], v41 offset:49152
    v_perm_b32 v59, v76, v35, s36
    v_mfma_f32_16x16x32_bf16 v[204:207], a[80:83], a[24:27], v[204:207]
    ds_read_b32 a100, v59
    v_perm_b32 v60, v76, v35, s37
    v_mfma_f32_16x16x32_bf16 v[208:211], a[80:83], a[40:43], 0
    ds_read_b32 a101, v60
    ds_read_b128 a[112:115], v40 offset:51200
    v_mfma_f32_16x16x32_bf16 v[208:211], a[84:87], a[44:47], v[208:211]
    buffer_load_dwordx4 v38, s[8:11], s3 offen offset:2048  lds
    v_mfma_f32_16x16x32_bf16 v[212:215], a[84:87], a[52:55], 0
    ds_read_b128 a[116:119], v41 offset:51200
    v_perm_b32 v61, v76, v35, s38
    v_mfma_f32_16x16x32_bf16 v[212:215], a[80:83], a[48:51], v[212:215]
    ds_read_b32 a102, v61
    v_perm_b32 v62, v76, v35, s39
    v_mfma_f32_16x16x32_bf16 v[216:219], a[80:83], a[56:59], 0
    ds_read_b32 a103, v62
    v_perm_b32 v63, v73, v35, s36
    v_mfma_f32_16x16x32_bf16 v[216:219], a[84:87], a[60:63], v[216:219]
    ds_read_b32 a120, v63
    v_perm_b32 v5, v73, v35, s37
    v_mfma_f32_16x16x32_bf16 v[220:223], a[84:87], a[76:79], 0
    ds_read_b128 a[128:131], v40 offset:53248
    ds_read_b32 a121, v5
    v_mfma_f32_16x16x32_bf16 v[220:223], a[80:83], a[72:75], v[220:223]
    s_waitcnt lgkmcnt(9)
    ds_read_b128 a[132:135], v41 offset:53248
    v_mfma_f32_16x16x32_bf16 v[224:227], a[88:91], a[2:5], 0
    buffer_load_dwordx4 v39, s[8:11], s3 offen offset:3072  lds
    v_mfma_f32_16x16x32_bf16 v[228:231], a[88:91], a[10:13], 0
    s_add_u32 m0, s57, 0
    ds_read_b128 a[136:139], v40 offset:55296
    v_perm_b32 v6, v73, v35, s38
    v_mfma_f32_16x16x32_bf16 v[232:235], a[88:91], a[18:21], 0
    s_add_u32 s3, s69, 512
    ds_read_b128 a[140:143], v41 offset:55296
    v_perm_b32 v7, v73, v35, s39
    v_mfma_f32_16x16x32_bf16 v[236:239], a[88:91], a[26:29], 0
    s_mov_b32 s44, 81920
    ds_read_b32 a122, v6
    ds_read_b32 a123, v7
    v_mfma_f32_16x16x32_bf16 v[240:243], a[88:91], a[42:45], 0
    ds_read_b128 a[144:147], v40 offset:57344
    v_mfma_f32_16x16x32_bf16 v[244:247], a[88:91], a[50:53], 0
    buffer_load_dwordx3 v[96:98], v18, s[4:7], s61 offen nt
    v_mfma_f32_16x16x32_bf16 v[248:251], a[88:91], a[58:61], 0
    ds_read_b128 a[148:151], v41 offset:57344
    v_perm_b32 v27, v77, v35, s36
    v_mfma_f32_16x16x32_bf16 v[252:255], a[88:91], a[74:77], 0
    ds_read_b128 a[156:159], v41 offset:59392
    v_perm_b32 v29, v77, v35, s37
    v_mfma_f32_16x16x32_bf16 v[128:131], a[96:99], a[104:107], v[128:131]
    s_waitcnt lgkmcnt(7)
    ds_read_b128 a[152:155], v40 offset:59392
    ds_read_b32 a124, v27
    v_mfma_f32_16x16x32_bf16 v[128:131], a[100:103], a[108:111], v[128:131]
    buffer_load_dword v99, v19, s[4:7], s61 offen nt
    v_mfma_f32_16x16x32_bf16 v[132:135], a[100:103], a[116:119], v[132:135]
    s_add_u32 s61, s61, 14336
    ds_read_b128 a[160:163], v40 offset:61440
    v_perm_b32 v31, v77, v35, s38
    v_mfma_f32_16x16x32_bf16 v[132:135], a[96:99], a[112:115], v[132:135]
    s_waitcnt lgkmcnt(8)
    ds_read_b128 a[164:167], v41 offset:61440
    v_perm_b32 v46, v77, v35, s39
    v_mfma_f32_16x16x32_bf16 v[136:139], a[96:99], a[128:131], v[136:139]
    s_mov_b32 s45, 98304
    ds_read_b32 a125, v29
    ds_read_b32 a126, v31
    v_mfma_f32_16x16x32_bf16 v[136:139], a[100:103], a[132:135], v[136:139]
    buffer_load_dwordx3 v[100:102], v18, s[4:7], s61 offen nt
    v_mfma_f32_16x16x32_bf16 v[140:143], a[100:103], a[140:143], v[140:143]
    s_waitcnt vmcnt(13)
    ds_read_b128 a[168:171], v40 offset:63488
    v_bitop3_b32 v56, v83, v87, s76 bitop3:0x7e
    v_mfma_f32_16x16x32_bf16 v[140:143], a[96:99], a[136:139], v[140:143]
    s_waitcnt lgkmcnt(8)
    ds_read_b128 a[172:175], v41 offset:63488
    ds_read_b32 a127, v46
    v_mfma_f32_16x16x32_bf16 v[144:147], a[96:99], a[144:147], v[144:147]
    s_waitcnt lgkmcnt(8)
    v_perm_b32 v57, v74, v35, s36
    v_mfma_f32_16x16x32_bf16 v[144:147], a[100:103], a[148:151], v[144:147]
    buffer_load_dword v103, v19, s[4:7], s61 offen nt
    v_mfma_f32_16x16x32_bf16 v[148:151], a[100:103], a[156:159], v[148:151]
    s_add_u32 s61, s61, 14336
    ds_read_b32 a176, v57
    v_perm_b32 v58, v74, v35, s37
    v_mfma_f32_16x16x32_bf16 v[148:151], a[96:99], a[152:155], v[148:151]
    s_waitcnt lgkmcnt(7)
    v_cmp_lt_u32 vcc, 0xffff, v56
    v_perm_b32 v59, v74, v35, s38
    v_mfma_f32_16x16x32_bf16 v[152:155], a[96:99], a[160:163], v[152:155]
    s_waitcnt lgkmcnt(6)
    ds_read_b32 a177, v58
    ds_read_b32 a178, v59
    v_mfma_f32_16x16x32_bf16 v[152:155], a[100:103], a[164:167], v[152:155]
    s_waitcnt lgkmcnt(4)
    buffer_load_dwordx3 v[104:106], v18, s[4:7], s61 offen nt
    v_mfma_f32_16x16x32_bf16 v[156:159], a[100:103], a[172:175], v[156:159]
    v_perm_b32 v60, v74, v35, s39
    s_cbranch_vccnz L_slow1_0
L_back1_0:
    v_mfma_f32_16x16x32_bf16 v[156:159], a[96:99], a[168:171], v[156:159]
    s_waitcnt lgkmcnt(3)
    v_perm_b32 v61, v78, v35, s36
    v_perm_b32 v62, v78, v35, s37
    v_mfma_f32_16x16x32_bf16 v[160:163], a[120:123], a[104:107], v[160:163]
    s_mov_b32 s72, 114688
    ds_read_b32 a179, v60
    ds_read_b32 a180, v61
    v_mfma_f32_16x16x32_bf16 v[160:163], a[124:127], a[108:111], v[160:163]
    buffer_load_dword v107, v19, s[4:7], s61 offen nt
    v_mfma_f32_16x16x32_bf16 v[164:167], a[124:127], a[116:119], v[164:167]
    s_add_u32 s61, s61, 14336
    ds_read_b32 a181, v62
    v_perm_b32 v63, v78, v35, s38
    v_mfma_f32_16x16x32_bf16 v[164:167], a[120:123], a[112:115], v[164:167]
    v_perm_b32 v5, v78, v35, s39
    v_perm_b32 v6, v75, v35, s36
    v_mfma_f32_16x16x32_bf16 v[168:171], a[120:123], a[128:131], v[168:171]
    ds_read_b32 a182, v63
    ds_read_b32 a183, v5
    v_mfma_f32_16x16x32_bf16 v[168:171], a[124:127], a[132:135], v[168:171]
    buffer_load_dwordx3 v[108:110], v18, s[4:7], s61 offen nt
    v_mfma_f32_16x16x32_bf16 v[172:175], a[124:127], a[140:143], v[172:175]
    ds_read_b32 a92, v6
    v_perm_b32 v7, v75, v35, s37
    v_mfma_f32_16x16x32_bf16 v[172:175], a[120:123], a[136:139], v[172:175]
    v_perm_b32 v27, v79, v35, s36
    v_perm_b32 v29, v79, v35, s37
    v_mfma_f32_16x16x32_bf16 v[176:179], a[120:123], a[144:147], v[176:179]
    ds_read_b32 a93, v7
    ds_read_b32 a94, v27
    v_mfma_f32_16x16x32_bf16 v[176:179], a[124:127], a[148:151], v[176:179]
    buffer_load_dword v111, v19, s[4:7], s61 offen nt
    v_mfma_f32_16x16x32_bf16 v[180:183], a[124:127], a[156:159], v[180:183]
    s_add_u32 s61, s61, 14336
    ds_read_b32 a95, v29
    v_perm_b32 v31, v80, v35, s36
    v_mfma_f32_16x16x32_bf16 v[180:183], a[120:123], a[152:155], v[180:183]
    v_perm_b32 v46, v80, v35, s37
    v_perm_b32 v57, v80, v35, s38
    v_mfma_f32_16x16x32_bf16 v[184:187], a[120:123], a[160:163], v[184:187]
    ds_read_b32 a184, v31
    ds_read_b32 a185, v46
    v_mfma_f32_16x16x32_bf16 v[184:187], a[124:127], a[164:167], v[184:187]
    buffer_load_dwordx3 v[112:114], v18, s[4:7], s61 offen nt
    v_mfma_f32_16x16x32_bf16 v[188:191], a[124:127], a[172:175], v[188:191]
    s_add_u32 s61, s61, 14336
    ds_read_b32 a186, v57
    v_perm_b32 v56, v80, v35, s39
    v_mfma_f32_16x16x32_bf16 v[188:191], a[120:123], a[168:171], v[188:191]
    s_waitcnt vmcnt(15) lgkmcnt(6)
    v_perm_b32 v58, v84, v35, s36
    v_perm_b32 v59, v84, v35, s37
    v_mfma_f32_16x16x32_bf16 v[192:195], a[176:179], a[104:107], v[192:195]
    s_barrier
    v_mfma_f32_16x16x32_bf16 v[192:195], a[180:183], a[108:111], v[192:195]
    buffer_load_dwordx3 v[116:118], v18, s[4:7], s61 offen nt
    v_mfma_f32_16x16x32_bf16 v[196:199], a[180:183], a[116:119], v[196:199]
    s_mul_i32 s66, s63, 96
    s_lshl_b32 s67, s65, 5
    s_lshl_b32 s70, s64, 2
    s_add_u32 s67, s67, s70
    s_add_u32 s67, s67, 384
    s_mul_i32 s71, s59, 448
    s_add_u32 s70, s66, s71
    v_mad_u32_u24 v22, v3, 24, s70
    s_add_u32 s70, s67, s71
    v_lshl_add_u32 v23, v3, 3, s70
    s_mov_b32 s34, 7168
    s_mov_b32 s35, 0x20000
    s_mov_b32 s26, 256
    s_mov_b32 s27, 0x20000
    s_lshl_b32 s77, s59, 4
    s_mov_b32 s18, 14680064
    s_mov_b32 s19, 0x20000
    s_sub_u32 s70, 1024, s71
    v_mul_u32_u24 v16, 464, v4
    v_add3_u32 v26, v22, v16, s70
    v_add3_u32 v28, v23, v16, s70
    s_lshl_b32 s70, s63, 9
    s_add_u32 s60, s70, 52992
    s_xor_b32 s70, s70, 512
    s_add_u32 s70, s70, 52992
    v_lshl_add_u32 v30, v2, 2, s70
    v_mul_u32_u24 v16, 2341, v2
    v_lshrrev_b32 v16, 16, v16
    s_mul_i32 s73, s63, 1856
    s_add_u32 s73, s73, 1024
    v_add_lshl_u32 v24, v2, v16, 4
    v_add_u32 v24, s73, v24
    s_lshl_b32 s74, s58, 7
    s_lshl_b32 s75, s63, 2
    s_add_u32 s74, s74, s75
    s_mul_i32 s74, s74, 7168
    s_add_u32 s74, s74, s71
    v_mul_u32_u24 v17, 6720, v16
    v_lshl_add_u32 v25, v2, 4, v17
    v_lshrrev_b32 v16, 1, v16
    v_lshlrev_b32 v16, 30, v16
    v_add3_u32 v25, v25, v16, s74
    v_mov_b32 v45, 1
    v_lshlrev_b32 v1, 22, v0
    v_mov_b32 v47, s76
    v_mfma_f32_16x16x32_bf16 v[196:199], a[176:179], a[112:115], v[196:199]
    s_add_u32 s61, s61, 14336
    ds_read_b32 a187, v56
    ds_read_b32 a188, v58
    v_mfma_f32_16x16x32_bf16 v[200:203], a[176:179], a[128:131], v[200:203]
    ds_read_b32 a189, v59
    ds_read_b128 a[192:195], v42 offset:0
    v_mfma_f32_16x16x32_bf16 v[200:203], a[180:183], a[132:135], v[200:203]
    buffer_load_dwordx3 v[120:122], v18, s[4:7], s61 offen nt
    v_mfma_f32_16x16x32_bf16 v[204:207], a[180:183], a[140:143], v[204:207]
    s_add_u32 s61, s61, 14336
    ds_read_b128 a[196:199], v43 offset:0
    v_perm_b32 v60, v84, v35, s38
    v_mfma_f32_16x16x32_bf16 v[204:207], a[176:179], a[136:139], v[204:207]
    ds_read_b32 a190, v60
    ds_read_b128 a[204:207], v43 offset:2048
    v_perm_b32 v61, v84, v35, s39
    v_mfma_f32_16x16x32_bf16 v[208:211], a[176:179], a[144:147], v[208:211]
    ds_read_b32 a191, v61
    ds_read_b128 a[200:203], v42 offset:2048
    v_mfma_f32_16x16x32_bf16 v[208:211], a[180:183], a[148:151], v[208:211]
    buffer_load_dwordx3 v[124:126], v18, s[4:7], s61 offen nt
    v_mfma_f32_16x16x32_bf16 v[212:215], a[180:183], a[156:159], v[212:215]
    ds_read_b128 a[208:211], v42 offset:4096
    v_perm_b32 v62, v81, v35, s36
    v_mfma_f32_16x16x32_bf16 v[212:215], a[176:179], a[152:155], v[212:215]
    ds_read_b128 a[212:215], v43 offset:4096
    ds_read_b32 a216, v62
    v_mfma_f32_16x16x32_bf16 v[216:219], a[176:179], a[160:163], v[216:219]
    ds_read_b128 a[228:231], v43 offset:6144
    v_perm_b32 v63, v81, v35, s37
    v_mfma_f32_16x16x32_bf16 v[216:219], a[180:183], a[164:167], v[216:219]
    ds_read_b128 a[224:227], v42 offset:6144
    ds_read_b32 a217, v63
    v_mfma_f32_16x16x32_bf16 v[220:223], a[180:183], a[172:175], v[220:223]
    buffer_load_dwordx4 v[48:51], v32, s[12:15], s41 offen sc1
    v_mfma_f32_16x16x32_bf16 v[220:223], a[176:179], a[168:171], v[220:223]
    s_waitcnt lgkmcnt(10)
    ds_read_b128 a[232:235], v42 offset:8192
    v_perm_b32 v5, v81, v35, s38
    v_mfma_f32_16x16x32_bf16 v[224:227], a[92:95], a[106:109], v[224:227]
    ds_read_b128 a[236:239], v43 offset:8192
    ds_read_b32 a218, v5
    v_mfma_f32_16x16x32_bf16 v[228:231], a[92:95], a[114:117], v[228:231]
    ds_read_b128 a[244:247], v43 offset:10240
    v_perm_b32 v6, v81, v35, s39
    v_mfma_f32_16x16x32_bf16 v[232:235], a[92:95], a[130:133], v[232:235]
    ds_read_b128 a[240:243], v42 offset:10240
    ds_read_b32 a219, v6
    v_mfma_f32_16x16x32_bf16 v[236:239], a[92:95], a[138:141], v[236:239]
    buffer_load_dwordx4 v[52:55], v33, s[12:15], s41 offen sc1
    v_mfma_f32_16x16x32_bf16 v[240:243], a[92:95], a[146:149], v[240:243]
    ds_read_b128 a[248:251], v42 offset:12288
    v_perm_b32 v7, v85, v35, s36
    v_mfma_f32_16x16x32_bf16 v[244:247], a[92:95], a[154:157], v[244:247]
    ds_read_b128 a[252:255], v43 offset:12288
    ds_read_b32 a220, v7
    v_mfma_f32_16x16x32_bf16 v[248:251], a[92:95], a[162:165], v[248:251]
    v_perm_b32 v27, v85, v35, s37
    v_perm_b32 v29, v85, v35, s38
    v_mfma_f32_16x16x32_bf16 v[252:255], a[92:95], a[170:173], v[252:255]
    s_waitcnt vmcnt(18) lgkmcnt(9)
    ds_read_b32 a221, v27
    ds_read_b32 a222, v29
    v_mfma_f32_16x16x32_bf16 v[128:131], a[184:187], a[192:195], v[128:131]
    buffer_load_dwordx4 v36, s[8:11], s56 offen offset:0  lds
    v_mfma_f32_16x16x32_bf16 v[128:131], a[188:191], a[196:199], v[128:131]
    ds_read_b128 a[32:35], v42 offset:14336
    v_perm_b32 v46, v85, v35, s39
    v_bitop3_b32 v31, v91, v95, s76 bitop3:0x7e
    v_mfma_f32_16x16x32_bf16 v[132:135], a[188:191], a[204:207], v[132:135]
    ds_read_b128 a[36:39], v43 offset:14336
    v_perm_b32 v57, v82, v35, s36
    v_cmp_lt_u32 vcc, 0xffff, v31
    v_mfma_f32_16x16x32_bf16 v[132:135], a[184:187], a[200:203], v[132:135]
    s_waitcnt vmcnt(11)
    ds_read_b32 a223, v46
    v_perm_b32 v56, v82, v35, s37
    v_mfma_f32_16x16x32_bf16 v[136:139], a[184:187], a[208:211], v[136:139]
    v_lshl_or_b32 v96, v100, 4, v96
    v_lshl_or_b32 v97, v101, 4, v97
    v_lshl_or_b32 v98, v102, 4, v98
    v_lshl_or_b32 v99, v103, 4, v99
    v_mfma_f32_16x16x32_bf16 v[136:139], a[188:191], a[212:215], v[136:139]
    buffer_load_dwordx4 v37, s[8:11], s56 offen offset:1024  lds
    v_mfma_f32_16x16x32_bf16 v[140:143], a[188:191], a[228:231], v[140:143]
    ds_read_b32 a64, v57
    s_cbranch_vccnz L_slow1_1
L_back1_1:
    v_mfma_f32_16x16x32_bf16 v[140:143], a[184:187], a[224:227], v[140:143]
    s_waitcnt lgkmcnt(6)
    v_perm_b32 v58, v82, v35, s38
    v_perm_b32 v59, v82, v35, s39
    v_mfma_f32_16x16x32_bf16 v[144:147], a[184:187], a[232:235], v[144:147]
    ds_read_b32 a65, v56
    v_perm_b32 v60, v86, v35, s36
    v_mfma_f32_16x16x32_bf16 v[144:147], a[188:191], a[236:239], v[144:147]
    ds_read_b32 a66, v58
    v_perm_b32 v61, v86, v35, s37
    v_mfma_f32_16x16x32_bf16 v[148:151], a[188:191], a[244:247], v[148:151]
    ds_read_b32 a67, v59
    v_perm_b32 v62, v86, v35, s38
    v_mfma_f32_16x16x32_bf16 v[148:151], a[184:187], a[240:243], v[148:151]
    ds_read_b32 a68, v60
    ds_read_b32 a69, v61
    v_mfma_f32_16x16x32_bf16 v[152:155], a[184:187], a[248:251], v[152:155]
    buffer_load_dwordx4 v38, s[8:11], s56 offen offset:2048  lds
    v_mfma_f32_16x16x32_bf16 v[152:155], a[188:191], a[252:255], v[152:155]
    s_waitcnt lgkmcnt(6)
    ds_read_b32 a70, v62
    v_perm_b32 v63, v86, v35, s39
    v_mfma_f32_16x16x32_bf16 v[156:159], a[188:191], a[36:39], v[156:159]
    v_perm_b32 v5, v83, v35, s36
    v_perm_b32 v6, v83, v35, s37
    v_mfma_f32_16x16x32_bf16 v[156:159], a[184:187], a[32:35], v[156:159]
    ds_read_b32 a71, v63
    ds_read_b32 a80, v5
    v_mfma_f32_16x16x32_bf16 v[160:163], a[216:219], a[192:195], v[160:163]
    buffer_load_dwordx4 v39, s[8:11], s56 offen offset:3072  lds
    v_mfma_f32_16x16x32_bf16 v[160:163], a[220:223], a[196:199], v[160:163]
    s_add_u32 m0, s57, 16384
    ds_read_b32 a81, v6
    v_perm_b32 v7, v87, v35, s36
    v_mfma_f32_16x16x32_bf16 v[164:167], a[220:223], a[204:207], v[164:167]
    s_add_u32 s56, s55, 768
    v_perm_b32 v27, v87, v35, s37
    v_perm_b32 v29, v88, v35, s36
    v_mfma_f32_16x16x32_bf16 v[164:167], a[216:219], a[200:203], v[164:167]
    ds_read_b32 a82, v7
    v_perm_b32 v31, v88, v35, s37
    v_mfma_f32_16x16x32_bf16 v[168:171], a[216:219], a[208:211], v[168:171]
    ds_read_b32 a83, v27
    v_perm_b32 v46, v88, v35, s38
    v_mfma_f32_16x16x32_bf16 v[168:171], a[220:223], a[212:215], v[168:171]
    ds_read_b32 a0, v29
    v_perm_b32 v57, v88, v35, s39
    v_mfma_f32_16x16x32_bf16 v[172:175], a[220:223], a[228:231], v[172:175]
    ds_read_b32 a1, v31
    v_perm_b32 v56, v92, v35, s36
    v_mfma_f32_16x16x32_bf16 v[172:175], a[216:219], a[224:227], v[172:175]
    ds_read_b32 a2, v46
    v_perm_b32 v58, v92, v35, s37
    v_mfma_f32_16x16x32_bf16 v[176:179], a[216:219], a[232:235], v[176:179]
    ds_read_b32 a3, v57
    v_perm_b32 v59, v92, v35, s38
    v_mfma_f32_16x16x32_bf16 v[176:179], a[220:223], a[236:239], v[176:179]
    ds_read_b32 a4, v56
    v_perm_b32 v60, v92, v35, s39
    v_mfma_f32_16x16x32_bf16 v[180:183], a[220:223], a[244:247], v[180:183]
    ds_read_b32 a5, v58
    v_perm_b32 v61, v89, v35, s36
    v_mfma_f32_16x16x32_bf16 v[180:183], a[216:219], a[240:243], v[180:183]
    ds_read_b32 a6, v59
    ds_read_b32 a7, v60
    v_mfma_f32_16x16x32_bf16 v[184:187], a[216:219], a[248:251], v[184:187]
    buffer_load_dwordx4 v[64:67], v34, s[12:15], s41 offen sc1
    v_mfma_f32_16x16x32_bf16 v[184:187], a[220:223], a[252:255], v[184:187]
    ds_read_b32 a8, v61
    v_perm_b32 v62, v89, v35, s37
    v_mfma_f32_16x16x32_bf16 v[188:191], a[220:223], a[36:39], v[188:191]
    v_perm_b32 v63, v89, v35, s38
    v_perm_b32 v5, v89, v35, s39
    v_mfma_f32_16x16x32_bf16 v[188:191], a[216:219], a[32:35], v[188:191]
    s_waitcnt lgkmcnt(7)
    ds_read_b32 a9, v62
    ds_read_b32 a10, v63
    v_mfma_f32_16x16x32_bf16 v[192:195], a[64:67], a[192:195], v[192:195]
    buffer_load_dwordx4 v[68:71], v44, s[12:15], s41 offen sc1
    v_mfma_f32_16x16x32_bf16 v[192:195], a[68:71], a[196:199], v[192:195]
    s_barrier
    v_mfma_f32_16x16x32_bf16 v[196:199], a[68:71], a[204:207], v[196:199]
    ds_read_b32 a11, v5
    v_perm_b32 v6, v93, v35, s36
    v_mfma_f32_16x16x32_bf16 v[196:199], a[64:67], a[200:203], v[196:199]
    ds_read_b32 a12, v6
    ds_read_b128 a[16:19], v42 offset:16384
    v_mfma_f32_16x16x32_bf16 v[200:203], a[64:67], a[208:211], v[200:203]
    buffer_load_dwordx4 v[72:75], v32, s[12:15], s42 offen sc1
    v_mfma_f32_16x16x32_bf16 v[200:203], a[68:71], a[212:215], v[200:203]
    ds_read_b128 a[20:23], v43 offset:16384
    v_perm_b32 v7, v93, v35, s37
    v_mfma_f32_16x16x32_bf16 v[204:207], a[68:71], a[228:231], v[204:207]
    ds_read_b32 a13, v7
    v_perm_b32 v27, v93, v35, s38
    v_mfma_f32_16x16x32_bf16 v[204:207], a[64:67], a[224:227], v[204:207]
    ds_read_b32 a14, v27
    ds_read_b128 a[24:27], v42 offset:18432
    v_mfma_f32_16x16x32_bf16 v[208:211], a[64:67], a[232:235], v[208:211]
    buffer_load_dwordx4 v[76:79], v33, s[12:15], s42 offen sc1
    v_mfma_f32_16x16x32_bf16 v[208:211], a[68:71], a[236:239], v[208:211]
    ds_read_b128 a[28:31], v43 offset:18432
    v_perm_b32 v29, v93, v35, s39
    v_mfma_f32_16x16x32_bf16 v[212:215], a[68:71], a[244:247], v[212:215]
    ds_read_b32 a15, v29
    v_perm_b32 v31, v90, v35, s36
    v_mfma_f32_16x16x32_bf16 v[212:215], a[64:67], a[240:243], v[212:215]
    ds_read_b32 a48, v31
    ds_read_b128 a[40:43], v42 offset:20480
    v_mfma_f32_16x16x32_bf16 v[216:219], a[64:67], a[248:251], v[216:219]
    buffer_load_dwordx4 v36, s[8:11], s3 offen offset:0  lds
    v_mfma_f32_16x16x32_bf16 v[216:219], a[68:71], a[252:255], v[216:219]
    ds_read_b128 a[44:47], v43 offset:20480
    v_perm_b32 v46, v90, v35, s37
    v_mfma_f32_16x16x32_bf16 v[220:223], a[68:71], a[36:39], v[220:223]
    s_waitcnt vmcnt(16)
    ds_read_b32 a49, v46
    v_perm_b32 v57, v90, v35, s38
    v_mfma_f32_16x16x32_bf16 v[220:223], a[64:67], a[32:35], v[220:223]
    v_lshl_or_b32 v96, v104, 8, v96
    v_lshl_or_b32 v97, v105, 8, v97
    v_lshl_or_b32 v98, v106, 8, v98
    v_lshl_or_b32 v99, v107, 8, v99
    v_lshl_or_b32 v96, v108, 12, v96
    v_lshl_or_b32 v97, v109, 12, v97
    v_lshl_or_b32 v98, v110, 12, v98
    s_waitcnt vmcnt(15)
    v_lshl_or_b32 v99, v111, 12, v99
    v_mov_b32_sdwa v99, s76 dst_sel:WORD_1 dst_unused:UNUSED_PRESERVE src0_sel:WORD_1
    s_waitcnt vmcnt(14)
    v_lshl_or_b32 v96, v112, 16, v96
    v_lshl_or_b32 v97, v113, 16, v97
    v_lshl_or_b32 v98, v114, 16, v98
    s_waitcnt vmcnt(13)
    v_lshl_or_b32 v96, v116, 20, v96
    v_lshl_or_b32 v97, v117, 20, v97
    v_lshl_or_b32 v98, v118, 20, v98
L_pad1:
    s_cbranch_execz L_pad2
    s_waitcnt vmcnt(12)
    v_lshl_or_b32 v96, v120, 24, v96
    v_lshl_or_b32 v97, v121, 24, v97
    v_lshl_or_b32 v98, v122, 24, v98
    s_waitcnt vmcnt(11)
    v_lshl_or_b32 v96, v124, 28, v96
    v_lshl_or_b32 v97, v125, 28, v97
    v_lshl_or_b32 v98, v126, 28, v98
    buffer_store_dwordx4 v[96:99], v20, s[12:15], s62 offen sc1
    v_mfma_f32_16x16x32_bf16 v[224:227], a[80:83], a[194:197], v[224:227]
    buffer_load_dwordx4 v37, s[8:11], s3 offen offset:1024  lds
    v_mfma_f32_16x16x32_bf16 v[228:231], a[80:83], a[202:205], v[228:231]
    ds_read_b32 a50, v57
    v_perm_b32 v56, v90, v35, s39
    v_mfma_f32_16x16x32_bf16 v[232:235], a[80:83], a[210:213], v[232:235]
    s_waitcnt vmcnt(11)
    ds_read_b128 a[60:63], v43 offset:22528
    ds_read_b32 a51, v56
    v_mfma_f32_16x16x32_bf16 v[236:239], a[80:83], a[226:229], v[236:239]
    ds_read_b128 a[56:59], v42 offset:22528
    v_perm_b32 v59, v94, v35, s36
    v_bitop3_b32 v58, v51, v55, s76 bitop3:0x7e
    v_mfma_f32_16x16x32_bf16 v[240:243], a[80:83], a[234:237], v[240:243]
    ds_read_b128 a[72:75], v42 offset:24576
    ds_read_b32 a52, v59
    v_cmp_lt_u32 vcc, 0xffff, v58
    v_mfma_f32_16x16x32_bf16 v[244:247], a[80:83], a[242:245], v[244:247]
    ds_read_b128 a[76:79], v43 offset:24576
    v_perm_b32 v60, v94, v35, s37
    v_mfma_f32_16x16x32_bf16 v[248:251], a[80:83], a[250:253], v[248:251]
    ds_read_b32 a53, v60
    v_perm_b32 v61, v94, v35, s38
    v_mfma_f32_16x16x32_bf16 v[252:255], a[80:83], a[34:37], v[252:255]
    s_waitcnt lgkmcnt(8)
    ds_read_b128 a[100:103], v43 offset:26624
    ds_read_b32 a54, v61
    v_mfma_f32_16x16x32_bf16 v[128:131], a[0:3], a[16:19], v[128:131]
    buffer_load_dwordx4 v38, s[8:11], s3 offen offset:2048  lds
    v_mfma_f32_16x16x32_bf16 v[128:131], a[4:7], a[20:23], v[128:131]
    ds_read_b128 a[96:99], v42 offset:26624
    s_cbranch_vccnz L_slow2_0
L_back2_0:
    v_mfma_f32_16x16x32_bf16 v[132:135], a[4:7], a[28:31], v[132:135]
    ds_read_b128 a[120:123], v42 offset:28672
    v_perm_b32 v62, v94, v35, s39
    v_mfma_f32_16x16x32_bf16 v[132:135], a[0:3], a[24:27], v[132:135]
    s_waitcnt lgkmcnt(8)
    ds_read_b128 a[124:127], v43 offset:28672
    ds_read_b32 a55, v62
    v_mfma_f32_16x16x32_bf16 v[136:139], a[0:3], a[40:43], v[136:139]
    buffer_load_dwordx4 v39, s[8:11], s3 offen offset:3072  lds
    v_mfma_f32_16x16x32_bf16 v[136:139], a[4:7], a[44:47], v[136:139]
    s_add_u32 m0, s57, 32768
    ds_read_b128 a[176:179], v42 offset:30720
    v_perm_b32 v63, v91, v35, s36
    v_mfma_f32_16x16x32_bf16 v[140:143], a[4:7], a[60:63], v[140:143]
    s_add_u32 s3, s69, 768
    v_perm_b32 v5, v91, v35, s37
    v_perm_b32 v6, v95, v35, s36
    v_mfma_f32_16x16x32_bf16 v[140:143], a[0:3], a[56:59], v[140:143]
    s_waitcnt lgkmcnt(7)
    ds_read_b128 a[180:183], v43 offset:30720
    ds_read_b32 a84, v63
    v_mfma_f32_16x16x32_bf16 v[144:147], a[0:3], a[72:75], v[144:147]
    buffer_load_dwordx4 v36, s[8:11], s56 offen offset:0  lds
    v_mfma_f32_16x16x32_bf16 v[144:147], a[4:7], a[76:79], v[144:147]
    s_waitcnt lgkmcnt(7)
    ds_read_b32 a85, v5
    v_perm_b32 v7, v95, v35, s37
    v_mfma_f32_16x16x32_bf16 v[148:151], a[4:7], a[100:103], v[148:151]
    s_waitcnt lgkmcnt(7)
    ds_read_b32 a86, v6
    v_perm_b32 v27, v48, v35, s36
    v_mfma_f32_16x16x32_bf16 v[148:151], a[0:3], a[96:99], v[148:151]
    s_waitcnt lgkmcnt(6)
    ds_read_b32 a87, v7
    ds_read_b32 a104, v27
    v_mfma_f32_16x16x32_bf16 v[152:155], a[0:3], a[120:123], v[152:155]
    buffer_load_dwordx4 v37, s[8:11], s56 offen offset:1024  lds
    v_mfma_f32_16x16x32_bf16 v[152:155], a[4:7], a[124:127], v[152:155]
    s_waitcnt lgkmcnt(5)
    v_perm_b32 v29, v48, v35, s37
    v_perm_b32 v31, v48, v35, s38
    v_mfma_f32_16x16x32_bf16 v[156:159], a[4:7], a[180:183], v[156:159]
    ds_read_b32 a105, v29
    v_perm_b32 v46, v48, v35, s39
    v_mfma_f32_16x16x32_bf16 v[156:159], a[0:3], a[176:179], v[156:159]
    ds_read_b32 a106, v31
    ds_read_b32 a107, v46
    v_mfma_f32_16x16x32_bf16 v[160:163], a[8:11], a[16:19], v[160:163]
    buffer_load_dwordx4 v38, s[8:11], s56 offen offset:2048  lds
    v_mfma_f32_16x16x32_bf16 v[160:163], a[12:15], a[20:23], v[160:163]
    v_perm_b32 v57, v52, v35, s36
    v_perm_b32 v56, v52, v35, s37
    v_mfma_f32_16x16x32_bf16 v[164:167], a[12:15], a[28:31], v[164:167]
    s_waitcnt vmcnt(12)
    ds_read_b32 a108, v57
    v_perm_b32 v58, v52, v35, s38
    v_mfma_f32_16x16x32_bf16 v[164:167], a[8:11], a[24:27], v[164:167]
    s_barrier
    v_mfma_f32_16x16x32_bf16 v[168:171], a[8:11], a[40:43], v[168:171]
    buffer_load_dwordx4 v39, s[8:11], s56 offen offset:3072  lds
    v_mfma_f32_16x16x32_bf16 v[168:171], a[12:15], a[44:47], v[168:171]
    s_add_u32 m0, s57, 49152
    ds_read_b32 a109, v56
    v_perm_b32 v59, v52, v35, s39
    v_mfma_f32_16x16x32_bf16 v[172:175], a[12:15], a[60:63], v[172:175]
    s_add_u32 s56, s55, 1024
    ds_read_b128 a[112:115], v40 offset:0
    ds_read_b32 a110, v58
    v_mfma_f32_16x16x32_bf16 v[172:175], a[8:11], a[56:59], v[172:175]
    ds_read_b128 a[116:119], v41 offset:0
    v_perm_b32 v60, v49, v35, s36
    v_mfma_f32_16x16x32_bf16 v[176:179], a[8:11], a[72:75], v[176:179]
    ds_read_b32 a111, v59
    ds_read_b128 a[132:135], v41 offset:2048
    v_mfma_f32_16x16x32_bf16 v[176:179], a[12:15], a[76:79], v[176:179]
    ds_read_b128 a[128:131], v40 offset:2048
    ds_read_b32 a136, v60
    v_mfma_f32_16x16x32_bf16 v[180:183], a[12:15], a[100:103], v[180:183]
    buffer_load_dwordx4 v36, s[8:11], s3 offen offset:0  lds
    v_mfma_f32_16x16x32_bf16 v[180:183], a[8:11], a[96:99], v[180:183]
    ds_read_b128 a[144:147], v40 offset:4096
    v_perm_b32 v61, v49, v35, s37
    v_mfma_f32_16x16x32_bf16 v[184:187], a[8:11], a[120:123], v[184:187]
    v_perm_b32 v62, v49, v35, s38
    v_perm_b32 v63, v49, v35, s39
    v_mfma_f32_16x16x32_bf16 v[184:187], a[12:15], a[124:127], v[184:187]
    s_waitcnt vmcnt(12)
    ds_read_b128 a[148:151], v41 offset:4096
    v_bitop3_b32 v5, v67, v71, s76 bitop3:0x7e
    v_mfma_f32_16x16x32_bf16 v[188:191], a[12:15], a[180:183], v[188:191]
    ds_read_b32 a137, v61
    v_cmp_lt_u32 vcc, 0xffff, v5
    v_mfma_f32_16x16x32_bf16 v[188:191], a[8:11], a[176:179], v[188:191]
    ds_read_b32 a138, v62
    v_perm_b32 v6, v53, v35, s36
    v_mfma_f32_16x16x32_bf16 v[192:195], a[48:51], a[16:19], v[192:195]
    ds_read_b128 a[152:155], v40 offset:6144
    ds_read_b32 a139, v63
    v_mfma_f32_16x16x32_bf16 v[192:195], a[52:55], a[20:23], v[192:195]
    buffer_load_dwordx4 v37, s[8:11], s3 offen offset:1024  lds
    v_mfma_f32_16x16x32_bf16 v[196:199], a[52:55], a[28:31], v[196:199]
    ds_read_b32 a140, v6
    s_cbranch_vccnz L_slow2_1
L_back2_1:
    v_mfma_f32_16x16x32_bf16 v[196:199], a[48:51], a[24:27], v[196:199]
    ds_read_b128 a[156:159], v41 offset:6144
    v_perm_b32 v7, v53, v35, s37
    v_mfma_f32_16x16x32_bf16 v[200:203], a[48:51], a[40:43], v[200:203]
    ds_read_b32 a141, v7
    v_perm_b32 v27, v53, v35, s38
    v_mfma_f32_16x16x32_bf16 v[200:203], a[52:55], a[44:47], v[200:203]
    ds_read_b32 a142, v27
    v_perm_b32 v29, v53, v35, s39
    v_mfma_f32_16x16x32_bf16 v[204:207], a[52:55], a[60:63], v[204:207]
    ds_read_b128 a[160:163], v40 offset:8192
    v_perm_b32 v31, v50, v35, s36
    v_mfma_f32_16x16x32_bf16 v[204:207], a[48:51], a[56:59], v[204:207]
    ds_read_b32 a143, v29
    v_perm_b32 v46, v50, v35, s37
    v_mfma_f32_16x16x32_bf16 v[208:211], a[48:51], a[72:75], v[208:211]
    ds_read_b32 a88, v31
    ds_read_b32 a89, v46
    v_mfma_f32_16x16x32_bf16 v[208:211], a[52:55], a[76:79], v[208:211]
    buffer_load_dwordx4 v38, s[8:11], s3 offen offset:2048  lds
    v_mfma_f32_16x16x32_bf16 v[212:215], a[52:55], a[100:103], v[212:215]
    ds_read_b128 a[164:167], v41 offset:8192
    v_perm_b32 v57, v50, v35, s38
    v_mfma_f32_16x16x32_bf16 v[212:215], a[48:51], a[96:99], v[212:215]
    v_perm_b32 v56, v50, v35, s39
    v_perm_b32 v58, v54, v35, s36
    v_mfma_f32_16x16x32_bf16 v[216:219], a[48:51], a[120:123], v[216:219]
    ds_read_b128 a[168:171], v40 offset:10240
    v_perm_b32 v59, v54, v35, s37
    v_mfma_f32_16x16x32_bf16 v[216:219], a[52:55], a[124:127], v[216:219]
    v_perm_b32 v60, v54, v35, s38
    v_perm_b32 v61, v54, v35, s39
    v_mfma_f32_16x16x32_bf16 v[220:223], a[52:55], a[180:183], v[220:223]
    ds_read_b32 a90, v57
    v_perm_b32 v5, v51, v35, s36
    v_mfma_f32_16x16x32_bf16 v[220:223], a[48:51], a[176:179], v[220:223]
    s_waitcnt lgkmcnt(6)
    ds_read_b128 a[172:175], v41 offset:10240
    ds_read_b32 a91, v56
    v_mfma_f32_16x16x32_bf16 v[224:227], a[84:87], a[18:21], v[224:227]
    buffer_load_dwordx4 v39, s[8:11], s3 offen offset:3072  lds
    v_mfma_f32_16x16x32_bf16 v[228:231], a[84:87], a[26:29], v[228:231]
    s_add_u32 m0, s57, 65536
    ds_read_b32 a92, v58
    v_perm_b32 v62, v51, v35, s37
    v_mfma_f32_16x16x32_bf16 v[232:235], a[84:87], a[42:45], v[232:235]
    s_add_u32 s3, s69, 1024
    ds_read_b128 a[184:187], v40 offset:12288
    ds_read_b32 a93, v59
    v_mfma_f32_16x16x32_bf16 v[236:239], a[84:87], a[58:61], v[236:239]
    ds_read_b32 a94, v60
    v_perm_b32 v63, v55, v35, s36
    v_mfma_f32_16x16x32_bf16 v[240:243], a[84:87], a[74:77], v[240:243]
    ds_read_b32 a95, v61
    ds_read_b32 a216, v5
    v_mfma_f32_16x16x32_bf16 v[244:247], a[84:87], a[98:101], v[244:247]
    buffer_load_dwordx4 v[100:103], v34, s[12:15], s42 offen sc1
    v_mfma_f32_16x16x32_bf16 v[248:251], a[84:87], a[122:125], v[248:251]
    ds_read_b128 a[188:191], v41 offset:12288
    v_perm_b32 v6, v55, v35, s37
    v_mfma_f32_16x16x32_bf16 v[252:255], a[84:87], a[178:181], v[252:255]
    v_perm_b32 v7, v64, v35, s36
    v_perm_b32 v27, v64, v35, s37
    v_mfma_f32_16x16x32_bf16 v[128:131], a[104:107], a[112:115], v[128:131]
    ds_read_b128 a[64:67], v40 offset:14336
    ds_read_b32 a217, v62
    v_mfma_f32_16x16x32_bf16 v[128:131], a[108:111], a[116:119], v[128:131]
    buffer_load_dwordx4 v[80:83], v44, s[12:15], s42 offen sc1
    v_mfma_f32_16x16x32_bf16 v[132:135], a[108:111], a[132:135], v[132:135]
    ds_read_b128 a[68:71], v41 offset:14336
    v_perm_b32 v29, v64, v35, s38
    v_mfma_f32_16x16x32_bf16 v[132:135], a[104:107], a[128:131], v[132:135]
    ds_read_b32 a218, v63
    v_perm_b32 v31, v64, v35, s39
    v_mfma_f32_16x16x32_bf16 v[136:139], a[104:107], a[144:147], v[136:139]
    ds_read_b32 a219, v6
    v_perm_b32 v46, v68, v35, s36
    v_mfma_f32_16x16x32_bf16 v[136:139], a[108:111], a[148:151], v[136:139]
    ds_read_b32 a192, v7
    v_perm_b32 v57, v68, v35, s37
    v_mfma_f32_16x16x32_bf16 v[140:143], a[108:111], a[156:159], v[140:143]
    ds_read_b32 a193, v27
    v_perm_b32 v56, v68, v35, s38
    v_mfma_f32_16x16x32_bf16 v[140:143], a[104:107], a[152:155], v[140:143]
    ds_read_b32 a194, v29
    v_perm_b32 v58, v68, v35, s39
    v_mfma_f32_16x16x32_bf16 v[144:147], a[104:107], a[160:163], v[144:147]
    s_waitcnt lgkmcnt(8)
    ds_read_b32 a195, v31
    ds_read_b32 a196, v46
    v_mfma_f32_16x16x32_bf16 v[144:147], a[108:111], a[164:167], v[144:147]
    buffer_load_dwordx4 v36, s[8:11], s56 offen offset:0  lds
    v_mfma_f32_16x16x32_bf16 v[148:151], a[108:111], a[172:175], v[148:151]
    v_perm_b32 v59, v65, v35, s36
    v_perm_b32 v60, v65, v35, s37
    v_mfma_f32_16x16x32_bf16 v[148:151], a[104:107], a[168:171], v[148:151]
    s_waitcnt vmcnt(16)
    ds_read_b32 a197, v57
    v_bitop3_b32 v61, v75, v79, s76 bitop3:0x7e
    v_mfma_f32_16x16x32_bf16 v[152:155], a[104:107], a[184:187], v[152:155]
    ds_read_b32 a198, v56
    v_cmp_lt_u32 vcc, 0xffff, v61
    v_mfma_f32_16x16x32_bf16 v[152:155], a[108:111], a[188:191], v[152:155]
    s_waitcnt lgkmcnt(7)
    ds_read_b32 a199, v58
    v_perm_b32 v5, v65, v35, s38
    v_mfma_f32_16x16x32_bf16 v[156:159], a[108:111], a[68:71], v[156:159]
    v_perm_b32 v62, v65, v35, s39
    s_cbranch_vccnz L_slow3_0
L_back3_0:
    v_mfma_f32_16x16x32_bf16 v[156:159], a[104:107], a[64:67], v[156:159]
    ds_read_b32 a200, v59
    v_perm_b32 v63, v69, v35, s36
    v_mfma_f32_16x16x32_bf16 v[160:163], a[136:139], a[112:115], v[160:163]
    ds_read_b32 a201, v60
    v_perm_b32 v6, v69, v35, s37
    v_mfma_f32_16x16x32_bf16 v[160:163], a[140:143], a[116:119], v[160:163]
    ds_read_b32 a202, v5
    v_perm_b32 v7, v69, v35, s38
    v_mfma_f32_16x16x32_bf16 v[164:167], a[140:143], a[132:135], v[164:167]
    ds_read_b32 a203, v62
    v_perm_b32 v27, v69, v35, s39
    v_mfma_f32_16x16x32_bf16 v[164:167], a[136:139], a[128:131], v[164:167]
    ds_read_b32 a204, v63
    ds_read_b32 a205, v6
    v_mfma_f32_16x16x32_bf16 v[168:171], a[136:139], a[144:147], v[168:171]
    buffer_load_dwordx4 v[84:87], v32, s[12:15], s43 offen sc1
    v_mfma_f32_16x16x32_bf16 v[168:171], a[140:143], a[148:151], v[168:171]
    ds_read_b32 a206, v7
    v_perm_b32 v29, v66, v35, s36
    v_mfma_f32_16x16x32_bf16 v[172:175], a[140:143], a[156:159], v[172:175]
    ds_read_b32 a207, v27
    v_perm_b32 v31, v66, v35, s37
    v_mfma_f32_16x16x32_bf16 v[172:175], a[136:139], a[152:155], v[172:175]
    ds_read_b32 a208, v29
    ds_read_b32 a209, v31
    v_mfma_f32_16x16x32_bf16 v[176:179], a[136:139], a[160:163], v[176:179]
    buffer_load_dwordx4 v[96:99], v33, s[12:15], s43 offen sc1
    v_mfma_f32_16x16x32_bf16 v[176:179], a[140:143], a[164:167], v[176:179]
    v_perm_b32 v46, v66, v35, s38
    v_perm_b32 v57, v66, v35, s39
    v_mfma_f32_16x16x32_bf16 v[180:183], a[140:143], a[172:175], v[180:183]
    v_perm_b32 v56, v70, v35, s36
    v_perm_b32 v61, v70, v35, s37
    v_mfma_f32_16x16x32_bf16 v[180:183], a[136:139], a[168:171], v[180:183]
    ds_read_b32 a210, v46
    ds_read_b32 a211, v57
    v_mfma_f32_16x16x32_bf16 v[184:187], a[136:139], a[184:187], v[184:187]
    buffer_load_dwordx4 v37, s[8:11], s56 offen offset:1024  lds
    v_mfma_f32_16x16x32_bf16 v[184:187], a[140:143], a[188:191], v[184:187]
    ds_read_b32 a212, v56
    v_perm_b32 v58, v70, v35, s38
    v_mfma_f32_16x16x32_bf16 v[188:191], a[140:143], a[68:71], v[188:191]
    ds_read_b32 a213, v61
    v_perm_b32 v59, v70, v35, s39
    v_mfma_f32_16x16x32_bf16 v[188:191], a[136:139], a[64:67], v[188:191]
    s_waitcnt vmcnt(14)
    ds_read_b32 a214, v58
    v_perm_b32 v60, v67, v35, s36
    v_mfma_f32_16x16x32_bf16 v[192:195], a[88:91], a[112:115], v[192:195]
    s_barrier
    v_mfma_f32_16x16x32_bf16 v[192:195], a[92:95], a[116:119], v[192:195]
    buffer_load_dwordx4 v38, s[8:11], s56 offen offset:2048  lds
    v_mfma_f32_16x16x32_bf16 v[196:199], a[92:95], a[132:135], v[196:199]
    ds_read_b32 a215, v59
    v_perm_b32 v5, v67, v35, s37
    v_mfma_f32_16x16x32_bf16 v[196:199], a[88:91], a[128:131], v[196:199]
    ds_read_b32 a220, v60
    v_perm_b32 v62, v71, v35, s36
    v_mfma_f32_16x16x32_bf16 v[200:203], a[88:91], a[144:147], v[200:203]
    ds_read_b32 a221, v5
    v_perm_b32 v63, v71, v35, s37
    v_mfma_f32_16x16x32_bf16 v[200:203], a[92:95], a[148:151], v[200:203]
    ds_read_b32 a222, v62
    v_perm_b32 v6, v72, v35, s36
    v_mfma_f32_16x16x32_bf16 v[204:207], a[92:95], a[156:159], v[204:207]
    ds_read_b128 a[224:227], v40 offset:16384
    v_perm_b32 v7, v72, v35, s37
    v_mfma_f32_16x16x32_bf16 v[204:207], a[88:91], a[152:155], v[204:207]
    ds_read_b32 a223, v63
    v_perm_b32 v27, v72, v35, s38
    v_mfma_f32_16x16x32_bf16 v[208:211], a[88:91], a[160:163], v[208:211]
    ds_read_b128 a[228:231], v41 offset:16384
    ds_read_b32 a232, v6
    v_mfma_f32_16x16x32_bf16 v[208:211], a[92:95], a[164:167], v[208:211]
    buffer_load_dwordx4 v39, s[8:11], s56 offen offset:3072  lds
    v_mfma_f32_16x16x32_bf16 v[212:215], a[92:95], a[172:175], v[212:215]
    s_add_u32 m0, s57, 81920
    ds_read_b128 a[240:243], v40 offset:18432
    ds_read_b32 a233, v7
    v_mfma_f32_16x16x32_bf16 v[212:215], a[88:91], a[168:171], v[212:215]
    ds_read_b32 a234, v27
    v_perm_b32 v29, v72, v35, s39
    v_mfma_f32_16x16x32_bf16 v[216:219], a[88:91], a[184:187], v[216:219]
    ds_read_b128 a[244:247], v41 offset:18432
    v_perm_b32 v31, v76, v35, s36
    v_mfma_f32_16x16x32_bf16 v[216:219], a[92:95], a[188:191], v[216:219]
    ds_read_b32 a235, v29
    v_perm_b32 v46, v76, v35, s37
    v_mfma_f32_16x16x32_bf16 v[220:223], a[92:95], a[68:71], v[220:223]
    ds_read_b128 a[248:251], v40 offset:20480
    v_perm_b32 v57, v76, v35, s38
    v_mfma_f32_16x16x32_bf16 v[220:223], a[88:91], a[64:67], v[220:223]
    ds_read_b32 a236, v31
    ds_read_b32 a237, v46
    v_mfma_f32_16x16x32_bf16 v[224:227], a[216:219], a[114:117], v[224:227]
    buffer_load_dwordx4 v36, s[8:11], s3 offen offset:0  lds
    v_mfma_f32_16x16x32_bf16 v[228:231], a[216:219], a[130:133], v[228:231]
    ds_read_b128 a[252:255], v41 offset:20480
    v_perm_b32 v56, v76, v35, s39
    v_mfma_f32_16x16x32_bf16 v[232:235], a[216:219], a[146:149], v[232:235]
    ds_read_b128 a[36:39], v41 offset:22528
    ds_read_b32 a238, v57
    v_mfma_f32_16x16x32_bf16 v[236:239], a[216:219], a[154:157], v[236:239]
    ds_read_b128 a[32:35], v40 offset:22528
    v_perm_b32 v61, v73, v35, s36
    v_mfma_f32_16x16x32_bf16 v[240:243], a[216:219], a[162:165], v[240:243]
    ds_read_b128 a[0:3], v40 offset:24576
    v_perm_b32 v58, v73, v35, s37
    v_mfma_f32_16x16x32_bf16 v[244:247], a[216:219], a[170:173], v[244:247]
    ds_read_b128 a[4:7], v41 offset:24576
    ds_read_b32 a239, v56
    v_mfma_f32_16x16x32_bf16 v[248:251], a[216:219], a[186:189], v[248:251]
    s_waitcnt lgkmcnt(10)
    ds_read_b32 a8, v61
    ds_read_b32 a9, v58
    v_mfma_f32_16x16x32_bf16 v[252:255], a[216:219], a[66:69], v[252:255]
    buffer_load_dwordx4 v37, s[8:11], s3 offen offset:1024  lds
    v_mfma_f32_16x16x32_bf16 v[128:131], a[192:195], a[224:227], v[128:131]
    ds_read_b128 a[52:55], v41 offset:26624
    v_perm_b32 v59, v73, v35, s38
    v_mfma_f32_16x16x32_bf16 v[128:131], a[196:199], a[228:231], v[128:131]
    ds_read_b128 a[48:51], v40 offset:26624
    v_perm_b32 v60, v73, v35, s39
    v_mfma_f32_16x16x32_bf16 v[132:135], a[196:199], a[244:247], v[132:135]
    s_add_u32 s56, s55, 1280
    ds_read_b128 a[16:19], v40 offset:28672
    v_perm_b32 v5, v77, v35, s36
    v_mfma_f32_16x16x32_bf16 v[132:135], a[192:195], a[240:243], v[132:135]
    s_waitcnt lgkmcnt(9)
    ds_read_b128 a[20:23], v41 offset:28672
    v_perm_b32 v62, v77, v35, s37
    v_mfma_f32_16x16x32_bf16 v[136:139], a[192:195], a[248:251], v[136:139]
    ds_read_b32 a10, v59
    v_perm_b32 v63, v77, v35, s38
    v_mfma_f32_16x16x32_bf16 v[136:139], a[196:199], a[252:255], v[136:139]
    ds_read_b128 a[24:27], v40 offset:30720
    v_perm_b32 v6, v77, v35, s39
    v_mfma_f32_16x16x32_bf16 v[140:143], a[196:199], a[36:39], v[140:143]
    s_waitcnt lgkmcnt(8)
    ds_read_b32 a11, v60
    ds_read_b32 a12, v5
    v_mfma_f32_16x16x32_bf16 v[140:143], a[192:195], a[32:35], v[140:143]
    buffer_load_dwordx4 v38, s[8:11], s3 offen offset:2048  lds
    v_mfma_f32_16x16x32_bf16 v[144:147], a[192:195], a[0:3], v[144:147]
    ds_read_b128 a[28:31], v41 offset:30720
    v_perm_b32 v7, v74, v35, s36
    v_mfma_f32_16x16x32_bf16 v[144:147], a[196:199], a[4:7], v[144:147]
    s_waitcnt lgkmcnt(8)
    ds_read_b32 a13, v62
    ds_read_b32 a14, v63
    v_mfma_f32_16x16x32_bf16 v[148:151], a[196:199], a[52:55], v[148:151]
    s_waitcnt lgkmcnt(9)
    ds_read_b32 a15, v6
    v_perm_b32 v27, v74, v35, s37
    v_mfma_f32_16x16x32_bf16 v[148:151], a[192:195], a[48:51], v[148:151]
    s_waitcnt lgkmcnt(9)
    v_perm_b32 v29, v74, v35, s38
    v_perm_b32 v31, v74, v35, s39
    v_mfma_f32_16x16x32_bf16 v[152:155], a[192:195], a[16:19], v[152:155]
    s_waitcnt lgkmcnt(8)
    ds_read_b32 a40, v7
    v_perm_b32 v46, v78, v35, s36
    v_mfma_f32_16x16x32_bf16 v[152:155], a[196:199], a[20:23], v[152:155]
    s_waitcnt vmcnt(11) lgkmcnt(4)
    ds_read_b32 a41, v27
    ds_read_b32 a42, v29
    v_mfma_f32_16x16x32_bf16 v[156:159], a[196:199], a[28:31], v[156:159]
    buffer_load_dwordx4 v39, s[8:11], s3 offen offset:3072  lds
    v_mfma_f32_16x16x32_bf16 v[156:159], a[192:195], a[24:27], v[156:159]
    s_add_u32 m0, s57, 0
    ds_read_b32 a43, v31
    v_perm_b32 v57, v78, v35, s37
    v_mfma_f32_16x16x32_bf16 v[160:163], a[200:203], a[224:227], v[160:163]
    s_barrier
    v_mfma_f32_16x16x32_bf16 v[160:163], a[204:207], a[228:231], v[160:163]
    ds_read_b32 a44, v46
    v_perm_b32 v56, v78, v35, s38
    v_mfma_f32_16x16x32_bf16 v[164:167], a[204:207], a[244:247], v[164:167]
    s_add_u32 s3, s69, 1280
    ds_read_b32 a45, v57
    ds_read_b32 a46, v56
    v_mfma_f32_16x16x32_bf16 v[164:167], a[200:203], a[240:243], v[164:167]
    buffer_load_dwordx4 v[104:107], v34, s[12:15], s43 offen sc1
    v_mfma_f32_16x16x32_bf16 v[168:171], a[200:203], a[248:251], v[168:171]
    ds_read_b128 a[56:59], v40 offset:32768
    v_perm_b32 v61, v78, v35, s39
    v_mfma_f32_16x16x32_bf16 v[168:171], a[204:207], a[252:255], v[168:171]
    ds_read_b128 a[60:63], v41 offset:32768
    v_perm_b32 v58, v75, v35, s36
    v_mfma_f32_16x16x32_bf16 v[172:175], a[204:207], a[36:39], v[172:175]
    ds_read_b128 a[72:75], v40 offset:34816
    v_perm_b32 v59, v75, v35, s37
    v_mfma_f32_16x16x32_bf16 v[172:175], a[200:203], a[32:35], v[172:175]
    ds_read_b128 a[76:79], v41 offset:34816
    ds_read_b32 a47, v61
    v_mfma_f32_16x16x32_bf16 v[176:179], a[200:203], a[0:3], v[176:179]
    buffer_load_dwordx4 v[108:111], v44, s[12:15], s43 offen sc1
    v_mfma_f32_16x16x32_bf16 v[176:179], a[204:207], a[4:7], v[176:179]
    s_waitcnt vmcnt(12)
    v_bitop3_b32 v60, v103, v83, s76 bitop3:0x7e
    v_perm_b32 v5, v79, v35, s36
    v_mfma_f32_16x16x32_bf16 v[180:183], a[204:207], a[52:55], v[180:183]
    ds_read_b128 a[96:99], v40 offset:36864
    v_cmp_lt_u32 vcc, 0xffff, v60
    v_mfma_f32_16x16x32_bf16 v[180:183], a[200:203], a[48:51], v[180:183]
    ds_read_b32 a120, v58
    ds_read_b32 a121, v59
    v_mfma_f32_16x16x32_bf16 v[184:187], a[200:203], a[16:19], v[184:187]
    buffer_load_dwordx4 v[112:115], v32, s[12:15], s44 offen sc1
    v_mfma_f32_16x16x32_bf16 v[184:187], a[204:207], a[20:23], v[184:187]
    ds_read_b128 a[100:103], v41 offset:36864
    s_cbranch_vccnz L_slow3_1
L_back3_1:
    v_mfma_f32_16x16x32_bf16 v[188:191], a[204:207], a[28:31], v[188:191]
    v_perm_b32 v62, v79, v35, s37
    v_perm_b32 v63, v103, v35, s36
    v_mfma_f32_16x16x32_bf16 v[188:191], a[200:203], a[24:27], v[188:191]
    v_perm_b32 v6, v103, v35, s37
    v_perm_b32 v7, v83, v35, s36
    v_mfma_f32_16x16x32_bf16 v[192:195], a[208:211], a[224:227], v[192:195]
    ds_read_b128 a[80:83], v40 offset:38912
    ds_read_b32 a122, v5
    v_mfma_f32_16x16x32_bf16 v[192:195], a[212:215], a[228:231], v[192:195]
    buffer_load_dwordx4 v[116:119], v33, s[12:15], s44 offen sc1
    v_mfma_f32_16x16x32_bf16 v[196:199], a[212:215], a[244:247], v[196:199]
    v_perm_b32 v27, v83, v35, s37
    v_perm_b32 v29, v100, v35, s36
    v_mfma_f32_16x16x32_bf16 v[196:199], a[208:211], a[240:243], v[196:199]
    ds_read_b128 a[84:87], v41 offset:38912
    v_perm_b32 v31, v100, v35, s37
    v_mfma_f32_16x16x32_bf16 v[200:203], a[208:211], a[248:251], v[200:203]
    ds_read_b32 a123, v62
    ds_read_b32 a124, v63
    v_mfma_f32_16x16x32_bf16 v[200:203], a[212:215], a[252:255], v[200:203]
    ds_read_b32 a125, v6
    v_perm_b32 v46, v100, v35, s38
    v_mfma_f32_16x16x32_bf16 v[204:207], a[212:215], a[36:39], v[204:207]
    ds_read_b128 a[176:179], v40 offset:40960
    ds_read_b32 a126, v7
    v_mfma_f32_16x16x32_bf16 v[204:207], a[208:211], a[32:35], v[204:207]
    v_perm_b32 v57, v100, v35, s39
    v_perm_b32 v56, v80, v35, s36
    v_mfma_f32_16x16x32_bf16 v[208:211], a[208:211], a[0:3], v[208:211]
    ds_read_b32 a127, v27
    ds_read_b32 a104, v29
    v_mfma_f32_16x16x32_bf16 v[208:211], a[212:215], a[4:7], v[208:211]
    buffer_load_dwordx4 v36, s[8:11], s56 offen offset:0  lds
    v_mfma_f32_16x16x32_bf16 v[212:215], a[212:215], a[52:55], v[212:215]
    ds_read_b128 a[180:183], v41 offset:40960
    v_perm_b32 v61, v80, v35, s37
    v_mfma_f32_16x16x32_bf16 v[212:215], a[208:211], a[48:51], v[212:215]
    ds_read_b32 a105, v31
    v_perm_b32 v60, v80, v35, s38
    v_mfma_f32_16x16x32_bf16 v[216:219], a[208:211], a[16:19], v[216:219]
    s_waitcnt vmcnt(12)
    ds_read_b128 a[136:139], v40 offset:43008
    v_bitop3_b32 v58, v87, v99, s76 bitop3:0x7e
    v_mfma_f32_16x16x32_bf16 v[216:219], a[212:215], a[20:23], v[216:219]
    ds_read_b32 a106, v46
    v_cmp_lt_u32 vcc, 0xffff, v58
    v_mfma_f32_16x16x32_bf16 v[220:223], a[212:215], a[28:31], v[220:223]
    ds_read_b32 a107, v57
    v_perm_b32 v59, v80, v35, s39
    v_mfma_f32_16x16x32_bf16 v[220:223], a[208:211], a[24:27], v[220:223]
    ds_read_b128 a[140:143], v41 offset:43008
    s_cbranch_vccnz L_slow4_0
L_back4_0:
    v_mfma_f32_16x16x32_bf16 v[224:227], a[220:223], a[226:229], v[224:227]
    buffer_load_dwordx4 v37, s[8:11], s56 offen offset:1024  lds
    v_mfma_f32_16x16x32_bf16 v[228:231], a[220:223], a[242:245], v[228:231]
    ds_read_b32 a108, v56
    v_perm_b32 v5, v101, v35, s36
    v_mfma_f32_16x16x32_bf16 v[232:235], a[220:223], a[250:253], v[232:235]
    ds_read_b128 a[88:91], v40 offset:45056
    v_perm_b32 v62, v101, v35, s37
    v_mfma_f32_16x16x32_bf16 v[236:239], a[220:223], a[34:37], v[236:239]
    ds_read_b32 a109, v61
    v_perm_b32 v63, v101, v35, s38
L_pad2:
    s_cbranch_execz L_pad3
    v_mfma_f32_16x16x32_bf16 v[240:243], a[220:223], a[2:5], v[240:243]
    ds_read_b32 a110, v60
    v_perm_b32 v6, v101, v35, s39
    v_mfma_f32_16x16x32_bf16 v[244:247], a[220:223], a[50:53], v[244:247]
    ds_read_b128 a[92:95], v41 offset:45056
    v_perm_b32 v7, v81, v35, s36
    v_mfma_f32_16x16x32_bf16 v[248:251], a[220:223], a[18:21], v[248:251]
    s_waitcnt lgkmcnt(7)
    ds_read_b32 a111, v59
    ds_read_b32 a112, v5
    v_mfma_f32_16x16x32_bf16 v[252:255], a[220:223], a[26:29], v[252:255]
    buffer_load_dwordx4 v38, s[8:11], s56 offen offset:2048  lds
    v_mfma_f32_16x16x32_bf16 v[128:131], a[232:235], a[56:59], v[128:131]
    ds_read_b128 a[128:131], v40 offset:47104
    v_perm_b32 v27, v81, v35, s37
    v_mfma_f32_16x16x32_bf16 v[128:131], a[236:239], a[60:63], v[128:131]
    ds_read_b32 a113, v62
    v_perm_b32 v29, v81, v35, s38
    v_mfma_f32_16x16x32_bf16 v[132:135], a[236:239], a[76:79], v[132:135]
    ds_read_b128 a[132:135], v41 offset:47104
    v_perm_b32 v31, v81, v35, s39
    v_mfma_f32_16x16x32_bf16 v[132:135], a[232:235], a[72:75], v[132:135]
    ds_read_b32 a114, v63
    v_perm_b32 v46, v102, v35, s36
    v_mfma_f32_16x16x32_bf16 v[136:139], a[232:235], a[96:99], v[136:139]
    ds_read_b32 a115, v6
    ds_read_b32 a116, v7
    v_mfma_f32_16x16x32_bf16 v[136:139], a[236:239], a[100:103], v[136:139]
    v_perm_b32 v58, v102, v35, s37
    v_perm_b32 v57, v102, v35, s38
    v_mfma_f32_16x16x32_bf16 v[140:143], a[236:239], a[84:87], v[140:143]
    ds_read_b32 a117, v27
    v_perm_b32 v56, v102, v35, s39
    v_mfma_f32_16x16x32_bf16 v[140:143], a[232:235], a[80:83], v[140:143]
    ds_read_b32 a118, v29
    v_perm_b32 v61, v82, v35, s36
    v_mfma_f32_16x16x32_bf16 v[144:147], a[232:235], a[176:179], v[144:147]
    s_waitcnt lgkmcnt(8)
    ds_read_b32 a119, v31
    ds_read_b32 a144, v46
    v_mfma_f32_16x16x32_bf16 v[144:147], a[236:239], a[180:183], v[144:147]
    buffer_load_dwordx4 v[120:123], v34, s[12:15], s44 offen sc1
    v_mfma_f32_16x16x32_bf16 v[148:151], a[236:239], a[140:143], v[148:151]
    v_perm_b32 v60, v82, v35, s37
    v_perm_b32 v59, v82, v35, s38
    v_mfma_f32_16x16x32_bf16 v[148:151], a[232:235], a[136:139], v[148:151]
    ds_read_b32 a145, v58
    ds_read_b32 a146, v57
    v_mfma_f32_16x16x32_bf16 v[152:155], a[232:235], a[88:91], v[152:155]
    s_waitcnt lgkmcnt(8)
    ds_read_b128 a[152:155], v40 offset:49152
    ds_read_b32 a147, v56
    v_mfma_f32_16x16x32_bf16 v[152:155], a[236:239], a[92:95], v[152:155]
    buffer_load_dwordx4 v[124:127], v44, s[12:15], s44 offen sc1
    v_mfma_f32_16x16x32_bf16 v[156:159], a[236:239], a[132:135], v[156:159]
    ds_read_b128 a[156:159], v41 offset:49152
    v_perm_b32 v5, v82, v35, s39
    v_mfma_f32_16x16x32_bf16 v[156:159], a[232:235], a[128:131], v[156:159]
    ds_read_b128 a[160:163], v40 offset:51200
    ds_read_b32 a148, v61
    v_mfma_f32_16x16x32_bf16 v[160:163], a[8:11], a[56:59], v[160:163]
    ds_read_b128 a[164:167], v41 offset:51200
    ds_read_b32 a149, v60
    v_mfma_f32_16x16x32_bf16 v[160:163], a[12:15], a[60:63], v[160:163]
    buffer_load_dwordx4 v39, s[8:11], s56 offen offset:3072  lds
    v_mfma_f32_16x16x32_bf16 v[164:167], a[12:15], a[76:79], v[164:167]
    s_add_u32 m0, s57, 16384
    ds_read_b128 a[168:171], v40 offset:53248
    v_perm_b32 v62, v84, v35, s36
    v_mfma_f32_16x16x32_bf16 v[164:167], a[8:11], a[72:75], v[164:167]
    ds_read_b32 a150, v59
    v_perm_b32 v63, v84, v35, s37
    v_mfma_f32_16x16x32_bf16 v[168:171], a[8:11], a[96:99], v[168:171]
    v_perm_b32 v6, v84, v35, s38
    v_perm_b32 v7, v84, v35, s39
    v_mfma_f32_16x16x32_bf16 v[168:171], a[12:15], a[100:103], v[168:171]
    ds_read_b128 a[172:175], v41 offset:53248
    ds_read_b32 a151, v5
    v_mfma_f32_16x16x32_bf16 v[172:175], a[12:15], a[84:87], v[172:175]
    v_perm_b32 v27, v96, v35, s36
    v_perm_b32 v29, v96, v35, s37
    v_mfma_f32_16x16x32_bf16 v[172:175], a[8:11], a[80:83], v[172:175]
    ds_read_b32 a184, v62
    ds_read_b32 a185, v63
    v_mfma_f32_16x16x32_bf16 v[176:179], a[8:11], a[176:179], v[176:179]
    buffer_load_dwordx4 v36, s[8:11], s3 offen offset:0  lds
    v_mfma_f32_16x16x32_bf16 v[176:179], a[12:15], a[180:183], v[176:179]
    ds_read_b128 a[64:67], v40 offset:55296
    v_perm_b32 v31, v96, v35, s38
    v_mfma_f32_16x16x32_bf16 v[180:183], a[12:15], a[140:143], v[180:183]
    ds_read_b32 a186, v6
    v_perm_b32 v46, v96, v35, s39
    v_mfma_f32_16x16x32_bf16 v[180:183], a[8:11], a[136:139], v[180:183]
    ds_read_b128 a[68:71], v41 offset:55296
    ds_read_b32 a187, v7
    v_mfma_f32_16x16x32_bf16 v[184:187], a[8:11], a[88:91], v[184:187]
    v_perm_b32 v58, v85, v35, s36
    v_perm_b32 v57, v85, v35, s37
    v_mfma_f32_16x16x32_bf16 v[184:187], a[12:15], a[92:95], v[184:187]
    ds_read_b32 a188, v27
    ds_read_b32 a189, v29
    v_mfma_f32_16x16x32_bf16 v[188:191], a[12:15], a[132:135], v[188:191]
    ds_read_b128 a[192:195], v40 offset:57344
    ds_read_b32 a190, v31
    v_mfma_f32_16x16x32_bf16 v[188:191], a[8:11], a[128:131], v[188:191]
    buffer_load_dwordx4 v37, s[8:11], s3 offen offset:1024  lds
    v_mfma_f32_16x16x32_bf16 v[192:195], a[40:43], a[56:59], v[192:195]
    v_perm_b32 v56, v85, v35, s38
    v_perm_b32 v61, v85, v35, s39
    v_mfma_f32_16x16x32_bf16 v[192:195], a[44:47], a[60:63], v[192:195]
    ds_read_b128 a[196:199], v41 offset:57344
    ds_read_b32 a191, v46
    v_mfma_f32_16x16x32_bf16 v[196:199], a[44:47], a[76:79], v[196:199]
    ds_read_b32 a200, v58
    v_perm_b32 v60, v97, v35, s36
    v_mfma_f32_16x16x32_bf16 v[196:199], a[40:43], a[72:75], v[196:199]
    ds_read_b32 a201, v57
    v_perm_b32 v59, v97, v35, s37
    v_mfma_f32_16x16x32_bf16 v[200:203], a[40:43], a[96:99], v[200:203]
    ds_read_b128 a[208:211], v40 offset:59392
    v_perm_b32 v5, v97, v35, s38
    v_mfma_f32_16x16x32_bf16 v[200:203], a[44:47], a[100:103], v[200:203]
    ds_read_b32 a202, v56
    ds_read_b32 a203, v61
    v_mfma_f32_16x16x32_bf16 v[204:207], a[44:47], a[84:87], v[204:207]
    buffer_load_dwordx4 v38, s[8:11], s3 offen offset:2048  lds
    v_mfma_f32_16x16x32_bf16 v[204:207], a[40:43], a[80:83], v[204:207]
    ds_read_b128 a[212:215], v41 offset:59392
    v_perm_b32 v62, v97, v35, s39
    v_mfma_f32_16x16x32_bf16 v[208:211], a[40:43], a[176:179], v[208:211]
    ds_read_b32 a204, v60
    v_perm_b32 v63, v86, v35, s36
    v_mfma_f32_16x16x32_bf16 v[208:211], a[44:47], a[180:183], v[208:211]
    ds_read_b32 a205, v59
    v_perm_b32 v6, v86, v35, s37
    v_mfma_f32_16x16x32_bf16 v[212:215], a[44:47], a[140:143], v[212:215]
    ds_read_b128 a[224:227], v40 offset:61440
    v_perm_b32 v7, v86, v35, s38
    v_mfma_f32_16x16x32_bf16 v[212:215], a[40:43], a[136:139], v[212:215]
    ds_read_b32 a206, v5
    v_perm_b32 v27, v86, v35, s39
    v_mfma_f32_16x16x32_bf16 v[216:219], a[40:43], a[88:91], v[216:219]
    ds_read_b32 a207, v62
    v_perm_b32 v29, v98, v35, s36
    v_mfma_f32_16x16x32_bf16 v[216:219], a[44:47], a[92:95], v[216:219]
    ds_read_b128 a[228:231], v41 offset:61440
    ds_read_b32 a240, v63
    v_mfma_f32_16x16x32_bf16 v[220:223], a[44:47], a[132:135], v[220:223]
    buffer_load_dwordx4 v39, s[8:11], s3 offen offset:3072  lds
    v_mfma_f32_16x16x32_bf16 v[220:223], a[40:43], a[128:131], v[220:223]
    s_waitcnt vmcnt(12)
    v_bitop3_b32 v31, v107, v111, s76 bitop3:0x7e
    v_perm_b32 v46, v98, v35, s37
    v_mfma_f32_16x16x32_bf16 v[224:227], a[120:123], a[58:61], v[224:227]
    s_waitcnt lgkmcnt(7)
    ds_read_b128 a[248:251], v40 offset:63488
    v_cmp_lt_u32 vcc, 0xffff, v31
    v_mfma_f32_16x16x32_bf16 v[224:227], a[124:127], a[154:157], v[224:227]
    ds_read_b32 a241, v6
    v_perm_b32 v58, v98, v35, s38
    v_mfma_f32_16x16x32_bf16 v[228:231], a[124:127], a[162:165], v[228:231]
    ds_read_b128 a[252:255], v41 offset:63488
    s_cbranch_vccnz L_slow4_1
L_back4_1:
    v_mfma_f32_16x16x32_bf16 v[228:231], a[120:123], a[74:77], v[228:231]
    ds_read_b32 a242, v7
    ds_read_b32 a243, v27
    v_mfma_f32_16x16x32_bf16 v[232:235], a[120:123], a[98:101], v[232:235]
    buffer_load_dwordx4 v[88:91], v32, s[12:15], s45 offen sc1
    v_mfma_f32_16x16x32_bf16 v[232:235], a[124:127], a[170:173], v[232:235]
    ds_read_b32 a244, v29
    v_perm_b32 v57, v98, v35, s39
    v_mfma_f32_16x16x32_bf16 v[236:239], a[124:127], a[66:69], v[236:239]
    v_perm_b32 v56, v87, v35, s36
    v_perm_b32 v61, v87, v35, s37
    v_mfma_f32_16x16x32_bf16 v[236:239], a[120:123], a[82:85], v[236:239]
    ds_read_b32 a245, v46
    ds_read_b32 a246, v58
    v_mfma_f32_16x16x32_bf16 v[240:243], a[120:123], a[178:181], v[240:243]
    buffer_load_dwordx4 v[92:95], v33, s[12:15], s45 offen sc1
    v_mfma_f32_16x16x32_bf16 v[240:243], a[124:127], a[194:197], v[240:243]
    v_perm_b32 v60, v99, v35, s36
    v_perm_b32 v59, v99, v35, s37
    v_mfma_f32_16x16x32_bf16 v[244:247], a[124:127], a[210:213], v[244:247]
    v_perm_b32 v5, v107, v35, s36
    v_perm_b32 v62, v107, v35, s37
    v_mfma_f32_16x16x32_bf16 v[244:247], a[120:123], a[138:141], v[244:247]
    s_waitcnt lgkmcnt(5)
    ds_read_b32 a247, v57
    ds_read_b32 a32, v56
    v_mfma_f32_16x16x32_bf16 v[248:251], a[120:123], a[90:93], v[248:251]
    buffer_load_dwordx4 v[48:51], v34, s[12:15], s45 offen sc1
    v_mfma_f32_16x16x32_bf16 v[248:251], a[124:127], a[226:229], v[248:251]
    s_barrier
    v_mfma_f32_16x16x32_bf16 v[252:255], a[124:127], a[250:253], v[252:255]
    s_add_u32 s56, s55, 1536
    ds_read_b32 a33, v61
    v_perm_b32 v63, v111, v35, s36
    v_mfma_f32_16x16x32_bf16 v[252:255], a[120:123], a[130:133], v[252:255]
    ds_read_b32 a34, v60
    v_perm_b32 v31, v111, v35, s37
    v_mfma_f32_16x16x32_bf16 v[128:131], a[104:107], a[152:155], v[128:131]
    ds_read_b32 a35, v59
    ds_read_b32 a36, v5
    v_mfma_f32_16x16x32_bf16 v[128:131], a[108:111], a[156:159], v[128:131]
    buffer_load_dwordx4 v[52:55], v44, s[12:15], s45 offen sc1
    v_mfma_f32_16x16x32_bf16 v[132:135], a[108:111], a[164:167], v[132:135]
    s_add_u32 m0, s57, 32768
    ds_read_b32 a37, v62
    v_perm_b32 v6, v104, v35, s36
    v_mfma_f32_16x16x32_bf16 v[132:135], a[104:107], a[160:163], v[132:135]
    v_perm_b32 v7, v104, v35, s37
    v_perm_b32 v27, v104, v35, s38
    v_mfma_f32_16x16x32_bf16 v[136:139], a[104:107], a[168:171], v[136:139]
    ds_read_b32 a38, v63
    v_perm_b32 v29, v104, v35, s39
    v_mfma_f32_16x16x32_bf16 v[136:139], a[108:111], a[172:175], v[136:139]
    ds_read_b32 a39, v31
    v_perm_b32 v46, v108, v35, s36
    v_mfma_f32_16x16x32_bf16 v[140:143], a[108:111], a[68:71], v[140:143]
    ds_read_b32 a0, v6
    v_perm_b32 v58, v108, v35, s37
    v_mfma_f32_16x16x32_bf16 v[140:143], a[104:107], a[64:67], v[140:143]
    ds_read_b32 a1, v7
    ds_read_b32 a2, v27
    v_mfma_f32_16x16x32_bf16 v[144:147], a[104:107], a[192:195], v[144:147]
    buffer_load_dwordx4 v36, s[8:11], s56 offen offset:0  lds
    v_mfma_f32_16x16x32_bf16 v[144:147], a[108:111], a[196:199], v[144:147]
    s_waitcnt vmcnt(15)
    v_perm_b32 v56, v108, v35, s38
    v_bitop3_b32 v57, v115, v119, s76 bitop3:0x7e
    v_mfma_f32_16x16x32_bf16 v[148:151], a[108:111], a[212:215], v[148:151]
    ds_read_b32 a3, v29
    v_cmp_lt_u32 vcc, 0xffff, v57
    v_mfma_f32_16x16x32_bf16 v[148:151], a[104:107], a[208:211], v[148:151]
    ds_read_b128 a[48:51], v42 offset:0
    v_perm_b32 v61, v108, v35, s39
    v_mfma_f32_16x16x32_bf16 v[152:155], a[104:107], a[224:227], v[152:155]
    ds_read_b128 a[52:55], v43 offset:0
    s_cbranch_vccnz L_slow5_0
L_back5_0:
    v_mfma_f32_16x16x32_bf16 v[152:155], a[108:111], a[228:231], v[152:155]
    ds_read_b32 a4, v46
    v_perm_b32 v60, v105, v35, s36
    v_mfma_f32_16x16x32_bf16 v[156:159], a[108:111], a[252:255], v[156:159]
    s_add_u32 s3, s69, 1536
    ds_read_b128 a[16:19], v42 offset:2048
    ds_read_b32 a5, v58
    v_mfma_f32_16x16x32_bf16 v[156:159], a[104:107], a[248:251], v[156:159]
    ds_read_b128 a[20:23], v43 offset:2048
    ds_read_b32 a6, v56
    v_mfma_f32_16x16x32_bf16 v[160:163], a[112:115], a[152:155], v[160:163]
    buffer_load_dwordx4 v37, s[8:11], s56 offen offset:1024  lds
    v_mfma_f32_16x16x32_bf16 v[160:163], a[116:119], a[156:159], v[160:163]
    v_perm_b32 v59, v105, v35, s37
    v_perm_b32 v5, v105, v35, s38
    v_mfma_f32_16x16x32_bf16 v[164:167], a[116:119], a[164:167], v[164:167]
    ds_read_b128 a[216:219], v42 offset:4096
    v_perm_b32 v62, v105, v35, s39
    v_mfma_f32_16x16x32_bf16 v[164:167], a[112:115], a[160:163], v[164:167]
    ds_read_b32 a7, v61
    v_perm_b32 v63, v109, v35, s36
    v_mfma_f32_16x16x32_bf16 v[168:171], a[112:115], a[168:171], v[168:171]
    ds_read_b32 a24, v60
    v_perm_b32 v31, v109, v35, s37
    v_mfma_f32_16x16x32_bf16 v[168:171], a[116:119], a[172:175], v[168:171]
    ds_read_b128 a[220:223], v43 offset:4096
    v_perm_b32 v6, v109, v35, s38
    v_mfma_f32_16x16x32_bf16 v[172:175], a[116:119], a[68:71], v[172:175]
    ds_read_b32 a25, v59
    ds_read_b32 a26, v5
    v_mfma_f32_16x16x32_bf16 v[172:175], a[112:115], a[64:67], v[172:175]
    buffer_load_dwordx4 v38, s[8:11], s56 offen offset:2048  lds
    v_mfma_f32_16x16x32_bf16 v[176:179], a[112:115], a[192:195], v[176:179]
    ds_read_b128 a[232:235], v42 offset:6144
    v_perm_b32 v7, v109, v35, s39
    v_mfma_f32_16x16x32_bf16 v[176:179], a[116:119], a[196:199], v[176:179]
    ds_read_b32 a27, v62
    v_perm_b32 v27, v106, v35, s36
    v_mfma_f32_16x16x32_bf16 v[180:183], a[116:119], a[212:215], v[180:183]
    ds_read_b32 a28, v63
    v_perm_b32 v29, v106, v35, s37
    v_mfma_f32_16x16x32_bf16 v[180:183], a[112:115], a[208:211], v[180:183]
    ds_read_b128 a[236:239], v43 offset:6144
    ds_read_b32 a29, v31
    v_mfma_f32_16x16x32_bf16 v[184:187], a[112:115], a[224:227], v[184:187]
    ds_read_b32 a30, v6
    v_perm_b32 v57, v106, v35, s38
    v_mfma_f32_16x16x32_bf16 v[184:187], a[116:119], a[228:231], v[184:187]
    ds_read_b32 a31, v7
    ds_read_b32 a8, v27
    v_mfma_f32_16x16x32_bf16 v[188:191], a[116:119], a[252:255], v[188:191]
    buffer_load_dwordx4 v39, s[8:11], s56 offen offset:3072  lds
    v_mfma_f32_16x16x32_bf16 v[188:191], a[112:115], a[248:251], v[188:191]
    s_add_u32 m0, s57, 49152
    ds_read_b128 a[40:43], v42 offset:8192
    v_perm_b32 v46, v106, v35, s39
    v_mfma_f32_16x16x32_bf16 v[192:195], a[144:147], a[152:155], v[192:195]
    s_add_u32 s56, s55, 1792
    v_perm_b32 v58, v110, v35, s36
    v_perm_b32 v56, v110, v35, s37
    v_mfma_f32_16x16x32_bf16 v[192:195], a[148:151], a[156:159], v[192:195]
    ds_read_b128 a[44:47], v43 offset:8192
    ds_read_b32 a9, v29
    v_mfma_f32_16x16x32_bf16 v[196:199], a[148:151], a[164:167], v[196:199]
    ds_read_b32 a10, v57
    v_perm_b32 v61, v110, v35, s38
    v_mfma_f32_16x16x32_bf16 v[196:199], a[144:147], a[160:163], v[196:199]
    v_perm_b32 v60, v110, v35, s39
    v_perm_b32 v59, v112, v35, s36
    v_mfma_f32_16x16x32_bf16 v[200:203], a[144:147], a[168:171], v[200:203]
    ds_read_b128 a[56:59], v42 offset:10240
    ds_read_b32 a11, v46
    v_mfma_f32_16x16x32_bf16 v[200:203], a[148:151], a[172:175], v[200:203]
    ds_read_b32 a12, v58
    ds_read_b32 a13, v56
    v_mfma_f32_16x16x32_bf16 v[204:207], a[148:151], a[68:71], v[204:207]
    buffer_load_dwordx4 v36, s[8:11], s3 offen offset:0  lds
    v_mfma_f32_16x16x32_bf16 v[204:207], a[144:147], a[64:67], v[204:207]
    ds_read_b128 a[60:63], v43 offset:10240
    v_perm_b32 v5, v112, v35, s37
    v_mfma_f32_16x16x32_bf16 v[208:211], a[144:147], a[192:195], v[208:211]
    ds_read_b32 a14, v61
    v_perm_b32 v62, v112, v35, s38
    v_mfma_f32_16x16x32_bf16 v[208:211], a[148:151], a[196:199], v[208:211]
    ds_read_b32 a15, v60
    v_perm_b32 v63, v112, v35, s39
    v_mfma_f32_16x16x32_bf16 v[212:215], a[148:151], a[212:215], v[212:215]
    ds_read_b128 a[72:75], v42 offset:12288
    ds_read_b32 a96, v59
    v_mfma_f32_16x16x32_bf16 v[212:215], a[144:147], a[208:211], v[212:215]
    v_perm_b32 v31, v116, v35, s36
    v_perm_b32 v6, v116, v35, s37
    v_mfma_f32_16x16x32_bf16 v[216:219], a[144:147], a[224:227], v[216:219]
    ds_read_b32 a97, v5
    ds_read_b32 a98, v62
    v_mfma_f32_16x16x32_bf16 v[216:219], a[148:151], a[228:231], v[216:219]
    buffer_load_dwordx4 v37, s[8:11], s3 offen offset:1024  lds
    v_mfma_f32_16x16x32_bf16 v[220:223], a[148:151], a[252:255], v[220:223]
    ds_read_b128 a[76:79], v43 offset:12288
    v_perm_b32 v7, v116, v35, s38
    v_mfma_f32_16x16x32_bf16 v[220:223], a[144:147], a[248:251], v[220:223]
    s_waitcnt lgkmcnt(8)
    ds_read_b32 a99, v63
    v_perm_b32 v27, v116, v35, s39
    v_mfma_f32_16x16x32_bf16 v[128:131], a[184:187], a[48:51], v[128:131]
    ds_read_b128 a[80:83], v42 offset:14336
    v_perm_b32 v29, v113, v35, s36
    v_mfma_f32_16x16x32_bf16 v[128:131], a[188:191], a[52:55], v[128:131]
    ds_read_b32 a100, v31
    ds_read_b32 a101, v6
    v_mfma_f32_16x16x32_bf16 v[132:135], a[188:191], a[20:23], v[132:135]
    ds_read_b128 a[84:87], v43 offset:14336
    v_perm_b32 v57, v113, v35, s37
    v_mfma_f32_16x16x32_bf16 v[132:135], a[184:187], a[16:19], v[132:135]
    ds_read_b32 a102, v7
    ds_read_b32 a103, v27
    v_mfma_f32_16x16x32_bf16 v[136:139], a[184:187], a[216:219], v[136:139]
    buffer_load_dwordx4 v38, s[8:11], s3 offen offset:2048  lds
    v_mfma_f32_16x16x32_bf16 v[136:139], a[188:191], a[220:223], v[136:139]
    s_waitcnt vmcnt(16)
    v_perm_b32 v58, v113, v35, s38
    v_bitop3_b32 v46, v123, v127, s76 bitop3:0x7e
    v_mfma_f32_16x16x32_bf16 v[140:143], a[188:191], a[236:239], v[140:143]
    v_cmp_lt_u32 vcc, 0xffff, v46
    v_perm_b32 v56, v113, v35, s39
    v_mfma_f32_16x16x32_bf16 v[140:143], a[184:187], a[232:235], v[140:143]
    ds_read_b32 a176, v29
    v_perm_b32 v61, v117, v35, s36
    v_mfma_f32_16x16x32_bf16 v[144:147], a[184:187], a[40:43], v[144:147]
    ds_read_b32 a177, v57
    s_cbranch_vccnz L_slow5_1
L_back5_1:
    v_mfma_f32_16x16x32_bf16 v[144:147], a[188:191], a[44:47], v[144:147]
    s_waitcnt lgkmcnt(7)
    v_perm_b32 v60, v117, v35, s37
    v_perm_b32 v59, v117, v35, s38
    v_mfma_f32_16x16x32_bf16 v[148:151], a[188:191], a[60:63], v[148:151]
    ds_read_b32 a178, v58
    v_perm_b32 v5, v117, v35, s39
    v_mfma_f32_16x16x32_bf16 v[148:151], a[184:187], a[56:59], v[148:151]
    s_waitcnt lgkmcnt(5)
    ds_read_b32 a179, v56
    ds_read_b128 a[136:139], v42 offset:16384
    v_mfma_f32_16x16x32_bf16 v[152:155], a[184:187], a[72:75], v[152:155]
    buffer_load_dwordx4 v39, s[8:11], s3 offen offset:3072  lds
    v_mfma_f32_16x16x32_bf16 v[152:155], a[188:191], a[76:79], v[152:155]
    s_add_u32 m0, s57, 65536
    ds_read_b128 a[140:143], v43 offset:16384
    v_perm_b32 v62, v114, v35, s36
    v_mfma_f32_16x16x32_bf16 v[156:159], a[188:191], a[84:87], v[156:159]
    s_add_u32 s3, s69, 1792
    ds_read_b128 a[88:91], v42 offset:18432
    ds_read_b32 a180, v61
    v_mfma_f32_16x16x32_bf16 v[156:159], a[184:187], a[80:83], v[156:159]
    ds_read_b128 a[92:95], v43 offset:18432
    v_perm_b32 v63, v114, v35, s37
    v_mfma_f32_16x16x32_bf16 v[160:163], a[200:203], a[48:51], v[160:163]
    ds_read_b32 a181, v60
    ds_read_b32 a182, v59
    v_mfma_f32_16x16x32_bf16 v[160:163], a[204:207], a[52:55], v[160:163]
    ds_read_b32 a183, v5
    v_perm_b32 v31, v114, v35, s38
    v_mfma_f32_16x16x32_bf16 v[164:167], a[204:207], a[20:23], v[164:167]
    ds_read_b128 a[120:123], v42 offset:20480
    v_perm_b32 v6, v114, v35, s39
    v_mfma_f32_16x16x32_bf16 v[164:167], a[200:203], a[16:19], v[164:167]
    ds_read_b32 a128, v62
    v_perm_b32 v7, v118, v35, s36
    v_mfma_f32_16x16x32_bf16 v[168:171], a[200:203], a[216:219], v[168:171]
    ds_read_b32 a129, v63
    v_perm_b32 v27, v118, v35, s37
    v_mfma_f32_16x16x32_bf16 v[168:171], a[204:207], a[220:223], v[168:171]
    ds_read_b128 a[124:127], v43 offset:20480
    ds_read_b32 a130, v31
    v_mfma_f32_16x16x32_bf16 v[172:175], a[204:207], a[236:239], v[172:175]
    buffer_load_dwordx4 v[64:67], v22, s[32:35], 0 offen
    v_mfma_f32_16x16x32_bf16 v[172:175], a[200:203], a[232:235], v[172:175]
    v_perm_b32 v46, v118, v35, s38
    v_perm_b32 v29, v118, v35, s39
    v_mfma_f32_16x16x32_bf16 v[176:179], a[200:203], a[40:43], v[176:179]
    ds_read_b128 a[104:107], v42 offset:22528
    ds_read_b32 a131, v6
    v_mfma_f32_16x16x32_bf16 v[176:179], a[204:207], a[44:47], v[176:179]
    ds_read_b32 a132, v7
    ds_read_b32 a133, v27
    v_mfma_f32_16x16x32_bf16 v[180:183], a[204:207], a[60:63], v[180:183]
    buffer_load_dwordx4 v[68:71], v32, s[12:15], s72 offen sc1
    v_mfma_f32_16x16x32_bf16 v[180:183], a[200:203], a[56:59], v[180:183]
    ds_read_b128 a[108:111], v43 offset:22528
    v_perm_b32 v57, v115, v35, s36
    v_mfma_f32_16x16x32_bf16 v[184:187], a[200:203], a[72:75], v[184:187]
    v_perm_b32 v58, v115, v35, s37
    v_perm_b32 v56, v119, v35, s36
    v_mfma_f32_16x16x32_bf16 v[184:187], a[204:207], a[76:79], v[184:187]
    ds_read_b32 a134, v46
    ds_read_b32 a135, v29
    v_mfma_f32_16x16x32_bf16 v[188:191], a[204:207], a[84:87], v[188:191]
    buffer_load_dwordx4 v[72:75], v33, s[12:15], s72 offen sc1
    v_mfma_f32_16x16x32_bf16 v[188:191], a[200:203], a[80:83], v[188:191]
    ds_read_b128 a[112:115], v42 offset:24576
    v_perm_b32 v61, v119, v35, s37
    v_mfma_f32_16x16x32_bf16 v[192:195], a[240:243], a[48:51], v[192:195]
    v_perm_b32 v60, v123, v35, s36
    v_perm_b32 v59, v123, v35, s37
    v_mfma_f32_16x16x32_bf16 v[192:195], a[244:247], a[52:55], v[192:195]
    ds_read_b128 a[116:119], v43 offset:24576
    ds_read_b32 a152, v57
    v_mfma_f32_16x16x32_bf16 v[196:199], a[244:247], a[20:23], v[196:199]
    buffer_load_dwordx4 v[76:79], v34, s[12:15], s72 offen sc1
    v_mfma_f32_16x16x32_bf16 v[196:199], a[240:243], a[16:19], v[196:199]
    ds_read_b32 a153, v58
    ds_read_b32 a154, v56
    v_mfma_f32_16x16x32_bf16 v[200:203], a[240:243], a[216:219], v[200:203]
    ds_read_b128 a[160:163], v42 offset:26624
    v_perm_b32 v5, v127, v35, s36
    v_mfma_f32_16x16x32_bf16 v[200:203], a[244:247], a[220:223], v[200:203]
    ds_read_b32 a155, v61
    ds_read_b32 a156, v60
    v_mfma_f32_16x16x32_bf16 v[204:207], a[244:247], a[236:239], v[204:207]
    buffer_load_dwordx4 v[100:103], v44, s[12:15], s72 offen sc1
    v_mfma_f32_16x16x32_bf16 v[204:207], a[240:243], a[232:235], v[204:207]
    ds_read_b128 a[164:167], v43 offset:26624
    v_perm_b32 v62, v127, v35, s37
    v_mfma_f32_16x16x32_bf16 v[208:211], a[240:243], a[40:43], v[208:211]
    ds_read_b32 a157, v59
    v_perm_b32 v63, v120, v35, s36
    v_mfma_f32_16x16x32_bf16 v[208:211], a[244:247], a[44:47], v[208:211]
    ds_read_b32 a158, v5
    ds_read_b32 a159, v62
    v_mfma_f32_16x16x32_bf16 v[212:215], a[244:247], a[60:63], v[212:215]
    buffer_load_dwordx2 v[80:81], v22, s[32:35], 0 offen offset:16
    v_mfma_f32_16x16x32_bf16 v[212:215], a[240:243], a[56:59], v[212:215]
    ds_read_b128 a[168:171], v42 offset:28672
    v_perm_b32 v31, v120, v35, s37
    v_mfma_f32_16x16x32_bf16 v[216:219], a[240:243], a[72:75], v[216:219]
    v_perm_b32 v6, v120, v35, s38
    v_perm_b32 v7, v120, v35, s39
    v_mfma_f32_16x16x32_bf16 v[216:219], a[244:247], a[76:79], v[216:219]
    ds_read_b128 a[172:175], v43 offset:28672
    ds_read_b32 a64, v63
    v_mfma_f32_16x16x32_bf16 v[220:223], a[244:247], a[84:87], v[220:223]
    buffer_load_dword v82, v23, s[32:35], 0 offen
    v_mfma_f32_16x16x32_bf16 v[220:223], a[240:243], a[80:83], v[220:223]
    v_perm_b32 v27, v124, v35, s36
    v_perm_b32 v46, v124, v35, s37
    v_mfma_f32_16x16x32_bf16 v[224:227], a[32:35], a[50:53], v[224:227]
    s_waitcnt lgkmcnt(6)
    ds_read_b128 a[192:195], v42 offset:30720
    v_perm_b32 v29, v124, v35, s38
    v_mfma_f32_16x16x32_bf16 v[224:227], a[36:39], a[138:141], v[224:227]
    s_waitcnt vmcnt(17)
    v_bitop3_b32 v57, v91, v95, s76 bitop3:0x7e
    v_perm_b32 v58, v124, v35, s39
    v_mfma_f32_16x16x32_bf16 v[228:231], a[36:39], a[90:93], v[228:231]
    ds_read_b128 a[196:199], v43 offset:30720
    v_cmp_lt_u32 vcc, 0xffff, v57
    v_mfma_f32_16x16x32_bf16 v[228:231], a[32:35], a[18:21], v[228:231]
    ds_read_b32 a65, v31
    v_perm_b32 v56, v121, v35, s36
    v_mfma_f32_16x16x32_bf16 v[232:235], a[32:35], a[218:221], v[232:235]
    ds_read_b32 a66, v6
    s_cbranch_vccnz L_slow6_0
L_back6_0:
    v_mfma_f32_16x16x32_bf16 v[232:235], a[36:39], a[122:125], v[232:235]
    ds_read_b32 a67, v7
    v_perm_b32 v61, v121, v35, s37
    v_mfma_f32_16x16x32_bf16 v[236:239], a[36:39], a[106:109], v[236:239]
    s_waitcnt vmcnt(15)
    v_perm_b32 v59, v121, v35, s38
    v_bitop3_b32 v60, v51, v55, s76 bitop3:0x7e
    v_mfma_f32_16x16x32_bf16 v[236:239], a[32:35], a[234:237], v[236:239]
    ds_read_b32 a68, v27
    v_cmp_lt_u32 vcc, 0xffff, v60
    v_mfma_f32_16x16x32_bf16 v[240:243], a[32:35], a[42:45], v[240:243]
    ds_read_b32 a69, v46
    ds_read_b32 a70, v29
    v_mfma_f32_16x16x32_bf16 v[240:243], a[36:39], a[114:117], v[240:243]
    v_perm_b32 v5, v121, v35, s39
    s_cbranch_vccnz L_slow6_1
L_back6_1:
    v_mfma_f32_16x16x32_bf16 v[244:247], a[36:39], a[162:165], v[244:247]
    ds_read_b32 a71, v58
    v_perm_b32 v62, v125, v35, s36
    v_mfma_f32_16x16x32_bf16 v[244:247], a[32:35], a[58:61], v[244:247]
    s_waitcnt lgkmcnt(7)
    ds_read_b32 a208, v56
    v_perm_b32 v63, v125, v35, s37
    v_mfma_f32_16x16x32_bf16 v[248:251], a[32:35], a[74:77], v[248:251]
    s_barrier
L_pad3:
    s_cbranch_execz L_pad4
    v_mfma_f32_16x16x32_bf16 v[248:251], a[36:39], a[170:173], v[248:251]
    buffer_load_dwordx4 v36, s[8:11], s56 offen offset:0  lds
    v_mfma_f32_16x16x32_bf16 v[252:255], a[36:39], a[194:197], v[252:255]
    ds_read_b32 a209, v61
    v_perm_b32 v57, v125, v35, s38
    v_mfma_f32_16x16x32_bf16 v[252:255], a[32:35], a[82:85], v[252:255]
    ds_read_b32 a210, v59
    v_perm_b32 v31, v125, v35, s39
    v_mfma_f32_16x16x32_bf16 v[128:131], a[0:3], a[136:139], v[128:131]
    ds_read_b32 a211, v5
    ds_read_b32 a212, v62
    v_mfma_f32_16x16x32_bf16 v[128:131], a[4:7], a[140:143], v[128:131]
    buffer_load_dwordx4 v37, s[8:11], s56 offen offset:1024  lds
    v_mfma_f32_16x16x32_bf16 v[132:135], a[4:7], a[92:95], v[132:135]
    v_perm_b32 v6, v122, v35, s36
    v_perm_b32 v7, v122, v35, s37
    v_mfma_f32_16x16x32_bf16 v[132:135], a[0:3], a[88:91], v[132:135]
    ds_read_b32 a213, v63
    v_perm_b32 v27, v122, v35, s38
    v_mfma_f32_16x16x32_bf16 v[136:139], a[0:3], a[120:123], v[136:139]
    ds_read_b32 a214, v57
    ds_read_b32 a215, v31
    v_mfma_f32_16x16x32_bf16 v[136:139], a[4:7], a[124:127], v[136:139]
    buffer_load_dwordx4 v38, s[8:11], s56 offen offset:2048  lds
    v_mfma_f32_16x16x32_bf16 v[140:143], a[4:7], a[108:111], v[140:143]
    v_perm_b32 v60, v122, v35, s39
    v_perm_b32 v46, v126, v35, s36
    v_mfma_f32_16x16x32_bf16 v[140:143], a[0:3], a[104:107], v[140:143]
    v_perm_b32 v29, v126, v35, s37
    v_perm_b32 v58, v126, v35, s38
    v_mfma_f32_16x16x32_bf16 v[144:147], a[0:3], a[112:115], v[144:147]
    ds_read_b32 a224, v6
    ds_read_b32 a225, v7
    v_mfma_f32_16x16x32_bf16 v[144:147], a[4:7], a[116:119], v[144:147]
    buffer_load_dwordx4 v39, s[8:11], s56 offen offset:3072  lds
    v_mfma_f32_16x16x32_bf16 v[148:151], a[4:7], a[164:167], v[148:151]
    s_add_u32 m0, s57, 81920
    ds_read_b32 a226, v27
    v_perm_b32 v56, v126, v35, s39
    v_mfma_f32_16x16x32_bf16 v[148:151], a[0:3], a[160:163], v[148:151]
    ds_read_b128 a[144:147], v40 offset:0
    v_perm_b32 v61, v91, v35, s36
    v_mfma_f32_16x16x32_bf16 v[152:155], a[0:3], a[168:171], v[152:155]
    ds_read_b128 a[148:151], v41 offset:0
    ds_read_b32 a227, v60
    v_mfma_f32_16x16x32_bf16 v[152:155], a[4:7], a[172:175], v[152:155]
    buffer_load_dwordx4 v36, s[8:11], s3 offen offset:0  lds
    v_mfma_f32_16x16x32_bf16 v[156:159], a[4:7], a[196:199], v[156:159]
    ds_read_b128 a[248:251], v40 offset:2048
    v_perm_b32 v59, v91, v35, s37
    v_mfma_f32_16x16x32_bf16 v[156:159], a[0:3], a[192:195], v[156:159]
    ds_read_b128 a[252:255], v41 offset:2048
    ds_read_b32 a228, v46
    v_mfma_f32_16x16x32_bf16 v[160:163], a[24:27], a[136:139], v[160:163]
    ds_read_b32 a229, v29
    ds_read_b32 a230, v58
    v_mfma_f32_16x16x32_bf16 v[160:163], a[28:31], a[140:143], v[160:163]
    buffer_load_dwordx4 v37, s[8:11], s3 offen offset:1024  lds
    v_mfma_f32_16x16x32_bf16 v[164:167], a[28:31], a[92:95], v[164:167]
    ds_read_b128 a[184:187], v40 offset:4096
    v_perm_b32 v5, v95, v35, s36
    v_mfma_f32_16x16x32_bf16 v[164:167], a[24:27], a[88:91], v[164:167]
    ds_read_b32 a231, v56
    v_perm_b32 v62, v95, v35, s37
    v_mfma_f32_16x16x32_bf16 v[168:171], a[24:27], a[120:123], v[168:171]
    ds_read_b32 a200, v61
    ds_read_b32 a201, v59
    v_mfma_f32_16x16x32_bf16 v[168:171], a[28:31], a[124:127], v[168:171]
    buffer_load_dwordx4 v38, s[8:11], s3 offen offset:2048  lds
    v_mfma_f32_16x16x32_bf16 v[172:175], a[28:31], a[108:111], v[172:175]
    ds_read_b128 a[188:191], v41 offset:4096
    v_perm_b32 v63, v51, v35, s36
    v_mfma_f32_16x16x32_bf16 v[172:175], a[24:27], a[104:107], v[172:175]
    v_perm_b32 v57, v51, v35, s37
    v_perm_b32 v31, v55, v35, s36
    v_mfma_f32_16x16x32_bf16 v[176:179], a[24:27], a[112:115], v[176:179]
    ds_read_b128 a[240:243], v40 offset:6144
    v_perm_b32 v6, v55, v35, s37
    v_mfma_f32_16x16x32_bf16 v[176:179], a[28:31], a[116:119], v[176:179]
    ds_read_b32 a202, v5
    ds_read_b32 a203, v62
    v_mfma_f32_16x16x32_bf16 v[180:183], a[28:31], a[164:167], v[180:183]
    buffer_load_dwordx4 v39, s[8:11], s3 offen offset:3072  lds
    v_mfma_f32_16x16x32_bf16 v[180:183], a[24:27], a[160:163], v[180:183]
    ds_read_b128 a[244:247], v41 offset:6144
    v_perm_b32 v7, v88, v35, s36
    v_mfma_f32_16x16x32_bf16 v[184:187], a[24:27], a[168:171], v[184:187]
    v_perm_b32 v27, v88, v35, s37
    v_perm_b32 v60, v88, v35, s38
    v_mfma_f32_16x16x32_bf16 v[184:187], a[28:31], a[172:175], v[184:187]
    ds_read_b32 a204, v63
    v_perm_b32 v46, v88, v35, s39
    v_mfma_f32_16x16x32_bf16 v[188:191], a[28:31], a[196:199], v[188:191]
    ds_read_b128 a[48:51], v40 offset:8192
    v_perm_b32 v29, v92, v35, s36
    v_mfma_f32_16x16x32_bf16 v[188:191], a[24:27], a[192:195], v[188:191]
    ds_read_b32 a205, v57
    ds_read_b32 a206, v31
    v_mfma_f32_16x16x32_bf16 v[192:195], a[8:11], a[136:139], v[192:195]
    ds_read_b32 a207, v6
    v_perm_b32 v58, v92, v35, s37
    v_mfma_f32_16x16x32_bf16 v[192:195], a[12:15], a[140:143], v[192:195]
    ds_read_b128 a[52:55], v41 offset:8192
    v_perm_b32 v56, v92, v35, s38
    v_mfma_f32_16x16x32_bf16 v[196:199], a[12:15], a[92:95], v[196:199]
    ds_read_b32 a16, v7
    v_perm_b32 v61, v92, v35, s39
    v_mfma_f32_16x16x32_bf16 v[196:199], a[8:11], a[88:91], v[196:199]
    ds_read_b32 a17, v27
    ds_read_b32 a18, v60
    v_mfma_f32_16x16x32_bf16 v[200:203], a[8:11], a[120:123], v[200:203]
    ds_read_b128 a[216:219], v40 offset:10240
    v_perm_b32 v59, v48, v35, s36
    v_mfma_f32_16x16x32_bf16 v[200:203], a[12:15], a[124:127], v[200:203]
    ds_read_b32 a19, v46
    ds_read_b32 a20, v29
    v_mfma_f32_16x16x32_bf16 v[204:207], a[12:15], a[108:111], v[204:207]
    v_perm_b32 v5, v48, v35, s37
    v_perm_b32 v62, v48, v35, s38
    v_mfma_f32_16x16x32_bf16 v[204:207], a[8:11], a[104:107], v[204:207]
    ds_read_b128 a[220:223], v41 offset:10240
    ds_read_b32 a21, v58
    v_mfma_f32_16x16x32_bf16 v[208:211], a[8:11], a[112:115], v[208:211]
    ds_read_b32 a22, v56
    v_perm_b32 v63, v48, v35, s39
    v_mfma_f32_16x16x32_bf16 v[208:211], a[12:15], a[116:119], v[208:211]
    ds_read_b32 a23, v61
    v_perm_b32 v57, v52, v35, s36
    v_mfma_f32_16x16x32_bf16 v[212:215], a[12:15], a[164:167], v[212:215]
    ds_read_b128 a[232:235], v40 offset:12288
    ds_read_b32 a40, v59
    v_mfma_f32_16x16x32_bf16 v[212:215], a[8:11], a[160:163], v[212:215]
    ds_read_b32 a41, v5
    v_perm_b32 v31, v52, v35, s37
    v_mfma_f32_16x16x32_bf16 v[216:219], a[8:11], a[168:171], v[216:219]
    ds_read_b32 a42, v62
    v_perm_b32 v6, v52, v35, s38
    v_mfma_f32_16x16x32_bf16 v[216:219], a[12:15], a[172:175], v[216:219]
    ds_read_b128 a[236:239], v41 offset:12288
    v_perm_b32 v7, v52, v35, s39
    v_mfma_f32_16x16x32_bf16 v[220:223], a[12:15], a[196:199], v[220:223]
    ds_read_b32 a43, v63
    ds_read_b32 a44, v57
    v_mfma_f32_16x16x32_bf16 v[220:223], a[8:11], a[192:195], v[220:223]
    s_waitcnt lgkmcnt(11)
    v_perm_b32 v27, v89, v35, s36
    v_perm_b32 v60, v89, v35, s37
    v_mfma_f32_16x16x32_bf16 v[128:131], a[96:99], a[144:147], v[128:131]
    ds_read_b32 a45, v31
    ds_read_b32 a46, v6
    v_mfma_f32_16x16x32_bf16 v[128:131], a[100:103], a[148:151], v[128:131]
    ds_read_b32 a47, v7
    v_perm_b32 v46, v89, v35, s38
    v_mfma_f32_16x16x32_bf16 v[132:135], a[100:103], a[252:255], v[132:135]
    ds_read_b32 a56, v27
    v_perm_b32 v29, v89, v35, s39
    v_mfma_f32_16x16x32_bf16 v[132:135], a[96:99], a[248:251], v[132:135]
    ds_read_b32 a57, v60
    v_perm_b32 v58, v93, v35, s36
    v_mfma_f32_16x16x32_bf16 v[136:139], a[96:99], a[184:187], v[136:139]
    ds_read_b32 a58, v46
    v_perm_b32 v56, v93, v35, s37
    v_mfma_f32_16x16x32_bf16 v[136:139], a[100:103], a[188:191], v[136:139]
    ds_read_b32 a59, v29
    v_perm_b32 v61, v93, v35, s38
    v_mfma_f32_16x16x32_bf16 v[140:143], a[100:103], a[244:247], v[140:143]
    ds_read_b128 a[72:75], v40 offset:16384
    v_perm_b32 v59, v93, v35, s39
    v_mfma_f32_16x16x32_bf16 v[140:143], a[96:99], a[240:243], v[140:143]
    ds_read_b32 a60, v58
    v_perm_b32 v5, v49, v35, s36
    v_mfma_f32_16x16x32_bf16 v[144:147], a[96:99], a[48:51], v[144:147]
    ds_read_b32 a61, v56
    v_perm_b32 v62, v49, v35, s37
    v_mfma_f32_16x16x32_bf16 v[144:147], a[100:103], a[52:55], v[144:147]
    s_waitcnt lgkmcnt(8)
    ds_read_b128 a[76:79], v41 offset:16384
    ds_read_b32 a62, v61
    v_mfma_f32_16x16x32_bf16 v[148:151], a[100:103], a[220:223], v[148:151]
    ds_read_b32 a63, v59
    v_perm_b32 v63, v49, v35, s38
    v_mfma_f32_16x16x32_bf16 v[148:151], a[96:99], a[216:219], v[148:151]
    ds_read_b32 a32, v5
    v_perm_b32 v57, v49, v35, s39
    v_mfma_f32_16x16x32_bf16 v[152:155], a[96:99], a[232:235], v[152:155]
    ds_read_b128 a[80:83], v40 offset:18432
    ds_read_b32 a33, v62
    v_mfma_f32_16x16x32_bf16 v[152:155], a[100:103], a[236:239], v[152:155]
    ds_read_b32 a34, v63
    v_perm_b32 v31, v53, v35, s36
    v_mfma_f32_16x16x32_bf16 v[160:163], a[176:179], a[144:147], v[160:163]
    ds_read_b32 a35, v57
    v_perm_b32 v6, v53, v35, s37
    v_mfma_f32_16x16x32_bf16 v[160:163], a[180:183], a[148:151], v[160:163]
    ds_read_b128 a[84:87], v41 offset:18432
    v_perm_b32 v7, v53, v35, s38
    v_mfma_f32_16x16x32_bf16 v[164:167], a[180:183], a[252:255], v[164:167]
    s_waitcnt vmcnt(12)
    ds_read_b32 a36, v31
    v_bitop3_b32 v27, v71, v75, s76 bitop3:0x7e
    v_mfma_f32_16x16x32_bf16 v[164:167], a[176:179], a[248:251], v[164:167]
    ds_read_b32 a37, v6
    v_cmp_lt_u32 vcc, 0xffff, v27
    v_mfma_f32_16x16x32_bf16 v[168:171], a[176:179], a[184:187], v[168:171]
    ds_read_b128 a[0:3], v40 offset:20480
    v_perm_b32 v60, v53, v35, s39
    v_mfma_f32_16x16x32_bf16 v[168:171], a[180:183], a[188:191], v[168:171]
    ds_read_b32 a38, v7
    s_cbranch_vccnz L_slow7_0
L_back7_0:
    v_mfma_f32_16x16x32_bf16 v[172:175], a[180:183], a[244:247], v[172:175]
    ds_read_b32 a39, v60
    v_perm_b32 v46, v90, v35, s36
    v_mfma_f32_16x16x32_bf16 v[172:175], a[176:179], a[240:243], v[172:175]
    ds_read_b128 a[4:7], v41 offset:20480
    v_perm_b32 v29, v90, v35, s37
    v_mfma_f32_16x16x32_bf16 v[176:179], a[176:179], a[48:51], v[176:179]
    ds_read_b32 a24, v46
    v_perm_b32 v58, v90, v35, s38
    v_mfma_f32_16x16x32_bf16 v[176:179], a[180:183], a[52:55], v[176:179]
    s_waitcnt vmcnt(10)
    ds_read_b32 a25, v29
    v_bitop3_b32 v56, v79, v103, s76 bitop3:0x7e
    v_mfma_f32_16x16x32_bf16 v[180:183], a[180:183], a[220:223], v[180:183]
    ds_read_b128 a[136:139], v40 offset:22528
    v_cmp_lt_u32 vcc, 0xffff, v56
    v_mfma_f32_16x16x32_bf16 v[180:183], a[176:179], a[216:219], v[180:183]
    ds_read_b32 a26, v58
    v_perm_b32 v61, v90, v35, s39
    v_mfma_f32_16x16x32_bf16 v[184:187], a[176:179], a[232:235], v[184:187]
    v_perm_b32 v59, v94, v35, s36
    s_cbranch_vccnz L_slow7_1
L_back7_1:
    v_mfma_f32_16x16x32_bf16 v[184:187], a[180:183], a[236:239], v[184:187]
    ds_read_b128 a[140:143], v41 offset:22528
    v_perm_b32 v5, v94, v35, s37
    v_mfma_f32_16x16x32_bf16 v[192:195], a[128:131], a[144:147], v[192:195]
    ds_read_b32 a27, v61
    v_perm_b32 v62, v94, v35, s38
    v_mfma_f32_16x16x32_bf16 v[192:195], a[132:135], a[148:151], v[192:195]
    ds_read_b32 a28, v59
    v_perm_b32 v63, v94, v35, s39
    v_mfma_f32_16x16x32_bf16 v[196:199], a[132:135], a[252:255], v[196:199]
    ds_read_b128 a[88:91], v40 offset:24576
    v_perm_b32 v57, v50, v35, s36
    v_mfma_f32_16x16x32_bf16 v[196:199], a[128:131], a[248:251], v[196:199]
    ds_read_b32 a29, v5
    v_perm_b32 v31, v50, v35, s37
    v_mfma_f32_16x16x32_bf16 v[200:203], a[128:131], a[184:187], v[200:203]
    ds_read_b32 a30, v62
    v_perm_b32 v6, v50, v35, s38
    v_mfma_f32_16x16x32_bf16 v[200:203], a[132:135], a[188:191], v[200:203]
    ds_read_b128 a[92:95], v41 offset:24576
    ds_read_b32 a31, v63
    v_mfma_f32_16x16x32_bf16 v[204:207], a[132:135], a[244:247], v[204:207]
    ds_read_b32 a120, v57
    v_perm_b32 v27, v50, v35, s39
    v_mfma_f32_16x16x32_bf16 v[204:207], a[128:131], a[240:243], v[204:207]
    ds_read_b32 a121, v31
    v_perm_b32 v7, v54, v35, s36
    v_mfma_f32_16x16x32_bf16 v[208:211], a[128:131], a[48:51], v[208:211]
    ds_read_b128 a[104:107], v40 offset:26624
    ds_read_b32 a122, v6
    v_mfma_f32_16x16x32_bf16 v[208:211], a[132:135], a[52:55], v[208:211]
    ds_read_b32 a123, v27
    v_perm_b32 v60, v54, v35, s37
    v_mfma_f32_16x16x32_bf16 v[212:215], a[132:135], a[220:223], v[212:215]
    ds_read_b32 a124, v7
    v_perm_b32 v46, v54, v35, s38
    v_mfma_f32_16x16x32_bf16 v[212:215], a[128:131], a[216:219], v[212:215]
    ds_read_b128 a[108:111], v41 offset:26624
    v_perm_b32 v29, v54, v35, s39
    v_mfma_f32_16x16x32_bf16 v[216:219], a[128:131], a[232:235], v[216:219]
    ds_read_b32 a125, v60
    v_perm_b32 v56, v71, v35, s36
    v_mfma_f32_16x16x32_bf16 v[216:219], a[132:135], a[236:239], v[216:219]
    ds_read_b32 a126, v46
    v_perm_b32 v58, v71, v35, s37
    v_mfma_f32_16x16x32_bf16 v[224:227], a[152:155], a[146:149], v[224:227]
    s_waitcnt lgkmcnt(9)
    ds_read_b128 a[112:115], v40 offset:28672
    v_perm_b32 v61, v75, v35, s36
    v_mfma_f32_16x16x32_bf16 v[224:227], a[156:159], a[74:77], v[224:227]
    ds_read_b128 a[116:119], v41 offset:28672
    ds_read_b32 a127, v29
    v_mfma_f32_16x16x32_bf16 v[228:231], a[156:159], a[82:85], v[228:231]
    ds_read_b32 a160, v56
    v_perm_b32 v59, v75, v35, s37
    v_mfma_f32_16x16x32_bf16 v[228:231], a[152:155], a[250:253], v[228:231]
    ds_read_b32 a161, v58
    v_perm_b32 v5, v79, v35, s36
    v_mfma_f32_16x16x32_bf16 v[232:235], a[152:155], a[186:189], v[232:235]
    ds_read_b32 a162, v61
    v_perm_b32 v62, v79, v35, s37
    v_mfma_f32_16x16x32_bf16 v[232:235], a[156:159], a[2:5], v[232:235]
    ds_read_b32 a163, v59
    v_perm_b32 v63, v103, v35, s36
    v_mfma_f32_16x16x32_bf16 v[236:239], a[156:159], a[138:141], v[236:239]
    ds_read_b32 a164, v5
    v_perm_b32 v57, v103, v35, s37
    v_mfma_f32_16x16x32_bf16 v[236:239], a[152:155], a[242:245], v[236:239]
    ds_read_b32 a165, v62
    v_perm_b32 v31, v68, v35, s36
    v_mfma_f32_16x16x32_bf16 v[240:243], a[152:155], a[50:53], v[240:243]
    ds_read_b32 a166, v63
    v_perm_b32 v6, v68, v35, s37
    v_mfma_f32_16x16x32_bf16 v[240:243], a[156:159], a[90:93], v[240:243]
    s_waitcnt lgkmcnt(9)
    ds_read_b32 a167, v57
    v_perm_b32 v27, v68, v35, s38
    v_mfma_f32_16x16x32_bf16 v[244:247], a[156:159], a[106:109], v[244:247]
    ds_read_b32 a168, v31
    v_perm_b32 v7, v68, v35, s39
    v_mfma_f32_16x16x32_bf16 v[244:247], a[152:155], a[218:221], v[244:247]
    ds_read_b32 a169, v6
    v_perm_b32 v60, v72, v35, s36
    v_mfma_f32_16x16x32_bf16 v[248:251], a[152:155], a[234:237], v[248:251]
    s_waitcnt lgkmcnt(8)
    ds_read_b32 a170, v27
    v_perm_b32 v46, v72, v35, s37
    v_mfma_f32_16x16x32_bf16 v[248:251], a[156:159], a[114:117], v[248:251]
    ds_read_b32 a171, v7
    v_perm_b32 v29, v72, v35, s38
    v_mfma_f32_16x16x32_bf16 v[128:131], a[64:67], a[72:75], v[128:131]
    ds_read_b32 a172, v60
    v_perm_b32 v56, v72, v35, s39
    v_mfma_f32_16x16x32_bf16 v[128:131], a[68:71], a[76:79], v[128:131]
    ds_read_b32 a173, v46
    v_perm_b32 v58, v76, v35, s36
    v_mfma_f32_16x16x32_bf16 v[132:135], a[68:71], a[84:87], v[132:135]
    ds_read_b32 a174, v29
    v_perm_b32 v61, v76, v35, s37
    v_mfma_f32_16x16x32_bf16 v[132:135], a[64:67], a[80:83], v[132:135]
    ds_read_b32 a175, v56
    v_perm_b32 v59, v76, v35, s38
    v_mfma_f32_16x16x32_bf16 v[136:139], a[64:67], a[0:3], v[136:139]
    ds_read_b32 a8, v58
    v_perm_b32 v5, v76, v35, s39
    v_mfma_f32_16x16x32_bf16 v[136:139], a[68:71], a[4:7], v[136:139]
    ds_read_b32 a9, v61
    v_perm_b32 v62, v100, v35, s36
    v_mfma_f32_16x16x32_bf16 v[140:143], a[68:71], a[140:143], v[140:143]
    ds_read_b32 a10, v59
    v_perm_b32 v63, v100, v35, s37
    v_mfma_f32_16x16x32_bf16 v[140:143], a[64:67], a[136:139], v[140:143]
    s_waitcnt vmcnt(0)
    ds_read_b32 a11, v5
    v_perm_b32 v57, v100, v35, s38
    v_mfma_f32_16x16x32_bf16 v[144:147], a[64:67], a[88:91], v[144:147]
    s_barrier
    v_mfma_f32_16x16x32_bf16 v[144:147], a[68:71], a[92:95], v[144:147]
    buffer_atomic_add v45, v1, s[24:27], s77 offen sc0 sc1
    v_mfma_f32_16x16x32_bf16 v[148:151], a[68:71], a[108:111], v[148:151]
    ds_read_b32 a12, v62
    ds_read_b32 a13, v63
    v_mfma_f32_16x16x32_bf16 v[148:151], a[64:67], a[104:107], v[148:151]
    ds_read_b32 a14, v57
    v_perm_b32 v31, v100, v35, s39
    v_mfma_f32_16x16x32_bf16 v[152:155], a[64:67], a[112:115], v[152:155]
    ds_read_b32 a15, v31
    v_perm_b32 v6, v69, v35, s36
    v_mfma_f32_16x16x32_bf16 v[152:155], a[68:71], a[116:119], v[152:155]
    ds_read_b128 a[192:195], v40 offset:32768
    v_perm_b32 v27, v69, v35, s37
    v_mfma_f32_16x16x32_bf16 v[160:163], a[208:211], a[72:75], v[160:163]
    ds_read_b32 a144, v6
    v_perm_b32 v7, v69, v35, s38
    v_mfma_f32_16x16x32_bf16 v[160:163], a[212:215], a[76:79], v[160:163]
    ds_read_b32 a145, v27
    v_perm_b32 v60, v69, v35, s39
    v_mfma_f32_16x16x32_bf16 v[164:167], a[212:215], a[84:87], v[164:167]
    ds_read_b128 a[196:199], v41 offset:32768
    v_perm_b32 v46, v73, v35, s36
    v_mfma_f32_16x16x32_bf16 v[164:167], a[208:211], a[80:83], v[164:167]
    ds_read_b32 a146, v7
    v_perm_b32 v29, v73, v35, s37
    v_mfma_f32_16x16x32_bf16 v[168:171], a[208:211], a[0:3], v[168:171]
    ds_read_b32 a147, v60
    v_perm_b32 v56, v73, v35, s38
    v_mfma_f32_16x16x32_bf16 v[168:171], a[212:215], a[4:7], v[168:171]
    ds_read_b32 a148, v46
    v_perm_b32 v58, v73, v35, s39
    v_mfma_f32_16x16x32_bf16 v[172:175], a[212:215], a[140:143], v[172:175]
    ds_read_b128 a[248:251], v40 offset:49152
    v_perm_b32 v61, v77, v35, s36
    v_mfma_f32_16x16x32_bf16 v[172:175], a[208:211], a[136:139], v[172:175]
    ds_read_b32 a149, v29
    v_perm_b32 v59, v77, v35, s37
    v_mfma_f32_16x16x32_bf16 v[176:179], a[208:211], a[88:91], v[176:179]
    s_mov_b32 m0, s60
    ds_read_b32 a150, v56
    v_perm_b32 v5, v77, v35, s38
    v_mfma_f32_16x16x32_bf16 v[176:179], a[212:215], a[92:95], v[176:179]
    ds_read_b128 a[252:255], v41 offset:49152
    ds_read_b32 a151, v58
    v_mfma_f32_16x16x32_bf16 v[180:183], a[212:215], a[108:111], v[180:183]
    ds_read_b32 a184, v61
    v_perm_b32 v62, v77, v35, s39
    v_mfma_f32_16x16x32_bf16 v[180:183], a[208:211], a[104:107], v[180:183]
    ds_read_b32 a185, v59
    v_perm_b32 v63, v101, v35, s36
    v_mfma_f32_16x16x32_bf16 v[184:187], a[208:211], a[112:115], v[184:187]
    ds_read_b32 a188, v63
    ds_read_b32 a186, v5
    v_mfma_f32_16x16x32_bf16 v[184:187], a[212:215], a[116:119], v[184:187]
    ds_read_b128 a[240:243], v42 offset:0
    v_perm_b32 v57, v101, v35, s37
    v_mfma_f32_16x16x32_bf16 v[192:195], a[224:227], a[72:75], v[192:195]
    ds_read_b32 a189, v57
    ds_read_b32 a187, v62
    v_mfma_f32_16x16x32_bf16 v[192:195], a[228:231], a[76:79], v[192:195]
    ds_read_b128 a[244:247], v43 offset:0
    v_perm_b32 v31, v101, v35, s38
    v_mfma_f32_16x16x32_bf16 v[196:199], a[228:231], a[84:87], v[196:199]
    ds_read_b32 a190, v31
    v_perm_b32 v6, v101, v35, s39
    v_mfma_f32_16x16x32_bf16 v[196:199], a[224:227], a[80:83], v[196:199]
    ds_read_b32 a191, v6
    v_perm_b32 v27, v70, v35, s36
    v_mfma_f32_16x16x32_bf16 v[200:203], a[224:227], a[0:3], v[200:203]
    ds_read_b32 a48, v27
    v_perm_b32 v7, v70, v35, s37
    v_mfma_f32_16x16x32_bf16 v[200:203], a[228:231], a[4:7], v[200:203]
    ds_read_b32 a49, v7
    v_perm_b32 v60, v70, v35, s38
    v_mfma_f32_16x16x32_bf16 v[204:207], a[228:231], a[140:143], v[204:207]
    ds_read_b128 a[216:219], v42 offset:16384
    v_perm_b32 v46, v70, v35, s39
    v_mfma_f32_16x16x32_bf16 v[204:207], a[224:227], a[136:139], v[204:207]
    ds_read_b32 a50, v60
    v_perm_b32 v29, v74, v35, s36
    v_mfma_f32_16x16x32_bf16 v[208:211], a[224:227], a[88:91], v[208:211]
    ds_read_b32 a52, v29
    v_perm_b32 v56, v74, v35, s37
    v_mfma_f32_16x16x32_bf16 v[208:211], a[228:231], a[92:95], v[208:211]
    ds_read_b128 a[220:223], v43 offset:16384
    v_perm_b32 v58, v74, v35, s38
    v_mfma_f32_16x16x32_bf16 v[212:215], a[228:231], a[108:111], v[212:215]
    ds_read_b32 a53, v56
    ds_read_b32 a51, v46
    v_mfma_f32_16x16x32_bf16 v[212:215], a[224:227], a[104:107], v[212:215]
    ds_read_b32 a54, v58
    v_perm_b32 v61, v74, v35, s39
    v_mfma_f32_16x16x32_bf16 v[216:219], a[224:227], a[112:115], v[216:219]
    ds_read_b32 a55, v61
    v_perm_b32 v59, v78, v35, s36
    v_mfma_f32_16x16x32_bf16 v[216:219], a[228:231], a[116:119], v[216:219]
    s_waitcnt lgkmcnt(9)
    ds_read_b128 a[232:235], v40 offset:34816
    v_perm_b32 v5, v78, v35, s37
    v_mfma_f32_16x16x32_bf16 v[224:227], a[200:203], a[194:197], v[224:227]
    s_mov_b32 s66, 0
    ds_read_b32 a72, v59
    v_lshlrev_b32 v84, 16, v82
    v_mfma_f32_16x16x32_bf16 v[224:227], a[204:207], a[250:253], v[224:227]
    s_mov_b32 s67, 14336
    ds_read_b32 a73, v5
    v_perm_b32 v63, v78, v35, s38
    v_mfma_f32_16x16x32_bf16 v[128:131], a[16:19], a[192:195], v[128:131]
    ds_read_b128 a[236:239], v41 offset:34816
    v_perm_b32 v62, v78, v35, s39
    v_mfma_f32_16x16x32_bf16 v[128:131], a[20:23], a[196:199], v[128:131]
    ds_read_b32 a74, v63
    v_and_b32 v85, 0xffff0000, v82
    v_mfma_f32_16x16x32_bf16 v[128:131], a[40:43], a[248:251], v[128:131]
    ds_read_b32 a75, v62
    v_perm_b32 v57, v102, v35, s36
    v_mfma_f32_16x16x32_bf16 v[128:131], a[44:47], a[252:255], v[128:131]
    ds_read_b128 a[80:83], v40 offset:51200
    v_perm_b32 v31, v102, v35, s37
    v_mfma_f32_16x16x32_bf16 v[160:163], a[56:59], a[192:195], v[160:163]
    ds_read_b32 a76, v57
    v_lshlrev_b32 v96, 16, v64
    v_mfma_f32_16x16x32_bf16 v[160:163], a[60:63], a[196:199], v[160:163]
    ds_read_b32 a77, v31
    v_perm_b32 v6, v102, v35, s38
    v_mfma_f32_16x16x32_bf16 v[160:163], a[32:35], a[248:251], v[160:163]
    ds_read_b128 a[84:87], v41 offset:51200
    v_and_b32 v97, 0xffff0000, v65
    v_mfma_f32_16x16x32_bf16 v[160:163], a[36:39], a[252:255], v[160:163]
    ds_read_b32 a78, v6
    v_perm_b32 v27, v102, v35, s39
    v_mfma_f32_16x16x32_bf16 v[192:195], a[24:27], a[192:195], v[192:195]
    ds_read_b128 a[0:3], v42 offset:2048
    v_lshlrev_b32 v98, 16, v67
    v_mfma_f32_16x16x32_bf16 v[192:195], a[28:31], a[196:199], v[192:195]
    ds_read_b32 a79, v27
    v_and_b32 v99, 0xffff0000, v80
    v_mfma_f32_16x16x32_bf16 v[192:195], a[120:123], a[248:251], v[192:195]
    ds_read_b128 a[4:7], v43 offset:2048
    v_and_b32 v104, 0xffff0000, v64
    v_mfma_f32_16x16x32_bf16 v[192:195], a[124:127], a[252:255], v[192:195]
    v_lshlrev_b32 v105, 16, v66
    v_and_b32 v106, 0xffff0000, v67
    v_mfma_f32_16x16x32_bf16 v[224:227], a[160:163], a[242:245], v[224:227]
    s_waitcnt lgkmcnt(7)
    v_lshlrev_b32 v107, 16, v81
    v_lshlrev_b32 v108, 16, v65
    v_mfma_f32_16x16x32_bf16 v[224:227], a[164:167], a[218:221], v[224:227]
    ds_read_b128 a[136:139], v42 offset:18432
    v_and_b32 v109, 0xffff0000, v66
    v_mfma_f32_16x16x32_bf16 v[128:131], a[168:171], a[240:243], v[128:131]
    v_lshlrev_b32 v110, 16, v80
    v_and_b32 v111, 0xffff0000, v81
    v_mfma_f32_16x16x32_bf16 v[128:131], a[172:175], a[244:247], v[128:131]
    v_mfma_f32_16x16x32_bf16 v[128:131], a[8:11], a[216:219], v[128:131]
    ds_read_b128 a[140:143], v43 offset:18432
    v_mfma_f32_16x16x32_bf16 v[128:131], a[12:15], a[220:223], v[128:131]
    ds_write_addtid_b32 v226 offset:28928
    ds_write_addtid_b32 v227 offset:29184
    v_mfma_f32_16x16x32_bf16 v[160:163], a[144:147], a[240:243], v[160:163]
    v_mfma_f32_16x16x32_bf16 v[160:163], a[148:151], a[244:247], v[160:163]
    v_mfma_f32_16x16x32_bf16 v[160:163], a[184:187], a[216:219], v[160:163]
    ds_read_b128 a[88:91], v40 offset:36864
    v_mfma_f32_16x16x32_bf16 v[160:163], a[188:191], a[220:223], v[160:163]
    s_nop 0
    v_mul_f32 v128, v128, v96
    v_mul_f32 v129, v129, v97
    v_mfma_f32_16x16x32_bf16 v[192:195], a[48:51], a[240:243], v[192:195]
    s_waitcnt lgkmcnt(1)
    s_barrier
    v_mfma_f32_16x16x32_bf16 v[192:195], a[52:55], a[244:247], v[192:195]
    ds_read2st64_b32 v[112:113], v30 offset0:113 offset1:114
    v_mul_f32 v130, v130, v98
    v_mfma_f32_16x16x32_bf16 v[192:195], a[72:75], a[216:219], v[192:195]
    ds_read_b128 a[92:95], v41 offset:36864
    v_mul_f32 v131, v131, v99
L_pad4:
    s_cbranch_execz L_warmed
    v_mfma_f32_16x16x32_bf16 v[192:195], a[76:79], a[220:223], v[192:195]
    v_mul_f32 v160, v160, v104
    v_cvt_pk_bf16_f32 v116, v128, v160
    v_mfma_f32_16x16x32_bf16 v[228:231], a[200:203], a[234:237], v[228:231]
    v_mul_f32 v161, v161, v105
    v_mul_f32 v162, v162, v106
    v_mfma_f32_16x16x32_bf16 v[228:231], a[204:207], a[82:85], v[228:231]
    ds_read_b128 a[104:107], v40 offset:53248
    v_cvt_pk_bf16_f32 v119, v130, v162
    v_mfma_f32_16x16x32_bf16 v[228:231], a[160:163], a[2:5], v[228:231]
    v_mul_f32 v163, v163, v107
    v_mfma_f32_16x16x32_bf16 v[228:231], a[164:167], a[138:141], v[228:231]
    v_mul_f32 v192, v192, v108
    v_mul_f32 v193, v193, v109
    v_mfma_f32_16x16x32_bf16 v[132:135], a[16:19], a[232:235], v[132:135]
    ds_read_b128 a[108:111], v41 offset:53248
    v_mul_f32 v194, v194, v110
    v_mfma_f32_16x16x32_bf16 v[132:135], a[20:23], a[236:239], v[132:135]
    v_mul_f32 v195, v195, v111
    v_cvt_pk_bf16_f32 v117, v192, v129
    v_mfma_f32_16x16x32_bf16 v[132:135], a[40:43], a[80:83], v[132:135]
    ds_write_b64 v26, v[116:117] offset:64512
    v_mfma_f32_16x16x32_bf16 v[132:135], a[44:47], a[84:87], v[132:135]
    ds_write_addtid_b32 v230 offset:30976
    v_cvt_pk_bf16_f32 v118, v161, v193
    v_mfma_f32_16x16x32_bf16 v[132:135], a[168:171], a[0:3], v[132:135]
    ds_write_b64 v26, v[118:119] offset:64520
    v_mfma_f32_16x16x32_bf16 v[132:135], a[172:175], a[4:7], v[132:135]
    ds_write_addtid_b32 v231 offset:31232
    v_cvt_pk_bf16_f32 v120, v194, v131
    v_mfma_f32_16x16x32_bf16 v[132:135], a[8:11], a[136:139], v[132:135]
    ds_read_b128 a[112:115], v42 offset:4096
    v_cvt_pk_bf16_f32 v121, v163, v195
    v_mfma_f32_16x16x32_bf16 v[132:135], a[12:15], a[140:143], v[132:135]
    ds_write_b64 v26, v[120:121] offset:64528
    v_mfma_f32_16x16x32_bf16 v[164:167], a[56:59], a[232:235], v[164:167]
    s_waitcnt lgkmcnt(7)
    v_add_f32 v224, v224, v112
    v_mul_f32 v224, v224, v84
    v_mfma_f32_16x16x32_bf16 v[164:167], a[60:63], a[236:239], v[164:167]
    v_add_f32 v225, v225, v113
    v_mul_f32 v225, v225, v85
    v_mfma_f32_16x16x32_bf16 v[164:167], a[32:35], a[80:83], v[164:167]
    ds_read_b128 a[116:119], v43 offset:4096
    v_cvt_pk_bf16_f32 v112, v224, v225
    v_mfma_f32_16x16x32_bf16 v[164:167], a[36:39], a[84:87], v[164:167]
    ds_write_b32 v28, v112 offset:64512
    v_mfma_f32_16x16x32_bf16 v[164:167], a[144:147], a[0:3], v[164:167]
    ds_read_b128 a[192:195], v42 offset:20480
    v_mul_f32 v132, v132, v96
    v_mfma_f32_16x16x32_bf16 v[164:167], a[148:151], a[4:7], v[164:167]
    v_mul_f32 v133, v133, v97
    v_mul_f32 v134, v134, v98
    v_mfma_f32_16x16x32_bf16 v[164:167], a[184:187], a[136:139], v[164:167]
    ds_read_b128 a[196:199], v43 offset:20480
    v_mul_f32 v135, v135, v99
    v_mfma_f32_16x16x32_bf16 v[164:167], a[188:191], a[140:143], v[164:167]
    v_mfma_f32_16x16x32_bf16 v[196:199], a[24:27], a[232:235], v[196:199]
    s_waitcnt lgkmcnt(2)
    s_barrier
    v_mfma_f32_16x16x32_bf16 v[196:199], a[28:31], a[236:239], v[196:199]
    ds_read_b128 v[124:127], v24 offset:64512
    ds_read2st64_b32 v[88:89], v30 offset0:121 offset1:122
    v_mfma_f32_16x16x32_bf16 v[196:199], a[120:123], a[80:83], v[196:199]
    ds_read_b128 v[92:95], v24 offset:65440
    v_mfma_f32_16x16x32_bf16 v[196:199], a[124:127], a[84:87], v[196:199]
    ds_read_b128 a[248:251], v40 offset:38912
    v_mul_f32 v164, v164, v104
    v_mfma_f32_16x16x32_bf16 v[196:199], a[48:51], a[0:3], v[196:199]
    v_cvt_pk_bf16_f32 v48, v132, v164
    v_mul_f32 v165, v165, v105
    v_mfma_f32_16x16x32_bf16 v[196:199], a[52:55], a[4:7], v[196:199]
    ds_read_b128 a[252:255], v41 offset:38912
    v_mul_f32 v166, v166, v106
    v_mfma_f32_16x16x32_bf16 v[196:199], a[72:75], a[136:139], v[196:199]
    v_cvt_pk_bf16_f32 v51, v134, v166
    v_mul_f32 v167, v167, v107
    v_mfma_f32_16x16x32_bf16 v[196:199], a[76:79], a[140:143], v[196:199]
    s_waitcnt lgkmcnt(3)
    v_mfma_f32_16x16x32_bf16 v[232:235], a[200:203], a[90:93], v[232:235]
    buffer_store_dwordx4 v[124:127], v25, s[16:19], s66 offen sc1
    v_mfma_f32_16x16x32_bf16 v[232:235], a[204:207], a[106:109], v[232:235]
    s_mov_b32 s66, 114688
    v_add_f32 v228, v228, v88
    v_mul_f32 v228, v228, v84
    v_mfma_f32_16x16x32_bf16 v[232:235], a[160:163], a[114:117], v[232:235]
    v_add_f32 v229, v229, v89
    v_mul_f32 v229, v229, v85
    v_mfma_f32_16x16x32_bf16 v[232:235], a[164:167], a[194:197], v[232:235]
    s_waitcnt lgkmcnt(2)
    ds_read_b128 a[240:243], v40 offset:55296
    v_mfma_f32_16x16x32_bf16 v[136:139], a[16:19], a[88:91], v[136:139]
    buffer_store_dwordx4 v[92:95], v25, s[16:19], s67 offen sc1
    v_mfma_f32_16x16x32_bf16 v[136:139], a[20:23], a[92:95], v[136:139]
    s_mov_b32 s67, 129024
    ds_read_b128 a[244:247], v41 offset:55296
    v_cvt_pk_bf16_f32 v88, v228, v229
    v_mfma_f32_16x16x32_bf16 v[136:139], a[40:43], a[104:107], v[136:139]
    ds_write_b32 v28, v88 offset:0
    v_mfma_f32_16x16x32_bf16 v[136:139], a[44:47], a[108:111], v[136:139]
    ds_write_addtid_b32 v234 offset:33024
    v_mul_f32 v196, v196, v108
    v_mfma_f32_16x16x32_bf16 v[136:139], a[168:171], a[112:115], v[136:139]
    ds_write_addtid_b32 v235 offset:33280
    v_mul_f32 v197, v197, v109
    v_mfma_f32_16x16x32_bf16 v[136:139], a[172:175], a[116:119], v[136:139]
    v_mul_f32 v198, v198, v110
    v_mul_f32 v199, v199, v111
    v_mfma_f32_16x16x32_bf16 v[136:139], a[8:11], a[192:195], v[136:139]
    ds_read_b128 a[216:219], v42 offset:6144
    v_cvt_pk_bf16_f32 v49, v196, v133
    v_mfma_f32_16x16x32_bf16 v[136:139], a[12:15], a[196:199], v[136:139]
    ds_write_b64 v26, v[48:49] offset:0
    v_mfma_f32_16x16x32_bf16 v[168:171], a[56:59], a[88:91], v[168:171]
    v_cvt_pk_bf16_f32 v50, v165, v197
    v_cvt_pk_bf16_f32 v52, v198, v135
    v_mfma_f32_16x16x32_bf16 v[168:171], a[60:63], a[92:95], v[168:171]
    ds_write_b64 v26, v[50:51] offset:8
    v_mfma_f32_16x16x32_bf16 v[168:171], a[32:35], a[104:107], v[168:171]
    ds_read_b128 a[220:223], v43 offset:6144
    v_cvt_pk_bf16_f32 v53, v167, v199
    v_mfma_f32_16x16x32_bf16 v[168:171], a[36:39], a[108:111], v[168:171]
    ds_write_b64 v26, v[52:53] offset:16
    v_mfma_f32_16x16x32_bf16 v[168:171], a[144:147], a[112:115], v[168:171]
    ds_read_b128 a[232:235], v42 offset:22528
    v_mul_f32 v136, v136, v96
    v_mfma_f32_16x16x32_bf16 v[168:171], a[148:151], a[116:119], v[168:171]
    v_mul_f32 v137, v137, v97
    v_mul_f32 v138, v138, v98
    v_mfma_f32_16x16x32_bf16 v[168:171], a[184:187], a[192:195], v[168:171]
    ds_read_b128 a[236:239], v43 offset:22528
    v_mul_f32 v139, v139, v99
    v_mfma_f32_16x16x32_bf16 v[168:171], a[188:191], a[196:199], v[168:171]
    v_mfma_f32_16x16x32_bf16 v[200:203], a[24:27], a[88:91], v[200:203]
    s_waitcnt lgkmcnt(2)
    s_barrier
    v_mfma_f32_16x16x32_bf16 v[200:203], a[28:31], a[92:95], v[200:203]
    ds_read_b128 v[68:71], v24 offset:0
    ds_read2st64_b32 v[72:73], v30 offset0:129 offset1:130
    v_mfma_f32_16x16x32_bf16 v[200:203], a[120:123], a[104:107], v[200:203]
    ds_read_b128 v[76:79], v24 offset:928
    v_mfma_f32_16x16x32_bf16 v[200:203], a[124:127], a[108:111], v[200:203]
    ds_read_b128 a[80:83], v40 offset:40960
    v_mul_f32 v168, v168, v104
    v_mfma_f32_16x16x32_bf16 v[200:203], a[48:51], a[112:115], v[200:203]
    v_cvt_pk_bf16_f32 v100, v136, v168
    v_mul_f32 v169, v169, v105
    v_mfma_f32_16x16x32_bf16 v[200:203], a[52:55], a[116:119], v[200:203]
    ds_read_b128 a[84:87], v41 offset:40960
    v_mul_f32 v170, v170, v106
    v_mfma_f32_16x16x32_bf16 v[200:203], a[72:75], a[192:195], v[200:203]
    v_cvt_pk_bf16_f32 v103, v138, v170
    v_mul_f32 v171, v171, v107
    v_mfma_f32_16x16x32_bf16 v[200:203], a[76:79], a[196:199], v[200:203]
    s_waitcnt lgkmcnt(3)
    v_mfma_f32_16x16x32_bf16 v[236:239], a[200:203], a[250:253], v[236:239]
    buffer_store_dwordx4 v[68:71], v25, s[16:19], s66 offen sc1
    v_mfma_f32_16x16x32_bf16 v[236:239], a[204:207], a[242:245], v[236:239]
    s_mov_b32 s66, 229376
    v_add_f32 v232, v232, v72
    v_mul_f32 v232, v232, v84
    v_mfma_f32_16x16x32_bf16 v[236:239], a[160:163], a[218:221], v[236:239]
    v_add_f32 v233, v233, v73
    v_mul_f32 v233, v233, v85
    v_mfma_f32_16x16x32_bf16 v[236:239], a[164:167], a[234:237], v[236:239]
    s_waitcnt lgkmcnt(2)
    ds_read_b128 a[0:3], v40 offset:57344
    v_mfma_f32_16x16x32_bf16 v[140:143], a[16:19], a[248:251], v[140:143]
    buffer_store_dwordx4 v[76:79], v25, s[16:19], s67 offen sc1
    v_mfma_f32_16x16x32_bf16 v[140:143], a[20:23], a[252:255], v[140:143]
    s_mov_b32 s67, 243712
    ds_read_b128 a[4:7], v41 offset:57344
    v_cvt_pk_bf16_f32 v72, v232, v233
    v_mfma_f32_16x16x32_bf16 v[140:143], a[40:43], a[240:243], v[140:143]
    ds_write_b32 v28, v72 offset:7424
    v_mfma_f32_16x16x32_bf16 v[140:143], a[44:47], a[244:247], v[140:143]
    ds_write_addtid_b32 v238 offset:0
    v_mul_f32 v200, v200, v108
    v_mfma_f32_16x16x32_bf16 v[140:143], a[168:171], a[216:219], v[140:143]
    ds_write_addtid_b32 v239 offset:256
    v_mul_f32 v201, v201, v109
    v_mfma_f32_16x16x32_bf16 v[140:143], a[172:175], a[220:223], v[140:143]
    v_mul_f32 v202, v202, v110
    v_mul_f32 v203, v203, v111
    v_mfma_f32_16x16x32_bf16 v[140:143], a[8:11], a[232:235], v[140:143]
    ds_read_b128 a[136:139], v42 offset:8192
    v_cvt_pk_bf16_f32 v101, v200, v137
    v_mfma_f32_16x16x32_bf16 v[140:143], a[12:15], a[236:239], v[140:143]
    ds_write_b64 v26, v[100:101] offset:7424
    v_mfma_f32_16x16x32_bf16 v[172:175], a[56:59], a[248:251], v[172:175]
    v_cvt_pk_bf16_f32 v102, v169, v201
    v_cvt_pk_bf16_f32 v64, v202, v139
    v_mfma_f32_16x16x32_bf16 v[172:175], a[60:63], a[252:255], v[172:175]
    ds_write_b64 v26, v[102:103] offset:7432
    v_mfma_f32_16x16x32_bf16 v[172:175], a[32:35], a[240:243], v[172:175]
    ds_read_b128 a[140:143], v43 offset:8192
    v_cvt_pk_bf16_f32 v65, v171, v203
    v_mfma_f32_16x16x32_bf16 v[172:175], a[36:39], a[244:247], v[172:175]
    ds_write_b64 v26, v[64:65] offset:7440
    v_mfma_f32_16x16x32_bf16 v[172:175], a[144:147], a[216:219], v[172:175]
    ds_read_b128 a[88:91], v42 offset:24576
    v_mul_f32 v140, v140, v96
    v_mfma_f32_16x16x32_bf16 v[172:175], a[148:151], a[220:223], v[172:175]
    v_mul_f32 v141, v141, v97
    v_mul_f32 v142, v142, v98
    v_mfma_f32_16x16x32_bf16 v[172:175], a[184:187], a[232:235], v[172:175]
    ds_read_b128 a[92:95], v43 offset:24576
    v_mul_f32 v143, v143, v99
    v_mfma_f32_16x16x32_bf16 v[172:175], a[188:191], a[236:239], v[172:175]
    v_mfma_f32_16x16x32_bf16 v[204:207], a[24:27], a[248:251], v[204:207]
    s_waitcnt lgkmcnt(2)
    s_barrier
    v_mfma_f32_16x16x32_bf16 v[204:207], a[28:31], a[252:255], v[204:207]
    ds_read_b128 v[80:83], v24 offset:7424
    ds_read2st64_b32 v[116:117], v30 offset0:0 offset1:1
    v_mfma_f32_16x16x32_bf16 v[204:207], a[120:123], a[240:243], v[204:207]
    ds_read_b128 v[120:123], v24 offset:8352
    v_mfma_f32_16x16x32_bf16 v[204:207], a[124:127], a[244:247], v[204:207]
    ds_read_b128 a[104:107], v40 offset:43008
    v_mul_f32 v172, v172, v104
    v_mfma_f32_16x16x32_bf16 v[204:207], a[48:51], a[216:219], v[204:207]
    v_cvt_pk_bf16_f32 v112, v140, v172
    v_mul_f32 v173, v173, v105
    v_mfma_f32_16x16x32_bf16 v[204:207], a[52:55], a[220:223], v[204:207]
    ds_read_b128 a[108:111], v41 offset:43008
    v_mul_f32 v174, v174, v106
    v_mfma_f32_16x16x32_bf16 v[204:207], a[72:75], a[232:235], v[204:207]
    v_cvt_pk_bf16_f32 v115, v142, v174
    v_mul_f32 v175, v175, v107
    v_mfma_f32_16x16x32_bf16 v[204:207], a[76:79], a[236:239], v[204:207]
    s_waitcnt lgkmcnt(3)
    v_mfma_f32_16x16x32_bf16 v[240:243], a[200:203], a[82:85], v[240:243]
    buffer_store_dwordx4 v[80:83], v25, s[16:19], s66 offen sc1
    v_mfma_f32_16x16x32_bf16 v[240:243], a[204:207], a[2:5], v[240:243]
    s_mov_b32 s66, 344064
    v_add_f32 v236, v236, v116
    v_mul_f32 v236, v236, v84
    v_mfma_f32_16x16x32_bf16 v[240:243], a[160:163], a[138:141], v[240:243]
    v_add_f32 v237, v237, v117
    v_mul_f32 v237, v237, v85
    v_mfma_f32_16x16x32_bf16 v[240:243], a[164:167], a[90:93], v[240:243]
    s_waitcnt lgkmcnt(2)
    ds_read_b128 a[112:115], v40 offset:59392
    v_mfma_f32_16x16x32_bf16 v[144:147], a[16:19], a[80:83], v[144:147]
    buffer_store_dwordx4 v[120:123], v25, s[16:19], s67 offen sc1
    v_mfma_f32_16x16x32_bf16 v[144:147], a[20:23], a[84:87], v[144:147]
    s_mov_b32 s67, 358400
    ds_read_b128 a[116:119], v41 offset:59392
    v_cvt_pk_bf16_f32 v116, v236, v237
    v_mfma_f32_16x16x32_bf16 v[144:147], a[40:43], a[0:3], v[144:147]
    ds_write_b32 v28, v116 offset:14848
    v_mfma_f32_16x16x32_bf16 v[144:147], a[44:47], a[4:7], v[144:147]
    ds_write_addtid_b32 v242 offset:2048
    v_mul_f32 v204, v204, v108
    v_mfma_f32_16x16x32_bf16 v[144:147], a[168:171], a[136:139], v[144:147]
    ds_write_addtid_b32 v243 offset:2304
    v_mul_f32 v205, v205, v109
    v_mfma_f32_16x16x32_bf16 v[144:147], a[172:175], a[140:143], v[144:147]
    v_mul_f32 v206, v206, v110
    v_mul_f32 v207, v207, v111
    v_mfma_f32_16x16x32_bf16 v[144:147], a[8:11], a[88:91], v[144:147]
    ds_read_b128 a[192:195], v42 offset:10240
    v_cvt_pk_bf16_f32 v113, v204, v141
    v_mfma_f32_16x16x32_bf16 v[144:147], a[12:15], a[92:95], v[144:147]
    ds_write_b64 v26, v[112:113] offset:14848
    v_mfma_f32_16x16x32_bf16 v[176:179], a[56:59], a[80:83], v[176:179]
    v_cvt_pk_bf16_f32 v114, v173, v205
    v_cvt_pk_bf16_f32 v124, v206, v143
    v_mfma_f32_16x16x32_bf16 v[176:179], a[60:63], a[84:87], v[176:179]
    ds_write_b64 v26, v[114:115] offset:14856
    v_mfma_f32_16x16x32_bf16 v[176:179], a[32:35], a[0:3], v[176:179]
    ds_read_b128 a[196:199], v43 offset:10240
    v_cvt_pk_bf16_f32 v125, v175, v207
    v_mfma_f32_16x16x32_bf16 v[176:179], a[36:39], a[4:7], v[176:179]
    ds_write_b64 v26, v[124:125] offset:14864
    v_mfma_f32_16x16x32_bf16 v[176:179], a[144:147], a[136:139], v[176:179]
    ds_read_b128 a[248:251], v42 offset:26624
    v_mul_f32 v144, v144, v96
    v_mfma_f32_16x16x32_bf16 v[176:179], a[148:151], a[140:143], v[176:179]
    v_mul_f32 v145, v145, v97
    v_mul_f32 v146, v146, v98
    v_mfma_f32_16x16x32_bf16 v[176:179], a[184:187], a[88:91], v[176:179]
    ds_read_b128 a[252:255], v43 offset:26624
    v_mul_f32 v147, v147, v99
    v_mfma_f32_16x16x32_bf16 v[176:179], a[188:191], a[92:95], v[176:179]
    s_waitcnt vmcnt(6)
    v_bitop3_b32 v45, v45, 15, v0 bitop3:0xbe
    v_lshlrev_b32 v45, 22, v45
    v_mfma_f32_16x16x32_bf16 v[208:211], a[24:27], a[80:83], v[208:211]
    s_waitcnt lgkmcnt(2)
    s_barrier
    v_mfma_f32_16x16x32_bf16 v[208:211], a[28:31], a[84:87], v[208:211]
    buffer_store_dword v47, v45, s[12:15], s78 offen sc1
    v_mfma_f32_16x16x32_bf16 v[208:211], a[120:123], a[0:3], v[208:211]
    ds_read_b128 v[92:95], v24 offset:14848
    ds_read2st64_b32 v[88:89], v30 offset0:8 offset1:9
    v_mfma_f32_16x16x32_bf16 v[208:211], a[124:127], a[4:7], v[208:211]
    ds_read_b128 v[48:51], v24 offset:15776
    v_mul_f32 v176, v176, v104
    v_mfma_f32_16x16x32_bf16 v[208:211], a[48:51], a[136:139], v[208:211]
    ds_read_b128 a[240:243], v40 offset:45056
    v_cvt_pk_bf16_f32 v52, v144, v176
    v_mfma_f32_16x16x32_bf16 v[208:211], a[52:55], a[140:143], v[208:211]
    ds_read_b128 a[244:247], v41 offset:45056
    v_mul_f32 v177, v177, v105
    v_mfma_f32_16x16x32_bf16 v[208:211], a[72:75], a[88:91], v[208:211]
    v_mul_f32 v178, v178, v106
    v_cvt_pk_bf16_f32 v55, v146, v178
    v_mfma_f32_16x16x32_bf16 v[208:211], a[76:79], a[92:95], v[208:211]
    v_mul_f32 v179, v179, v107
    v_mfma_f32_16x16x32_bf16 v[244:247], a[200:203], a[106:109], v[244:247]
    s_waitcnt lgkmcnt(3)
    v_mfma_f32_16x16x32_bf16 v[244:247], a[204:207], a[114:117], v[244:247]
    buffer_store_dwordx4 v[92:95], v25, s[16:19], s66 offen sc1
    v_mfma_f32_16x16x32_bf16 v[244:247], a[160:163], a[194:197], v[244:247]
    s_mov_b32 s66, 458752
    v_add_f32 v240, v240, v88
    v_mul_f32 v240, v240, v84
    v_mfma_f32_16x16x32_bf16 v[244:247], a[164:167], a[250:253], v[244:247]
    v_add_f32 v241, v241, v89
    v_mul_f32 v241, v241, v85
    v_mfma_f32_16x16x32_bf16 v[148:151], a[16:19], a[104:107], v[148:151]
    s_waitcnt lgkmcnt(2)
    ds_read_b128 a[216:219], v40 offset:61440
    v_mfma_f32_16x16x32_bf16 v[148:151], a[20:23], a[108:111], v[148:151]
    buffer_store_dwordx4 v[48:51], v25, s[16:19], s67 offen sc1
    v_mfma_f32_16x16x32_bf16 v[148:151], a[40:43], a[112:115], v[148:151]
    s_mov_b32 s67, 473088
    ds_read_b128 a[220:223], v41 offset:61440
    v_cvt_pk_bf16_f32 v88, v240, v241
    v_mfma_f32_16x16x32_bf16 v[148:151], a[44:47], a[116:119], v[148:151]
    ds_write_b32 v28, v88 offset:22272
    v_mfma_f32_16x16x32_bf16 v[148:151], a[168:171], a[192:195], v[148:151]
    ds_write_addtid_b32 v246 offset:4096
    v_mul_f32 v208, v208, v108
    v_mfma_f32_16x16x32_bf16 v[148:151], a[172:175], a[196:199], v[148:151]
    v_mul_f32 v209, v209, v109
    v_mul_f32 v210, v210, v110
    v_mfma_f32_16x16x32_bf16 v[148:151], a[8:11], a[248:251], v[148:151]
    v_mul_f32 v211, v211, v111
    v_cvt_pk_bf16_f32 v53, v208, v145
    v_mfma_f32_16x16x32_bf16 v[148:151], a[12:15], a[252:255], v[148:151]
    ds_write_b64 v26, v[52:53] offset:22272
    v_mfma_f32_16x16x32_bf16 v[180:183], a[56:59], a[104:107], v[180:183]
    v_cvt_pk_bf16_f32 v54, v177, v209
    v_cvt_pk_bf16_f32 v68, v210, v147
    v_mfma_f32_16x16x32_bf16 v[180:183], a[60:63], a[108:111], v[180:183]
    ds_read_b128 a[232:235], v42 offset:12288
    v_cvt_pk_bf16_f32 v69, v179, v211
    v_mfma_f32_16x16x32_bf16 v[180:183], a[32:35], a[112:115], v[180:183]
    ds_write_b64 v26, v[54:55] offset:22280
    v_mfma_f32_16x16x32_bf16 v[180:183], a[36:39], a[116:119], v[180:183]
    ds_write_b64 v26, v[68:69] offset:22288
    v_mfma_f32_16x16x32_bf16 v[180:183], a[144:147], a[192:195], v[180:183]
    ds_read_b128 a[236:239], v43 offset:12288
    ds_write_addtid_b32 v247 offset:4352
    v_mfma_f32_16x16x32_bf16 v[180:183], a[148:151], a[196:199], v[180:183]
    ds_read_b128 a[80:83], v42 offset:28672
    v_mul_f32 v148, v148, v96
    v_mfma_f32_16x16x32_bf16 v[180:183], a[184:187], a[248:251], v[180:183]
    ds_read_b128 a[84:87], v43 offset:28672
    v_mul_f32 v149, v149, v97
    v_mfma_f32_16x16x32_bf16 v[180:183], a[188:191], a[252:255], v[180:183]
    v_mul_f32 v150, v150, v98
    v_mul_f32 v151, v151, v99
    v_mfma_f32_16x16x32_bf16 v[212:215], a[24:27], a[104:107], v[212:215]
    v_mfma_f32_16x16x32_bf16 v[212:215], a[28:31], a[108:111], v[212:215]
    s_waitcnt lgkmcnt(2)
    s_barrier
    v_mfma_f32_16x16x32_bf16 v[212:215], a[120:123], a[112:115], v[212:215]
    ds_read_b128 v[76:79], v24 offset:22272
    ds_read2st64_b32 v[72:73], v30 offset0:16 offset1:17
    v_mfma_f32_16x16x32_bf16 v[212:215], a[124:127], a[116:119], v[212:215]
    ds_read_b128 v[100:103], v24 offset:23200
    v_mul_f32 v180, v180, v104
    v_mfma_f32_16x16x32_bf16 v[212:215], a[48:51], a[192:195], v[212:215]
    ds_read_b128 a[0:3], v40 offset:14336
    v_cvt_pk_bf16_f32 v64, v148, v180
    v_mfma_f32_16x16x32_bf16 v[212:215], a[52:55], a[196:199], v[212:215]
    ds_read_b128 a[4:7], v41 offset:14336
    v_mul_f32 v181, v181, v105
    v_mfma_f32_16x16x32_bf16 v[212:215], a[72:75], a[248:251], v[212:215]
    v_mul_f32 v182, v182, v106
    v_cvt_pk_bf16_f32 v67, v150, v182
    v_mfma_f32_16x16x32_bf16 v[212:215], a[76:79], a[252:255], v[212:215]
    v_mul_f32 v183, v183, v107
    v_mfma_f32_16x16x32_bf16 v[248:251], a[200:203], a[242:245], v[248:251]
    s_waitcnt lgkmcnt(3)
    v_mfma_f32_16x16x32_bf16 v[248:251], a[204:207], a[218:221], v[248:251]
    buffer_store_dwordx4 v[76:79], v25, s[16:19], s66 offen sc1
    v_mfma_f32_16x16x32_bf16 v[248:251], a[160:163], a[234:237], v[248:251]
    s_mov_b32 s66, 573440
    v_add_f32 v244, v244, v72
    v_mul_f32 v244, v244, v84
    v_mfma_f32_16x16x32_bf16 v[248:251], a[164:167], a[82:85], v[248:251]
    v_add_f32 v245, v245, v73
    v_mul_f32 v245, v245, v85
    v_mfma_f32_16x16x32_bf16 v[152:155], a[16:19], a[240:243], v[152:155]
    s_waitcnt lgkmcnt(2)
    ds_read_b128 a[136:139], v40 offset:30720
    v_mfma_f32_16x16x32_bf16 v[152:155], a[20:23], a[244:247], v[152:155]
    buffer_store_dwordx4 v[100:103], v25, s[16:19], s67 offen sc1
    v_mfma_f32_16x16x32_bf16 v[152:155], a[40:43], a[216:219], v[152:155]
    s_mov_b32 s67, 587776
    ds_read_b128 a[140:143], v41 offset:30720
    v_cvt_pk_bf16_f32 v72, v244, v245
    v_mfma_f32_16x16x32_bf16 v[152:155], a[44:47], a[220:223], v[152:155]
    ds_write_b32 v28, v72 offset:29696
    v_mfma_f32_16x16x32_bf16 v[152:155], a[168:171], a[232:235], v[152:155]
    ds_write_addtid_b32 v250 offset:6144
    v_mul_f32 v212, v212, v108
    v_mfma_f32_16x16x32_bf16 v[152:155], a[172:175], a[236:239], v[152:155]
    v_mul_f32 v213, v213, v109
    v_mul_f32 v214, v214, v110
    v_mfma_f32_16x16x32_bf16 v[152:155], a[8:11], a[80:83], v[152:155]
    v_mul_f32 v215, v215, v111
    v_cvt_pk_bf16_f32 v65, v212, v149
    v_mfma_f32_16x16x32_bf16 v[152:155], a[12:15], a[84:87], v[152:155]
    ds_write_b64 v26, v[64:65] offset:29696
    v_mfma_f32_16x16x32_bf16 v[184:187], a[56:59], a[240:243], v[184:187]
    v_cvt_pk_bf16_f32 v66, v181, v213
    v_cvt_pk_bf16_f32 v80, v214, v151
    v_mfma_f32_16x16x32_bf16 v[184:187], a[60:63], a[244:247], v[184:187]
    ds_read_b128 a[88:91], v40 offset:47104
    v_cvt_pk_bf16_f32 v81, v183, v215
    v_mfma_f32_16x16x32_bf16 v[184:187], a[32:35], a[216:219], v[184:187]
    ds_write_b64 v26, v[66:67] offset:29704
    v_mfma_f32_16x16x32_bf16 v[184:187], a[36:39], a[220:223], v[184:187]
    ds_write_b64 v26, v[80:81] offset:29712
    v_mfma_f32_16x16x32_bf16 v[184:187], a[144:147], a[232:235], v[184:187]
    ds_read_b128 a[92:95], v41 offset:47104
    ds_write_addtid_b32 v251 offset:6400
    v_mfma_f32_16x16x32_bf16 v[184:187], a[148:151], a[236:239], v[184:187]
    ds_read_b128 a[104:107], v40 offset:63488
    v_mul_f32 v152, v152, v96
    v_mfma_f32_16x16x32_bf16 v[184:187], a[184:187], a[80:83], v[184:187]
    ds_read_b128 a[108:111], v41 offset:63488
    v_mul_f32 v153, v153, v97
    v_mfma_f32_16x16x32_bf16 v[184:187], a[188:191], a[84:87], v[184:187]
    v_mul_f32 v154, v154, v98
    v_mul_f32 v155, v155, v99
    v_mfma_f32_16x16x32_bf16 v[216:219], a[24:27], a[240:243], v[216:219]
    ds_read_b128 a[112:115], v42 offset:14336
    v_mfma_f32_16x16x32_bf16 v[216:219], a[28:31], a[244:247], v[216:219]
    s_waitcnt lgkmcnt(3)
    s_barrier
    v_mfma_f32_16x16x32_bf16 v[216:219], a[120:123], a[216:219], v[216:219]
    ds_read_b128 a[116:119], v43 offset:14336
    ds_read2st64_b32 v[120:121], v30 offset0:24 offset1:25
    v_mfma_f32_16x16x32_bf16 v[216:219], a[124:127], a[220:223], v[216:219]
    ds_read_b128 a[192:195], v42 offset:30720
    v_mul_f32 v184, v184, v104
    v_mfma_f32_16x16x32_bf16 v[216:219], a[48:51], a[232:235], v[216:219]
    ds_read_b128 a[196:199], v43 offset:30720
    v_cvt_pk_bf16_f32 v116, v152, v184
    v_mfma_f32_16x16x32_bf16 v[216:219], a[52:55], a[236:239], v[216:219]
    ds_read_b128 v[112:115], v24 offset:29696
    v_mul_f32 v185, v185, v105
    v_mfma_f32_16x16x32_bf16 v[216:219], a[72:75], a[80:83], v[216:219]
    ds_read_b128 v[124:127], v24 offset:30624
    v_mul_f32 v186, v186, v106
    v_mfma_f32_16x16x32_bf16 v[216:219], a[76:79], a[84:87], v[216:219]
    v_cvt_pk_bf16_f32 v119, v154, v186
    v_mul_f32 v187, v187, v107
    v_mfma_f32_16x16x32_bf16 v[252:255], a[152:155], a[2:5], v[252:255]
    v_mfma_f32_16x16x32_bf16 v[252:255], a[156:159], a[138:141], v[252:255]
    s_waitcnt lgkmcnt(4)
    v_add_f32 v248, v248, v120
    v_mul_f32 v248, v248, v84
    v_mfma_f32_16x16x32_bf16 v[252:255], a[200:203], a[90:93], v[252:255]
    v_add_f32 v249, v249, v121
    v_mul_f32 v249, v249, v85
    v_mfma_f32_16x16x32_bf16 v[252:255], a[204:207], a[106:109], v[252:255]
    s_waitcnt lgkmcnt(1)
    v_cvt_pk_bf16_f32 v120, v248, v249
    v_mfma_f32_16x16x32_bf16 v[252:255], a[160:163], a[114:117], v[252:255]
    buffer_store_dwordx4 v[112:115], v25, s[16:19], s66 offen sc1
    v_mfma_f32_16x16x32_bf16 v[252:255], a[164:167], a[194:197], v[252:255]
    s_mov_b32 s66, 688128
    ds_write_b32 v28, v120 offset:37120
    v_mfma_f32_16x16x32_bf16 v[156:159], a[96:99], a[0:3], v[156:159]
    v_mul_f32 v216, v216, v108
    v_mul_f32 v217, v217, v109
    v_mfma_f32_16x16x32_bf16 v[156:159], a[100:103], a[4:7], v[156:159]
    s_waitcnt lgkmcnt(1)
    v_mul_f32 v218, v218, v110
    v_mfma_f32_16x16x32_bf16 v[156:159], a[64:67], a[136:139], v[156:159]
    buffer_store_dwordx4 v[124:127], v25, s[16:19], s67 offen sc1
    v_mfma_f32_16x16x32_bf16 v[156:159], a[68:71], a[140:143], v[156:159]
    s_mov_b32 s67, 702464
    ds_write_addtid_b32 v254 offset:8192
    v_mul_f32 v219, v219, v111
    v_mfma_f32_16x16x32_bf16 v[156:159], a[16:19], a[88:91], v[156:159]
    ds_write_addtid_b32 v255 offset:8448
    v_cvt_pk_bf16_f32 v117, v216, v153
    v_mfma_f32_16x16x32_bf16 v[156:159], a[20:23], a[92:95], v[156:159]
    ds_write_b64 v26, v[116:117] offset:37120
    v_mfma_f32_16x16x32_bf16 v[156:159], a[40:43], a[104:107], v[156:159]
    v_cvt_pk_bf16_f32 v118, v185, v217
    v_cvt_pk_bf16_f32 v92, v218, v155
    v_mfma_f32_16x16x32_bf16 v[156:159], a[44:47], a[108:111], v[156:159]
    ds_write_b64 v26, v[118:119] offset:37128
    v_mfma_f32_16x16x32_bf16 v[156:159], a[168:171], a[112:115], v[156:159]
    v_cvt_pk_bf16_f32 v93, v187, v219
    v_mfma_f32_16x16x32_bf16 v[156:159], a[172:175], a[116:119], v[156:159]
    ds_write_b64 v26, v[92:93] offset:37136
    v_mfma_f32_16x16x32_bf16 v[156:159], a[8:11], a[192:195], v[156:159]
    v_mfma_f32_16x16x32_bf16 v[156:159], a[12:15], a[196:199], v[156:159]
    v_mfma_f32_16x16x32_bf16 v[188:191], a[176:179], a[0:3], v[188:191]
    v_mfma_f32_16x16x32_bf16 v[188:191], a[180:183], a[4:7], v[188:191]
    v_mfma_f32_16x16x32_bf16 v[188:191], a[208:211], a[136:139], v[188:191]
    s_waitcnt lgkmcnt(0)
    s_barrier
    v_mfma_f32_16x16x32_bf16 v[188:191], a[212:215], a[140:143], v[188:191]
    ds_read_b128 v[48:51], v24 offset:37120
    ds_read2st64_b32 v[88:89], v30 offset0:32 offset1:33
    v_mfma_f32_16x16x32_bf16 v[188:191], a[56:59], a[88:91], v[188:191]
    ds_read_b128 v[52:55], v24 offset:38048
    v_mul_f32 v156, v156, v96
    v_mfma_f32_16x16x32_bf16 v[188:191], a[60:63], a[92:95], v[188:191]
    v_mul_f32 v157, v157, v97
    v_mul_f32 v158, v158, v98
    v_mfma_f32_16x16x32_bf16 v[188:191], a[32:35], a[104:107], v[188:191]
    v_mul_f32 v159, v159, v99
    v_mfma_f32_16x16x32_bf16 v[188:191], a[36:39], a[108:111], v[188:191]
    v_mfma_f32_16x16x32_bf16 v[188:191], a[144:147], a[112:115], v[188:191]
    v_mfma_f32_16x16x32_bf16 v[188:191], a[148:151], a[116:119], v[188:191]
    s_waitcnt lgkmcnt(1)
    v_mfma_f32_16x16x32_bf16 v[188:191], a[184:187], a[192:195], v[188:191]
    buffer_store_dwordx4 v[48:51], v25, s[16:19], s66 offen sc1
    v_mfma_f32_16x16x32_bf16 v[188:191], a[188:191], a[196:199], v[188:191]
    s_mov_b32 s66, 802816
    v_add_f32 v252, v252, v88
    v_mul_f32 v252, v252, v84
    v_mfma_f32_16x16x32_bf16 v[220:223], a[128:131], a[0:3], v[220:223]
    v_add_f32 v253, v253, v89
    v_mul_f32 v253, v253, v85
    v_mfma_f32_16x16x32_bf16 v[220:223], a[132:135], a[4:7], v[220:223]
    s_waitcnt lgkmcnt(0)
    v_cvt_pk_bf16_f32 v88, v252, v253
    v_mfma_f32_16x16x32_bf16 v[220:223], a[224:227], a[136:139], v[220:223]
    buffer_store_dwordx4 v[52:55], v25, s[16:19], s67 offen sc1
    v_mfma_f32_16x16x32_bf16 v[220:223], a[228:231], a[140:143], v[220:223]
    s_mov_b32 s67, 817152
    ds_write_b32 v28, v88 offset:44544
    v_mfma_f32_16x16x32_bf16 v[220:223], a[24:27], a[88:91], v[220:223]
    v_mul_f32 v188, v188, v104
    v_cvt_pk_bf16_f32 v68, v156, v188
    v_mfma_f32_16x16x32_bf16 v[220:223], a[28:31], a[92:95], v[220:223]
    v_mul_f32 v189, v189, v105
    v_mul_f32 v190, v190, v106
    v_mfma_f32_16x16x32_bf16 v[220:223], a[120:123], a[104:107], v[220:223]
    v_cvt_pk_bf16_f32 v71, v158, v190
    v_mul_f32 v191, v191, v107
    v_mfma_f32_16x16x32_bf16 v[220:223], a[124:127], a[108:111], v[220:223]
    v_mfma_f32_16x16x32_bf16 v[220:223], a[48:51], a[112:115], v[220:223]
    v_mfma_f32_16x16x32_bf16 v[220:223], a[52:55], a[116:119], v[220:223]
    v_mfma_f32_16x16x32_bf16 v[220:223], a[72:75], a[192:195], v[220:223]
    v_mfma_f32_16x16x32_bf16 v[220:223], a[76:79], a[196:199], v[220:223]
    s_nop 7
    v_mul_f32 v220, v220, v108
    v_mul_f32 v221, v221, v109
    v_mul_f32 v222, v222, v110
    v_mul_f32 v223, v223, v111
    v_cvt_pk_bf16_f32 v69, v220, v157
    v_cvt_pk_bf16_f32 v70, v189, v221
    v_cvt_pk_bf16_f32 v76, v222, v159
    v_cvt_pk_bf16_f32 v77, v191, v223
    ds_write_b64 v26, v[68:69] offset:44544
    ds_write_b64 v26, v[70:71] offset:44552
    ds_write_b64 v26, v[76:77] offset:44560
    s_waitcnt lgkmcnt(0)
    s_barrier
    ds_read_b128 v[100:103], v24 offset:44544
    ds_read_b128 v[72:75], v24 offset:45472
    s_waitcnt lgkmcnt(1)
    buffer_store_dwordx4 v[100:103], v25, s[16:19], s66 offen sc1
    s_waitcnt lgkmcnt(0)
    buffer_store_dwordx4 v[72:75], v25, s[16:19], s67 offen sc1
L_end:
    s_endpgm
L_help:
    s_mov_b32 s53, s61
    s_mov_b32 s54, s62
    s_mul_i32 s61, s22, 1835008
    s_add_u32 s61, s61, s79
    s_lshl_b32 s62, s22, 14
    s_add_u32 s62, s62, s68
    s_mov_b32 s22, 0
L_help_row:
    v_mov_b32 v21, v19
    s_xor_b32 s23, s22, s58
    s_bitcmp0_b32 s23, 2
    s_cbranch_scc1 L_help_same
    v_add_u32 v12, 57344, v19
    v_subrev_u32 v13, 57344, v19
    v_min_u32 v21, v12, v13
L_help_same:
    v_mov_b32 v8, 0
    v_mov_b32 v9, 0
    v_mov_b32 v10, 0
    v_mov_b32 v11, 0
    s_mov_b32 s23, 0
L_help_e:
    v_mov_b32 v15, 0
    buffer_load_dwordx3 v[12:14], v18, s[4:7], s61 offen nt
    s_cmp_ge_u32 s23, 16
    s_cbranch_scc1 L_help_own
    buffer_load_dword v15, v21, s[4:7], s61 offen nt
L_help_own:
    s_waitcnt vmcnt(0)
    v_lshl_or_b32 v8, v12, s23, v8
    v_lshl_or_b32 v9, v13, s23, v9
    v_lshl_or_b32 v10, v14, s23, v10
    v_lshl_or_b32 v11, v15, s23, v11
    s_add_u32 s61, s61, 14336
    s_add_u32 s23, s23, 4
    s_cmp_lt_u32 s23, 32
    s_cbranch_scc1 L_help_e
    v_mov_b32_sdwa v11, s76 dst_sel:WORD_1 dst_unused:UNUSED_PRESERVE src0_sel:WORD_1
    s_nop 1
    buffer_store_dwordx4 v[8:11], v20, s[12:15], s62 offen sc1
    s_add_u32 s62, s62, 1024
    s_waitcnt vmcnt(0)
    s_add_u32 s22, s22, 1
    s_cmp_lt_u32 s22, 16
    s_cbranch_scc1 L_help_row
    s_mov_b32 s61, s53
    s_mov_b32 s62, s54
    s_setpc_b64 s[20:21]
L_code_end:

.section .rodata,"a"
.p2align 6
.amdhsa_kernel standalone__normalfloat_lut_af4__prompt_kernel
  .amdhsa_next_free_vgpr 512
  .amdhsa_next_free_sgpr 102
  .amdhsa_accum_offset 256
  .amdhsa_group_segment_fixed_size 0
  .amdhsa_kernarg_size 56
  .amdhsa_user_sgpr_count 2
  .amdhsa_user_sgpr_kernarg_segment_ptr 1
  .amdhsa_system_sgpr_workgroup_id_x 1
.end_amdhsa_kernel
```

```asm
; @launch grid=(256,1,1) block=(256,1,1) lds=163840
.amdgcn_target "amdgcn-amd-amdhsa--gfx950"
.text
.globl standalone__normalfloat_lut_af4__prompt_kernel
.p2align 8
.type standalone__normalfloat_lut_af4__prompt_kernel,@function
standalone__normalfloat_lut_af4__prompt_kernel:
    s_cmp_ge_u32 s2, 256
    s_cbranch_scc1 L_end
    s_load_dwordx2 s[4:5], s[0:1], 8
    s_load_dwordx2 s[12:13], s[0:1], 48
    s_load_dwordx2 s[8:9], s[0:1], 0
    s_load_dwordx2 s[28:29], s[0:1], 16
    s_getpc_b64 s[48:49]
L_pc:
    s_mov_b32 s50, L_code_end-L_pc
    s_mov_b32 s51, 0x20000
    s_lshr_b32 s61, s2, 3
    v_lshl_add_u32 v46, v0, 5, s61
    v_lshlrev_b32 v46, 7, v46
    buffer_load_dword v1, v46, s[48:51], 0 offen offset:256
    v_lshrrev_b32 v5, 6, v0
    v_and_b32 v2, 63, v0
    s_and_b32 s60, s2, 7
    v_readfirstlane_b32 s63, v5
    s_and_b32 s58, s60, 3
    s_lshl_b32 s58, s58, 2
    s_and_b32 s62, s61, 3
    s_add_u32 s58, s58, s62
    s_lshr_b32 s59, s60, 2
    s_lshl_b32 s59, s59, 3
    s_lshr_b32 s62, s61, 2
    s_add_u32 s59, s59, s62
    v_mul_u32_u24 v18, 12, v2
    s_lshl_b32 s60, s63, 4
    s_add_u32 s60, s60, s58
    s_mul_i32 s61, s60, 114688
    s_mul_i32 s79, s59, 896
    s_add_u32 s61, s61, s79
    s_mov_b32 s6, 14680064
    s_mov_b32 s7, 0x20000
    s_lshl_b32 s78, s59, 7
    s_add_u32 s78, s78, 2097164
    v_and_b32 v4, 15, v2
    v_lshrrev_b32 v3, 4, v2
    v_and_b32 v12, 1, v3
    v_lshlrev_b32 v13, 1, v12
    v_xor_b32 v13, v13, v4
    v_lshrrev_b32 v19, 1, v3
    v_lshl_add_u32 v19, v19, 4, v13
    s_bfe_u32 s70, s58, 0x10002
    s_xor_b32 s70, s70, 1
    v_xor_b32 v12, s70, v12
    v_mul_u32_u24 v12, 14336, v12
    v_add_lshl_u32 v19, v19, v12, 2
    v_add_u32 v19, 768, v19
    s_mov_b32 s46, 2
    s_cmp_lg_u32 s63, 0
    s_cbranch_scc1 L_role0
    s_mov_b32 s46, 0
L_role0:
    s_cmp_lg_u32 s63, 1
    s_cbranch_scc1 L_role1
    s_mov_b32 s46, 1
L_role1:
    v_lshlrev_b32 v16, 1, v4
    v_lshrrev_b32 v17, 4, v0
    v_lshlrev_b32 v17, 1, v17
    s_mov_b32 s30, 32
    s_mov_b32 s31, 0x20000
    v_lshrrev_b32 v6, 3, v2
    v_and_b32 v7, 7, v2
    v_xor_b32 v13, v7, v3
    s_lshl_b32 s70, s63, 5
    v_add_lshl_u32 v12, v6, s70, 11
    v_lshl_add_u32 v36, v13, 4, v12
    v_xor_b32 v37, 64, v36
    v_add_u32 v37, 15360, v37
    v_add_u32 v38, 30720, v36
    v_add_u32 v39, 30720, v37
    s_mov_b32 s10, 4194304
    s_mov_b32 s11, 0x20000
    s_lshl_b32 s55, s58, 18
    s_and_b32 s71, s58, 8
    s_lshl_b32 s70, s71, 4
    s_add_u32 s55, s55, s70
    s_lshl_b32 s57, s63, 12
    s_xor_b32 s69, s55, 128
    s_add_u32 s57, s57, 65536
    s_mov_b32 s14, 2099200
    s_mov_b32 s15, 0x20000
    s_lshl_b32 s68, s59, 17
    s_lshl_b32 s62, s60, 10
    s_add_u32 s62, s62, s68
    v_lshlrev_b32 v20, 4, v2
    s_waitcnt lgkmcnt(0)
    s_load_dword s76, s[12:13], s78
    s_cmp_eq_u32 s46, 1
    s_cbranch_scc1 L_L
    s_cmp_eq_u32 s46, 2
    s_cbranch_scc1 L_L
L_X:
    buffer_load_dwordx3 v[128:130], v18, s[4:7], s61 offen nt
    buffer_load_dword v131, v19, s[4:7], s61 offen nt
    s_add_u32 s61, s61, 14336
    buffer_load_dwordx3 v[132:134], v18, s[4:7], s61 offen nt
    buffer_load_dword v135, v19, s[4:7], s61 offen nt
    s_add_u32 s61, s61, 14336
    buffer_load_dwordx3 v[136:138], v18, s[4:7], s61 offen nt
    buffer_load_dword v139, v19, s[4:7], s61 offen nt
    s_add_u32 s61, s61, 14336
    buffer_load_dwordx3 v[140:142], v18, s[4:7], s61 offen nt
    buffer_load_dword v143, v19, s[4:7], s61 offen nt
    s_add_u32 s61, s61, 14336
    buffer_load_dwordx3 v[144:146], v18, s[4:7], s61 offen nt
    s_add_u32 s61, s61, 14336
    buffer_load_dwordx3 v[148:150], v18, s[4:7], s61 offen nt
    s_add_u32 s61, s61, 14336
    buffer_load_dwordx3 v[152:154], v18, s[4:7], s61 offen nt
    s_add_u32 s61, s61, 14336
    buffer_load_dwordx3 v[156:158], v18, s[4:7], s61 offen nt
    s_add_u32 s61, s61, 7239680
    s_cmp_eq_u32 s46, 1
    s_cbranch_scc1 L_D
    s_cmp_eq_u32 s46, 2
    s_cbranch_scc1 L_B
L_L:
    buffer_load_ushort v16, v16, s[28:31], 0 offen
    buffer_load_ushort v17, v17, s[28:31], 0 offen
    s_cmp_eq_u32 s46, 1
    s_cbranch_scc1 L_S
    s_cmp_eq_u32 s46, 2
    s_cbranch_scc1 L_S
L_D:
    s_add_u32 m0, s57, 32768
    s_add_u32 s56, s55, 0
    buffer_load_dwordx4 v36, s[8:11], s56 offen offset:0  lds
    buffer_load_dwordx4 v37, s[8:11], s56 offen offset:1024  lds
    buffer_load_dwordx4 v38, s[8:11], s56 offen offset:2048  lds
    buffer_load_dwordx4 v39, s[8:11], s56 offen offset:3072  lds
    s_cmp_eq_u32 s46, 1
    s_cbranch_scc1 L_G
    s_cmp_eq_u32 s46, 2
    s_cbranch_scc1 L_G
L_S:
    s_load_dwordx2 s[32:33], s[0:1], 24
    s_load_dwordx2 s[16:17], s[0:1], 32
    s_load_dwordx2 s[24:25], s[0:1], 40
    s_and_b32 s64, s63, 1
    s_lshr_b32 s65, s63, 1
    s_and_b32 s70, s58, 8
    s_lshl_b32 s70, s70, 10
    s_lshl_b32 s71, s64, 12
    s_add_u32 s70, s70, s71
    s_lshl_b32 s71, s63, 8
    s_add_u32 s70, s70, s71
    s_add_u32 s70, s70, s68
    v_lshl_add_u32 v32, v4, 4, s70
    v_lshl_add_u32 v32, v3, 10, v32
    v_xor_b32 v33, 4096, v32
    v_xor_b32 v34, 8192, v32
    v_xor_b32 v44, 12288, v32
    s_mov_b32 s36, 202114048
    s_mov_b32 s37, 202114304
    s_mov_b32 s38, 202114560
    s_mov_b32 s39, 202114816
    v_and_b32 v35, 31, v2
    v_lshlrev_b32 v35, 2, v35
    s_lshl_b32 s70, s64, 6
    s_add_u32 s70, s70, 65536
    v_lshrrev_b32 v12, 1, v4
    v_xor_b32 v12, v12, v3
    v_lshlrev_b32 v12, 4, v12
    v_lshl_add_u32 v12, v4, 7, v12
    v_xor_b32 v40, s70, v12
    v_xor_b32 v41, 64, v40
    v_add_u32 v42, 65536, v40
    v_add_u32 v43, 65536, v41
    s_mov_b32 s52, 0
    v_lshlrev_b32 v8, 4, v7
    v_lshl_add_u32 v8, v0, 8, v8
    v_xor_b32 v9, 16, v8
    v_xor_b32 v10, 32, v8
    v_xor_b32 v11, 48, v8
    v_xor_b32 v12, 64, v8
    v_xor_b32 v13, 80, v8
    v_xor_b32 v14, 96, v8
    v_xor_b32 v15, 112, v8
    s_cmp_eq_u32 s46, 1
    s_cbranch_scc1 L_X
    s_cmp_eq_u32 s46, 2
    s_cbranch_scc1 L_D
L_G:
    s_waitcnt lgkmcnt(0)
    s_add_u32 s76, s76, 2654435769
    s_cmp_eq_u32 s46, 1
    s_cbranch_scc1 L_T
    s_cmp_eq_u32 s46, 2
    s_cbranch_scc1 L_T
L_K:
    s_waitcnt vmcnt(15)
    v_lshl_or_b32 v128, v132, 4, v128
    v_lshl_or_b32 v129, v133, 4, v129
    v_lshl_or_b32 v130, v134, 4, v130
    s_waitcnt vmcnt(14)
    v_lshl_or_b32 v131, v135, 4, v131
    s_waitcnt vmcnt(13)
    v_lshl_or_b32 v128, v136, 8, v128
    v_lshl_or_b32 v129, v137, 8, v129
    v_lshl_or_b32 v130, v138, 8, v130
    s_waitcnt vmcnt(12)
    v_lshl_or_b32 v131, v139, 8, v131
    s_waitcnt vmcnt(11)
    v_lshl_or_b32 v128, v140, 12, v128
    v_lshl_or_b32 v129, v141, 12, v129
    v_lshl_or_b32 v130, v142, 12, v130
    s_waitcnt vmcnt(10)
    v_lshl_or_b32 v131, v143, 12, v131
    v_mov_b32_sdwa v131, s76 dst_sel:WORD_1 dst_unused:UNUSED_PRESERVE src0_sel:WORD_1
    s_waitcnt vmcnt(9)
    v_lshl_or_b32 v128, v144, 16, v128
    v_lshl_or_b32 v129, v145, 16, v129
    v_lshl_or_b32 v130, v146, 16, v130
    s_waitcnt vmcnt(8)
    v_lshl_or_b32 v128, v148, 20, v128
    v_lshl_or_b32 v129, v149, 20, v129
    v_lshl_or_b32 v130, v150, 20, v130
    s_waitcnt vmcnt(7)
    v_lshl_or_b32 v128, v152, 24, v128
    v_lshl_or_b32 v129, v153, 24, v129
    v_lshl_or_b32 v130, v154, 24, v130
    s_waitcnt vmcnt(6)
    v_lshl_or_b32 v128, v156, 28, v128
    v_lshl_or_b32 v129, v157, 28, v129
    v_lshl_or_b32 v130, v158, 28, v130
    buffer_store_dwordx4 v[128:131], v20, s[12:15], s62 offen sc1
    s_add_u32 s62, s62, 65536
    s_cmp_eq_u32 s46, 1
    s_cbranch_scc1 L_B
    s_cmp_eq_u32 s46, 2
    s_cbranch_scc1 L_E
L_T:
    s_waitcnt vmcnt(16)
    s_cmp_eq_u32 s46, 1
    s_cbranch_scc1 L_rw1
    s_waitcnt vmcnt(5)
    s_cmp_eq_u32 s46, 0
    s_cbranch_scc1 L_rw1
    s_waitcnt vmcnt(4)
L_rw1:
    v_lshl_or_b32 v56, v17, 16, v16
    v_lshl_or_b32 v57, v17, 16, v16
    v_lshl_or_b32 v58, v17, 16, v16
    v_lshl_or_b32 v59, v17, 16, v16
    ds_write_b128 v8, v[56:59]
    ds_write_b128 v9, v[56:59]
    ds_write_b128 v10, v[56:59]
    ds_write_b128 v11, v[56:59]
    ds_write_b128 v12, v[56:59]
    ds_write_b128 v13, v[56:59]
    ds_write_b128 v14, v[56:59]
    ds_write_b128 v15, v[56:59]
    s_cmp_lg_u32 s46, 1
    s_cbranch_scc1 L_ed2
    s_waitcnt vmcnt(4)
    s_branch L_K
L_ed2:
    s_cmp_eq_u32 s46, 2
    s_cbranch_scc1 L_X
L_W:
    s_mov_b64 exec, 0
    s_cmp_eq_u32 s63, 0
    s_cbranch_scc1 L_pad0
L_warmed:
    s_mov_b64 exec, -1
L_B:
    s_waitcnt vmcnt(12) lgkmcnt(0)
    s_cmp_eq_u32 s46, 2
    s_cbranch_scc1 L_rw3
    s_waitcnt vmcnt(1)
L_rw3:
    s_barrier
L_Q:
    ds_read_b128 a[0:3], v40 offset:32768
    ds_read_b128 a[4:7], v41 offset:32768
    ds_read_b128 a[8:11], v40 offset:34816
    ds_read_b128 a[12:15], v41 offset:34816
    ds_read_b128 a[16:19], v40 offset:36864
    ds_read_b128 a[20:23], v41 offset:36864
    ds_read_b128 a[24:27], v40 offset:38912
    ds_read_b128 a[28:31], v41 offset:38912
    ds_read_b128 a[40:43], v40 offset:40960
    ds_read_b128 a[44:47], v41 offset:40960
    ds_read_b128 a[48:51], v40 offset:43008
    ds_read_b128 a[52:55], v41 offset:43008
    ds_read_b128 a[56:59], v40 offset:45056
    ds_read_b128 a[60:63], v41 offset:45056
    ds_read_b128 a[72:75], v40 offset:47104
    ds_read_b128 a[76:79], v41 offset:47104
L_P:
    buffer_load_dwordx4 v[64:67], v32, s[12:15], 0 offen sc1
    buffer_load_dwordx4 v[68:71], v33, s[12:15], 0 offen sc1
L_d:
    s_add_u32 m0, s57, 49152
    s_add_u32 s3, s69, 0
    buffer_load_dwordx4 v36, s[8:11], s3 offen offset:0  lds
    buffer_load_dwordx4 v37, s[8:11], s3 offen offset:1024  lds
    buffer_load_dwordx4 v38, s[8:11], s3 offen offset:2048  lds
    buffer_load_dwordx4 v39, s[8:11], s3 offen offset:3072  lds
    s_cmp_lg_u32 s46, 2
    s_cbranch_scc1 L_ed4
    s_waitcnt vmcnt(6)
    s_branch L_K
L_ed4:
L_E:
L_chk0:
    s_waitcnt vmcnt(5)
    s_cmp_eq_u32 s46, 2
    s_cbranch_scc1 L_rw5
    s_waitcnt vmcnt(4)
L_rw5:
    v_bitop3_b32 v12, v67, v71, s76 bitop3:0x7e
    v_cmp_lt_u32 vcc, 0xffff, v12
    s_cbranch_vccnz L_retry0
    buffer_load_dwordx4 v[72:75], v34, s[12:15], 0 offen sc1
    buffer_load_dwordx4 v[76:79], v44, s[12:15], 0 offen sc1
    v_perm_b32 v56, v64, v35, s36
    v_perm_b32 v57, v64, v35, s37
    v_perm_b32 v58, v64, v35, s38
    v_perm_b32 v59, v64, v35, s39
    v_perm_b32 v60, v68, v35, s36
    v_perm_b32 v61, v68, v35, s37
    v_perm_b32 v62, v68, v35, s38
    v_perm_b32 v63, v68, v35, s39
    ds_read_b32 a32, v56
    ds_read_b32 a33, v57
    ds_read_b32 a34, v58
    ds_read_b32 a35, v59
    ds_read_b32 a36, v60
    ds_read_b32 a37, v61
    ds_read_b32 a38, v62
    ds_read_b32 a39, v63
    v_perm_b32 v5, v65, v35, s36
    v_perm_b32 v6, v65, v35, s37
    v_perm_b32 v7, v65, v35, s38
    v_perm_b32 v27, v65, v35, s39
    v_perm_b32 v29, v69, v35, s36
    v_perm_b32 v31, v69, v35, s37
    ds_read_b32 a64, v5
    ds_read_b32 a65, v6
    ds_read_b32 a66, v7
    ds_read_b32 a67, v27
    s_cbranch_vccz L_main
L_retry0:
    s_add_u32 s52, s52, 1
    s_and_b32 s23, s52, 4095
    s_cbranch_scc1 L_retry0b
    s_mov_b32 s22, 0
    s_call_b64 s[20:21], L_help
L_retry0b:
    buffer_load_dwordx4 v[64:67], v32, s[12:15], 0 offen sc1
    buffer_load_dwordx4 v[68:71], v33, s[12:15], 0 offen sc1
    s_waitcnt vmcnt(0) lgkmcnt(0)
    s_branch L_chk0
L_tick:
    s_add_u32 s52, s52, 1
    s_and_b32 s23, s52, 4095
    s_cbranch_scc0 L_help
    s_setpc_b64 s[20:21]
L_slow0_1:
    s_mov_b32 s22, 0
    s_call_b64 s[20:21], L_tick
    buffer_load_dwordx4 v[72:75], v34, s[12:15], 0 offen sc1
    buffer_load_dwordx4 v[76:79], v44, s[12:15], 0 offen sc1
    s_waitcnt vmcnt(0)
    v_bitop3_b32 v12, v75, v79, s76 bitop3:0x7e
    v_cmp_lt_u32 vcc, 0xffff, v12
    s_cbranch_vccnz L_slow0_1
    s_branch L_back0_1
L_slow4_0:
    s_mov_b32 s22, 4
    s_call_b64 s[20:21], L_tick
    buffer_load_dwordx4 v[84:87], v32, s[12:15], s43 offen sc1
    buffer_load_dwordx4 v[96:99], v33, s[12:15], s43 offen sc1
    s_waitcnt vmcnt(0)
    v_bitop3_b32 v12, v87, v99, s76 bitop3:0x7e
    v_cmp_lt_u32 vcc, 0xffff, v12
    s_cbranch_vccnz L_slow4_0
    s_branch L_back4_0
L_slow4_1:
    s_mov_b32 s22, 4
    s_call_b64 s[20:21], L_tick
    buffer_load_dwordx4 v[104:107], v34, s[12:15], s43 offen sc1
    buffer_load_dwordx4 v[108:111], v44, s[12:15], s43 offen sc1
    s_waitcnt vmcnt(0)
    v_bitop3_b32 v12, v107, v111, s76 bitop3:0x7e
    v_cmp_lt_u32 vcc, 0xffff, v12
    s_cbranch_vccnz L_slow4_1
    s_branch L_back4_1
L_slow1_0:
    s_mov_b32 s22, 1
    s_call_b64 s[20:21], L_tick
    buffer_load_dwordx4 v[80:83], v32, s[12:15], s40 offen sc1
    buffer_load_dwordx4 v[84:87], v33, s[12:15], s40 offen sc1
    s_waitcnt vmcnt(0)
    v_bitop3_b32 v12, v83, v87, s76 bitop3:0x7e
    v_cmp_lt_u32 vcc, 0xffff, v12
    s_cbranch_vccnz L_slow1_0
    s_branch L_back1_0
L_slow1_1:
    s_mov_b32 s22, 1
    s_call_b64 s[20:21], L_tick
    buffer_load_dwordx4 v[88:91], v34, s[12:15], s40 offen sc1
    buffer_load_dwordx4 v[92:95], v44, s[12:15], s40 offen sc1
    s_waitcnt vmcnt(0)
    v_bitop3_b32 v12, v91, v95, s76 bitop3:0x7e
    v_cmp_lt_u32 vcc, 0xffff, v12
    s_cbranch_vccnz L_slow1_1
    s_branch L_back1_1
L_slow5_0:
    s_mov_b32 s22, 5
    s_call_b64 s[20:21], L_tick
    buffer_load_dwordx4 v[112:115], v32, s[12:15], s44 offen sc1
    buffer_load_dwordx4 v[116:119], v33, s[12:15], s44 offen sc1
    s_waitcnt vmcnt(0)
    v_bitop3_b32 v12, v115, v119, s76 bitop3:0x7e
    v_cmp_lt_u32 vcc, 0xffff, v12
    s_cbranch_vccnz L_slow5_0
    s_branch L_back5_0
L_slow5_1:
    s_mov_b32 s22, 5
    s_call_b64 s[20:21], L_tick
    buffer_load_dwordx4 v[120:123], v34, s[12:15], s44 offen sc1
    buffer_load_dwordx4 v[124:127], v44, s[12:15], s44 offen sc1
    s_waitcnt vmcnt(0)
    v_bitop3_b32 v12, v123, v127, s76 bitop3:0x7e
    v_cmp_lt_u32 vcc, 0xffff, v12
    s_cbranch_vccnz L_slow5_1
    s_branch L_back5_1
L_slow2_0:
    s_mov_b32 s22, 2
    s_call_b64 s[20:21], L_tick
    buffer_load_dwordx4 v[48:51], v32, s[12:15], s41 offen sc1
    buffer_load_dwordx4 v[52:55], v33, s[12:15], s41 offen sc1
    s_waitcnt vmcnt(0)
    v_bitop3_b32 v12, v51, v55, s76 bitop3:0x7e
    v_cmp_lt_u32 vcc, 0xffff, v12
    s_cbranch_vccnz L_slow2_0
    s_branch L_back2_0
L_slow2_1:
    s_mov_b32 s22, 2
    s_call_b64 s[20:21], L_tick
    buffer_load_dwordx4 v[64:67], v34, s[12:15], s41 offen sc1
    buffer_load_dwordx4 v[68:71], v44, s[12:15], s41 offen sc1
    s_waitcnt vmcnt(0)
    v_bitop3_b32 v12, v67, v71, s76 bitop3:0x7e
    v_cmp_lt_u32 vcc, 0xffff, v12
    s_cbranch_vccnz L_slow2_1
    s_branch L_back2_1
L_slow6_0:
    s_mov_b32 s22, 6
    s_call_b64 s[20:21], L_tick
    buffer_load_dwordx4 v[88:91], v32, s[12:15], s45 offen sc1
    buffer_load_dwordx4 v[92:95], v33, s[12:15], s45 offen sc1
    s_waitcnt vmcnt(0)
    v_bitop3_b32 v12, v91, v95, s76 bitop3:0x7e
    v_cmp_lt_u32 vcc, 0xffff, v12
    s_cbranch_vccnz L_slow6_0
    s_branch L_back6_0
L_slow6_1:
    s_mov_b32 s22, 6
    s_call_b64 s[20:21], L_tick
    buffer_load_dwordx4 v[48:51], v34, s[12:15], s45 offen sc1
    buffer_load_dwordx4 v[52:55], v44, s[12:15], s45 offen sc1
    s_waitcnt vmcnt(0)
    v_bitop3_b32 v12, v51, v55, s76 bitop3:0x7e
    v_cmp_lt_u32 vcc, 0xffff, v12
    s_cbranch_vccnz L_slow6_1
    s_branch L_back6_1
L_slow3_0:
    s_mov_b32 s22, 3
    s_call_b64 s[20:21], L_tick
    buffer_load_dwordx4 v[72:75], v32, s[12:15], s42 offen sc1
    buffer_load_dwordx4 v[76:79], v33, s[12:15], s42 offen sc1
    s_waitcnt vmcnt(0)
    v_bitop3_b32 v12, v75, v79, s76 bitop3:0x7e
    v_cmp_lt_u32 vcc, 0xffff, v12
    s_cbranch_vccnz L_slow3_0
    s_branch L_back3_0
L_slow3_1:
    s_mov_b32 s22, 3
    s_call_b64 s[20:21], L_tick
    buffer_load_dwordx4 v[100:103], v34, s[12:15], s42 offen sc1
    buffer_load_dwordx4 v[80:83], v44, s[12:15], s42 offen sc1
    s_waitcnt vmcnt(0)
    v_bitop3_b32 v12, v103, v83, s76 bitop3:0x7e
    v_cmp_lt_u32 vcc, 0xffff, v12
    s_cbranch_vccnz L_slow3_1
    s_branch L_back3_1
L_slow7_0:
    s_mov_b32 s22, 7
    s_call_b64 s[20:21], L_tick
    buffer_load_dwordx4 v[68:71], v32, s[12:15], s72 offen sc1
    buffer_load_dwordx4 v[72:75], v33, s[12:15], s72 offen sc1
    s_waitcnt vmcnt(0)
    v_bitop3_b32 v12, v71, v75, s76 bitop3:0x7e
    v_cmp_lt_u32 vcc, 0xffff, v12
    s_cbranch_vccnz L_slow7_0
    s_branch L_back7_0
L_slow7_1:
    s_mov_b32 s22, 7
    s_call_b64 s[20:21], L_tick
    buffer_load_dwordx4 v[76:79], v34, s[12:15], s72 offen sc1
    buffer_load_dwordx4 v[100:103], v44, s[12:15], s72 offen sc1
    s_waitcnt vmcnt(0)
    v_bitop3_b32 v12, v79, v103, s76 bitop3:0x7e
    v_cmp_lt_u32 vcc, 0xffff, v12
    s_cbranch_vccnz L_slow7_1
    s_branch L_back7_1
.p2align 12
L_main:
L_pad0:
    s_cbranch_execz L_pad1
    s_waitcnt lgkmcnt(8)
    v_mfma_f32_16x16x32_bf16 v[128:131], a[32:35], a[0:3], 0
    s_waitcnt lgkmcnt(4)
    s_mov_b32 s40, 16384
    ds_read_b32 a68, v29
    v_mfma_f32_16x16x32_bf16 v[128:131], a[36:39], a[4:7], v[128:131]
    buffer_load_dwordx4 v[80:83], v32, s[12:15], s40 offen sc1
    v_mfma_f32_16x16x32_bf16 v[132:135], a[36:39], a[12:15], 0
    s_add_u32 m0, s57, 65536
    ds_read_b32 a69, v31
    v_perm_b32 v46, v69, v35, s38
    v_mfma_f32_16x16x32_bf16 v[132:135], a[32:35], a[8:11], v[132:135]
    s_add_u32 s56, s55, 256
    ds_read_b32 a70, v46
    v_perm_b32 v56, v69, v35, s39
    v_mfma_f32_16x16x32_bf16 v[136:139], a[32:35], a[16:19], 0
    s_add_u32 s3, s69, 256
    ds_read_b32 a71, v56
    v_mfma_f32_16x16x32_bf16 v[136:139], a[36:39], a[20:23], v[136:139]
    buffer_load_dwordx4 v[84:87], v33, s[12:15], s40 offen sc1
    v_mfma_f32_16x16x32_bf16 v[140:143], a[36:39], a[28:31], 0
    v_perm_b32 v57, v66, v35, s36
    v_perm_b32 v58, v66, v35, s37
    v_mfma_f32_16x16x32_bf16 v[140:143], a[32:35], a[24:27], v[140:143]
    ds_read_b32 a80, v57
    v_perm_b32 v59, v66, v35, s38
    v_mfma_f32_16x16x32_bf16 v[144:147], a[32:35], a[40:43], 0
    ds_read_b32 a81, v58
    v_mfma_f32_16x16x32_bf16 v[144:147], a[36:39], a[44:47], v[144:147]
    buffer_load_dwordx4 v36, s[8:11], s56 offen offset:0  lds
    v_mfma_f32_16x16x32_bf16 v[148:151], a[36:39], a[52:55], 0
    ds_read_b32 a82, v59
    v_perm_b32 v60, v66, v35, s39
    v_mfma_f32_16x16x32_bf16 v[148:151], a[32:35], a[48:51], v[148:151]
    v_perm_b32 v61, v70, v35, s36
    v_perm_b32 v62, v70, v35, s37
    v_mfma_f32_16x16x32_bf16 v[152:155], a[32:35], a[56:59], 0
    s_mov_b32 s41, 32768
    ds_read_b32 a83, v60
    ds_read_b32 a84, v61
    v_mfma_f32_16x16x32_bf16 v[152:155], a[36:39], a[60:63], v[152:155]
    buffer_load_dwordx4 v37, s[8:11], s56 offen offset:1024  lds
    v_mfma_f32_16x16x32_bf16 v[156:159], a[36:39], a[76:79], 0
    ds_read_b32 a85, v62
    v_perm_b32 v63, v70, v35, s38
    v_mfma_f32_16x16x32_bf16 v[156:159], a[32:35], a[72:75], v[156:159]
    s_waitcnt lgkmcnt(6)
    ds_read_b32 a86, v63
    v_perm_b32 v5, v70, v35, s39
    v_mfma_f32_16x16x32_bf16 v[160:163], a[64:67], a[0:3], 0
    ds_read_b32 a87, v5
    v_mfma_f32_16x16x32_bf16 v[160:163], a[68:71], a[4:7], v[160:163]
    buffer_load_dwordx4 v38, s[8:11], s56 offen offset:2048  lds
    v_mfma_f32_16x16x32_bf16 v[164:167], a[68:71], a[12:15], 0
    v_perm_b32 v6, v67, v35, s36
    v_perm_b32 v7, v67, v35, s37
    v_mfma_f32_16x16x32_bf16 v[164:167], a[64:67], a[8:11], v[164:167]
    ds_read_b32 a88, v6
    v_perm_b32 v27, v71, v35, s36
    v_mfma_f32_16x16x32_bf16 v[168:171], a[64:67], a[16:19], 0
    ds_read_b32 a89, v7
    v_mfma_f32_16x16x32_bf16 v[168:171], a[68:71], a[20:23], v[168:171]
    buffer_load_dwordx4 v39, s[8:11], s56 offen offset:3072  lds
    v_mfma_f32_16x16x32_bf16 v[172:175], a[68:71], a[28:31], 0
    s_add_u32 m0, s57, 81920
    ds_read_b32 a90, v27
    v_perm_b32 v29, v71, v35, s37
    v_mfma_f32_16x16x32_bf16 v[172:175], a[64:67], a[24:27], v[172:175]
    s_add_u32 s56, s55, 512
    ds_read_b32 a91, v29
    v_mfma_f32_16x16x32_bf16 v[176:179], a[64:67], a[40:43], 0
    s_waitcnt vmcnt(6)
    s_mov_b32 s42, 49152
    v_bitop3_b32 v31, v75, v79, s76 bitop3:0x7e
    v_mfma_f32_16x16x32_bf16 v[176:179], a[68:71], a[44:47], v[176:179]
    buffer_load_dwordx4 v[88:91], v34, s[12:15], s40 offen sc1
    v_mfma_f32_16x16x32_bf16 v[180:183], a[68:71], a[52:55], 0
    v_cmp_lt_u32 vcc, 0xffff, v31
    v_mfma_f32_16x16x32_bf16 v[180:183], a[64:67], a[48:51], v[180:183]
    v_mfma_f32_16x16x32_bf16 v[184:187], a[64:67], a[56:59], 0
    s_cbranch_vccnz L_slow0_1
L_back0_1:
    v_mfma_f32_16x16x32_bf16 v[184:187], a[68:71], a[60:63], v[184:187]
    buffer_load_dwordx4 v[92:95], v44, s[12:15], s40 offen sc1
    v_mfma_f32_16x16x32_bf16 v[188:191], a[68:71], a[76:79], 0
    v_perm_b32 v46, v72, v35, s36
    v_perm_b32 v56, v72, v35, s37
    v_mfma_f32_16x16x32_bf16 v[188:191], a[64:67], a[72:75], v[188:191]
    s_waitcnt lgkmcnt(1)
    ds_read_b32 a96, v46
    v_perm_b32 v57, v72, v35, s38
    v_mfma_f32_16x16x32_bf16 v[192:195], a[80:83], a[0:3], 0
    s_barrier
    v_mfma_f32_16x16x32_bf16 v[192:195], a[84:87], a[4:7], v[192:195]
    buffer_load_dwordx4 v36, s[8:11], s3 offen offset:0  lds
    v_mfma_f32_16x16x32_bf16 v[196:199], a[84:87], a[12:15], 0
    ds_read_b32 a97, v56
    v_perm_b32 v58, v72, v35, s39
    v_mfma_f32_16x16x32_bf16 v[196:199], a[80:83], a[8:11], v[196:199]
    ds_read_b32 a98, v57
    ds_read_b32 a99, v58
    v_mfma_f32_16x16x32_bf16 v[200:203], a[80:83], a[16:19], 0
    s_mov_b32 s43, 65536
    ds_read_b128 a[104:107], v40 offset:49152
    v_mfma_f32_16x16x32_bf16 v[200:203], a[84:87], a[20:23], v[200:203]
    buffer_load_dwordx4 v37, s[8:11], s3 offen offset:1024  lds
    v_mfma_f32_16x16x32_bf16 v[204:207], a[84:87], a[28:31], 0
    ds_read_b128 a[108:111], v41 offset:49152
    v_perm_b32 v59, v76, v35, s36
    v_mfma_f32_16x16x32_bf16 v[204:207], a[80:83], a[24:27], v[204:207]
    ds_read_b32 a100, v59
    v_perm_b32 v60, v76, v35, s37
    v_mfma_f32_16x16x32_bf16 v[208:211], a[80:83], a[40:43], 0
    ds_read_b32 a101, v60
    ds_read_b128 a[112:115], v40 offset:51200
    v_mfma_f32_16x16x32_bf16 v[208:211], a[84:87], a[44:47], v[208:211]
    buffer_load_dwordx4 v38, s[8:11], s3 offen offset:2048  lds
    v_mfma_f32_16x16x32_bf16 v[212:215], a[84:87], a[52:55], 0
    ds_read_b128 a[116:119], v41 offset:51200
    v_perm_b32 v61, v76, v35, s38
    v_mfma_f32_16x16x32_bf16 v[212:215], a[80:83], a[48:51], v[212:215]
    ds_read_b32 a102, v61
    v_perm_b32 v62, v76, v35, s39
    v_mfma_f32_16x16x32_bf16 v[216:219], a[80:83], a[56:59], 0
    ds_read_b32 a103, v62
    v_perm_b32 v63, v73, v35, s36
    v_mfma_f32_16x16x32_bf16 v[216:219], a[84:87], a[60:63], v[216:219]
    ds_read_b32 a120, v63
    v_perm_b32 v5, v73, v35, s37
    v_mfma_f32_16x16x32_bf16 v[220:223], a[84:87], a[76:79], 0
    ds_read_b128 a[128:131], v40 offset:53248
    ds_read_b32 a121, v5
    v_mfma_f32_16x16x32_bf16 v[220:223], a[80:83], a[72:75], v[220:223]
    s_waitcnt lgkmcnt(9)
    ds_read_b128 a[132:135], v41 offset:53248
    v_mfma_f32_16x16x32_bf16 v[224:227], a[88:91], a[2:5], 0
    buffer_load_dwordx4 v39, s[8:11], s3 offen offset:3072  lds
    v_mfma_f32_16x16x32_bf16 v[228:231], a[88:91], a[10:13], 0
    s_add_u32 m0, s57, 0
    ds_read_b128 a[136:139], v40 offset:55296
    v_perm_b32 v6, v73, v35, s38
    v_mfma_f32_16x16x32_bf16 v[232:235], a[88:91], a[18:21], 0
    s_add_u32 s3, s69, 512
    ds_read_b128 a[140:143], v41 offset:55296
    v_perm_b32 v7, v73, v35, s39
    v_mfma_f32_16x16x32_bf16 v[236:239], a[88:91], a[26:29], 0
    s_mov_b32 s44, 81920
    ds_read_b32 a122, v6
    ds_read_b32 a123, v7
    v_mfma_f32_16x16x32_bf16 v[240:243], a[88:91], a[42:45], 0
    ds_read_b128 a[144:147], v40 offset:57344
    v_mfma_f32_16x16x32_bf16 v[244:247], a[88:91], a[50:53], 0
    buffer_load_dwordx3 v[96:98], v18, s[4:7], s61 offen nt
    v_mfma_f32_16x16x32_bf16 v[248:251], a[88:91], a[58:61], 0
    ds_read_b128 a[148:151], v41 offset:57344
    v_perm_b32 v27, v77, v35, s36
    v_mfma_f32_16x16x32_bf16 v[252:255], a[88:91], a[74:77], 0
    ds_read_b128 a[156:159], v41 offset:59392
    v_perm_b32 v29, v77, v35, s37
    v_mfma_f32_16x16x32_bf16 v[128:131], a[96:99], a[104:107], v[128:131]
    s_waitcnt lgkmcnt(7)
    ds_read_b128 a[152:155], v40 offset:59392
    ds_read_b32 a124, v27
    v_mfma_f32_16x16x32_bf16 v[128:131], a[100:103], a[108:111], v[128:131]
    buffer_load_dword v99, v19, s[4:7], s61 offen nt
    v_mfma_f32_16x16x32_bf16 v[132:135], a[100:103], a[116:119], v[132:135]
    s_add_u32 s61, s61, 14336
    ds_read_b128 a[160:163], v40 offset:61440
    v_perm_b32 v31, v77, v35, s38
    v_mfma_f32_16x16x32_bf16 v[132:135], a[96:99], a[112:115], v[132:135]
    s_waitcnt lgkmcnt(8)
    ds_read_b128 a[164:167], v41 offset:61440
    v_perm_b32 v46, v77, v35, s39
    v_mfma_f32_16x16x32_bf16 v[136:139], a[96:99], a[128:131], v[136:139]
    s_mov_b32 s45, 98304
    ds_read_b32 a125, v29
    ds_read_b32 a126, v31
    v_mfma_f32_16x16x32_bf16 v[136:139], a[100:103], a[132:135], v[136:139]
    buffer_load_dwordx3 v[100:102], v18, s[4:7], s61 offen nt
    v_mfma_f32_16x16x32_bf16 v[140:143], a[100:103], a[140:143], v[140:143]
    s_waitcnt vmcnt(13)
    ds_read_b128 a[168:171], v40 offset:63488
    v_bitop3_b32 v56, v83, v87, s76 bitop3:0x7e
    v_mfma_f32_16x16x32_bf16 v[140:143], a[96:99], a[136:139], v[140:143]
    s_waitcnt lgkmcnt(8)
    ds_read_b128 a[172:175], v41 offset:63488
    ds_read_b32 a127, v46
    v_mfma_f32_16x16x32_bf16 v[144:147], a[96:99], a[144:147], v[144:147]
    s_waitcnt lgkmcnt(8)
    v_perm_b32 v57, v74, v35, s36
    v_mfma_f32_16x16x32_bf16 v[144:147], a[100:103], a[148:151], v[144:147]
    buffer_load_dword v103, v19, s[4:7], s61 offen nt
    v_mfma_f32_16x16x32_bf16 v[148:151], a[100:103], a[156:159], v[148:151]
    s_add_u32 s61, s61, 14336
    ds_read_b32 a176, v57
    v_perm_b32 v58, v74, v35, s37
    v_mfma_f32_16x16x32_bf16 v[148:151], a[96:99], a[152:155], v[148:151]
    s_waitcnt lgkmcnt(7)
    v_cmp_lt_u32 vcc, 0xffff, v56
    v_perm_b32 v59, v74, v35, s38
    v_mfma_f32_16x16x32_bf16 v[152:155], a[96:99], a[160:163], v[152:155]
    s_waitcnt lgkmcnt(6)
    ds_read_b32 a177, v58
    ds_read_b32 a178, v59
    v_mfma_f32_16x16x32_bf16 v[152:155], a[100:103], a[164:167], v[152:155]
    s_waitcnt lgkmcnt(4)
    buffer_load_dwordx3 v[104:106], v18, s[4:7], s61 offen nt
    v_mfma_f32_16x16x32_bf16 v[156:159], a[100:103], a[172:175], v[156:159]
    v_perm_b32 v60, v74, v35, s39
    s_cbranch_vccnz L_slow1_0
L_back1_0:
    v_mfma_f32_16x16x32_bf16 v[156:159], a[96:99], a[168:171], v[156:159]
    s_waitcnt lgkmcnt(3)
    v_perm_b32 v61, v78, v35, s36
    v_perm_b32 v62, v78, v35, s37
    v_mfma_f32_16x16x32_bf16 v[160:163], a[120:123], a[104:107], v[160:163]
    s_mov_b32 s72, 114688
    ds_read_b32 a179, v60
    ds_read_b32 a180, v61
    v_mfma_f32_16x16x32_bf16 v[160:163], a[124:127], a[108:111], v[160:163]
    buffer_load_dword v107, v19, s[4:7], s61 offen nt
    v_mfma_f32_16x16x32_bf16 v[164:167], a[124:127], a[116:119], v[164:167]
    s_add_u32 s61, s61, 14336
    ds_read_b32 a181, v62
    v_perm_b32 v63, v78, v35, s38
    v_mfma_f32_16x16x32_bf16 v[164:167], a[120:123], a[112:115], v[164:167]
    v_perm_b32 v5, v78, v35, s39
    v_perm_b32 v6, v75, v35, s36
    v_mfma_f32_16x16x32_bf16 v[168:171], a[120:123], a[128:131], v[168:171]
    ds_read_b32 a182, v63
    ds_read_b32 a183, v5
    v_mfma_f32_16x16x32_bf16 v[168:171], a[124:127], a[132:135], v[168:171]
    buffer_load_dwordx3 v[108:110], v18, s[4:7], s61 offen nt
    v_mfma_f32_16x16x32_bf16 v[172:175], a[124:127], a[140:143], v[172:175]
    ds_read_b32 a92, v6
    v_perm_b32 v7, v75, v35, s37
    v_mfma_f32_16x16x32_bf16 v[172:175], a[120:123], a[136:139], v[172:175]
    v_perm_b32 v27, v79, v35, s36
    v_perm_b32 v29, v79, v35, s37
    v_mfma_f32_16x16x32_bf16 v[176:179], a[120:123], a[144:147], v[176:179]
    ds_read_b32 a93, v7
    ds_read_b32 a94, v27
    v_mfma_f32_16x16x32_bf16 v[176:179], a[124:127], a[148:151], v[176:179]
    buffer_load_dword v111, v19, s[4:7], s61 offen nt
    v_mfma_f32_16x16x32_bf16 v[180:183], a[124:127], a[156:159], v[180:183]
    s_add_u32 s61, s61, 14336
    ds_read_b32 a95, v29
    v_perm_b32 v31, v80, v35, s36
    v_mfma_f32_16x16x32_bf16 v[180:183], a[120:123], a[152:155], v[180:183]
    v_perm_b32 v46, v80, v35, s37
    v_perm_b32 v57, v80, v35, s38
    v_mfma_f32_16x16x32_bf16 v[184:187], a[120:123], a[160:163], v[184:187]
    ds_read_b32 a184, v31
    ds_read_b32 a185, v46
    v_mfma_f32_16x16x32_bf16 v[184:187], a[124:127], a[164:167], v[184:187]
    buffer_load_dwordx3 v[112:114], v18, s[4:7], s61 offen nt
    v_mfma_f32_16x16x32_bf16 v[188:191], a[124:127], a[172:175], v[188:191]
    s_mul_i32 s66, s63, 96
    s_lshl_b32 s67, s65, 5
    s_lshl_b32 s70, s64, 2
    s_add_u32 s67, s67, s70
    s_add_u32 s67, s67, 384
    s_mul_i32 s71, s59, 448
    s_add_u32 s70, s66, s71
    v_mad_u32_u24 v22, v3, 24, s70
    s_add_u32 s70, s67, s71
    v_lshl_add_u32 v23, v3, 3, s70
    s_mov_b32 s34, 7168
    s_mov_b32 s35, 0x20000
    s_mov_b32 s26, 256
    s_mov_b32 s27, 0x20000
    s_lshl_b32 s77, s59, 4
    s_mov_b32 s18, 14680064
    s_mov_b32 s19, 0x20000
    s_sub_u32 s70, 1024, s71
    v_mul_u32_u24 v16, 464, v4
    v_add3_u32 v26, v22, v16, s70
    v_add3_u32 v28, v23, v16, s70
    s_lshl_b32 s70, s63, 9
    s_add_u32 s60, s70, 52992
    s_xor_b32 s70, s70, 512
    s_add_u32 s70, s70, 52992
    v_lshl_add_u32 v30, v2, 2, s70
    v_mul_u32_u24 v16, 2341, v2
    v_lshrrev_b32 v16, 16, v16
    s_mul_i32 s73, s63, 1856
    s_add_u32 s73, s73, 1024
    v_add_lshl_u32 v24, v2, v16, 4
    v_add_u32 v24, s73, v24
    s_lshl_b32 s74, s58, 7
    s_lshl_b32 s75, s63, 2
    s_add_u32 s74, s74, s75
    s_mul_i32 s74, s74, 7168
    s_add_u32 s74, s74, s71
    v_mul_u32_u24 v17, 6720, v16
    v_lshl_add_u32 v25, v2, 4, v17
    v_lshrrev_b32 v16, 1, v16
    v_lshlrev_b32 v16, 30, v16
    v_add3_u32 v25, v25, v16, s74
    v_mov_b32 v45, 1
    v_lshlrev_b32 v1, 22, v0
    v_mov_b32 v47, s76
    v_mfma_f32_16x16x32_bf16 v[188:191], a[120:123], a[168:171], v[188:191]
    s_waitcnt vmcnt(15) lgkmcnt(5)
    s_add_u32 s61, s61, 14336
    ds_read_b32 a186, v57
    v_perm_b32 v56, v80, v35, s39
    v_mfma_f32_16x16x32_bf16 v[192:195], a[176:179], a[104:107], v[192:195]
    s_barrier
    v_mfma_f32_16x16x32_bf16 v[192:195], a[180:183], a[108:111], v[192:195]
    buffer_load_dwordx3 v[116:118], v18, s[4:7], s61 offen nt
    v_mfma_f32_16x16x32_bf16 v[196:199], a[180:183], a[116:119], v[196:199]
    s_add_u32 s61, s61, 14336
    ds_read_b32 a187, v56
    v_perm_b32 v58, v84, v35, s36
    v_mfma_f32_16x16x32_bf16 v[196:199], a[176:179], a[112:115], v[196:199]
    ds_read_b32 a188, v58
    ds_read_b128 a[192:195], v42 offset:0
    v_mfma_f32_16x16x32_bf16 v[200:203], a[176:179], a[128:131], v[200:203]
    ds_read_b128 a[196:199], v43 offset:0
    v_mfma_f32_16x16x32_bf16 v[200:203], a[180:183], a[132:135], v[200:203]
    buffer_load_dwordx3 v[120:122], v18, s[4:7], s61 offen nt
    v_mfma_f32_16x16x32_bf16 v[204:207], a[180:183], a[140:143], v[204:207]
    s_add_u32 s61, s61, 14336
    ds_read_b128 a[204:207], v43 offset:2048
    v_perm_b32 v59, v84, v35, s37
    v_mfma_f32_16x16x32_bf16 v[204:207], a[176:179], a[136:139], v[204:207]
    ds_read_b32 a189, v59
    ds_read_b128 a[200:203], v42 offset:2048
    v_perm_b32 v60, v84, v35, s38
    v_mfma_f32_16x16x32_bf16 v[208:211], a[176:179], a[144:147], v[208:211]
    ds_read_b32 a190, v60
    ds_read_b128 a[208:211], v42 offset:4096
    v_mfma_f32_16x16x32_bf16 v[208:211], a[180:183], a[148:151], v[208:211]
    buffer_load_dwordx3 v[124:126], v18, s[4:7], s61 offen nt
    v_mfma_f32_16x16x32_bf16 v[212:215], a[180:183], a[156:159], v[212:215]
    ds_read_b128 a[212:215], v43 offset:4096
    v_perm_b32 v61, v84, v35, s39
    v_mfma_f32_16x16x32_bf16 v[212:215], a[176:179], a[152:155], v[212:215]
    ds_read_b32 a191, v61
    ds_read_b128 a[220:223], v43 offset:6144
    v_mfma_f32_16x16x32_bf16 v[216:219], a[176:179], a[160:163], v[216:219]
    ds_read_b128 a[216:219], v42 offset:6144
    v_perm_b32 v62, v81, v35, s36
    v_mfma_f32_16x16x32_bf16 v[216:219], a[180:183], a[164:167], v[216:219]
    ds_read_b128 a[224:227], v42 offset:8192
    ds_read_b32 a232, v62
    v_mfma_f32_16x16x32_bf16 v[220:223], a[180:183], a[172:175], v[220:223]
    buffer_load_dwordx4 v[48:51], v32, s[12:15], s41 offen sc1
    v_mfma_f32_16x16x32_bf16 v[220:223], a[176:179], a[168:171], v[220:223]
    s_waitcnt lgkmcnt(10)
    ds_read_b128 a[228:231], v43 offset:8192
    v_perm_b32 v63, v81, v35, s37
    v_mfma_f32_16x16x32_bf16 v[224:227], a[92:95], a[106:109], v[224:227]
    ds_read_b128 a[244:247], v43 offset:10240
    ds_read_b32 a233, v63
    v_mfma_f32_16x16x32_bf16 v[228:231], a[92:95], a[114:117], v[228:231]
    ds_read_b128 a[240:243], v42 offset:10240
    v_perm_b32 v5, v81, v35, s38
    v_mfma_f32_16x16x32_bf16 v[232:235], a[92:95], a[130:133], v[232:235]
    ds_read_b128 a[248:251], v42 offset:12288
    ds_read_b32 a234, v5
    v_mfma_f32_16x16x32_bf16 v[236:239], a[92:95], a[138:141], v[236:239]
    buffer_load_dwordx4 v[52:55], v33, s[12:15], s41 offen sc1
    v_mfma_f32_16x16x32_bf16 v[240:243], a[92:95], a[146:149], v[240:243]
    v_perm_b32 v6, v81, v35, s39
    v_perm_b32 v7, v85, v35, s36
    v_mfma_f32_16x16x32_bf16 v[244:247], a[92:95], a[154:157], v[244:247]
    s_waitcnt vmcnt(10)
    ds_read_b128 a[252:255], v43 offset:12288
    ds_read_b32 a235, v6
    v_mfma_f32_16x16x32_bf16 v[248:251], a[92:95], a[162:165], v[248:251]
    v_lshl_or_b32 v96, v100, 4, v96
    v_lshl_or_b32 v97, v101, 4, v97
    v_lshl_or_b32 v98, v102, 4, v98
    v_lshl_or_b32 v99, v103, 4, v99
    v_mfma_f32_16x16x32_bf16 v[252:255], a[92:95], a[170:173], v[252:255]
    buffer_load_dwordx4 v36, s[8:11], s56 offen offset:0  lds
    v_mfma_f32_16x16x32_bf16 v[128:131], a[184:187], a[192:195], v[128:131]
    s_waitcnt lgkmcnt(7)
    ds_read_b32 a236, v7
    v_perm_b32 v27, v85, v35, s37
    v_mfma_f32_16x16x32_bf16 v[128:131], a[188:191], a[196:199], v[128:131]
    ds_read_b128 a[32:35], v42 offset:14336
    v_perm_b32 v31, v85, v35, s38
    v_bitop3_b32 v29, v91, v95, s76 bitop3:0x7e
    v_mfma_f32_16x16x32_bf16 v[132:135], a[188:191], a[204:207], v[132:135]
    ds_read_b128 a[36:39], v43 offset:14336
    v_perm_b32 v46, v85, v35, s39
    v_cmp_lt_u32 vcc, 0xffff, v29
    v_mfma_f32_16x16x32_bf16 v[132:135], a[184:187], a[200:203], v[132:135]
    ds_read_b32 a237, v27
    v_perm_b32 v57, v82, v35, s36
    v_mfma_f32_16x16x32_bf16 v[136:139], a[184:187], a[208:211], v[136:139]
    ds_read_b32 a238, v31
    v_perm_b32 v56, v82, v35, s37
    v_mfma_f32_16x16x32_bf16 v[136:139], a[188:191], a[212:215], v[136:139]
    ds_read_b32 a239, v46
    v_perm_b32 v58, v82, v35, s38
    v_mfma_f32_16x16x32_bf16 v[140:143], a[188:191], a[220:223], v[140:143]
    ds_read_b32 a64, v57
    v_perm_b32 v59, v82, v35, s39
    v_mfma_f32_16x16x32_bf16 v[140:143], a[184:187], a[216:219], v[140:143]
    ds_read_b32 a65, v56
    v_perm_b32 v60, v86, v35, s36
    v_mfma_f32_16x16x32_bf16 v[144:147], a[184:187], a[224:227], v[144:147]
    s_waitcnt lgkmcnt(8)
    ds_read_b32 a66, v58
    ds_read_b32 a67, v59
    v_mfma_f32_16x16x32_bf16 v[144:147], a[188:191], a[228:231], v[144:147]
    buffer_load_dwordx4 v37, s[8:11], s56 offen offset:1024  lds
    v_mfma_f32_16x16x32_bf16 v[148:151], a[188:191], a[244:247], v[148:151]
    ds_read_b32 a68, v60
    s_cbranch_vccnz L_slow1_1
L_back1_1:
    v_mfma_f32_16x16x32_bf16 v[148:151], a[184:187], a[240:243], v[148:151]
    v_perm_b32 v61, v86, v35, s37
    v_perm_b32 v62, v86, v35, s38
    v_mfma_f32_16x16x32_bf16 v[152:155], a[184:187], a[248:251], v[152:155]
    s_waitcnt lgkmcnt(7)
    ds_read_b32 a69, v61
    ds_read_b32 a70, v62
    v_mfma_f32_16x16x32_bf16 v[152:155], a[188:191], a[252:255], v[152:155]
    buffer_load_dwordx4 v38, s[8:11], s56 offen offset:2048  lds
    v_mfma_f32_16x16x32_bf16 v[156:159], a[188:191], a[36:39], v[156:159]
    v_perm_b32 v63, v86, v35, s39
    v_perm_b32 v5, v83, v35, s36
    v_mfma_f32_16x16x32_bf16 v[156:159], a[184:187], a[32:35], v[156:159]
    ds_read_b32 a71, v63
    v_perm_b32 v6, v83, v35, s37
    v_mfma_f32_16x16x32_bf16 v[160:163], a[232:235], a[192:195], v[160:163]
    s_waitcnt lgkmcnt(6)
    ds_read_b32 a80, v5
    ds_read_b32 a81, v6
    v_mfma_f32_16x16x32_bf16 v[160:163], a[236:239], a[196:199], v[160:163]
    buffer_load_dwordx4 v39, s[8:11], s56 offen offset:3072  lds
    v_mfma_f32_16x16x32_bf16 v[164:167], a[236:239], a[204:207], v[164:167]
    s_add_u32 m0, s57, 16384
    v_perm_b32 v7, v87, v35, s36
    v_perm_b32 v29, v87, v35, s37
    v_mfma_f32_16x16x32_bf16 v[164:167], a[232:235], a[200:203], v[164:167]
    s_add_u32 s56, s55, 768
    ds_read_b32 a82, v7
    v_perm_b32 v27, v88, v35, s36
    v_mfma_f32_16x16x32_bf16 v[168:171], a[232:235], a[208:211], v[168:171]
    ds_read_b32 a83, v29
    v_perm_b32 v31, v88, v35, s37
    v_mfma_f32_16x16x32_bf16 v[168:171], a[236:239], a[212:215], v[168:171]
    ds_read_b32 a0, v27
    v_perm_b32 v46, v88, v35, s38
    v_mfma_f32_16x16x32_bf16 v[172:175], a[236:239], a[220:223], v[172:175]
    ds_read_b32 a1, v31
    v_perm_b32 v57, v88, v35, s39
    v_mfma_f32_16x16x32_bf16 v[172:175], a[232:235], a[216:219], v[172:175]
    ds_read_b32 a2, v46
    v_perm_b32 v56, v92, v35, s36
    v_mfma_f32_16x16x32_bf16 v[176:179], a[232:235], a[224:227], v[176:179]
    ds_read_b32 a3, v57
    ds_read_b32 a4, v56
    v_mfma_f32_16x16x32_bf16 v[176:179], a[236:239], a[228:231], v[176:179]
    buffer_load_dwordx4 v[64:67], v34, s[12:15], s41 offen sc1
    v_mfma_f32_16x16x32_bf16 v[180:183], a[236:239], a[244:247], v[180:183]
    v_perm_b32 v58, v92, v35, s37
    v_perm_b32 v59, v92, v35, s38
    v_mfma_f32_16x16x32_bf16 v[180:183], a[232:235], a[240:243], v[180:183]
    ds_read_b32 a5, v58
    v_perm_b32 v60, v92, v35, s39
    v_mfma_f32_16x16x32_bf16 v[184:187], a[232:235], a[248:251], v[184:187]
    ds_read_b32 a6, v59
    ds_read_b32 a7, v60
    v_mfma_f32_16x16x32_bf16 v[184:187], a[236:239], a[252:255], v[184:187]
    buffer_load_dwordx4 v[68:71], v44, s[12:15], s41 offen sc1
    v_mfma_f32_16x16x32_bf16 v[188:191], a[236:239], a[36:39], v[188:191]
    v_perm_b32 v61, v89, v35, s36
    v_perm_b32 v62, v89, v35, s37
    v_mfma_f32_16x16x32_bf16 v[188:191], a[232:235], a[32:35], v[188:191]
    s_waitcnt lgkmcnt(6)
    ds_read_b32 a8, v61
    v_perm_b32 v63, v89, v35, s38
    v_mfma_f32_16x16x32_bf16 v[192:195], a[64:67], a[192:195], v[192:195]
    s_barrier
    v_mfma_f32_16x16x32_bf16 v[192:195], a[68:71], a[196:199], v[192:195]
    buffer_load_dwordx4 v[72:75], v32, s[12:15], s42 offen sc1
    v_mfma_f32_16x16x32_bf16 v[196:199], a[68:71], a[204:207], v[196:199]
    ds_read_b32 a9, v62
    v_perm_b32 v5, v89, v35, s39
    v_mfma_f32_16x16x32_bf16 v[196:199], a[64:67], a[200:203], v[196:199]
    ds_read_b32 a10, v63
    ds_read_b32 a11, v5
    v_mfma_f32_16x16x32_bf16 v[200:203], a[64:67], a[208:211], v[200:203]
    ds_read_b128 a[16:19], v42 offset:16384
    v_mfma_f32_16x16x32_bf16 v[200:203], a[68:71], a[212:215], v[200:203]
    buffer_load_dwordx4 v[76:79], v33, s[12:15], s42 offen sc1
    v_mfma_f32_16x16x32_bf16 v[204:207], a[68:71], a[220:223], v[204:207]
    ds_read_b128 a[20:23], v43 offset:16384
    v_perm_b32 v6, v93, v35, s36
    v_mfma_f32_16x16x32_bf16 v[204:207], a[64:67], a[216:219], v[204:207]
    ds_read_b32 a12, v6
    v_perm_b32 v7, v93, v35, s37
    v_mfma_f32_16x16x32_bf16 v[208:211], a[64:67], a[224:227], v[208:211]
    ds_read_b32 a13, v7
    v_perm_b32 v29, v93, v35, s38
    v_mfma_f32_16x16x32_bf16 v[208:211], a[68:71], a[228:231], v[208:211]
    ds_read_b32 a14, v29
    ds_read_b128 a[24:27], v42 offset:18432
    v_mfma_f32_16x16x32_bf16 v[212:215], a[68:71], a[244:247], v[212:215]
    buffer_load_dwordx4 v36, s[8:11], s3 offen offset:0  lds
    v_mfma_f32_16x16x32_bf16 v[212:215], a[64:67], a[240:243], v[212:215]
    ds_read_b128 a[28:31], v43 offset:18432
    v_perm_b32 v27, v93, v35, s39
    v_mfma_f32_16x16x32_bf16 v[216:219], a[64:67], a[248:251], v[216:219]
    ds_read_b32 a15, v27
    v_perm_b32 v31, v90, v35, s36
    v_mfma_f32_16x16x32_bf16 v[216:219], a[68:71], a[252:255], v[216:219]
    s_waitcnt vmcnt(16)
    ds_read_b32 a48, v31
    ds_read_b128 a[40:43], v42 offset:20480
    v_mfma_f32_16x16x32_bf16 v[220:223], a[68:71], a[36:39], v[220:223]
    buffer_load_dwordx4 v37, s[8:11], s3 offen offset:1024  lds
    v_mfma_f32_16x16x32_bf16 v[220:223], a[64:67], a[32:35], v[220:223]
    v_lshl_or_b32 v96, v104, 8, v96
    v_lshl_or_b32 v97, v105, 8, v97
    v_lshl_or_b32 v98, v106, 8, v98
    v_lshl_or_b32 v99, v107, 8, v99
    v_lshl_or_b32 v96, v108, 12, v96
    v_lshl_or_b32 v97, v109, 12, v97
    v_lshl_or_b32 v98, v110, 12, v98
    s_waitcnt vmcnt(16)
    v_lshl_or_b32 v99, v111, 12, v99
    v_mov_b32_sdwa v99, s76 dst_sel:WORD_1 dst_unused:UNUSED_PRESERVE src0_sel:WORD_1
    s_waitcnt vmcnt(15)
    v_lshl_or_b32 v96, v112, 16, v96
    v_lshl_or_b32 v97, v113, 16, v97
    v_lshl_or_b32 v98, v114, 16, v98
    s_waitcnt vmcnt(14)
    v_lshl_or_b32 v96, v116, 20, v96
    v_lshl_or_b32 v97, v117, 20, v97
    v_lshl_or_b32 v98, v118, 20, v98
    s_waitcnt vmcnt(13)
    v_lshl_or_b32 v96, v120, 24, v96
    v_lshl_or_b32 v97, v121, 24, v97
L_pad1:
    s_cbranch_execz L_pad2
    v_lshl_or_b32 v98, v122, 24, v98
    s_waitcnt vmcnt(12)
    v_lshl_or_b32 v96, v124, 28, v96
    v_lshl_or_b32 v97, v125, 28, v97
    v_lshl_or_b32 v98, v126, 28, v98
    buffer_store_dwordx4 v[96:99], v20, s[12:15], s62 offen sc1
    v_mfma_f32_16x16x32_bf16 v[224:227], a[80:83], a[194:197], v[224:227]
    s_waitcnt vmcnt(11)
    ds_read_b128 a[44:47], v43 offset:20480
    v_perm_b32 v57, v90, v35, s37
    v_bitop3_b32 v46, v51, v55, s76 bitop3:0x7e
    v_mfma_f32_16x16x32_bf16 v[228:231], a[80:83], a[202:205], v[228:231]
    ds_read_b32 a49, v57
    v_perm_b32 v56, v90, v35, s38
    v_cmp_lt_u32 vcc, 0xffff, v46
    v_mfma_f32_16x16x32_bf16 v[232:235], a[80:83], a[210:213], v[232:235]
    ds_read_b128 a[60:63], v43 offset:22528
    ds_read_b32 a50, v56
    v_mfma_f32_16x16x32_bf16 v[236:239], a[80:83], a[218:221], v[236:239]
    buffer_load_dwordx4 v38, s[8:11], s3 offen offset:2048  lds
    v_mfma_f32_16x16x32_bf16 v[240:243], a[80:83], a[226:229], v[240:243]
    ds_read_b128 a[56:59], v42 offset:22528
    s_cbranch_vccnz L_slow2_0
L_back2_0:
    v_mfma_f32_16x16x32_bf16 v[244:247], a[80:83], a[242:245], v[244:247]
    ds_read_b128 a[72:75], v42 offset:24576
    v_perm_b32 v58, v90, v35, s39
    v_mfma_f32_16x16x32_bf16 v[248:251], a[80:83], a[250:253], v[248:251]
    s_waitcnt lgkmcnt(6)
    ds_read_b128 a[76:79], v43 offset:24576
    ds_read_b32 a51, v58
    v_mfma_f32_16x16x32_bf16 v[252:255], a[80:83], a[34:37], v[252:255]
    buffer_load_dwordx4 v39, s[8:11], s3 offen offset:3072  lds
    v_mfma_f32_16x16x32_bf16 v[128:131], a[0:3], a[16:19], v[128:131]
    s_add_u32 m0, s57, 32768
    ds_read_b128 a[100:103], v43 offset:26624
    v_perm_b32 v59, v94, v35, s36
    v_mfma_f32_16x16x32_bf16 v[128:131], a[4:7], a[20:23], v[128:131]
    s_add_u32 s3, s69, 768
    ds_read_b128 a[96:99], v42 offset:26624
    v_perm_b32 v60, v94, v35, s37
    v_mfma_f32_16x16x32_bf16 v[132:135], a[4:7], a[28:31], v[132:135]
    ds_read_b128 a[120:123], v42 offset:28672
    ds_read_b32 a52, v59
    v_mfma_f32_16x16x32_bf16 v[132:135], a[0:3], a[24:27], v[132:135]
    buffer_load_dwordx4 v36, s[8:11], s56 offen offset:0  lds
    v_mfma_f32_16x16x32_bf16 v[136:139], a[0:3], a[40:43], v[136:139]
    s_waitcnt lgkmcnt(8)
    ds_read_b128 a[124:127], v43 offset:28672
    v_perm_b32 v61, v94, v35, s38
    v_mfma_f32_16x16x32_bf16 v[136:139], a[4:7], a[44:47], v[136:139]
    ds_read_b128 a[176:179], v42 offset:30720
    v_perm_b32 v62, v94, v35, s39
    v_mfma_f32_16x16x32_bf16 v[140:143], a[4:7], a[60:63], v[140:143]
    s_waitcnt lgkmcnt(8)
    ds_read_b32 a53, v60
    v_perm_b32 v63, v91, v35, s36
    v_mfma_f32_16x16x32_bf16 v[140:143], a[0:3], a[56:59], v[140:143]
    s_waitcnt lgkmcnt(7)
    ds_read_b128 a[180:183], v43 offset:30720
    ds_read_b32 a54, v61
    v_mfma_f32_16x16x32_bf16 v[144:147], a[0:3], a[72:75], v[144:147]
    buffer_load_dwordx4 v37, s[8:11], s56 offen offset:1024  lds
    v_mfma_f32_16x16x32_bf16 v[144:147], a[4:7], a[76:79], v[144:147]
    s_waitcnt lgkmcnt(8)
    ds_read_b32 a55, v62
    v_perm_b32 v5, v91, v35, s37
    v_mfma_f32_16x16x32_bf16 v[148:151], a[4:7], a[100:103], v[148:151]
    s_waitcnt lgkmcnt(8)
    ds_read_b32 a84, v63
    v_perm_b32 v6, v95, v35, s36
    v_mfma_f32_16x16x32_bf16 v[148:151], a[0:3], a[96:99], v[148:151]
    s_waitcnt lgkmcnt(7)
    ds_read_b32 a85, v5
    v_perm_b32 v7, v95, v35, s37
    v_mfma_f32_16x16x32_bf16 v[152:155], a[0:3], a[120:123], v[152:155]
    s_waitcnt lgkmcnt(7)
    ds_read_b32 a86, v6
    v_perm_b32 v29, v48, v35, s36
    v_mfma_f32_16x16x32_bf16 v[152:155], a[4:7], a[124:127], v[152:155]
    s_waitcnt lgkmcnt(5)
    ds_read_b32 a87, v7
    v_perm_b32 v27, v48, v35, s37
    v_mfma_f32_16x16x32_bf16 v[156:159], a[4:7], a[180:183], v[156:159]
    ds_read_b32 a104, v29
    v_perm_b32 v31, v48, v35, s38
    v_mfma_f32_16x16x32_bf16 v[156:159], a[0:3], a[176:179], v[156:159]
    s_waitcnt vmcnt(11)
    ds_read_b32 a105, v27
    v_perm_b32 v46, v48, v35, s39
    v_mfma_f32_16x16x32_bf16 v[160:163], a[8:11], a[16:19], v[160:163]
    s_barrier
    v_mfma_f32_16x16x32_bf16 v[160:163], a[12:15], a[20:23], v[160:163]
    buffer_load_dwordx4 v38, s[8:11], s56 offen offset:2048  lds
    v_mfma_f32_16x16x32_bf16 v[164:167], a[12:15], a[28:31], v[164:167]
    ds_read_b32 a106, v31
    v_perm_b32 v57, v52, v35, s36
    v_mfma_f32_16x16x32_bf16 v[164:167], a[8:11], a[24:27], v[164:167]
    ds_read_b32 a107, v46
    ds_read_b32 a108, v57
    v_mfma_f32_16x16x32_bf16 v[168:171], a[8:11], a[40:43], v[168:171]
    v_perm_b32 v56, v52, v35, s37
    v_perm_b32 v58, v52, v35, s38
    v_mfma_f32_16x16x32_bf16 v[168:171], a[12:15], a[44:47], v[168:171]
    ds_read_b32 a109, v56
    ds_read_b128 a[112:115], v40 offset:0
    v_mfma_f32_16x16x32_bf16 v[172:175], a[12:15], a[60:63], v[172:175]
    buffer_load_dwordx4 v39, s[8:11], s56 offen offset:3072  lds
    v_mfma_f32_16x16x32_bf16 v[172:175], a[8:11], a[56:59], v[172:175]
    s_add_u32 m0, s57, 49152
    ds_read_b32 a110, v58
    v_perm_b32 v59, v52, v35, s39
    v_mfma_f32_16x16x32_bf16 v[176:179], a[8:11], a[72:75], v[176:179]
    s_add_u32 s56, s55, 1024
    ds_read_b128 a[116:119], v41 offset:0
    ds_read_b32 a111, v59
    v_mfma_f32_16x16x32_bf16 v[176:179], a[12:15], a[76:79], v[176:179]
    ds_read_b128 a[132:135], v41 offset:2048
    v_mfma_f32_16x16x32_bf16 v[180:183], a[12:15], a[100:103], v[180:183]
    buffer_load_dwordx4 v36, s[8:11], s3 offen offset:0  lds
    v_mfma_f32_16x16x32_bf16 v[180:183], a[8:11], a[96:99], v[180:183]
    ds_read_b128 a[128:131], v40 offset:2048
    v_perm_b32 v60, v49, v35, s36
    v_mfma_f32_16x16x32_bf16 v[184:187], a[8:11], a[120:123], v[184:187]
    ds_read_b128 a[136:139], v40 offset:4096
    v_perm_b32 v61, v49, v35, s37
    v_mfma_f32_16x16x32_bf16 v[184:187], a[12:15], a[124:127], v[184:187]
    s_waitcnt vmcnt(12) lgkmcnt(8)
    ds_read_b128 a[140:143], v41 offset:4096
    ds_read_b32 a144, v60
    v_mfma_f32_16x16x32_bf16 v[188:191], a[12:15], a[180:183], v[188:191]
    buffer_load_dwordx4 v37, s[8:11], s3 offen offset:1024  lds
    v_mfma_f32_16x16x32_bf16 v[188:191], a[8:11], a[176:179], v[188:191]
    ds_read_b32 a145, v61
    v_perm_b32 v63, v49, v35, s38
    v_bitop3_b32 v62, v67, v71, s76 bitop3:0x7e
    v_mfma_f32_16x16x32_bf16 v[192:195], a[48:51], a[16:19], v[192:195]
    ds_read_b128 a[152:155], v40 offset:6144
    v_perm_b32 v5, v49, v35, s39
    v_cmp_lt_u32 vcc, 0xffff, v62
    v_mfma_f32_16x16x32_bf16 v[192:195], a[52:55], a[20:23], v[192:195]
    ds_read_b32 a146, v63
    v_perm_b32 v6, v53, v35, s36
    v_mfma_f32_16x16x32_bf16 v[196:199], a[52:55], a[28:31], v[196:199]
    ds_read_b32 a147, v5
    s_cbranch_vccnz L_slow2_1
L_back2_1:
    v_mfma_f32_16x16x32_bf16 v[196:199], a[48:51], a[24:27], v[196:199]
    ds_read_b128 a[156:159], v41 offset:6144
    ds_read_b32 a148, v6
    v_perm_b32 v7, v53, v35, s37
    v_mfma_f32_16x16x32_bf16 v[200:203], a[48:51], a[40:43], v[200:203]
    ds_read_b32 a149, v7
    v_perm_b32 v29, v53, v35, s38
    v_mfma_f32_16x16x32_bf16 v[200:203], a[52:55], a[44:47], v[200:203]
    ds_read_b32 a150, v29
    ds_read_b128 a[160:163], v40 offset:8192
    v_mfma_f32_16x16x32_bf16 v[204:207], a[52:55], a[60:63], v[204:207]
    buffer_load_dwordx4 v38, s[8:11], s3 offen offset:2048  lds
    v_mfma_f32_16x16x32_bf16 v[204:207], a[48:51], a[56:59], v[204:207]
    v_perm_b32 v27, v53, v35, s39
    v_perm_b32 v31, v50, v35, s36
    v_mfma_f32_16x16x32_bf16 v[208:211], a[48:51], a[72:75], v[208:211]
    ds_read_b32 a151, v27
    v_perm_b32 v46, v50, v35, s37
    v_mfma_f32_16x16x32_bf16 v[208:211], a[52:55], a[76:79], v[208:211]
    ds_read_b128 a[164:167], v41 offset:8192
    v_perm_b32 v57, v50, v35, s38
    v_mfma_f32_16x16x32_bf16 v[212:215], a[52:55], a[100:103], v[212:215]
    v_perm_b32 v56, v50, v35, s39
    v_perm_b32 v58, v54, v35, s36
    v_mfma_f32_16x16x32_bf16 v[212:215], a[48:51], a[96:99], v[212:215]
    v_perm_b32 v59, v54, v35, s37
    v_perm_b32 v60, v54, v35, s38
    v_mfma_f32_16x16x32_bf16 v[216:219], a[48:51], a[120:123], v[216:219]
    ds_read_b128 a[88:91], v40 offset:10240
    ds_read_b32 a168, v31
    v_mfma_f32_16x16x32_bf16 v[216:219], a[52:55], a[124:127], v[216:219]
    buffer_load_dwordx4 v39, s[8:11], s3 offen offset:3072  lds
    v_mfma_f32_16x16x32_bf16 v[220:223], a[52:55], a[180:183], v[220:223]
    s_add_u32 m0, s57, 65536
    ds_read_b32 a169, v46
    v_perm_b32 v61, v54, v35, s39
    v_mfma_f32_16x16x32_bf16 v[220:223], a[48:51], a[176:179], v[220:223]
    s_add_u32 s3, s69, 1024
    ds_read_b128 a[92:95], v41 offset:10240
    ds_read_b32 a170, v57
    v_mfma_f32_16x16x32_bf16 v[224:227], a[84:87], a[18:21], v[224:227]
    ds_read_b32 a171, v56
    v_perm_b32 v62, v51, v35, s36
    v_mfma_f32_16x16x32_bf16 v[228:231], a[84:87], a[26:29], v[228:231]
    ds_read_b32 a172, v58
    ds_read_b32 a173, v59
    v_mfma_f32_16x16x32_bf16 v[232:235], a[84:87], a[42:45], v[232:235]
    buffer_load_dwordx4 v[100:103], v34, s[12:15], s42 offen sc1
    v_mfma_f32_16x16x32_bf16 v[236:239], a[84:87], a[58:61], v[236:239]
    ds_read_b128 a[184:187], v40 offset:12288
    ds_read_b32 a174, v60
    v_mfma_f32_16x16x32_bf16 v[240:243], a[84:87], a[74:77], v[240:243]
    ds_read_b32 a175, v61
    v_perm_b32 v63, v51, v35, s37
    v_mfma_f32_16x16x32_bf16 v[244:247], a[84:87], a[98:101], v[244:247]
    ds_read_b128 a[188:191], v41 offset:12288
    ds_read_b32 a232, v62
    v_mfma_f32_16x16x32_bf16 v[248:251], a[84:87], a[122:125], v[248:251]
    buffer_load_dwordx4 v[80:83], v44, s[12:15], s42 offen sc1
    v_mfma_f32_16x16x32_bf16 v[252:255], a[84:87], a[178:181], v[252:255]
    s_waitcnt lgkmcnt(10)
    v_perm_b32 v5, v55, v35, s36
    v_perm_b32 v6, v55, v35, s37
    v_mfma_f32_16x16x32_bf16 v[128:131], a[104:107], a[112:115], v[128:131]
    ds_read_b128 a[64:67], v40 offset:14336
    v_perm_b32 v7, v64, v35, s36
    v_mfma_f32_16x16x32_bf16 v[128:131], a[108:111], a[116:119], v[128:131]
    v_perm_b32 v29, v64, v35, s37
    v_perm_b32 v27, v64, v35, s38
    v_mfma_f32_16x16x32_bf16 v[132:135], a[108:111], a[132:135], v[132:135]
    ds_read_b128 a[68:71], v41 offset:14336
    v_perm_b32 v31, v64, v35, s39
    v_mfma_f32_16x16x32_bf16 v[132:135], a[104:107], a[128:131], v[132:135]
    ds_read_b32 a233, v63
    v_perm_b32 v46, v68, v35, s36
    v_mfma_f32_16x16x32_bf16 v[136:139], a[104:107], a[136:139], v[136:139]
    ds_read_b32 a234, v5
    v_perm_b32 v57, v68, v35, s37
    v_mfma_f32_16x16x32_bf16 v[136:139], a[108:111], a[140:143], v[136:139]
    ds_read_b32 a235, v6
    ds_read_b32 a192, v7
    v_mfma_f32_16x16x32_bf16 v[140:143], a[108:111], a[156:159], v[140:143]
    buffer_load_dwordx4 v36, s[8:11], s56 offen offset:0  lds
    v_mfma_f32_16x16x32_bf16 v[140:143], a[104:107], a[152:155], v[140:143]
    ds_read_b32 a193, v29
    v_perm_b32 v56, v68, v35, s38
    v_mfma_f32_16x16x32_bf16 v[144:147], a[104:107], a[160:163], v[144:147]
    ds_read_b32 a194, v27
    v_perm_b32 v58, v68, v35, s39
    v_mfma_f32_16x16x32_bf16 v[144:147], a[108:111], a[164:167], v[144:147]
    s_waitcnt lgkmcnt(7)
    ds_read_b32 a195, v31
    ds_read_b32 a196, v46
    v_mfma_f32_16x16x32_bf16 v[148:151], a[108:111], a[92:95], v[148:151]
    ds_read_b32 a197, v57
    v_perm_b32 v59, v65, v35, s36
    v_mfma_f32_16x16x32_bf16 v[148:151], a[104:107], a[88:91], v[148:151]
    s_waitcnt vmcnt(16)
    v_perm_b32 v61, v65, v35, s37
    v_bitop3_b32 v60, v75, v79, s76 bitop3:0x7e
    v_mfma_f32_16x16x32_bf16 v[152:155], a[104:107], a[184:187], v[152:155]
    s_waitcnt lgkmcnt(8)
    ds_read_b32 a198, v56
    ds_read_b32 a199, v58
    v_mfma_f32_16x16x32_bf16 v[152:155], a[108:111], a[188:191], v[152:155]
    buffer_load_dwordx4 v37, s[8:11], s56 offen offset:1024  lds
    v_mfma_f32_16x16x32_bf16 v[156:159], a[108:111], a[68:71], v[156:159]
    v_cmp_lt_u32 vcc, 0xffff, v60
    v_perm_b32 v62, v65, v35, s38
    v_mfma_f32_16x16x32_bf16 v[156:159], a[104:107], a[64:67], v[156:159]
    v_perm_b32 v63, v65, v35, s39
    v_perm_b32 v5, v69, v35, s36
    v_mfma_f32_16x16x32_bf16 v[160:163], a[144:147], a[112:115], v[160:163]
    ds_read_b32 a200, v59
    s_cbranch_vccnz L_slow3_0
L_back3_0:
    v_mfma_f32_16x16x32_bf16 v[160:163], a[148:151], a[116:119], v[160:163]
    ds_read_b32 a201, v61
    v_perm_b32 v6, v69, v35, s37
    v_mfma_f32_16x16x32_bf16 v[164:167], a[148:151], a[132:135], v[164:167]
    v_perm_b32 v7, v69, v35, s38
    v_perm_b32 v29, v69, v35, s39
    v_mfma_f32_16x16x32_bf16 v[164:167], a[144:147], a[128:131], v[164:167]
    ds_read_b32 a202, v62
    ds_read_b32 a203, v63
    v_mfma_f32_16x16x32_bf16 v[168:171], a[144:147], a[136:139], v[168:171]
    buffer_load_dwordx4 v[84:87], v32, s[12:15], s43 offen sc1
    v_mfma_f32_16x16x32_bf16 v[168:171], a[148:151], a[140:143], v[168:171]
    ds_read_b32 a204, v5
    v_perm_b32 v27, v66, v35, s36
    v_mfma_f32_16x16x32_bf16 v[172:175], a[148:151], a[156:159], v[172:175]
    ds_read_b32 a205, v6
    v_perm_b32 v31, v66, v35, s37
    v_mfma_f32_16x16x32_bf16 v[172:175], a[144:147], a[152:155], v[172:175]
    ds_read_b32 a206, v7
    ds_read_b32 a207, v29
    v_mfma_f32_16x16x32_bf16 v[176:179], a[144:147], a[160:163], v[176:179]
    buffer_load_dwordx4 v[96:99], v33, s[12:15], s43 offen sc1
    v_mfma_f32_16x16x32_bf16 v[176:179], a[148:151], a[164:167], v[176:179]
    v_perm_b32 v46, v66, v35, s38
    v_perm_b32 v57, v66, v35, s39
    v_mfma_f32_16x16x32_bf16 v[180:183], a[148:151], a[92:95], v[180:183]
    ds_read_b32 a208, v27
    v_perm_b32 v56, v70, v35, s36
    v_mfma_f32_16x16x32_bf16 v[180:183], a[144:147], a[88:91], v[180:183]
    ds_read_b32 a209, v31
    v_perm_b32 v58, v70, v35, s37
    v_mfma_f32_16x16x32_bf16 v[184:187], a[144:147], a[184:187], v[184:187]
    ds_read_b32 a210, v46
    v_perm_b32 v60, v70, v35, s38
    v_mfma_f32_16x16x32_bf16 v[184:187], a[148:151], a[188:191], v[184:187]
    ds_read_b32 a211, v57
    ds_read_b32 a212, v56
    v_mfma_f32_16x16x32_bf16 v[188:191], a[148:151], a[68:71], v[188:191]
    buffer_load_dwordx4 v38, s[8:11], s56 offen offset:2048  lds
    v_mfma_f32_16x16x32_bf16 v[188:191], a[144:147], a[64:67], v[188:191]
    s_waitcnt vmcnt(15)
    ds_read_b32 a213, v58
    v_perm_b32 v59, v70, v35, s39
    v_mfma_f32_16x16x32_bf16 v[192:195], a[168:171], a[112:115], v[192:195]
    s_barrier
    v_mfma_f32_16x16x32_bf16 v[192:195], a[172:175], a[116:119], v[192:195]
    ds_read_b32 a214, v60
    v_perm_b32 v61, v67, v35, s36
    v_mfma_f32_16x16x32_bf16 v[196:199], a[172:175], a[132:135], v[196:199]
    v_perm_b32 v62, v67, v35, s37
    v_perm_b32 v63, v71, v35, s36
    v_mfma_f32_16x16x32_bf16 v[196:199], a[168:171], a[128:131], v[196:199]
    ds_read_b32 a215, v59
    v_perm_b32 v5, v71, v35, s37
    v_mfma_f32_16x16x32_bf16 v[200:203], a[168:171], a[136:139], v[200:203]
    ds_read_b32 a236, v61
    ds_read_b32 a237, v62
    v_mfma_f32_16x16x32_bf16 v[200:203], a[172:175], a[140:143], v[200:203]
    buffer_load_dwordx4 v39, s[8:11], s56 offen offset:3072  lds
    v_mfma_f32_16x16x32_bf16 v[204:207], a[172:175], a[156:159], v[204:207]
    s_add_u32 m0, s57, 81920
    ds_read_b128 a[216:219], v40 offset:16384
    v_perm_b32 v6, v72, v35, s36
    v_mfma_f32_16x16x32_bf16 v[204:207], a[168:171], a[152:155], v[204:207]
    ds_read_b32 a238, v63
    ds_read_b32 a239, v5
    v_mfma_f32_16x16x32_bf16 v[208:211], a[168:171], a[160:163], v[208:211]
    ds_read_b128 a[220:223], v41 offset:16384
    v_perm_b32 v7, v72, v35, s37
    v_mfma_f32_16x16x32_bf16 v[208:211], a[172:175], a[164:167], v[208:211]
    ds_read_b32 a224, v6
    v_perm_b32 v29, v72, v35, s38
    v_mfma_f32_16x16x32_bf16 v[212:215], a[172:175], a[92:95], v[212:215]
    ds_read_b128 a[240:243], v40 offset:18432
    v_perm_b32 v27, v72, v35, s39
    v_mfma_f32_16x16x32_bf16 v[212:215], a[168:171], a[88:91], v[212:215]
    ds_read_b32 a225, v7
    v_perm_b32 v31, v76, v35, s36
    v_mfma_f32_16x16x32_bf16 v[216:219], a[168:171], a[184:187], v[216:219]
    ds_read_b128 a[244:247], v41 offset:18432
    ds_read_b32 a226, v29
    v_mfma_f32_16x16x32_bf16 v[216:219], a[172:175], a[188:191], v[216:219]
    buffer_load_dwordx4 v36, s[8:11], s3 offen offset:0  lds
    v_mfma_f32_16x16x32_bf16 v[220:223], a[172:175], a[68:71], v[220:223]
    ds_read_b128 a[248:251], v40 offset:20480
    v_perm_b32 v46, v76, v35, s37
    v_mfma_f32_16x16x32_bf16 v[220:223], a[168:171], a[64:67], v[220:223]
    s_waitcnt lgkmcnt(9)
    ds_read_b32 a227, v27
    ds_read_b32 a228, v31
    v_mfma_f32_16x16x32_bf16 v[224:227], a[232:235], a[114:117], v[224:227]
    ds_read_b128 a[252:255], v41 offset:20480
    v_perm_b32 v57, v76, v35, s38
    v_mfma_f32_16x16x32_bf16 v[228:231], a[232:235], a[130:133], v[228:231]
    ds_read_b32 a229, v46
    v_perm_b32 v56, v76, v35, s39
    v_mfma_f32_16x16x32_bf16 v[232:235], a[232:235], a[138:141], v[232:235]
    ds_read_b128 a[36:39], v41 offset:22528
    v_perm_b32 v58, v73, v35, s36
    v_mfma_f32_16x16x32_bf16 v[236:239], a[232:235], a[154:157], v[236:239]
    ds_read_b128 a[32:35], v40 offset:22528
    ds_read_b32 a230, v57
    v_mfma_f32_16x16x32_bf16 v[240:243], a[232:235], a[162:165], v[240:243]
    buffer_load_dwordx4 v37, s[8:11], s3 offen offset:1024  lds
    v_mfma_f32_16x16x32_bf16 v[244:247], a[232:235], a[90:93], v[244:247]
    ds_read_b128 a[0:3], v40 offset:24576
    v_perm_b32 v60, v73, v35, s37
    v_mfma_f32_16x16x32_bf16 v[248:251], a[232:235], a[186:189], v[248:251]
    ds_read_b128 a[4:7], v41 offset:24576
    ds_read_b32 a231, v56
    v_mfma_f32_16x16x32_bf16 v[252:255], a[232:235], a[66:69], v[252:255]
    ds_read_b128 a[12:15], v41 offset:26624
    v_perm_b32 v59, v73, v35, s38
    v_mfma_f32_16x16x32_bf16 v[128:131], a[192:195], a[216:219], v[128:131]
    s_waitcnt lgkmcnt(9)
    ds_read_b128 a[8:11], v40 offset:26624
    ds_read_b32 a48, v58
    v_mfma_f32_16x16x32_bf16 v[128:131], a[196:199], a[220:223], v[128:131]
    ds_read_b128 a[16:19], v40 offset:28672
    v_perm_b32 v61, v73, v35, s39
    v_mfma_f32_16x16x32_bf16 v[132:135], a[196:199], a[244:247], v[132:135]
    s_add_u32 s56, s55, 1280
    ds_read_b32 a49, v60
    ds_read_b32 a50, v59
    v_mfma_f32_16x16x32_bf16 v[132:135], a[192:195], a[240:243], v[132:135]
    buffer_load_dwordx4 v38, s[8:11], s3 offen offset:2048  lds
    v_mfma_f32_16x16x32_bf16 v[136:139], a[192:195], a[248:251], v[136:139]
    s_waitcnt lgkmcnt(9)
    ds_read_b128 a[20:23], v41 offset:28672
    v_perm_b32 v62, v77, v35, s36
    v_mfma_f32_16x16x32_bf16 v[136:139], a[196:199], a[252:255], v[136:139]
    ds_read_b128 a[24:27], v40 offset:30720
    v_perm_b32 v63, v77, v35, s37
    v_mfma_f32_16x16x32_bf16 v[140:143], a[196:199], a[36:39], v[140:143]
    v_perm_b32 v5, v77, v35, s38
    v_perm_b32 v6, v77, v35, s39
    v_mfma_f32_16x16x32_bf16 v[140:143], a[192:195], a[32:35], v[140:143]
    s_waitcnt lgkmcnt(8)
    ds_read_b128 a[28:31], v41 offset:30720
    ds_read_b32 a51, v61
    v_mfma_f32_16x16x32_bf16 v[144:147], a[192:195], a[0:3], v[144:147]
    ds_read_b32 a52, v62
    v_perm_b32 v7, v74, v35, s36
    v_mfma_f32_16x16x32_bf16 v[144:147], a[196:199], a[4:7], v[144:147]
    s_waitcnt lgkmcnt(8)
    ds_read_b32 a53, v63
    v_perm_b32 v29, v74, v35, s37
    v_mfma_f32_16x16x32_bf16 v[148:151], a[196:199], a[12:15], v[148:151]
    s_waitcnt lgkmcnt(5)
    ds_read_b32 a54, v5
    ds_read_b32 a55, v6
    v_mfma_f32_16x16x32_bf16 v[148:151], a[192:195], a[8:11], v[148:151]
    buffer_load_dwordx4 v39, s[8:11], s3 offen offset:3072  lds
    v_mfma_f32_16x16x32_bf16 v[152:155], a[192:195], a[16:19], v[152:155]
    s_add_u32 m0, s57, 0
    v_perm_b32 v27, v74, v35, s38
    v_perm_b32 v31, v74, v35, s39
    v_mfma_f32_16x16x32_bf16 v[152:155], a[196:199], a[20:23], v[152:155]
    s_waitcnt lgkmcnt(5)
    ds_read_b32 a40, v7
    v_perm_b32 v46, v78, v35, s36
    v_mfma_f32_16x16x32_bf16 v[156:159], a[196:199], a[28:31], v[156:159]
    s_waitcnt vmcnt(12)
    ds_read_b32 a41, v29
    v_perm_b32 v57, v78, v35, s37
    v_mfma_f32_16x16x32_bf16 v[156:159], a[192:195], a[24:27], v[156:159]
    s_barrier
    v_mfma_f32_16x16x32_bf16 v[160:163], a[200:203], a[216:219], v[160:163]
    ds_read_b32 a42, v27
    v_perm_b32 v56, v78, v35, s38
    v_mfma_f32_16x16x32_bf16 v[160:163], a[204:207], a[220:223], v[160:163]
    ds_read_b32 a43, v31
    ds_read_b32 a44, v46
    v_mfma_f32_16x16x32_bf16 v[164:167], a[204:207], a[244:247], v[164:167]
    s_add_u32 s3, s69, 1280
    ds_read_b32 a45, v57
    ds_read_b32 a46, v56
    v_mfma_f32_16x16x32_bf16 v[164:167], a[200:203], a[240:243], v[164:167]
    buffer_load_dwordx4 v[104:107], v34, s[12:15], s43 offen sc1
    v_mfma_f32_16x16x32_bf16 v[168:171], a[200:203], a[248:251], v[168:171]
    ds_read_b128 a[56:59], v40 offset:32768
    v_perm_b32 v58, v78, v35, s39
    v_mfma_f32_16x16x32_bf16 v[168:171], a[204:207], a[252:255], v[168:171]
    s_waitcnt vmcnt(11)
    ds_read_b128 a[60:63], v41 offset:32768
    v_bitop3_b32 v60, v103, v83, s76 bitop3:0x7e
    v_mfma_f32_16x16x32_bf16 v[172:175], a[204:207], a[36:39], v[172:175]
    ds_read_b128 a[72:75], v40 offset:34816
    ds_read_b32 a47, v58
    v_mfma_f32_16x16x32_bf16 v[172:175], a[200:203], a[32:35], v[172:175]
    buffer_load_dwordx4 v[108:111], v44, s[12:15], s43 offen sc1
    v_mfma_f32_16x16x32_bf16 v[176:179], a[200:203], a[0:3], v[176:179]
    ds_read_b128 a[76:79], v41 offset:34816
    v_cmp_lt_u32 vcc, 0xffff, v60
    v_mfma_f32_16x16x32_bf16 v[176:179], a[204:207], a[4:7], v[176:179]
    v_perm_b32 v59, v75, v35, s36
    v_perm_b32 v61, v75, v35, s37
    v_mfma_f32_16x16x32_bf16 v[180:183], a[204:207], a[12:15], v[180:183]
    ds_read_b128 a[96:99], v40 offset:36864
    s_cbranch_vccnz L_slow3_1
L_back3_1:
    v_mfma_f32_16x16x32_bf16 v[180:183], a[200:203], a[8:11], v[180:183]
    buffer_load_dwordx4 v[112:115], v32, s[12:15], s44 offen sc1
    v_mfma_f32_16x16x32_bf16 v[184:187], a[200:203], a[16:19], v[184:187]
    v_perm_b32 v62, v79, v35, s36
    v_perm_b32 v63, v79, v35, s37
    v_mfma_f32_16x16x32_bf16 v[184:187], a[204:207], a[20:23], v[184:187]
    ds_read_b128 a[100:103], v41 offset:36864
    v_perm_b32 v5, v103, v35, s36
    v_mfma_f32_16x16x32_bf16 v[188:191], a[204:207], a[28:31], v[188:191]
    ds_read_b32 a120, v59
    ds_read_b32 a121, v61
    v_mfma_f32_16x16x32_bf16 v[188:191], a[200:203], a[24:27], v[188:191]
    buffer_load_dwordx4 v[116:119], v33, s[12:15], s44 offen sc1
    v_mfma_f32_16x16x32_bf16 v[192:195], a[208:211], a[216:219], v[192:195]
    ds_read_b128 a[80:83], v40 offset:38912
    v_perm_b32 v6, v103, v35, s37
    v_mfma_f32_16x16x32_bf16 v[192:195], a[212:215], a[220:223], v[192:195]
    v_perm_b32 v7, v83, v35, s36
    v_perm_b32 v29, v83, v35, s37
    v_mfma_f32_16x16x32_bf16 v[196:199], a[212:215], a[244:247], v[196:199]
    ds_read_b32 a122, v62
    v_perm_b32 v27, v100, v35, s36
    v_mfma_f32_16x16x32_bf16 v[196:199], a[208:211], a[240:243], v[196:199]
    ds_read_b128 a[84:87], v41 offset:38912
    ds_read_b32 a123, v63
    v_mfma_f32_16x16x32_bf16 v[200:203], a[208:211], a[248:251], v[200:203]
    ds_read_b32 a124, v5
    ds_read_b32 a125, v6
    v_mfma_f32_16x16x32_bf16 v[200:203], a[212:215], a[252:255], v[200:203]
    buffer_load_dwordx4 v36, s[8:11], s56 offen offset:0  lds
    v_mfma_f32_16x16x32_bf16 v[204:207], a[212:215], a[36:39], v[204:207]
    ds_read_b128 a[176:179], v40 offset:40960
    v_perm_b32 v31, v100, v35, s37
    v_mfma_f32_16x16x32_bf16 v[204:207], a[208:211], a[32:35], v[204:207]
    v_perm_b32 v46, v100, v35, s38
    v_perm_b32 v57, v100, v35, s39
    v_mfma_f32_16x16x32_bf16 v[208:211], a[208:211], a[0:3], v[208:211]
    ds_read_b32 a126, v7
    ds_read_b32 a127, v29
    v_mfma_f32_16x16x32_bf16 v[208:211], a[212:215], a[4:7], v[208:211]
    ds_read_b128 a[180:183], v41 offset:40960
    v_perm_b32 v56, v80, v35, s36
    v_mfma_f32_16x16x32_bf16 v[212:215], a[212:215], a[12:15], v[212:215]
    ds_read_b32 a104, v27
    v_perm_b32 v58, v80, v35, s37
    v_mfma_f32_16x16x32_bf16 v[212:215], a[208:211], a[8:11], v[212:215]
    v_perm_b32 v60, v80, v35, s38
    v_perm_b32 v59, v80, v35, s39
    v_mfma_f32_16x16x32_bf16 v[216:219], a[208:211], a[16:19], v[216:219]
    ds_read_b128 a[144:147], v40 offset:43008
    ds_read_b32 a105, v31
    v_mfma_f32_16x16x32_bf16 v[216:219], a[212:215], a[20:23], v[216:219]
    buffer_load_dwordx4 v37, s[8:11], s56 offen offset:1024  lds
    v_mfma_f32_16x16x32_bf16 v[220:223], a[212:215], a[28:31], v[220:223]
    s_waitcnt vmcnt(12)
    ds_read_b32 a106, v46
    v_bitop3_b32 v61, v87, v99, s76 bitop3:0x7e
    v_mfma_f32_16x16x32_bf16 v[220:223], a[208:211], a[24:27], v[220:223]
    ds_read_b128 a[148:151], v41 offset:43008
    v_cmp_lt_u32 vcc, 0xffff, v61
    v_mfma_f32_16x16x32_bf16 v[224:227], a[236:239], a[218:221], v[224:227]
    ds_read_b32 a107, v57
    v_perm_b32 v62, v101, v35, s36
    v_mfma_f32_16x16x32_bf16 v[228:231], a[236:239], a[242:245], v[228:231]
    v_perm_b32 v63, v101, v35, s37
    s_cbranch_vccnz L_slow4_0
L_back4_0:
    v_mfma_f32_16x16x32_bf16 v[232:235], a[236:239], a[250:253], v[232:235]
    ds_read_b128 a[168:171], v40 offset:45056
    ds_read_b32 a108, v56
    v_mfma_f32_16x16x32_bf16 v[236:239], a[236:239], a[34:37], v[236:239]
    ds_read_b32 a109, v58
    ds_read_b32 a110, v60
    v_mfma_f32_16x16x32_bf16 v[240:243], a[236:239], a[2:5], v[240:243]
    buffer_load_dwordx4 v38, s[8:11], s56 offen offset:2048  lds
L_pad2:
    s_cbranch_execz L_pad3
    v_mfma_f32_16x16x32_bf16 v[244:247], a[236:239], a[10:13], v[244:247]
    ds_read_b128 a[172:175], v41 offset:45056
    v_perm_b32 v5, v101, v35, s38
    v_mfma_f32_16x16x32_bf16 v[248:251], a[236:239], a[18:21], v[248:251]
    ds_read_b32 a111, v59
    v_perm_b32 v6, v101, v35, s39
    v_mfma_f32_16x16x32_bf16 v[252:255], a[236:239], a[26:29], v[252:255]
    s_waitcnt lgkmcnt(8)
    v_perm_b32 v7, v81, v35, s36
    v_perm_b32 v29, v81, v35, s37
    v_mfma_f32_16x16x32_bf16 v[128:131], a[224:227], a[56:59], v[128:131]
    ds_read_b128 a[112:115], v40 offset:47104
    ds_read_b32 a128, v62
    v_mfma_f32_16x16x32_bf16 v[128:131], a[228:231], a[60:63], v[128:131]
    ds_read_b32 a129, v63
    v_perm_b32 v27, v81, v35, s38
    v_mfma_f32_16x16x32_bf16 v[132:135], a[228:231], a[76:79], v[132:135]
    ds_read_b128 a[116:119], v41 offset:47104
    ds_read_b32 a130, v5
    v_mfma_f32_16x16x32_bf16 v[132:135], a[224:227], a[72:75], v[132:135]
    buffer_load_dwordx4 v39, s[8:11], s56 offen offset:3072  lds
    v_mfma_f32_16x16x32_bf16 v[136:139], a[224:227], a[96:99], v[136:139]
    s_add_u32 m0, s57, 16384
    v_perm_b32 v31, v81, v35, s39
    v_perm_b32 v46, v102, v35, s36
    v_mfma_f32_16x16x32_bf16 v[136:139], a[228:231], a[100:103], v[136:139]
    ds_read_b32 a131, v6
    v_perm_b32 v61, v102, v35, s37
    v_mfma_f32_16x16x32_bf16 v[140:143], a[228:231], a[84:87], v[140:143]
    ds_read_b32 a132, v7
    v_perm_b32 v57, v102, v35, s38
    v_mfma_f32_16x16x32_bf16 v[140:143], a[224:227], a[80:83], v[140:143]
    ds_read_b32 a133, v29
    v_perm_b32 v56, v102, v35, s39
    v_mfma_f32_16x16x32_bf16 v[144:147], a[224:227], a[176:179], v[144:147]
    s_waitcnt lgkmcnt(8)
    ds_read_b32 a134, v27
    ds_read_b32 a135, v31
    v_mfma_f32_16x16x32_bf16 v[144:147], a[228:231], a[180:183], v[144:147]
    buffer_load_dwordx4 v[120:123], v34, s[12:15], s44 offen sc1
    v_mfma_f32_16x16x32_bf16 v[148:151], a[228:231], a[148:151], v[148:151]
    v_perm_b32 v58, v82, v35, s36
    v_perm_b32 v60, v82, v35, s37
    v_mfma_f32_16x16x32_bf16 v[148:151], a[224:227], a[144:147], v[148:151]
    ds_read_b32 a136, v46
    v_perm_b32 v59, v82, v35, s38
    v_mfma_f32_16x16x32_bf16 v[152:155], a[224:227], a[168:171], v[152:155]
    s_waitcnt lgkmcnt(6)
    ds_read_b128 a[152:155], v40 offset:49152
    ds_read_b32 a137, v61
    v_mfma_f32_16x16x32_bf16 v[152:155], a[228:231], a[172:175], v[152:155]
    buffer_load_dwordx4 v[124:127], v44, s[12:15], s44 offen sc1
    v_mfma_f32_16x16x32_bf16 v[156:159], a[228:231], a[116:119], v[156:159]
    ds_read_b128 a[156:159], v41 offset:49152
    ds_read_b32 a138, v57
    v_mfma_f32_16x16x32_bf16 v[156:159], a[224:227], a[112:115], v[156:159]
    ds_read_b128 a[160:163], v40 offset:51200
    v_perm_b32 v62, v82, v35, s39
    v_mfma_f32_16x16x32_bf16 v[160:163], a[48:51], a[56:59], v[160:163]
    ds_read_b128 a[164:167], v41 offset:51200
    ds_read_b32 a139, v56
    v_mfma_f32_16x16x32_bf16 v[160:163], a[52:55], a[60:63], v[160:163]
    v_perm_b32 v63, v84, v35, s36
    v_perm_b32 v5, v84, v35, s37
    v_mfma_f32_16x16x32_bf16 v[164:167], a[52:55], a[76:79], v[164:167]
    ds_read_b128 a[88:91], v40 offset:53248
    ds_read_b32 a140, v58
    v_mfma_f32_16x16x32_bf16 v[164:167], a[48:51], a[72:75], v[164:167]
    ds_read_b32 a141, v60
    ds_read_b32 a142, v59
    v_mfma_f32_16x16x32_bf16 v[168:171], a[48:51], a[96:99], v[168:171]
    buffer_load_dwordx4 v36, s[8:11], s3 offen offset:0  lds
    v_mfma_f32_16x16x32_bf16 v[168:171], a[52:55], a[100:103], v[168:171]
    ds_read_b128 a[92:95], v41 offset:53248
    v_perm_b32 v6, v84, v35, s38
    v_mfma_f32_16x16x32_bf16 v[172:175], a[52:55], a[84:87], v[172:175]
    v_perm_b32 v7, v84, v35, s39
    v_perm_b32 v29, v96, v35, s36
    v_mfma_f32_16x16x32_bf16 v[172:175], a[48:51], a[80:83], v[172:175]
    ds_read_b32 a143, v62
    v_perm_b32 v27, v96, v35, s37
    v_mfma_f32_16x16x32_bf16 v[176:179], a[48:51], a[176:179], v[176:179]
    ds_read_b128 a[184:187], v40 offset:55296
    ds_read_b32 a64, v63
    v_mfma_f32_16x16x32_bf16 v[176:179], a[52:55], a[180:183], v[176:179]
    ds_read_b32 a65, v5
    v_perm_b32 v31, v96, v35, s38
    v_mfma_f32_16x16x32_bf16 v[180:183], a[52:55], a[148:151], v[180:183]
    v_perm_b32 v46, v96, v35, s39
    v_perm_b32 v61, v85, v35, s36
    v_mfma_f32_16x16x32_bf16 v[180:183], a[48:51], a[144:147], v[180:183]
    ds_read_b128 a[188:191], v41 offset:55296
    ds_read_b32 a66, v6
    v_mfma_f32_16x16x32_bf16 v[184:187], a[48:51], a[168:171], v[184:187]
    buffer_load_dwordx4 v37, s[8:11], s3 offen offset:1024  lds
    v_mfma_f32_16x16x32_bf16 v[184:187], a[52:55], a[172:175], v[184:187]
    ds_read_b32 a67, v7
    v_perm_b32 v57, v85, v35, s37
    v_mfma_f32_16x16x32_bf16 v[188:191], a[52:55], a[116:119], v[188:191]
    ds_read_b128 a[192:195], v40 offset:57344
    ds_read_b32 a68, v29
    v_mfma_f32_16x16x32_bf16 v[188:191], a[48:51], a[112:115], v[188:191]
    ds_read_b32 a69, v27
    v_perm_b32 v56, v85, v35, s38
    v_mfma_f32_16x16x32_bf16 v[192:195], a[40:43], a[56:59], v[192:195]
    ds_read_b32 a70, v31
    v_perm_b32 v58, v85, v35, s39
    v_mfma_f32_16x16x32_bf16 v[192:195], a[44:47], a[60:63], v[192:195]
    ds_read_b128 a[196:199], v41 offset:57344
    ds_read_b32 a71, v46
    v_mfma_f32_16x16x32_bf16 v[196:199], a[44:47], a[76:79], v[196:199]
    ds_read_b32 a200, v61
    ds_read_b32 a201, v57
    v_mfma_f32_16x16x32_bf16 v[196:199], a[40:43], a[72:75], v[196:199]
    buffer_load_dwordx4 v38, s[8:11], s3 offen offset:2048  lds
    v_mfma_f32_16x16x32_bf16 v[200:203], a[40:43], a[96:99], v[200:203]
    ds_read_b128 a[208:211], v40 offset:59392
    v_perm_b32 v60, v97, v35, s36
    v_mfma_f32_16x16x32_bf16 v[200:203], a[44:47], a[100:103], v[200:203]
    v_perm_b32 v59, v97, v35, s37
    v_perm_b32 v62, v97, v35, s38
    v_mfma_f32_16x16x32_bf16 v[204:207], a[44:47], a[84:87], v[204:207]
    ds_read_b32 a202, v56
    v_perm_b32 v63, v97, v35, s39
    v_mfma_f32_16x16x32_bf16 v[204:207], a[40:43], a[80:83], v[204:207]
    ds_read_b128 a[212:215], v41 offset:59392
    ds_read_b32 a203, v58
    v_mfma_f32_16x16x32_bf16 v[208:211], a[40:43], a[176:179], v[208:211]
    v_perm_b32 v5, v86, v35, s36
    v_perm_b32 v6, v86, v35, s37
    v_mfma_f32_16x16x32_bf16 v[208:211], a[44:47], a[180:183], v[208:211]
    ds_read_b32 a204, v60
    v_perm_b32 v7, v86, v35, s38
    v_mfma_f32_16x16x32_bf16 v[212:215], a[44:47], a[148:151], v[212:215]
    ds_read_b128 a[216:219], v40 offset:61440
    ds_read_b32 a205, v59
    v_mfma_f32_16x16x32_bf16 v[212:215], a[40:43], a[144:147], v[212:215]
    buffer_load_dwordx4 v39, s[8:11], s3 offen offset:3072  lds
    v_mfma_f32_16x16x32_bf16 v[216:219], a[40:43], a[168:171], v[216:219]
    s_waitcnt vmcnt(12)
    ds_read_b32 a206, v62
    v_bitop3_b32 v29, v107, v111, s76 bitop3:0x7e
    v_mfma_f32_16x16x32_bf16 v[216:219], a[44:47], a[172:175], v[216:219]
    ds_read_b128 a[220:223], v41 offset:61440
    v_cmp_lt_u32 vcc, 0xffff, v29
    v_mfma_f32_16x16x32_bf16 v[220:223], a[44:47], a[116:119], v[220:223]
    ds_read_b32 a207, v63
    v_perm_b32 v27, v86, v35, s39
    v_mfma_f32_16x16x32_bf16 v[220:223], a[40:43], a[112:115], v[220:223]
    v_perm_b32 v31, v98, v35, s36
    s_cbranch_vccnz L_slow4_1
L_back4_1:
    v_mfma_f32_16x16x32_bf16 v[224:227], a[120:123], a[58:61], v[224:227]
    s_waitcnt lgkmcnt(6)
    ds_read_b128 a[240:243], v40 offset:63488
    ds_read_b32 a248, v5
    v_mfma_f32_16x16x32_bf16 v[224:227], a[124:127], a[154:157], v[224:227]
    ds_read_b32 a249, v6
    v_perm_b32 v46, v98, v35, s37
    v_mfma_f32_16x16x32_bf16 v[228:231], a[124:127], a[162:165], v[228:231]
    ds_read_b128 a[244:247], v41 offset:63488
    ds_read_b32 a250, v7
    v_mfma_f32_16x16x32_bf16 v[228:231], a[120:123], a[74:77], v[228:231]
    ds_read_b32 a251, v27
    ds_read_b32 a252, v31
    v_mfma_f32_16x16x32_bf16 v[232:235], a[120:123], a[98:101], v[232:235]
    buffer_load_dwordx4 v[88:91], v32, s[12:15], s45 offen sc1
    v_mfma_f32_16x16x32_bf16 v[232:235], a[124:127], a[90:93], v[232:235]
    v_perm_b32 v61, v98, v35, s38
    v_perm_b32 v57, v98, v35, s39
    v_mfma_f32_16x16x32_bf16 v[236:239], a[124:127], a[186:189], v[236:239]
    v_perm_b32 v56, v87, v35, s36
    v_perm_b32 v58, v87, v35, s37
    v_mfma_f32_16x16x32_bf16 v[236:239], a[120:123], a[82:85], v[236:239]
    ds_read_b32 a253, v46
    ds_read_b32 a254, v61
    v_mfma_f32_16x16x32_bf16 v[240:243], a[120:123], a[178:181], v[240:243]
    buffer_load_dwordx4 v[92:95], v33, s[12:15], s45 offen sc1
    v_mfma_f32_16x16x32_bf16 v[240:243], a[124:127], a[194:197], v[240:243]
    v_perm_b32 v60, v99, v35, s36
    v_perm_b32 v59, v99, v35, s37
    v_mfma_f32_16x16x32_bf16 v[244:247], a[124:127], a[210:213], v[244:247]
    v_perm_b32 v62, v107, v35, s36
    v_perm_b32 v29, v107, v35, s37
    v_mfma_f32_16x16x32_bf16 v[244:247], a[120:123], a[146:149], v[244:247]
    s_waitcnt lgkmcnt(4)
    ds_read_b32 a255, v57
    ds_read_b32 a32, v56
    v_mfma_f32_16x16x32_bf16 v[248:251], a[120:123], a[170:173], v[248:251]
    buffer_load_dwordx4 v[48:51], v34, s[12:15], s45 offen sc1
    v_mfma_f32_16x16x32_bf16 v[248:251], a[124:127], a[218:221], v[248:251]
    s_barrier
    v_mfma_f32_16x16x32_bf16 v[252:255], a[124:127], a[242:245], v[252:255]
    s_add_u32 s56, s55, 1536
    ds_read_b32 a33, v58
    v_perm_b32 v63, v111, v35, s36
    v_mfma_f32_16x16x32_bf16 v[252:255], a[120:123], a[114:117], v[252:255]
    ds_read_b32 a34, v60
    ds_read_b32 a35, v59
    v_mfma_f32_16x16x32_bf16 v[128:131], a[104:107], a[152:155], v[128:131]
    buffer_load_dwordx4 v[52:55], v44, s[12:15], s45 offen sc1
    v_mfma_f32_16x16x32_bf16 v[128:131], a[108:111], a[156:159], v[128:131]
    s_add_u32 m0, s57, 32768
    v_perm_b32 v5, v111, v35, s37
    v_perm_b32 v6, v104, v35, s36
    v_mfma_f32_16x16x32_bf16 v[132:135], a[108:111], a[164:167], v[132:135]
    ds_read_b32 a36, v62
    ds_read_b32 a37, v29
    v_mfma_f32_16x16x32_bf16 v[132:135], a[104:107], a[160:163], v[132:135]
    v_perm_b32 v7, v104, v35, s37
    v_perm_b32 v27, v104, v35, s38
    v_mfma_f32_16x16x32_bf16 v[136:139], a[104:107], a[88:91], v[136:139]
    ds_read_b32 a38, v63
    ds_read_b32 a39, v5
    v_mfma_f32_16x16x32_bf16 v[136:139], a[108:111], a[92:95], v[136:139]
    buffer_load_dwordx4 v36, s[8:11], s56 offen offset:0  lds
    v_mfma_f32_16x16x32_bf16 v[140:143], a[108:111], a[188:191], v[140:143]
    v_perm_b32 v31, v104, v35, s39
    v_perm_b32 v46, v108, v35, s36
    v_mfma_f32_16x16x32_bf16 v[140:143], a[104:107], a[184:187], v[140:143]
    ds_read_b32 a0, v6
    v_perm_b32 v61, v108, v35, s37
    v_mfma_f32_16x16x32_bf16 v[144:147], a[104:107], a[192:195], v[144:147]
    s_waitcnt vmcnt(15)
    v_perm_b32 v56, v108, v35, s38
    v_bitop3_b32 v57, v115, v119, s76 bitop3:0x7e
    v_mfma_f32_16x16x32_bf16 v[144:147], a[108:111], a[196:199], v[144:147]
    ds_read_b32 a1, v7
    v_cmp_lt_u32 vcc, 0xffff, v57
    v_mfma_f32_16x16x32_bf16 v[148:151], a[108:111], a[212:215], v[148:151]
    ds_read_b32 a2, v27
    v_perm_b32 v58, v108, v35, s39
    v_mfma_f32_16x16x32_bf16 v[148:151], a[104:107], a[208:211], v[148:151]
    ds_read_b128 a[8:11], v42 offset:0
    s_cbranch_vccnz L_slow5_0
L_back5_0:
    v_mfma_f32_16x16x32_bf16 v[152:155], a[104:107], a[216:219], v[152:155]
    buffer_load_dwordx4 v37, s[8:11], s56 offen offset:1024  lds
    v_mfma_f32_16x16x32_bf16 v[152:155], a[108:111], a[220:223], v[152:155]
    ds_read_b128 a[12:15], v43 offset:0
    v_perm_b32 v60, v105, v35, s36
    v_mfma_f32_16x16x32_bf16 v[156:159], a[108:111], a[244:247], v[156:159]
    s_add_u32 s3, s69, 1536
    ds_read_b128 a[16:19], v42 offset:2048
    ds_read_b32 a3, v31
    v_mfma_f32_16x16x32_bf16 v[156:159], a[104:107], a[240:243], v[156:159]
    ds_read_b128 a[20:23], v43 offset:2048
    ds_read_b32 a4, v46
    v_mfma_f32_16x16x32_bf16 v[160:163], a[128:131], a[152:155], v[160:163]
    ds_read_b32 a5, v61
    v_perm_b32 v59, v105, v35, s37
    v_mfma_f32_16x16x32_bf16 v[160:163], a[132:135], a[156:159], v[160:163]
    ds_read_b32 a6, v56
    v_perm_b32 v62, v105, v35, s38
    v_mfma_f32_16x16x32_bf16 v[164:167], a[132:135], a[164:167], v[164:167]
    ds_read_b128 a[232:235], v42 offset:4096
    ds_read_b32 a7, v58
    v_mfma_f32_16x16x32_bf16 v[164:167], a[128:131], a[160:163], v[164:167]
    ds_read_b32 a24, v60
    ds_read_b32 a25, v59
    v_mfma_f32_16x16x32_bf16 v[168:171], a[128:131], a[88:91], v[168:171]
    buffer_load_dwordx4 v38, s[8:11], s56 offen offset:2048  lds
    v_mfma_f32_16x16x32_bf16 v[168:171], a[132:135], a[92:95], v[168:171]
    ds_read_b128 a[236:239], v43 offset:4096
    v_perm_b32 v29, v105, v35, s39
    v_mfma_f32_16x16x32_bf16 v[172:175], a[132:135], a[188:191], v[172:175]
    v_perm_b32 v63, v109, v35, s36
    v_perm_b32 v5, v109, v35, s37
    v_mfma_f32_16x16x32_bf16 v[172:175], a[128:131], a[184:187], v[172:175]
    v_perm_b32 v6, v109, v35, s38
    v_perm_b32 v7, v109, v35, s39
    v_mfma_f32_16x16x32_bf16 v[176:179], a[128:131], a[192:195], v[176:179]
    ds_read_b128 a[224:227], v42 offset:6144
    ds_read_b32 a26, v62
    v_mfma_f32_16x16x32_bf16 v[176:179], a[132:135], a[196:199], v[176:179]
    v_perm_b32 v57, v106, v35, s36
    v_perm_b32 v27, v106, v35, s37
    v_mfma_f32_16x16x32_bf16 v[180:183], a[132:135], a[212:215], v[180:183]
    ds_read_b32 a27, v29
    ds_read_b32 a28, v63
    v_mfma_f32_16x16x32_bf16 v[180:183], a[128:131], a[208:211], v[180:183]
    buffer_load_dwordx4 v39, s[8:11], s56 offen offset:3072  lds
    v_mfma_f32_16x16x32_bf16 v[184:187], a[128:131], a[216:219], v[184:187]
    s_add_u32 m0, s57, 49152
    ds_read_b128 a[228:231], v43 offset:6144
    v_perm_b32 v31, v106, v35, s38
    v_mfma_f32_16x16x32_bf16 v[184:187], a[132:135], a[220:223], v[184:187]
    s_add_u32 s56, s55, 1792
    ds_read_b32 a29, v5
    v_perm_b32 v46, v106, v35, s39
    v_mfma_f32_16x16x32_bf16 v[188:191], a[132:135], a[244:247], v[188:191]
    ds_read_b128 a[48:51], v42 offset:8192
    ds_read_b32 a30, v6
    v_mfma_f32_16x16x32_bf16 v[188:191], a[128:131], a[240:243], v[188:191]
    ds_read_b32 a31, v7
    v_perm_b32 v61, v110, v35, s36
    v_mfma_f32_16x16x32_bf16 v[192:195], a[136:139], a[152:155], v[192:195]
    ds_read_b32 a40, v57
    ds_read_b32 a41, v27
    v_mfma_f32_16x16x32_bf16 v[192:195], a[140:143], a[156:159], v[192:195]
    ds_read_b128 a[52:55], v43 offset:8192
    v_perm_b32 v56, v110, v35, s37
    v_mfma_f32_16x16x32_bf16 v[196:199], a[140:143], a[164:167], v[196:199]
    ds_read_b32 a42, v31
    ds_read_b32 a43, v46
    v_mfma_f32_16x16x32_bf16 v[196:199], a[136:139], a[160:163], v[196:199]
    buffer_load_dwordx4 v36, s[8:11], s3 offen offset:0  lds
    v_mfma_f32_16x16x32_bf16 v[200:203], a[136:139], a[88:91], v[200:203]
    ds_read_b128 a[56:59], v42 offset:10240
    v_perm_b32 v58, v110, v35, s38
    v_mfma_f32_16x16x32_bf16 v[200:203], a[140:143], a[92:95], v[200:203]
    v_perm_b32 v60, v110, v35, s39
    v_perm_b32 v59, v112, v35, s36
    v_mfma_f32_16x16x32_bf16 v[204:207], a[140:143], a[188:191], v[204:207]
    ds_read_b32 a44, v61
    v_perm_b32 v62, v112, v35, s37
    v_mfma_f32_16x16x32_bf16 v[204:207], a[136:139], a[184:187], v[204:207]
    ds_read_b128 a[60:63], v43 offset:10240
    ds_read_b32 a45, v56
    v_mfma_f32_16x16x32_bf16 v[208:211], a[136:139], a[192:195], v[208:211]
    v_perm_b32 v29, v112, v35, s38
    v_perm_b32 v63, v112, v35, s39
    v_mfma_f32_16x16x32_bf16 v[208:211], a[140:143], a[196:199], v[208:211]
    ds_read_b32 a46, v58
    ds_read_b32 a47, v60
    v_mfma_f32_16x16x32_bf16 v[212:215], a[140:143], a[212:215], v[212:215]
    buffer_load_dwordx4 v37, s[8:11], s3 offen offset:1024  lds
    v_mfma_f32_16x16x32_bf16 v[212:215], a[136:139], a[208:211], v[212:215]
    ds_read_b128 a[72:75], v42 offset:12288
    v_perm_b32 v5, v116, v35, s36
    v_mfma_f32_16x16x32_bf16 v[216:219], a[136:139], a[216:219], v[216:219]
    ds_read_b32 a96, v59
    v_perm_b32 v6, v116, v35, s37
    v_mfma_f32_16x16x32_bf16 v[216:219], a[140:143], a[220:223], v[216:219]
    ds_read_b128 a[76:79], v43 offset:12288
    ds_read_b32 a97, v62
    v_mfma_f32_16x16x32_bf16 v[220:223], a[140:143], a[244:247], v[220:223]
    ds_read_b32 a98, v29
    v_perm_b32 v7, v116, v35, s38
    v_mfma_f32_16x16x32_bf16 v[220:223], a[136:139], a[240:243], v[220:223]
    s_waitcnt lgkmcnt(9)
    ds_read_b32 a99, v63
    v_perm_b32 v57, v116, v35, s39
    v_mfma_f32_16x16x32_bf16 v[128:131], a[64:67], a[8:11], v[128:131]
    ds_read_b128 a[80:83], v42 offset:14336
    ds_read_b32 a100, v5
    v_mfma_f32_16x16x32_bf16 v[128:131], a[68:71], a[12:15], v[128:131]
    buffer_load_dwordx4 v38, s[8:11], s3 offen offset:2048  lds
    v_mfma_f32_16x16x32_bf16 v[132:135], a[68:71], a[20:23], v[132:135]
    ds_read_b128 a[84:87], v43 offset:14336
    v_perm_b32 v27, v113, v35, s36
    v_mfma_f32_16x16x32_bf16 v[132:135], a[64:67], a[16:19], v[132:135]
    ds_read_b32 a101, v6
    v_perm_b32 v31, v113, v35, s37
    v_mfma_f32_16x16x32_bf16 v[136:139], a[64:67], a[232:235], v[136:139]
    s_waitcnt vmcnt(15)
    v_perm_b32 v61, v113, v35, s38
    v_bitop3_b32 v46, v123, v127, s76 bitop3:0x7e
    v_mfma_f32_16x16x32_bf16 v[136:139], a[68:71], a[236:239], v[136:139]
    ds_read_b32 a102, v7
    v_cmp_lt_u32 vcc, 0xffff, v46
    v_mfma_f32_16x16x32_bf16 v[140:143], a[68:71], a[228:231], v[140:143]
    ds_read_b32 a103, v57
    v_perm_b32 v56, v113, v35, s39
    v_mfma_f32_16x16x32_bf16 v[140:143], a[64:67], a[224:227], v[140:143]
    v_perm_b32 v58, v117, v35, s36
    s_cbranch_vccnz L_slow5_1
L_back5_1:
    v_mfma_f32_16x16x32_bf16 v[144:147], a[64:67], a[48:51], v[144:147]
    s_waitcnt lgkmcnt(6)
    ds_read_b32 a176, v27
    ds_read_b32 a177, v31
    v_mfma_f32_16x16x32_bf16 v[144:147], a[68:71], a[52:55], v[144:147]
    buffer_load_dwordx4 v39, s[8:11], s3 offen offset:3072  lds
    v_mfma_f32_16x16x32_bf16 v[148:151], a[68:71], a[60:63], v[148:151]
    s_add_u32 m0, s57, 65536
    v_perm_b32 v60, v117, v35, s37
    v_perm_b32 v59, v117, v35, s38
    v_mfma_f32_16x16x32_bf16 v[148:151], a[64:67], a[56:59], v[148:151]
    s_add_u32 s3, s69, 1792
    ds_read_b32 a178, v61
    v_perm_b32 v62, v117, v35, s39
    v_mfma_f32_16x16x32_bf16 v[152:155], a[64:67], a[72:75], v[152:155]
    ds_read_b128 a[144:147], v42 offset:16384
    ds_read_b32 a179, v56
    v_mfma_f32_16x16x32_bf16 v[152:155], a[68:71], a[76:79], v[152:155]
    s_waitcnt lgkmcnt(7)
    ds_read_b128 a[148:151], v43 offset:16384
    v_perm_b32 v29, v114, v35, s36
    v_mfma_f32_16x16x32_bf16 v[156:159], a[68:71], a[84:87], v[156:159]
    ds_read_b128 a[168:171], v42 offset:18432
    ds_read_b32 a180, v58
    v_mfma_f32_16x16x32_bf16 v[156:159], a[64:67], a[80:83], v[156:159]
    ds_read_b128 a[172:175], v43 offset:18432
    v_perm_b32 v63, v114, v35, s37
    v_mfma_f32_16x16x32_bf16 v[160:163], a[200:203], a[8:11], v[160:163]
    ds_read_b32 a181, v60
    v_perm_b32 v5, v114, v35, s38
    v_mfma_f32_16x16x32_bf16 v[160:163], a[204:207], a[12:15], v[160:163]
    ds_read_b32 a182, v59
    ds_read_b32 a183, v62
    v_mfma_f32_16x16x32_bf16 v[164:167], a[204:207], a[20:23], v[164:167]
    ds_read_b128 a[120:123], v42 offset:20480
    v_perm_b32 v6, v114, v35, s39
    v_mfma_f32_16x16x32_bf16 v[164:167], a[200:203], a[16:19], v[164:167]
    ds_read_b32 a112, v29
    v_perm_b32 v7, v118, v35, s36
    v_mfma_f32_16x16x32_bf16 v[168:171], a[200:203], a[232:235], v[168:171]
    ds_read_b32 a113, v63
    v_perm_b32 v46, v118, v35, s37
    v_mfma_f32_16x16x32_bf16 v[168:171], a[204:207], a[236:239], v[168:171]
    ds_read_b128 a[124:127], v43 offset:20480
    ds_read_b32 a114, v5
    v_mfma_f32_16x16x32_bf16 v[172:175], a[204:207], a[228:231], v[172:175]
    buffer_load_dwordx4 v[64:67], v22, s[32:35], 0 offen
    v_mfma_f32_16x16x32_bf16 v[172:175], a[200:203], a[224:227], v[172:175]
    v_perm_b32 v57, v118, v35, s38
    v_perm_b32 v27, v118, v35, s39
    v_mfma_f32_16x16x32_bf16 v[176:179], a[200:203], a[48:51], v[176:179]
    ds_read_b128 a[104:107], v42 offset:22528
    ds_read_b32 a115, v6
    v_mfma_f32_16x16x32_bf16 v[176:179], a[204:207], a[52:55], v[176:179]
    ds_read_b32 a116, v7
    ds_read_b32 a117, v46
    v_mfma_f32_16x16x32_bf16 v[180:183], a[204:207], a[60:63], v[180:183]
    buffer_load_dwordx4 v[68:71], v32, s[12:15], s72 offen sc1
    v_mfma_f32_16x16x32_bf16 v[180:183], a[200:203], a[56:59], v[180:183]
    ds_read_b128 a[108:111], v43 offset:22528
    v_perm_b32 v31, v115, v35, s36
    v_mfma_f32_16x16x32_bf16 v[184:187], a[200:203], a[72:75], v[184:187]
    v_perm_b32 v61, v115, v35, s37
    v_perm_b32 v56, v119, v35, s36
    v_mfma_f32_16x16x32_bf16 v[184:187], a[204:207], a[76:79], v[184:187]
    ds_read_b32 a118, v57
    ds_read_b32 a119, v27
    v_mfma_f32_16x16x32_bf16 v[188:191], a[204:207], a[84:87], v[188:191]
    buffer_load_dwordx4 v[72:75], v33, s[12:15], s72 offen sc1
    v_mfma_f32_16x16x32_bf16 v[188:191], a[200:203], a[80:83], v[188:191]
    ds_read_b128 a[128:131], v42 offset:24576
    v_perm_b32 v58, v119, v35, s37
    v_mfma_f32_16x16x32_bf16 v[192:195], a[248:251], a[8:11], v[192:195]
    v_perm_b32 v60, v123, v35, s36
    v_perm_b32 v59, v123, v35, s37
    v_mfma_f32_16x16x32_bf16 v[192:195], a[252:255], a[12:15], v[192:195]
    ds_read_b128 a[132:135], v43 offset:24576
    ds_read_b32 a152, v31
    v_mfma_f32_16x16x32_bf16 v[196:199], a[252:255], a[20:23], v[196:199]
    buffer_load_dwordx4 v[76:79], v34, s[12:15], s72 offen sc1
    v_mfma_f32_16x16x32_bf16 v[196:199], a[248:251], a[16:19], v[196:199]
    ds_read_b32 a153, v61
    ds_read_b32 a154, v56
    v_mfma_f32_16x16x32_bf16 v[200:203], a[248:251], a[232:235], v[200:203]
    ds_read_b128 a[160:163], v42 offset:26624
    v_perm_b32 v62, v127, v35, s36
    v_mfma_f32_16x16x32_bf16 v[200:203], a[252:255], a[236:239], v[200:203]
    ds_read_b32 a155, v58
    ds_read_b32 a156, v60
    v_mfma_f32_16x16x32_bf16 v[204:207], a[252:255], a[228:231], v[204:207]
    buffer_load_dwordx4 v[100:103], v44, s[12:15], s72 offen sc1
    v_mfma_f32_16x16x32_bf16 v[204:207], a[248:251], a[224:227], v[204:207]
    ds_read_b128 a[164:167], v43 offset:26624
    v_perm_b32 v29, v127, v35, s37
    v_mfma_f32_16x16x32_bf16 v[208:211], a[248:251], a[48:51], v[208:211]
    ds_read_b32 a157, v59
    v_perm_b32 v63, v120, v35, s36
    v_mfma_f32_16x16x32_bf16 v[208:211], a[252:255], a[52:55], v[208:211]
    ds_read_b32 a158, v62
    ds_read_b32 a159, v29
    v_mfma_f32_16x16x32_bf16 v[212:215], a[252:255], a[60:63], v[212:215]
    buffer_load_dwordx2 v[80:81], v22, s[32:35], 0 offen offset:16
    v_mfma_f32_16x16x32_bf16 v[212:215], a[248:251], a[56:59], v[212:215]
    ds_read_b128 a[88:91], v42 offset:28672
    v_perm_b32 v5, v120, v35, s37
    v_mfma_f32_16x16x32_bf16 v[216:219], a[248:251], a[72:75], v[216:219]
    v_perm_b32 v6, v120, v35, s38
    v_perm_b32 v7, v120, v35, s39
    v_mfma_f32_16x16x32_bf16 v[216:219], a[252:255], a[76:79], v[216:219]
    ds_read_b128 a[92:95], v43 offset:28672
    ds_read_b32 a184, v63
    v_mfma_f32_16x16x32_bf16 v[220:223], a[252:255], a[84:87], v[220:223]
    buffer_load_dword v82, v23, s[32:35], 0 offen
    v_mfma_f32_16x16x32_bf16 v[220:223], a[248:251], a[80:83], v[220:223]
    v_perm_b32 v46, v124, v35, s36
    v_perm_b32 v57, v124, v35, s37
    v_mfma_f32_16x16x32_bf16 v[224:227], a[32:35], a[10:13], v[224:227]
    s_waitcnt lgkmcnt(6)
    ds_read_b128 a[192:195], v42 offset:30720
    v_perm_b32 v27, v124, v35, s38
    v_mfma_f32_16x16x32_bf16 v[224:227], a[36:39], a[146:149], v[224:227]
    s_waitcnt vmcnt(17)
    v_bitop3_b32 v31, v91, v95, s76 bitop3:0x7e
    v_perm_b32 v61, v124, v35, s39
    v_mfma_f32_16x16x32_bf16 v[228:231], a[36:39], a[170:173], v[228:231]
    ds_read_b128 a[196:199], v43 offset:30720
    v_cmp_lt_u32 vcc, 0xffff, v31
    v_mfma_f32_16x16x32_bf16 v[228:231], a[32:35], a[18:21], v[228:231]
    ds_read_b32 a185, v5
    v_perm_b32 v56, v121, v35, s36
    v_mfma_f32_16x16x32_bf16 v[232:235], a[32:35], a[234:237], v[232:235]
    ds_read_b32 a186, v6
    s_cbranch_vccnz L_slow6_0
L_back6_0:
    v_mfma_f32_16x16x32_bf16 v[232:235], a[36:39], a[122:125], v[232:235]
    ds_read_b32 a187, v7
    v_perm_b32 v58, v121, v35, s37
    v_mfma_f32_16x16x32_bf16 v[236:239], a[36:39], a[106:109], v[236:239]
    s_waitcnt vmcnt(15)
    v_perm_b32 v59, v121, v35, s38
    v_bitop3_b32 v60, v51, v55, s76 bitop3:0x7e
    v_mfma_f32_16x16x32_bf16 v[236:239], a[32:35], a[226:229], v[236:239]
    ds_read_b32 a188, v46
    v_cmp_lt_u32 vcc, 0xffff, v60
    v_mfma_f32_16x16x32_bf16 v[240:243], a[32:35], a[50:53], v[240:243]
    ds_read_b32 a189, v57
    ds_read_b32 a190, v27
    v_mfma_f32_16x16x32_bf16 v[240:243], a[36:39], a[130:133], v[240:243]
    v_perm_b32 v62, v121, v35, s39
    s_cbranch_vccnz L_slow6_1
L_back6_1:
    v_mfma_f32_16x16x32_bf16 v[244:247], a[36:39], a[162:165], v[244:247]
    ds_read_b32 a191, v61
    v_perm_b32 v29, v125, v35, s36
    v_mfma_f32_16x16x32_bf16 v[244:247], a[32:35], a[58:61], v[244:247]
    s_waitcnt lgkmcnt(7)
    ds_read_b32 a208, v56
    v_perm_b32 v63, v125, v35, s37
    v_mfma_f32_16x16x32_bf16 v[248:251], a[32:35], a[74:77], v[248:251]
    s_barrier
L_pad3:
    s_cbranch_execz L_pad4
    v_mfma_f32_16x16x32_bf16 v[248:251], a[36:39], a[90:93], v[248:251]
    buffer_load_dwordx4 v36, s[8:11], s56 offen offset:0  lds
    v_mfma_f32_16x16x32_bf16 v[252:255], a[36:39], a[194:197], v[252:255]
    ds_read_b32 a209, v58
    v_perm_b32 v31, v125, v35, s38
    v_mfma_f32_16x16x32_bf16 v[252:255], a[32:35], a[82:85], v[252:255]
    ds_read_b32 a210, v59
    v_perm_b32 v5, v125, v35, s39
    v_mfma_f32_16x16x32_bf16 v[128:131], a[0:3], a[144:147], v[128:131]
    ds_read_b32 a211, v62
    ds_read_b32 a212, v29
    v_mfma_f32_16x16x32_bf16 v[128:131], a[4:7], a[148:151], v[128:131]
    buffer_load_dwordx4 v37, s[8:11], s56 offen offset:1024  lds
    v_mfma_f32_16x16x32_bf16 v[132:135], a[4:7], a[172:175], v[132:135]
    v_perm_b32 v6, v122, v35, s36
    v_perm_b32 v7, v122, v35, s37
    v_mfma_f32_16x16x32_bf16 v[132:135], a[0:3], a[168:171], v[132:135]
    ds_read_b32 a213, v63
    v_perm_b32 v46, v122, v35, s38
    v_mfma_f32_16x16x32_bf16 v[136:139], a[0:3], a[120:123], v[136:139]
    ds_read_b32 a214, v31
    ds_read_b32 a215, v5
    v_mfma_f32_16x16x32_bf16 v[136:139], a[4:7], a[124:127], v[136:139]
    buffer_load_dwordx4 v38, s[8:11], s56 offen offset:2048  lds
    v_mfma_f32_16x16x32_bf16 v[140:143], a[4:7], a[108:111], v[140:143]
    v_perm_b32 v60, v122, v35, s39
    v_perm_b32 v57, v126, v35, s36
    v_mfma_f32_16x16x32_bf16 v[140:143], a[0:3], a[104:107], v[140:143]
    v_perm_b32 v27, v126, v35, s37
    v_perm_b32 v61, v126, v35, s38
    v_mfma_f32_16x16x32_bf16 v[144:147], a[0:3], a[128:131], v[144:147]
    ds_read_b32 a216, v6
    ds_read_b32 a217, v7
    v_mfma_f32_16x16x32_bf16 v[144:147], a[4:7], a[132:135], v[144:147]
    buffer_load_dwordx4 v39, s[8:11], s56 offen offset:3072  lds
    v_mfma_f32_16x16x32_bf16 v[148:151], a[4:7], a[164:167], v[148:151]
    s_add_u32 m0, s57, 81920
    ds_read_b32 a218, v46
    v_perm_b32 v56, v126, v35, s39
    v_mfma_f32_16x16x32_bf16 v[148:151], a[0:3], a[160:163], v[148:151]
    ds_read_b128 a[136:139], v40 offset:0
    v_perm_b32 v58, v91, v35, s36
    v_mfma_f32_16x16x32_bf16 v[152:155], a[0:3], a[88:91], v[152:155]
    ds_read_b128 a[140:143], v41 offset:0
    ds_read_b32 a219, v60
    v_mfma_f32_16x16x32_bf16 v[152:155], a[4:7], a[92:95], v[152:155]
    buffer_load_dwordx4 v36, s[8:11], s3 offen offset:0  lds
    v_mfma_f32_16x16x32_bf16 v[156:159], a[4:7], a[196:199], v[156:159]
    ds_read_b128 a[240:243], v40 offset:2048
    v_perm_b32 v59, v91, v35, s37
    v_mfma_f32_16x16x32_bf16 v[156:159], a[0:3], a[192:195], v[156:159]
    ds_read_b128 a[244:247], v41 offset:2048
    ds_read_b32 a220, v57
    v_mfma_f32_16x16x32_bf16 v[160:163], a[24:27], a[144:147], v[160:163]
    ds_read_b32 a221, v27
    ds_read_b32 a222, v61
    v_mfma_f32_16x16x32_bf16 v[160:163], a[28:31], a[148:151], v[160:163]
    buffer_load_dwordx4 v37, s[8:11], s3 offen offset:1024  lds
    v_mfma_f32_16x16x32_bf16 v[164:167], a[28:31], a[172:175], v[164:167]
    ds_read_b128 a[64:67], v40 offset:4096
    v_perm_b32 v62, v95, v35, s36
    v_mfma_f32_16x16x32_bf16 v[164:167], a[24:27], a[168:171], v[164:167]
    ds_read_b32 a223, v56
    v_perm_b32 v29, v95, v35, s37
    v_mfma_f32_16x16x32_bf16 v[168:171], a[24:27], a[120:123], v[168:171]
    ds_read_b32 a200, v58
    ds_read_b32 a201, v59
    v_mfma_f32_16x16x32_bf16 v[168:171], a[28:31], a[124:127], v[168:171]
    buffer_load_dwordx4 v38, s[8:11], s3 offen offset:2048  lds
    v_mfma_f32_16x16x32_bf16 v[172:175], a[28:31], a[108:111], v[172:175]
    ds_read_b128 a[68:71], v41 offset:4096
    v_perm_b32 v63, v51, v35, s36
    v_mfma_f32_16x16x32_bf16 v[172:175], a[24:27], a[104:107], v[172:175]
    v_perm_b32 v31, v51, v35, s37
    v_perm_b32 v5, v55, v35, s36
    v_mfma_f32_16x16x32_bf16 v[176:179], a[24:27], a[128:131], v[176:179]
    ds_read_b128 a[248:251], v40 offset:6144
    v_perm_b32 v6, v55, v35, s37
    v_mfma_f32_16x16x32_bf16 v[176:179], a[28:31], a[132:135], v[176:179]
    ds_read_b32 a202, v62
    ds_read_b32 a203, v29
    v_mfma_f32_16x16x32_bf16 v[180:183], a[28:31], a[164:167], v[180:183]
    buffer_load_dwordx4 v39, s[8:11], s3 offen offset:3072  lds
    v_mfma_f32_16x16x32_bf16 v[180:183], a[24:27], a[160:163], v[180:183]
    ds_read_b128 a[252:255], v41 offset:6144
    v_perm_b32 v7, v88, v35, s36
    v_mfma_f32_16x16x32_bf16 v[184:187], a[24:27], a[88:91], v[184:187]
    v_perm_b32 v46, v88, v35, s37
    v_perm_b32 v60, v88, v35, s38
    v_mfma_f32_16x16x32_bf16 v[184:187], a[28:31], a[92:95], v[184:187]
    ds_read_b32 a204, v63
    v_perm_b32 v57, v88, v35, s39
    v_mfma_f32_16x16x32_bf16 v[188:191], a[28:31], a[196:199], v[188:191]
    ds_read_b128 a[8:11], v40 offset:8192
    v_perm_b32 v27, v92, v35, s36
    v_mfma_f32_16x16x32_bf16 v[188:191], a[24:27], a[192:195], v[188:191]
    ds_read_b32 a205, v31
    ds_read_b32 a206, v5
    v_mfma_f32_16x16x32_bf16 v[192:195], a[40:43], a[144:147], v[192:195]
    ds_read_b32 a207, v6
    v_perm_b32 v61, v92, v35, s37
    v_mfma_f32_16x16x32_bf16 v[192:195], a[44:47], a[148:151], v[192:195]
    ds_read_b128 a[12:15], v41 offset:8192
    v_perm_b32 v56, v92, v35, s38
    v_mfma_f32_16x16x32_bf16 v[196:199], a[44:47], a[172:175], v[196:199]
    ds_read_b32 a16, v7
    v_perm_b32 v58, v92, v35, s39
    v_mfma_f32_16x16x32_bf16 v[196:199], a[40:43], a[168:171], v[196:199]
    ds_read_b32 a17, v46
    ds_read_b32 a18, v60
    v_mfma_f32_16x16x32_bf16 v[200:203], a[40:43], a[120:123], v[200:203]
    ds_read_b128 a[232:235], v40 offset:10240
    v_perm_b32 v59, v48, v35, s36
    v_mfma_f32_16x16x32_bf16 v[200:203], a[44:47], a[124:127], v[200:203]
    ds_read_b32 a19, v57
    ds_read_b32 a20, v27
    v_mfma_f32_16x16x32_bf16 v[204:207], a[44:47], a[108:111], v[204:207]
    v_perm_b32 v62, v48, v35, s37
    v_perm_b32 v29, v48, v35, s38
    v_mfma_f32_16x16x32_bf16 v[204:207], a[40:43], a[104:107], v[204:207]
    ds_read_b128 a[236:239], v41 offset:10240
    ds_read_b32 a21, v61
    v_mfma_f32_16x16x32_bf16 v[208:211], a[40:43], a[128:131], v[208:211]
    ds_read_b32 a22, v56
    v_perm_b32 v63, v48, v35, s39
    v_mfma_f32_16x16x32_bf16 v[208:211], a[44:47], a[132:135], v[208:211]
    ds_read_b32 a23, v58
    v_perm_b32 v31, v52, v35, s36
    v_mfma_f32_16x16x32_bf16 v[212:215], a[44:47], a[164:167], v[212:215]
    ds_read_b128 a[224:227], v40 offset:12288
    ds_read_b32 a48, v59
    v_mfma_f32_16x16x32_bf16 v[212:215], a[40:43], a[160:163], v[212:215]
    ds_read_b32 a49, v62
    v_perm_b32 v5, v52, v35, s37
    v_mfma_f32_16x16x32_bf16 v[216:219], a[40:43], a[88:91], v[216:219]
    ds_read_b32 a50, v29
    v_perm_b32 v6, v52, v35, s38
    v_mfma_f32_16x16x32_bf16 v[216:219], a[44:47], a[92:95], v[216:219]
    ds_read_b128 a[228:231], v41 offset:12288
    v_perm_b32 v7, v52, v35, s39
    v_mfma_f32_16x16x32_bf16 v[220:223], a[44:47], a[196:199], v[220:223]
    ds_read_b32 a51, v63
    ds_read_b32 a52, v31
    v_mfma_f32_16x16x32_bf16 v[220:223], a[40:43], a[192:195], v[220:223]
    s_waitcnt lgkmcnt(11)
    v_perm_b32 v46, v89, v35, s36
    v_perm_b32 v60, v89, v35, s37
    v_mfma_f32_16x16x32_bf16 v[128:131], a[96:99], a[136:139], v[128:131]
    ds_read_b32 a53, v5
    ds_read_b32 a54, v6
    v_mfma_f32_16x16x32_bf16 v[128:131], a[100:103], a[140:143], v[128:131]
    ds_read_b32 a55, v7
    v_perm_b32 v57, v89, v35, s38
    v_mfma_f32_16x16x32_bf16 v[132:135], a[100:103], a[244:247], v[132:135]
    ds_read_b32 a56, v46
    v_perm_b32 v27, v89, v35, s39
    v_mfma_f32_16x16x32_bf16 v[132:135], a[96:99], a[240:243], v[132:135]
    ds_read_b32 a57, v60
    v_perm_b32 v61, v93, v35, s36
    v_mfma_f32_16x16x32_bf16 v[136:139], a[96:99], a[64:67], v[136:139]
    ds_read_b32 a58, v57
    v_perm_b32 v56, v93, v35, s37
    v_mfma_f32_16x16x32_bf16 v[136:139], a[100:103], a[68:71], v[136:139]
    ds_read_b32 a59, v27
    v_perm_b32 v58, v93, v35, s38
    v_mfma_f32_16x16x32_bf16 v[140:143], a[100:103], a[252:255], v[140:143]
    ds_read_b128 a[72:75], v40 offset:16384
    v_perm_b32 v59, v93, v35, s39
    v_mfma_f32_16x16x32_bf16 v[140:143], a[96:99], a[248:251], v[140:143]
    ds_read_b32 a60, v61
    v_perm_b32 v62, v49, v35, s36
    v_mfma_f32_16x16x32_bf16 v[144:147], a[96:99], a[8:11], v[144:147]
    ds_read_b32 a61, v56
    v_perm_b32 v29, v49, v35, s37
    v_mfma_f32_16x16x32_bf16 v[144:147], a[100:103], a[12:15], v[144:147]
    s_waitcnt lgkmcnt(8)
    ds_read_b128 a[76:79], v41 offset:16384
    ds_read_b32 a62, v58
    v_mfma_f32_16x16x32_bf16 v[148:151], a[100:103], a[236:239], v[148:151]
    ds_read_b32 a63, v59
    v_perm_b32 v63, v49, v35, s38
    v_mfma_f32_16x16x32_bf16 v[148:151], a[96:99], a[232:235], v[148:151]
    ds_read_b32 a32, v62
    v_perm_b32 v31, v49, v35, s39
    v_mfma_f32_16x16x32_bf16 v[152:155], a[96:99], a[224:227], v[152:155]
    ds_read_b128 a[80:83], v40 offset:18432
    ds_read_b32 a33, v29
    v_mfma_f32_16x16x32_bf16 v[152:155], a[100:103], a[228:231], v[152:155]
    ds_read_b32 a34, v63
    v_perm_b32 v5, v53, v35, s36
    v_mfma_f32_16x16x32_bf16 v[160:163], a[176:179], a[136:139], v[160:163]
    ds_read_b32 a35, v31
    v_perm_b32 v6, v53, v35, s37
    v_mfma_f32_16x16x32_bf16 v[160:163], a[180:183], a[140:143], v[160:163]
    ds_read_b128 a[84:87], v41 offset:18432
    v_perm_b32 v7, v53, v35, s38
    v_mfma_f32_16x16x32_bf16 v[164:167], a[180:183], a[244:247], v[164:167]
    s_waitcnt vmcnt(12)
    ds_read_b32 a36, v5
    v_bitop3_b32 v46, v71, v75, s76 bitop3:0x7e
    v_mfma_f32_16x16x32_bf16 v[164:167], a[176:179], a[240:243], v[164:167]
    ds_read_b32 a37, v6
    v_cmp_lt_u32 vcc, 0xffff, v46
    v_mfma_f32_16x16x32_bf16 v[168:171], a[176:179], a[64:67], v[168:171]
    ds_read_b128 a[0:3], v40 offset:20480
    v_perm_b32 v60, v53, v35, s39
    v_mfma_f32_16x16x32_bf16 v[168:171], a[180:183], a[68:71], v[168:171]
    ds_read_b32 a38, v7
    s_cbranch_vccnz L_slow7_0
L_back7_0:
    v_mfma_f32_16x16x32_bf16 v[172:175], a[180:183], a[252:255], v[172:175]
    ds_read_b32 a39, v60
    v_perm_b32 v57, v90, v35, s36
    v_mfma_f32_16x16x32_bf16 v[172:175], a[176:179], a[248:251], v[172:175]
    ds_read_b128 a[4:7], v41 offset:20480
    v_perm_b32 v27, v90, v35, s37
    v_mfma_f32_16x16x32_bf16 v[176:179], a[176:179], a[8:11], v[176:179]
    ds_read_b32 a24, v57
    v_perm_b32 v61, v90, v35, s38
    v_mfma_f32_16x16x32_bf16 v[176:179], a[180:183], a[12:15], v[176:179]
    s_waitcnt vmcnt(10)
    ds_read_b32 a25, v27
    v_bitop3_b32 v56, v79, v103, s76 bitop3:0x7e
    v_mfma_f32_16x16x32_bf16 v[180:183], a[180:183], a[236:239], v[180:183]
    ds_read_b128 a[144:147], v40 offset:22528
    v_cmp_lt_u32 vcc, 0xffff, v56
    v_mfma_f32_16x16x32_bf16 v[180:183], a[176:179], a[232:235], v[180:183]
    ds_read_b32 a26, v61
    v_perm_b32 v58, v90, v35, s39
    v_mfma_f32_16x16x32_bf16 v[184:187], a[176:179], a[224:227], v[184:187]
    v_perm_b32 v59, v94, v35, s36
    s_cbranch_vccnz L_slow7_1
L_back7_1:
    v_mfma_f32_16x16x32_bf16 v[184:187], a[180:183], a[228:231], v[184:187]
    ds_read_b128 a[148:151], v41 offset:22528
    v_perm_b32 v62, v94, v35, s37
    v_mfma_f32_16x16x32_bf16 v[192:195], a[112:115], a[136:139], v[192:195]
    ds_read_b32 a27, v58
    v_perm_b32 v29, v94, v35, s38
    v_mfma_f32_16x16x32_bf16 v[192:195], a[116:119], a[140:143], v[192:195]
    ds_read_b32 a28, v59
    v_perm_b32 v63, v94, v35, s39
    v_mfma_f32_16x16x32_bf16 v[196:199], a[116:119], a[244:247], v[196:199]
    ds_read_b128 a[168:171], v40 offset:24576
    v_perm_b32 v31, v50, v35, s36
    v_mfma_f32_16x16x32_bf16 v[196:199], a[112:115], a[240:243], v[196:199]
    ds_read_b32 a29, v62
    v_perm_b32 v5, v50, v35, s37
    v_mfma_f32_16x16x32_bf16 v[200:203], a[112:115], a[64:67], v[200:203]
    ds_read_b32 a30, v29
    v_perm_b32 v6, v50, v35, s38
    v_mfma_f32_16x16x32_bf16 v[200:203], a[116:119], a[68:71], v[200:203]
    ds_read_b128 a[172:175], v41 offset:24576
    ds_read_b32 a31, v63
    v_mfma_f32_16x16x32_bf16 v[204:207], a[116:119], a[252:255], v[204:207]
    ds_read_b32 a120, v31
    v_perm_b32 v46, v50, v35, s39
    v_mfma_f32_16x16x32_bf16 v[204:207], a[112:115], a[248:251], v[204:207]
    ds_read_b32 a121, v5
    v_perm_b32 v7, v54, v35, s36
    v_mfma_f32_16x16x32_bf16 v[208:211], a[112:115], a[8:11], v[208:211]
    ds_read_b128 a[104:107], v40 offset:26624
    ds_read_b32 a122, v6
    v_mfma_f32_16x16x32_bf16 v[208:211], a[116:119], a[12:15], v[208:211]
    ds_read_b32 a123, v46
    v_perm_b32 v60, v54, v35, s37
    v_mfma_f32_16x16x32_bf16 v[212:215], a[116:119], a[236:239], v[212:215]
    ds_read_b32 a124, v7
    v_perm_b32 v57, v54, v35, s38
    v_mfma_f32_16x16x32_bf16 v[212:215], a[112:115], a[232:235], v[212:215]
    ds_read_b128 a[108:111], v41 offset:26624
    v_perm_b32 v27, v54, v35, s39
    v_mfma_f32_16x16x32_bf16 v[216:219], a[112:115], a[224:227], v[216:219]
    ds_read_b32 a125, v60
    v_perm_b32 v56, v71, v35, s36
    v_mfma_f32_16x16x32_bf16 v[216:219], a[116:119], a[228:231], v[216:219]
    ds_read_b32 a126, v57
    v_perm_b32 v61, v71, v35, s37
    v_mfma_f32_16x16x32_bf16 v[224:227], a[152:155], a[138:141], v[224:227]
    s_waitcnt lgkmcnt(9)
    ds_read_b128 a[128:131], v40 offset:28672
    v_perm_b32 v58, v75, v35, s36
    v_mfma_f32_16x16x32_bf16 v[224:227], a[156:159], a[74:77], v[224:227]
    ds_read_b128 a[132:135], v41 offset:28672
    ds_read_b32 a127, v27
    v_mfma_f32_16x16x32_bf16 v[228:231], a[156:159], a[82:85], v[228:231]
    ds_read_b32 a160, v56
    v_perm_b32 v59, v75, v35, s37
    v_mfma_f32_16x16x32_bf16 v[228:231], a[152:155], a[242:245], v[228:231]
    ds_read_b32 a161, v61
    v_perm_b32 v62, v79, v35, s36
    v_mfma_f32_16x16x32_bf16 v[232:235], a[152:155], a[66:69], v[232:235]
    ds_read_b32 a162, v58
    v_perm_b32 v29, v79, v35, s37
    v_mfma_f32_16x16x32_bf16 v[232:235], a[156:159], a[2:5], v[232:235]
    ds_read_b32 a163, v59
    v_perm_b32 v63, v103, v35, s36
    v_mfma_f32_16x16x32_bf16 v[236:239], a[156:159], a[146:149], v[236:239]
    ds_read_b32 a164, v62
    v_perm_b32 v31, v103, v35, s37
    v_mfma_f32_16x16x32_bf16 v[236:239], a[152:155], a[250:253], v[236:239]
    ds_read_b32 a165, v29
    v_perm_b32 v5, v68, v35, s36
    v_mfma_f32_16x16x32_bf16 v[240:243], a[152:155], a[10:13], v[240:243]
    ds_read_b32 a166, v63
    v_perm_b32 v6, v68, v35, s37
    v_mfma_f32_16x16x32_bf16 v[240:243], a[156:159], a[170:173], v[240:243]
    s_waitcnt lgkmcnt(9)
    ds_read_b32 a167, v31
    v_perm_b32 v46, v68, v35, s38
    v_mfma_f32_16x16x32_bf16 v[244:247], a[156:159], a[106:109], v[244:247]
    ds_read_b32 a88, v5
    v_perm_b32 v7, v68, v35, s39
    v_mfma_f32_16x16x32_bf16 v[244:247], a[152:155], a[234:237], v[244:247]
    ds_read_b32 a89, v6
    v_perm_b32 v60, v72, v35, s36
    v_mfma_f32_16x16x32_bf16 v[248:251], a[152:155], a[226:229], v[248:251]
    s_waitcnt lgkmcnt(8)
    ds_read_b32 a90, v46
    v_perm_b32 v57, v72, v35, s37
    v_mfma_f32_16x16x32_bf16 v[248:251], a[156:159], a[130:133], v[248:251]
    ds_read_b32 a91, v7
    v_perm_b32 v27, v72, v35, s38
    v_mfma_f32_16x16x32_bf16 v[128:131], a[184:187], a[72:75], v[128:131]
    ds_read_b32 a92, v60
    v_perm_b32 v56, v72, v35, s39
    v_mfma_f32_16x16x32_bf16 v[128:131], a[188:191], a[76:79], v[128:131]
    ds_read_b32 a93, v57
    v_perm_b32 v61, v76, v35, s36
    v_mfma_f32_16x16x32_bf16 v[132:135], a[188:191], a[84:87], v[132:135]
    ds_read_b32 a94, v27
    v_perm_b32 v58, v76, v35, s37
    v_mfma_f32_16x16x32_bf16 v[132:135], a[184:187], a[80:83], v[132:135]
    ds_read_b32 a95, v56
    v_perm_b32 v59, v76, v35, s38
    v_mfma_f32_16x16x32_bf16 v[136:139], a[184:187], a[0:3], v[136:139]
    ds_read_b32 a40, v61
    v_perm_b32 v62, v76, v35, s39
    v_mfma_f32_16x16x32_bf16 v[136:139], a[188:191], a[4:7], v[136:139]
    ds_read_b32 a41, v58
    v_perm_b32 v29, v100, v35, s36
    v_mfma_f32_16x16x32_bf16 v[140:143], a[188:191], a[148:151], v[140:143]
    ds_read_b32 a42, v59
    v_perm_b32 v63, v100, v35, s37
    v_mfma_f32_16x16x32_bf16 v[140:143], a[184:187], a[144:147], v[140:143]
    s_waitcnt vmcnt(0)
    ds_read_b32 a43, v62
    v_perm_b32 v31, v100, v35, s38
    v_mfma_f32_16x16x32_bf16 v[144:147], a[184:187], a[168:171], v[144:147]
    s_barrier
    v_mfma_f32_16x16x32_bf16 v[144:147], a[188:191], a[172:175], v[144:147]
    buffer_atomic_add v45, v1, s[24:27], s77 offen sc0 sc1
    v_mfma_f32_16x16x32_bf16 v[148:151], a[188:191], a[108:111], v[148:151]
    ds_read_b32 a44, v29
    ds_read_b32 a45, v63
    v_mfma_f32_16x16x32_bf16 v[148:151], a[184:187], a[104:107], v[148:151]
    ds_read_b32 a46, v31
    v_perm_b32 v5, v100, v35, s39
    v_mfma_f32_16x16x32_bf16 v[152:155], a[184:187], a[128:131], v[152:155]
    ds_read_b32 a47, v5
    v_perm_b32 v6, v69, v35, s36
    v_mfma_f32_16x16x32_bf16 v[152:155], a[188:191], a[132:135], v[152:155]
    ds_read_b128 a[192:195], v40 offset:32768
    v_perm_b32 v46, v69, v35, s37
    v_mfma_f32_16x16x32_bf16 v[160:163], a[208:211], a[72:75], v[160:163]
    ds_read_b32 a136, v6
    v_perm_b32 v7, v69, v35, s38
    v_mfma_f32_16x16x32_bf16 v[160:163], a[212:215], a[76:79], v[160:163]
    ds_read_b32 a137, v46
    v_perm_b32 v60, v69, v35, s39
    v_mfma_f32_16x16x32_bf16 v[164:167], a[212:215], a[84:87], v[164:167]
    ds_read_b128 a[196:199], v41 offset:32768
    v_perm_b32 v57, v73, v35, s36
    v_mfma_f32_16x16x32_bf16 v[164:167], a[208:211], a[80:83], v[164:167]
    ds_read_b32 a138, v7
    v_perm_b32 v27, v73, v35, s37
    v_mfma_f32_16x16x32_bf16 v[168:171], a[208:211], a[0:3], v[168:171]
    ds_read_b32 a139, v60
    v_perm_b32 v56, v73, v35, s38
    v_mfma_f32_16x16x32_bf16 v[168:171], a[212:215], a[4:7], v[168:171]
    ds_read_b32 a140, v57
    v_perm_b32 v61, v73, v35, s39
    v_mfma_f32_16x16x32_bf16 v[172:175], a[212:215], a[148:151], v[172:175]
    ds_read_b128 a[240:243], v40 offset:49152
    v_perm_b32 v58, v77, v35, s36
    v_mfma_f32_16x16x32_bf16 v[172:175], a[208:211], a[144:147], v[172:175]
    ds_read_b32 a141, v27
    v_perm_b32 v59, v77, v35, s37
    v_mfma_f32_16x16x32_bf16 v[176:179], a[208:211], a[168:171], v[176:179]
    s_mov_b32 m0, s60
    ds_read_b32 a142, v56
    v_perm_b32 v62, v77, v35, s38
    v_mfma_f32_16x16x32_bf16 v[176:179], a[212:215], a[172:175], v[176:179]
    ds_read_b128 a[244:247], v41 offset:49152
    ds_read_b32 a143, v61
    v_mfma_f32_16x16x32_bf16 v[180:183], a[212:215], a[108:111], v[180:183]
    ds_read_b32 a64, v58
    v_perm_b32 v29, v77, v35, s39
    v_mfma_f32_16x16x32_bf16 v[180:183], a[208:211], a[104:107], v[180:183]
    ds_read_b32 a65, v59
    v_perm_b32 v63, v101, v35, s36
    v_mfma_f32_16x16x32_bf16 v[184:187], a[208:211], a[128:131], v[184:187]
    ds_read_b32 a68, v63
    ds_read_b32 a66, v62
    v_mfma_f32_16x16x32_bf16 v[184:187], a[212:215], a[132:135], v[184:187]
    ds_read_b128 a[248:251], v42 offset:0
    v_perm_b32 v31, v101, v35, s37
    v_mfma_f32_16x16x32_bf16 v[192:195], a[216:219], a[72:75], v[192:195]
    ds_read_b32 a69, v31
    ds_read_b32 a67, v29
    v_mfma_f32_16x16x32_bf16 v[192:195], a[220:223], a[76:79], v[192:195]
    ds_read_b128 a[252:255], v43 offset:0
    v_perm_b32 v5, v101, v35, s38
    v_mfma_f32_16x16x32_bf16 v[196:199], a[220:223], a[84:87], v[196:199]
    ds_read_b32 a70, v5
    v_perm_b32 v6, v101, v35, s39
    v_mfma_f32_16x16x32_bf16 v[196:199], a[216:219], a[80:83], v[196:199]
    ds_read_b32 a71, v6
    v_perm_b32 v46, v70, v35, s36
    v_mfma_f32_16x16x32_bf16 v[200:203], a[216:219], a[0:3], v[200:203]
    ds_read_b32 a8, v46
    v_perm_b32 v7, v70, v35, s37
    v_mfma_f32_16x16x32_bf16 v[200:203], a[220:223], a[4:7], v[200:203]
    ds_read_b32 a9, v7
    v_perm_b32 v60, v70, v35, s38
    v_mfma_f32_16x16x32_bf16 v[204:207], a[220:223], a[148:151], v[204:207]
    ds_read_b128 a[232:235], v42 offset:16384
    v_perm_b32 v57, v70, v35, s39
    v_mfma_f32_16x16x32_bf16 v[204:207], a[216:219], a[144:147], v[204:207]
    ds_read_b32 a10, v60
    v_perm_b32 v27, v74, v35, s36
    v_mfma_f32_16x16x32_bf16 v[208:211], a[216:219], a[168:171], v[208:211]
    ds_read_b32 a12, v27
    v_perm_b32 v56, v74, v35, s37
    v_mfma_f32_16x16x32_bf16 v[208:211], a[220:223], a[172:175], v[208:211]
    ds_read_b128 a[236:239], v43 offset:16384
    v_perm_b32 v61, v74, v35, s38
    v_mfma_f32_16x16x32_bf16 v[212:215], a[220:223], a[108:111], v[212:215]
    ds_read_b32 a13, v56
    ds_read_b32 a11, v57
    v_mfma_f32_16x16x32_bf16 v[212:215], a[216:219], a[104:107], v[212:215]
    ds_read_b32 a14, v61
    v_perm_b32 v58, v74, v35, s39
    v_mfma_f32_16x16x32_bf16 v[216:219], a[216:219], a[128:131], v[216:219]
    ds_read_b32 a15, v58
    v_perm_b32 v59, v78, v35, s36
    v_mfma_f32_16x16x32_bf16 v[216:219], a[220:223], a[132:135], v[216:219]
    s_waitcnt lgkmcnt(9)
    ds_read_b128 a[224:227], v40 offset:34816
    v_perm_b32 v62, v78, v35, s37
    v_mfma_f32_16x16x32_bf16 v[224:227], a[200:203], a[194:197], v[224:227]
    s_mov_b32 s66, 0
    ds_read_b32 a72, v59
    v_lshlrev_b32 v84, 16, v82
    v_mfma_f32_16x16x32_bf16 v[224:227], a[204:207], a[242:245], v[224:227]
    s_mov_b32 s67, 14336
    ds_read_b32 a73, v62
    v_perm_b32 v63, v78, v35, s38
    v_mfma_f32_16x16x32_bf16 v[128:131], a[16:19], a[192:195], v[128:131]
    ds_read_b128 a[228:231], v41 offset:34816
    v_perm_b32 v29, v78, v35, s39
    v_mfma_f32_16x16x32_bf16 v[128:131], a[20:23], a[196:199], v[128:131]
    ds_read_b32 a74, v63
    v_and_b32 v85, 0xffff0000, v82
    v_mfma_f32_16x16x32_bf16 v[128:131], a[48:51], a[240:243], v[128:131]
    ds_read_b32 a75, v29
    v_perm_b32 v31, v102, v35, s36
    v_mfma_f32_16x16x32_bf16 v[128:131], a[52:55], a[244:247], v[128:131]
    ds_read_b128 a[80:83], v40 offset:51200
    v_perm_b32 v5, v102, v35, s37
    v_mfma_f32_16x16x32_bf16 v[160:163], a[56:59], a[192:195], v[160:163]
    ds_read_b32 a76, v31
    v_lshlrev_b32 v96, 16, v64
    v_mfma_f32_16x16x32_bf16 v[160:163], a[60:63], a[196:199], v[160:163]
    ds_read_b32 a77, v5
    v_perm_b32 v6, v102, v35, s38
    v_mfma_f32_16x16x32_bf16 v[160:163], a[32:35], a[240:243], v[160:163]
    ds_read_b128 a[84:87], v41 offset:51200
    v_and_b32 v97, 0xffff0000, v65
    v_mfma_f32_16x16x32_bf16 v[160:163], a[36:39], a[244:247], v[160:163]
    ds_read_b32 a78, v6
    v_perm_b32 v46, v102, v35, s39
    v_mfma_f32_16x16x32_bf16 v[192:195], a[24:27], a[192:195], v[192:195]
    ds_read_b128 a[0:3], v42 offset:2048
    v_lshlrev_b32 v98, 16, v67
    v_mfma_f32_16x16x32_bf16 v[192:195], a[28:31], a[196:199], v[192:195]
    ds_read_b32 a79, v46
    v_and_b32 v99, 0xffff0000, v80
    v_mfma_f32_16x16x32_bf16 v[192:195], a[120:123], a[240:243], v[192:195]
    ds_read_b128 a[4:7], v43 offset:2048
    v_and_b32 v104, 0xffff0000, v64
    v_mfma_f32_16x16x32_bf16 v[192:195], a[124:127], a[244:247], v[192:195]
    v_lshlrev_b32 v105, 16, v66
    v_and_b32 v106, 0xffff0000, v67
    v_mfma_f32_16x16x32_bf16 v[224:227], a[160:163], a[250:253], v[224:227]
    s_waitcnt lgkmcnt(7)
    v_lshlrev_b32 v107, 16, v81
    v_lshlrev_b32 v108, 16, v65
    v_mfma_f32_16x16x32_bf16 v[224:227], a[164:167], a[234:237], v[224:227]
    ds_read_b128 a[144:147], v42 offset:18432
    v_and_b32 v109, 0xffff0000, v66
    v_mfma_f32_16x16x32_bf16 v[128:131], a[88:91], a[248:251], v[128:131]
    v_lshlrev_b32 v110, 16, v80
    v_and_b32 v111, 0xffff0000, v81
    v_mfma_f32_16x16x32_bf16 v[128:131], a[92:95], a[252:255], v[128:131]
    v_mfma_f32_16x16x32_bf16 v[128:131], a[40:43], a[232:235], v[128:131]
    ds_read_b128 a[148:151], v43 offset:18432
    v_mfma_f32_16x16x32_bf16 v[128:131], a[44:47], a[236:239], v[128:131]
    ds_write_addtid_b32 v226 offset:28928
    ds_write_addtid_b32 v227 offset:29184
    v_mfma_f32_16x16x32_bf16 v[160:163], a[136:139], a[248:251], v[160:163]
    v_mfma_f32_16x16x32_bf16 v[160:163], a[140:143], a[252:255], v[160:163]
    v_mfma_f32_16x16x32_bf16 v[160:163], a[64:67], a[232:235], v[160:163]
    ds_read_b128 a[168:171], v40 offset:36864
    v_mfma_f32_16x16x32_bf16 v[160:163], a[68:71], a[236:239], v[160:163]
    s_nop 0
    v_mul_f32 v128, v128, v96
    v_mul_f32 v129, v129, v97
    v_mfma_f32_16x16x32_bf16 v[192:195], a[8:11], a[248:251], v[192:195]
    s_waitcnt lgkmcnt(1)
    s_barrier
    v_mfma_f32_16x16x32_bf16 v[192:195], a[12:15], a[252:255], v[192:195]
    ds_read2st64_b32 v[112:113], v30 offset0:113 offset1:114
    v_mul_f32 v130, v130, v98
L_pad4:
    s_cbranch_execz L_warmed
    v_mfma_f32_16x16x32_bf16 v[192:195], a[72:75], a[232:235], v[192:195]
    ds_read_b128 a[172:175], v41 offset:36864
    v_mul_f32 v131, v131, v99
    v_mfma_f32_16x16x32_bf16 v[192:195], a[76:79], a[236:239], v[192:195]
    v_mul_f32 v160, v160, v104
    v_cvt_pk_bf16_f32 v116, v128, v160
    v_mfma_f32_16x16x32_bf16 v[228:231], a[200:203], a[226:229], v[228:231]
    v_mul_f32 v161, v161, v105
    v_mul_f32 v162, v162, v106
    v_mfma_f32_16x16x32_bf16 v[228:231], a[204:207], a[82:85], v[228:231]
    ds_read_b128 a[104:107], v40 offset:53248
    v_cvt_pk_bf16_f32 v119, v130, v162
    v_mfma_f32_16x16x32_bf16 v[228:231], a[160:163], a[2:5], v[228:231]
    v_mul_f32 v163, v163, v107
    v_mfma_f32_16x16x32_bf16 v[228:231], a[164:167], a[146:149], v[228:231]
    v_mul_f32 v192, v192, v108
    v_mul_f32 v193, v193, v109
    v_mfma_f32_16x16x32_bf16 v[132:135], a[16:19], a[224:227], v[132:135]
    ds_read_b128 a[108:111], v41 offset:53248
    v_mul_f32 v194, v194, v110
    v_mfma_f32_16x16x32_bf16 v[132:135], a[20:23], a[228:231], v[132:135]
    v_mul_f32 v195, v195, v111
    v_cvt_pk_bf16_f32 v117, v192, v129
    v_mfma_f32_16x16x32_bf16 v[132:135], a[48:51], a[80:83], v[132:135]
    ds_write_b64 v26, v[116:117] offset:64512
    v_mfma_f32_16x16x32_bf16 v[132:135], a[52:55], a[84:87], v[132:135]
    ds_write_addtid_b32 v230 offset:30976
    v_cvt_pk_bf16_f32 v118, v161, v193
    v_mfma_f32_16x16x32_bf16 v[132:135], a[88:91], a[0:3], v[132:135]
    ds_write_b64 v26, v[118:119] offset:64520
    v_mfma_f32_16x16x32_bf16 v[132:135], a[92:95], a[4:7], v[132:135]
    ds_write_addtid_b32 v231 offset:31232
    v_cvt_pk_bf16_f32 v120, v194, v131
    v_mfma_f32_16x16x32_bf16 v[132:135], a[40:43], a[144:147], v[132:135]
    ds_read_b128 a[128:131], v42 offset:4096
    v_cvt_pk_bf16_f32 v121, v163, v195
    v_mfma_f32_16x16x32_bf16 v[132:135], a[44:47], a[148:151], v[132:135]
    ds_write_b64 v26, v[120:121] offset:64528
    v_mfma_f32_16x16x32_bf16 v[164:167], a[56:59], a[224:227], v[164:167]
    s_waitcnt lgkmcnt(7)
    v_add_f32 v224, v224, v112
    v_mul_f32 v224, v224, v84
    v_mfma_f32_16x16x32_bf16 v[164:167], a[60:63], a[228:231], v[164:167]
    v_add_f32 v225, v225, v113
    v_mul_f32 v225, v225, v85
    v_mfma_f32_16x16x32_bf16 v[164:167], a[32:35], a[80:83], v[164:167]
    ds_read_b128 a[132:135], v43 offset:4096
    v_cvt_pk_bf16_f32 v112, v224, v225
    v_mfma_f32_16x16x32_bf16 v[164:167], a[36:39], a[84:87], v[164:167]
    ds_write_b32 v28, v112 offset:64512
    v_mfma_f32_16x16x32_bf16 v[164:167], a[136:139], a[0:3], v[164:167]
    ds_read_b128 a[192:195], v42 offset:20480
    v_mul_f32 v132, v132, v96
    v_mfma_f32_16x16x32_bf16 v[164:167], a[140:143], a[4:7], v[164:167]
    v_mul_f32 v133, v133, v97
    v_mul_f32 v134, v134, v98
    v_mfma_f32_16x16x32_bf16 v[164:167], a[64:67], a[144:147], v[164:167]
    ds_read_b128 a[196:199], v43 offset:20480
    v_mul_f32 v135, v135, v99
    v_mfma_f32_16x16x32_bf16 v[164:167], a[68:71], a[148:151], v[164:167]
    v_mfma_f32_16x16x32_bf16 v[196:199], a[24:27], a[224:227], v[196:199]
    s_waitcnt lgkmcnt(2)
    s_barrier
    v_mfma_f32_16x16x32_bf16 v[196:199], a[28:31], a[228:231], v[196:199]
    ds_read_b128 v[124:127], v24 offset:64512
    ds_read2st64_b32 v[88:89], v30 offset0:121 offset1:122
    v_mfma_f32_16x16x32_bf16 v[196:199], a[120:123], a[80:83], v[196:199]
    ds_read_b128 v[92:95], v24 offset:65440
    v_mfma_f32_16x16x32_bf16 v[196:199], a[124:127], a[84:87], v[196:199]
    ds_read_b128 a[240:243], v40 offset:38912
    v_mul_f32 v164, v164, v104
    v_mfma_f32_16x16x32_bf16 v[196:199], a[8:11], a[0:3], v[196:199]
    v_cvt_pk_bf16_f32 v48, v132, v164
    v_mul_f32 v165, v165, v105
    v_mfma_f32_16x16x32_bf16 v[196:199], a[12:15], a[4:7], v[196:199]
    ds_read_b128 a[244:247], v41 offset:38912
    v_mul_f32 v166, v166, v106
    v_mfma_f32_16x16x32_bf16 v[196:199], a[72:75], a[144:147], v[196:199]
    v_cvt_pk_bf16_f32 v51, v134, v166
    v_mul_f32 v167, v167, v107
    v_mfma_f32_16x16x32_bf16 v[196:199], a[76:79], a[148:151], v[196:199]
    s_waitcnt lgkmcnt(3)
    v_mfma_f32_16x16x32_bf16 v[232:235], a[200:203], a[170:173], v[232:235]
    buffer_store_dwordx4 v[124:127], v25, s[16:19], s66 offen sc1
    v_mfma_f32_16x16x32_bf16 v[232:235], a[204:207], a[106:109], v[232:235]
    s_mov_b32 s66, 114688
    v_add_f32 v228, v228, v88
    v_mul_f32 v228, v228, v84
    v_mfma_f32_16x16x32_bf16 v[232:235], a[160:163], a[130:133], v[232:235]
    v_add_f32 v229, v229, v89
    v_mul_f32 v229, v229, v85
    v_mfma_f32_16x16x32_bf16 v[232:235], a[164:167], a[194:197], v[232:235]
    s_waitcnt lgkmcnt(2)
    ds_read_b128 a[248:251], v40 offset:55296
    v_mfma_f32_16x16x32_bf16 v[136:139], a[16:19], a[168:171], v[136:139]
    buffer_store_dwordx4 v[92:95], v25, s[16:19], s67 offen sc1
    v_mfma_f32_16x16x32_bf16 v[136:139], a[20:23], a[172:175], v[136:139]
    s_mov_b32 s67, 129024
    ds_read_b128 a[252:255], v41 offset:55296
    v_cvt_pk_bf16_f32 v88, v228, v229
    v_mfma_f32_16x16x32_bf16 v[136:139], a[48:51], a[104:107], v[136:139]
    ds_write_b32 v28, v88 offset:0
    v_mfma_f32_16x16x32_bf16 v[136:139], a[52:55], a[108:111], v[136:139]
    ds_write_addtid_b32 v234 offset:33024
    v_mul_f32 v196, v196, v108
    v_mfma_f32_16x16x32_bf16 v[136:139], a[88:91], a[128:131], v[136:139]
    ds_write_addtid_b32 v235 offset:33280
    v_mul_f32 v197, v197, v109
    v_mfma_f32_16x16x32_bf16 v[136:139], a[92:95], a[132:135], v[136:139]
    v_mul_f32 v198, v198, v110
    v_mul_f32 v199, v199, v111
    v_mfma_f32_16x16x32_bf16 v[136:139], a[40:43], a[192:195], v[136:139]
    ds_read_b128 a[232:235], v42 offset:6144
    v_cvt_pk_bf16_f32 v49, v196, v133
    v_mfma_f32_16x16x32_bf16 v[136:139], a[44:47], a[196:199], v[136:139]
    ds_write_b64 v26, v[48:49] offset:0
    v_mfma_f32_16x16x32_bf16 v[168:171], a[56:59], a[168:171], v[168:171]
    v_cvt_pk_bf16_f32 v50, v165, v197
    v_cvt_pk_bf16_f32 v52, v198, v135
    v_mfma_f32_16x16x32_bf16 v[168:171], a[60:63], a[172:175], v[168:171]
    ds_write_b64 v26, v[50:51] offset:8
    v_mfma_f32_16x16x32_bf16 v[168:171], a[32:35], a[104:107], v[168:171]
    ds_read_b128 a[236:239], v43 offset:6144
    v_cvt_pk_bf16_f32 v53, v167, v199
    v_mfma_f32_16x16x32_bf16 v[168:171], a[36:39], a[108:111], v[168:171]
    ds_write_b64 v26, v[52:53] offset:16
    v_mfma_f32_16x16x32_bf16 v[168:171], a[136:139], a[128:131], v[168:171]
    ds_read_b128 a[224:227], v42 offset:22528
    v_mul_f32 v136, v136, v96
    v_mfma_f32_16x16x32_bf16 v[168:171], a[140:143], a[132:135], v[168:171]
    v_mul_f32 v137, v137, v97
    v_mul_f32 v138, v138, v98
    v_mfma_f32_16x16x32_bf16 v[168:171], a[64:67], a[192:195], v[168:171]
    ds_read_b128 a[228:231], v43 offset:22528
    v_mul_f32 v139, v139, v99
    v_mfma_f32_16x16x32_bf16 v[168:171], a[68:71], a[196:199], v[168:171]
    v_mfma_f32_16x16x32_bf16 v[200:203], a[24:27], a[168:171], v[200:203]
    s_waitcnt lgkmcnt(2)
    s_barrier
    v_mfma_f32_16x16x32_bf16 v[200:203], a[28:31], a[172:175], v[200:203]
    ds_read_b128 v[68:71], v24 offset:0
    ds_read2st64_b32 v[72:73], v30 offset0:129 offset1:130
    v_mfma_f32_16x16x32_bf16 v[200:203], a[120:123], a[104:107], v[200:203]
    ds_read_b128 v[76:79], v24 offset:928
    v_mfma_f32_16x16x32_bf16 v[200:203], a[124:127], a[108:111], v[200:203]
    ds_read_b128 a[80:83], v40 offset:40960
    v_mul_f32 v168, v168, v104
    v_mfma_f32_16x16x32_bf16 v[200:203], a[8:11], a[128:131], v[200:203]
    v_cvt_pk_bf16_f32 v100, v136, v168
    v_mul_f32 v169, v169, v105
    v_mfma_f32_16x16x32_bf16 v[200:203], a[12:15], a[132:135], v[200:203]
    ds_read_b128 a[84:87], v41 offset:40960
    v_mul_f32 v170, v170, v106
    v_mfma_f32_16x16x32_bf16 v[200:203], a[72:75], a[192:195], v[200:203]
    v_cvt_pk_bf16_f32 v103, v138, v170
    v_mul_f32 v171, v171, v107
    v_mfma_f32_16x16x32_bf16 v[200:203], a[76:79], a[196:199], v[200:203]
    s_waitcnt lgkmcnt(3)
    v_mfma_f32_16x16x32_bf16 v[236:239], a[200:203], a[242:245], v[236:239]
    buffer_store_dwordx4 v[68:71], v25, s[16:19], s66 offen sc1
    v_mfma_f32_16x16x32_bf16 v[236:239], a[204:207], a[250:253], v[236:239]
    s_mov_b32 s66, 229376
    v_add_f32 v232, v232, v72
    v_mul_f32 v232, v232, v84
    v_mfma_f32_16x16x32_bf16 v[236:239], a[160:163], a[234:237], v[236:239]
    v_add_f32 v233, v233, v73
    v_mul_f32 v233, v233, v85
    v_mfma_f32_16x16x32_bf16 v[236:239], a[164:167], a[226:229], v[236:239]
    s_waitcnt lgkmcnt(2)
    ds_read_b128 a[0:3], v40 offset:57344
    v_mfma_f32_16x16x32_bf16 v[140:143], a[16:19], a[240:243], v[140:143]
    buffer_store_dwordx4 v[76:79], v25, s[16:19], s67 offen sc1
    v_mfma_f32_16x16x32_bf16 v[140:143], a[20:23], a[244:247], v[140:143]
    s_mov_b32 s67, 243712
    ds_read_b128 a[4:7], v41 offset:57344
    v_cvt_pk_bf16_f32 v72, v232, v233
    v_mfma_f32_16x16x32_bf16 v[140:143], a[48:51], a[248:251], v[140:143]
    ds_write_b32 v28, v72 offset:7424
    v_mfma_f32_16x16x32_bf16 v[140:143], a[52:55], a[252:255], v[140:143]
    ds_write_addtid_b32 v238 offset:0
    v_mul_f32 v200, v200, v108
    v_mfma_f32_16x16x32_bf16 v[140:143], a[88:91], a[232:235], v[140:143]
    ds_write_addtid_b32 v239 offset:256
    v_mul_f32 v201, v201, v109
    v_mfma_f32_16x16x32_bf16 v[140:143], a[92:95], a[236:239], v[140:143]
    v_mul_f32 v202, v202, v110
    v_mul_f32 v203, v203, v111
    v_mfma_f32_16x16x32_bf16 v[140:143], a[40:43], a[224:227], v[140:143]
    ds_read_b128 a[144:147], v42 offset:8192
    v_cvt_pk_bf16_f32 v101, v200, v137
    v_mfma_f32_16x16x32_bf16 v[140:143], a[44:47], a[228:231], v[140:143]
    ds_write_b64 v26, v[100:101] offset:7424
    v_mfma_f32_16x16x32_bf16 v[172:175], a[56:59], a[240:243], v[172:175]
    v_cvt_pk_bf16_f32 v102, v169, v201
    v_cvt_pk_bf16_f32 v64, v202, v139
    v_mfma_f32_16x16x32_bf16 v[172:175], a[60:63], a[244:247], v[172:175]
    ds_write_b64 v26, v[102:103] offset:7432
    v_mfma_f32_16x16x32_bf16 v[172:175], a[32:35], a[248:251], v[172:175]
    ds_read_b128 a[148:151], v43 offset:8192
    v_cvt_pk_bf16_f32 v65, v171, v203
    v_mfma_f32_16x16x32_bf16 v[172:175], a[36:39], a[252:255], v[172:175]
    ds_write_b64 v26, v[64:65] offset:7440
    v_mfma_f32_16x16x32_bf16 v[172:175], a[136:139], a[232:235], v[172:175]
    ds_read_b128 a[168:171], v42 offset:24576
    v_mul_f32 v140, v140, v96
    v_mfma_f32_16x16x32_bf16 v[172:175], a[140:143], a[236:239], v[172:175]
    v_mul_f32 v141, v141, v97
    v_mul_f32 v142, v142, v98
    v_mfma_f32_16x16x32_bf16 v[172:175], a[64:67], a[224:227], v[172:175]
    ds_read_b128 a[172:175], v43 offset:24576
    v_mul_f32 v143, v143, v99
    v_mfma_f32_16x16x32_bf16 v[172:175], a[68:71], a[228:231], v[172:175]
    v_mfma_f32_16x16x32_bf16 v[204:207], a[24:27], a[240:243], v[204:207]
    s_waitcnt lgkmcnt(2)
    s_barrier
    v_mfma_f32_16x16x32_bf16 v[204:207], a[28:31], a[244:247], v[204:207]
    ds_read_b128 v[80:83], v24 offset:7424
    ds_read2st64_b32 v[116:117], v30 offset0:0 offset1:1
    v_mfma_f32_16x16x32_bf16 v[204:207], a[120:123], a[248:251], v[204:207]
    ds_read_b128 v[120:123], v24 offset:8352
    v_mfma_f32_16x16x32_bf16 v[204:207], a[124:127], a[252:255], v[204:207]
    ds_read_b128 a[104:107], v40 offset:43008
    v_mul_f32 v172, v172, v104
    v_mfma_f32_16x16x32_bf16 v[204:207], a[8:11], a[232:235], v[204:207]
    v_cvt_pk_bf16_f32 v112, v140, v172
    v_mul_f32 v173, v173, v105
    v_mfma_f32_16x16x32_bf16 v[204:207], a[12:15], a[236:239], v[204:207]
    ds_read_b128 a[108:111], v41 offset:43008
    v_mul_f32 v174, v174, v106
    v_mfma_f32_16x16x32_bf16 v[204:207], a[72:75], a[224:227], v[204:207]
    v_cvt_pk_bf16_f32 v115, v142, v174
    v_mul_f32 v175, v175, v107
    v_mfma_f32_16x16x32_bf16 v[204:207], a[76:79], a[228:231], v[204:207]
    s_waitcnt lgkmcnt(3)
    v_mfma_f32_16x16x32_bf16 v[240:243], a[200:203], a[82:85], v[240:243]
    buffer_store_dwordx4 v[80:83], v25, s[16:19], s66 offen sc1
    v_mfma_f32_16x16x32_bf16 v[240:243], a[204:207], a[2:5], v[240:243]
    s_mov_b32 s66, 344064
    v_add_f32 v236, v236, v116
    v_mul_f32 v236, v236, v84
    v_mfma_f32_16x16x32_bf16 v[240:243], a[160:163], a[146:149], v[240:243]
    v_add_f32 v237, v237, v117
    v_mul_f32 v237, v237, v85
    v_mfma_f32_16x16x32_bf16 v[240:243], a[164:167], a[170:173], v[240:243]
    s_waitcnt lgkmcnt(2)
    ds_read_b128 a[128:131], v40 offset:59392
    v_mfma_f32_16x16x32_bf16 v[144:147], a[16:19], a[80:83], v[144:147]
    buffer_store_dwordx4 v[120:123], v25, s[16:19], s67 offen sc1
    v_mfma_f32_16x16x32_bf16 v[144:147], a[20:23], a[84:87], v[144:147]
    s_mov_b32 s67, 358400
    ds_read_b128 a[132:135], v41 offset:59392
    v_cvt_pk_bf16_f32 v116, v236, v237
    v_mfma_f32_16x16x32_bf16 v[144:147], a[48:51], a[0:3], v[144:147]
    ds_write_b32 v28, v116 offset:14848
    v_mfma_f32_16x16x32_bf16 v[144:147], a[52:55], a[4:7], v[144:147]
    ds_write_addtid_b32 v242 offset:2048
    v_mul_f32 v204, v204, v108
    v_mfma_f32_16x16x32_bf16 v[144:147], a[88:91], a[144:147], v[144:147]
    ds_write_addtid_b32 v243 offset:2304
    v_mul_f32 v205, v205, v109
    v_mfma_f32_16x16x32_bf16 v[144:147], a[92:95], a[148:151], v[144:147]
    v_mul_f32 v206, v206, v110
    v_mul_f32 v207, v207, v111
    v_mfma_f32_16x16x32_bf16 v[144:147], a[40:43], a[168:171], v[144:147]
    ds_read_b128 a[192:195], v42 offset:10240
    v_cvt_pk_bf16_f32 v113, v204, v141
    v_mfma_f32_16x16x32_bf16 v[144:147], a[44:47], a[172:175], v[144:147]
    ds_write_b64 v26, v[112:113] offset:14848
    v_mfma_f32_16x16x32_bf16 v[176:179], a[56:59], a[80:83], v[176:179]
    v_cvt_pk_bf16_f32 v114, v173, v205
    v_cvt_pk_bf16_f32 v124, v206, v143
    v_mfma_f32_16x16x32_bf16 v[176:179], a[60:63], a[84:87], v[176:179]
    ds_write_b64 v26, v[114:115] offset:14856
    v_mfma_f32_16x16x32_bf16 v[176:179], a[32:35], a[0:3], v[176:179]
    ds_read_b128 a[196:199], v43 offset:10240
    v_cvt_pk_bf16_f32 v125, v175, v207
    v_mfma_f32_16x16x32_bf16 v[176:179], a[36:39], a[4:7], v[176:179]
    ds_write_b64 v26, v[124:125] offset:14864
    v_mfma_f32_16x16x32_bf16 v[176:179], a[136:139], a[144:147], v[176:179]
    ds_read_b128 a[240:243], v42 offset:26624
    v_mul_f32 v144, v144, v96
    v_mfma_f32_16x16x32_bf16 v[176:179], a[140:143], a[148:151], v[176:179]
    v_mul_f32 v145, v145, v97
    v_mul_f32 v146, v146, v98
    v_mfma_f32_16x16x32_bf16 v[176:179], a[64:67], a[168:171], v[176:179]
    ds_read_b128 a[244:247], v43 offset:26624
    v_mul_f32 v147, v147, v99
    v_mfma_f32_16x16x32_bf16 v[176:179], a[68:71], a[172:175], v[176:179]
    s_waitcnt vmcnt(6)
    v_bitop3_b32 v45, v45, 15, v0 bitop3:0xbe
    v_lshlrev_b32 v45, 22, v45
    v_mfma_f32_16x16x32_bf16 v[208:211], a[24:27], a[80:83], v[208:211]
    s_waitcnt lgkmcnt(2)
    s_barrier
    v_mfma_f32_16x16x32_bf16 v[208:211], a[28:31], a[84:87], v[208:211]
    buffer_store_dword v47, v45, s[12:15], s78 offen sc1
    v_mfma_f32_16x16x32_bf16 v[208:211], a[120:123], a[0:3], v[208:211]
    ds_read_b128 v[92:95], v24 offset:14848
    ds_read2st64_b32 v[88:89], v30 offset0:8 offset1:9
    v_mfma_f32_16x16x32_bf16 v[208:211], a[124:127], a[4:7], v[208:211]
    ds_read_b128 v[48:51], v24 offset:15776
    v_mul_f32 v176, v176, v104
    v_mfma_f32_16x16x32_bf16 v[208:211], a[8:11], a[144:147], v[208:211]
    ds_read_b128 a[248:251], v40 offset:45056
    v_cvt_pk_bf16_f32 v52, v144, v176
    v_mfma_f32_16x16x32_bf16 v[208:211], a[12:15], a[148:151], v[208:211]
    ds_read_b128 a[252:255], v41 offset:45056
    v_mul_f32 v177, v177, v105
    v_mfma_f32_16x16x32_bf16 v[208:211], a[72:75], a[168:171], v[208:211]
    v_mul_f32 v178, v178, v106
    v_cvt_pk_bf16_f32 v55, v146, v178
    v_mfma_f32_16x16x32_bf16 v[208:211], a[76:79], a[172:175], v[208:211]
    v_mul_f32 v179, v179, v107
    v_mfma_f32_16x16x32_bf16 v[244:247], a[200:203], a[106:109], v[244:247]
    s_waitcnt lgkmcnt(3)
    v_mfma_f32_16x16x32_bf16 v[244:247], a[204:207], a[130:133], v[244:247]
    buffer_store_dwordx4 v[92:95], v25, s[16:19], s66 offen sc1
    v_mfma_f32_16x16x32_bf16 v[244:247], a[160:163], a[194:197], v[244:247]
    s_mov_b32 s66, 458752
    v_add_f32 v240, v240, v88
    v_mul_f32 v240, v240, v84
    v_mfma_f32_16x16x32_bf16 v[244:247], a[164:167], a[242:245], v[244:247]
    v_add_f32 v241, v241, v89
    v_mul_f32 v241, v241, v85
    v_mfma_f32_16x16x32_bf16 v[148:151], a[16:19], a[104:107], v[148:151]
    s_waitcnt lgkmcnt(2)
    ds_read_b128 a[232:235], v40 offset:61440
    v_mfma_f32_16x16x32_bf16 v[148:151], a[20:23], a[108:111], v[148:151]
    buffer_store_dwordx4 v[48:51], v25, s[16:19], s67 offen sc1
    v_mfma_f32_16x16x32_bf16 v[148:151], a[48:51], a[128:131], v[148:151]
    s_mov_b32 s67, 473088
    ds_read_b128 a[236:239], v41 offset:61440
    v_cvt_pk_bf16_f32 v88, v240, v241
    v_mfma_f32_16x16x32_bf16 v[148:151], a[52:55], a[132:135], v[148:151]
    ds_write_b32 v28, v88 offset:22272
    v_mfma_f32_16x16x32_bf16 v[148:151], a[88:91], a[192:195], v[148:151]
    ds_write_addtid_b32 v246 offset:4096
    v_mul_f32 v208, v208, v108
    v_mfma_f32_16x16x32_bf16 v[148:151], a[92:95], a[196:199], v[148:151]
    v_mul_f32 v209, v209, v109
    v_mul_f32 v210, v210, v110
    v_mfma_f32_16x16x32_bf16 v[148:151], a[40:43], a[240:243], v[148:151]
    v_mul_f32 v211, v211, v111
    v_cvt_pk_bf16_f32 v53, v208, v145
    v_mfma_f32_16x16x32_bf16 v[148:151], a[44:47], a[244:247], v[148:151]
    ds_write_b64 v26, v[52:53] offset:22272
    v_mfma_f32_16x16x32_bf16 v[180:183], a[56:59], a[104:107], v[180:183]
    v_cvt_pk_bf16_f32 v54, v177, v209
    v_cvt_pk_bf16_f32 v68, v210, v147
    v_mfma_f32_16x16x32_bf16 v[180:183], a[60:63], a[108:111], v[180:183]
    ds_read_b128 a[224:227], v42 offset:12288
    v_cvt_pk_bf16_f32 v69, v179, v211
    v_mfma_f32_16x16x32_bf16 v[180:183], a[32:35], a[128:131], v[180:183]
    ds_write_b64 v26, v[54:55] offset:22280
    v_mfma_f32_16x16x32_bf16 v[180:183], a[36:39], a[132:135], v[180:183]
    ds_write_b64 v26, v[68:69] offset:22288
    v_mfma_f32_16x16x32_bf16 v[180:183], a[136:139], a[192:195], v[180:183]
    ds_read_b128 a[228:231], v43 offset:12288
    ds_write_addtid_b32 v247 offset:4352
    v_mfma_f32_16x16x32_bf16 v[180:183], a[140:143], a[196:199], v[180:183]
    ds_read_b128 a[80:83], v42 offset:28672
    v_mul_f32 v148, v148, v96
    v_mfma_f32_16x16x32_bf16 v[180:183], a[64:67], a[240:243], v[180:183]
    ds_read_b128 a[84:87], v43 offset:28672
    v_mul_f32 v149, v149, v97
    v_mfma_f32_16x16x32_bf16 v[180:183], a[68:71], a[244:247], v[180:183]
    v_mul_f32 v150, v150, v98
    v_mul_f32 v151, v151, v99
    v_mfma_f32_16x16x32_bf16 v[212:215], a[24:27], a[104:107], v[212:215]
    v_mfma_f32_16x16x32_bf16 v[212:215], a[28:31], a[108:111], v[212:215]
    s_waitcnt lgkmcnt(2)
    s_barrier
    v_mfma_f32_16x16x32_bf16 v[212:215], a[120:123], a[128:131], v[212:215]
    ds_read_b128 v[76:79], v24 offset:22272
    ds_read2st64_b32 v[72:73], v30 offset0:16 offset1:17
    v_mfma_f32_16x16x32_bf16 v[212:215], a[124:127], a[132:135], v[212:215]
    ds_read_b128 v[100:103], v24 offset:23200
    v_mul_f32 v180, v180, v104
    v_mfma_f32_16x16x32_bf16 v[212:215], a[8:11], a[192:195], v[212:215]
    ds_read_b128 a[0:3], v40 offset:14336
    v_cvt_pk_bf16_f32 v64, v148, v180
    v_mfma_f32_16x16x32_bf16 v[212:215], a[12:15], a[196:199], v[212:215]
    ds_read_b128 a[4:7], v41 offset:14336
    v_mul_f32 v181, v181, v105
    v_mfma_f32_16x16x32_bf16 v[212:215], a[72:75], a[240:243], v[212:215]
    v_mul_f32 v182, v182, v106
    v_cvt_pk_bf16_f32 v67, v150, v182
    v_mfma_f32_16x16x32_bf16 v[212:215], a[76:79], a[244:247], v[212:215]
    v_mul_f32 v183, v183, v107
    v_mfma_f32_16x16x32_bf16 v[248:251], a[200:203], a[250:253], v[248:251]
    s_waitcnt lgkmcnt(3)
    v_mfma_f32_16x16x32_bf16 v[248:251], a[204:207], a[234:237], v[248:251]
    buffer_store_dwordx4 v[76:79], v25, s[16:19], s66 offen sc1
    v_mfma_f32_16x16x32_bf16 v[248:251], a[160:163], a[226:229], v[248:251]
    s_mov_b32 s66, 573440
    v_add_f32 v244, v244, v72
    v_mul_f32 v244, v244, v84
    v_mfma_f32_16x16x32_bf16 v[248:251], a[164:167], a[82:85], v[248:251]
    v_add_f32 v245, v245, v73
    v_mul_f32 v245, v245, v85
    v_mfma_f32_16x16x32_bf16 v[152:155], a[16:19], a[248:251], v[152:155]
    s_waitcnt lgkmcnt(2)
    ds_read_b128 a[144:147], v40 offset:30720
    v_mfma_f32_16x16x32_bf16 v[152:155], a[20:23], a[252:255], v[152:155]
    buffer_store_dwordx4 v[100:103], v25, s[16:19], s67 offen sc1
    v_mfma_f32_16x16x32_bf16 v[152:155], a[48:51], a[232:235], v[152:155]
    s_mov_b32 s67, 587776
    ds_read_b128 a[148:151], v41 offset:30720
    v_cvt_pk_bf16_f32 v72, v244, v245
    v_mfma_f32_16x16x32_bf16 v[152:155], a[52:55], a[236:239], v[152:155]
    ds_write_b32 v28, v72 offset:29696
    v_mfma_f32_16x16x32_bf16 v[152:155], a[88:91], a[224:227], v[152:155]
    ds_write_addtid_b32 v250 offset:6144
    v_mul_f32 v212, v212, v108
    v_mfma_f32_16x16x32_bf16 v[152:155], a[92:95], a[228:231], v[152:155]
    v_mul_f32 v213, v213, v109
    v_mul_f32 v214, v214, v110
    v_mfma_f32_16x16x32_bf16 v[152:155], a[40:43], a[80:83], v[152:155]
    v_mul_f32 v215, v215, v111
    v_cvt_pk_bf16_f32 v65, v212, v149
    v_mfma_f32_16x16x32_bf16 v[152:155], a[44:47], a[84:87], v[152:155]
    ds_write_b64 v26, v[64:65] offset:29696
    v_mfma_f32_16x16x32_bf16 v[184:187], a[56:59], a[248:251], v[184:187]
    v_cvt_pk_bf16_f32 v66, v181, v213
    v_cvt_pk_bf16_f32 v80, v214, v151
    v_mfma_f32_16x16x32_bf16 v[184:187], a[60:63], a[252:255], v[184:187]
    ds_read_b128 a[168:171], v40 offset:47104
    v_cvt_pk_bf16_f32 v81, v183, v215
    v_mfma_f32_16x16x32_bf16 v[184:187], a[32:35], a[232:235], v[184:187]
    ds_write_b64 v26, v[66:67] offset:29704
    v_mfma_f32_16x16x32_bf16 v[184:187], a[36:39], a[236:239], v[184:187]
    ds_write_b64 v26, v[80:81] offset:29712
    v_mfma_f32_16x16x32_bf16 v[184:187], a[136:139], a[224:227], v[184:187]
    ds_read_b128 a[172:175], v41 offset:47104
    ds_write_addtid_b32 v251 offset:6400
    v_mfma_f32_16x16x32_bf16 v[184:187], a[140:143], a[228:231], v[184:187]
    ds_read_b128 a[104:107], v40 offset:63488
    v_mul_f32 v152, v152, v96
    v_mfma_f32_16x16x32_bf16 v[184:187], a[64:67], a[80:83], v[184:187]
    ds_read_b128 a[108:111], v41 offset:63488
    v_mul_f32 v153, v153, v97
    v_mfma_f32_16x16x32_bf16 v[184:187], a[68:71], a[84:87], v[184:187]
    v_mul_f32 v154, v154, v98
    v_mul_f32 v155, v155, v99
    v_mfma_f32_16x16x32_bf16 v[216:219], a[24:27], a[248:251], v[216:219]
    ds_read_b128 a[128:131], v42 offset:14336
    v_mfma_f32_16x16x32_bf16 v[216:219], a[28:31], a[252:255], v[216:219]
    s_waitcnt lgkmcnt(3)
    s_barrier
    v_mfma_f32_16x16x32_bf16 v[216:219], a[120:123], a[232:235], v[216:219]
    ds_read_b128 a[132:135], v43 offset:14336
    ds_read2st64_b32 v[120:121], v30 offset0:24 offset1:25
    v_mfma_f32_16x16x32_bf16 v[216:219], a[124:127], a[236:239], v[216:219]
    ds_read_b128 a[192:195], v42 offset:30720
    v_mul_f32 v184, v184, v104
    v_mfma_f32_16x16x32_bf16 v[216:219], a[8:11], a[224:227], v[216:219]
    ds_read_b128 a[196:199], v43 offset:30720
    v_cvt_pk_bf16_f32 v116, v152, v184
    v_mfma_f32_16x16x32_bf16 v[216:219], a[12:15], a[228:231], v[216:219]
    ds_read_b128 v[112:115], v24 offset:29696
    v_mul_f32 v185, v185, v105
    v_mfma_f32_16x16x32_bf16 v[216:219], a[72:75], a[80:83], v[216:219]
    ds_read_b128 v[124:127], v24 offset:30624
    v_mul_f32 v186, v186, v106
    v_mfma_f32_16x16x32_bf16 v[216:219], a[76:79], a[84:87], v[216:219]
    v_cvt_pk_bf16_f32 v119, v154, v186
    v_mul_f32 v187, v187, v107
    v_mfma_f32_16x16x32_bf16 v[252:255], a[152:155], a[2:5], v[252:255]
    v_mfma_f32_16x16x32_bf16 v[252:255], a[156:159], a[146:149], v[252:255]
    s_waitcnt lgkmcnt(4)
    v_add_f32 v248, v248, v120
    v_mul_f32 v248, v248, v84
    v_mfma_f32_16x16x32_bf16 v[252:255], a[200:203], a[170:173], v[252:255]
    v_add_f32 v249, v249, v121
    v_mul_f32 v249, v249, v85
    v_mfma_f32_16x16x32_bf16 v[252:255], a[204:207], a[106:109], v[252:255]
    s_waitcnt lgkmcnt(1)
    v_cvt_pk_bf16_f32 v120, v248, v249
    v_mfma_f32_16x16x32_bf16 v[252:255], a[160:163], a[130:133], v[252:255]
    buffer_store_dwordx4 v[112:115], v25, s[16:19], s66 offen sc1
    v_mfma_f32_16x16x32_bf16 v[252:255], a[164:167], a[194:197], v[252:255]
    s_mov_b32 s66, 688128
    ds_write_b32 v28, v120 offset:37120
    v_mfma_f32_16x16x32_bf16 v[156:159], a[96:99], a[0:3], v[156:159]
    v_mul_f32 v216, v216, v108
    v_mul_f32 v217, v217, v109
    v_mfma_f32_16x16x32_bf16 v[156:159], a[100:103], a[4:7], v[156:159]
    s_waitcnt lgkmcnt(1)
    v_mul_f32 v218, v218, v110
    v_mfma_f32_16x16x32_bf16 v[156:159], a[184:187], a[144:147], v[156:159]
    buffer_store_dwordx4 v[124:127], v25, s[16:19], s67 offen sc1
    v_mfma_f32_16x16x32_bf16 v[156:159], a[188:191], a[148:151], v[156:159]
    s_mov_b32 s67, 702464
    ds_write_addtid_b32 v254 offset:8192
    v_mul_f32 v219, v219, v111
    v_mfma_f32_16x16x32_bf16 v[156:159], a[16:19], a[168:171], v[156:159]
    ds_write_addtid_b32 v255 offset:8448
    v_cvt_pk_bf16_f32 v117, v216, v153
    v_mfma_f32_16x16x32_bf16 v[156:159], a[20:23], a[172:175], v[156:159]
    ds_write_b64 v26, v[116:117] offset:37120
    v_mfma_f32_16x16x32_bf16 v[156:159], a[48:51], a[104:107], v[156:159]
    v_cvt_pk_bf16_f32 v118, v185, v217
    v_cvt_pk_bf16_f32 v92, v218, v155
    v_mfma_f32_16x16x32_bf16 v[156:159], a[52:55], a[108:111], v[156:159]
    ds_write_b64 v26, v[118:119] offset:37128
    v_mfma_f32_16x16x32_bf16 v[156:159], a[88:91], a[128:131], v[156:159]
    v_cvt_pk_bf16_f32 v93, v187, v219
    v_mfma_f32_16x16x32_bf16 v[156:159], a[92:95], a[132:135], v[156:159]
    ds_write_b64 v26, v[92:93] offset:37136
    v_mfma_f32_16x16x32_bf16 v[156:159], a[40:43], a[192:195], v[156:159]
    v_mfma_f32_16x16x32_bf16 v[156:159], a[44:47], a[196:199], v[156:159]
    v_mfma_f32_16x16x32_bf16 v[188:191], a[176:179], a[0:3], v[188:191]
    v_mfma_f32_16x16x32_bf16 v[188:191], a[180:183], a[4:7], v[188:191]
    v_mfma_f32_16x16x32_bf16 v[188:191], a[208:211], a[144:147], v[188:191]
    s_waitcnt lgkmcnt(0)
    s_barrier
    v_mfma_f32_16x16x32_bf16 v[188:191], a[212:215], a[148:151], v[188:191]
    ds_read_b128 v[48:51], v24 offset:37120
    ds_read2st64_b32 v[88:89], v30 offset0:32 offset1:33
    v_mfma_f32_16x16x32_bf16 v[188:191], a[56:59], a[168:171], v[188:191]
    ds_read_b128 v[52:55], v24 offset:38048
    v_mul_f32 v156, v156, v96
    v_mfma_f32_16x16x32_bf16 v[188:191], a[60:63], a[172:175], v[188:191]
    v_mul_f32 v157, v157, v97
    v_mul_f32 v158, v158, v98
    v_mfma_f32_16x16x32_bf16 v[188:191], a[32:35], a[104:107], v[188:191]
    v_mul_f32 v159, v159, v99
    v_mfma_f32_16x16x32_bf16 v[188:191], a[36:39], a[108:111], v[188:191]
    v_mfma_f32_16x16x32_bf16 v[188:191], a[136:139], a[128:131], v[188:191]
    v_mfma_f32_16x16x32_bf16 v[188:191], a[140:143], a[132:135], v[188:191]
    s_waitcnt lgkmcnt(1)
    v_mfma_f32_16x16x32_bf16 v[188:191], a[64:67], a[192:195], v[188:191]
    buffer_store_dwordx4 v[48:51], v25, s[16:19], s66 offen sc1
    v_mfma_f32_16x16x32_bf16 v[188:191], a[68:71], a[196:199], v[188:191]
    s_mov_b32 s66, 802816
    v_add_f32 v252, v252, v88
    v_mul_f32 v252, v252, v84
    v_mfma_f32_16x16x32_bf16 v[220:223], a[112:115], a[0:3], v[220:223]
    v_add_f32 v253, v253, v89
    v_mul_f32 v253, v253, v85
    v_mfma_f32_16x16x32_bf16 v[220:223], a[116:119], a[4:7], v[220:223]
    s_waitcnt lgkmcnt(0)
    v_cvt_pk_bf16_f32 v88, v252, v253
    v_mfma_f32_16x16x32_bf16 v[220:223], a[216:219], a[144:147], v[220:223]
    buffer_store_dwordx4 v[52:55], v25, s[16:19], s67 offen sc1
    v_mfma_f32_16x16x32_bf16 v[220:223], a[220:223], a[148:151], v[220:223]
    s_mov_b32 s67, 817152
    ds_write_b32 v28, v88 offset:44544
    v_mfma_f32_16x16x32_bf16 v[220:223], a[24:27], a[168:171], v[220:223]
    v_mul_f32 v188, v188, v104
    v_cvt_pk_bf16_f32 v68, v156, v188
    v_mfma_f32_16x16x32_bf16 v[220:223], a[28:31], a[172:175], v[220:223]
    v_mul_f32 v189, v189, v105
    v_mul_f32 v190, v190, v106
    v_mfma_f32_16x16x32_bf16 v[220:223], a[120:123], a[104:107], v[220:223]
    v_cvt_pk_bf16_f32 v71, v158, v190
    v_mul_f32 v191, v191, v107
    v_mfma_f32_16x16x32_bf16 v[220:223], a[124:127], a[108:111], v[220:223]
    v_mfma_f32_16x16x32_bf16 v[220:223], a[8:11], a[128:131], v[220:223]
    v_mfma_f32_16x16x32_bf16 v[220:223], a[12:15], a[132:135], v[220:223]
    v_mfma_f32_16x16x32_bf16 v[220:223], a[72:75], a[192:195], v[220:223]
    v_mfma_f32_16x16x32_bf16 v[220:223], a[76:79], a[196:199], v[220:223]
    s_nop 7
    v_mul_f32 v220, v220, v108
    v_mul_f32 v221, v221, v109
    v_mul_f32 v222, v222, v110
    v_mul_f32 v223, v223, v111
    v_cvt_pk_bf16_f32 v69, v220, v157
    v_cvt_pk_bf16_f32 v70, v189, v221
    v_cvt_pk_bf16_f32 v76, v222, v159
    v_cvt_pk_bf16_f32 v77, v191, v223
    ds_write_b64 v26, v[68:69] offset:44544
    ds_write_b64 v26, v[70:71] offset:44552
    ds_write_b64 v26, v[76:77] offset:44560
    s_waitcnt lgkmcnt(0)
    s_barrier
    ds_read_b128 v[100:103], v24 offset:44544
    ds_read_b128 v[72:75], v24 offset:45472
    s_waitcnt lgkmcnt(1)
    buffer_store_dwordx4 v[100:103], v25, s[16:19], s66 offen sc1
    s_waitcnt lgkmcnt(0)
    buffer_store_dwordx4 v[72:75], v25, s[16:19], s67 offen sc1
L_end:
    s_endpgm
L_help:
    s_mov_b32 s53, s61
    s_mov_b32 s54, s62
    s_mul_i32 s61, s22, 1835008
    s_add_u32 s61, s61, s79
    s_lshl_b32 s62, s22, 14
    s_add_u32 s62, s62, s68
    s_mov_b32 s22, 0
L_help_row:
    v_mov_b32 v21, v19
    s_xor_b32 s23, s22, s58
    s_bitcmp0_b32 s23, 2
    s_cbranch_scc1 L_help_same
    v_add_u32 v12, 57344, v19
    v_subrev_u32 v13, 57344, v19
    v_min_u32 v21, v12, v13
L_help_same:
    v_mov_b32 v8, 0
    v_mov_b32 v9, 0
    v_mov_b32 v10, 0
    v_mov_b32 v11, 0
    s_mov_b32 s23, 0
L_help_e:
    v_mov_b32 v15, 0
    buffer_load_dwordx3 v[12:14], v18, s[4:7], s61 offen nt
    s_cmp_ge_u32 s23, 16
    s_cbranch_scc1 L_help_own
    buffer_load_dword v15, v21, s[4:7], s61 offen nt
L_help_own:
    s_waitcnt vmcnt(0)
    v_lshl_or_b32 v8, v12, s23, v8
    v_lshl_or_b32 v9, v13, s23, v9
    v_lshl_or_b32 v10, v14, s23, v10
    v_lshl_or_b32 v11, v15, s23, v11
    s_add_u32 s61, s61, 14336
    s_add_u32 s23, s23, 4
    s_cmp_lt_u32 s23, 32
    s_cbranch_scc1 L_help_e
    v_mov_b32_sdwa v11, s76 dst_sel:WORD_1 dst_unused:UNUSED_PRESERVE src0_sel:WORD_1
    s_nop 1
    buffer_store_dwordx4 v[8:11], v20, s[12:15], s62 offen sc1
    s_add_u32 s62, s62, 1024
    s_waitcnt vmcnt(0)
    s_add_u32 s22, s22, 1
    s_cmp_lt_u32 s22, 16
    s_cbranch_scc1 L_help_row
    s_mov_b32 s61, s53
    s_mov_b32 s62, s54
    s_setpc_b64 s[20:21]
L_code_end:

.section .rodata,"a"
.p2align 6
.amdhsa_kernel standalone__normalfloat_lut_af4__prompt_kernel
  .amdhsa_next_free_vgpr 512
  .amdhsa_next_free_sgpr 102
  .amdhsa_accum_offset 256
  .amdhsa_group_segment_fixed_size 0
  .amdhsa_kernarg_size 56
  .amdhsa_user_sgpr_count 2
  .amdhsa_user_sgpr_kernarg_segment_ptr 1
  .amdhsa_system_sgpr_workgroup_id_x 1
.end_amdhsa_kernel
```
